```python
import torch

def _softmax(x, axis=-1):
    return torch.softmax(x, dim=axis)

def _gelu(x):
    return torch.nn.functional.gelu(x, approximate='tanh')

def _silu(x):
    return torch.nn.functional.silu(x)

def _sigmoid(x):
    return torch.sigmoid(x)

def _layernorm(x, axis=-1, eps=1e-05):
    m = x.mean(dim=axis, keepdim=True)
    v = x.var(dim=axis, keepdim=True, unbiased=False)
    return (x - m) / torch.sqrt(v + eps)

def _scatter_add(tgt, idx, src, axis=0):
    return tgt.clone().index_add_(axis, idx, src)

def _segment_sum(src, seg, n):
    out = torch.zeros((n,) + src.shape[1:], dtype=src.dtype)
    return out.index_add_(0, seg, src)

def _pad(x, pw):
    flat = tuple((v for pair in reversed(pw) for v in pair))
    return torch.nn.functional.pad(x, flat)
kernel_name = 'adaLN_cond__sliding_block_cached__glu_gated_swiglu__decode'

def setup_inputs():

    _w = lambda a: (lambda t: t.to(torch.bfloat16) if t.is_floating_point() else t)(torch.as_tensor(a))

    def _A_setup():
        B, Sq, D = (2, 1, 512)
        Hq, Hkv, Sk, Dh = (32, 32, 16384, 128)
        assert Hq % Hkv == 0, (Hq, Hkv)
        return {'x': _w((lambda *s: torch.randn(*s, dtype=torch.bfloat16) * 0.05)(B, Sq, D)), 'k_cache': _w((lambda *s: torch.randn(*s, dtype=torch.bfloat16) * 3.2)(B, Hkv, Sk, Dh)), 'v_cache': _w((lambda *s: torch.randn(*s, dtype=torch.bfloat16) * 3.2)(B, Hkv, Sk, Dh)), 'wq': _w((lambda *s: torch.randn(*s, dtype=torch.bfloat16) * 3.2)(D, Hq * Dh) * D ** (-0.5)), 'wo': _w((lambda *s: torch.randn(*s, dtype=torch.bfloat16) * 3.2)(Hq * Dh, D) * (Hq * Dh) ** (-0.5))}
    _A_in = _A_setup()

    def _B_setup():
        B, S, D, F = (2, 1, 512, 1376)
        return {'x': _w((lambda *s: torch.randn(*s, dtype=torch.bfloat16) * 0.05)(B, S, D)), 'w1': _w((lambda *s: torch.randn(*s, dtype=torch.bfloat16) * 1.6)(D, F) * (2.0 / D) ** 0.5), 'w3': _w((lambda *s: torch.randn(*s, dtype=torch.bfloat16) * 1.6)(D, F) * (2.0 / D) ** 0.5), 'w2': _w((lambda *s: torch.randn(*s, dtype=torch.bfloat16) * 1.6)(F, D) * (2.0 / F) ** 0.5)}
    _B_in = _B_setup()
    return {'A_x': _A_in['x'], 'A_k_cache': _A_in['k_cache'], 'A_v_cache': _A_in['v_cache'], 'A_wq': _A_in['wq'], 'A_wo': _A_in['wo'], 'B_x': _B_in['x'], 'B_w1': _B_in['w1'], 'B_w3': _B_in['w3'], 'B_w2': _B_in['w2'], 'c': _w((lambda *s: torch.randn(*s, dtype=torch.bfloat16) * 0.2)(2, 512) * 8.0), 'w_mod': _w((lambda *s: torch.randn(*s, dtype=torch.bfloat16) * 0.2)(512, 6 * 512) * 512 ** (-0.5) * 8.0)}

def reference(A_x, A_k_cache, A_v_cache, A_wq, A_wo, B_x, B_w1, B_w3, B_w2, c, w_mod):

    def _A_ref(x, k_cache, v_cache, wq, wo):
        B, Sq, D = x.shape
        Hq, Dh = (32, 128)
        Hkv, Sk = (k_cache.shape[1], k_cache.shape[2])
        W = min(4096, max(256, Sk // 4))
        rep = Hq // Hkv
        q = (lambda x, *d: x.permute(*d))((x @ wq).reshape(B, Sq, Hq, Dh), 0, 2, 1, 3)
        k = (lambda x, n, axis: torch.repeat_interleave(x, n, dim=axis))(k_cache[:, :, Sk - W:, :], rep, axis=1)
        v = (lambda x, n, axis: torch.repeat_interleave(x, n, dim=axis))(v_cache[:, :, Sk - W:, :], rep, axis=1)
        scores = torch.einsum('bhqd,bhkd->bhqk', q, k) * Dh ** (-0.5)
        p = _softmax(scores, axis=-1)
        o = torch.einsum('bhqk,bhkd->bhqd', p, v)
        return (lambda x, *d: x.permute(*d))(o, 0, 2, 1, 3).reshape(B, Sq, Hq * Dh) @ wo

    def _B_ref(x, w1, w3, w2):
        gate = torch.einsum('bsd,df->bsf', x, w1)
        up = torch.einsum('bsd,df->bsf', x, w3)
        h = _silu(gate) * up
        out = torch.einsum('bsf,fd->bsd', h, w2)
        return out
    x = A_x
    mod = (_silu(c) @ w_mod).reshape(c.shape[0], 6, 1, -1)
    sa, ca, ga, sb, cb, gb = (mod[:, 0].clone(), mod[:, 1].clone(), mod[:, 2].clone(), mod[:, 3].clone(), mod[:, 4].clone(), mod[:, 5].clone())
    h = _layernorm(x, axis=-1) * (1 + ca) + sa
    x = x + ga * _A_ref(h, A_k_cache, A_v_cache, A_wq, A_wo)
    h = _layernorm(x, axis=-1) * (1 + cb) + sb
    x = x + gb * _B_ref(h, B_w1, B_w3, B_w2)
    return x
```

```asm
; @launch grid=(256,1,1) block=(768,1,1) lds=151552
.amdgcn_target "amdgcn-amd-amdhsa--gfx950"
.text
.globl adaLN_cond__sliding_block_cached__glu_gated_swiglu__decode_kernel
.p2align 8
.type adaLN_cond__sliding_block_cached__glu_gated_swiglu__decode_kernel,@function
adaLN_cond__sliding_block_cached__glu_gated_swiglu__decode_kernel:
  s_cmpk_ge_u32 s2, 256
  s_cbranch_scc1 L_end
  s_load_dwordx2 s[44:45], s[0:1], 8
  v_readfirstlane_b32 s5, v0
  s_and_b32 s6, s2, 63
  s_lshr_b32 s7, s2, 6
  s_lshr_b32 s5, s5, 6
  v_and_b32 v1, 63, v0
  s_cmp_lt_u32 s5, 4
  s_cbranch_scc1 L_helper
  s_lshl_b32 s10, s6, 22
  s_mul_i32 s58, s7, 229376
  s_add_u32 s11, s10, 3141632
  v_lshl_add_u32 v2, v0, 4, s11
  s_lshl_b32 s46, 1, 28
  s_lshl_b32 s47, 1, 17
  s_mul_i32 s12, s6, 5
  s_and_b32 s12, s12, 15
  s_lshl_b32 s12, s12, 13
  s_add_u32 s12, s12, s58
  s_waitcnt lgkmcnt(0)
L_nb1:
  buffer_load_dwordx4 v[56:59], v2, s[44:47], s12 offen nt
  s_addk_i32 s12, 0x2000
  buffer_load_dwordx4 v[60:63], v2, s[44:47], s12 offen nt
  s_addk_i32 s12, 0x2000
  buffer_load_dwordx4 v[64:67], v2, s[44:47], s12 offen nt
  s_addk_i32 s12, 0x2000
  buffer_load_dwordx4 v[68:71], v2, s[44:47], s12 offen nt
  s_addk_i32 s12, 0x2000
  s_getpc_b64 s[56:57]
L_pc:
  s_lshl_b32 s3, s2, 2
  s_add_u32 s3, s3, L_table-L_pc
  s_load_dword s14, s[56:57], s3
  s_load_dwordx2 s[48:49], s[0:1], 16
  s_load_dwordx4 s[20:23], s[0:1], 24
  s_load_dwordx2 s[28:29], s[0:1], 80
  s_barrier
  s_sub_u32 s9, s5, 4
  s_and_b32 s68, s2, 7
  s_lshr_b32 s68, 85, s68
  s_mov_b64 s[50:51], s[46:47]
  s_mov_b32 s52, 0xcccccccc
  s_mov_b32 s53, 0xcccccccc
  s_mov_b32 s54, 0xaaaaaaaa
  s_mov_b32 s55, 0xaaaaaaaa
  s_mul_i32 s15, s9, 8192
  s_add_u32 s15, s15, 86016
  s_add_u32 s59, s58, 229376
  v_mov_b32 v4, 0
  v_lshrrev_b32 v5, 3, v1
  v_and_b32 v6, 6, v5
  v_xor_b32 v6, v6, v1
  v_and_b32 v6, 7, v6
  s_lshl_b32 s33, s9, 6
  s_movk_i32 s26, 6144
  s_mov_b32 s30, 3145728
  s_mov_b32 s31, s47
  s_lshl_b32 s34, s9, 13
  s_add_u32 s34, s34, 20480
  s_add_u32 s35, s34, 8192
  s_and_b32 s36, s2, 7
  s_lshl_b32 s36, s36, 1
  s_and_b32 s37, s9, 1
  s_add_u32 s36, s36, s37
  s_lshr_b32 s37, s9, 1
  s_lshl_b32 s37, s37, 4
  s_add_u32 s36, s36, s37
  s_lshl_b32 s36, s36, 6
  s_waitcnt lgkmcnt(0)
  s_and_b32 s27, s14, 7
  s_cmp_eq_u32 s27, 6
  s_cselect_b64 s[28:29], s[20:21], s[28:29]
  s_cselect_b32 s26, 0x2000, s26
  s_cselect_b32 s30, 0x400000, s30
  s_cmp_eq_u32 s27, 1
  s_cselect_b64 s[28:29], s[22:23], s[28:29]
  s_cselect_b32 s26, 0x400, s26
  s_cselect_b32 s30, 0x400000, s30
  s_cselect_b32 s33, s36, s33
  s_cselect_b32 s27, 4, s27
  v_mul_u32_u24 v5, s26, v5
  v_lshl_add_u32 v5, v6, 4, v5
  v_mov_b32 v6, 1
  s_mul_i32 s33, s33, s26
  s_bfe_u32 s32, s14, 0x60003
  s_lshl_b32 s32, s32, 7
  s_add_u32 s33, s33, s32
  s_lshl_b32 s26, s26, 3
  s_cmp_lt_u32 s27, 4
  s_cbranch_scc1 L_we_2
L_wl_1:
  s_mov_b32 m0, s34
  s_waitcnt vmcnt(3)
  buffer_load_dwordx4 v5, s[28:31], s33 offen nt lds
  s_add_u32 s33, s33, s26
  s_addk_i32 s34, 1024
  s_cmp_lt_u32 s34, s35
  s_cbranch_scc1 L_wl_1
L_we_2:
  s_waitcnt vmcnt(3)
  buffer_load_dwordx4 v[72:75], v2, s[44:47], s12 offen nt
  s_addk_i32 s12, 0x2000
  s_waitcnt vmcnt(3)
  s_bitcmp0_b32 s68, 0
  s_cbranch_scc1 L_th_3
  s_waitcnt vmcnt(2)
L_th_3:
  buffer_load_dwordx4 v[76:79], v2, s[44:47], s12 offen nt
  s_addk_i32 s12, 0x2000
  s_waitcnt vmcnt(3)
  buffer_load_dwordx4 v[80:83], v2, s[44:47], s12 offen nt
  s_addk_i32 s12, 0x2000
  s_waitcnt vmcnt(3)
  s_bitcmp0_b32 s68, 0
  s_cbranch_scc1 L_th_4
  s_waitcnt vmcnt(2)
L_th_4:
  buffer_load_dwordx4 v[84:87], v2, s[44:47], s12 offen nt
  s_addk_i32 s12, 0x2000
  s_cmp_lt_u32 s27, 4
  s_cbranch_scc1 L_ws_5
  s_mov_b64 exec, 1
  ds_add_u32 v4, v6 offset:6720
  s_mov_b64 exec, -1
L_ws_5:
  s_waitcnt vmcnt(3)
  buffer_load_dwordx4 v[88:91], v2, s[44:47], s12 offen nt
  s_addk_i32 s12, 0x2000
  s_waitcnt vmcnt(3)
  s_bitcmp0_b32 s68, 0
  s_cbranch_scc1 L_th_6
  s_waitcnt vmcnt(2)
L_th_6:
  buffer_load_dwordx4 v[92:95], v2, s[44:47], s12 offen nt
  s_addk_i32 s12, 0x2000
  s_waitcnt vmcnt(3)
  buffer_load_dwordx4 v[96:99], v2, s[44:47], s12 offen nt
  s_addk_i32 s12, 0x2000
  s_waitcnt vmcnt(3)
  s_bitcmp0_b32 s68, 0
  s_cbranch_scc1 L_th_7
  s_waitcnt vmcnt(2)
L_th_7:
  buffer_load_dwordx4 v[100:103], v2, s[44:47], s12 offen nt
  s_addk_i32 s12, 0x2000
  s_bfe_u32 s61, s14, 0xa0010
  s_lshl_b32 s61, s61, 10
  s_bfe_u32 s60, s14, 0x70009
  s_sub_u32 s60, s9, s60
  s_add_u32 s60, s60, 64
  s_lshr_b32 s60, s60, 3
  v_bfrev_b32 v3, v1
  v_lshrrev_b32 v3, 28, v3
  v_cmp_gt_u32 s[66:67], s60, v3
  v_and_b32 v3, 15, v1
  v_lshlrev_b32 v3, 4, v3
  s_mov_b32 s13, s61
  s_cmp_gt_u32 s60, 7
  s_cbranch_scc1 L_opts_8
  s_waitcnt vmcnt(3)
  buffer_load_dwordx4 v[52:55], v2, s[44:47], s13 offen nt
  s_addk_i32 s13, 0x2000
  s_cmp_gt_u32 s60, 6
  s_cbranch_scc1 L_opts_8
  s_waitcnt vmcnt(3)
  s_bitcmp0_b32 s68, 0
  s_cbranch_scc1 L_th_9
  s_waitcnt vmcnt(2)
L_th_9:
  buffer_load_dwordx4 v[48:51], v2, s[44:47], s13 offen nt
  s_addk_i32 s13, 0x2000
  s_cmp_gt_u32 s60, 5
  s_cbranch_scc1 L_opts_8
  s_waitcnt vmcnt(3)
  buffer_load_dwordx4 v[44:47], v2, s[44:47], s13 offen nt
  s_addk_i32 s13, 0x2000
  s_cmp_gt_u32 s60, 4
  s_cbranch_scc1 L_opts_8
  s_waitcnt vmcnt(3)
  s_bitcmp0_b32 s68, 0
  s_cbranch_scc1 L_th_10
  s_waitcnt vmcnt(2)
L_th_10:
  buffer_load_dwordx4 v[40:43], v2, s[44:47], s13 offen nt
  s_addk_i32 s13, 0x2000
  s_cmp_gt_u32 s60, 3
  s_cbranch_scc1 L_opts_8
  s_waitcnt vmcnt(3)
  buffer_load_dwordx4 v[36:39], v2, s[44:47], s13 offen nt
  s_addk_i32 s13, 0x2000
  s_cmp_gt_u32 s60, 2
  s_cbranch_scc1 L_opts_8
  s_waitcnt vmcnt(3)
  s_bitcmp0_b32 s68, 0
  s_cbranch_scc1 L_th_11
  s_waitcnt vmcnt(2)
L_th_11:
  buffer_load_dwordx4 v[32:35], v2, s[44:47], s13 offen nt
  s_addk_i32 s13, 0x2000
  s_cmp_gt_u32 s60, 1
  s_cbranch_scc1 L_opts_8
  s_waitcnt vmcnt(3)
  buffer_load_dwordx4 v[28:31], v2, s[44:47], s13 offen nt
  s_addk_i32 s13, 0x2000
  s_cmp_gt_u32 s60, 0
  s_cbranch_scc1 L_opts_8
  s_waitcnt vmcnt(3)
  s_bitcmp0_b32 s68, 0
  s_cbranch_scc1 L_th_12
  s_waitcnt vmcnt(2)
L_th_12:
  buffer_load_dwordx4 v[24:27], v2, s[44:47], s13 offen nt
  s_addk_i32 s13, 0x2000
L_opts_8:
  s_waitcnt vmcnt(3)
  buffer_load_dwordx4 v[104:107], v2, s[44:47], s12 offen nt
  s_addk_i32 s12, 0x2000
  s_cmp_ge_u32 s12, s59
  s_cselect_b32 s12, s58, s12
  s_waitcnt vmcnt(3)
  s_bitcmp0_b32 s68, 0
  s_cbranch_scc1 L_th_13
  s_waitcnt vmcnt(2)
L_th_13:
  buffer_load_dwordx4 v[108:111], v2, s[44:47], s12 offen nt
  s_addk_i32 s12, 0x2000
  s_cmp_ge_u32 s12, s59
  s_cselect_b32 s12, s58, s12
  s_waitcnt vmcnt(3)
  buffer_load_dwordx4 v[112:115], v2, s[44:47], s12 offen nt
  s_addk_i32 s12, 0x2000
  s_cmp_ge_u32 s12, s59
  s_cselect_b32 s12, s58, s12
  s_waitcnt vmcnt(3)
  s_bitcmp0_b32 s68, 0
  s_cbranch_scc1 L_th_14
  s_waitcnt vmcnt(2)
L_th_14:
  buffer_load_dwordx4 v[116:119], v2, s[44:47], s12 offen nt
  s_addk_i32 s12, 0x2000
  s_cmp_ge_u32 s12, s59
  s_cselect_b32 s12, s58, s12
  ds_write_b32 v4, v4 offset:6672
  s_waitcnt vmcnt(3)
  buffer_load_dwordx4 v[120:123], v2, s[44:47], s12 offen nt
  s_addk_i32 s12, 0x2000
  s_cmp_ge_u32 s12, s59
  s_cselect_b32 s12, s58, s12
  s_waitcnt vmcnt(3)
  s_bitcmp0_b32 s68, 0
  s_cbranch_scc1 L_th_15
  s_waitcnt vmcnt(2)
L_th_15:
  buffer_load_dwordx4 v[124:127], v2, s[44:47], s12 offen nt
  s_addk_i32 s12, 0x2000
  s_cmp_ge_u32 s12, s59
  s_cselect_b32 s12, s58, s12
  s_waitcnt vmcnt(3)
  buffer_load_dwordx4 v[128:131], v2, s[44:47], s12 offen nt
  s_addk_i32 s12, 0x2000
  s_cmp_ge_u32 s12, s59
  s_cselect_b32 s12, s58, s12
  s_waitcnt vmcnt(3)
  s_bitcmp0_b32 s68, 0
  s_cbranch_scc1 L_th_16
  s_waitcnt vmcnt(2)
L_th_16:
  buffer_load_dwordx4 v[132:135], v2, s[44:47], s12 offen nt
  s_addk_i32 s12, 0x2000
  s_cmp_ge_u32 s12, s59
  s_cselect_b32 s12, s58, s12
  s_waitcnt vmcnt(3)
  buffer_load_dwordx4 v[136:139], v2, s[44:47], s12 offen nt
  s_addk_i32 s12, 0x2000
  s_cmp_ge_u32 s12, s59
  s_cselect_b32 s12, s58, s12
  s_waitcnt vmcnt(3)
  s_bitcmp0_b32 s68, 0
  s_cbranch_scc1 L_th_17
  s_waitcnt vmcnt(2)
L_th_17:
  buffer_load_dwordx4 v[140:143], v2, s[44:47], s12 offen nt
  s_addk_i32 s12, 0x2000
  s_cmp_ge_u32 s12, s59
  s_cselect_b32 s12, s58, s12
  s_waitcnt vmcnt(3)
  buffer_load_dwordx4 v[144:147], v2, s[44:47], s12 offen nt
  s_addk_i32 s12, 0x2000
  s_cmp_ge_u32 s12, s59
  s_cselect_b32 s12, s58, s12
  s_waitcnt vmcnt(3)
  s_bitcmp0_b32 s68, 0
  s_cbranch_scc1 L_th_18
  s_waitcnt vmcnt(2)
L_th_18:
  buffer_load_dwordx4 v[148:151], v2, s[44:47], s12 offen nt
  s_addk_i32 s12, 0x2000
  s_cmp_ge_u32 s12, s59
  s_cselect_b32 s12, s58, s12
  s_waitcnt vmcnt(3)
  buffer_load_dwordx4 v[152:155], v2, s[44:47], s12 offen nt
  s_addk_i32 s12, 0x2000
  s_cmp_ge_u32 s12, s59
  s_cselect_b32 s12, s58, s12
  s_waitcnt vmcnt(3)
  s_bitcmp0_b32 s68, 0
  s_cbranch_scc1 L_th_19
  s_waitcnt vmcnt(2)
L_th_19:
  buffer_load_dwordx4 v[156:159], v2, s[44:47], s12 offen nt
  s_addk_i32 s12, 0x2000
  s_cmp_ge_u32 s12, s59
  s_cselect_b32 s12, s58, s12
  s_waitcnt vmcnt(3)
  buffer_load_dwordx4 v[160:163], v2, s[44:47], s12 offen nt
  s_addk_i32 s12, 0x2000
  s_cmp_ge_u32 s12, s59
  s_cselect_b32 s12, s58, s12
  s_waitcnt vmcnt(3)
  s_bitcmp0_b32 s68, 0
  s_cbranch_scc1 L_th_20
  s_waitcnt vmcnt(2)
L_th_20:
  buffer_load_dwordx4 v[164:167], v2, s[44:47], s12 offen nt
  s_addk_i32 s12, 0x2000
  s_cmp_ge_u32 s12, s59
  s_cselect_b32 s12, s58, s12
  s_waitcnt vmcnt(3)
  s_add_u32 m0, s15, 0
  s_nop 0
  buffer_load_dwordx4 v2, s[48:51], s12 offen nt lds
  s_addk_i32 s12, 0x2000
  s_waitcnt vmcnt(3)
  s_bitcmp0_b32 s68, 0
  s_cbranch_scc1 L_th_21
  s_waitcnt vmcnt(2)
L_th_21:
  s_add_u32 m0, s15, 1024
  s_nop 0
  buffer_load_dwordx4 v2, s[48:51], s12 offen nt lds
  s_addk_i32 s12, 0x2000
  s_waitcnt vmcnt(3)
  s_add_u32 m0, s15, 2048
  s_nop 0
  buffer_load_dwordx4 v2, s[48:51], s12 offen nt lds
  s_addk_i32 s12, 0x2000
  ds_write_b32 v4, v4 offset:6664
  s_waitcnt vmcnt(3)
  s_bitcmp0_b32 s68, 0
  s_cbranch_scc1 L_th_22
  s_waitcnt vmcnt(2)
L_th_22:
  s_add_u32 m0, s15, 3072
  s_nop 0
  buffer_load_dwordx4 v2, s[48:51], s12 offen nt lds
  s_addk_i32 s12, 0x2000
  s_waitcnt vmcnt(3)
  s_add_u32 m0, s15, 4096
  s_nop 0
  buffer_load_dwordx4 v2, s[48:51], s12 offen nt lds
  s_addk_i32 s12, 0x2000
  s_waitcnt vmcnt(3)
  s_bitcmp0_b32 s68, 0
  s_cbranch_scc1 L_th_23
  s_waitcnt vmcnt(2)
L_th_23:
  s_add_u32 m0, s15, 5120
  s_nop 0
  buffer_load_dwordx4 v2, s[48:51], s12 offen nt lds
  s_addk_i32 s12, 0x2000
  s_waitcnt vmcnt(3)
  s_add_u32 m0, s15, 6144
  s_nop 0
  buffer_load_dwordx4 v2, s[48:51], s12 offen nt lds
  s_addk_i32 s12, 0x2000
  s_waitcnt vmcnt(3)
  s_bitcmp0_b32 s68, 0
  s_cbranch_scc1 L_th_24
  s_waitcnt vmcnt(2)
L_th_24:
  s_add_u32 m0, s15, 7168
  s_nop 0
  buffer_load_dwordx4 v2, s[48:51], s12 offen nt lds
  s_addk_i32 s12, 0x2000
  s_mov_b32 s70, 0
L_pl_25:
  ds_read_b128 v[4:7], v3 offset:6400
  s_waitcnt lgkmcnt(0)
  v_max3_u32 v8, v4, v5, v6
  v_max_u32 v8, v8, v7
  v_cmp_eq_u32 vcc, -1, v8
  s_cmp_eq_u64 vcc, 0
  s_cbranch_scc1 L_pld_26
  s_sleep 2
  s_add_u32 s70, s70, 1
  s_cmp_lt_u32 s70, 1048576
  s_cbranch_scc1 L_pl_25
L_pld_26:
  s_waitcnt vmcnt(8)
  v_dot2_f32_bf16 v8, v56, v4, 0
  v_dot2_f32_bf16 v9, v60, v4, 0
  v_dot2_f32_bf16 v10, v64, v4, 0
  v_dot2_f32_bf16 v11, v68, v4, 0
  v_dot2_f32_bf16 v12, v72, v4, 0
  v_dot2_f32_bf16 v13, v76, v4, 0
  v_dot2_f32_bf16 v14, v80, v4, 0
  v_dot2_f32_bf16 v15, v84, v4, 0
  v_dot2_f32_bf16 v8, v57, v5, v8
  v_dot2_f32_bf16 v9, v61, v5, v9
  v_dot2_f32_bf16 v10, v65, v5, v10
  v_dot2_f32_bf16 v11, v69, v5, v11
  v_dot2_f32_bf16 v12, v73, v5, v12
  v_dot2_f32_bf16 v13, v77, v5, v13
  v_dot2_f32_bf16 v14, v81, v5, v14
  v_dot2_f32_bf16 v15, v85, v5, v15
  v_dot2_f32_bf16 v8, v58, v6, v8
  v_dot2_f32_bf16 v9, v62, v6, v9
  v_dot2_f32_bf16 v10, v66, v6, v10
  v_dot2_f32_bf16 v11, v70, v6, v11
  v_dot2_f32_bf16 v12, v74, v6, v12
  v_dot2_f32_bf16 v13, v78, v6, v13
  v_dot2_f32_bf16 v14, v82, v6, v14
  v_dot2_f32_bf16 v15, v86, v6, v15
  v_dot2_f32_bf16 v8, v59, v7, v8
  v_dot2_f32_bf16 v9, v63, v7, v9
  v_dot2_f32_bf16 v10, v67, v7, v10
  v_dot2_f32_bf16 v11, v71, v7, v11
  v_dot2_f32_bf16 v12, v75, v7, v12
  v_dot2_f32_bf16 v13, v79, v7, v13
  v_dot2_f32_bf16 v14, v83, v7, v14
  v_dot2_f32_bf16 v15, v87, v7, v15
  v_add_f32_dpp v8, v8, v8 row_ror:8 row_mask:0xf bank_mask:0x3
  v_add_f32_dpp v8, v9, v9 row_ror:8 row_mask:0xf bank_mask:0xc
  v_add_f32_dpp v10, v10, v10 row_ror:8 row_mask:0xf bank_mask:0x3
  v_add_f32_dpp v10, v11, v11 row_ror:8 row_mask:0xf bank_mask:0xc
  v_add_f32_dpp v12, v12, v12 row_ror:8 row_mask:0xf bank_mask:0x3
  v_add_f32_dpp v12, v13, v13 row_ror:8 row_mask:0xf bank_mask:0xc
  v_add_f32_dpp v14, v14, v14 row_ror:8 row_mask:0xf bank_mask:0x3
  v_add_f32_dpp v14, v15, v15 row_ror:8 row_mask:0xf bank_mask:0xc
  v_add_f32_dpp v18, v8, v8 row_shl:4 row_mask:0xf bank_mask:0x5
  v_add_f32_dpp v18, v10, v10 row_shr:4 row_mask:0xf bank_mask:0xa
  v_add_f32_dpp v19, v12, v12 row_shl:4 row_mask:0xf bank_mask:0x5
  v_add_f32_dpp v19, v14, v14 row_shr:4 row_mask:0xf bank_mask:0xa
  v_dot2_f32_bf16 v8, v88, v4, 0
  v_dot2_f32_bf16 v9, v92, v4, 0
  v_dot2_f32_bf16 v10, v96, v4, 0
  v_dot2_f32_bf16 v11, v100, v4, 0
  v_dot2_f32_bf16 v12, v104, v4, 0
  v_dot2_f32_bf16 v13, v108, v4, 0
  v_dot2_f32_bf16 v14, v112, v4, 0
  v_dot2_f32_bf16 v15, v116, v4, 0
  v_dot2_f32_bf16 v8, v89, v5, v8
  v_dot2_f32_bf16 v9, v93, v5, v9
  v_dot2_f32_bf16 v10, v97, v5, v10
  v_dot2_f32_bf16 v11, v101, v5, v11
  v_dot2_f32_bf16 v12, v105, v5, v12
  v_dot2_f32_bf16 v13, v109, v5, v13
  v_dot2_f32_bf16 v14, v113, v5, v14
  v_dot2_f32_bf16 v15, v117, v5, v15
  v_dot2_f32_bf16 v8, v90, v6, v8
  v_dot2_f32_bf16 v9, v94, v6, v9
  v_dot2_f32_bf16 v10, v98, v6, v10
  v_dot2_f32_bf16 v11, v102, v6, v11
  v_dot2_f32_bf16 v12, v106, v6, v12
  v_dot2_f32_bf16 v13, v110, v6, v13
  v_dot2_f32_bf16 v14, v114, v6, v14
  v_dot2_f32_bf16 v15, v118, v6, v15
  v_dot2_f32_bf16 v8, v91, v7, v8
  v_dot2_f32_bf16 v9, v95, v7, v9
  v_dot2_f32_bf16 v10, v99, v7, v10
  v_dot2_f32_bf16 v11, v103, v7, v11
  v_dot2_f32_bf16 v12, v107, v7, v12
  v_dot2_f32_bf16 v13, v111, v7, v13
  v_dot2_f32_bf16 v14, v115, v7, v14
  v_dot2_f32_bf16 v15, v119, v7, v15
  buffer_load_dwordx4 v[88:91], v2, s[48:51], s12 offen nt
  s_addk_i32 s12, 0x2000
  v_add_f32_dpp v8, v8, v8 row_ror:8 row_mask:0xf bank_mask:0x3
  v_add_f32_dpp v8, v9, v9 row_ror:8 row_mask:0xf bank_mask:0xc
  v_add_f32_dpp v10, v10, v10 row_ror:8 row_mask:0xf bank_mask:0x3
  v_add_f32_dpp v10, v11, v11 row_ror:8 row_mask:0xf bank_mask:0xc
  v_add_f32_dpp v12, v12, v12 row_ror:8 row_mask:0xf bank_mask:0x3
  v_add_f32_dpp v12, v13, v13 row_ror:8 row_mask:0xf bank_mask:0xc
  v_add_f32_dpp v14, v14, v14 row_ror:8 row_mask:0xf bank_mask:0x3
  v_add_f32_dpp v14, v15, v15 row_ror:8 row_mask:0xf bank_mask:0xc
  v_add_f32_dpp v20, v8, v8 row_shl:4 row_mask:0xf bank_mask:0x5
  v_add_f32_dpp v20, v10, v10 row_shr:4 row_mask:0xf bank_mask:0xa
  v_add_f32_dpp v21, v12, v12 row_shl:4 row_mask:0xf bank_mask:0x5
  v_add_f32_dpp v21, v14, v14 row_shr:4 row_mask:0xf bank_mask:0xa
  v_dot2_f32_bf16 v8, v120, v4, 0
  v_dot2_f32_bf16 v9, v124, v4, 0
  v_dot2_f32_bf16 v10, v128, v4, 0
  v_dot2_f32_bf16 v11, v132, v4, 0
  v_dot2_f32_bf16 v12, v136, v4, 0
  v_dot2_f32_bf16 v13, v140, v4, 0
  v_dot2_f32_bf16 v14, v144, v4, 0
  v_dot2_f32_bf16 v15, v148, v4, 0
  v_dot2_f32_bf16 v8, v121, v5, v8
  v_dot2_f32_bf16 v9, v125, v5, v9
  v_dot2_f32_bf16 v10, v129, v5, v10
  v_dot2_f32_bf16 v11, v133, v5, v11
  v_dot2_f32_bf16 v12, v137, v5, v12
  v_dot2_f32_bf16 v13, v141, v5, v13
  v_dot2_f32_bf16 v14, v145, v5, v14
  v_dot2_f32_bf16 v15, v149, v5, v15
  v_dot2_f32_bf16 v8, v122, v6, v8
  v_dot2_f32_bf16 v9, v126, v6, v9
  v_dot2_f32_bf16 v10, v130, v6, v10
  v_dot2_f32_bf16 v11, v134, v6, v11
  v_dot2_f32_bf16 v12, v138, v6, v12
  v_dot2_f32_bf16 v13, v142, v6, v13
  v_dot2_f32_bf16 v14, v146, v6, v14
  v_dot2_f32_bf16 v15, v150, v6, v15
  v_dot2_f32_bf16 v8, v123, v7, v8
  v_dot2_f32_bf16 v9, v127, v7, v9
  v_dot2_f32_bf16 v10, v131, v7, v10
  v_dot2_f32_bf16 v11, v135, v7, v11
  v_dot2_f32_bf16 v12, v139, v7, v12
  v_dot2_f32_bf16 v13, v143, v7, v13
  v_dot2_f32_bf16 v14, v147, v7, v14
  v_dot2_f32_bf16 v15, v151, v7, v15
  buffer_load_dwordx4 v[92:95], v2, s[48:51], s12 offen nt
  s_addk_i32 s12, 0x2000
  v_add_f32_dpp v8, v8, v8 row_ror:8 row_mask:0xf bank_mask:0x3
  v_add_f32_dpp v8, v9, v9 row_ror:8 row_mask:0xf bank_mask:0xc
  v_add_f32_dpp v10, v10, v10 row_ror:8 row_mask:0xf bank_mask:0x3
  v_add_f32_dpp v10, v11, v11 row_ror:8 row_mask:0xf bank_mask:0xc
  v_add_f32_dpp v12, v12, v12 row_ror:8 row_mask:0xf bank_mask:0x3
  v_add_f32_dpp v12, v13, v13 row_ror:8 row_mask:0xf bank_mask:0xc
  v_add_f32_dpp v14, v14, v14 row_ror:8 row_mask:0xf bank_mask:0x3
  v_add_f32_dpp v14, v15, v15 row_ror:8 row_mask:0xf bank_mask:0xc
  v_add_f32_dpp v22, v8, v8 row_shl:4 row_mask:0xf bank_mask:0x5
  v_add_f32_dpp v22, v10, v10 row_shr:4 row_mask:0xf bank_mask:0xa
  v_add_f32_dpp v23, v12, v12 row_shl:4 row_mask:0xf bank_mask:0x5
  v_add_f32_dpp v23, v14, v14 row_shr:4 row_mask:0xf bank_mask:0xa
  v_dot2_f32_bf16 v8, v152, v4, 0
  v_dot2_f32_bf16 v9, v156, v4, 0
  v_dot2_f32_bf16 v10, v160, v4, 0
  v_dot2_f32_bf16 v11, v164, v4, 0
  v_dot2_f32_bf16 v8, v153, v5, v8
  v_dot2_f32_bf16 v9, v157, v5, v9
  v_dot2_f32_bf16 v10, v161, v5, v10
  v_dot2_f32_bf16 v11, v165, v5, v11
  v_dot2_f32_bf16 v8, v154, v6, v8
  v_dot2_f32_bf16 v9, v158, v6, v9
  v_dot2_f32_bf16 v10, v162, v6, v10
  v_dot2_f32_bf16 v11, v166, v6, v11
  v_dot2_f32_bf16 v8, v155, v7, v8
  v_dot2_f32_bf16 v9, v159, v7, v9
  v_dot2_f32_bf16 v10, v163, v7, v10
  v_dot2_f32_bf16 v11, v167, v7, v11
  v_add_f32_dpp v8, v8, v8 row_ror:8 row_mask:0xf bank_mask:0x3
  v_add_f32_dpp v8, v9, v9 row_ror:8 row_mask:0xf bank_mask:0xc
  v_add_f32_dpp v10, v10, v10 row_ror:8 row_mask:0xf bank_mask:0x3
  v_add_f32_dpp v10, v11, v11 row_ror:8 row_mask:0xf bank_mask:0xc
  s_nop 0
  v_add_f32_dpp v3, v8, v8 row_shl:4 row_mask:0xf bank_mask:0x5
  v_add_f32_dpp v3, v10, v10 row_shr:4 row_mask:0xf bank_mask:0xa
  v_dot2_f32_bf16 v8, v24, v4, 0
  v_dot2_f32_bf16 v9, v28, v4, 0
  v_dot2_f32_bf16 v10, v32, v4, 0
  v_dot2_f32_bf16 v11, v36, v4, 0
  v_dot2_f32_bf16 v12, v40, v4, 0
  v_dot2_f32_bf16 v13, v44, v4, 0
  v_dot2_f32_bf16 v14, v48, v4, 0
  v_dot2_f32_bf16 v15, v52, v4, 0
  v_dot2_f32_bf16 v8, v25, v5, v8
  v_dot2_f32_bf16 v9, v29, v5, v9
  v_dot2_f32_bf16 v10, v33, v5, v10
  v_dot2_f32_bf16 v11, v37, v5, v11
  v_dot2_f32_bf16 v12, v41, v5, v12
  v_dot2_f32_bf16 v13, v45, v5, v13
  v_dot2_f32_bf16 v14, v49, v5, v14
  v_dot2_f32_bf16 v15, v53, v5, v15
  v_dot2_f32_bf16 v8, v26, v6, v8
  v_dot2_f32_bf16 v9, v30, v6, v9
  v_dot2_f32_bf16 v10, v34, v6, v10
  v_dot2_f32_bf16 v11, v38, v6, v11
  v_dot2_f32_bf16 v12, v42, v6, v12
  v_dot2_f32_bf16 v13, v46, v6, v13
  v_dot2_f32_bf16 v14, v50, v6, v14
  v_dot2_f32_bf16 v15, v54, v6, v15
  v_dot2_f32_bf16 v8, v27, v7, v8
  v_dot2_f32_bf16 v9, v31, v7, v9
  v_dot2_f32_bf16 v10, v35, v7, v10
  v_dot2_f32_bf16 v11, v39, v7, v11
  v_dot2_f32_bf16 v12, v43, v7, v12
  v_dot2_f32_bf16 v13, v47, v7, v13
  v_dot2_f32_bf16 v14, v51, v7, v14
  v_dot2_f32_bf16 v15, v55, v7, v15
  buffer_load_dwordx4 v[96:99], v2, s[48:51], s12 offen nt
  s_addk_i32 s12, 0x2000
  v_add_f32_dpp v8, v8, v8 row_ror:8 row_mask:0xf bank_mask:0x3
  v_add_f32_dpp v8, v9, v9 row_ror:8 row_mask:0xf bank_mask:0xc
  v_add_f32_dpp v10, v10, v10 row_ror:8 row_mask:0xf bank_mask:0x3
  v_add_f32_dpp v10, v11, v11 row_ror:8 row_mask:0xf bank_mask:0xc
  v_add_f32_dpp v12, v12, v12 row_ror:8 row_mask:0xf bank_mask:0x3
  v_add_f32_dpp v12, v13, v13 row_ror:8 row_mask:0xf bank_mask:0xc
  v_add_f32_dpp v14, v14, v14 row_ror:8 row_mask:0xf bank_mask:0x3
  v_add_f32_dpp v14, v15, v15 row_ror:8 row_mask:0xf bank_mask:0xc
  v_add_f32_dpp v16, v8, v8 row_shl:4 row_mask:0xf bank_mask:0x5
  v_add_f32_dpp v16, v10, v10 row_shr:4 row_mask:0xf bank_mask:0xa
  v_add_f32_dpp v17, v12, v12 row_shl:4 row_mask:0xf bank_mask:0x5
  v_add_f32_dpp v17, v14, v14 row_shr:4 row_mask:0xf bank_mask:0xa
  v_add_f32_dpp v3, v3, v3 quad_perm:[2,3,0,1] row_mask:0xf bank_mask:0xf
  v_add_f32_dpp v18, v18, v18 quad_perm:[2,3,0,1] row_mask:0xf bank_mask:0xf
  v_add_f32_dpp v19, v19, v19 quad_perm:[2,3,0,1] row_mask:0xf bank_mask:0xf
  v_add_f32_dpp v20, v20, v20 quad_perm:[2,3,0,1] row_mask:0xf bank_mask:0xf
  v_add_f32_dpp v21, v21, v21 quad_perm:[2,3,0,1] row_mask:0xf bank_mask:0xf
  v_add_f32_dpp v22, v22, v22 quad_perm:[2,3,0,1] row_mask:0xf bank_mask:0xf
  v_add_f32_dpp v23, v23, v23 quad_perm:[2,3,0,1] row_mask:0xf bank_mask:0xf
  v_add_f32_dpp v16, v16, v16 quad_perm:[2,3,0,1] row_mask:0xf bank_mask:0xf
  v_add_f32_dpp v17, v17, v17 quad_perm:[2,3,0,1] row_mask:0xf bank_mask:0xf
  v_cndmask_b32 v8, v16, v17, s[52:53]
  v_cndmask_b32 v9, v18, v19, s[52:53]
  v_cndmask_b32 v10, v20, v21, s[52:53]
  v_cndmask_b32 v11, v22, v23, s[52:53]
  v_add_f32_dpp v18, v3, v3 quad_perm:[1,0,3,2] row_mask:0xf bank_mask:0xf
  v_add_f32_dpp v8, v8, v8 quad_perm:[1,0,3,2] row_mask:0xf bank_mask:0xf
  v_add_f32_dpp v9, v9, v9 quad_perm:[1,0,3,2] row_mask:0xf bank_mask:0xf
  v_add_f32_dpp v10, v10, v10 quad_perm:[1,0,3,2] row_mask:0xf bank_mask:0xf
  v_add_f32_dpp v11, v11, v11 quad_perm:[1,0,3,2] row_mask:0xf bank_mask:0xf
  v_cndmask_b32 v16, v8, v9, s[54:55]
  v_cndmask_b32 v17, v10, v11, s[54:55]
  v_cvt_pk_bf16_f32 v16, 0, v16
  v_cvt_pk_bf16_f32 v17, 0, v17
  v_cvt_pk_bf16_f32 v18, 0, v18
  v_mul_f32 v16, 0x3db504f3, v16
  v_mul_f32 v17, 0x3db504f3, v17
  v_mul_f32 v18, 0x3db504f3, v18
  v_cvt_pk_bf16_f32 v16, 0, v16
  v_cvt_pk_bf16_f32 v17, 0, v17
  v_cvt_pk_bf16_f32 v18, 0, v18
  v_mov_b32 v19, 0xff800000
  s_mov_b32 s52, 0xeeeeeeee
  s_mov_b32 s53, 0xeeeeeeee
  v_cndmask_b32 v16, v16, v19, s[66:67]
  v_cndmask_b32 v18, v18, v19, s[52:53]
  s_lshl_b32 s11, s9, 10
  v_lshl_add_u32 v3, v1, 4, s11
  ds_write_b128 v3, v[16:19] offset:12032
  s_waitcnt vmcnt(3)
  buffer_load_dwordx4 v[100:103], v2, s[48:51], s12 offen nt
  s_addk_i32 s12, 0x2000
  v_lshl_add_u32 v3, v1, 4, s15
  ds_read_b128 v[56:59], v3 offset:0
  ds_read_b128 v[60:63], v3 offset:1024
  ds_read_b128 v[64:67], v3 offset:2048
  ds_read_b128 v[68:71], v3 offset:3072
  ds_read_b128 v[72:75], v3 offset:4096
  ds_read_b128 v[76:79], v3 offset:5120
  ds_read_b128 v[80:83], v3 offset:6144
  ds_read_b128 v[84:87], v3 offset:7168
  v_max3_f32 v22, v16, v17, v18
  s_nop 1
  v_max_f32_dpp v22, v22, v22 row_ror:8 row_mask:0xf bank_mask:0xf
  s_nop 1
  v_max_f32_dpp v22, v22, v22 row_ror:4 row_mask:0xf bank_mask:0xf
  s_nop 1
  v_max_f32_dpp v22, v22, v22 row_ror:2 row_mask:0xf bank_mask:0xf
  s_nop 1
  v_max_f32_dpp v22, v22, v22 row_ror:1 row_mask:0xf bank_mask:0xf
  v_mov_b32 v23, v22
  s_nop 1
  v_permlane16_swap_b32 v23, v22
  v_max_f32 v22, v22, v23
  v_mov_b32 v23, v22
  s_nop 1
  v_permlane32_swap_b32 v23, v22
  v_max_f32 v22, v22, v23
  v_sub_f32 v16, v16, v22
  v_sub_f32 v17, v17, v22
  v_sub_f32 v18, v18, v22
  v_mul_f32 v16, 0x3fb8aa3b, v16
  v_mul_f32 v17, 0x3fb8aa3b, v17
  v_mul_f32 v18, 0x3fb8aa3b, v18
  v_exp_f32 v16, v16
  v_exp_f32 v17, v17
  v_exp_f32 v18, v18
  s_nop 0
  v_cvt_pk_bf16_f32 v4, v16, 0
  v_cvt_pk_bf16_f32 v5, 0, v16
  v_cvt_pk_bf16_f32 v6, v17, 0
  v_cvt_pk_bf16_f32 v7, 0, v17
  v_cvt_pk_bf16_f32 v20, v18, 0
  v_cvt_pk_bf16_f32 v21, 0, v18
  v_mov_b32 v8, 0
  v_mov_b32 v9, 0
  v_mov_b32 v10, 0
  v_mov_b32 v11, 0
  v_mov_b32 v12, 0
  v_mov_b32 v13, 0
  v_mov_b32 v14, 0
  v_mov_b32 v15, 0
  s_lshl_b32 s11, s9, 9
  v_and_b32 v3, 15, v1
  v_lshlrev_b32 v3, 5, v3
  v_lshrrev_b32 v16, 4, v1
  v_lshl_add_u32 v3, v16, 3, v3
  v_add_u32 v3, s11, v3
  v_mov_b32 v16, 6656
  s_waitcnt lgkmcnt(0)
  s_mov_b32 s13, s61
  s_cmp_gt_u32 s60, 7
  s_cbranch_scc1 L_opts_27
  s_waitcnt vmcnt(3)
  s_bitcmp0_b32 s68, 0
  s_cbranch_scc1 L_th_28
  s_waitcnt vmcnt(2)
L_th_28:
  buffer_load_dwordx4 v[52:55], v2, s[48:51], s13 offen nt
  s_addk_i32 s13, 0x2000
  s_cmp_gt_u32 s60, 6
  s_cbranch_scc1 L_opts_27
  s_waitcnt vmcnt(3)
  buffer_load_dwordx4 v[48:51], v2, s[48:51], s13 offen nt
  s_addk_i32 s13, 0x2000
  s_cmp_gt_u32 s60, 5
  s_cbranch_scc1 L_opts_27
  s_waitcnt vmcnt(3)
  s_bitcmp0_b32 s68, 0
  s_cbranch_scc1 L_th_29
  s_waitcnt vmcnt(2)
L_th_29:
  buffer_load_dwordx4 v[44:47], v2, s[48:51], s13 offen nt
  s_addk_i32 s13, 0x2000
  s_cmp_gt_u32 s60, 4
  s_cbranch_scc1 L_opts_27
  s_waitcnt vmcnt(3)
  buffer_load_dwordx4 v[40:43], v2, s[48:51], s13 offen nt
  s_addk_i32 s13, 0x2000
  s_cmp_gt_u32 s60, 3
  s_cbranch_scc1 L_opts_27
  s_waitcnt vmcnt(3)
  s_bitcmp0_b32 s68, 0
  s_cbranch_scc1 L_th_30
  s_waitcnt vmcnt(2)
L_th_30:
  buffer_load_dwordx4 v[36:39], v2, s[48:51], s13 offen nt
  s_addk_i32 s13, 0x2000
  s_cmp_gt_u32 s60, 2
  s_cbranch_scc1 L_opts_27
  s_waitcnt vmcnt(3)
  buffer_load_dwordx4 v[32:35], v2, s[48:51], s13 offen nt
  s_addk_i32 s13, 0x2000
  s_cmp_gt_u32 s60, 1
  s_cbranch_scc1 L_opts_27
  s_waitcnt vmcnt(3)
  s_bitcmp0_b32 s68, 0
  s_cbranch_scc1 L_th_31
  s_waitcnt vmcnt(2)
L_th_31:
  buffer_load_dwordx4 v[28:31], v2, s[48:51], s13 offen nt
  s_addk_i32 s13, 0x2000
  s_cmp_gt_u32 s60, 0
  s_cbranch_scc1 L_opts_27
  s_waitcnt vmcnt(3)
  buffer_load_dwordx4 v[24:27], v2, s[48:51], s13 offen nt
  s_addk_i32 s13, 0x2000
L_opts_27:
  s_waitcnt vmcnt(3)
  s_bitcmp0_b32 s68, 0
  s_cbranch_scc1 L_th_32
  s_waitcnt vmcnt(2)
L_th_32:
  buffer_load_dwordx4 v[104:107], v2, s[48:51], s12 offen nt
  s_addk_i32 s12, 0x2000
  s_cmp_ge_u32 s12, s59
  s_cselect_b32 s12, s58, s12
  v_dot2c_f32_bf16_dpp v8, v4, v56 row_newbcast:1 row_mask:0xf bank_mask:0xf
  v_dot2c_f32_bf16_dpp v9, v5, v56 row_newbcast:1 row_mask:0xf bank_mask:0xf
  v_dot2c_f32_bf16_dpp v10, v4, v57 row_newbcast:1 row_mask:0xf bank_mask:0xf
  v_dot2c_f32_bf16_dpp v11, v5, v57 row_newbcast:1 row_mask:0xf bank_mask:0xf
  v_dot2c_f32_bf16_dpp v12, v4, v58 row_newbcast:1 row_mask:0xf bank_mask:0xf
  v_dot2c_f32_bf16_dpp v13, v5, v58 row_newbcast:1 row_mask:0xf bank_mask:0xf
  v_dot2c_f32_bf16_dpp v14, v4, v59 row_newbcast:1 row_mask:0xf bank_mask:0xf
  v_dot2c_f32_bf16_dpp v15, v5, v59 row_newbcast:1 row_mask:0xf bank_mask:0xf
  v_dot2c_f32_bf16_dpp v8, v4, v60 row_newbcast:9 row_mask:0xf bank_mask:0xf
  v_dot2c_f32_bf16_dpp v9, v5, v60 row_newbcast:9 row_mask:0xf bank_mask:0xf
  v_dot2c_f32_bf16_dpp v10, v4, v61 row_newbcast:9 row_mask:0xf bank_mask:0xf
  v_dot2c_f32_bf16_dpp v11, v5, v61 row_newbcast:9 row_mask:0xf bank_mask:0xf
  v_dot2c_f32_bf16_dpp v12, v4, v62 row_newbcast:9 row_mask:0xf bank_mask:0xf
  v_dot2c_f32_bf16_dpp v13, v5, v62 row_newbcast:9 row_mask:0xf bank_mask:0xf
  v_dot2c_f32_bf16_dpp v14, v4, v63 row_newbcast:9 row_mask:0xf bank_mask:0xf
  v_dot2c_f32_bf16_dpp v15, v5, v63 row_newbcast:9 row_mask:0xf bank_mask:0xf
  v_dot2c_f32_bf16_dpp v8, v4, v64 row_newbcast:5 row_mask:0xf bank_mask:0xf
  v_dot2c_f32_bf16_dpp v9, v5, v64 row_newbcast:5 row_mask:0xf bank_mask:0xf
  v_dot2c_f32_bf16_dpp v10, v4, v65 row_newbcast:5 row_mask:0xf bank_mask:0xf
  v_dot2c_f32_bf16_dpp v11, v5, v65 row_newbcast:5 row_mask:0xf bank_mask:0xf
  v_dot2c_f32_bf16_dpp v12, v4, v66 row_newbcast:5 row_mask:0xf bank_mask:0xf
  v_dot2c_f32_bf16_dpp v13, v5, v66 row_newbcast:5 row_mask:0xf bank_mask:0xf
  v_dot2c_f32_bf16_dpp v14, v4, v67 row_newbcast:5 row_mask:0xf bank_mask:0xf
  v_dot2c_f32_bf16_dpp v15, v5, v67 row_newbcast:5 row_mask:0xf bank_mask:0xf
  s_waitcnt vmcnt(3)
  buffer_load_dwordx4 v[108:111], v2, s[48:51], s12 offen nt
  s_addk_i32 s12, 0x2000
  s_cmp_ge_u32 s12, s59
  s_cselect_b32 s12, s58, s12
  v_dot2c_f32_bf16_dpp v8, v4, v68 row_newbcast:13 row_mask:0xf bank_mask:0xf
  v_dot2c_f32_bf16_dpp v9, v5, v68 row_newbcast:13 row_mask:0xf bank_mask:0xf
  v_dot2c_f32_bf16_dpp v10, v4, v69 row_newbcast:13 row_mask:0xf bank_mask:0xf
  v_dot2c_f32_bf16_dpp v11, v5, v69 row_newbcast:13 row_mask:0xf bank_mask:0xf
  v_dot2c_f32_bf16_dpp v12, v4, v70 row_newbcast:13 row_mask:0xf bank_mask:0xf
  v_dot2c_f32_bf16_dpp v13, v5, v70 row_newbcast:13 row_mask:0xf bank_mask:0xf
  v_dot2c_f32_bf16_dpp v14, v4, v71 row_newbcast:13 row_mask:0xf bank_mask:0xf
  v_dot2c_f32_bf16_dpp v15, v5, v71 row_newbcast:13 row_mask:0xf bank_mask:0xf
  v_dot2c_f32_bf16_dpp v8, v4, v72 row_newbcast:3 row_mask:0xf bank_mask:0xf
  v_dot2c_f32_bf16_dpp v9, v5, v72 row_newbcast:3 row_mask:0xf bank_mask:0xf
  v_dot2c_f32_bf16_dpp v10, v4, v73 row_newbcast:3 row_mask:0xf bank_mask:0xf
  v_dot2c_f32_bf16_dpp v11, v5, v73 row_newbcast:3 row_mask:0xf bank_mask:0xf
  v_dot2c_f32_bf16_dpp v12, v4, v74 row_newbcast:3 row_mask:0xf bank_mask:0xf
  v_dot2c_f32_bf16_dpp v13, v5, v74 row_newbcast:3 row_mask:0xf bank_mask:0xf
  v_dot2c_f32_bf16_dpp v14, v4, v75 row_newbcast:3 row_mask:0xf bank_mask:0xf
  v_dot2c_f32_bf16_dpp v15, v5, v75 row_newbcast:3 row_mask:0xf bank_mask:0xf
  v_dot2c_f32_bf16_dpp v8, v4, v76 row_newbcast:11 row_mask:0xf bank_mask:0xf
  v_dot2c_f32_bf16_dpp v9, v5, v76 row_newbcast:11 row_mask:0xf bank_mask:0xf
  v_dot2c_f32_bf16_dpp v10, v4, v77 row_newbcast:11 row_mask:0xf bank_mask:0xf
  v_dot2c_f32_bf16_dpp v11, v5, v77 row_newbcast:11 row_mask:0xf bank_mask:0xf
  v_dot2c_f32_bf16_dpp v12, v4, v78 row_newbcast:11 row_mask:0xf bank_mask:0xf
  v_dot2c_f32_bf16_dpp v13, v5, v78 row_newbcast:11 row_mask:0xf bank_mask:0xf
  v_dot2c_f32_bf16_dpp v14, v4, v79 row_newbcast:11 row_mask:0xf bank_mask:0xf
  v_dot2c_f32_bf16_dpp v15, v5, v79 row_newbcast:11 row_mask:0xf bank_mask:0xf
  s_waitcnt vmcnt(3)
  s_bitcmp0_b32 s68, 0
  s_cbranch_scc1 L_th_33
  s_waitcnt vmcnt(2)
L_th_33:
  buffer_load_dwordx4 v[112:115], v2, s[48:51], s12 offen nt
  s_addk_i32 s12, 0x2000
  s_cmp_ge_u32 s12, s59
  s_cselect_b32 s12, s58, s12
  v_dot2c_f32_bf16_dpp v8, v4, v80 row_newbcast:7 row_mask:0xf bank_mask:0xf
  v_dot2c_f32_bf16_dpp v9, v5, v80 row_newbcast:7 row_mask:0xf bank_mask:0xf
  v_dot2c_f32_bf16_dpp v10, v4, v81 row_newbcast:7 row_mask:0xf bank_mask:0xf
  v_dot2c_f32_bf16_dpp v11, v5, v81 row_newbcast:7 row_mask:0xf bank_mask:0xf
  v_dot2c_f32_bf16_dpp v12, v4, v82 row_newbcast:7 row_mask:0xf bank_mask:0xf
  v_dot2c_f32_bf16_dpp v13, v5, v82 row_newbcast:7 row_mask:0xf bank_mask:0xf
  v_dot2c_f32_bf16_dpp v14, v4, v83 row_newbcast:7 row_mask:0xf bank_mask:0xf
  v_dot2c_f32_bf16_dpp v15, v5, v83 row_newbcast:7 row_mask:0xf bank_mask:0xf
  v_dot2c_f32_bf16_dpp v8, v4, v84 row_newbcast:15 row_mask:0xf bank_mask:0xf
  v_dot2c_f32_bf16_dpp v9, v5, v84 row_newbcast:15 row_mask:0xf bank_mask:0xf
  v_dot2c_f32_bf16_dpp v10, v4, v85 row_newbcast:15 row_mask:0xf bank_mask:0xf
  v_dot2c_f32_bf16_dpp v11, v5, v85 row_newbcast:15 row_mask:0xf bank_mask:0xf
  v_dot2c_f32_bf16_dpp v12, v4, v86 row_newbcast:15 row_mask:0xf bank_mask:0xf
  v_dot2c_f32_bf16_dpp v13, v5, v86 row_newbcast:15 row_mask:0xf bank_mask:0xf
  v_dot2c_f32_bf16_dpp v14, v4, v87 row_newbcast:15 row_mask:0xf bank_mask:0xf
  v_dot2c_f32_bf16_dpp v15, v5, v87 row_newbcast:15 row_mask:0xf bank_mask:0xf
  v_dot2c_f32_bf16_dpp v8, v6, v88 row_newbcast:0 row_mask:0xf bank_mask:0xf
  v_dot2c_f32_bf16_dpp v9, v7, v88 row_newbcast:0 row_mask:0xf bank_mask:0xf
  v_dot2c_f32_bf16_dpp v10, v6, v89 row_newbcast:0 row_mask:0xf bank_mask:0xf
  v_dot2c_f32_bf16_dpp v11, v7, v89 row_newbcast:0 row_mask:0xf bank_mask:0xf
  v_dot2c_f32_bf16_dpp v12, v6, v90 row_newbcast:0 row_mask:0xf bank_mask:0xf
  v_dot2c_f32_bf16_dpp v13, v7, v90 row_newbcast:0 row_mask:0xf bank_mask:0xf
  v_dot2c_f32_bf16_dpp v14, v6, v91 row_newbcast:0 row_mask:0xf bank_mask:0xf
  v_dot2c_f32_bf16_dpp v15, v7, v91 row_newbcast:0 row_mask:0xf bank_mask:0xf
  s_waitcnt vmcnt(3)
  buffer_load_dwordx4 v[116:119], v2, s[48:51], s12 offen nt
  s_addk_i32 s12, 0x2000
  s_cmp_ge_u32 s12, s59
  s_cselect_b32 s12, s58, s12
  v_dot2c_f32_bf16_dpp v8, v6, v92 row_newbcast:8 row_mask:0xf bank_mask:0xf
  v_dot2c_f32_bf16_dpp v9, v7, v92 row_newbcast:8 row_mask:0xf bank_mask:0xf
  v_dot2c_f32_bf16_dpp v10, v6, v93 row_newbcast:8 row_mask:0xf bank_mask:0xf
  v_dot2c_f32_bf16_dpp v11, v7, v93 row_newbcast:8 row_mask:0xf bank_mask:0xf
  v_dot2c_f32_bf16_dpp v12, v6, v94 row_newbcast:8 row_mask:0xf bank_mask:0xf
  v_dot2c_f32_bf16_dpp v13, v7, v94 row_newbcast:8 row_mask:0xf bank_mask:0xf
  v_dot2c_f32_bf16_dpp v14, v6, v95 row_newbcast:8 row_mask:0xf bank_mask:0xf
  v_dot2c_f32_bf16_dpp v15, v7, v95 row_newbcast:8 row_mask:0xf bank_mask:0xf
  v_dot2c_f32_bf16_dpp v8, v6, v96 row_newbcast:4 row_mask:0xf bank_mask:0xf
  v_dot2c_f32_bf16_dpp v9, v7, v96 row_newbcast:4 row_mask:0xf bank_mask:0xf
  v_dot2c_f32_bf16_dpp v10, v6, v97 row_newbcast:4 row_mask:0xf bank_mask:0xf
  v_dot2c_f32_bf16_dpp v11, v7, v97 row_newbcast:4 row_mask:0xf bank_mask:0xf
  v_dot2c_f32_bf16_dpp v12, v6, v98 row_newbcast:4 row_mask:0xf bank_mask:0xf
  v_dot2c_f32_bf16_dpp v13, v7, v98 row_newbcast:4 row_mask:0xf bank_mask:0xf
  v_dot2c_f32_bf16_dpp v14, v6, v99 row_newbcast:4 row_mask:0xf bank_mask:0xf
  v_dot2c_f32_bf16_dpp v15, v7, v99 row_newbcast:4 row_mask:0xf bank_mask:0xf
  v_dot2c_f32_bf16_dpp v8, v6, v100 row_newbcast:12 row_mask:0xf bank_mask:0xf
  v_dot2c_f32_bf16_dpp v9, v7, v100 row_newbcast:12 row_mask:0xf bank_mask:0xf
  v_dot2c_f32_bf16_dpp v10, v6, v101 row_newbcast:12 row_mask:0xf bank_mask:0xf
  v_dot2c_f32_bf16_dpp v11, v7, v101 row_newbcast:12 row_mask:0xf bank_mask:0xf
  v_dot2c_f32_bf16_dpp v12, v6, v102 row_newbcast:12 row_mask:0xf bank_mask:0xf
  v_dot2c_f32_bf16_dpp v13, v7, v102 row_newbcast:12 row_mask:0xf bank_mask:0xf
  v_dot2c_f32_bf16_dpp v14, v6, v103 row_newbcast:12 row_mask:0xf bank_mask:0xf
  v_dot2c_f32_bf16_dpp v15, v7, v103 row_newbcast:12 row_mask:0xf bank_mask:0xf
  s_waitcnt vmcnt(3)
  s_bitcmp0_b32 s68, 0
  s_cbranch_scc1 L_th_34
  s_waitcnt vmcnt(2)
L_th_34:
  buffer_load_dwordx4 v[120:123], v2, s[48:51], s12 offen nt
  s_addk_i32 s12, 0x2000
  s_cmp_ge_u32 s12, s59
  s_cselect_b32 s12, s58, s12
  ds_write_b32 v16, v16 offset:20
  s_cmp_gt_u32 s60, 7
  s_cbranch_scc1 L_opt_35
  v_dot2c_f32_bf16_dpp v8, v4, v52 row_newbcast:14 row_mask:0xf bank_mask:0xf
  v_dot2c_f32_bf16_dpp v9, v5, v52 row_newbcast:14 row_mask:0xf bank_mask:0xf
  v_dot2c_f32_bf16_dpp v10, v4, v53 row_newbcast:14 row_mask:0xf bank_mask:0xf
  v_dot2c_f32_bf16_dpp v11, v5, v53 row_newbcast:14 row_mask:0xf bank_mask:0xf
  v_dot2c_f32_bf16_dpp v12, v4, v54 row_newbcast:14 row_mask:0xf bank_mask:0xf
  v_dot2c_f32_bf16_dpp v13, v5, v54 row_newbcast:14 row_mask:0xf bank_mask:0xf
  v_dot2c_f32_bf16_dpp v14, v4, v55 row_newbcast:14 row_mask:0xf bank_mask:0xf
  v_dot2c_f32_bf16_dpp v15, v5, v55 row_newbcast:14 row_mask:0xf bank_mask:0xf
L_opt_35:
  s_cmp_gt_u32 s60, 6
  s_cbranch_scc1 L_opt_36
  v_dot2c_f32_bf16_dpp v8, v4, v48 row_newbcast:6 row_mask:0xf bank_mask:0xf
  v_dot2c_f32_bf16_dpp v9, v5, v48 row_newbcast:6 row_mask:0xf bank_mask:0xf
  v_dot2c_f32_bf16_dpp v10, v4, v49 row_newbcast:6 row_mask:0xf bank_mask:0xf
  v_dot2c_f32_bf16_dpp v11, v5, v49 row_newbcast:6 row_mask:0xf bank_mask:0xf
  v_dot2c_f32_bf16_dpp v12, v4, v50 row_newbcast:6 row_mask:0xf bank_mask:0xf
  v_dot2c_f32_bf16_dpp v13, v5, v50 row_newbcast:6 row_mask:0xf bank_mask:0xf
  v_dot2c_f32_bf16_dpp v14, v4, v51 row_newbcast:6 row_mask:0xf bank_mask:0xf
  v_dot2c_f32_bf16_dpp v15, v5, v51 row_newbcast:6 row_mask:0xf bank_mask:0xf
L_opt_36:
  s_cmp_gt_u32 s60, 5
  s_cbranch_scc1 L_opt_37
  v_dot2c_f32_bf16_dpp v8, v4, v44 row_newbcast:10 row_mask:0xf bank_mask:0xf
  v_dot2c_f32_bf16_dpp v9, v5, v44 row_newbcast:10 row_mask:0xf bank_mask:0xf
  v_dot2c_f32_bf16_dpp v10, v4, v45 row_newbcast:10 row_mask:0xf bank_mask:0xf
  v_dot2c_f32_bf16_dpp v11, v5, v45 row_newbcast:10 row_mask:0xf bank_mask:0xf
  v_dot2c_f32_bf16_dpp v12, v4, v46 row_newbcast:10 row_mask:0xf bank_mask:0xf
  v_dot2c_f32_bf16_dpp v13, v5, v46 row_newbcast:10 row_mask:0xf bank_mask:0xf
  v_dot2c_f32_bf16_dpp v14, v4, v47 row_newbcast:10 row_mask:0xf bank_mask:0xf
  v_dot2c_f32_bf16_dpp v15, v5, v47 row_newbcast:10 row_mask:0xf bank_mask:0xf
L_opt_37:
  s_waitcnt vmcnt(3)
  buffer_load_dwordx4 v[124:127], v2, s[48:51], s12 offen nt
  s_addk_i32 s12, 0x2000
  s_cmp_ge_u32 s12, s59
  s_cselect_b32 s12, s58, s12
  s_cmp_gt_u32 s60, 4
  s_cbranch_scc1 L_opt_38
  v_dot2c_f32_bf16_dpp v8, v4, v40 row_newbcast:2 row_mask:0xf bank_mask:0xf
  v_dot2c_f32_bf16_dpp v9, v5, v40 row_newbcast:2 row_mask:0xf bank_mask:0xf
  v_dot2c_f32_bf16_dpp v10, v4, v41 row_newbcast:2 row_mask:0xf bank_mask:0xf
  v_dot2c_f32_bf16_dpp v11, v5, v41 row_newbcast:2 row_mask:0xf bank_mask:0xf
  v_dot2c_f32_bf16_dpp v12, v4, v42 row_newbcast:2 row_mask:0xf bank_mask:0xf
  v_dot2c_f32_bf16_dpp v13, v5, v42 row_newbcast:2 row_mask:0xf bank_mask:0xf
  v_dot2c_f32_bf16_dpp v14, v4, v43 row_newbcast:2 row_mask:0xf bank_mask:0xf
  v_dot2c_f32_bf16_dpp v15, v5, v43 row_newbcast:2 row_mask:0xf bank_mask:0xf
L_opt_38:
  s_cmp_gt_u32 s60, 3
  s_cbranch_scc1 L_opt_39
  v_dot2c_f32_bf16_dpp v8, v4, v36 row_newbcast:12 row_mask:0xf bank_mask:0xf
  v_dot2c_f32_bf16_dpp v9, v5, v36 row_newbcast:12 row_mask:0xf bank_mask:0xf
  v_dot2c_f32_bf16_dpp v10, v4, v37 row_newbcast:12 row_mask:0xf bank_mask:0xf
  v_dot2c_f32_bf16_dpp v11, v5, v37 row_newbcast:12 row_mask:0xf bank_mask:0xf
  v_dot2c_f32_bf16_dpp v12, v4, v38 row_newbcast:12 row_mask:0xf bank_mask:0xf
  v_dot2c_f32_bf16_dpp v13, v5, v38 row_newbcast:12 row_mask:0xf bank_mask:0xf
  v_dot2c_f32_bf16_dpp v14, v4, v39 row_newbcast:12 row_mask:0xf bank_mask:0xf
  v_dot2c_f32_bf16_dpp v15, v5, v39 row_newbcast:12 row_mask:0xf bank_mask:0xf
L_opt_39:
  s_cmp_gt_u32 s60, 2
  s_cbranch_scc1 L_opt_40
  v_dot2c_f32_bf16_dpp v8, v4, v32 row_newbcast:4 row_mask:0xf bank_mask:0xf
  v_dot2c_f32_bf16_dpp v9, v5, v32 row_newbcast:4 row_mask:0xf bank_mask:0xf
  v_dot2c_f32_bf16_dpp v10, v4, v33 row_newbcast:4 row_mask:0xf bank_mask:0xf
  v_dot2c_f32_bf16_dpp v11, v5, v33 row_newbcast:4 row_mask:0xf bank_mask:0xf
  v_dot2c_f32_bf16_dpp v12, v4, v34 row_newbcast:4 row_mask:0xf bank_mask:0xf
  v_dot2c_f32_bf16_dpp v13, v5, v34 row_newbcast:4 row_mask:0xf bank_mask:0xf
  v_dot2c_f32_bf16_dpp v14, v4, v35 row_newbcast:4 row_mask:0xf bank_mask:0xf
  v_dot2c_f32_bf16_dpp v15, v5, v35 row_newbcast:4 row_mask:0xf bank_mask:0xf
L_opt_40:
  s_waitcnt vmcnt(3)
  s_bitcmp0_b32 s68, 0
  s_cbranch_scc1 L_th_41
  s_waitcnt vmcnt(2)
L_th_41:
  buffer_load_dwordx4 v[128:131], v2, s[48:51], s12 offen nt
  s_addk_i32 s12, 0x2000
  s_cmp_ge_u32 s12, s59
  s_cselect_b32 s12, s58, s12
  s_cmp_gt_u32 s60, 1
  s_cbranch_scc1 L_opt_42
  v_dot2c_f32_bf16_dpp v8, v4, v28 row_newbcast:8 row_mask:0xf bank_mask:0xf
  v_dot2c_f32_bf16_dpp v9, v5, v28 row_newbcast:8 row_mask:0xf bank_mask:0xf
  v_dot2c_f32_bf16_dpp v10, v4, v29 row_newbcast:8 row_mask:0xf bank_mask:0xf
  v_dot2c_f32_bf16_dpp v11, v5, v29 row_newbcast:8 row_mask:0xf bank_mask:0xf
  v_dot2c_f32_bf16_dpp v12, v4, v30 row_newbcast:8 row_mask:0xf bank_mask:0xf
  v_dot2c_f32_bf16_dpp v13, v5, v30 row_newbcast:8 row_mask:0xf bank_mask:0xf
  v_dot2c_f32_bf16_dpp v14, v4, v31 row_newbcast:8 row_mask:0xf bank_mask:0xf
  v_dot2c_f32_bf16_dpp v15, v5, v31 row_newbcast:8 row_mask:0xf bank_mask:0xf
L_opt_42:
  s_cmp_gt_u32 s60, 0
  s_cbranch_scc1 L_opt_43
  v_dot2c_f32_bf16_dpp v8, v4, v24 row_newbcast:0 row_mask:0xf bank_mask:0xf
  v_dot2c_f32_bf16_dpp v9, v5, v24 row_newbcast:0 row_mask:0xf bank_mask:0xf
  v_dot2c_f32_bf16_dpp v10, v4, v25 row_newbcast:0 row_mask:0xf bank_mask:0xf
  v_dot2c_f32_bf16_dpp v11, v5, v25 row_newbcast:0 row_mask:0xf bank_mask:0xf
  v_dot2c_f32_bf16_dpp v12, v4, v26 row_newbcast:0 row_mask:0xf bank_mask:0xf
  v_dot2c_f32_bf16_dpp v13, v5, v26 row_newbcast:0 row_mask:0xf bank_mask:0xf
  v_dot2c_f32_bf16_dpp v14, v4, v27 row_newbcast:0 row_mask:0xf bank_mask:0xf
  v_dot2c_f32_bf16_dpp v15, v5, v27 row_newbcast:0 row_mask:0xf bank_mask:0xf
L_opt_43:
  v_dot2c_f32_bf16_dpp v8, v6, v104 row_newbcast:2 row_mask:0xf bank_mask:0xf
  v_dot2c_f32_bf16_dpp v9, v7, v104 row_newbcast:2 row_mask:0xf bank_mask:0xf
  v_dot2c_f32_bf16_dpp v10, v6, v105 row_newbcast:2 row_mask:0xf bank_mask:0xf
  v_dot2c_f32_bf16_dpp v11, v7, v105 row_newbcast:2 row_mask:0xf bank_mask:0xf
  v_dot2c_f32_bf16_dpp v12, v6, v106 row_newbcast:2 row_mask:0xf bank_mask:0xf
  v_dot2c_f32_bf16_dpp v13, v7, v106 row_newbcast:2 row_mask:0xf bank_mask:0xf
  v_dot2c_f32_bf16_dpp v14, v6, v107 row_newbcast:2 row_mask:0xf bank_mask:0xf
  v_dot2c_f32_bf16_dpp v15, v7, v107 row_newbcast:2 row_mask:0xf bank_mask:0xf
  s_waitcnt vmcnt(3)
  buffer_load_dwordx4 v[132:135], v2, s[48:51], s12 offen nt
  s_addk_i32 s12, 0x2000
  s_cmp_ge_u32 s12, s59
  s_cselect_b32 s12, s58, s12
  v_dot2c_f32_bf16_dpp v8, v6, v108 row_newbcast:10 row_mask:0xf bank_mask:0xf
  v_dot2c_f32_bf16_dpp v9, v7, v108 row_newbcast:10 row_mask:0xf bank_mask:0xf
  v_dot2c_f32_bf16_dpp v10, v6, v109 row_newbcast:10 row_mask:0xf bank_mask:0xf
  v_dot2c_f32_bf16_dpp v11, v7, v109 row_newbcast:10 row_mask:0xf bank_mask:0xf
  v_dot2c_f32_bf16_dpp v12, v6, v110 row_newbcast:10 row_mask:0xf bank_mask:0xf
  v_dot2c_f32_bf16_dpp v13, v7, v110 row_newbcast:10 row_mask:0xf bank_mask:0xf
  v_dot2c_f32_bf16_dpp v14, v6, v111 row_newbcast:10 row_mask:0xf bank_mask:0xf
  v_dot2c_f32_bf16_dpp v15, v7, v111 row_newbcast:10 row_mask:0xf bank_mask:0xf
  v_dot2c_f32_bf16_dpp v8, v6, v112 row_newbcast:6 row_mask:0xf bank_mask:0xf
  v_dot2c_f32_bf16_dpp v9, v7, v112 row_newbcast:6 row_mask:0xf bank_mask:0xf
  v_dot2c_f32_bf16_dpp v10, v6, v113 row_newbcast:6 row_mask:0xf bank_mask:0xf
  v_dot2c_f32_bf16_dpp v11, v7, v113 row_newbcast:6 row_mask:0xf bank_mask:0xf
  v_dot2c_f32_bf16_dpp v12, v6, v114 row_newbcast:6 row_mask:0xf bank_mask:0xf
  v_dot2c_f32_bf16_dpp v13, v7, v114 row_newbcast:6 row_mask:0xf bank_mask:0xf
  v_dot2c_f32_bf16_dpp v14, v6, v115 row_newbcast:6 row_mask:0xf bank_mask:0xf
  v_dot2c_f32_bf16_dpp v15, v7, v115 row_newbcast:6 row_mask:0xf bank_mask:0xf
  v_dot2c_f32_bf16_dpp v8, v6, v116 row_newbcast:14 row_mask:0xf bank_mask:0xf
  v_dot2c_f32_bf16_dpp v9, v7, v116 row_newbcast:14 row_mask:0xf bank_mask:0xf
  v_dot2c_f32_bf16_dpp v10, v6, v117 row_newbcast:14 row_mask:0xf bank_mask:0xf
  v_dot2c_f32_bf16_dpp v11, v7, v117 row_newbcast:14 row_mask:0xf bank_mask:0xf
  v_dot2c_f32_bf16_dpp v12, v6, v118 row_newbcast:14 row_mask:0xf bank_mask:0xf
  v_dot2c_f32_bf16_dpp v13, v7, v118 row_newbcast:14 row_mask:0xf bank_mask:0xf
  v_dot2c_f32_bf16_dpp v14, v6, v119 row_newbcast:14 row_mask:0xf bank_mask:0xf
  v_dot2c_f32_bf16_dpp v15, v7, v119 row_newbcast:14 row_mask:0xf bank_mask:0xf
  s_waitcnt vmcnt(3)
  buffer_load_dwordx4 v[136:139], v2, s[48:51], s12 offen nt
  s_addk_i32 s12, 0x2000
  s_cmp_ge_u32 s12, s59
  s_cselect_b32 s12, s58, s12
  v_dot2c_f32_bf16_dpp v8, v6, v120 row_newbcast:1 row_mask:0xf bank_mask:0xf
  v_dot2c_f32_bf16_dpp v9, v7, v120 row_newbcast:1 row_mask:0xf bank_mask:0xf
  v_dot2c_f32_bf16_dpp v10, v6, v121 row_newbcast:1 row_mask:0xf bank_mask:0xf
  v_dot2c_f32_bf16_dpp v11, v7, v121 row_newbcast:1 row_mask:0xf bank_mask:0xf
  v_dot2c_f32_bf16_dpp v12, v6, v122 row_newbcast:1 row_mask:0xf bank_mask:0xf
  v_dot2c_f32_bf16_dpp v13, v7, v122 row_newbcast:1 row_mask:0xf bank_mask:0xf
  v_dot2c_f32_bf16_dpp v14, v6, v123 row_newbcast:1 row_mask:0xf bank_mask:0xf
  v_dot2c_f32_bf16_dpp v15, v7, v123 row_newbcast:1 row_mask:0xf bank_mask:0xf
  s_waitcnt vmcnt(3)
  buffer_load_dwordx4 v[140:143], v2, s[48:51], s12 offen nt
  s_addk_i32 s12, 0x2000
  s_cmp_ge_u32 s12, s59
  s_cselect_b32 s12, s58, s12
  v_dot2c_f32_bf16_dpp v8, v6, v124 row_newbcast:9 row_mask:0xf bank_mask:0xf
  v_dot2c_f32_bf16_dpp v9, v7, v124 row_newbcast:9 row_mask:0xf bank_mask:0xf
  v_dot2c_f32_bf16_dpp v10, v6, v125 row_newbcast:9 row_mask:0xf bank_mask:0xf
  v_dot2c_f32_bf16_dpp v11, v7, v125 row_newbcast:9 row_mask:0xf bank_mask:0xf
  v_dot2c_f32_bf16_dpp v12, v6, v126 row_newbcast:9 row_mask:0xf bank_mask:0xf
  v_dot2c_f32_bf16_dpp v13, v7, v126 row_newbcast:9 row_mask:0xf bank_mask:0xf
  v_dot2c_f32_bf16_dpp v14, v6, v127 row_newbcast:9 row_mask:0xf bank_mask:0xf
  v_dot2c_f32_bf16_dpp v15, v7, v127 row_newbcast:9 row_mask:0xf bank_mask:0xf
  s_waitcnt vmcnt(3)
  buffer_load_dwordx4 v[144:147], v2, s[48:51], s12 offen nt
  s_addk_i32 s12, 0x2000
  s_cmp_ge_u32 s12, s59
  s_cselect_b32 s12, s58, s12
  v_dot2c_f32_bf16_dpp v8, v6, v128 row_newbcast:5 row_mask:0xf bank_mask:0xf
  v_dot2c_f32_bf16_dpp v9, v7, v128 row_newbcast:5 row_mask:0xf bank_mask:0xf
  v_dot2c_f32_bf16_dpp v10, v6, v129 row_newbcast:5 row_mask:0xf bank_mask:0xf
  v_dot2c_f32_bf16_dpp v11, v7, v129 row_newbcast:5 row_mask:0xf bank_mask:0xf
  v_dot2c_f32_bf16_dpp v12, v6, v130 row_newbcast:5 row_mask:0xf bank_mask:0xf
  v_dot2c_f32_bf16_dpp v13, v7, v130 row_newbcast:5 row_mask:0xf bank_mask:0xf
  v_dot2c_f32_bf16_dpp v14, v6, v131 row_newbcast:5 row_mask:0xf bank_mask:0xf
  v_dot2c_f32_bf16_dpp v15, v7, v131 row_newbcast:5 row_mask:0xf bank_mask:0xf
  s_waitcnt vmcnt(3)
  buffer_load_dwordx4 v[148:151], v2, s[48:51], s12 offen nt
  s_addk_i32 s12, 0x2000
  s_cmp_ge_u32 s12, s59
  s_cselect_b32 s12, s58, s12
  v_dot2c_f32_bf16_dpp v8, v6, v132 row_newbcast:13 row_mask:0xf bank_mask:0xf
  v_dot2c_f32_bf16_dpp v9, v7, v132 row_newbcast:13 row_mask:0xf bank_mask:0xf
  v_dot2c_f32_bf16_dpp v10, v6, v133 row_newbcast:13 row_mask:0xf bank_mask:0xf
  v_dot2c_f32_bf16_dpp v11, v7, v133 row_newbcast:13 row_mask:0xf bank_mask:0xf
  v_dot2c_f32_bf16_dpp v12, v6, v134 row_newbcast:13 row_mask:0xf bank_mask:0xf
  v_dot2c_f32_bf16_dpp v13, v7, v134 row_newbcast:13 row_mask:0xf bank_mask:0xf
  v_dot2c_f32_bf16_dpp v14, v6, v135 row_newbcast:13 row_mask:0xf bank_mask:0xf
  v_dot2c_f32_bf16_dpp v15, v7, v135 row_newbcast:13 row_mask:0xf bank_mask:0xf
  buffer_load_dwordx4 v[152:155], v2, s[48:51], s12 offen nt
  s_addk_i32 s12, 0x2000
  s_cmp_ge_u32 s12, s59
  s_cselect_b32 s12, s58, s12
  buffer_load_dwordx4 v[156:159], v2, s[48:51], s12 offen nt
  s_addk_i32 s12, 0x2000
  s_cmp_ge_u32 s12, s59
  s_cselect_b32 s12, s58, s12
  buffer_load_dwordx4 v[160:163], v2, s[48:51], s12 offen nt
  s_addk_i32 s12, 0x2000
  s_cmp_ge_u32 s12, s59
  s_cselect_b32 s12, s58, s12
  buffer_load_dwordx4 v[164:167], v2, s[48:51], s12 offen nt
  s_mov_b32 s70, 0
L_pl_44:
  ds_read_b32 v18, v16
  s_waitcnt lgkmcnt(0)
  v_cmp_eq_u32 vcc, -1, v18
  s_cmp_eq_u64 vcc, 0
  s_cbranch_scc1 L_pld_45
  s_sleep 2
  s_add_u32 s70, s70, 1
  s_cmp_lt_u32 s70, 1048576
  s_cbranch_scc1 L_pl_44
L_pld_45:
  v_sub_f32 v22, v22, v18
  v_mul_f32 v22, 0x3fb8aa3b, v22
  v_exp_f32 v22, v22
  s_waitcnt vmcnt(7)
  v_dot2c_f32_bf16_dpp v8, v6, v136 row_newbcast:3 row_mask:0xf bank_mask:0xf
  v_dot2c_f32_bf16_dpp v9, v7, v136 row_newbcast:3 row_mask:0xf bank_mask:0xf
  v_dot2c_f32_bf16_dpp v10, v6, v137 row_newbcast:3 row_mask:0xf bank_mask:0xf
  v_dot2c_f32_bf16_dpp v11, v7, v137 row_newbcast:3 row_mask:0xf bank_mask:0xf
  v_dot2c_f32_bf16_dpp v12, v6, v138 row_newbcast:3 row_mask:0xf bank_mask:0xf
  v_dot2c_f32_bf16_dpp v13, v7, v138 row_newbcast:3 row_mask:0xf bank_mask:0xf
  v_dot2c_f32_bf16_dpp v14, v6, v139 row_newbcast:3 row_mask:0xf bank_mask:0xf
  v_dot2c_f32_bf16_dpp v15, v7, v139 row_newbcast:3 row_mask:0xf bank_mask:0xf
  s_waitcnt vmcnt(6)
  v_dot2c_f32_bf16_dpp v8, v6, v140 row_newbcast:11 row_mask:0xf bank_mask:0xf
  v_dot2c_f32_bf16_dpp v9, v7, v140 row_newbcast:11 row_mask:0xf bank_mask:0xf
  v_dot2c_f32_bf16_dpp v10, v6, v141 row_newbcast:11 row_mask:0xf bank_mask:0xf
  v_dot2c_f32_bf16_dpp v11, v7, v141 row_newbcast:11 row_mask:0xf bank_mask:0xf
  v_dot2c_f32_bf16_dpp v12, v6, v142 row_newbcast:11 row_mask:0xf bank_mask:0xf
  v_dot2c_f32_bf16_dpp v13, v7, v142 row_newbcast:11 row_mask:0xf bank_mask:0xf
  v_dot2c_f32_bf16_dpp v14, v6, v143 row_newbcast:11 row_mask:0xf bank_mask:0xf
  v_dot2c_f32_bf16_dpp v15, v7, v143 row_newbcast:11 row_mask:0xf bank_mask:0xf
  s_waitcnt vmcnt(5)
  v_dot2c_f32_bf16_dpp v8, v6, v144 row_newbcast:7 row_mask:0xf bank_mask:0xf
  v_dot2c_f32_bf16_dpp v9, v7, v144 row_newbcast:7 row_mask:0xf bank_mask:0xf
  v_dot2c_f32_bf16_dpp v10, v6, v145 row_newbcast:7 row_mask:0xf bank_mask:0xf
  v_dot2c_f32_bf16_dpp v11, v7, v145 row_newbcast:7 row_mask:0xf bank_mask:0xf
  v_dot2c_f32_bf16_dpp v12, v6, v146 row_newbcast:7 row_mask:0xf bank_mask:0xf
  v_dot2c_f32_bf16_dpp v13, v7, v146 row_newbcast:7 row_mask:0xf bank_mask:0xf
  v_dot2c_f32_bf16_dpp v14, v6, v147 row_newbcast:7 row_mask:0xf bank_mask:0xf
  v_dot2c_f32_bf16_dpp v15, v7, v147 row_newbcast:7 row_mask:0xf bank_mask:0xf
  s_waitcnt vmcnt(4)
  v_dot2c_f32_bf16_dpp v8, v6, v148 row_newbcast:15 row_mask:0xf bank_mask:0xf
  v_dot2c_f32_bf16_dpp v9, v7, v148 row_newbcast:15 row_mask:0xf bank_mask:0xf
  v_dot2c_f32_bf16_dpp v10, v6, v149 row_newbcast:15 row_mask:0xf bank_mask:0xf
  v_dot2c_f32_bf16_dpp v11, v7, v149 row_newbcast:15 row_mask:0xf bank_mask:0xf
  v_dot2c_f32_bf16_dpp v12, v6, v150 row_newbcast:15 row_mask:0xf bank_mask:0xf
  v_dot2c_f32_bf16_dpp v13, v7, v150 row_newbcast:15 row_mask:0xf bank_mask:0xf
  v_dot2c_f32_bf16_dpp v14, v6, v151 row_newbcast:15 row_mask:0xf bank_mask:0xf
  v_dot2c_f32_bf16_dpp v15, v7, v151 row_newbcast:15 row_mask:0xf bank_mask:0xf
  s_waitcnt vmcnt(3)
  v_dot2c_f32_bf16_dpp v8, v20, v152 row_newbcast:0 row_mask:0xf bank_mask:0xf
  v_dot2c_f32_bf16_dpp v9, v21, v152 row_newbcast:0 row_mask:0xf bank_mask:0xf
  v_dot2c_f32_bf16_dpp v10, v20, v153 row_newbcast:0 row_mask:0xf bank_mask:0xf
  v_dot2c_f32_bf16_dpp v11, v21, v153 row_newbcast:0 row_mask:0xf bank_mask:0xf
  v_dot2c_f32_bf16_dpp v12, v20, v154 row_newbcast:0 row_mask:0xf bank_mask:0xf
  v_dot2c_f32_bf16_dpp v13, v21, v154 row_newbcast:0 row_mask:0xf bank_mask:0xf
  v_dot2c_f32_bf16_dpp v14, v20, v155 row_newbcast:0 row_mask:0xf bank_mask:0xf
  v_dot2c_f32_bf16_dpp v15, v21, v155 row_newbcast:0 row_mask:0xf bank_mask:0xf
  s_waitcnt vmcnt(2)
  v_dot2c_f32_bf16_dpp v8, v20, v156 row_newbcast:8 row_mask:0xf bank_mask:0xf
  v_dot2c_f32_bf16_dpp v9, v21, v156 row_newbcast:8 row_mask:0xf bank_mask:0xf
  v_dot2c_f32_bf16_dpp v10, v20, v157 row_newbcast:8 row_mask:0xf bank_mask:0xf
  v_dot2c_f32_bf16_dpp v11, v21, v157 row_newbcast:8 row_mask:0xf bank_mask:0xf
  v_dot2c_f32_bf16_dpp v12, v20, v158 row_newbcast:8 row_mask:0xf bank_mask:0xf
  v_dot2c_f32_bf16_dpp v13, v21, v158 row_newbcast:8 row_mask:0xf bank_mask:0xf
  v_dot2c_f32_bf16_dpp v14, v20, v159 row_newbcast:8 row_mask:0xf bank_mask:0xf
  v_dot2c_f32_bf16_dpp v15, v21, v159 row_newbcast:8 row_mask:0xf bank_mask:0xf
  s_waitcnt vmcnt(1)
  v_dot2c_f32_bf16_dpp v8, v20, v160 row_newbcast:4 row_mask:0xf bank_mask:0xf
  v_dot2c_f32_bf16_dpp v9, v21, v160 row_newbcast:4 row_mask:0xf bank_mask:0xf
  v_dot2c_f32_bf16_dpp v10, v20, v161 row_newbcast:4 row_mask:0xf bank_mask:0xf
  v_dot2c_f32_bf16_dpp v11, v21, v161 row_newbcast:4 row_mask:0xf bank_mask:0xf
  v_dot2c_f32_bf16_dpp v12, v20, v162 row_newbcast:4 row_mask:0xf bank_mask:0xf
  v_dot2c_f32_bf16_dpp v13, v21, v162 row_newbcast:4 row_mask:0xf bank_mask:0xf
  v_dot2c_f32_bf16_dpp v14, v20, v163 row_newbcast:4 row_mask:0xf bank_mask:0xf
  v_dot2c_f32_bf16_dpp v15, v21, v163 row_newbcast:4 row_mask:0xf bank_mask:0xf
  s_waitcnt vmcnt(0)
  v_dot2c_f32_bf16_dpp v8, v20, v164 row_newbcast:12 row_mask:0xf bank_mask:0xf
  v_dot2c_f32_bf16_dpp v9, v21, v164 row_newbcast:12 row_mask:0xf bank_mask:0xf
  v_dot2c_f32_bf16_dpp v10, v20, v165 row_newbcast:12 row_mask:0xf bank_mask:0xf
  v_dot2c_f32_bf16_dpp v11, v21, v165 row_newbcast:12 row_mask:0xf bank_mask:0xf
  v_dot2c_f32_bf16_dpp v12, v20, v166 row_newbcast:12 row_mask:0xf bank_mask:0xf
  v_dot2c_f32_bf16_dpp v13, v21, v166 row_newbcast:12 row_mask:0xf bank_mask:0xf
  v_dot2c_f32_bf16_dpp v14, v20, v167 row_newbcast:12 row_mask:0xf bank_mask:0xf
  v_dot2c_f32_bf16_dpp v15, v21, v167 row_newbcast:12 row_mask:0xf bank_mask:0xf
  s_nop 2
  v_permlane32_swap_b32 v8, v12
  v_permlane32_swap_b32 v9, v13
  v_permlane32_swap_b32 v10, v14
  v_permlane32_swap_b32 v11, v15
  v_add_f32 v8, v8, v12
  v_add_f32 v9, v9, v13
  v_add_f32 v10, v10, v14
  v_add_f32 v11, v11, v15
  s_nop 0
  v_permlane16_swap_b32 v8, v10
  v_permlane16_swap_b32 v9, v11
  v_add_f32 v8, v8, v10
  v_add_f32 v9, v9, v11
  v_mul_f32 v8, v8, v22
  v_mul_f32 v9, v9, v22
  ds_write_b64 v3, v[8:9] offset:6912
  s_waitcnt lgkmcnt(0)
  s_endpgm
L_helper:
  s_getpc_b64 s[56:57]
L_pc2:
  s_lshl_b32 s3, s2, 2
  s_add_u32 s3, s3, L_table-L_pc2
  s_load_dwordx16 s[16:31], s[0:1], 0
  s_load_dword s14, s[56:57], s3
  s_load_dwordx8 s[32:39], s[0:1], 64
  s_load_dwordx4 s[40:43], s[0:1], 96
  s_and_b32 s8, s2, 7
  s_lshl_b32 s3, s8, 3
  s_add_u32 s3, s3, L_gtab-L_pc2
  s_load_dwordx2 s[100:101], s[56:57], s3
  s_mov_b32 s72, 0xfffffffe
  s_mov_b32 s73, 0xffff0000
  v_mov_b32 v4, -1
  v_mov_b32 v5, -1
  v_mov_b32 v6, -1
  v_mov_b32 v7, -1
  v_lshlrev_b32 v2, 4, v0
  ds_write_b128 v2, v[4:7] offset:12032
  ds_write_b128 v2, v[4:7] offset:16128
  v_lshlrev_b32 v2, 2, v1
  ds_write_b32 v2, v4 offset:6400
  v_mov_b32 v38, 0
  ds_write_b128 v38, v[4:7] offset:6656
  ds_write_b128 v38, v[4:7] offset:6672
  ds_write_b32 v38, v38 offset:6720
  s_getreg_b32 s76, hwreg(HW_REG_XCC_ID, 0, 4)
  v_lshrrev_b32 v12, 3, v0
  v_lshlrev_b32 v12, 5, v12
  v_bfe_u32 v3, v1, 2, 1
  v_lshl_add_u32 v12, v3, 10, v12
  v_and_b32 v8, 3, v1
  v_lshl_add_u32 v13, v8, 3, v12
  v_and_b32 v12, 0xffffffdf, v12
  v_lshl_add_u32 v12, v8, 4, v12
  v_bfe_u32 v8, v1, 3, 1
  v_lshl_add_u32 v12, v8, 3, v12
  v_lshl_add_u32 v12, v3, 5, v12
  s_waitcnt lgkmcnt(0)
  s_barrier
  s_load_dword s74, s[42:43], 0
  s_and_b32 s13, s14, 7
  s_bfe_u32 s61, s14, 0x60003
  s_cmp_eq_u32 s13, 6
  s_cbranch_scc1 L_r_q
  s_cmp_ge_u32 s13, 4
  s_cbranch_scc1 L_r_moda
  s_cmp_eq_u32 s13, 1
  s_cbranch_scc1 L_r_wo
  s_cmp_eq_u32 s13, 2
  s_cbranch_scc1 L_r_f1
  s_cmp_eq_u32 s13, 3
  s_cbranch_scc1 L_r_f2
  s_branch L_r_none
L_r_moda:
  s_lshl_b32 s58, s61, 9
  s_add_u32 s58, s58, 4096
  global_load_dwordx2 v[14:15], v13, s[34:35]
  s_waitcnt lgkmcnt(0)
  s_mul_i32 s74, s74, 0x9e3779b1
  s_add_u32 s74, s74, 0x7f4a7c15
  s_add_u32 s76, s76, s74
  s_waitcnt vmcnt(0)
  v_lshlrev_b32 v16, 16, v14
  v_and_b32 v17, s73, v14
  v_lshlrev_b32 v18, 16, v15
  v_and_b32 v19, s73, v15
  v_mul_f32 v20, 0xbfb8aa3b, v16
  v_mul_f32 v21, 0xbfb8aa3b, v17
  v_mul_f32 v22, 0xbfb8aa3b, v18
  v_mul_f32 v23, 0xbfb8aa3b, v19
  v_exp_f32 v20, v20
  v_exp_f32 v21, v21
  v_exp_f32 v22, v22
  v_exp_f32 v23, v23
  s_nop 0
  v_add_f32 v20, 1.0, v20
  v_add_f32 v21, 1.0, v21
  v_add_f32 v22, 1.0, v22
  v_add_f32 v23, 1.0, v23
  v_rcp_f32 v20, v20
  v_rcp_f32 v21, v21
  v_rcp_f32 v22, v22
  v_rcp_f32 v23, v23
  s_nop 0
  v_mul_f32 v16, v16, v20
  v_mul_f32 v17, v17, v21
  v_mul_f32 v18, v18, v22
  v_mul_f32 v19, v19, v23
  v_cvt_pk_bf16_f32 v14, v16, v17
  v_cvt_pk_bf16_f32 v15, v18, v19
  ds_write_b64 v12, v[14:15] offset:0
  v_and_b32 v13, 1, v1
  v_lshlrev_b32 v13, 6, v13
  v_lshrrev_b32 v3, 4, v1
  v_lshl_add_u32 v13, v3, 4, v13
  s_lshl_b32 s49, s5, 7
  s_add_u32 s49, s49, s58
  v_add_u32 v13, s49, v13
  v_and_b32 v14, 1, v1
  v_mul_u32_u24 v14, 1056, v14
  v_lshrrev_b32 v3, 4, v1
  v_lshl_add_u32 v14, v3, 4, v14
  v_lshrrev_b32 v2, 2, v1
  v_bfe_u32 v3, v1, 1, 1
  s_lshl_b32 s49, s5, 1
  v_or_b32 v3, s49, v3
  v_and_b32 v10, 6, v2
  v_xor_b32 v3, v3, v10
  v_lshlrev_b32 v2, 7, v2
  v_lshl_add_u32 v2, v3, 4, v2
  v_and_b32 v3, 1, v1
  v_lshl_add_u32 v2, v3, 3, v2
  v_add_u32 v2, 20480, v2
  s_waitcnt lgkmcnt(0)
  v_mov_b32 v9, 1
  s_mov_b64 exec, 1
  ds_add_u32 v38, v9 offset:6720
  s_mov_b64 exec, -1
  s_mov_b32 s70, 0
L_hs_46:
  ds_read_b32 v9, v38 offset:6720
  s_waitcnt lgkmcnt(0)
  v_cmp_gt_u32 vcc, 12, v9
  s_cmp_eq_u64 vcc, 0
  s_cbranch_scc1 L_hsd_47
  s_sleep 2
  s_add_u32 s70, s70, 1
  s_cmp_lt_u32 s70, 2097152
  s_cbranch_scc1 L_hs_46
L_hsd_47:
  ds_read_b64_tr_b16 v[40:41], v2 offset:0
  ds_read_b64_tr_b16 v[42:43], v2 offset:2048
  ds_read_b128 v[104:107], v14 offset:0
  ds_read_b64_tr_b16 v[44:45], v2 offset:4096
  ds_read_b64_tr_b16 v[46:47], v2 offset:6144
  ds_read_b128 v[108:111], v14 offset:64
  ds_read_b64_tr_b16 v[48:49], v2 offset:8192
  ds_read_b64_tr_b16 v[50:51], v2 offset:10240
  ds_read_b128 v[112:115], v14 offset:128
  ds_read_b64_tr_b16 v[52:53], v2 offset:12288
  ds_read_b64_tr_b16 v[54:55], v2 offset:14336
  ds_read_b128 v[116:119], v14 offset:192
  ds_read_b64_tr_b16 v[56:57], v2 offset:16384
  ds_read_b64_tr_b16 v[58:59], v2 offset:18432
  ds_read_b128 v[120:123], v14 offset:256
  s_waitcnt lgkmcnt(12)
  v_mfma_f32_16x16x32_bf16 v[8:11], v[40:43], v[104:107], 0
  ds_read_b64_tr_b16 v[60:61], v2 offset:20480
  ds_read_b64_tr_b16 v[62:63], v2 offset:22528
  ds_read_b128 v[124:127], v14 offset:320
  s_waitcnt lgkmcnt(12)
  v_mfma_f32_16x16x32_bf16 v[8:11], v[44:47], v[108:111], v[8:11]
  ds_read_b64_tr_b16 v[64:65], v2 offset:24576
  ds_read_b64_tr_b16 v[66:67], v2 offset:26624
  ds_read_b128 v[128:131], v14 offset:384
  s_waitcnt lgkmcnt(12)
  v_mfma_f32_16x16x32_bf16 v[8:11], v[48:51], v[112:115], v[8:11]
  ds_read_b64_tr_b16 v[68:69], v2 offset:28672
  ds_read_b64_tr_b16 v[70:71], v2 offset:30720
  ds_read_b128 v[132:135], v14 offset:448
  s_waitcnt lgkmcnt(12)
  v_mfma_f32_16x16x32_bf16 v[8:11], v[52:55], v[116:119], v[8:11]
  ds_read_b64_tr_b16 v[72:73], v2 offset:32768
  ds_read_b64_tr_b16 v[74:75], v2 offset:34816
  ds_read_b128 v[136:139], v14 offset:512
  s_waitcnt lgkmcnt(12)
  v_mfma_f32_16x16x32_bf16 v[8:11], v[56:59], v[120:123], v[8:11]
  ds_read_b64_tr_b16 v[76:77], v2 offset:36864
  ds_read_b64_tr_b16 v[78:79], v2 offset:38912
  ds_read_b128 v[140:143], v14 offset:576
  s_waitcnt lgkmcnt(12)
  v_mfma_f32_16x16x32_bf16 v[8:11], v[60:63], v[124:127], v[8:11]
  ds_read_b64_tr_b16 v[80:81], v2 offset:40960
  ds_read_b64_tr_b16 v[82:83], v2 offset:43008
  ds_read_b128 v[144:147], v14 offset:640
  s_waitcnt lgkmcnt(12)
  v_mfma_f32_16x16x32_bf16 v[8:11], v[64:67], v[128:131], v[8:11]
  ds_read_b64_tr_b16 v[84:85], v2 offset:45056
  ds_read_b64_tr_b16 v[86:87], v2 offset:47104
  ds_read_b128 v[148:151], v14 offset:704
  s_waitcnt lgkmcnt(12)
  v_mfma_f32_16x16x32_bf16 v[8:11], v[68:71], v[132:135], v[8:11]
  ds_read_b64_tr_b16 v[88:89], v2 offset:49152
  ds_read_b64_tr_b16 v[90:91], v2 offset:51200
  ds_read_b128 v[152:155], v14 offset:768
  s_waitcnt lgkmcnt(12)
  v_mfma_f32_16x16x32_bf16 v[8:11], v[72:75], v[136:139], v[8:11]
  ds_read_b64_tr_b16 v[92:93], v2 offset:53248
  ds_read_b64_tr_b16 v[94:95], v2 offset:55296
  ds_read_b128 v[156:159], v14 offset:832
  s_waitcnt lgkmcnt(12)
  v_mfma_f32_16x16x32_bf16 v[8:11], v[76:79], v[140:143], v[8:11]
  ds_read_b64_tr_b16 v[96:97], v2 offset:57344
  ds_read_b64_tr_b16 v[98:99], v2 offset:59392
  ds_read_b128 v[160:163], v14 offset:896
  s_waitcnt lgkmcnt(12)
  v_mfma_f32_16x16x32_bf16 v[8:11], v[80:83], v[144:147], v[8:11]
  ds_read_b64_tr_b16 v[100:101], v2 offset:61440
  ds_read_b64_tr_b16 v[102:103], v2 offset:63488
  ds_read_b128 v[164:167], v14 offset:960
  s_waitcnt lgkmcnt(12)
  v_mfma_f32_16x16x32_bf16 v[8:11], v[84:87], v[148:151], v[8:11]
  s_waitcnt lgkmcnt(9)
  v_mfma_f32_16x16x32_bf16 v[8:11], v[88:91], v[152:155], v[8:11]
  s_waitcnt lgkmcnt(6)
  v_mfma_f32_16x16x32_bf16 v[8:11], v[92:95], v[156:159], v[8:11]
  s_waitcnt lgkmcnt(3)
  v_mfma_f32_16x16x32_bf16 v[8:11], v[96:99], v[160:163], v[8:11]
  s_waitcnt lgkmcnt(0)
  v_mfma_f32_16x16x32_bf16 v[8:11], v[100:103], v[164:167], v[8:11]
  s_nop 7
  v_cvt_pk_bf16_f32 v8, v8, v9
  v_cvt_pk_bf16_f32 v10, v10, v11
  v_mov_b32 v9, s74
  v_mov_b32 v11, s74
  s_mov_b32 exec_lo, 0x00030003
  s_mov_b32 exec_hi, 0x00030003
  global_store_dwordx4 v13, v[8:11], s[42:43] sc1
  s_mov_b64 exec, -1
  s_mov_b32 s60, 0
  s_branch L_svc1
L_r_q:
  s_lshl_b32 s58, s61, 9
  s_add_u32 s58, s58, 32768
  global_load_dwordx2 v[14:15], v13, s[16:17]
  s_waitcnt lgkmcnt(0)
  s_mul_i32 s74, s74, 0x9e3779b1
  s_add_u32 s74, s74, 0x7f4a7c15
  s_add_u32 s76, s76, s74
  s_waitcnt vmcnt(0)
  v_bfe_u32 v6, v1, 2, 1
  v_lshlrev_b32 v6, 5, v6
  v_add_u32 v6, 11008, v6
  s_lshl_b32 s49, s5, 3
  v_add_u32 v5, s49, v6
  v_lshlrev_b32 v20, 16, v14
  v_and_b32 v21, s73, v14
  v_lshlrev_b32 v22, 16, v15
  v_and_b32 v23, s73, v15
  v_add_f32 v8, v20, v21
  v_mul_f32 v9, v20, v20
  v_add_f32 v10, v22, v23
  v_mul_f32 v11, v22, v22
  v_fmac_f32 v9, v21, v21
  v_fmac_f32 v11, v23, v23
  v_add_f32 v8, v8, v10
  v_add_f32 v9, v9, v11
  s_nop 0
  v_add_f32_dpp v8, v8, v8 quad_perm:[1,0,3,2] row_mask:0xf bank_mask:0xf
  v_add_f32_dpp v9, v9, v9 quad_perm:[1,0,3,2] row_mask:0xf bank_mask:0xf
  s_nop 0
  v_add_f32_dpp v8, v8, v8 quad_perm:[2,3,0,1] row_mask:0xf bank_mask:0xf
  v_add_f32_dpp v9, v9, v9 quad_perm:[2,3,0,1] row_mask:0xf bank_mask:0xf
  s_nop 0
  v_add_f32_dpp v8, v8, v8 row_ror:8 row_mask:0xf bank_mask:0xf
  v_add_f32_dpp v9, v9, v9 row_ror:8 row_mask:0xf bank_mask:0xf
  s_nop 0
  v_mov_b32 v10, v8
  v_mov_b32 v11, v9
  s_nop 0
  v_permlane16_swap_b32 v10, v8
  v_permlane16_swap_b32 v11, v9
  v_add_f32 v8, v8, v10
  v_add_f32 v9, v9, v11
  v_mov_b32 v10, v8
  v_mov_b32 v11, v9
  s_nop 0
  v_permlane32_swap_b32 v10, v8
  v_permlane32_swap_b32 v11, v9
  v_add_f32 v8, v8, v10
  v_add_f32 v9, v9, v11
  ds_write_b64 v5, v[8:9]
  s_waitcnt lgkmcnt(0)
  v_mov_b32 v9, 1
  s_mov_b64 exec, 1
  ds_add_u32 v38, v9 offset:6720
  s_mov_b64 exec, -1
  s_mov_b32 s70, 0
L_hs_48:
  ds_read_b32 v9, v38 offset:6720
  s_waitcnt lgkmcnt(0)
  v_cmp_gt_u32 vcc, 12, v9
  s_cmp_eq_u64 vcc, 0
  s_cbranch_scc1 L_hsd_49
  s_sleep 4
  s_add_u32 s70, s70, 1
  s_cmp_lt_u32 s70, 2097152
  s_cbranch_scc1 L_hs_48
L_hsd_49:
  ds_read_b128 v[24:27], v6
  ds_read_b128 v[28:31], v6 offset:16
  s_waitcnt lgkmcnt(0)
  v_pk_add_f32 v[24:25], v[24:25], v[26:27]
  v_pk_add_f32 v[28:29], v[28:29], v[30:31]
  v_pk_add_f32 v[24:25], v[24:25], v[28:29]
  v_mul_f32 v8, 0x3b000000, v24
  v_mul_f32 v9, 0x3b000000, v25
  v_fma_f32 v9, -v8, v8, v9
  v_cvt_pk_bf16_f32 v8, 0, v8
  v_max_f32 v9, 0, v9
  v_cvt_pk_bf16_f32 v9, 0, v9
  v_sub_f32 v20, v20, v8
  v_sub_f32 v21, v21, v8
  v_add_f32 v9, 0x3727c5ac, v9
  v_sub_f32 v22, v22, v8
  v_sub_f32 v23, v23, v8
  v_cvt_pk_bf16_f32 v9, 0, v9
  v_cvt_pk_bf16_f32 v20, 0, v20
  v_sqrt_f32 v9, v9
  v_cvt_pk_bf16_f32 v21, 0, v21
  v_cvt_pk_bf16_f32 v9, 0, v9
  v_cvt_pk_bf16_f32 v22, 0, v22
  v_rcp_f32 v9, v9
  v_cvt_pk_bf16_f32 v23, 0, v23
  v_mul_f32 v20, v20, v9
  v_mul_f32 v21, v21, v9
  v_mul_f32 v22, v22, v9
  v_mul_f32 v23, v23, v9
  v_cvt_pk_bf16_f32 v20, 0, v20
  v_cvt_pk_bf16_f32 v21, 0, v21
  v_cvt_pk_bf16_f32 v22, 0, v22
  v_cvt_pk_bf16_f32 v23, 0, v23
  v_lshrrev_b32 v2, 2, v1
  v_bfe_u32 v3, v1, 1, 1
  s_lshl_b32 s49, s5, 1
  v_or_b32 v3, s49, v3
  v_and_b32 v10, 6, v2
  v_xor_b32 v3, v3, v10
  v_lshlrev_b32 v2, 7, v2
  v_lshl_add_u32 v2, v3, 4, v2
  v_and_b32 v3, 1, v1
  v_lshl_add_u32 v2, v3, 3, v2
  v_add_u32 v2, 20480, v2
  ds_read_b64_tr_b16 v[40:41], v2 offset:0
  ds_read_b64_tr_b16 v[42:43], v2 offset:2048
  ds_read_b64_tr_b16 v[44:45], v2 offset:4096
  ds_read_b64_tr_b16 v[46:47], v2 offset:6144
  ds_read_b64_tr_b16 v[48:49], v2 offset:8192
  ds_read_b64_tr_b16 v[50:51], v2 offset:10240
  ds_read_b64_tr_b16 v[52:53], v2 offset:12288
  ds_read_b64_tr_b16 v[54:55], v2 offset:14336
  ds_read_b64_tr_b16 v[56:57], v2 offset:16384
  ds_read_b64_tr_b16 v[58:59], v2 offset:18432
  ds_read_b64_tr_b16 v[60:61], v2 offset:20480
  ds_read_b64_tr_b16 v[62:63], v2 offset:22528
  s_waitcnt lgkmcnt(10)
  ds_read_b64_tr_b16 v[64:65], v2 offset:24576
  ds_read_b64_tr_b16 v[66:67], v2 offset:26624
  s_waitcnt lgkmcnt(10)
  ds_read_b64_tr_b16 v[68:69], v2 offset:28672
  ds_read_b64_tr_b16 v[70:71], v2 offset:30720
  s_waitcnt lgkmcnt(10)
  ds_read_b64_tr_b16 v[72:73], v2 offset:32768
  ds_read_b64_tr_b16 v[74:75], v2 offset:34816
  s_waitcnt lgkmcnt(10)
  ds_read_b64_tr_b16 v[76:77], v2 offset:36864
  ds_read_b64_tr_b16 v[78:79], v2 offset:38912
  s_waitcnt lgkmcnt(10)
  ds_read_b64_tr_b16 v[80:81], v2 offset:40960
  ds_read_b64_tr_b16 v[82:83], v2 offset:43008
  s_waitcnt lgkmcnt(10)
  ds_read_b64_tr_b16 v[84:85], v2 offset:45056
  ds_read_b64_tr_b16 v[86:87], v2 offset:47104
  s_waitcnt lgkmcnt(10)
  ds_read_b64_tr_b16 v[88:89], v2 offset:49152
  ds_read_b64_tr_b16 v[90:91], v2 offset:51200
  s_waitcnt lgkmcnt(10)
  ds_read_b64_tr_b16 v[92:93], v2 offset:53248
  ds_read_b64_tr_b16 v[94:95], v2 offset:55296
  s_waitcnt lgkmcnt(10)
  ds_read_b64_tr_b16 v[96:97], v2 offset:57344
  ds_read_b64_tr_b16 v[98:99], v2 offset:59392
  s_waitcnt lgkmcnt(10)
  ds_read_b64_tr_b16 v[100:101], v2 offset:61440
  ds_read_b64_tr_b16 v[102:103], v2 offset:63488
  s_waitcnt lgkmcnt(10)
  s_waitcnt lgkmcnt(0)
  v_and_b32 v13, 1, v1
  v_lshlrev_b32 v13, 6, v13
  v_lshrrev_b32 v3, 4, v1
  v_lshl_add_u32 v13, v3, 4, v13
  s_lshl_b32 s49, s5, 7
  s_add_u32 s49, s49, s58
  v_add_u32 v13, s49, v13
  v_and_b32 v14, 1, v1
  v_mul_u32_u24 v14, 1056, v14
  v_lshrrev_b32 v3, 4, v1
  v_lshl_add_u32 v14, v3, 4, v14
  v_lshlrev_b32 v15, 4, v0
  v_add_u32 v15, 4096, v15
  v_add_u32 v36, 0x1000, v15
  s_mov_b32 s70, 0
L_pl_50:
  ds_read_b32 v8, v38 offset:6672
  s_waitcnt lgkmcnt(0)
  v_cmp_eq_u32 vcc, -1, v8
  s_cmp_eq_u64 vcc, 0
  s_cbranch_scc1 L_pld_51
  s_sleep 8
  s_add_u32 s70, s70, 1
  s_cmp_lt_u32 s70, 1048576
  s_cbranch_scc1 L_pl_50
L_pld_51:
  s_mov_b64 s[64:65], -1
  s_mov_b64 s[66:67], -1
  s_mov_b32 s70, 0
L_q_p:
  s_mov_b64 exec, s[64:65]
  global_load_dwordx4 v[16:19], v15, s[42:43] sc1
  s_mov_b64 exec, s[66:67]
  global_load_dwordx4 v[32:35], v36, s[42:43] sc1
  s_mov_b64 exec, -1
  s_waitcnt vmcnt(0)
  v_cmp_ne_u32 s[64:65], s74, v17
  v_cmp_ne_u32 s[68:69], s74, v19
  s_or_b64 s[64:65], s[64:65], s[68:69]
  v_cmp_ne_u32 s[66:67], s74, v33
  v_cmp_ne_u32 s[68:69], s74, v35
  s_or_b64 s[66:67], s[66:67], s[68:69]
  s_or_b64 vcc, s[64:65], s[66:67]
  s_cmp_eq_u64 vcc, 0
  s_cbranch_scc1 L_q_ok
  s_add_u32 s70, s70, 1
  s_cmp_lt_u32 s70, 262144
  s_cbranch_scc1 L_q_p
L_q_ok:
  v_lshlrev_b32 v28, 16, v32
  v_and_b32 v29, s73, v32
  v_lshlrev_b32 v30, 16, v34
  v_and_b32 v31, s73, v34
  v_lshlrev_b32 v24, 16, v16
  v_and_b32 v25, s73, v16
  v_lshlrev_b32 v26, 16, v18
  v_and_b32 v27, s73, v18
  v_add_f32 v28, 1.0, v28
  v_add_f32 v29, 1.0, v29
  v_add_f32 v30, 1.0, v30
  v_add_f32 v31, 1.0, v31
  v_cvt_pk_bf16_f32 v28, 0, v28
  v_cvt_pk_bf16_f32 v29, 0, v29
  v_cvt_pk_bf16_f32 v30, 0, v30
  v_cvt_pk_bf16_f32 v31, 0, v31
  v_mul_f32 v20, v20, v28
  v_mul_f32 v21, v21, v29
  v_mul_f32 v22, v22, v30
  v_mul_f32 v23, v23, v31
  v_cvt_pk_bf16_f32 v20, 0, v20
  v_cvt_pk_bf16_f32 v21, 0, v21
  v_cvt_pk_bf16_f32 v22, 0, v22
  v_cvt_pk_bf16_f32 v23, 0, v23
  v_add_f32 v20, v20, v24
  v_add_f32 v21, v21, v25
  v_add_f32 v22, v22, v26
  v_add_f32 v23, v23, v27
  v_cvt_pk_bf16_f32 v16, v20, v21
  v_cvt_pk_bf16_f32 v17, v22, v23
  ds_write_b64 v12, v[16:17] offset:0
  v_mov_b32 v9, 1
  s_mov_b64 exec, 1
  ds_add_u32 v38, v9 offset:6720
  s_mov_b64 exec, -1
  s_mov_b32 s70, 0
L_hs_52:
  ds_read_b32 v9, v38 offset:6720
  s_waitcnt lgkmcnt(0)
  v_cmp_gt_u32 vcc, 16, v9
  s_cmp_eq_u64 vcc, 0
  s_cbranch_scc1 L_hsd_53
  s_add_u32 s70, s70, 1
  s_cmp_lt_u32 s70, 2097152
  s_cbranch_scc1 L_hs_52
L_hsd_53:
  ds_read_b128 v[104:107], v14 offset:0
  ds_read_b128 v[108:111], v14 offset:64
  ds_read_b128 v[112:115], v14 offset:128
  ds_read_b128 v[116:119], v14 offset:192
  ds_read_b128 v[120:123], v14 offset:256
  ds_read_b128 v[124:127], v14 offset:320
  ds_read_b128 v[128:131], v14 offset:384
  ds_read_b128 v[132:135], v14 offset:448
  ds_read_b128 v[136:139], v14 offset:512
  ds_read_b128 v[140:143], v14 offset:576
  ds_read_b128 v[144:147], v14 offset:640
  ds_read_b128 v[148:151], v14 offset:704
  s_waitcnt lgkmcnt(11)
  v_mfma_f32_16x16x32_bf16 v[8:11], v[40:43], v[104:107], 0
  ds_read_b128 v[152:155], v14 offset:768
  s_waitcnt lgkmcnt(11)
  v_mfma_f32_16x16x32_bf16 v[8:11], v[44:47], v[108:111], v[8:11]
  ds_read_b128 v[156:159], v14 offset:832
  s_waitcnt lgkmcnt(11)
  v_mfma_f32_16x16x32_bf16 v[8:11], v[48:51], v[112:115], v[8:11]
  ds_read_b128 v[160:163], v14 offset:896
  s_waitcnt lgkmcnt(11)
  v_mfma_f32_16x16x32_bf16 v[8:11], v[52:55], v[116:119], v[8:11]
  ds_read_b128 v[164:167], v14 offset:960
  s_waitcnt lgkmcnt(11)
  v_mfma_f32_16x16x32_bf16 v[8:11], v[56:59], v[120:123], v[8:11]
  s_waitcnt lgkmcnt(10)
  v_mfma_f32_16x16x32_bf16 v[8:11], v[60:63], v[124:127], v[8:11]
  s_waitcnt lgkmcnt(9)
  v_mfma_f32_16x16x32_bf16 v[8:11], v[64:67], v[128:131], v[8:11]
  s_waitcnt lgkmcnt(8)
  v_mfma_f32_16x16x32_bf16 v[8:11], v[68:71], v[132:135], v[8:11]
  s_waitcnt lgkmcnt(7)
  v_mfma_f32_16x16x32_bf16 v[8:11], v[72:75], v[136:139], v[8:11]
  s_waitcnt lgkmcnt(6)
  v_mfma_f32_16x16x32_bf16 v[8:11], v[76:79], v[140:143], v[8:11]
  s_waitcnt lgkmcnt(5)
  v_mfma_f32_16x16x32_bf16 v[8:11], v[80:83], v[144:147], v[8:11]
  s_waitcnt lgkmcnt(4)
  v_mfma_f32_16x16x32_bf16 v[8:11], v[84:87], v[148:151], v[8:11]
  s_waitcnt lgkmcnt(3)
  v_mfma_f32_16x16x32_bf16 v[8:11], v[88:91], v[152:155], v[8:11]
  s_waitcnt lgkmcnt(2)
  v_mfma_f32_16x16x32_bf16 v[8:11], v[92:95], v[156:159], v[8:11]
  s_waitcnt lgkmcnt(1)
  v_mfma_f32_16x16x32_bf16 v[8:11], v[96:99], v[160:163], v[8:11]
  s_waitcnt lgkmcnt(0)
  v_mfma_f32_16x16x32_bf16 v[8:11], v[100:103], v[164:167], v[8:11]
  s_nop 7
  v_cvt_pk_bf16_f32 v8, v8, v9
  v_cvt_pk_bf16_f32 v10, v10, v11
  v_mov_b32 v9, s74
  v_mov_b32 v11, s74
  v_min_u32 v8, s72, v8
  v_min_u32 v10, s72, v10
  s_mov_b32 exec_lo, 0x00030003
  s_mov_b32 exec_hi, 0x00030003
  global_store_dwordx4 v13, v[8:11], s[42:43] sc1
  s_mov_b64 exec, -1
  s_mov_b32 s60, 0
  s_branch L_svc1
L_r_wo:
  s_and_b32 s66, s2, 7
  s_lshr_b32 s58, s66, 1
  s_lshl_b32 s58, s58, 14
  s_and_b32 s49, s66, 1
  s_lshl_b32 s49, s49, 12
  s_add_u32 s58, s58, s49
  s_lshl_b32 s49, s61, 9
  s_add_u32 s58, s58, s49
  s_add_u32 s58, s58, 327680
  s_waitcnt lgkmcnt(0)
  s_mul_i32 s74, s74, 0x9e3779b1
  s_add_u32 s74, s74, 0x7f4a7c15
  s_add_u32 s76, s76, s74
  s_cmp_lg_u32 s5, 3
  s_cbranch_scc1 L_nr_54
  s_lshl_b32 s49, s61, 14
  s_lshl_b32 s50, s8, 10
  s_add_u32 s49, s49, s50
  s_add_u32 s49, s49, 524288
  s_add_u32 s50, s49, 256
  s_mov_b32 s54, -1
  s_mov_b32 s55, -1
L_nrl_55:
  s_memtime s[64:65]
  s_waitcnt lgkmcnt(0)
  s_load_dword s51, s[42:43], s49
  s_waitcnt lgkmcnt(0)
  s_memtime s[68:69]
  s_waitcnt lgkmcnt(0)
  s_sub_u32 s68, s68, s64
  s_min_u32 s54, s54, s68
  s_xor_b32 s49, s49, 0x2000
  s_memtime s[64:65]
  s_waitcnt lgkmcnt(0)
  s_load_dword s51, s[42:43], s49
  s_waitcnt lgkmcnt(0)
  s_memtime s[68:69]
  s_waitcnt lgkmcnt(0)
  s_sub_u32 s68, s68, s64
  s_min_u32 s55, s55, s68
  s_xor_b32 s49, s49, 0x2000
  s_add_u32 s49, s49, 128
  s_cmp_lt_u32 s49, s50
  s_cbranch_scc1 L_nrl_55
  s_cmp_lt_u32 s55, s54
  s_cselect_b32 s54, 1, 0
  s_sub_u32 s55, s76, s74
  s_lshr_b32 s55, s55, 2
  s_xor_b32 s54, s54, s55
  s_and_b32 s54, s54, 1
  s_add_u32 s54, s54, s74
  s_lshl_b32 s55, s8, 3
  s_add_u32 s55, s55, s61
  s_lshl_b32 s55, s55, 5
  v_mov_b32 v8, s55
  v_mov_b32 v10, s76
  v_mov_b32 v11, s54
  s_mov_b64 exec, 1
  global_store_dwordx2 v8, v[10:11], s[42:43] offset:1024 sc1
  s_mov_b64 exec, -1
L_nr_54:
  s_mov_b32 s60, 1
  s_branch L_svc1
L_r_f1:
  s_lshl_b32 s48, s61, 6
  s_mul_i32 s49, s61, 47
  s_lshr_b32 s49, s49, 9
  s_mul_i32 s49, s49, 10752
  s_lshl_b32 s58, s61, 9
  s_add_u32 s58, s58, s49
  s_add_u32 s58, s58, 262144
  s_cmp_lt_u32 s5, 2
  s_cselect_b32 s44, s28, s30
  s_cselect_b32 s45, s29, s31
  s_mov_b32 s46, 1409024
  s_mov_b32 s47, 0x20000
  s_mov_b32 s60, 2
  s_waitcnt lgkmcnt(0)
  s_mul_i32 s74, s74, 0x9e3779b1
  s_add_u32 s74, s74, 0x7f4a7c15
  s_add_u32 s76, s76, s74
  s_branch L_svc1
L_r_f2:
  s_mov_b32 s44, s32
  s_mov_b32 s45, s33
  s_mov_b32 s46, 1409024
  s_mov_b32 s47, 0x20000
  s_waitcnt lgkmcnt(0)
  s_mul_i32 s74, s74, 0x9e3779b1
  s_add_u32 s74, s74, 0x7f4a7c15
  s_add_u32 s76, s76, s74
  s_mov_b32 s60, 3
  s_lshl_b32 s48, s61, 5
  global_load_dword v167, v38, s[38:39]
  s_branch L_svc1
L_r_none:
  s_mov_b32 s60, 0
  s_waitcnt lgkmcnt(0)
  s_mul_i32 s74, s74, 0x9e3779b1
  s_add_u32 s74, s74, 0x7f4a7c15
  s_add_u32 s76, s76, s74
L_svc1:
  s_cmp_lg_u32 s5, 0
  s_cbranch_scc1 L_disp3
  s_and_b32 s64, s6, 31
  s_lshl_b32 s64, s64, 10
  s_and_b32 s65, s6, 32
  s_lshl_b32 s65, s65, 1
  s_add_u32 s64, s64, s65
  s_add_u32 s64, s64, 32768
  v_bfe_u32 v16, v1, 2, 3
  v_lshl_add_u32 v16, v16, 7, s64
  v_and_b32 v17, 3, v1
  v_lshl_add_u32 v16, v17, 4, v16
  v_and_b32 v17, 31, v1
  v_lshlrev_b32 v17, 3, v17
  s_lshl_b32 s71, s8, 8
  v_and_b32 v18, 7, v1
  v_lshl_add_u32 v18, v18, 5, s71
  s_mov_b32 s70, 0
L_pl_56:
  ds_read_b32 v8, v38 offset:6664
  s_waitcnt lgkmcnt(0)
  v_cmp_eq_u32 vcc, -1, v8
  s_cmp_eq_u64 vcc, 0
  s_cbranch_scc1 L_pld_57
  s_sleep 8
  s_add_u32 s70, s70, 1
  s_cmp_lt_u32 s70, 1048576
  s_cbranch_scc1 L_pl_56
L_pld_57:
  global_load_dword v19, v18, s[42:43] offset:1024 sc1
  s_mov_b32 s70, 0
L_polt_58:
  global_load_dwordx4 v[20:23], v16, s[42:43] sc1
  s_waitcnt vmcnt(0)
  v_cmp_ne_u32 vcc, s74, v21
  v_cmp_ne_u32 s[68:69], s74, v23
  s_or_b64 vcc, vcc, s[68:69]
  s_cmp_eq_u64 vcc, 0
  s_cbranch_scc1 L_poltd_59
  s_add_u32 s70, s70, 1
  s_cmp_lt_u32 s70, 262144
  s_cbranch_scc1 L_polt_58
L_poltd_59:
  v_mov_b32 v21, v22
  ds_write_b64 v17, v[20:21] offset:6400
  v_cmp_ne_u32 vcc, s76, v19
  s_cmp_eq_u64 vcc, 0
  s_cselect_b32 s75, 1, 0
L_svc2:
  v_lshlrev_b32 v16, 4, v1
  s_lshl_b32 s64, s6, 9
  s_add_u32 s64, s64, 65536
  s_lshl_b32 s65, s7, 7
  s_add_u32 s65, s65, s64
  v_mov_b32 v18, s65
  s_mov_b32 s70, 0
L_pl_60:
  ds_read_b128 v[104:107], v16 offset:12032
  ds_read_b128 v[108:111], v16 offset:13056
  ds_read_b128 v[112:115], v16 offset:14080
  ds_read_b128 v[116:119], v16 offset:15104
  ds_read_b128 v[120:123], v16 offset:16128
  ds_read_b128 v[124:127], v16 offset:17152
  ds_read_b128 v[128:131], v16 offset:18176
  ds_read_b128 v[132:135], v16 offset:19200
  s_waitcnt lgkmcnt(0)
  v_max3_u32 v8, v104, v105, v106
  v_max3_u32 v8, v8, v108, v109
  v_max3_u32 v8, v8, v110, v112
  v_max3_u32 v8, v8, v113, v114
  v_max3_u32 v8, v8, v116, v117
  v_max3_u32 v8, v8, v118, v120
  v_max3_u32 v8, v8, v121, v122
  v_max3_u32 v8, v8, v124, v125
  v_max3_u32 v8, v8, v126, v128
  v_max3_u32 v8, v8, v129, v130
  v_max3_u32 v8, v8, v132, v133
  v_max_u32 v8, v8, v134
  v_cmp_eq_u32 vcc, -1, v8
  s_cmp_eq_u64 vcc, 0
  s_cbranch_scc1 L_pld_61
  s_sleep 4
  s_add_u32 s70, s70, 1
  s_cmp_lt_u32 s70, 1048576
  s_cbranch_scc1 L_pl_60
L_pld_61:
  v_max3_f32 v8, v104, v105, v106
  v_max3_f32 v8, v8, v108, v109
  v_max3_f32 v8, v8, v110, v112
  v_max3_f32 v8, v8, v113, v114
  v_max3_f32 v8, v8, v116, v117
  v_max3_f32 v8, v8, v118, v120
  v_max3_f32 v8, v8, v121, v122
  v_max3_f32 v8, v8, v124, v125
  v_max3_f32 v8, v8, v126, v128
  v_max3_f32 v8, v8, v129, v130
  v_max3_f32 v8, v8, v132, v133
  v_max_f32 v8, v8, v134
  s_nop 1
  v_max_f32_dpp v8, v8, v8 row_ror:8 row_mask:0xf bank_mask:0xf
  s_nop 1
  v_max_f32_dpp v8, v8, v8 row_ror:4 row_mask:0xf bank_mask:0xf
  s_nop 1
  v_max_f32_dpp v8, v8, v8 row_ror:2 row_mask:0xf bank_mask:0xf
  s_nop 1
  v_max_f32_dpp v8, v8, v8 row_ror:1 row_mask:0xf bank_mask:0xf
  v_mov_b32 v11, v8
  s_nop 1
  v_permlane16_swap_b32 v11, v8
  v_max_f32 v8, v8, v11
  v_mov_b32 v11, v8
  s_nop 1
  v_permlane32_swap_b32 v11, v8
  v_max_f32 v8, v8, v11
  v_min_u32 v9, s72, v8
  ds_write_b32 v38, v9 offset:6656
  v_sub_f32 v104, v104, v8
  v_sub_f32 v105, v105, v8
  v_sub_f32 v106, v106, v8
  v_sub_f32 v108, v108, v8
  v_sub_f32 v109, v109, v8
  v_sub_f32 v110, v110, v8
  v_sub_f32 v112, v112, v8
  v_sub_f32 v113, v113, v8
  v_sub_f32 v114, v114, v8
  v_sub_f32 v116, v116, v8
  v_sub_f32 v117, v117, v8
  v_sub_f32 v118, v118, v8
  v_sub_f32 v120, v120, v8
  v_sub_f32 v121, v121, v8
  v_sub_f32 v122, v122, v8
  v_sub_f32 v124, v124, v8
  v_sub_f32 v125, v125, v8
  v_sub_f32 v126, v126, v8
  v_sub_f32 v128, v128, v8
  v_sub_f32 v129, v129, v8
  v_sub_f32 v130, v130, v8
  v_sub_f32 v132, v132, v8
  v_sub_f32 v133, v133, v8
  v_sub_f32 v134, v134, v8
  v_mul_f32 v104, 0x3fb8aa3b, v104
  v_mul_f32 v105, 0x3fb8aa3b, v105
  v_mul_f32 v106, 0x3fb8aa3b, v106
  v_mul_f32 v108, 0x3fb8aa3b, v108
  v_mul_f32 v109, 0x3fb8aa3b, v109
  v_mul_f32 v110, 0x3fb8aa3b, v110
  v_mul_f32 v112, 0x3fb8aa3b, v112
  v_mul_f32 v113, 0x3fb8aa3b, v113
  v_mul_f32 v114, 0x3fb8aa3b, v114
  v_mul_f32 v116, 0x3fb8aa3b, v116
  v_mul_f32 v117, 0x3fb8aa3b, v117
  v_mul_f32 v118, 0x3fb8aa3b, v118
  v_mul_f32 v120, 0x3fb8aa3b, v120
  v_mul_f32 v121, 0x3fb8aa3b, v121
  v_mul_f32 v122, 0x3fb8aa3b, v122
  v_mul_f32 v124, 0x3fb8aa3b, v124
  v_mul_f32 v125, 0x3fb8aa3b, v125
  v_mul_f32 v126, 0x3fb8aa3b, v126
  v_mul_f32 v128, 0x3fb8aa3b, v128
  v_mul_f32 v129, 0x3fb8aa3b, v129
  v_mul_f32 v130, 0x3fb8aa3b, v130
  v_mul_f32 v132, 0x3fb8aa3b, v132
  v_mul_f32 v133, 0x3fb8aa3b, v133
  v_mul_f32 v134, 0x3fb8aa3b, v134
  v_exp_f32 v104, v104
  v_exp_f32 v105, v105
  v_exp_f32 v106, v106
  v_exp_f32 v108, v108
  v_exp_f32 v109, v109
  v_exp_f32 v110, v110
  v_exp_f32 v112, v112
  v_exp_f32 v113, v113
  v_exp_f32 v114, v114
  v_exp_f32 v116, v116
  v_exp_f32 v117, v117
  v_exp_f32 v118, v118
  v_exp_f32 v120, v120
  v_exp_f32 v121, v121
  v_exp_f32 v122, v122
  v_exp_f32 v124, v124
  v_exp_f32 v125, v125
  v_exp_f32 v126, v126
  v_exp_f32 v128, v128
  v_exp_f32 v129, v129
  v_exp_f32 v130, v130
  v_exp_f32 v132, v132
  v_exp_f32 v133, v133
  v_exp_f32 v134, v134
  s_nop 0
  v_add_f32 v104, v104, v120
  v_add_f32 v105, v105, v121
  v_add_f32 v106, v106, v122
  v_add_f32 v108, v108, v124
  v_add_f32 v109, v109, v125
  v_add_f32 v110, v110, v126
  v_add_f32 v112, v112, v128
  v_add_f32 v113, v113, v129
  v_add_f32 v114, v114, v130
  v_add_f32 v116, v116, v132
  v_add_f32 v117, v117, v133
  v_add_f32 v118, v118, v134
  v_add_f32 v104, v104, v112
  v_add_f32 v105, v105, v113
  v_add_f32 v106, v106, v114
  v_add_f32 v108, v108, v116
  v_add_f32 v109, v109, v117
  v_add_f32 v110, v110, v118
  v_add_f32 v104, v104, v108
  v_add_f32 v105, v105, v109
  v_add_f32 v106, v106, v110
  v_add_f32 v10, v104, v105
  v_add_f32 v10, v10, v106
  s_nop 1
  v_add_f32_dpp v10, v10, v10 row_ror:8 row_mask:0xf bank_mask:0xf
  s_nop 1
  v_add_f32_dpp v10, v10, v10 row_ror:4 row_mask:0xf bank_mask:0xf
  s_nop 1
  v_add_f32_dpp v10, v10, v10 row_ror:2 row_mask:0xf bank_mask:0xf
  s_nop 1
  v_add_f32_dpp v10, v10, v10 row_ror:1 row_mask:0xf bank_mask:0xf
  v_mov_b32 v11, v10
  s_nop 1
  v_permlane16_swap_b32 v11, v10
  v_add_f32 v10, v10, v11
  v_mov_b32 v11, v10
  s_nop 1
  v_permlane32_swap_b32 v11, v10
  v_add_f32 v10, v10, v11
  v_mov_b32 v9, s74
  v_mov_b32 v11, s74
  s_mov_b64 exec, 1
  s_cmp_eq_u32 s75, 1
  s_cbranch_scc0 L_pf_62
  global_store_dwordx4 v18, v[8:11], s[42:43]
  s_branch L_pe_63
L_pf_62:
  global_store_dwordx4 v18, v[8:11], s[42:43] sc1
L_pe_63:
  s_mov_b64 exec, -1
L_disp3:
  s_mov_b32 s77, 0
  s_bfe_u32 s62, s74, 0x80000
  s_bfe_u32 s63, s74, 0x80008
  s_bfe_u32 s64, s74, 0x80010
  s_bfe_u32 s65, s74, 0x80018
  s_cmp_lg_u32 s5, 1
  s_cbranch_scc1 L_dry_ret
  s_mov_b32 s77, 1
  v_mov_b32 v5, 11008
  v_mov_b32 v6, 11008
  v_mov_b32 v7, 11008
  v_mov_b32 v14, 11008
  v_mov_b32 v30, 11008
  v_mov_b32 v2, 0
  v_mov_b32 v7, 0
  s_mov_b64 s[50:51], -1
  s_branch L_dry_op
L_dry_1:
  s_cmp_eq_u32 s60, 1
  s_cbranch_scc1 L_wo_ok
  s_cmp_eq_u32 s60, 2
  s_cbranch_scc1 L_f1_ok
  s_cmp_eq_u32 s60, 3
  s_cbranch_scc1 L_f2_ok
L_dry_end:
  s_mov_b64 exec, -1
  s_mov_b32 s77, 0
L_dry_ret:
  s_cmp_lg_u32 s5, 2
  s_cbranch_scc1 L_opt_64
  s_mov_b32 s70, 0
L_pl_65:
  ds_read_b32 v8, v38 offset:6656
  s_waitcnt lgkmcnt(0)
  v_cmp_eq_u32 vcc, -1, v8
  s_cmp_eq_u64 vcc, 0
  s_cbranch_scc1 L_pld_66
  s_sleep 32
  s_add_u32 s70, s70, 1
  s_cmp_lt_u32 s70, 1048576
  s_cbranch_scc1 L_pl_65
L_pld_66:
  s_lshl_b32 s56, s6, 2
  s_add_u32 s56, s56, s7
  s_lshl_b32 s57, s56, 9
  s_add_u32 s57, s57, 131072
  v_lshl_add_u32 v3, v1, 3, s57
  global_load_dword v167, v3, s[42:43] sc1
L_opt_64:
  s_cmp_eq_u32 s60, 2
  s_cbranch_scc1 L_pre_f1
  s_cmp_eq_u32 s60, 3
  s_cbranch_scc1 L_pre_f2
  s_cmp_eq_u32 s60, 1
  s_cbranch_scc1 L_pre_wo
  s_lshr_b32 s68, s14, 26
  s_lshl_b32 s68, s68, 2
  s_add_u32 s68, s68, s5
  s_and_b32 s68, s68, 31
  s_and_b32 s69, s100, 0xffff
  s_lshr_b32 s100, s100, 16
  v_and_b32 v12, 3, v1
  v_lshl_add_u32 v12, v12, 7, s69
  v_min_u32 v12, s100, v12
  v_lshrrev_b32 v13, 2, v1
  v_mul_u32_u24 v13, 2752, v13
  s_mul_i32 s69, s68, 44032
  v_add3_u32 v12, v12, v13, s69
  v_min_u32 v13, 42, v1
  s_mul_i32 s68, s68, 44032
  s_add_u32 s68, s68, s101
  v_lshl_add_u32 v13, v13, 10, s68
  s_branch L_join
L_pre_wo:
  s_mov_b32 s70, 0
L_hs_67:
  ds_read_b32 v9, v38 offset:6720
  s_waitcnt lgkmcnt(0)
  v_cmp_gt_u32 vcc, 8, v9
  s_cmp_eq_u64 vcc, 0
  s_cbranch_scc1 L_hsd_68
  s_sleep 8
  s_add_u32 s70, s70, 1
  s_cmp_lt_u32 s70, 2097152
  s_cbranch_scc1 L_hs_67
L_hsd_68:
  v_lshrrev_b32 v2, 2, v1
  v_bfe_u32 v3, v1, 1, 1
  s_lshl_b32 s49, s5, 1
  v_or_b32 v3, s49, v3
  v_and_b32 v10, 6, v2
  v_xor_b32 v3, v3, v10
  v_lshlrev_b32 v2, 7, v2
  v_lshl_add_u32 v2, v3, 4, v2
  v_and_b32 v3, 1, v1
  v_lshl_add_u32 v2, v3, 3, v2
  v_add_u32 v2, 20480, v2
  ds_read_b64_tr_b16 v[40:41], v2 offset:0
  ds_read_b64_tr_b16 v[42:43], v2 offset:2048
  ds_read_b64_tr_b16 v[44:45], v2 offset:4096
  ds_read_b64_tr_b16 v[46:47], v2 offset:6144
  ds_read_b64_tr_b16 v[48:49], v2 offset:8192
  ds_read_b64_tr_b16 v[50:51], v2 offset:10240
  ds_read_b64_tr_b16 v[52:53], v2 offset:12288
  ds_read_b64_tr_b16 v[54:55], v2 offset:14336
  ds_read_b64_tr_b16 v[56:57], v2 offset:16384
  ds_read_b64_tr_b16 v[58:59], v2 offset:18432
  ds_read_b64_tr_b16 v[60:61], v2 offset:20480
  ds_read_b64_tr_b16 v[62:63], v2 offset:22528
  s_waitcnt lgkmcnt(10)
  ds_read_b64_tr_b16 v[64:65], v2 offset:24576
  ds_read_b64_tr_b16 v[66:67], v2 offset:26624
  s_waitcnt lgkmcnt(10)
  ds_read_b64_tr_b16 v[68:69], v2 offset:28672
  ds_read_b64_tr_b16 v[70:71], v2 offset:30720
  s_waitcnt lgkmcnt(10)
  ds_read_b64_tr_b16 v[72:73], v2 offset:32768
  ds_read_b64_tr_b16 v[74:75], v2 offset:34816
  s_waitcnt lgkmcnt(10)
  ds_read_b64_tr_b16 v[76:77], v2 offset:36864
  ds_read_b64_tr_b16 v[78:79], v2 offset:38912
  s_waitcnt lgkmcnt(10)
  ds_read_b64_tr_b16 v[80:81], v2 offset:40960
  ds_read_b64_tr_b16 v[82:83], v2 offset:43008
  s_waitcnt lgkmcnt(10)
  ds_read_b64_tr_b16 v[84:85], v2 offset:45056
  ds_read_b64_tr_b16 v[86:87], v2 offset:47104
  s_waitcnt lgkmcnt(10)
  ds_read_b64_tr_b16 v[88:89], v2 offset:49152
  ds_read_b64_tr_b16 v[90:91], v2 offset:51200
  s_waitcnt lgkmcnt(10)
  ds_read_b64_tr_b16 v[92:93], v2 offset:53248
  ds_read_b64_tr_b16 v[94:95], v2 offset:55296
  s_waitcnt lgkmcnt(10)
  ds_read_b64_tr_b16 v[96:97], v2 offset:57344
  ds_read_b64_tr_b16 v[98:99], v2 offset:59392
  s_waitcnt lgkmcnt(10)
  ds_read_b64_tr_b16 v[100:101], v2 offset:61440
  ds_read_b64_tr_b16 v[102:103], v2 offset:63488
  s_waitcnt lgkmcnt(10)
  s_waitcnt lgkmcnt(0)
  s_lshl_b32 s49, s5, 3
  s_add_u32 s49, s49, s66
  s_lshl_b32 s50, s49, 9
  s_add_u32 s50, s50, 65536
  v_lshrrev_b32 v12, 5, v1
  v_lshl_add_u32 v15, v12, 14, s50
  v_and_b32 v16, 3, v1
  v_lshl_add_u32 v15, v16, 7, v15
  s_mov_b32 s70, 0
L_pl_69:
  ds_read_b32 v8, v38 offset:6676
  s_waitcnt lgkmcnt(0)
  v_cmp_eq_u32 vcc, -1, v8
  s_cmp_eq_u64 vcc, 0
  s_cbranch_scc1 L_pld_70
  s_sleep 16
  s_add_u32 s70, s70, 1
  s_cmp_lt_u32 s70, 1048576
  s_cbranch_scc1 L_pl_69
L_pld_70:
  s_mov_b32 s70, 0
L_polt_71:
  global_load_dwordx4 v[16:19], v15, s[42:43] sc1
  s_waitcnt vmcnt(0)
  v_cmp_ne_u32 vcc, s74, v17
  v_cmp_ne_u32 s[68:69], s74, v19
  s_or_b64 vcc, vcc, s[68:69]
  s_cmp_eq_u64 vcc, 0
  s_cbranch_scc1 L_poltd_72
  s_sleep 8
  s_add_u32 s70, s70, 1
  s_cmp_lt_u32 s70, 262144
  s_cbranch_scc1 L_polt_71
L_poltd_72:
  v_max_f32_dpp v10, v16, v16 quad_perm:[1,0,3,2] row_mask:0xf bank_mask:0xf
  s_nop 1
  v_max_f32_dpp v10, v10, v10 quad_perm:[2,3,0,1] row_mask:0xf bank_mask:0xf
  v_sub_f32 v8, v16, v10
  v_mul_f32 v8, 0x3fb8aa3b, v8
  v_exp_f32 v8, v8
  s_nop 0
  v_mul_f32 v9, v18, v8
  s_nop 1
  v_add_f32_dpp v9, v9, v9 quad_perm:[1,0,3,2] row_mask:0xf bank_mask:0xf
  s_nop 1
  v_add_f32_dpp v9, v9, v9 quad_perm:[2,3,0,1] row_mask:0xf bank_mask:0xf
  v_rcp_f32 v9, v9
  s_nop 0
  v_mul_f32 v8, v8, v9
  s_nop 1
  v_mov_b32_dpp v20, v8 quad_perm:[0,0,0,0] row_mask:0xf bank_mask:0xf
  v_mov_b32_dpp v21, v8 quad_perm:[1,1,1,1] row_mask:0xf bank_mask:0xf
  v_mov_b32_dpp v22, v8 quad_perm:[2,2,2,2] row_mask:0xf bank_mask:0xf
  v_mov_b32_dpp v23, v8 quad_perm:[3,3,3,3] row_mask:0xf bank_mask:0xf
  s_lshl_b32 s49, s49, 11
  s_add_u32 s49, s49, 131072
  v_lshrrev_b32 v12, 5, v1
  v_and_b32 v16, 31, v1
  v_lshlrev_b32 v15, 16, v12
  v_lshl_add_u32 v15, v16, 4, v15
  v_add_u32 v15, s49, v15
  v_mul_u32_u24 v12, 1056, v12
  v_bfe_u32 v16, v1, 3, 2
  v_lshl_add_u32 v12, v16, 6, v12
  v_and_b32 v16, 3, v1
  v_lshl_add_u32 v12, v16, 4, v12
  v_bfe_u32 v16, v1, 2, 1
  v_lshl_add_u32 v12, v16, 3, v12
  s_lshl_b32 s49, s5, 8
  v_add_u32 v12, s49, v12
  v_and_b32 v14, 1, v1
  v_mul_u32_u24 v14, 1056, v14
  v_lshrrev_b32 v3, 4, v1
  v_lshl_add_u32 v14, v3, 4, v14
  v_and_b32 v13, 1, v1
  v_lshlrev_b32 v13, 6, v13
  v_lshrrev_b32 v3, 4, v1
  v_lshl_add_u32 v13, v3, 4, v13
  s_lshl_b32 s49, s5, 7
  s_add_u32 s49, s49, s58
  v_add_u32 v13, s49, v13
  v_add_u32 v37, 0x2000, v13
  v_mov_b32 v36, 0xff
  s_branch L_join
L_pre_f1:
  s_cmp_lg_u32 s5, 3
  s_cbranch_scc1 L_hc_73
  s_mov_b32 s70, 0
L_pl_74:
  ds_read_b32 v8, v38 offset:6400
  s_waitcnt lgkmcnt(0)
  v_cmp_eq_u32 vcc, -1, v8
  s_cmp_eq_u64 vcc, 0
  s_cbranch_scc1 L_pld_75
  s_sleep 32
  s_add_u32 s70, s70, 1
  s_cmp_lt_u32 s70, 1048576
  s_cbranch_scc1 L_pl_74
L_pld_75:
  v_lshlrev_b32 v110, 5, v1
  global_load_dword v109, v110, s[42:43] offset:1028 sc1
  s_waitcnt vmcnt(0)
  v_subrev_u32 v109, s74, v109
  v_cmp_eq_u32 vcc, 1, v109
  s_bcnt1_i32_b64 s70, vcc
  v_cmp_eq_u32 vcc, 0, v109
  s_bcnt1_i32_b64 s71, vcc
  s_cmp_gt_u32 s70, s71
  s_cselect_b32 s71, 4, 0
  s_sub_u32 s68, s76, s74
  s_xor_b32 s71, s71, s68
  s_and_b32 s71, s71, 4
  s_lshl_b32 s71, s71, 11
  v_mov_b32 v104, s71
  ds_write_b32 v38, v104 offset:6668
L_hc_73:
  v_mov_b32 v31, v13
  v_lshlrev_b32 v15, 4, v0
  v_add_u32 v24, 12288, v15
  v_add_u32 v25, 16384, v15
  v_add_u32 v26, 20480, v15
  s_mov_b32 s70, 0
L_pl_76:
  ds_read_b32 v11, v38 offset:6668
  s_waitcnt lgkmcnt(0)
  v_cmp_eq_u32 vcc, -1, v11
  s_cmp_eq_u64 vcc, 0
  s_cbranch_scc1 L_pld_77
  s_sleep 8
  s_add_u32 s70, s70, 1
  s_cmp_lt_u32 s70, 1048576
  s_cbranch_scc1 L_pl_76
L_pld_77:
  v_add_u32 v15, 327680, v15
  v_add_u32 v15, v11, v15
  v_add_u32 v35, 4096, v15
  v_add_u32 v32, 16384, v15
  v_add_u32 v36, 20480, v15
  v_add_u32 v33, 32768, v15
  v_add_u32 v37, 36864, v15
  v_add_u32 v34, 49152, v15
  v_add_u32 v39, 53248, v15
  v_bfe_u32 v6, v1, 2, 1
  v_lshlrev_b32 v6, 5, v6
  v_add_u32 v6, 11008, v6
  s_lshl_b32 s49, s5, 3
  v_add_u32 v5, s49, v6
  v_and_b32 v14, 7, v1
  v_mul_u32_u24 v14, 1056, v14
  v_lshrrev_b32 v3, 4, v1
  v_lshl_add_u32 v14, v3, 4, v14
  v_and_b32 v7, 1, v1
  v_lshlrev_b32 v7, 5, v7
  v_and_b32 v13, 1, v1
  v_lshlrev_b32 v13, 5, v13
  v_bfe_u32 v3, v1, 4, 1
  v_lshl_add_u32 v13, v3, 3, v13
  s_lshl_b32 s49, s5, 7
  s_add_u32 s49, s49, s58
  v_add_u32 v13, s49, v13
  v_lshrrev_b32 v3, 5, v1
  v_lshl_add_u32 v13, v3, 4, v13
  v_add_u32 v4, 0x2000, v13
  s_mov_b32 s54, 0
  v_lshrrev_b32 v2, 2, v1
  v_mul_u32_u24 v2, 5504, v2
  s_and_b32 s49, s5, 2
  s_or_b32 s49, s49, s54
  v_xor_b32 v3, s49, v1
  v_and_b32 v3, 3, v3
  v_lshl_add_u32 v2, v3, 4, v2
  v_mov_b32 v0, v2
  v_lshrrev_b32 v6, 3, v1
  v_lshlrev_b32 v6, 6, v6
  v_bfe_u32 v3, v1, 2, 1
  v_lshl_add_u32 v6, v3, 14, v6
  v_and_b32 v8, 2, v1
  v_or_b32 v3, v3, v8
  v_xor_b32 v3, s5, v3
  v_lshl_add_u32 v6, v3, 4, v6
  v_lshl_add_u32 v6, v8, 14, v6
  v_and_b32 v3, 1, v1
  v_lshl_add_u32 v6, v3, 3, v6
  v_add_u32 v6, 20480, v6
  s_and_b32 s55, s5, 1
  s_mul_i32 s49, s55, 704512
  s_add_u32 s49, s49, s48
  s_mul_i32 s50, s54, 2752
  s_add_u32 s49, s49, s50
  s_lshr_b32 s50, s5, 1
  s_lshl_b32 s50, s50, 15
  s_lshl_b32 s54, s54, 14
  s_add_u32 s50, s50, s54
  s_lshl_b32 s55, s55, 13
  s_add_u32 s50, s50, s55
  s_add_u32 s50, s50, 20480
  s_mov_b32 s70, 0
L_pl_78:
  ds_read_b32 v8, v38 offset:6676
  s_waitcnt lgkmcnt(0)
  v_cmp_eq_u32 vcc, -1, v8
  s_cmp_eq_u64 vcc, 0
  s_cbranch_scc1 L_pld_79
  s_sleep 16
  s_add_u32 s70, s70, 1
  s_cmp_lt_u32 s70, 1048576
  s_cbranch_scc1 L_pl_78
L_pld_79:
  global_load_dwordx2 v[8:9], v31, s[16:17]
  s_mov_b32 s70, 0
L_polt_80:
  global_load_dwordx4 v[136:139], v24, s[42:43] sc1
  global_load_dwordx4 v[140:143], v25, s[42:43] sc1
  global_load_dwordx4 v[144:147], v26, s[42:43] sc1
  s_waitcnt vmcnt(0)
  v_cmp_ne_u32 vcc, s74, v137
  v_cmp_ne_u32 s[68:69], s74, v139
  s_or_b64 vcc, vcc, s[68:69]
  v_cmp_ne_u32 s[68:69], s74, v141
  s_or_b64 vcc, vcc, s[68:69]
  v_cmp_ne_u32 s[68:69], s74, v143
  s_or_b64 vcc, vcc, s[68:69]
  v_cmp_ne_u32 s[68:69], s74, v145
  s_or_b64 vcc, vcc, s[68:69]
  v_cmp_ne_u32 s[68:69], s74, v147
  s_or_b64 vcc, vcc, s[68:69]
  s_cmp_eq_u64 vcc, 0
  s_cbranch_scc1 L_poltd_81
  s_sleep 8
  s_add_u32 s70, s70, 1
  s_cmp_lt_u32 s70, 262144
  s_cbranch_scc1 L_polt_80
L_poltd_81:
  v_lshlrev_b32 v16, 16, v8
  v_and_b32 v17, s73, v8
  v_lshlrev_b32 v18, 16, v9
  v_and_b32 v19, s73, v9
  v_lshlrev_b32 v20, 16, v136
  v_and_b32 v21, s73, v136
  v_lshlrev_b32 v22, 16, v138
  v_and_b32 v23, s73, v138
  v_lshlrev_b32 v28, 16, v144
  v_and_b32 v29, s73, v144
  v_lshlrev_b32 v30, 16, v146
  v_and_b32 v31, s73, v146
  v_add_f32 v28, 1.0, v28
  v_add_f32 v29, 1.0, v29
  v_add_f32 v30, 1.0, v30
  v_add_f32 v31, 1.0, v31
  v_cvt_pk_bf16_f32 v8, v28, v29
  v_cvt_pk_bf16_f32 v9, v30, v31
  v_mov_b32 v141, v142
  ds_write_b64 v12, v[8:9] offset:2112
  ds_write_b64 v12, v[140:141] offset:4224
  v_cvt_pk_bf16_f32 v28, 0, v28
  v_cvt_pk_bf16_f32 v29, 0, v29
  v_cvt_pk_bf16_f32 v30, 0, v30
  v_cvt_pk_bf16_f32 v31, 0, v31
  v_mul_f32 v24, v20, v28
  v_mul_f32 v25, v21, v29
  v_mul_f32 v26, v22, v30
  v_mul_f32 v27, v23, v31
  v_mul_f32 v28, v16, v28
  v_mul_f32 v29, v17, v29
  v_mul_f32 v30, v18, v30
  v_mul_f32 v31, v19, v31
  s_branch L_join
L_pre_f2:
  s_cmp_lg_u32 s5, 3
  s_cbranch_scc1 L_hc_82
  s_mov_b32 s70, 0
L_pl_83:
  ds_read_b32 v8, v38 offset:6400
  s_waitcnt lgkmcnt(0)
  v_cmp_eq_u32 vcc, -1, v8
  s_cmp_eq_u64 vcc, 0
  s_cbranch_scc1 L_pld_84
  s_sleep 32
  s_add_u32 s70, s70, 1
  s_cmp_lt_u32 s70, 1048576
  s_cbranch_scc1 L_pl_83
L_pld_84:
  v_lshlrev_b32 v110, 5, v1
  global_load_dword v109, v110, s[42:43] offset:1028 sc1
  s_waitcnt vmcnt(0)
  v_subrev_u32 v109, s74, v109
  v_cmp_eq_u32 vcc, 1, v109
  s_bcnt1_i32_b64 s70, vcc
  v_cmp_eq_u32 vcc, 0, v109
  s_bcnt1_i32_b64 s71, vcc
  s_cmp_gt_u32 s70, s71
  s_cselect_b32 s71, 4, 0
  s_sub_u32 s68, s76, s74
  s_xor_b32 s71, s71, s68
  s_and_b32 s71, s71, 4
  s_lshl_b32 s71, s71, 11
  v_mov_b32 v104, s71
  ds_write_b32 v38, v104 offset:6668
L_hc_82:
  v_and_b32 v12, 1, v1
  v_lshrrev_b32 v14, 4, v1
  s_lshl_b32 s49, s61, 5
  v_lshl_add_u32 v3, v14, 3, s49
  v_lshl_add_u32 v13, v12, 10, v3
  v_mov_b32 v31, v13
  v_lshlrev_b32 v15, 6, v12
  v_lshl_add_u32 v15, v14, 4, v15
  s_lshl_b32 s49, s61, 7
  v_add_u32 v15, s49, v15
  v_add_u32 v24, 12288, v15
  v_add_u32 v25, 24576, v15
  s_mov_b32 s70, 0
L_pl_85:
  ds_read_b32 v11, v38 offset:6668
  s_waitcnt lgkmcnt(0)
  v_cmp_eq_u32 vcc, -1, v11
  s_cmp_eq_u64 vcc, 0
  s_cbranch_scc1 L_pld_86
  s_sleep 8
  s_add_u32 s70, s70, 1
  s_cmp_lt_u32 s70, 1048576
  s_cbranch_scc1 L_pl_85
L_pld_86:
  v_add_u32 v15, 327680, v15
  v_add_u32 v15, v11, v15
  v_add_u32 v35, 4096, v15
  v_add_u32 v32, 16384, v15
  v_add_u32 v36, 20480, v15
  v_add_u32 v33, 32768, v15
  v_add_u32 v37, 36864, v15
  v_add_u32 v34, 49152, v15
  v_add_u32 v39, 53248, v15
  s_lshl_b32 s49, s5, 14
  s_add_u32 s49, s49, 264192
  v_lshl_add_u32 v28, v14, 7, s49
  v_add_u32 v28, v11, v28
  v_lshl_add_u32 v28, v12, 5, v28
  v_and_b32 v3, 2, v1
  v_lshl_add_u32 v28, v3, 3, v28
  v_bfe_u32 v3, v1, 2, 2
  v_lshl_add_u32 v28, v3, 9, v28
  v_lshl_add_u32 v12, v14, 1, v12
  v_lshlrev_b32 v12, 4, v12
  v_add_u32 v12, 11008, v12
  s_lshl_b32 s49, s5, 7
  v_add_u32 v30, s49, v12
  v_lshrrev_b32 v2, 1, v1
  v_lshlrev_b32 v2, 10, v2
  v_and_b32 v3, 1, v1
  v_lshl_add_u32 v2, v3, 4, v2
  v_mov_b32 v29, v2
  v_lshlrev_b32 v6, 8, v14
  v_bfe_u32 v3, v1, 2, 2
  v_lshl_add_u32 v6, v3, 5, v6
  v_and_b32 v3, 3, v1
  v_lshl_add_u32 v6, v3, 3, v6
  s_mul_i32 s49, s5, 11264
  s_add_u32 s49, s49, 20480
  v_add_u32 v6, s49, v6
  s_mov_b32 s70, 0
L_pl_87:
  ds_read_b32 v8, v38 offset:6676
  s_waitcnt lgkmcnt(0)
  v_cmp_eq_u32 vcc, -1, v8
  s_cmp_eq_u64 vcc, 0
  s_cbranch_scc1 L_pld_88
  s_sleep 16
  s_add_u32 s70, s70, 1
  s_cmp_lt_u32 s70, 1048576
  s_cbranch_scc1 L_pl_87
L_pld_88:
  global_load_dwordx2 v[8:9], v31, s[16:17]
  s_mov_b32 s70, 0
L_polt_89:
  global_load_dwordx4 v[136:139], v24, s[42:43] sc1
  global_load_dwordx4 v[140:143], v25, s[42:43] sc1
  s_waitcnt vmcnt(0)
  v_cmp_ne_u32 vcc, s74, v137
  v_cmp_ne_u32 s[68:69], s74, v139
  s_or_b64 vcc, vcc, s[68:69]
  v_cmp_ne_u32 s[68:69], s74, v141
  s_or_b64 vcc, vcc, s[68:69]
  v_cmp_ne_u32 s[68:69], s74, v143
  s_or_b64 vcc, vcc, s[68:69]
  s_cmp_eq_u64 vcc, 0
  s_cbranch_scc1 L_poltd_90
  s_sleep 8
  s_add_u32 s70, s70, 1
  s_cmp_lt_u32 s70, 262144
  s_cbranch_scc1 L_polt_89
L_poltd_90:
  v_lshlrev_b32 v16, 16, v8
  v_and_b32 v17, s73, v8
  v_lshlrev_b32 v18, 16, v9
  v_and_b32 v19, s73, v9
  v_lshlrev_b32 v20, 16, v136
  v_and_b32 v21, s73, v136
  v_lshlrev_b32 v22, 16, v138
  v_and_b32 v23, s73, v138
  v_lshlrev_b32 v24, 16, v140
  v_and_b32 v25, s73, v140
  v_lshlrev_b32 v26, 16, v142
  v_and_b32 v27, s73, v142
L_join:
  v_lshlrev_b32 v2, 3, v1
  s_lshl_b32 s56, s6, 2
  s_add_u32 s56, s56, s7
  s_lshl_b32 s57, s56, 9
  s_add_u32 s57, s57, 131072
  v_lshl_add_u32 v3, v1, 3, s57
  v_and_b32 v8, 1, v1
  v_lshlrev_b32 v8, 4, v8
  v_lshrrev_b32 v8, v8, s74
  v_lshrrev_b32 v9, 8, v8
  s_movk_i32 s56, 0xff
  s_waitcnt vmcnt(0) lgkmcnt(0)
  s_barrier
  s_cmp_lg_u32 s5, 0
  s_cbranch_scc1 L_tail
L_dry_op:
  ds_read_b64 v[104:105], v2 offset:6912
  ds_read_b64 v[106:107], v2 offset:7424
  ds_read_b64 v[108:109], v2 offset:7936
  ds_read_b64 v[110:111], v2 offset:8448
  ds_read_b64 v[112:113], v2 offset:8960
  ds_read_b64 v[114:115], v2 offset:9472
  ds_read_b64 v[116:117], v2 offset:9984
  ds_read_b64 v[118:119], v2 offset:10496
  s_waitcnt lgkmcnt(6)
  v_pk_add_f32 v[104:105], v[104:105], v[106:107]
  s_waitcnt lgkmcnt(4)
  v_pk_add_f32 v[108:109], v[108:109], v[110:111]
  s_waitcnt lgkmcnt(2)
  v_pk_add_f32 v[112:113], v[112:113], v[114:115]
  s_waitcnt lgkmcnt(0)
  v_pk_add_f32 v[116:117], v[116:117], v[118:119]
  v_pk_add_f32 v[104:105], v[104:105], v[108:109]
  v_pk_add_f32 v[112:113], v[112:113], v[116:117]
  v_pk_add_f32 v[104:105], v[104:105], v[112:113]
  v_bfi_b32 v10, s56, v8, v104
  v_bfi_b32 v11, s56, v9, v105
  s_cmp_eq_u32 s77, 1
  s_cbranch_scc1 L_dry_1
  s_cmp_eq_u32 s75, 1
  s_cbranch_scc0 L_pf_91
  global_store_dwordx2 v3, v[10:11], s[42:43]
  s_branch L_pe_92
L_pf_91:
  global_store_dwordx2 v3, v[10:11], s[42:43] sc1
L_pe_92:
L_tail:
  s_cmp_eq_u32 s60, 1
  s_cbranch_scc1 L_t_wo
  s_cmp_eq_u32 s60, 2
  s_cbranch_scc1 L_t_f1
  s_cmp_eq_u32 s60, 3
  s_cbranch_scc1 L_t_f2
  s_barrier
  global_load_dword v16, v12, s[28:29]
  global_load_dword v17, v12, s[30:31]
  global_load_dword v18, v13, s[32:33]
  s_branch L_fin
L_t_wo:
  s_mov_b32 s70, 0
L_wo_p:
  global_load_dwordx4 v[104:107], v15, s[42:43] offset:0 sc1
  global_load_dwordx4 v[108:111], v15, s[42:43] offset:512 sc1
  global_load_dwordx4 v[112:115], v15, s[42:43] offset:1024 sc1
  global_load_dwordx4 v[116:119], v15, s[42:43] offset:1536 sc1
  s_waitcnt vmcnt(3)
  v_xor_b32 v104, s62, v104
  v_xor_b32 v105, s63, v105
  v_xor_b32 v106, s64, v106
  v_xor_b32 v107, s65, v107
  s_waitcnt vmcnt(2)
  v_xor_b32 v108, s62, v108
  v_xor_b32 v109, s63, v109
  v_xor_b32 v110, s64, v110
  v_xor_b32 v111, s65, v111
  s_waitcnt vmcnt(1)
  v_xor_b32 v112, s62, v112
  v_xor_b32 v113, s63, v113
  v_xor_b32 v114, s64, v114
  v_xor_b32 v115, s65, v115
  s_waitcnt vmcnt(0)
  v_xor_b32 v116, s62, v116
  v_xor_b32 v117, s63, v117
  v_xor_b32 v118, s64, v118
  v_xor_b32 v119, s65, v119
  v_or3_b32 v28, v104, v105, v106
  v_or3_b32 v29, v107, v108, v109
  v_or3_b32 v30, v110, v111, v112
  v_or3_b32 v31, v113, v114, v115
  v_or3_b32 v32, v116, v117, v118
  v_or3_b32 v28, v28, v29, v30
  v_or3_b32 v31, v31, v32, v119
  v_or_b32 v28, v28, v31
  v_lshlrev_b32 v28, 24, v28
  v_cmp_ne_u32 vcc, 0, v28
  v_pk_mul_f32 v[16:17], v[104:105], v[20:21] op_sel:[0,0] op_sel_hi:[1,0]
  v_pk_mul_f32 v[18:19], v[106:107], v[20:21] op_sel:[0,0] op_sel_hi:[1,0]
  v_pk_fma_f32 v[16:17], v[108:109], v[20:21], v[16:17] op_sel:[0,1,0] op_sel_hi:[1,1,1]
  v_pk_fma_f32 v[18:19], v[110:111], v[20:21], v[18:19] op_sel:[0,1,0] op_sel_hi:[1,1,1]
  v_pk_fma_f32 v[16:17], v[112:113], v[22:23], v[16:17] op_sel:[0,0,0] op_sel_hi:[1,0,1]
  v_pk_fma_f32 v[18:19], v[114:115], v[22:23], v[18:19] op_sel:[0,0,0] op_sel_hi:[1,0,1]
  v_pk_fma_f32 v[16:17], v[116:117], v[22:23], v[16:17] op_sel:[0,1,0] op_sel_hi:[1,1,1]
  v_pk_fma_f32 v[18:19], v[118:119], v[22:23], v[18:19] op_sel:[0,1,0] op_sel_hi:[1,1,1]
  s_cmp_eq_u64 vcc, 0
  s_cbranch_scc1 L_wo_ok
  s_add_u32 s70, s70, 1
  s_cmp_lt_u32 s70, 262144
  s_cbranch_scc1 L_wo_p
L_wo_ok:
  v_cvt_pk_bf16_f32 v8, v16, v17
  v_cvt_pk_bf16_f32 v9, v18, v19
  ds_write_b64 v12, v[8:9] offset:0
  s_waitcnt lgkmcnt(0)
  s_cmp_eq_u32 s77, 1
  s_cbranch_scc1 L_nb_93
  s_barrier
L_nb_93:
  ds_read_b128 v[104:107], v14 offset:0
  ds_read_b128 v[108:111], v14 offset:64
  ds_read_b128 v[112:115], v14 offset:128
  ds_read_b128 v[116:119], v14 offset:192
  ds_read_b128 v[120:123], v14 offset:256
  ds_read_b128 v[124:127], v14 offset:320
  ds_read_b128 v[128:131], v14 offset:384
  ds_read_b128 v[132:135], v14 offset:448
  ds_read_b128 v[136:139], v14 offset:512
  ds_read_b128 v[140:143], v14 offset:576
  ds_read_b128 v[144:147], v14 offset:640
  ds_read_b128 v[148:151], v14 offset:704
  s_waitcnt lgkmcnt(11)
  v_mfma_f32_16x16x32_bf16 v[8:11], v[40:43], v[104:107], 0
  ds_read_b128 v[152:155], v14 offset:768
  s_waitcnt lgkmcnt(11)
  v_mfma_f32_16x16x32_bf16 v[8:11], v[44:47], v[108:111], v[8:11]
  ds_read_b128 v[156:159], v14 offset:832
  s_waitcnt lgkmcnt(11)
  v_mfma_f32_16x16x32_bf16 v[8:11], v[48:51], v[112:115], v[8:11]
  ds_read_b128 v[160:163], v14 offset:896
  s_waitcnt lgkmcnt(11)
  v_mfma_f32_16x16x32_bf16 v[8:11], v[52:55], v[116:119], v[8:11]
  ds_read_b128 v[164:167], v14 offset:960
  s_waitcnt lgkmcnt(11)
  v_mfma_f32_16x16x32_bf16 v[8:11], v[56:59], v[120:123], v[8:11]
  s_waitcnt lgkmcnt(10)
  v_mfma_f32_16x16x32_bf16 v[8:11], v[60:63], v[124:127], v[8:11]
  s_waitcnt lgkmcnt(9)
  v_mfma_f32_16x16x32_bf16 v[8:11], v[64:67], v[128:131], v[8:11]
  s_waitcnt lgkmcnt(8)
  v_mfma_f32_16x16x32_bf16 v[8:11], v[68:71], v[132:135], v[8:11]
  s_waitcnt lgkmcnt(7)
  v_mfma_f32_16x16x32_bf16 v[8:11], v[72:75], v[136:139], v[8:11]
  s_waitcnt lgkmcnt(6)
  v_mfma_f32_16x16x32_bf16 v[8:11], v[76:79], v[140:143], v[8:11]
  s_waitcnt lgkmcnt(5)
  v_mfma_f32_16x16x32_bf16 v[8:11], v[80:83], v[144:147], v[8:11]
  s_waitcnt lgkmcnt(4)
  v_mfma_f32_16x16x32_bf16 v[8:11], v[84:87], v[148:151], v[8:11]
  s_waitcnt lgkmcnt(3)
  v_mfma_f32_16x16x32_bf16 v[8:11], v[88:91], v[152:155], v[8:11]
  s_waitcnt lgkmcnt(2)
  v_mfma_f32_16x16x32_bf16 v[8:11], v[92:95], v[156:159], v[8:11]
  s_waitcnt lgkmcnt(1)
  v_mfma_f32_16x16x32_bf16 v[8:11], v[96:99], v[160:163], v[8:11]
  s_waitcnt lgkmcnt(0)
  v_mfma_f32_16x16x32_bf16 v[8:11], v[100:103], v[164:167], v[8:11]
  s_nop 7
  v_bfi_b32 v8, v36, s62, v8
  v_bfi_b32 v9, v36, s63, v9
  v_bfi_b32 v10, v36, s64, v10
  v_bfi_b32 v11, v36, s65, v11
  s_mov_b32 exec_lo, 0x00030003
  s_mov_b32 exec_hi, 0x00030003
  s_cmp_eq_u32 s77, 1
  s_cbranch_scc1 L_dry_end
  global_store_dwordx4 v13, v[8:11], s[42:43] sc1
  global_store_dwordx4 v37, v[8:11], s[42:43] sc1
  s_branch L_fin
L_t_f1:
  s_barrier
  v_mov_b32 v2, v0
  s_add_u32 s51, s50, 8192
L_dma_94:
  s_mov_b32 m0, s50
  s_add_u32 s50, s50, 1024
  buffer_load_dwordx4 v2, s[44:47], s49 offen nt lds
  s_add_u32 s49, s49, 88064
  s_cmp_lt_u32 s50, s51
  s_cbranch_scc1 L_dma_94
L_dmae_95:
  v_xor_b32 v2, 16, v2
  s_add_u32 s49, s49, 4294265536
  s_add_u32 s50, s50, 8192
  s_add_u32 s51, s50, 8192
L_dma_96:
  s_mov_b32 m0, s50
  s_add_u32 s50, s50, 1024
  buffer_load_dwordx4 v2, s[44:47], s49 offen nt lds
  s_add_u32 s49, s49, 88064
  s_cmp_lt_u32 s50, s51
  s_cbranch_scc1 L_dma_96
L_dmae_97:
  global_load_dwordx4 v[104:107], v15, s[42:43] sc1
  global_load_dwordx4 v[108:111], v35, s[42:43] sc1
  global_load_dwordx4 v[112:115], v32, s[42:43] sc1
  global_load_dwordx4 v[116:119], v36, s[42:43] sc1
  global_load_dwordx4 v[120:123], v33, s[42:43] sc1
  global_load_dwordx4 v[124:127], v37, s[42:43] sc1
  global_load_dwordx4 v[128:131], v34, s[42:43] sc1
  global_load_dwordx4 v[132:135], v39, s[42:43] sc1
  v_mov_b32 v2, v6
  s_waitcnt vmcnt(8)
  s_barrier
  ds_read_b64_tr_b16 v[40:41], v2 offset:0
  ds_read_b64_tr_b16 v[42:43], v2 offset:512
  ds_read_b64_tr_b16 v[44:45], v2 offset:1024
  ds_read_b64_tr_b16 v[46:47], v2 offset:1536
  ds_read_b64_tr_b16 v[48:49], v2 offset:2048
  ds_read_b64_tr_b16 v[50:51], v2 offset:2560
  ds_read_b64_tr_b16 v[52:53], v2 offset:3072
  ds_read_b64_tr_b16 v[54:55], v2 offset:3584
  ds_read_b64_tr_b16 v[56:57], v2 offset:4096
  ds_read_b64_tr_b16 v[58:59], v2 offset:4608
  ds_read_b64_tr_b16 v[60:61], v2 offset:5120
  ds_read_b64_tr_b16 v[62:63], v2 offset:5632
  s_waitcnt lgkmcnt(10)
  ds_read_b64_tr_b16 v[64:65], v2 offset:6144
  ds_read_b64_tr_b16 v[66:67], v2 offset:6656
  s_waitcnt lgkmcnt(10)
  ds_read_b64_tr_b16 v[68:69], v2 offset:7168
  ds_read_b64_tr_b16 v[70:71], v2 offset:7680
  s_waitcnt lgkmcnt(10)
  ds_read_b64_tr_b16 v[72:73], v2 offset:8192
  ds_read_b64_tr_b16 v[74:75], v2 offset:8704
  s_waitcnt lgkmcnt(10)
  ds_read_b64_tr_b16 v[76:77], v2 offset:9216
  ds_read_b64_tr_b16 v[78:79], v2 offset:9728
  s_waitcnt lgkmcnt(10)
  ds_read_b64_tr_b16 v[80:81], v2 offset:10240
  ds_read_b64_tr_b16 v[82:83], v2 offset:10752
  s_waitcnt lgkmcnt(10)
  ds_read_b64_tr_b16 v[84:85], v2 offset:11264
  ds_read_b64_tr_b16 v[86:87], v2 offset:11776
  s_waitcnt lgkmcnt(10)
  ds_read_b64_tr_b16 v[88:89], v2 offset:12288
  ds_read_b64_tr_b16 v[90:91], v2 offset:12800
  s_waitcnt lgkmcnt(10)
  ds_read_b64_tr_b16 v[92:93], v2 offset:13312
  ds_read_b64_tr_b16 v[94:95], v2 offset:13824
  s_waitcnt lgkmcnt(10)
  ds_read_b64_tr_b16 v[96:97], v2 offset:14336
  ds_read_b64_tr_b16 v[98:99], v2 offset:14848
  s_waitcnt lgkmcnt(10)
  ds_read_b64_tr_b16 v[100:101], v2 offset:15360
  ds_read_b64_tr_b16 v[102:103], v2 offset:15872
  s_waitcnt lgkmcnt(10)
  s_waitcnt lgkmcnt(0)
  s_mov_b32 s70, 0
  s_mov_b32 s71, 15
  s_branch L_f1_c
L_f1_p:
  s_add_u32 s70, s70, 1
  s_cmp_ge_u32 s70, 262144
  s_cbranch_scc1 L_f1_ok
  s_bitcmp1_b32 s71, 0
  s_cbranch_scc0 L_fl_98
  global_load_dwordx4 v[104:107], v15, s[42:43] sc1
  global_load_dwordx4 v[108:111], v35, s[42:43] sc1
L_fl_98:
  s_bitcmp1_b32 s71, 1
  s_cbranch_scc0 L_fl_99
  global_load_dwordx4 v[112:115], v32, s[42:43] sc1
  global_load_dwordx4 v[116:119], v36, s[42:43] sc1
L_fl_99:
  s_bitcmp1_b32 s71, 2
  s_cbranch_scc0 L_fl_100
  global_load_dwordx4 v[120:123], v33, s[42:43] sc1
  global_load_dwordx4 v[124:127], v37, s[42:43] sc1
L_fl_100:
  s_bitcmp1_b32 s71, 3
  s_cbranch_scc0 L_fl_101
  global_load_dwordx4 v[128:131], v34, s[42:43] sc1
  global_load_dwordx4 v[132:135], v39, s[42:43] sc1
L_fl_101:
L_f1_c:
  s_waitcnt vmcnt(0)
  s_bitcmp1_b32 s71, 0
  s_cbranch_scc0 L_fc_102
  v_xor_b32 v104, s62, v104
  v_xor_b32 v105, s63, v105
  v_xor_b32 v106, s64, v106
  v_xor_b32 v107, s65, v107
  v_xor_b32 v108, s62, v108
  v_xor_b32 v109, s63, v109
  v_xor_b32 v110, s64, v110
  v_xor_b32 v111, s65, v111
  v_or3_b32 v8, v104, v105, v106
  v_or3_b32 v9, v107, v108, v109
  v_or3_b32 v8, v8, v110, v111
  v_pk_add_f32 v[136:137], v[104:105], v[108:109]
  v_pk_add_f32 v[138:139], v[106:107], v[110:111]
  v_or_b32 v8, v8, v9
  v_lshlrev_b32 v8, 24, v8
  v_cmp_ne_u32 vcc, 0, v8
  s_cmp_lg_u64 vcc, 0
  s_cbranch_scc1 L_fc_102
  s_bitset0_b32 s71, 0
L_fc_102:
  s_bitcmp1_b32 s71, 1
  s_cbranch_scc0 L_fc_103
  v_xor_b32 v112, s62, v112
  v_xor_b32 v113, s63, v113
  v_xor_b32 v114, s64, v114
  v_xor_b32 v115, s65, v115
  v_xor_b32 v116, s62, v116
  v_xor_b32 v117, s63, v117
  v_xor_b32 v118, s64, v118
  v_xor_b32 v119, s65, v119
  v_or3_b32 v8, v112, v113, v114
  v_or3_b32 v9, v115, v116, v117
  v_or3_b32 v8, v8, v118, v119
  v_pk_add_f32 v[144:145], v[112:113], v[116:117]
  v_pk_add_f32 v[146:147], v[114:115], v[118:119]
  v_or_b32 v8, v8, v9
  v_lshlrev_b32 v8, 24, v8
  v_cmp_ne_u32 vcc, 0, v8
  s_cmp_lg_u64 vcc, 0
  s_cbranch_scc1 L_fc_103
  s_bitset0_b32 s71, 1
L_fc_103:
  s_bitcmp1_b32 s71, 2
  s_cbranch_scc0 L_fc_104
  v_xor_b32 v120, s62, v120
  v_xor_b32 v121, s63, v121
  v_xor_b32 v122, s64, v122
  v_xor_b32 v123, s65, v123
  v_xor_b32 v124, s62, v124
  v_xor_b32 v125, s63, v125
  v_xor_b32 v126, s64, v126
  v_xor_b32 v127, s65, v127
  v_or3_b32 v8, v120, v121, v122
  v_or3_b32 v9, v123, v124, v125
  v_or3_b32 v8, v8, v126, v127
  v_pk_add_f32 v[152:153], v[120:121], v[124:125]
  v_pk_add_f32 v[154:155], v[122:123], v[126:127]
  v_or_b32 v8, v8, v9
  v_lshlrev_b32 v8, 24, v8
  v_cmp_ne_u32 vcc, 0, v8
  s_cmp_lg_u64 vcc, 0
  s_cbranch_scc1 L_fc_104
  s_bitset0_b32 s71, 2
L_fc_104:
  s_bitcmp1_b32 s71, 3
  s_cbranch_scc0 L_fc_105
  v_xor_b32 v128, s62, v128
  v_xor_b32 v129, s63, v129
  v_xor_b32 v130, s64, v130
  v_xor_b32 v131, s65, v131
  v_xor_b32 v132, s62, v132
  v_xor_b32 v133, s63, v133
  v_xor_b32 v134, s64, v134
  v_xor_b32 v135, s65, v135
  v_or3_b32 v8, v128, v129, v130
  v_or3_b32 v9, v131, v132, v133
  v_or3_b32 v8, v8, v134, v135
  v_pk_add_f32 v[160:161], v[128:129], v[132:133]
  v_pk_add_f32 v[162:163], v[130:131], v[134:135]
  v_or_b32 v8, v8, v9
  v_lshlrev_b32 v8, 24, v8
  v_cmp_ne_u32 vcc, 0, v8
  s_cmp_lg_u64 vcc, 0
  s_cbranch_scc1 L_fc_105
  s_bitset0_b32 s71, 3
L_fc_105:
  s_cmp_lg_u32 s71, 0
  s_cbranch_scc1 L_f1_p
L_f1_ok:
  v_pk_add_f32 v[136:137], v[136:137], v[144:145]
  v_pk_add_f32 v[138:139], v[138:139], v[146:147]
  v_pk_add_f32 v[152:153], v[152:153], v[160:161]
  v_pk_add_f32 v[154:155], v[154:155], v[162:163]
  v_pk_add_f32 v[136:137], v[136:137], v[152:153]
  v_pk_add_f32 v[138:139], v[138:139], v[154:155]
  v_pk_fma_f32 v[8:9], v[136:137], v[24:25], v[28:29]
  v_pk_fma_f32 v[10:11], v[138:139], v[26:27], v[30:31]
  v_cvt_pk_bf16_f32 v8, v8, v9
  v_cvt_pk_bf16_f32 v9, v10, v11
  ds_write_b64 v12, v[8:9] offset:0
  v_pk_fma_f32 v[16:17], v[136:137], v[20:21], v[16:17]
  v_pk_fma_f32 v[18:19], v[138:139], v[22:23], v[18:19]
  s_waitcnt lgkmcnt(0)
  s_cmp_eq_u32 s77, 1
  s_cbranch_scc1 L_nb_106
  s_barrier
L_nb_106:
  ds_read_b128 v[104:107], v14 offset:0
  ds_read_b128 v[108:111], v14 offset:64
  ds_read_b128 v[112:115], v14 offset:128
  ds_read_b128 v[116:119], v14 offset:192
  ds_read_b128 v[120:123], v14 offset:256
  ds_read_b128 v[124:127], v14 offset:320
  ds_read_b128 v[128:131], v14 offset:384
  ds_read_b128 v[132:135], v14 offset:448
  ds_read_b128 v[136:139], v14 offset:512
  ds_read_b128 v[140:143], v14 offset:576
  ds_read_b128 v[144:147], v14 offset:640
  ds_read_b128 v[148:151], v14 offset:704
  v_add_f32 v8, v16, v17
  v_mul_f32 v9, v16, v16
  v_add_f32 v10, v18, v19
  v_mul_f32 v11, v18, v18
  v_fmac_f32 v9, v17, v17
  v_fmac_f32 v11, v19, v19
  v_add_f32 v8, v8, v10
  v_add_f32 v9, v9, v11
  s_nop 0
  v_add_f32_dpp v8, v8, v8 quad_perm:[1,0,3,2] row_mask:0xf bank_mask:0xf
  v_add_f32_dpp v9, v9, v9 quad_perm:[1,0,3,2] row_mask:0xf bank_mask:0xf
  s_waitcnt lgkmcnt(11)
  v_mfma_f32_16x16x32_bf16 v[32:35], v[40:43], v[104:107], 0
  ds_read_b128 v[152:155], v14 offset:768
  v_add_f32_dpp v8, v8, v8 quad_perm:[2,3,0,1] row_mask:0xf bank_mask:0xf
  v_add_f32_dpp v9, v9, v9 quad_perm:[2,3,0,1] row_mask:0xf bank_mask:0xf
  s_waitcnt lgkmcnt(11)
  v_mfma_f32_16x16x32_bf16 v[32:35], v[44:47], v[108:111], v[32:35]
  ds_read_b128 v[156:159], v14 offset:832
  v_add_f32_dpp v8, v8, v8 row_ror:8 row_mask:0xf bank_mask:0xf
  v_add_f32_dpp v9, v9, v9 row_ror:8 row_mask:0xf bank_mask:0xf
  s_waitcnt lgkmcnt(11)
  v_mfma_f32_16x16x32_bf16 v[32:35], v[48:51], v[112:115], v[32:35]
  ds_read_b128 v[160:163], v14 offset:896
  v_mov_b32 v10, v8
  v_mov_b32 v11, v9
  s_waitcnt lgkmcnt(11)
  v_mfma_f32_16x16x32_bf16 v[32:35], v[52:55], v[116:119], v[32:35]
  ds_read_b128 v[164:167], v14 offset:960
  v_permlane16_swap_b32 v10, v8
  v_permlane16_swap_b32 v11, v9
  s_waitcnt lgkmcnt(11)
  v_mfma_f32_16x16x32_bf16 v[32:35], v[56:59], v[120:123], v[32:35]
  v_add_f32 v8, v8, v10
  v_add_f32 v9, v9, v11
  v_mov_b32 v10, v8
  v_mov_b32 v11, v9
  s_waitcnt lgkmcnt(10)
  v_mfma_f32_16x16x32_bf16 v[32:35], v[60:63], v[124:127], v[32:35]
  v_permlane32_swap_b32 v10, v8
  v_permlane32_swap_b32 v11, v9
  s_waitcnt lgkmcnt(9)
  v_mfma_f32_16x16x32_bf16 v[32:35], v[64:67], v[128:131], v[32:35]
  v_add_f32 v8, v8, v10
  v_add_f32 v9, v9, v11
  ds_write_b64 v5, v[8:9]
  s_waitcnt lgkmcnt(9)
  v_mfma_f32_16x16x32_bf16 v[32:35], v[68:71], v[132:135], v[32:35]
  s_waitcnt lgkmcnt(8)
  v_mfma_f32_16x16x32_bf16 v[32:35], v[72:75], v[136:139], v[32:35]
  s_waitcnt lgkmcnt(7)
  v_mfma_f32_16x16x32_bf16 v[32:35], v[76:79], v[140:143], v[32:35]
  s_waitcnt lgkmcnt(0)
  s_cmp_eq_u32 s77, 1
  s_cbranch_scc1 L_nb_107
  s_barrier
L_nb_107:
  ds_read_b128 v[20:23], v7 offset:11008
  ds_read_b128 v[24:27], v7 offset:11024
  v_mfma_f32_16x16x32_bf16 v[32:35], v[80:83], v[144:147], v[32:35]
  v_mfma_f32_16x16x32_bf16 v[32:35], v[84:87], v[148:151], v[32:35]
  v_mfma_f32_16x16x32_bf16 v[32:35], v[88:91], v[152:155], v[32:35]
  v_mfma_f32_16x16x32_bf16 v[32:35], v[92:95], v[156:159], v[32:35]
  v_mfma_f32_16x16x32_bf16 v[32:35], v[96:99], v[160:163], v[32:35]
  s_waitcnt lgkmcnt(0)
  v_pk_add_f32 v[20:21], v[20:21], v[22:23]
  v_pk_add_f32 v[24:25], v[24:25], v[26:27]
  v_mfma_f32_16x16x32_bf16 v[32:35], v[100:103], v[164:167], v[32:35]
  v_pk_add_f32 v[20:21], v[20:21], v[24:25]
  v_mul_f32 v20, 0xbb000000, v20
  v_mul_f32 v21, 0x3b000000, v21
  v_fma_f32 v21, -v20, v20, v21
  v_max_f32 v21, 0, v21
  v_add_f32 v21, 0x3727c5ac, v21
  v_rsq_f32 v21, v21
  s_nop 0
  v_fmac_f32_dpp v32, v32, v20 row_shl:2 row_mask:0xf bank_mask:0x1
  v_fmac_f32_dpp v33, v33, v20 row_shl:2 row_mask:0xf bank_mask:0x1
  v_fmac_f32_dpp v34, v34, v20 row_shl:2 row_mask:0xf bank_mask:0x1
  v_fmac_f32_dpp v35, v35, v20 row_shl:2 row_mask:0xf bank_mask:0x1
  v_mul_f32 v8, v32, v21
  v_mul_f32 v9, v33, v21
  v_mul_f32 v10, v34, v21
  v_mul_f32 v11, v35, v21
  v_add_f32_dpp v8, v32, v8 row_shl:4 row_mask:0xf bank_mask:0xf
  v_add_f32_dpp v9, v33, v9 row_shl:4 row_mask:0xf bank_mask:0xf
  v_add_f32_dpp v10, v34, v10 row_shl:4 row_mask:0xf bank_mask:0xf
  v_add_f32_dpp v11, v35, v11 row_shl:4 row_mask:0xf bank_mask:0xf
  s_mov_b32 s50, 0x00030003
  s_mov_b32 s51, 0x00030003
  v_permlane32_swap_b32 v8, v10
  v_permlane32_swap_b32 v9, v11
  v_mul_f32 v20, 0xbfb8aa3b, v8
  v_mul_f32 v21, 0xbfb8aa3b, v9
  v_exp_f32 v20, v20
  v_exp_f32 v21, v21
  v_mul_f32 v8, v8, v10
  v_mul_f32 v9, v9, v11
  v_add_f32 v20, 1.0, v20
  v_add_f32 v21, 1.0, v21
  v_rcp_f32 v20, v20
  v_rcp_f32 v21, v21
  s_mov_b64 exec, s[50:51]
  v_mul_f32 v8, v8, v20
  v_mul_f32 v9, v9, v21
  v_cvt_pk_bf16_f32 v8, v8, v9
  v_mov_b32 v9, s74
  s_cmp_eq_u32 s77, 1
  s_cbranch_scc1 L_dry_end
  global_store_dwordx2 v13, v[8:9], s[42:43] sc1
  global_store_dwordx2 v4, v[8:9], s[42:43] sc1
  s_branch L_fin
L_t_f2:
  s_barrier
  v_mov_b32 v2, v29
  s_and_b32 s59, s61, 3
  s_mul_i32 s59, s59, 3072
  s_mul_i32 s49, s5, 360448
  s_add_u32 s49, s49, s48
  s_mul_i32 s50, s5, 11264
  s_add_u32 s50, s50, 20480
  s_lshl_b32 s52, s59, 5
  s_add_u32 s49, s49, s52
  s_add_u32 s50, s50, s59
  s_sub_u32 s52, 11264, s59
  s_add_u32 s51, s50, s52
  s_cmp_lt_u32 s50, s51
  s_cbranch_scc0 L_dmae_109
L_dma_108:
  s_mov_b32 m0, s50
  s_add_u32 s50, s50, 1024
  buffer_load_dwordx4 v2, s[44:47], s49 offen nt lds
  s_add_u32 s49, s49, 32768
  s_cmp_lt_u32 s50, s51
  s_cbranch_scc1 L_dma_108
L_dmae_109:
  s_mul_i32 s49, s5, 360448
  s_add_u32 s49, s49, s48
  s_mul_i32 s50, s5, 11264
  s_add_u32 s50, s50, 20480
  s_add_u32 s51, s50, s59
  s_cmp_lt_u32 s50, s51
  s_cbranch_scc0 L_dmae_111
L_dma_110:
  s_mov_b32 m0, s50
  s_add_u32 s50, s50, 1024
  buffer_load_dwordx4 v2, s[44:47], s49 offen nt lds
  s_add_u32 s49, s49, 32768
  s_cmp_lt_u32 s50, s51
  s_cbranch_scc1 L_dma_110
L_dmae_111:
  v_mov_b32 v2, v6
  s_mov_b32 s50, 0x00030003
  s_mov_b32 s51, 0x00030003
  s_mov_b32 s53, 0x0fff0fff
  s_cmp_eq_u32 s5, 3
  s_cselect_b32 s52, 0x00ff00ff, s53
  s_mov_b32 s53, s52
  s_cmp_lg_u32 s5, 0
  s_cbranch_scc1 L_f2_w
  s_mov_b64 exec, s[50:51]
  global_load_dwordx4 v[104:107], v15, s[42:43] sc1
  global_load_dwordx4 v[108:111], v35, s[42:43] sc1
  global_load_dwordx4 v[112:115], v32, s[42:43] sc1
  global_load_dwordx4 v[116:119], v36, s[42:43] sc1
  global_load_dwordx4 v[120:123], v33, s[42:43] sc1
  global_load_dwordx4 v[124:127], v37, s[42:43] sc1
  global_load_dwordx4 v[128:131], v34, s[42:43] sc1
  global_load_dwordx4 v[132:135], v39, s[42:43] sc1
  s_mov_b64 exec, -1
  s_waitcnt vmcnt(8)
  s_branch L_f2_w2
L_f2_w:
  s_waitcnt vmcnt(0)
L_f2_w2:
  ds_read_b64_tr_b16 v[40:41], v2 offset:0
  ds_read_b64_tr_b16 v[42:43], v2 offset:128
  ds_read_b64_tr_b16 v[44:45], v2 offset:1024
  ds_read_b64_tr_b16 v[46:47], v2 offset:1152
  ds_read_b64_tr_b16 v[48:49], v2 offset:2048
  ds_read_b64_tr_b16 v[50:51], v2 offset:2176
  ds_read_b64_tr_b16 v[52:53], v2 offset:3072
  ds_read_b64_tr_b16 v[54:55], v2 offset:3200
  ds_read_b64_tr_b16 v[56:57], v2 offset:4096
  ds_read_b64_tr_b16 v[58:59], v2 offset:4224
  ds_read_b64_tr_b16 v[60:61], v2 offset:5120
  ds_read_b64_tr_b16 v[62:63], v2 offset:5248
  s_waitcnt lgkmcnt(10)
  ds_read_b64_tr_b16 v[64:65], v2 offset:6144
  ds_read_b64_tr_b16 v[66:67], v2 offset:6272
  s_waitcnt lgkmcnt(10)
  ds_read_b64_tr_b16 v[68:69], v2 offset:7168
  ds_read_b64_tr_b16 v[70:71], v2 offset:7296
  s_waitcnt lgkmcnt(10)
  ds_read_b64_tr_b16 v[72:73], v2 offset:8192
  ds_read_b64_tr_b16 v[74:75], v2 offset:8320
  s_waitcnt lgkmcnt(10)
  ds_read_b64_tr_b16 v[76:77], v2 offset:9216
  ds_read_b64_tr_b16 v[78:79], v2 offset:9344
  s_waitcnt lgkmcnt(10)
  ds_read_b64_tr_b16 v[80:81], v2 offset:10240
  ds_read_b64_tr_b16 v[82:83], v2 offset:10368
  s_waitcnt lgkmcnt(10)
  s_waitcnt lgkmcnt(0)
  s_cmp_lg_u32 s5, 0
  s_cbranch_scc1 L_f2x_112
  s_mov_b32 s70, 0
  s_mov_b64 exec, s[50:51]
  s_branch L_f2_ac
L_f2_a:
  s_mov_b64 exec, s[50:51]
  global_load_dwordx4 v[104:107], v15, s[42:43] sc1
  global_load_dwordx4 v[108:111], v35, s[42:43] sc1
  global_load_dwordx4 v[112:115], v32, s[42:43] sc1
  global_load_dwordx4 v[116:119], v36, s[42:43] sc1
  global_load_dwordx4 v[120:123], v33, s[42:43] sc1
  global_load_dwordx4 v[124:127], v37, s[42:43] sc1
  global_load_dwordx4 v[128:131], v34, s[42:43] sc1
  global_load_dwordx4 v[132:135], v39, s[42:43] sc1
L_f2_ac:
  s_waitcnt vmcnt(0)
  v_xor_b32 v136, s62, v104
  v_xor_b32 v137, s63, v105
  v_xor_b32 v138, s64, v106
  v_xor_b32 v139, s65, v107
  v_xor_b32 v140, s62, v108
  v_xor_b32 v141, s63, v109
  v_xor_b32 v142, s64, v110
  v_xor_b32 v143, s65, v111
  v_xor_b32 v144, s62, v112
  v_xor_b32 v145, s63, v113
  v_xor_b32 v146, s64, v114
  v_xor_b32 v147, s65, v115
  v_xor_b32 v148, s62, v116
  v_xor_b32 v149, s63, v117
  v_xor_b32 v150, s64, v118
  v_xor_b32 v151, s65, v119
  v_xor_b32 v152, s62, v120
  v_xor_b32 v153, s63, v121
  v_xor_b32 v154, s64, v122
  v_xor_b32 v155, s65, v123
  v_xor_b32 v156, s62, v124
  v_xor_b32 v157, s63, v125
  v_xor_b32 v158, s64, v126
  v_xor_b32 v159, s65, v127
  v_xor_b32 v160, s62, v128
  v_xor_b32 v161, s63, v129
  v_xor_b32 v162, s64, v130
  v_xor_b32 v163, s65, v131
  v_xor_b32 v164, s62, v132
  v_xor_b32 v165, s63, v133
  v_xor_b32 v166, s64, v134
  v_xor_b32 v167, s65, v135
  v_or3_b32 v8, v136, v137, v138
  v_or3_b32 v9, v144, v145, v146
  v_or3_b32 v10, v152, v153, v154
  v_or3_b32 v11, v160, v161, v162
  v_or3_b32 v8, v8, v139, v140
  v_or3_b32 v9, v9, v147, v148
  v_or3_b32 v10, v10, v155, v156
  v_or3_b32 v11, v11, v163, v164
  v_or3_b32 v8, v8, v141, v142
  v_or3_b32 v9, v9, v149, v150
  v_or3_b32 v10, v10, v157, v158
  v_or3_b32 v11, v11, v165, v166
  v_or_b32 v8, v8, v143
  v_or_b32 v9, v9, v151
  v_or_b32 v10, v10, v159
  v_or_b32 v11, v11, v167
  v_or3_b32 v3, v8, v9, v10
  v_or_b32 v3, v3, v11
  v_lshlrev_b32 v3, 24, v3
  v_cmp_ne_u32 vcc, 0, v3
  s_cmp_eq_u64 vcc, 0
  s_cbranch_scc1 L_f2_ad
  s_sleep 2
  s_add_u32 s70, s70, 1
  s_cmp_lt_u32 s70, 262144
  s_cbranch_scc1 L_f2_a
L_f2_ad:
  s_mov_b64 exec, -1
  v_pk_add_f32 v[136:137], v[136:137], v[140:141]
  v_pk_add_f32 v[138:139], v[138:139], v[142:143]
  v_pk_add_f32 v[144:145], v[144:145], v[148:149]
  v_pk_add_f32 v[146:147], v[146:147], v[150:151]
  v_pk_add_f32 v[152:153], v[152:153], v[156:157]
  v_pk_add_f32 v[154:155], v[154:155], v[158:159]
  v_pk_add_f32 v[160:161], v[160:161], v[164:165]
  v_pk_add_f32 v[162:163], v[162:163], v[166:167]
  v_pk_add_f32 v[136:137], v[136:137], v[144:145]
  v_pk_add_f32 v[138:139], v[138:139], v[146:147]
  v_pk_add_f32 v[152:153], v[152:153], v[160:161]
  v_pk_add_f32 v[154:155], v[154:155], v[162:163]
  v_pk_add_f32 v[136:137], v[136:137], v[152:153]
  v_pk_add_f32 v[138:139], v[138:139], v[154:155]
  v_cvt_pk_bf16_f32 v136, 0, v136
  v_cvt_pk_bf16_f32 v137, 0, v137
  v_cvt_pk_bf16_f32 v138, 0, v138
  v_cvt_pk_bf16_f32 v139, 0, v139
  v_mul_f32 v136, v136, v20
  v_mul_f32 v137, v137, v21
  v_mul_f32 v138, v138, v22
  v_mul_f32 v139, v139, v23
  v_cvt_pk_bf16_f32 v136, 0, v136
  v_cvt_pk_bf16_f32 v137, 0, v137
  v_cvt_pk_bf16_f32 v138, 0, v138
  v_cvt_pk_bf16_f32 v139, 0, v139
  v_add_f32 v16, v16, v136
  v_add_f32 v17, v17, v137
  v_add_f32 v18, v18, v138
  v_add_f32 v19, v19, v139
  v_cvt_pk_bf16_f32 v16, 0, v16
  v_cvt_pk_bf16_f32 v17, 0, v17
  v_cvt_pk_bf16_f32 v18, 0, v18
  v_cvt_pk_bf16_f32 v19, 0, v19
L_f2x_112:
  v_mov_b32 v112, 0
  v_mov_b32 v113, 0
  v_mov_b32 v114, 0
  v_mov_b32 v115, 0
  s_mov_b32 s70, 0
L_f2_p:
  global_load_dwordx4 v[104:107], v28, s[42:43] offset:-2048 sc1
  global_load_dwordx4 v[108:111], v28, s[42:43] sc1
  s_mov_b64 exec, s[52:53]
  global_load_dwordx4 v[112:115], v28, s[42:43] offset:2048 sc1
  s_mov_b64 exec, -1
  s_waitcnt vmcnt(2)
  v_xor_b32 v105, s74, v105
  v_xor_b32 v107, s74, v107
  s_waitcnt vmcnt(1)
  v_xor_b32 v109, s74, v109
  v_xor_b32 v111, s74, v111
  s_waitcnt vmcnt(0)
  v_xor_b32 v113, s74, v113
  v_xor_b32 v115, s74, v115
  v_or3_b32 v31, v105, v107, v109
  v_or_b32 v3, v113, v115
  v_or_b32 v31, v111, v31
  v_cmp_ne_u32 s[68:69], 0, v3
  v_cmp_ne_u32 vcc, 0, v31
  v_mov_b32_dpp v105, v104 quad_perm:[2,3,2,3] row_mask:0xf bank_mask:0xf
  v_mov_b32_dpp v107, v106 quad_perm:[2,3,2,3] row_mask:0xf bank_mask:0xf
  v_mov_b32_dpp v109, v108 quad_perm:[2,3,2,3] row_mask:0xf bank_mask:0xf
  v_mov_b32_dpp v111, v110 quad_perm:[2,3,2,3] row_mask:0xf bank_mask:0xf
  v_mov_b32_dpp v113, v112 quad_perm:[2,3,2,3] row_mask:0xf bank_mask:0xf
  v_mov_b32_dpp v115, v114 quad_perm:[2,3,2,3] row_mask:0xf bank_mask:0xf
  s_and_b64 s[68:69], s[68:69], s[52:53]
  s_or_b64 vcc, vcc, s[68:69]
  v_mfma_f32_16x16x32_bf16 v[120:123], v[40:43], v[104:107], 0
  v_mfma_f32_16x16x32_bf16 v[124:127], v[44:47], v[104:107], 0
  v_mfma_f32_16x16x32_bf16 v[128:131], v[48:51], v[104:107], 0
  v_mfma_f32_16x16x32_bf16 v[132:135], v[52:55], v[104:107], 0
  s_cmp_eq_u64 vcc, 0
  s_cbranch_scc1 L_f2_ok
  s_add_u32 s70, s70, 1
  s_cmp_lt_u32 s70, 262144
  s_cbranch_scc1 L_f2_p
L_f2_ok:
  v_mfma_f32_16x16x32_bf16 v[120:123], v[56:59], v[108:111], v[120:123]
  v_mfma_f32_16x16x32_bf16 v[124:127], v[60:63], v[108:111], v[124:127]
  v_mfma_f32_16x16x32_bf16 v[128:131], v[64:67], v[108:111], v[128:131]
  v_mfma_f32_16x16x32_bf16 v[132:135], v[68:71], v[108:111], v[132:135]
  v_mfma_f32_16x16x32_bf16 v[120:123], v[72:75], v[112:115], v[120:123]
  v_mfma_f32_16x16x32_bf16 v[124:127], v[76:79], v[112:115], v[124:127]
  v_mfma_f32_16x16x32_bf16 v[128:131], v[80:83], v[112:115], v[128:131]
  s_nop 6
  v_add_f32_dpp v8, v124, v120 row_shl:4 row_mask:0xf bank_mask:0xf
  v_add_f32_dpp v9, v125, v121 row_shl:4 row_mask:0xf bank_mask:0xf
  v_add_f32_dpp v10, v126, v122 row_shl:4 row_mask:0xf bank_mask:0xf
  v_add_f32_dpp v11, v127, v123 row_shl:4 row_mask:0xf bank_mask:0xf
  v_add_f32_dpp v128, v132, v128 row_shl:4 row_mask:0xf bank_mask:0xf
  v_add_f32_dpp v129, v133, v129 row_shl:4 row_mask:0xf bank_mask:0xf
  v_add_f32_dpp v130, v134, v130 row_shl:4 row_mask:0xf bank_mask:0xf
  v_add_f32_dpp v131, v135, v131 row_shl:4 row_mask:0xf bank_mask:0xf
  v_add_f32_dpp v8, v128, v8 row_shl:8 row_mask:0xf bank_mask:0xf
  v_add_f32_dpp v9, v129, v9 row_shl:8 row_mask:0xf bank_mask:0xf
  v_add_f32_dpp v10, v130, v10 row_shl:8 row_mask:0xf bank_mask:0xf
  v_add_f32_dpp v11, v131, v11 row_shl:8 row_mask:0xf bank_mask:0xf
  s_mov_b64 exec, s[50:51]
  ds_write_b128 v30, v[8:11]
  s_waitcnt lgkmcnt(0)
  s_cmp_eq_u32 s77, 1
  s_cbranch_scc1 L_nb_113
  s_barrier
L_nb_113:
  s_cmp_lg_u32 s5, s77
  s_cbranch_scc1 L_fin
  ds_read_b128 v[104:107], v12 offset:128
  ds_read_b128 v[108:111], v12 offset:256
  ds_read_b128 v[112:115], v12 offset:384
  s_waitcnt lgkmcnt(2)
  v_pk_add_f32 v[8:9], v[8:9], v[104:105]
  v_pk_add_f32 v[10:11], v[10:11], v[106:107]
  s_waitcnt lgkmcnt(0)
  v_pk_add_f32 v[108:109], v[108:109], v[112:113]
  v_pk_add_f32 v[110:111], v[110:111], v[114:115]
  v_pk_add_f32 v[8:9], v[8:9], v[108:109]
  v_pk_add_f32 v[10:11], v[10:11], v[110:111]
  v_pk_fma_f32 v[8:9], v[8:9], v[24:25], v[16:17]
  v_pk_fma_f32 v[10:11], v[10:11], v[26:27], v[18:19]
  v_cvt_pk_bf16_f32 v8, v8, v9
  v_cvt_pk_bf16_f32 v9, v10, v11
  s_cmp_eq_u32 s77, 1
  s_cbranch_scc1 L_dry_end
  global_store_dwordx2 v13, v[8:9], s[38:39]
  s_mov_b64 exec, 1
  s_cmp_lg_u32 s61, 0
  s_cbranch_scc1 L_noep
  v_mov_b32 v10, s74
  global_store_dword v38, v10, s[42:43] offset:0
L_noep:
L_fin:
L_end:
  s_endpgm
.p2align 7
L_table:
  .long 0x03803066, 0x03800e5d, 0x03800a9e, 0x0380310e, 0x03803675, 0x03803435, 0x03802fbe, 0x03802f36
  .long 0x07802ef6, 0x07800a5e, 0x07802e2e, 0x07800cde, 0x07800b1e, 0x07800b5e, 0x0780363d, 0x07803056
  .long 0x0b803016, 0x0b80360d, 0x0b803615, 0x0b803625, 0x0b802e86, 0x0b802d6e, 0x0b802d2e, 0x0b803645
  .long 0x0f801819, 0x0f801219, 0x0f801419, 0x0f802f56, 0x0f802fae, 0x0f802fb6, 0x0f801219, 0x0f801219
  .long 0x0f803605, 0x0f803146, 0x0f80314e, 0x13802e7e, 0x138031f6, 0x1380367d, 0x0f8030e6, 0x0f800bde
  .long 0x13800e1d, 0x13803655, 0x13803196, 0x17802bee, 0x17802f16, 0x17802c46, 0x13802c06, 0x13802d7e
  .long 0x1780313e, 0x17803026, 0x17802fe6, 0x1b802e36, 0x1b80362d, 0x1b802cd6, 0x17800b9e, 0x17802ca6
  .long 0x1b800a1e, 0x1b802e6e, 0x1b802ebe, 0x1f802ec6, 0x1f803a39, 0x1f802bfe, 0x1b802f76, 0x1b802fc6
  .long 0x1f982f86, 0x1f873401, 0x1f853601, 0x23983801, 0x1f9b2c3e, 0x239a3401, 0x1f973801, 0x1f973801
  .long 0x23973809, 0x1f853609, 0x1f973809, 0x23863609, 0x23853609, 0x23853609, 0x1f9b2c4e, 0x1f982e0e
  .long 0x23982eae, 0x1f9b2cfe, 0x1f9b3465, 0x239b366d, 0x23973811, 0x23963411, 0x23963411, 0x239b2cee
  .long 0x278c3ce4, 0x23893b34, 0x238a169c, 0x27971419, 0x23971219, 0x23971219, 0x2389151c, 0x2789155c
  .long 0x2b9b344d, 0x27982eb6, 0x27982e76, 0x27973821, 0x23982ece, 0x239b2c8e, 0x27982e96, 0x2b853621
  .long 0x2f873429, 0x2b9b2dd6, 0x2b982f06, 0x27952da6, 0x27973829, 0x27963429, 0x2b963429, 0x2b963429
  .long 0x2f982fce, 0x2f982f8e, 0x2f973831, 0x2b973831, 0x279b2d66, 0x27963431, 0x2b853631, 0x2b963431
  .long 0x33853639, 0x33973839, 0x2f973839, 0x2b973839, 0x2b9d4104, 0x27952d26, 0x2b973839, 0x2b973839
  .long 0x33af3801, 0x33a1604a, 0x2fa06072, 0x2bb43ab4, 0x2fb13601, 0x2bb43ac4, 0x2bb33a84, 0x2bb33ad4
  .long 0x33b33a94, 0x33a06052, 0x2fb33b3c, 0x2fa160aa, 0x2fa060c2, 0x2fa060f2, 0x2fb13609, 0x2faf3809
  .long 0x37af3811, 0x33b13611, 0x33b53611, 0x2fb63611, 0x2fb33abc, 0x2fb0397c, 0x2fb03914, 0x2fb13611
  .long 0x37aa3f2c, 0x33a638ec, 0x33956c43, 0x2fa1608a, 0x33a060b2, 0x33a060fa, 0x33935f0a, 0x2f935f42
  .long 0x3bb53621, 0x37af3821, 0x33af3821, 0x2fb33b44, 0x33af3821, 0x33b13621, 0x33af3821, 0x2fa06132
  .long 0x3ba1602a, 0x37b13629, 0x33af3829, 0x33ab3229, 0x33b33b4c, 0x33b0390c, 0x33b038cc, 0x2fb0396c
  .long 0x3baf3831, 0x37af3831, 0x33b33aac, 0x33b33b74, 0x37b13631, 0x37b03954, 0x37a06112, 0x33b0388c
  .long 0x3ba0600a, 0x37b33aa4, 0x37b33af4, 0x37b33afc, 0x37bd18dc, 0x3bab3239, 0x37b33b64, 0x37b33b24
  .long 0x3bcb6a0b, 0x3bd15e42, 0x3bd06082, 0x3bd15e73, 0x3bcc6893, 0x3bd15eea, 0x3bd0611a, 0x3bd0613a
  .long 0x3bd06012, 0x3bd0603a, 0x3bd0605a, 0x3bd15e6b, 0x3bd060d2, 0x3bd060e2, 0x3bcc68cb, 0x3bcb6afb
  .long 0x3bcb6a13, 0x3bcc6823, 0x3bd0607a, 0x3bd15e7b, 0x3bd060ba, 0x3bcc68bb, 0x3bcc68c3, 0x3bcc68f3
  .long 0x3bc96e1b, 0x3bc27c00, 0x3bcb6a5b, 0x3bd15e63, 0x3bd060ca, 0x3bd06102, 0x3bc27c00, 0x3bc27c00
  .long 0x3bd0601a, 0x3fcb6a3b, 0x3bcb6a4b, 0x3bd06092, 0x3bcb6a83, 0x3bcc68ab, 0x3fcb6ad3, 0x3fd0614a
  .long 0x3bd15e02, 0x3fcc682b, 0x3bcb6a53, 0x3bc47800, 0x3bd060da, 0x3bcc68a3, 0x3fcc68db, 0x3fcc68e3
  .long 0x3bcb6a03, 0x3fcb6a33, 0x3bd0606a, 0x3fd0609a, 0x3bcc689b, 0x3bcc68b3, 0x3fd0612a, 0x3fcc68eb
  .long 0x3bd06022, 0x3fd06032, 0x3bd06062, 0x3fd060a2, 0x3bc96e8b, 0x3bc47800, 0x3fd06122, 0x3fd06152
L_gtab:
  .long 0x017c0000, 0x00000000
  .long 0x02bc0180, 0x00000080
  .long 0x043c02c0, 0x00000100
  .long 0x057c0440, 0x00000180
  .long 0x06fc0580, 0x00000200
  .long 0x083c0700, 0x00000280
  .long 0x097c0840, 0x00000300
  .long 0x0abc0980, 0x00000380
.section .rodata,"a"
.p2align 6
.amdhsa_kernel adaLN_cond__sliding_block_cached__glu_gated_swiglu__decode_kernel
  .amdhsa_next_free_vgpr 168
  .amdhsa_next_free_sgpr 102
  .amdhsa_accum_offset 168
  .amdhsa_group_segment_fixed_size 0
  .amdhsa_kernarg_size 112
  .amdhsa_user_sgpr_count 2
  .amdhsa_user_sgpr_kernarg_segment_ptr 1
  .amdhsa_system_sgpr_workgroup_id_x 1
.end_amdhsa_kernel
```

```asm
; @launch grid=(256,1,1) block=(768,1,1) lds=151552
.amdgcn_target "amdgcn-amd-amdhsa--gfx950"
.text
.globl adaLN_cond__sliding_block_cached__glu_gated_swiglu__decode_kernel
.p2align 8
.type adaLN_cond__sliding_block_cached__glu_gated_swiglu__decode_kernel,@function
adaLN_cond__sliding_block_cached__glu_gated_swiglu__decode_kernel:
  s_cmpk_ge_u32 s2, 256
  s_cbranch_scc1 L_end
  s_load_dwordx2 s[44:45], s[0:1], 8
  v_readfirstlane_b32 s5, v0
  s_and_b32 s6, s2, 63
  s_lshr_b32 s7, s2, 6
  s_lshr_b32 s5, s5, 6
  v_and_b32 v1, 63, v0
  s_cmp_lt_u32 s5, 4
  s_cbranch_scc1 L_helper
  s_lshl_b32 s10, s6, 22
  s_mul_i32 s58, s7, 229376
  s_add_u32 s11, s10, 3141632
  v_lshl_add_u32 v2, v0, 4, s11
  s_lshl_b32 s46, 1, 28
  s_lshl_b32 s47, 1, 17
  s_mul_i32 s12, s6, 5
  s_and_b32 s12, s12, 15
  s_lshl_b32 s12, s12, 13
  s_add_u32 s12, s12, s58
  s_waitcnt lgkmcnt(0)
L_nb1:
  buffer_load_dwordx4 v[56:59], v2, s[44:47], s12 offen nt
  s_addk_i32 s12, 0x2000
  buffer_load_dwordx4 v[60:63], v2, s[44:47], s12 offen nt
  s_addk_i32 s12, 0x2000
  buffer_load_dwordx4 v[64:67], v2, s[44:47], s12 offen nt
  s_addk_i32 s12, 0x2000
  buffer_load_dwordx4 v[68:71], v2, s[44:47], s12 offen nt
  s_addk_i32 s12, 0x2000
  s_getpc_b64 s[56:57]
L_pc:
  s_lshl_b32 s3, s2, 2
  s_add_u32 s3, s3, L_table-L_pc
  s_load_dword s14, s[56:57], s3
  s_load_dwordx2 s[48:49], s[0:1], 16
  s_load_dwordx4 s[20:23], s[0:1], 24
  s_load_dwordx2 s[28:29], s[0:1], 80
  s_load_dwordx2 s[42:43], s[0:1], 104
  s_barrier
  s_sub_u32 s9, s5, 4
  s_getreg_b32 s68, hwreg(HW_REG_XCC_ID, 0, 3)
  s_lshr_b32 s68, 85, s68
  s_mov_b64 s[50:51], s[46:47]
  s_mov_b32 s52, 0xcccccccc
  s_mov_b32 s53, 0xcccccccc
  s_mov_b32 s54, 0xaaaaaaaa
  s_mov_b32 s55, 0xaaaaaaaa
  s_mul_i32 s15, s9, 8192
  s_add_u32 s15, s15, 86016
  s_add_u32 s59, s58, 229376
  v_mov_b32 v4, 0
  v_lshrrev_b32 v5, 3, v1
  v_and_b32 v6, 6, v5
  v_xor_b32 v6, v6, v1
  v_and_b32 v6, 7, v6
  s_lshl_b32 s33, s9, 6
  s_movk_i32 s26, 6144
  s_mov_b32 s30, 3145728
  s_mov_b32 s31, s47
  s_lshl_b32 s34, s9, 13
  s_add_u32 s34, s34, 20480
  s_add_u32 s35, s34, 8192
  s_and_b32 s36, s2, 7
  s_lshl_b32 s36, s36, 1
  s_and_b32 s37, s9, 1
  s_add_u32 s36, s36, s37
  s_lshr_b32 s37, s9, 1
  s_lshl_b32 s37, s37, 4
  s_add_u32 s36, s36, s37
  s_lshl_b32 s36, s36, 6
  s_waitcnt lgkmcnt(0)
  s_and_b32 s27, s14, 7
  s_cmp_eq_u32 s27, 6
  s_cselect_b64 s[28:29], s[20:21], s[28:29]
  s_cselect_b32 s26, 0x2000, s26
  s_cselect_b32 s30, 0x400000, s30
  s_cmp_eq_u32 s27, 1
  s_cselect_b64 s[28:29], s[22:23], s[28:29]
  s_cselect_b32 s26, 0x400, s26
  s_cselect_b32 s30, 0x400000, s30
  s_cselect_b32 s33, s36, s33
  s_cselect_b32 s27, 4, s27
  v_mul_u32_u24 v5, s26, v5
  v_lshl_add_u32 v5, v6, 4, v5
  v_mov_b32 v6, 1
  s_mul_i32 s33, s33, s26
  s_bfe_u32 s32, s14, 0x60003
  s_lshl_b32 s32, s32, 7
  s_add_u32 s33, s33, s32
  s_lshl_b32 s26, s26, 3
  s_cmp_lt_u32 s27, 4
  s_cbranch_scc1 L_we_2
L_wl_1:
  s_mov_b32 m0, s34
  s_waitcnt vmcnt(3)
  s_bitcmp0_b32 s68, 0
  s_cbranch_scc1 L_th_3
  s_waitcnt vmcnt(2)
L_th_3:
  buffer_load_dwordx4 v5, s[28:31], s33 offen nt lds
  s_add_u32 s33, s33, s26
  s_addk_i32 s34, 1024
  s_cmp_lt_u32 s34, s35
  s_cbranch_scc1 L_wl_1
L_we_2:
  s_waitcnt vmcnt(3)
  s_bitcmp0_b32 s68, 0
  s_cbranch_scc1 L_th_4
  s_waitcnt vmcnt(2)
L_th_4:
  buffer_load_dwordx4 v[72:75], v2, s[44:47], s12 offen nt
  s_addk_i32 s12, 0x2000
  s_waitcnt vmcnt(3)
  s_bitcmp0_b32 s68, 0
  s_cbranch_scc1 L_th_5
  s_waitcnt vmcnt(2)
L_th_5:
  buffer_load_dwordx4 v[76:79], v2, s[44:47], s12 offen nt
  s_addk_i32 s12, 0x2000
  s_waitcnt vmcnt(3)
  s_bitcmp0_b32 s68, 0
  s_cbranch_scc1 L_th_6
  s_waitcnt vmcnt(2)
L_th_6:
  buffer_load_dwordx4 v[80:83], v2, s[44:47], s12 offen nt
  s_addk_i32 s12, 0x2000
  s_waitcnt vmcnt(3)
  s_bitcmp0_b32 s68, 0
  s_cbranch_scc1 L_th_7
  s_waitcnt vmcnt(2)
L_th_7:
  buffer_load_dwordx4 v[84:87], v2, s[44:47], s12 offen nt
  s_addk_i32 s12, 0x2000
  s_cmp_lt_u32 s27, 4
  s_cbranch_scc1 L_ws_8
  s_mov_b64 exec, 1
  ds_add_u32 v4, v6 offset:6720
  s_mov_b64 exec, -1
L_ws_8:
  s_waitcnt vmcnt(3)
  s_bitcmp0_b32 s68, 0
  s_cbranch_scc1 L_th_9
  s_waitcnt vmcnt(2)
L_th_9:
  buffer_load_dwordx4 v[88:91], v2, s[44:47], s12 offen nt
  s_addk_i32 s12, 0x2000
  s_waitcnt vmcnt(3)
  s_bitcmp0_b32 s68, 0
  s_cbranch_scc1 L_th_10
  s_waitcnt vmcnt(2)
L_th_10:
  buffer_load_dwordx4 v[92:95], v2, s[44:47], s12 offen nt
  s_addk_i32 s12, 0x2000
  s_waitcnt vmcnt(3)
  s_bitcmp0_b32 s68, 0
  s_cbranch_scc1 L_th_11
  s_waitcnt vmcnt(2)
L_th_11:
  buffer_load_dwordx4 v[96:99], v2, s[44:47], s12 offen nt
  s_addk_i32 s12, 0x2000
  s_waitcnt vmcnt(3)
  s_bitcmp0_b32 s68, 0
  s_cbranch_scc1 L_th_12
  s_waitcnt vmcnt(2)
L_th_12:
  buffer_load_dwordx4 v[100:103], v2, s[44:47], s12 offen nt
  s_addk_i32 s12, 0x2000
  s_bfe_u32 s61, s14, 0xa0010
  s_lshl_b32 s61, s61, 10
  s_bfe_u32 s60, s14, 0x70009
  s_sub_u32 s60, s9, s60
  s_add_u32 s60, s60, 64
  s_lshr_b32 s60, s60, 3
  v_bfrev_b32 v3, v1
  v_lshrrev_b32 v3, 28, v3
  v_cmp_gt_u32 s[66:67], s60, v3
  v_and_b32 v3, 15, v1
  v_lshlrev_b32 v3, 4, v3
  s_mov_b32 s13, s61
  s_cmp_gt_u32 s60, 7
  s_cbranch_scc1 L_opts_13
  s_waitcnt vmcnt(3)
  s_bitcmp0_b32 s68, 0
  s_cbranch_scc1 L_th_14
  s_waitcnt vmcnt(2)
L_th_14:
  buffer_load_dwordx4 v[52:55], v2, s[44:47], s13 offen nt
  s_addk_i32 s13, 0x2000
  s_cmp_gt_u32 s60, 6
  s_cbranch_scc1 L_opts_13
  s_waitcnt vmcnt(3)
  s_bitcmp0_b32 s68, 0
  s_cbranch_scc1 L_th_15
  s_waitcnt vmcnt(2)
L_th_15:
  buffer_load_dwordx4 v[48:51], v2, s[44:47], s13 offen nt
  s_addk_i32 s13, 0x2000
  s_cmp_gt_u32 s60, 5
  s_cbranch_scc1 L_opts_13
  s_waitcnt vmcnt(3)
  s_bitcmp0_b32 s68, 0
  s_cbranch_scc1 L_th_16
  s_waitcnt vmcnt(2)
L_th_16:
  buffer_load_dwordx4 v[44:47], v2, s[44:47], s13 offen nt
  s_addk_i32 s13, 0x2000
  s_cmp_gt_u32 s60, 4
  s_cbranch_scc1 L_opts_13
  s_waitcnt vmcnt(3)
  s_bitcmp0_b32 s68, 0
  s_cbranch_scc1 L_th_17
  s_waitcnt vmcnt(2)
L_th_17:
  buffer_load_dwordx4 v[40:43], v2, s[44:47], s13 offen nt
  s_addk_i32 s13, 0x2000
  s_cmp_gt_u32 s60, 3
  s_cbranch_scc1 L_opts_13
  s_waitcnt vmcnt(3)
  s_bitcmp0_b32 s68, 0
  s_cbranch_scc1 L_th_18
  s_waitcnt vmcnt(2)
L_th_18:
  buffer_load_dwordx4 v[36:39], v2, s[44:47], s13 offen nt
  s_addk_i32 s13, 0x2000
  s_cmp_gt_u32 s60, 2
  s_cbranch_scc1 L_opts_13
  s_waitcnt vmcnt(3)
  s_bitcmp0_b32 s68, 0
  s_cbranch_scc1 L_th_19
  s_waitcnt vmcnt(2)
L_th_19:
  buffer_load_dwordx4 v[32:35], v2, s[44:47], s13 offen nt
  s_addk_i32 s13, 0x2000
  s_cmp_gt_u32 s60, 1
  s_cbranch_scc1 L_opts_13
  s_waitcnt vmcnt(3)
  s_bitcmp0_b32 s68, 0
  s_cbranch_scc1 L_th_20
  s_waitcnt vmcnt(2)
L_th_20:
  buffer_load_dwordx4 v[28:31], v2, s[44:47], s13 offen nt
  s_addk_i32 s13, 0x2000
  s_cmp_gt_u32 s60, 0
  s_cbranch_scc1 L_opts_13
  s_waitcnt vmcnt(3)
  s_bitcmp0_b32 s68, 0
  s_cbranch_scc1 L_th_21
  s_waitcnt vmcnt(2)
L_th_21:
  buffer_load_dwordx4 v[24:27], v2, s[44:47], s13 offen nt
  s_addk_i32 s13, 0x2000
L_opts_13:
  s_waitcnt vmcnt(3)
  s_bitcmp0_b32 s68, 0
  s_cbranch_scc1 L_th_22
  s_waitcnt vmcnt(2)
L_th_22:
  buffer_load_dwordx4 v[104:107], v2, s[44:47], s12 offen nt
  s_addk_i32 s12, 0x2000
  s_cmp_ge_u32 s12, s59
  s_cselect_b32 s12, s58, s12
  s_waitcnt vmcnt(3)
  s_bitcmp0_b32 s68, 0
  s_cbranch_scc1 L_th_23
  s_waitcnt vmcnt(2)
L_th_23:
  buffer_load_dwordx4 v[108:111], v2, s[44:47], s12 offen nt
  s_addk_i32 s12, 0x2000
  s_cmp_ge_u32 s12, s59
  s_cselect_b32 s12, s58, s12
  s_waitcnt vmcnt(3)
  s_bitcmp0_b32 s68, 0
  s_cbranch_scc1 L_th_24
  s_waitcnt vmcnt(2)
L_th_24:
  buffer_load_dwordx4 v[112:115], v2, s[44:47], s12 offen nt
  s_addk_i32 s12, 0x2000
  s_cmp_ge_u32 s12, s59
  s_cselect_b32 s12, s58, s12
  s_waitcnt vmcnt(3)
  s_bitcmp0_b32 s68, 0
  s_cbranch_scc1 L_th_25
  s_waitcnt vmcnt(2)
L_th_25:
  buffer_load_dwordx4 v[116:119], v2, s[44:47], s12 offen nt
  s_addk_i32 s12, 0x2000
  s_cmp_ge_u32 s12, s59
  s_cselect_b32 s12, s58, s12
  ds_write_b32 v4, v4 offset:6672
  s_waitcnt vmcnt(3)
  s_bitcmp0_b32 s68, 0
  s_cbranch_scc1 L_th_26
  s_waitcnt vmcnt(2)
L_th_26:
  buffer_load_dwordx4 v[120:123], v2, s[44:47], s12 offen nt
  s_addk_i32 s12, 0x2000
  s_cmp_ge_u32 s12, s59
  s_cselect_b32 s12, s58, s12
  s_waitcnt vmcnt(3)
  s_bitcmp0_b32 s68, 0
  s_cbranch_scc1 L_th_27
  s_waitcnt vmcnt(2)
L_th_27:
  buffer_load_dwordx4 v[124:127], v2, s[44:47], s12 offen nt
  s_addk_i32 s12, 0x2000
  s_cmp_ge_u32 s12, s59
  s_cselect_b32 s12, s58, s12
  s_waitcnt vmcnt(3)
  s_bitcmp0_b32 s68, 0
  s_cbranch_scc1 L_th_28
  s_waitcnt vmcnt(2)
L_th_28:
  buffer_load_dwordx4 v[128:131], v2, s[44:47], s12 offen nt
  s_addk_i32 s12, 0x2000
  s_cmp_ge_u32 s12, s59
  s_cselect_b32 s12, s58, s12
  s_waitcnt vmcnt(3)
  s_bitcmp0_b32 s68, 0
  s_cbranch_scc1 L_th_29
  s_waitcnt vmcnt(2)
L_th_29:
  buffer_load_dwordx4 v[132:135], v2, s[44:47], s12 offen nt
  s_addk_i32 s12, 0x2000
  s_cmp_ge_u32 s12, s59
  s_cselect_b32 s12, s58, s12
  s_waitcnt vmcnt(3)
  s_bitcmp0_b32 s68, 0
  s_cbranch_scc1 L_th_30
  s_waitcnt vmcnt(2)
L_th_30:
  buffer_load_dwordx4 v[136:139], v2, s[44:47], s12 offen nt
  s_addk_i32 s12, 0x2000
  s_cmp_ge_u32 s12, s59
  s_cselect_b32 s12, s58, s12
  s_waitcnt vmcnt(3)
  s_bitcmp0_b32 s68, 0
  s_cbranch_scc1 L_th_31
  s_waitcnt vmcnt(2)
L_th_31:
  buffer_load_dwordx4 v[140:143], v2, s[44:47], s12 offen nt
  s_addk_i32 s12, 0x2000
  s_cmp_ge_u32 s12, s59
  s_cselect_b32 s12, s58, s12
  s_waitcnt vmcnt(3)
  s_bitcmp0_b32 s68, 0
  s_cbranch_scc1 L_th_32
  s_waitcnt vmcnt(2)
L_th_32:
  buffer_load_dwordx4 v[144:147], v2, s[44:47], s12 offen nt
  s_addk_i32 s12, 0x2000
  s_cmp_ge_u32 s12, s59
  s_cselect_b32 s12, s58, s12
  s_waitcnt vmcnt(3)
  s_bitcmp0_b32 s68, 0
  s_cbranch_scc1 L_th_33
  s_waitcnt vmcnt(2)
L_th_33:
  buffer_load_dwordx4 v[148:151], v2, s[44:47], s12 offen nt
  s_addk_i32 s12, 0x2000
  s_cmp_ge_u32 s12, s59
  s_cselect_b32 s12, s58, s12
  s_waitcnt vmcnt(3)
  s_bitcmp0_b32 s68, 0
  s_cbranch_scc1 L_th_34
  s_waitcnt vmcnt(2)
L_th_34:
  buffer_load_dwordx4 v[152:155], v2, s[44:47], s12 offen nt
  s_addk_i32 s12, 0x2000
  s_cmp_ge_u32 s12, s59
  s_cselect_b32 s12, s58, s12
  s_waitcnt vmcnt(3)
  s_bitcmp0_b32 s68, 0
  s_cbranch_scc1 L_th_35
  s_waitcnt vmcnt(2)
L_th_35:
  buffer_load_dwordx4 v[156:159], v2, s[44:47], s12 offen nt
  s_addk_i32 s12, 0x2000
  s_cmp_ge_u32 s12, s59
  s_cselect_b32 s12, s58, s12
  s_waitcnt vmcnt(3)
  s_bitcmp0_b32 s68, 0
  s_cbranch_scc1 L_th_36
  s_waitcnt vmcnt(2)
L_th_36:
  buffer_load_dwordx4 v[160:163], v2, s[44:47], s12 offen nt
  s_addk_i32 s12, 0x2000
  s_cmp_ge_u32 s12, s59
  s_cselect_b32 s12, s58, s12
  s_waitcnt vmcnt(3)
  s_bitcmp0_b32 s68, 0
  s_cbranch_scc1 L_th_37
  s_waitcnt vmcnt(2)
L_th_37:
  buffer_load_dwordx4 v[164:167], v2, s[44:47], s12 offen nt
  s_addk_i32 s12, 0x2000
  s_cmp_ge_u32 s12, s59
  s_cselect_b32 s12, s58, s12
  s_waitcnt vmcnt(3)
  s_bitcmp0_b32 s68, 0
  s_cbranch_scc1 L_th_38
  s_waitcnt vmcnt(2)
L_th_38:
  s_add_u32 m0, s15, 0
  s_nop 0
  buffer_load_dwordx4 v2, s[48:51], s12 offen nt lds
  s_addk_i32 s12, 0x2000
  s_waitcnt vmcnt(3)
  s_bitcmp0_b32 s68, 0
  s_cbranch_scc1 L_th_39
  s_waitcnt vmcnt(2)
L_th_39:
  s_add_u32 m0, s15, 1024
  s_nop 0
  buffer_load_dwordx4 v2, s[48:51], s12 offen nt lds
  s_addk_i32 s12, 0x2000
  s_waitcnt vmcnt(3)
  s_bitcmp0_b32 s68, 0
  s_cbranch_scc1 L_th_40
  s_waitcnt vmcnt(2)
L_th_40:
  s_add_u32 m0, s15, 2048
  s_nop 0
  buffer_load_dwordx4 v2, s[48:51], s12 offen nt lds
  s_addk_i32 s12, 0x2000
  ds_write_b32 v4, v4 offset:6664
  s_waitcnt vmcnt(3)
  s_bitcmp0_b32 s68, 0
  s_cbranch_scc1 L_th_41
  s_waitcnt vmcnt(2)
L_th_41:
  s_add_u32 m0, s15, 3072
  s_nop 0
  buffer_load_dwordx4 v2, s[48:51], s12 offen nt lds
  s_addk_i32 s12, 0x2000
  s_waitcnt vmcnt(3)
  s_add_u32 m0, s15, 4096
  s_nop 0
  buffer_load_dwordx4 v2, s[48:51], s12 offen nt lds
  s_addk_i32 s12, 0x2000
  s_waitcnt vmcnt(3)
  s_add_u32 m0, s15, 5120
  s_nop 0
  buffer_load_dwordx4 v2, s[48:51], s12 offen nt lds
  s_addk_i32 s12, 0x2000
  s_waitcnt vmcnt(3)
  s_add_u32 m0, s15, 6144
  s_nop 0
  buffer_load_dwordx4 v2, s[48:51], s12 offen nt lds
  s_addk_i32 s12, 0x2000
  s_waitcnt vmcnt(3)
  s_add_u32 m0, s15, 7168
  s_nop 0
  buffer_load_dwordx4 v2, s[48:51], s12 offen nt lds
  s_addk_i32 s12, 0x2000
  s_mov_b32 s70, 0
L_pl_42:
  ds_read_b128 v[4:7], v3 offset:6400
  s_waitcnt lgkmcnt(0)
  v_max3_u32 v8, v4, v5, v6
  v_max_u32 v8, v8, v7
  v_cmp_eq_u32 vcc, -1, v8
  s_cmp_eq_u64 vcc, 0
  s_cbranch_scc1 L_pld_43
  s_sleep 2
  s_add_u32 s70, s70, 1
  s_cmp_lt_u32 s70, 1048576
  s_cbranch_scc1 L_pl_42
L_pld_43:
  s_waitcnt vmcnt(8)
  v_dot2_f32_bf16 v8, v56, v4, 0
  v_dot2_f32_bf16 v9, v60, v4, 0
  v_dot2_f32_bf16 v10, v64, v4, 0
  v_dot2_f32_bf16 v11, v68, v4, 0
  v_dot2_f32_bf16 v12, v72, v4, 0
  v_dot2_f32_bf16 v13, v76, v4, 0
  v_dot2_f32_bf16 v14, v80, v4, 0
  v_dot2_f32_bf16 v15, v84, v4, 0
  v_dot2_f32_bf16 v8, v57, v5, v8
  v_dot2_f32_bf16 v9, v61, v5, v9
  v_dot2_f32_bf16 v10, v65, v5, v10
  v_dot2_f32_bf16 v11, v69, v5, v11
  v_dot2_f32_bf16 v12, v73, v5, v12
  v_dot2_f32_bf16 v13, v77, v5, v13
  v_dot2_f32_bf16 v14, v81, v5, v14
  v_dot2_f32_bf16 v15, v85, v5, v15
  v_dot2_f32_bf16 v8, v58, v6, v8
  v_dot2_f32_bf16 v9, v62, v6, v9
  v_dot2_f32_bf16 v10, v66, v6, v10
  v_dot2_f32_bf16 v11, v70, v6, v11
  v_dot2_f32_bf16 v12, v74, v6, v12
  v_dot2_f32_bf16 v13, v78, v6, v13
  v_dot2_f32_bf16 v14, v82, v6, v14
  v_dot2_f32_bf16 v15, v86, v6, v15
  v_dot2_f32_bf16 v8, v59, v7, v8
  v_dot2_f32_bf16 v9, v63, v7, v9
  v_dot2_f32_bf16 v10, v67, v7, v10
  v_dot2_f32_bf16 v11, v71, v7, v11
  v_dot2_f32_bf16 v12, v75, v7, v12
  v_dot2_f32_bf16 v13, v79, v7, v13
  v_dot2_f32_bf16 v14, v83, v7, v14
  v_dot2_f32_bf16 v15, v87, v7, v15
  v_add_f32_dpp v8, v8, v8 row_ror:8 row_mask:0xf bank_mask:0x3
  v_add_f32_dpp v8, v9, v9 row_ror:8 row_mask:0xf bank_mask:0xc
  v_add_f32_dpp v10, v10, v10 row_ror:8 row_mask:0xf bank_mask:0x3
  v_add_f32_dpp v10, v11, v11 row_ror:8 row_mask:0xf bank_mask:0xc
  v_add_f32_dpp v12, v12, v12 row_ror:8 row_mask:0xf bank_mask:0x3
  v_add_f32_dpp v12, v13, v13 row_ror:8 row_mask:0xf bank_mask:0xc
  v_add_f32_dpp v14, v14, v14 row_ror:8 row_mask:0xf bank_mask:0x3
  v_add_f32_dpp v14, v15, v15 row_ror:8 row_mask:0xf bank_mask:0xc
  v_add_f32_dpp v18, v8, v8 row_shl:4 row_mask:0xf bank_mask:0x5
  v_add_f32_dpp v18, v10, v10 row_shr:4 row_mask:0xf bank_mask:0xa
  v_add_f32_dpp v19, v12, v12 row_shl:4 row_mask:0xf bank_mask:0x5
  v_add_f32_dpp v19, v14, v14 row_shr:4 row_mask:0xf bank_mask:0xa
  v_dot2_f32_bf16 v8, v88, v4, 0
  v_dot2_f32_bf16 v9, v92, v4, 0
  v_dot2_f32_bf16 v10, v96, v4, 0
  v_dot2_f32_bf16 v11, v100, v4, 0
  v_dot2_f32_bf16 v12, v104, v4, 0
  v_dot2_f32_bf16 v13, v108, v4, 0
  v_dot2_f32_bf16 v14, v112, v4, 0
  v_dot2_f32_bf16 v15, v116, v4, 0
  v_dot2_f32_bf16 v8, v89, v5, v8
  v_dot2_f32_bf16 v9, v93, v5, v9
  v_dot2_f32_bf16 v10, v97, v5, v10
  v_dot2_f32_bf16 v11, v101, v5, v11
  v_dot2_f32_bf16 v12, v105, v5, v12
  v_dot2_f32_bf16 v13, v109, v5, v13
  v_dot2_f32_bf16 v14, v113, v5, v14
  v_dot2_f32_bf16 v15, v117, v5, v15
  v_dot2_f32_bf16 v8, v90, v6, v8
  v_dot2_f32_bf16 v9, v94, v6, v9
  v_dot2_f32_bf16 v10, v98, v6, v10
  v_dot2_f32_bf16 v11, v102, v6, v11
  v_dot2_f32_bf16 v12, v106, v6, v12
  v_dot2_f32_bf16 v13, v110, v6, v13
  v_dot2_f32_bf16 v14, v114, v6, v14
  v_dot2_f32_bf16 v15, v118, v6, v15
  v_dot2_f32_bf16 v8, v91, v7, v8
  v_dot2_f32_bf16 v9, v95, v7, v9
  v_dot2_f32_bf16 v10, v99, v7, v10
  v_dot2_f32_bf16 v11, v103, v7, v11
  v_dot2_f32_bf16 v12, v107, v7, v12
  v_dot2_f32_bf16 v13, v111, v7, v13
  v_dot2_f32_bf16 v14, v115, v7, v14
  v_dot2_f32_bf16 v15, v119, v7, v15
  buffer_load_dwordx4 v[88:91], v2, s[48:51], s12 offen nt
  s_addk_i32 s12, 0x2000
  v_add_f32_dpp v8, v8, v8 row_ror:8 row_mask:0xf bank_mask:0x3
  v_add_f32_dpp v8, v9, v9 row_ror:8 row_mask:0xf bank_mask:0xc
  v_add_f32_dpp v10, v10, v10 row_ror:8 row_mask:0xf bank_mask:0x3
  v_add_f32_dpp v10, v11, v11 row_ror:8 row_mask:0xf bank_mask:0xc
  v_add_f32_dpp v12, v12, v12 row_ror:8 row_mask:0xf bank_mask:0x3
  v_add_f32_dpp v12, v13, v13 row_ror:8 row_mask:0xf bank_mask:0xc
  v_add_f32_dpp v14, v14, v14 row_ror:8 row_mask:0xf bank_mask:0x3
  v_add_f32_dpp v14, v15, v15 row_ror:8 row_mask:0xf bank_mask:0xc
  v_add_f32_dpp v20, v8, v8 row_shl:4 row_mask:0xf bank_mask:0x5
  v_add_f32_dpp v20, v10, v10 row_shr:4 row_mask:0xf bank_mask:0xa
  v_add_f32_dpp v21, v12, v12 row_shl:4 row_mask:0xf bank_mask:0x5
  v_add_f32_dpp v21, v14, v14 row_shr:4 row_mask:0xf bank_mask:0xa
  v_dot2_f32_bf16 v8, v120, v4, 0
  v_dot2_f32_bf16 v9, v124, v4, 0
  v_dot2_f32_bf16 v10, v128, v4, 0
  v_dot2_f32_bf16 v11, v132, v4, 0
  v_dot2_f32_bf16 v12, v136, v4, 0
  v_dot2_f32_bf16 v13, v140, v4, 0
  v_dot2_f32_bf16 v14, v144, v4, 0
  v_dot2_f32_bf16 v15, v148, v4, 0
  v_dot2_f32_bf16 v8, v121, v5, v8
  v_dot2_f32_bf16 v9, v125, v5, v9
  v_dot2_f32_bf16 v10, v129, v5, v10
  v_dot2_f32_bf16 v11, v133, v5, v11
  v_dot2_f32_bf16 v12, v137, v5, v12
  v_dot2_f32_bf16 v13, v141, v5, v13
  v_dot2_f32_bf16 v14, v145, v5, v14
  v_dot2_f32_bf16 v15, v149, v5, v15
  v_dot2_f32_bf16 v8, v122, v6, v8
  v_dot2_f32_bf16 v9, v126, v6, v9
  v_dot2_f32_bf16 v10, v130, v6, v10
  v_dot2_f32_bf16 v11, v134, v6, v11
  v_dot2_f32_bf16 v12, v138, v6, v12
  v_dot2_f32_bf16 v13, v142, v6, v13
  v_dot2_f32_bf16 v14, v146, v6, v14
  v_dot2_f32_bf16 v15, v150, v6, v15
  v_dot2_f32_bf16 v8, v123, v7, v8
  v_dot2_f32_bf16 v9, v127, v7, v9
  v_dot2_f32_bf16 v10, v131, v7, v10
  v_dot2_f32_bf16 v11, v135, v7, v11
  v_dot2_f32_bf16 v12, v139, v7, v12
  v_dot2_f32_bf16 v13, v143, v7, v13
  v_dot2_f32_bf16 v14, v147, v7, v14
  v_dot2_f32_bf16 v15, v151, v7, v15
  buffer_load_dwordx4 v[92:95], v2, s[48:51], s12 offen nt
  s_addk_i32 s12, 0x2000
  v_add_f32_dpp v8, v8, v8 row_ror:8 row_mask:0xf bank_mask:0x3
  v_add_f32_dpp v8, v9, v9 row_ror:8 row_mask:0xf bank_mask:0xc
  v_add_f32_dpp v10, v10, v10 row_ror:8 row_mask:0xf bank_mask:0x3
  v_add_f32_dpp v10, v11, v11 row_ror:8 row_mask:0xf bank_mask:0xc
  v_add_f32_dpp v12, v12, v12 row_ror:8 row_mask:0xf bank_mask:0x3
  v_add_f32_dpp v12, v13, v13 row_ror:8 row_mask:0xf bank_mask:0xc
  v_add_f32_dpp v14, v14, v14 row_ror:8 row_mask:0xf bank_mask:0x3
  v_add_f32_dpp v14, v15, v15 row_ror:8 row_mask:0xf bank_mask:0xc
  v_add_f32_dpp v22, v8, v8 row_shl:4 row_mask:0xf bank_mask:0x5
  v_add_f32_dpp v22, v10, v10 row_shr:4 row_mask:0xf bank_mask:0xa
  v_add_f32_dpp v23, v12, v12 row_shl:4 row_mask:0xf bank_mask:0x5
  v_add_f32_dpp v23, v14, v14 row_shr:4 row_mask:0xf bank_mask:0xa
  v_dot2_f32_bf16 v8, v152, v4, 0
  v_dot2_f32_bf16 v9, v156, v4, 0
  v_dot2_f32_bf16 v10, v160, v4, 0
  v_dot2_f32_bf16 v11, v164, v4, 0
  v_dot2_f32_bf16 v8, v153, v5, v8
  v_dot2_f32_bf16 v9, v157, v5, v9
  v_dot2_f32_bf16 v10, v161, v5, v10
  v_dot2_f32_bf16 v11, v165, v5, v11
  v_dot2_f32_bf16 v8, v154, v6, v8
  v_dot2_f32_bf16 v9, v158, v6, v9
  v_dot2_f32_bf16 v10, v162, v6, v10
  v_dot2_f32_bf16 v11, v166, v6, v11
  v_dot2_f32_bf16 v8, v155, v7, v8
  v_dot2_f32_bf16 v9, v159, v7, v9
  v_dot2_f32_bf16 v10, v163, v7, v10
  v_dot2_f32_bf16 v11, v167, v7, v11
  v_add_f32_dpp v8, v8, v8 row_ror:8 row_mask:0xf bank_mask:0x3
  v_add_f32_dpp v8, v9, v9 row_ror:8 row_mask:0xf bank_mask:0xc
  v_add_f32_dpp v10, v10, v10 row_ror:8 row_mask:0xf bank_mask:0x3
  v_add_f32_dpp v10, v11, v11 row_ror:8 row_mask:0xf bank_mask:0xc
  s_nop 0
  v_add_f32_dpp v3, v8, v8 row_shl:4 row_mask:0xf bank_mask:0x5
  v_add_f32_dpp v3, v10, v10 row_shr:4 row_mask:0xf bank_mask:0xa
  v_dot2_f32_bf16 v8, v24, v4, 0
  v_dot2_f32_bf16 v9, v28, v4, 0
  v_dot2_f32_bf16 v10, v32, v4, 0
  v_dot2_f32_bf16 v11, v36, v4, 0
  v_dot2_f32_bf16 v12, v40, v4, 0
  v_dot2_f32_bf16 v13, v44, v4, 0
  v_dot2_f32_bf16 v14, v48, v4, 0
  v_dot2_f32_bf16 v15, v52, v4, 0
  v_dot2_f32_bf16 v8, v25, v5, v8
  v_dot2_f32_bf16 v9, v29, v5, v9
  v_dot2_f32_bf16 v10, v33, v5, v10
  v_dot2_f32_bf16 v11, v37, v5, v11
  v_dot2_f32_bf16 v12, v41, v5, v12
  v_dot2_f32_bf16 v13, v45, v5, v13
  v_dot2_f32_bf16 v14, v49, v5, v14
  v_dot2_f32_bf16 v15, v53, v5, v15
  v_dot2_f32_bf16 v8, v26, v6, v8
  v_dot2_f32_bf16 v9, v30, v6, v9
  v_dot2_f32_bf16 v10, v34, v6, v10
  v_dot2_f32_bf16 v11, v38, v6, v11
  v_dot2_f32_bf16 v12, v42, v6, v12
  v_dot2_f32_bf16 v13, v46, v6, v13
  v_dot2_f32_bf16 v14, v50, v6, v14
  v_dot2_f32_bf16 v15, v54, v6, v15
  v_dot2_f32_bf16 v8, v27, v7, v8
  v_dot2_f32_bf16 v9, v31, v7, v9
  v_dot2_f32_bf16 v10, v35, v7, v10
  v_dot2_f32_bf16 v11, v39, v7, v11
  v_dot2_f32_bf16 v12, v43, v7, v12
  v_dot2_f32_bf16 v13, v47, v7, v13
  v_dot2_f32_bf16 v14, v51, v7, v14
  v_dot2_f32_bf16 v15, v55, v7, v15
  buffer_load_dwordx4 v[96:99], v2, s[48:51], s12 offen nt
  s_addk_i32 s12, 0x2000
  v_add_f32_dpp v8, v8, v8 row_ror:8 row_mask:0xf bank_mask:0x3
  v_add_f32_dpp v8, v9, v9 row_ror:8 row_mask:0xf bank_mask:0xc
  v_add_f32_dpp v10, v10, v10 row_ror:8 row_mask:0xf bank_mask:0x3
  v_add_f32_dpp v10, v11, v11 row_ror:8 row_mask:0xf bank_mask:0xc
  v_add_f32_dpp v12, v12, v12 row_ror:8 row_mask:0xf bank_mask:0x3
  v_add_f32_dpp v12, v13, v13 row_ror:8 row_mask:0xf bank_mask:0xc
  v_add_f32_dpp v14, v14, v14 row_ror:8 row_mask:0xf bank_mask:0x3
  v_add_f32_dpp v14, v15, v15 row_ror:8 row_mask:0xf bank_mask:0xc
  v_add_f32_dpp v16, v8, v8 row_shl:4 row_mask:0xf bank_mask:0x5
  v_add_f32_dpp v16, v10, v10 row_shr:4 row_mask:0xf bank_mask:0xa
  v_add_f32_dpp v17, v12, v12 row_shl:4 row_mask:0xf bank_mask:0x5
  v_add_f32_dpp v17, v14, v14 row_shr:4 row_mask:0xf bank_mask:0xa
  v_add_f32_dpp v3, v3, v3 quad_perm:[2,3,0,1] row_mask:0xf bank_mask:0xf
  v_add_f32_dpp v18, v18, v18 quad_perm:[2,3,0,1] row_mask:0xf bank_mask:0xf
  v_add_f32_dpp v19, v19, v19 quad_perm:[2,3,0,1] row_mask:0xf bank_mask:0xf
  v_add_f32_dpp v20, v20, v20 quad_perm:[2,3,0,1] row_mask:0xf bank_mask:0xf
  v_add_f32_dpp v21, v21, v21 quad_perm:[2,3,0,1] row_mask:0xf bank_mask:0xf
  v_add_f32_dpp v22, v22, v22 quad_perm:[2,3,0,1] row_mask:0xf bank_mask:0xf
  v_add_f32_dpp v23, v23, v23 quad_perm:[2,3,0,1] row_mask:0xf bank_mask:0xf
  v_add_f32_dpp v16, v16, v16 quad_perm:[2,3,0,1] row_mask:0xf bank_mask:0xf
  v_add_f32_dpp v17, v17, v17 quad_perm:[2,3,0,1] row_mask:0xf bank_mask:0xf
  v_cndmask_b32 v8, v16, v17, s[52:53]
  v_cndmask_b32 v9, v18, v19, s[52:53]
  v_cndmask_b32 v10, v20, v21, s[52:53]
  v_cndmask_b32 v11, v22, v23, s[52:53]
  v_add_f32_dpp v18, v3, v3 quad_perm:[1,0,3,2] row_mask:0xf bank_mask:0xf
  v_add_f32_dpp v8, v8, v8 quad_perm:[1,0,3,2] row_mask:0xf bank_mask:0xf
  v_add_f32_dpp v9, v9, v9 quad_perm:[1,0,3,2] row_mask:0xf bank_mask:0xf
  v_add_f32_dpp v10, v10, v10 quad_perm:[1,0,3,2] row_mask:0xf bank_mask:0xf
  v_add_f32_dpp v11, v11, v11 quad_perm:[1,0,3,2] row_mask:0xf bank_mask:0xf
  v_cndmask_b32 v16, v8, v9, s[54:55]
  v_cndmask_b32 v17, v10, v11, s[54:55]
  v_cvt_pk_bf16_f32 v16, 0, v16
  v_cvt_pk_bf16_f32 v17, 0, v17
  v_cvt_pk_bf16_f32 v18, 0, v18
  v_mul_f32 v16, 0x3db504f3, v16
  v_mul_f32 v17, 0x3db504f3, v17
  v_mul_f32 v18, 0x3db504f3, v18
  v_cvt_pk_bf16_f32 v16, 0, v16
  v_cvt_pk_bf16_f32 v17, 0, v17
  v_cvt_pk_bf16_f32 v18, 0, v18
  v_mov_b32 v19, 0xff800000
  s_mov_b32 s52, 0xeeeeeeee
  s_mov_b32 s53, 0xeeeeeeee
  v_cndmask_b32 v16, v16, v19, s[66:67]
  v_cndmask_b32 v18, v18, v19, s[52:53]
  s_lshl_b32 s11, s9, 10
  v_lshl_add_u32 v3, v1, 4, s11
  ds_write_b128 v3, v[16:19] offset:12032
  s_waitcnt vmcnt(3)
  buffer_load_dwordx4 v[100:103], v2, s[48:51], s12 offen nt
  s_addk_i32 s12, 0x2000
  v_lshl_add_u32 v3, v1, 4, s15
  ds_read_b128 v[56:59], v3 offset:0
  ds_read_b128 v[60:63], v3 offset:1024
  ds_read_b128 v[64:67], v3 offset:2048
  ds_read_b128 v[68:71], v3 offset:3072
  ds_read_b128 v[72:75], v3 offset:4096
  ds_read_b128 v[76:79], v3 offset:5120
  ds_read_b128 v[80:83], v3 offset:6144
  ds_read_b128 v[84:87], v3 offset:7168
  v_max3_f32 v22, v16, v17, v18
  s_nop 1
  v_max_f32_dpp v22, v22, v22 row_ror:8 row_mask:0xf bank_mask:0xf
  s_nop 1
  v_max_f32_dpp v22, v22, v22 row_ror:4 row_mask:0xf bank_mask:0xf
  s_nop 1
  v_max_f32_dpp v22, v22, v22 row_ror:2 row_mask:0xf bank_mask:0xf
  s_nop 1
  v_max_f32_dpp v22, v22, v22 row_ror:1 row_mask:0xf bank_mask:0xf
  v_mov_b32 v23, v22
  s_nop 1
  v_permlane16_swap_b32 v23, v22
  v_max_f32 v22, v22, v23
  v_mov_b32 v23, v22
  s_nop 1
  v_permlane32_swap_b32 v23, v22
  v_max_f32 v22, v22, v23
  v_sub_f32 v16, v16, v22
  v_sub_f32 v17, v17, v22
  v_sub_f32 v18, v18, v22
  v_mul_f32 v16, 0x3fb8aa3b, v16
  v_mul_f32 v17, 0x3fb8aa3b, v17
  v_mul_f32 v18, 0x3fb8aa3b, v18
  v_exp_f32 v16, v16
  v_exp_f32 v17, v17
  v_exp_f32 v18, v18
  s_nop 0
  v_cvt_pk_bf16_f32 v4, v16, 0
  v_cvt_pk_bf16_f32 v5, 0, v16
  v_cvt_pk_bf16_f32 v6, v17, 0
  v_cvt_pk_bf16_f32 v7, 0, v17
  v_cvt_pk_bf16_f32 v20, v18, 0
  v_cvt_pk_bf16_f32 v21, 0, v18
  v_mov_b32 v8, 0
  v_mov_b32 v9, 0
  v_mov_b32 v10, 0
  v_mov_b32 v11, 0
  v_mov_b32 v12, 0
  v_mov_b32 v13, 0
  v_mov_b32 v14, 0
  v_mov_b32 v15, 0
  s_lshl_b32 s11, s9, 9
  v_and_b32 v3, 15, v1
  v_lshlrev_b32 v3, 5, v3
  v_lshrrev_b32 v16, 4, v1
  v_lshl_add_u32 v3, v16, 3, v3
  v_add_u32 v3, s11, v3
  v_mov_b32 v16, 6656
  s_waitcnt lgkmcnt(0)
  s_mov_b32 s13, s61
  s_cmp_gt_u32 s60, 7
  s_cbranch_scc1 L_opts_44
  s_waitcnt vmcnt(3)
  buffer_load_dwordx4 v[52:55], v2, s[48:51], s13 offen nt
  s_addk_i32 s13, 0x2000
  s_cmp_gt_u32 s60, 6
  s_cbranch_scc1 L_opts_44
  s_waitcnt vmcnt(3)
  buffer_load_dwordx4 v[48:51], v2, s[48:51], s13 offen nt
  s_addk_i32 s13, 0x2000
  s_cmp_gt_u32 s60, 5
  s_cbranch_scc1 L_opts_44
  s_waitcnt vmcnt(3)
  buffer_load_dwordx4 v[44:47], v2, s[48:51], s13 offen nt
  s_addk_i32 s13, 0x2000
  s_cmp_gt_u32 s60, 4
  s_cbranch_scc1 L_opts_44
  s_waitcnt vmcnt(3)
  buffer_load_dwordx4 v[40:43], v2, s[48:51], s13 offen nt
  s_addk_i32 s13, 0x2000
  s_cmp_gt_u32 s60, 3
  s_cbranch_scc1 L_opts_44
  s_waitcnt vmcnt(3)
  buffer_load_dwordx4 v[36:39], v2, s[48:51], s13 offen nt
  s_addk_i32 s13, 0x2000
  s_cmp_gt_u32 s60, 2
  s_cbranch_scc1 L_opts_44
  s_waitcnt vmcnt(3)
  buffer_load_dwordx4 v[32:35], v2, s[48:51], s13 offen nt
  s_addk_i32 s13, 0x2000
  s_cmp_gt_u32 s60, 1
  s_cbranch_scc1 L_opts_44
  s_waitcnt vmcnt(3)
  buffer_load_dwordx4 v[28:31], v2, s[48:51], s13 offen nt
  s_addk_i32 s13, 0x2000
  s_cmp_gt_u32 s60, 0
  s_cbranch_scc1 L_opts_44
  s_waitcnt vmcnt(3)
  buffer_load_dwordx4 v[24:27], v2, s[48:51], s13 offen nt
  s_addk_i32 s13, 0x2000
L_opts_44:
  s_waitcnt vmcnt(3)
  buffer_load_dwordx4 v[104:107], v2, s[48:51], s12 offen nt
  s_addk_i32 s12, 0x2000
  s_cmp_ge_u32 s12, s59
  s_cselect_b32 s12, s58, s12
  v_dot2c_f32_bf16_dpp v8, v4, v56 row_newbcast:1 row_mask:0xf bank_mask:0xf
  v_dot2c_f32_bf16_dpp v9, v5, v56 row_newbcast:1 row_mask:0xf bank_mask:0xf
  v_dot2c_f32_bf16_dpp v10, v4, v57 row_newbcast:1 row_mask:0xf bank_mask:0xf
  v_dot2c_f32_bf16_dpp v11, v5, v57 row_newbcast:1 row_mask:0xf bank_mask:0xf
  v_dot2c_f32_bf16_dpp v12, v4, v58 row_newbcast:1 row_mask:0xf bank_mask:0xf
  v_dot2c_f32_bf16_dpp v13, v5, v58 row_newbcast:1 row_mask:0xf bank_mask:0xf
  v_dot2c_f32_bf16_dpp v14, v4, v59 row_newbcast:1 row_mask:0xf bank_mask:0xf
  v_dot2c_f32_bf16_dpp v15, v5, v59 row_newbcast:1 row_mask:0xf bank_mask:0xf
  v_dot2c_f32_bf16_dpp v8, v4, v60 row_newbcast:9 row_mask:0xf bank_mask:0xf
  v_dot2c_f32_bf16_dpp v9, v5, v60 row_newbcast:9 row_mask:0xf bank_mask:0xf
  v_dot2c_f32_bf16_dpp v10, v4, v61 row_newbcast:9 row_mask:0xf bank_mask:0xf
  v_dot2c_f32_bf16_dpp v11, v5, v61 row_newbcast:9 row_mask:0xf bank_mask:0xf
  v_dot2c_f32_bf16_dpp v12, v4, v62 row_newbcast:9 row_mask:0xf bank_mask:0xf
  v_dot2c_f32_bf16_dpp v13, v5, v62 row_newbcast:9 row_mask:0xf bank_mask:0xf
  v_dot2c_f32_bf16_dpp v14, v4, v63 row_newbcast:9 row_mask:0xf bank_mask:0xf
  v_dot2c_f32_bf16_dpp v15, v5, v63 row_newbcast:9 row_mask:0xf bank_mask:0xf
  v_dot2c_f32_bf16_dpp v8, v4, v64 row_newbcast:5 row_mask:0xf bank_mask:0xf
  v_dot2c_f32_bf16_dpp v9, v5, v64 row_newbcast:5 row_mask:0xf bank_mask:0xf
  v_dot2c_f32_bf16_dpp v10, v4, v65 row_newbcast:5 row_mask:0xf bank_mask:0xf
  v_dot2c_f32_bf16_dpp v11, v5, v65 row_newbcast:5 row_mask:0xf bank_mask:0xf
  v_dot2c_f32_bf16_dpp v12, v4, v66 row_newbcast:5 row_mask:0xf bank_mask:0xf
  v_dot2c_f32_bf16_dpp v13, v5, v66 row_newbcast:5 row_mask:0xf bank_mask:0xf
  v_dot2c_f32_bf16_dpp v14, v4, v67 row_newbcast:5 row_mask:0xf bank_mask:0xf
  v_dot2c_f32_bf16_dpp v15, v5, v67 row_newbcast:5 row_mask:0xf bank_mask:0xf
  s_waitcnt vmcnt(3)
  buffer_load_dwordx4 v[108:111], v2, s[48:51], s12 offen nt
  s_addk_i32 s12, 0x2000
  s_cmp_ge_u32 s12, s59
  s_cselect_b32 s12, s58, s12
  v_dot2c_f32_bf16_dpp v8, v4, v68 row_newbcast:13 row_mask:0xf bank_mask:0xf
  v_dot2c_f32_bf16_dpp v9, v5, v68 row_newbcast:13 row_mask:0xf bank_mask:0xf
  v_dot2c_f32_bf16_dpp v10, v4, v69 row_newbcast:13 row_mask:0xf bank_mask:0xf
  v_dot2c_f32_bf16_dpp v11, v5, v69 row_newbcast:13 row_mask:0xf bank_mask:0xf
  v_dot2c_f32_bf16_dpp v12, v4, v70 row_newbcast:13 row_mask:0xf bank_mask:0xf
  v_dot2c_f32_bf16_dpp v13, v5, v70 row_newbcast:13 row_mask:0xf bank_mask:0xf
  v_dot2c_f32_bf16_dpp v14, v4, v71 row_newbcast:13 row_mask:0xf bank_mask:0xf
  v_dot2c_f32_bf16_dpp v15, v5, v71 row_newbcast:13 row_mask:0xf bank_mask:0xf
  v_dot2c_f32_bf16_dpp v8, v4, v72 row_newbcast:3 row_mask:0xf bank_mask:0xf
  v_dot2c_f32_bf16_dpp v9, v5, v72 row_newbcast:3 row_mask:0xf bank_mask:0xf
  v_dot2c_f32_bf16_dpp v10, v4, v73 row_newbcast:3 row_mask:0xf bank_mask:0xf
  v_dot2c_f32_bf16_dpp v11, v5, v73 row_newbcast:3 row_mask:0xf bank_mask:0xf
  v_dot2c_f32_bf16_dpp v12, v4, v74 row_newbcast:3 row_mask:0xf bank_mask:0xf
  v_dot2c_f32_bf16_dpp v13, v5, v74 row_newbcast:3 row_mask:0xf bank_mask:0xf
  v_dot2c_f32_bf16_dpp v14, v4, v75 row_newbcast:3 row_mask:0xf bank_mask:0xf
  v_dot2c_f32_bf16_dpp v15, v5, v75 row_newbcast:3 row_mask:0xf bank_mask:0xf
  v_dot2c_f32_bf16_dpp v8, v4, v76 row_newbcast:11 row_mask:0xf bank_mask:0xf
  v_dot2c_f32_bf16_dpp v9, v5, v76 row_newbcast:11 row_mask:0xf bank_mask:0xf
  v_dot2c_f32_bf16_dpp v10, v4, v77 row_newbcast:11 row_mask:0xf bank_mask:0xf
  v_dot2c_f32_bf16_dpp v11, v5, v77 row_newbcast:11 row_mask:0xf bank_mask:0xf
  v_dot2c_f32_bf16_dpp v12, v4, v78 row_newbcast:11 row_mask:0xf bank_mask:0xf
  v_dot2c_f32_bf16_dpp v13, v5, v78 row_newbcast:11 row_mask:0xf bank_mask:0xf
  v_dot2c_f32_bf16_dpp v14, v4, v79 row_newbcast:11 row_mask:0xf bank_mask:0xf
  v_dot2c_f32_bf16_dpp v15, v5, v79 row_newbcast:11 row_mask:0xf bank_mask:0xf
  s_waitcnt vmcnt(3)
  buffer_load_dwordx4 v[112:115], v2, s[48:51], s12 offen nt
  s_addk_i32 s12, 0x2000
  s_cmp_ge_u32 s12, s59
  s_cselect_b32 s12, s58, s12
  v_dot2c_f32_bf16_dpp v8, v4, v80 row_newbcast:7 row_mask:0xf bank_mask:0xf
  v_dot2c_f32_bf16_dpp v9, v5, v80 row_newbcast:7 row_mask:0xf bank_mask:0xf
  v_dot2c_f32_bf16_dpp v10, v4, v81 row_newbcast:7 row_mask:0xf bank_mask:0xf
  v_dot2c_f32_bf16_dpp v11, v5, v81 row_newbcast:7 row_mask:0xf bank_mask:0xf
  v_dot2c_f32_bf16_dpp v12, v4, v82 row_newbcast:7 row_mask:0xf bank_mask:0xf
  v_dot2c_f32_bf16_dpp v13, v5, v82 row_newbcast:7 row_mask:0xf bank_mask:0xf
  v_dot2c_f32_bf16_dpp v14, v4, v83 row_newbcast:7 row_mask:0xf bank_mask:0xf
  v_dot2c_f32_bf16_dpp v15, v5, v83 row_newbcast:7 row_mask:0xf bank_mask:0xf
  v_dot2c_f32_bf16_dpp v8, v4, v84 row_newbcast:15 row_mask:0xf bank_mask:0xf
  v_dot2c_f32_bf16_dpp v9, v5, v84 row_newbcast:15 row_mask:0xf bank_mask:0xf
  v_dot2c_f32_bf16_dpp v10, v4, v85 row_newbcast:15 row_mask:0xf bank_mask:0xf
  v_dot2c_f32_bf16_dpp v11, v5, v85 row_newbcast:15 row_mask:0xf bank_mask:0xf
  v_dot2c_f32_bf16_dpp v12, v4, v86 row_newbcast:15 row_mask:0xf bank_mask:0xf
  v_dot2c_f32_bf16_dpp v13, v5, v86 row_newbcast:15 row_mask:0xf bank_mask:0xf
  v_dot2c_f32_bf16_dpp v14, v4, v87 row_newbcast:15 row_mask:0xf bank_mask:0xf
  v_dot2c_f32_bf16_dpp v15, v5, v87 row_newbcast:15 row_mask:0xf bank_mask:0xf
  v_dot2c_f32_bf16_dpp v8, v6, v88 row_newbcast:0 row_mask:0xf bank_mask:0xf
  v_dot2c_f32_bf16_dpp v9, v7, v88 row_newbcast:0 row_mask:0xf bank_mask:0xf
  v_dot2c_f32_bf16_dpp v10, v6, v89 row_newbcast:0 row_mask:0xf bank_mask:0xf
  v_dot2c_f32_bf16_dpp v11, v7, v89 row_newbcast:0 row_mask:0xf bank_mask:0xf
  v_dot2c_f32_bf16_dpp v12, v6, v90 row_newbcast:0 row_mask:0xf bank_mask:0xf
  v_dot2c_f32_bf16_dpp v13, v7, v90 row_newbcast:0 row_mask:0xf bank_mask:0xf
  v_dot2c_f32_bf16_dpp v14, v6, v91 row_newbcast:0 row_mask:0xf bank_mask:0xf
  v_dot2c_f32_bf16_dpp v15, v7, v91 row_newbcast:0 row_mask:0xf bank_mask:0xf
  s_waitcnt vmcnt(3)
  buffer_load_dwordx4 v[116:119], v2, s[48:51], s12 offen nt
  s_addk_i32 s12, 0x2000
  s_cmp_ge_u32 s12, s59
  s_cselect_b32 s12, s58, s12
  v_dot2c_f32_bf16_dpp v8, v6, v92 row_newbcast:8 row_mask:0xf bank_mask:0xf
  v_dot2c_f32_bf16_dpp v9, v7, v92 row_newbcast:8 row_mask:0xf bank_mask:0xf
  v_dot2c_f32_bf16_dpp v10, v6, v93 row_newbcast:8 row_mask:0xf bank_mask:0xf
  v_dot2c_f32_bf16_dpp v11, v7, v93 row_newbcast:8 row_mask:0xf bank_mask:0xf
  v_dot2c_f32_bf16_dpp v12, v6, v94 row_newbcast:8 row_mask:0xf bank_mask:0xf
  v_dot2c_f32_bf16_dpp v13, v7, v94 row_newbcast:8 row_mask:0xf bank_mask:0xf
  v_dot2c_f32_bf16_dpp v14, v6, v95 row_newbcast:8 row_mask:0xf bank_mask:0xf
  v_dot2c_f32_bf16_dpp v15, v7, v95 row_newbcast:8 row_mask:0xf bank_mask:0xf
  v_dot2c_f32_bf16_dpp v8, v6, v96 row_newbcast:4 row_mask:0xf bank_mask:0xf
  v_dot2c_f32_bf16_dpp v9, v7, v96 row_newbcast:4 row_mask:0xf bank_mask:0xf
  v_dot2c_f32_bf16_dpp v10, v6, v97 row_newbcast:4 row_mask:0xf bank_mask:0xf
  v_dot2c_f32_bf16_dpp v11, v7, v97 row_newbcast:4 row_mask:0xf bank_mask:0xf
  v_dot2c_f32_bf16_dpp v12, v6, v98 row_newbcast:4 row_mask:0xf bank_mask:0xf
  v_dot2c_f32_bf16_dpp v13, v7, v98 row_newbcast:4 row_mask:0xf bank_mask:0xf
  v_dot2c_f32_bf16_dpp v14, v6, v99 row_newbcast:4 row_mask:0xf bank_mask:0xf
  v_dot2c_f32_bf16_dpp v15, v7, v99 row_newbcast:4 row_mask:0xf bank_mask:0xf
  v_dot2c_f32_bf16_dpp v8, v6, v100 row_newbcast:12 row_mask:0xf bank_mask:0xf
  v_dot2c_f32_bf16_dpp v9, v7, v100 row_newbcast:12 row_mask:0xf bank_mask:0xf
  v_dot2c_f32_bf16_dpp v10, v6, v101 row_newbcast:12 row_mask:0xf bank_mask:0xf
  v_dot2c_f32_bf16_dpp v11, v7, v101 row_newbcast:12 row_mask:0xf bank_mask:0xf
  v_dot2c_f32_bf16_dpp v12, v6, v102 row_newbcast:12 row_mask:0xf bank_mask:0xf
  v_dot2c_f32_bf16_dpp v13, v7, v102 row_newbcast:12 row_mask:0xf bank_mask:0xf
  v_dot2c_f32_bf16_dpp v14, v6, v103 row_newbcast:12 row_mask:0xf bank_mask:0xf
  v_dot2c_f32_bf16_dpp v15, v7, v103 row_newbcast:12 row_mask:0xf bank_mask:0xf
  s_waitcnt vmcnt(3)
  buffer_load_dwordx4 v[120:123], v2, s[48:51], s12 offen nt
  s_addk_i32 s12, 0x2000
  s_cmp_ge_u32 s12, s59
  s_cselect_b32 s12, s58, s12
  ds_write_b32 v16, v16 offset:20
  s_cmp_gt_u32 s60, 7
  s_cbranch_scc1 L_opt_45
  v_dot2c_f32_bf16_dpp v8, v4, v52 row_newbcast:14 row_mask:0xf bank_mask:0xf
  v_dot2c_f32_bf16_dpp v9, v5, v52 row_newbcast:14 row_mask:0xf bank_mask:0xf
  v_dot2c_f32_bf16_dpp v10, v4, v53 row_newbcast:14 row_mask:0xf bank_mask:0xf
  v_dot2c_f32_bf16_dpp v11, v5, v53 row_newbcast:14 row_mask:0xf bank_mask:0xf
  v_dot2c_f32_bf16_dpp v12, v4, v54 row_newbcast:14 row_mask:0xf bank_mask:0xf
  v_dot2c_f32_bf16_dpp v13, v5, v54 row_newbcast:14 row_mask:0xf bank_mask:0xf
  v_dot2c_f32_bf16_dpp v14, v4, v55 row_newbcast:14 row_mask:0xf bank_mask:0xf
  v_dot2c_f32_bf16_dpp v15, v5, v55 row_newbcast:14 row_mask:0xf bank_mask:0xf
L_opt_45:
  s_cmp_gt_u32 s60, 6
  s_cbranch_scc1 L_opt_46
  v_dot2c_f32_bf16_dpp v8, v4, v48 row_newbcast:6 row_mask:0xf bank_mask:0xf
  v_dot2c_f32_bf16_dpp v9, v5, v48 row_newbcast:6 row_mask:0xf bank_mask:0xf
  v_dot2c_f32_bf16_dpp v10, v4, v49 row_newbcast:6 row_mask:0xf bank_mask:0xf
  v_dot2c_f32_bf16_dpp v11, v5, v49 row_newbcast:6 row_mask:0xf bank_mask:0xf
  v_dot2c_f32_bf16_dpp v12, v4, v50 row_newbcast:6 row_mask:0xf bank_mask:0xf
  v_dot2c_f32_bf16_dpp v13, v5, v50 row_newbcast:6 row_mask:0xf bank_mask:0xf
  v_dot2c_f32_bf16_dpp v14, v4, v51 row_newbcast:6 row_mask:0xf bank_mask:0xf
  v_dot2c_f32_bf16_dpp v15, v5, v51 row_newbcast:6 row_mask:0xf bank_mask:0xf
L_opt_46:
  s_cmp_gt_u32 s60, 5
  s_cbranch_scc1 L_opt_47
  v_dot2c_f32_bf16_dpp v8, v4, v44 row_newbcast:10 row_mask:0xf bank_mask:0xf
  v_dot2c_f32_bf16_dpp v9, v5, v44 row_newbcast:10 row_mask:0xf bank_mask:0xf
  v_dot2c_f32_bf16_dpp v10, v4, v45 row_newbcast:10 row_mask:0xf bank_mask:0xf
  v_dot2c_f32_bf16_dpp v11, v5, v45 row_newbcast:10 row_mask:0xf bank_mask:0xf
  v_dot2c_f32_bf16_dpp v12, v4, v46 row_newbcast:10 row_mask:0xf bank_mask:0xf
  v_dot2c_f32_bf16_dpp v13, v5, v46 row_newbcast:10 row_mask:0xf bank_mask:0xf
  v_dot2c_f32_bf16_dpp v14, v4, v47 row_newbcast:10 row_mask:0xf bank_mask:0xf
  v_dot2c_f32_bf16_dpp v15, v5, v47 row_newbcast:10 row_mask:0xf bank_mask:0xf
L_opt_47:
  s_waitcnt vmcnt(3)
  buffer_load_dwordx4 v[124:127], v2, s[48:51], s12 offen nt
  s_addk_i32 s12, 0x2000
  s_cmp_ge_u32 s12, s59
  s_cselect_b32 s12, s58, s12
  s_cmp_gt_u32 s60, 4
  s_cbranch_scc1 L_opt_48
  v_dot2c_f32_bf16_dpp v8, v4, v40 row_newbcast:2 row_mask:0xf bank_mask:0xf
  v_dot2c_f32_bf16_dpp v9, v5, v40 row_newbcast:2 row_mask:0xf bank_mask:0xf
  v_dot2c_f32_bf16_dpp v10, v4, v41 row_newbcast:2 row_mask:0xf bank_mask:0xf
  v_dot2c_f32_bf16_dpp v11, v5, v41 row_newbcast:2 row_mask:0xf bank_mask:0xf
  v_dot2c_f32_bf16_dpp v12, v4, v42 row_newbcast:2 row_mask:0xf bank_mask:0xf
  v_dot2c_f32_bf16_dpp v13, v5, v42 row_newbcast:2 row_mask:0xf bank_mask:0xf
  v_dot2c_f32_bf16_dpp v14, v4, v43 row_newbcast:2 row_mask:0xf bank_mask:0xf
  v_dot2c_f32_bf16_dpp v15, v5, v43 row_newbcast:2 row_mask:0xf bank_mask:0xf
L_opt_48:
  s_cmp_gt_u32 s60, 3
  s_cbranch_scc1 L_opt_49
  v_dot2c_f32_bf16_dpp v8, v4, v36 row_newbcast:12 row_mask:0xf bank_mask:0xf
  v_dot2c_f32_bf16_dpp v9, v5, v36 row_newbcast:12 row_mask:0xf bank_mask:0xf
  v_dot2c_f32_bf16_dpp v10, v4, v37 row_newbcast:12 row_mask:0xf bank_mask:0xf
  v_dot2c_f32_bf16_dpp v11, v5, v37 row_newbcast:12 row_mask:0xf bank_mask:0xf
  v_dot2c_f32_bf16_dpp v12, v4, v38 row_newbcast:12 row_mask:0xf bank_mask:0xf
  v_dot2c_f32_bf16_dpp v13, v5, v38 row_newbcast:12 row_mask:0xf bank_mask:0xf
  v_dot2c_f32_bf16_dpp v14, v4, v39 row_newbcast:12 row_mask:0xf bank_mask:0xf
  v_dot2c_f32_bf16_dpp v15, v5, v39 row_newbcast:12 row_mask:0xf bank_mask:0xf
L_opt_49:
  s_cmp_gt_u32 s60, 2
  s_cbranch_scc1 L_opt_50
  v_dot2c_f32_bf16_dpp v8, v4, v32 row_newbcast:4 row_mask:0xf bank_mask:0xf
  v_dot2c_f32_bf16_dpp v9, v5, v32 row_newbcast:4 row_mask:0xf bank_mask:0xf
  v_dot2c_f32_bf16_dpp v10, v4, v33 row_newbcast:4 row_mask:0xf bank_mask:0xf
  v_dot2c_f32_bf16_dpp v11, v5, v33 row_newbcast:4 row_mask:0xf bank_mask:0xf
  v_dot2c_f32_bf16_dpp v12, v4, v34 row_newbcast:4 row_mask:0xf bank_mask:0xf
  v_dot2c_f32_bf16_dpp v13, v5, v34 row_newbcast:4 row_mask:0xf bank_mask:0xf
  v_dot2c_f32_bf16_dpp v14, v4, v35 row_newbcast:4 row_mask:0xf bank_mask:0xf
  v_dot2c_f32_bf16_dpp v15, v5, v35 row_newbcast:4 row_mask:0xf bank_mask:0xf
L_opt_50:
  s_waitcnt vmcnt(3)
  buffer_load_dwordx4 v[128:131], v2, s[48:51], s12 offen nt
  s_addk_i32 s12, 0x2000
  s_cmp_ge_u32 s12, s59
  s_cselect_b32 s12, s58, s12
  s_cmp_gt_u32 s60, 1
  s_cbranch_scc1 L_opt_51
  v_dot2c_f32_bf16_dpp v8, v4, v28 row_newbcast:8 row_mask:0xf bank_mask:0xf
  v_dot2c_f32_bf16_dpp v9, v5, v28 row_newbcast:8 row_mask:0xf bank_mask:0xf
  v_dot2c_f32_bf16_dpp v10, v4, v29 row_newbcast:8 row_mask:0xf bank_mask:0xf
  v_dot2c_f32_bf16_dpp v11, v5, v29 row_newbcast:8 row_mask:0xf bank_mask:0xf
  v_dot2c_f32_bf16_dpp v12, v4, v30 row_newbcast:8 row_mask:0xf bank_mask:0xf
  v_dot2c_f32_bf16_dpp v13, v5, v30 row_newbcast:8 row_mask:0xf bank_mask:0xf
  v_dot2c_f32_bf16_dpp v14, v4, v31 row_newbcast:8 row_mask:0xf bank_mask:0xf
  v_dot2c_f32_bf16_dpp v15, v5, v31 row_newbcast:8 row_mask:0xf bank_mask:0xf
L_opt_51:
  s_cmp_gt_u32 s60, 0
  s_cbranch_scc1 L_opt_52
  v_dot2c_f32_bf16_dpp v8, v4, v24 row_newbcast:0 row_mask:0xf bank_mask:0xf
  v_dot2c_f32_bf16_dpp v9, v5, v24 row_newbcast:0 row_mask:0xf bank_mask:0xf
  v_dot2c_f32_bf16_dpp v10, v4, v25 row_newbcast:0 row_mask:0xf bank_mask:0xf
  v_dot2c_f32_bf16_dpp v11, v5, v25 row_newbcast:0 row_mask:0xf bank_mask:0xf
  v_dot2c_f32_bf16_dpp v12, v4, v26 row_newbcast:0 row_mask:0xf bank_mask:0xf
  v_dot2c_f32_bf16_dpp v13, v5, v26 row_newbcast:0 row_mask:0xf bank_mask:0xf
  v_dot2c_f32_bf16_dpp v14, v4, v27 row_newbcast:0 row_mask:0xf bank_mask:0xf
  v_dot2c_f32_bf16_dpp v15, v5, v27 row_newbcast:0 row_mask:0xf bank_mask:0xf
L_opt_52:
  v_dot2c_f32_bf16_dpp v8, v6, v104 row_newbcast:2 row_mask:0xf bank_mask:0xf
  v_dot2c_f32_bf16_dpp v9, v7, v104 row_newbcast:2 row_mask:0xf bank_mask:0xf
  v_dot2c_f32_bf16_dpp v10, v6, v105 row_newbcast:2 row_mask:0xf bank_mask:0xf
  v_dot2c_f32_bf16_dpp v11, v7, v105 row_newbcast:2 row_mask:0xf bank_mask:0xf
  v_dot2c_f32_bf16_dpp v12, v6, v106 row_newbcast:2 row_mask:0xf bank_mask:0xf
  v_dot2c_f32_bf16_dpp v13, v7, v106 row_newbcast:2 row_mask:0xf bank_mask:0xf
  v_dot2c_f32_bf16_dpp v14, v6, v107 row_newbcast:2 row_mask:0xf bank_mask:0xf
  v_dot2c_f32_bf16_dpp v15, v7, v107 row_newbcast:2 row_mask:0xf bank_mask:0xf
  s_waitcnt vmcnt(3)
  buffer_load_dwordx4 v[132:135], v2, s[48:51], s12 offen nt
  s_addk_i32 s12, 0x2000
  s_cmp_ge_u32 s12, s59
  s_cselect_b32 s12, s58, s12
  v_dot2c_f32_bf16_dpp v8, v6, v108 row_newbcast:10 row_mask:0xf bank_mask:0xf
  v_dot2c_f32_bf16_dpp v9, v7, v108 row_newbcast:10 row_mask:0xf bank_mask:0xf
  v_dot2c_f32_bf16_dpp v10, v6, v109 row_newbcast:10 row_mask:0xf bank_mask:0xf
  v_dot2c_f32_bf16_dpp v11, v7, v109 row_newbcast:10 row_mask:0xf bank_mask:0xf
  v_dot2c_f32_bf16_dpp v12, v6, v110 row_newbcast:10 row_mask:0xf bank_mask:0xf
  v_dot2c_f32_bf16_dpp v13, v7, v110 row_newbcast:10 row_mask:0xf bank_mask:0xf
  v_dot2c_f32_bf16_dpp v14, v6, v111 row_newbcast:10 row_mask:0xf bank_mask:0xf
  v_dot2c_f32_bf16_dpp v15, v7, v111 row_newbcast:10 row_mask:0xf bank_mask:0xf
  v_dot2c_f32_bf16_dpp v8, v6, v112 row_newbcast:6 row_mask:0xf bank_mask:0xf
  v_dot2c_f32_bf16_dpp v9, v7, v112 row_newbcast:6 row_mask:0xf bank_mask:0xf
  v_dot2c_f32_bf16_dpp v10, v6, v113 row_newbcast:6 row_mask:0xf bank_mask:0xf
  v_dot2c_f32_bf16_dpp v11, v7, v113 row_newbcast:6 row_mask:0xf bank_mask:0xf
  v_dot2c_f32_bf16_dpp v12, v6, v114 row_newbcast:6 row_mask:0xf bank_mask:0xf
  v_dot2c_f32_bf16_dpp v13, v7, v114 row_newbcast:6 row_mask:0xf bank_mask:0xf
  v_dot2c_f32_bf16_dpp v14, v6, v115 row_newbcast:6 row_mask:0xf bank_mask:0xf
  v_dot2c_f32_bf16_dpp v15, v7, v115 row_newbcast:6 row_mask:0xf bank_mask:0xf
  v_dot2c_f32_bf16_dpp v8, v6, v116 row_newbcast:14 row_mask:0xf bank_mask:0xf
  v_dot2c_f32_bf16_dpp v9, v7, v116 row_newbcast:14 row_mask:0xf bank_mask:0xf
  v_dot2c_f32_bf16_dpp v10, v6, v117 row_newbcast:14 row_mask:0xf bank_mask:0xf
  v_dot2c_f32_bf16_dpp v11, v7, v117 row_newbcast:14 row_mask:0xf bank_mask:0xf
  v_dot2c_f32_bf16_dpp v12, v6, v118 row_newbcast:14 row_mask:0xf bank_mask:0xf
  v_dot2c_f32_bf16_dpp v13, v7, v118 row_newbcast:14 row_mask:0xf bank_mask:0xf
  v_dot2c_f32_bf16_dpp v14, v6, v119 row_newbcast:14 row_mask:0xf bank_mask:0xf
  v_dot2c_f32_bf16_dpp v15, v7, v119 row_newbcast:14 row_mask:0xf bank_mask:0xf
  s_waitcnt vmcnt(3)
  buffer_load_dwordx4 v[136:139], v2, s[48:51], s12 offen nt
  s_addk_i32 s12, 0x2000
  s_cmp_ge_u32 s12, s59
  s_cselect_b32 s12, s58, s12
  v_dot2c_f32_bf16_dpp v8, v6, v120 row_newbcast:1 row_mask:0xf bank_mask:0xf
  v_dot2c_f32_bf16_dpp v9, v7, v120 row_newbcast:1 row_mask:0xf bank_mask:0xf
  v_dot2c_f32_bf16_dpp v10, v6, v121 row_newbcast:1 row_mask:0xf bank_mask:0xf
  v_dot2c_f32_bf16_dpp v11, v7, v121 row_newbcast:1 row_mask:0xf bank_mask:0xf
  v_dot2c_f32_bf16_dpp v12, v6, v122 row_newbcast:1 row_mask:0xf bank_mask:0xf
  v_dot2c_f32_bf16_dpp v13, v7, v122 row_newbcast:1 row_mask:0xf bank_mask:0xf
  v_dot2c_f32_bf16_dpp v14, v6, v123 row_newbcast:1 row_mask:0xf bank_mask:0xf
  v_dot2c_f32_bf16_dpp v15, v7, v123 row_newbcast:1 row_mask:0xf bank_mask:0xf
  s_waitcnt vmcnt(3)
  buffer_load_dwordx4 v[140:143], v2, s[48:51], s12 offen nt
  s_addk_i32 s12, 0x2000
  s_cmp_ge_u32 s12, s59
  s_cselect_b32 s12, s58, s12
  v_dot2c_f32_bf16_dpp v8, v6, v124 row_newbcast:9 row_mask:0xf bank_mask:0xf
  v_dot2c_f32_bf16_dpp v9, v7, v124 row_newbcast:9 row_mask:0xf bank_mask:0xf
  v_dot2c_f32_bf16_dpp v10, v6, v125 row_newbcast:9 row_mask:0xf bank_mask:0xf
  v_dot2c_f32_bf16_dpp v11, v7, v125 row_newbcast:9 row_mask:0xf bank_mask:0xf
  v_dot2c_f32_bf16_dpp v12, v6, v126 row_newbcast:9 row_mask:0xf bank_mask:0xf
  v_dot2c_f32_bf16_dpp v13, v7, v126 row_newbcast:9 row_mask:0xf bank_mask:0xf
  v_dot2c_f32_bf16_dpp v14, v6, v127 row_newbcast:9 row_mask:0xf bank_mask:0xf
  v_dot2c_f32_bf16_dpp v15, v7, v127 row_newbcast:9 row_mask:0xf bank_mask:0xf
  s_waitcnt vmcnt(3)
  buffer_load_dwordx4 v[144:147], v2, s[48:51], s12 offen nt
  s_addk_i32 s12, 0x2000
  s_cmp_ge_u32 s12, s59
  s_cselect_b32 s12, s58, s12
  v_dot2c_f32_bf16_dpp v8, v6, v128 row_newbcast:5 row_mask:0xf bank_mask:0xf
  v_dot2c_f32_bf16_dpp v9, v7, v128 row_newbcast:5 row_mask:0xf bank_mask:0xf
  v_dot2c_f32_bf16_dpp v10, v6, v129 row_newbcast:5 row_mask:0xf bank_mask:0xf
  v_dot2c_f32_bf16_dpp v11, v7, v129 row_newbcast:5 row_mask:0xf bank_mask:0xf
  v_dot2c_f32_bf16_dpp v12, v6, v130 row_newbcast:5 row_mask:0xf bank_mask:0xf
  v_dot2c_f32_bf16_dpp v13, v7, v130 row_newbcast:5 row_mask:0xf bank_mask:0xf
  v_dot2c_f32_bf16_dpp v14, v6, v131 row_newbcast:5 row_mask:0xf bank_mask:0xf
  v_dot2c_f32_bf16_dpp v15, v7, v131 row_newbcast:5 row_mask:0xf bank_mask:0xf
  s_waitcnt vmcnt(3)
  buffer_load_dwordx4 v[148:151], v2, s[48:51], s12 offen nt
  s_addk_i32 s12, 0x2000
  s_cmp_ge_u32 s12, s59
  s_cselect_b32 s12, s58, s12
  v_dot2c_f32_bf16_dpp v8, v6, v132 row_newbcast:13 row_mask:0xf bank_mask:0xf
  v_dot2c_f32_bf16_dpp v9, v7, v132 row_newbcast:13 row_mask:0xf bank_mask:0xf
  v_dot2c_f32_bf16_dpp v10, v6, v133 row_newbcast:13 row_mask:0xf bank_mask:0xf
  v_dot2c_f32_bf16_dpp v11, v7, v133 row_newbcast:13 row_mask:0xf bank_mask:0xf
  v_dot2c_f32_bf16_dpp v12, v6, v134 row_newbcast:13 row_mask:0xf bank_mask:0xf
  v_dot2c_f32_bf16_dpp v13, v7, v134 row_newbcast:13 row_mask:0xf bank_mask:0xf
  v_dot2c_f32_bf16_dpp v14, v6, v135 row_newbcast:13 row_mask:0xf bank_mask:0xf
  v_dot2c_f32_bf16_dpp v15, v7, v135 row_newbcast:13 row_mask:0xf bank_mask:0xf
  buffer_load_dwordx4 v[152:155], v2, s[48:51], s12 offen nt
  s_addk_i32 s12, 0x2000
  s_cmp_ge_u32 s12, s59
  s_cselect_b32 s12, s58, s12
  buffer_load_dwordx4 v[156:159], v2, s[48:51], s12 offen nt
  s_addk_i32 s12, 0x2000
  s_cmp_ge_u32 s12, s59
  s_cselect_b32 s12, s58, s12
  buffer_load_dwordx4 v[160:163], v2, s[48:51], s12 offen nt
  s_addk_i32 s12, 0x2000
  s_cmp_ge_u32 s12, s59
  s_cselect_b32 s12, s58, s12
  buffer_load_dwordx4 v[164:167], v2, s[48:51], s12 offen nt
  s_mov_b32 s70, 0
L_pl_53:
  ds_read_b32 v18, v16
  s_waitcnt lgkmcnt(0)
  v_cmp_eq_u32 vcc, -1, v18
  s_cmp_eq_u64 vcc, 0
  s_cbranch_scc1 L_pld_54
  s_sleep 2
  s_add_u32 s70, s70, 1
  s_cmp_lt_u32 s70, 1048576
  s_cbranch_scc1 L_pl_53
L_pld_54:
  v_sub_f32 v22, v22, v18
  v_mul_f32 v22, 0x3fb8aa3b, v22
  v_exp_f32 v22, v22
  ds_read_b64 v[18:19], v16 offset:32
  s_lshl_b32 s56, s6, 2
  s_add_u32 s56, s56, s7
  s_lshl_b32 s57, s56, 9
  s_add_u32 s57, s57, 131072
  v_lshl_add_u32 v2, v1, 3, s57
  v_and_b32 v17, 1, v1
  v_lshlrev_b32 v17, 4, v17
  v_lshlrev_b32 v1, 3, v1
  v_mov_b32 v0, 1
  s_movk_i32 s56, 0xff
  s_waitcnt lgkmcnt(0)
  v_readfirstlane_b32 s75, v19
  v_lshrrev_b32 v18, v17, v18
  v_lshrrev_b32 v19, 8, v18
  s_waitcnt vmcnt(7)
  v_dot2c_f32_bf16_dpp v8, v6, v136 row_newbcast:3 row_mask:0xf bank_mask:0xf
  v_dot2c_f32_bf16_dpp v9, v7, v136 row_newbcast:3 row_mask:0xf bank_mask:0xf
  v_dot2c_f32_bf16_dpp v10, v6, v137 row_newbcast:3 row_mask:0xf bank_mask:0xf
  v_dot2c_f32_bf16_dpp v11, v7, v137 row_newbcast:3 row_mask:0xf bank_mask:0xf
  v_dot2c_f32_bf16_dpp v12, v6, v138 row_newbcast:3 row_mask:0xf bank_mask:0xf
  v_dot2c_f32_bf16_dpp v13, v7, v138 row_newbcast:3 row_mask:0xf bank_mask:0xf
  v_dot2c_f32_bf16_dpp v14, v6, v139 row_newbcast:3 row_mask:0xf bank_mask:0xf
  v_dot2c_f32_bf16_dpp v15, v7, v139 row_newbcast:3 row_mask:0xf bank_mask:0xf
  s_waitcnt vmcnt(6)
  v_dot2c_f32_bf16_dpp v8, v6, v140 row_newbcast:11 row_mask:0xf bank_mask:0xf
  v_dot2c_f32_bf16_dpp v9, v7, v140 row_newbcast:11 row_mask:0xf bank_mask:0xf
  v_dot2c_f32_bf16_dpp v10, v6, v141 row_newbcast:11 row_mask:0xf bank_mask:0xf
  v_dot2c_f32_bf16_dpp v11, v7, v141 row_newbcast:11 row_mask:0xf bank_mask:0xf
  v_dot2c_f32_bf16_dpp v12, v6, v142 row_newbcast:11 row_mask:0xf bank_mask:0xf
  v_dot2c_f32_bf16_dpp v13, v7, v142 row_newbcast:11 row_mask:0xf bank_mask:0xf
  v_dot2c_f32_bf16_dpp v14, v6, v143 row_newbcast:11 row_mask:0xf bank_mask:0xf
  v_dot2c_f32_bf16_dpp v15, v7, v143 row_newbcast:11 row_mask:0xf bank_mask:0xf
  s_waitcnt vmcnt(5)
  v_dot2c_f32_bf16_dpp v8, v6, v144 row_newbcast:7 row_mask:0xf bank_mask:0xf
  v_dot2c_f32_bf16_dpp v9, v7, v144 row_newbcast:7 row_mask:0xf bank_mask:0xf
  v_dot2c_f32_bf16_dpp v10, v6, v145 row_newbcast:7 row_mask:0xf bank_mask:0xf
  v_dot2c_f32_bf16_dpp v11, v7, v145 row_newbcast:7 row_mask:0xf bank_mask:0xf
  v_dot2c_f32_bf16_dpp v12, v6, v146 row_newbcast:7 row_mask:0xf bank_mask:0xf
  v_dot2c_f32_bf16_dpp v13, v7, v146 row_newbcast:7 row_mask:0xf bank_mask:0xf
  v_dot2c_f32_bf16_dpp v14, v6, v147 row_newbcast:7 row_mask:0xf bank_mask:0xf
  v_dot2c_f32_bf16_dpp v15, v7, v147 row_newbcast:7 row_mask:0xf bank_mask:0xf
  s_waitcnt vmcnt(4)
  v_dot2c_f32_bf16_dpp v8, v6, v148 row_newbcast:15 row_mask:0xf bank_mask:0xf
  v_dot2c_f32_bf16_dpp v9, v7, v148 row_newbcast:15 row_mask:0xf bank_mask:0xf
  v_dot2c_f32_bf16_dpp v10, v6, v149 row_newbcast:15 row_mask:0xf bank_mask:0xf
  v_dot2c_f32_bf16_dpp v11, v7, v149 row_newbcast:15 row_mask:0xf bank_mask:0xf
  v_dot2c_f32_bf16_dpp v12, v6, v150 row_newbcast:15 row_mask:0xf bank_mask:0xf
  v_dot2c_f32_bf16_dpp v13, v7, v150 row_newbcast:15 row_mask:0xf bank_mask:0xf
  v_dot2c_f32_bf16_dpp v14, v6, v151 row_newbcast:15 row_mask:0xf bank_mask:0xf
  v_dot2c_f32_bf16_dpp v15, v7, v151 row_newbcast:15 row_mask:0xf bank_mask:0xf
  s_waitcnt vmcnt(3)
  v_dot2c_f32_bf16_dpp v8, v20, v152 row_newbcast:0 row_mask:0xf bank_mask:0xf
  v_dot2c_f32_bf16_dpp v9, v21, v152 row_newbcast:0 row_mask:0xf bank_mask:0xf
  v_dot2c_f32_bf16_dpp v10, v20, v153 row_newbcast:0 row_mask:0xf bank_mask:0xf
  v_dot2c_f32_bf16_dpp v11, v21, v153 row_newbcast:0 row_mask:0xf bank_mask:0xf
  v_dot2c_f32_bf16_dpp v12, v20, v154 row_newbcast:0 row_mask:0xf bank_mask:0xf
  v_dot2c_f32_bf16_dpp v13, v21, v154 row_newbcast:0 row_mask:0xf bank_mask:0xf
  v_dot2c_f32_bf16_dpp v14, v20, v155 row_newbcast:0 row_mask:0xf bank_mask:0xf
  v_dot2c_f32_bf16_dpp v15, v21, v155 row_newbcast:0 row_mask:0xf bank_mask:0xf
  s_waitcnt vmcnt(2)
  v_dot2c_f32_bf16_dpp v8, v20, v156 row_newbcast:8 row_mask:0xf bank_mask:0xf
  v_dot2c_f32_bf16_dpp v9, v21, v156 row_newbcast:8 row_mask:0xf bank_mask:0xf
  v_dot2c_f32_bf16_dpp v10, v20, v157 row_newbcast:8 row_mask:0xf bank_mask:0xf
  v_dot2c_f32_bf16_dpp v11, v21, v157 row_newbcast:8 row_mask:0xf bank_mask:0xf
  v_dot2c_f32_bf16_dpp v12, v20, v158 row_newbcast:8 row_mask:0xf bank_mask:0xf
  v_dot2c_f32_bf16_dpp v13, v21, v158 row_newbcast:8 row_mask:0xf bank_mask:0xf
  v_dot2c_f32_bf16_dpp v14, v20, v159 row_newbcast:8 row_mask:0xf bank_mask:0xf
  v_dot2c_f32_bf16_dpp v15, v21, v159 row_newbcast:8 row_mask:0xf bank_mask:0xf
  s_waitcnt vmcnt(1)
  v_dot2c_f32_bf16_dpp v8, v20, v160 row_newbcast:4 row_mask:0xf bank_mask:0xf
  v_dot2c_f32_bf16_dpp v9, v21, v160 row_newbcast:4 row_mask:0xf bank_mask:0xf
  v_dot2c_f32_bf16_dpp v10, v20, v161 row_newbcast:4 row_mask:0xf bank_mask:0xf
  v_dot2c_f32_bf16_dpp v11, v21, v161 row_newbcast:4 row_mask:0xf bank_mask:0xf
  v_dot2c_f32_bf16_dpp v12, v20, v162 row_newbcast:4 row_mask:0xf bank_mask:0xf
  v_dot2c_f32_bf16_dpp v13, v21, v162 row_newbcast:4 row_mask:0xf bank_mask:0xf
  v_dot2c_f32_bf16_dpp v14, v20, v163 row_newbcast:4 row_mask:0xf bank_mask:0xf
  v_dot2c_f32_bf16_dpp v15, v21, v163 row_newbcast:4 row_mask:0xf bank_mask:0xf
  s_waitcnt vmcnt(0)
  v_dot2c_f32_bf16_dpp v8, v20, v164 row_newbcast:12 row_mask:0xf bank_mask:0xf
  v_dot2c_f32_bf16_dpp v9, v21, v164 row_newbcast:12 row_mask:0xf bank_mask:0xf
  v_dot2c_f32_bf16_dpp v10, v20, v165 row_newbcast:12 row_mask:0xf bank_mask:0xf
  v_dot2c_f32_bf16_dpp v11, v21, v165 row_newbcast:12 row_mask:0xf bank_mask:0xf
  v_dot2c_f32_bf16_dpp v12, v20, v166 row_newbcast:12 row_mask:0xf bank_mask:0xf
  v_dot2c_f32_bf16_dpp v13, v21, v166 row_newbcast:12 row_mask:0xf bank_mask:0xf
  v_dot2c_f32_bf16_dpp v14, v20, v167 row_newbcast:12 row_mask:0xf bank_mask:0xf
  v_dot2c_f32_bf16_dpp v15, v21, v167 row_newbcast:12 row_mask:0xf bank_mask:0xf
  s_nop 2
  v_permlane32_swap_b32 v8, v12
  v_permlane32_swap_b32 v9, v13
  v_permlane32_swap_b32 v10, v14
  v_permlane32_swap_b32 v11, v15
  v_add_f32 v8, v8, v12
  v_add_f32 v9, v9, v13
  v_add_f32 v10, v10, v14
  v_add_f32 v11, v11, v15
  s_nop 0
  v_permlane16_swap_b32 v8, v10
  v_permlane16_swap_b32 v9, v11
  v_add_f32 v8, v8, v10
  v_add_f32 v9, v9, v11
  v_mul_f32 v8, v8, v22
  v_mul_f32 v9, v9, v22
  ds_write_b64 v3, v[8:9] offset:6912
  s_mov_b64 exec, 1
  ds_add_rtn_u32 v17, v16, v0 offset:68
  s_mov_b64 exec, -1
  ds_read_b64 v[56:57], v1 offset:6912
  ds_read_b64 v[58:59], v1 offset:7424
  ds_read_b64 v[60:61], v1 offset:7936
  ds_read_b64 v[62:63], v1 offset:8448
  ds_read_b64 v[64:65], v1 offset:8960
  ds_read_b64 v[66:67], v1 offset:9472
  ds_read_b64 v[68:69], v1 offset:9984
  ds_read_b64 v[70:71], v1 offset:10496
  s_waitcnt lgkmcnt(6)
  v_readfirstlane_b32 s57, v17
  v_pk_add_f32 v[56:57], v[56:57], v[58:59]
  s_waitcnt lgkmcnt(4)
  v_pk_add_f32 v[60:61], v[60:61], v[62:63]
  s_waitcnt lgkmcnt(2)
  v_pk_add_f32 v[64:65], v[64:65], v[66:67]
  s_waitcnt lgkmcnt(0)
  v_pk_add_f32 v[68:69], v[68:69], v[70:71]
  v_pk_add_f32 v[56:57], v[56:57], v[60:61]
  v_pk_add_f32 v[64:65], v[64:65], v[68:69]
  s_cmp_lg_u32 s57, 7
  v_pk_add_f32 v[56:57], v[56:57], v[64:65]
  v_bfi_b32 v18, s56, v18, v56
  v_bfi_b32 v19, s56, v19, v57
  s_cbranch_scc1 L_send
  s_cmp_eq_u32 s75, 1
  s_cbranch_scc0 L_pf_55
  global_store_dwordx2 v2, v[18:19], s[42:43]
  s_branch L_pe_56
L_pf_55:
  global_store_dwordx2 v2, v[18:19], s[42:43] sc1
L_pe_56:
L_send:
  s_endpgm
L_helper:
  s_getpc_b64 s[56:57]
L_pc2:
  s_lshl_b32 s3, s2, 2
  s_add_u32 s3, s3, L_table-L_pc2
  s_load_dwordx16 s[16:31], s[0:1], 0
  s_load_dword s14, s[56:57], s3
  s_load_dwordx8 s[32:39], s[0:1], 64
  s_load_dwordx4 s[40:43], s[0:1], 96
  s_and_b32 s8, s2, 7
  s_mov_b64 s[100:101], s[56:57]
  s_mov_b32 s72, 0xfffffffe
  s_mov_b32 s73, 0xffff0000
  v_mov_b32 v4, -1
  v_mov_b32 v5, -1
  v_mov_b32 v6, -1
  v_mov_b32 v7, -1
  v_lshlrev_b32 v2, 4, v0
  ds_write_b128 v2, v[4:7] offset:12032
  ds_write_b128 v2, v[4:7] offset:16128
  v_lshlrev_b32 v2, 2, v1
  ds_write_b32 v2, v4 offset:6400
  v_mov_b32 v38, 0
  ds_write_b128 v38, v[4:7] offset:6656
  ds_write_b128 v38, v[4:7] offset:6672
  v_mov_b32 v39, 0
  ds_write_b64 v38, v[38:39] offset:6720
  s_getreg_b32 s76, hwreg(HW_REG_XCC_ID, 0, 4)
  v_lshrrev_b32 v12, 3, v0
  v_lshlrev_b32 v12, 5, v12
  v_bfe_u32 v3, v1, 2, 1
  v_lshl_add_u32 v12, v3, 10, v12
  v_and_b32 v8, 3, v1
  v_lshl_add_u32 v13, v8, 3, v12
  v_and_b32 v12, 0xffffffdf, v12
  v_lshl_add_u32 v12, v8, 4, v12
  v_bfe_u32 v8, v1, 3, 1
  v_lshl_add_u32 v12, v8, 3, v12
  v_lshl_add_u32 v12, v3, 5, v12
  s_waitcnt lgkmcnt(0)
  s_barrier
  s_load_dword s74, s[42:43], 0
  s_and_b32 s13, s14, 7
  s_bfe_u32 s61, s14, 0x60003
  s_cmp_eq_u32 s13, 6
  s_cbranch_scc1 L_r_q
  s_cmp_ge_u32 s13, 4
  s_cbranch_scc1 L_r_moda
  s_cmp_eq_u32 s13, 1
  s_cbranch_scc1 L_r_wo
  s_cmp_eq_u32 s13, 2
  s_cbranch_scc1 L_r_f1
  s_cmp_eq_u32 s13, 3
  s_cbranch_scc1 L_r_f2
  s_branch L_r_none
L_r_moda:
  s_lshl_b32 s58, s61, 9
  s_add_u32 s58, s58, 4096
  global_load_dwordx2 v[14:15], v13, s[34:35]
  s_waitcnt lgkmcnt(0)
  s_mul_i32 s74, s74, 0x9e3779b1
  s_add_u32 s74, s74, 0x7f4a7c15
  s_add_u32 s76, s76, s74
  s_waitcnt vmcnt(0)
  v_lshlrev_b32 v16, 16, v14
  v_and_b32 v17, s73, v14
  v_lshlrev_b32 v18, 16, v15
  v_and_b32 v19, s73, v15
  v_mul_f32 v20, 0xbfb8aa3b, v16
  v_mul_f32 v21, 0xbfb8aa3b, v17
  v_mul_f32 v22, 0xbfb8aa3b, v18
  v_mul_f32 v23, 0xbfb8aa3b, v19
  v_exp_f32 v20, v20
  v_exp_f32 v21, v21
  v_exp_f32 v22, v22
  v_exp_f32 v23, v23
  s_nop 0
  v_add_f32 v20, 1.0, v20
  v_add_f32 v21, 1.0, v21
  v_add_f32 v22, 1.0, v22
  v_add_f32 v23, 1.0, v23
  v_rcp_f32 v20, v20
  v_rcp_f32 v21, v21
  v_rcp_f32 v22, v22
  v_rcp_f32 v23, v23
  s_nop 0
  v_mul_f32 v16, v16, v20
  v_mul_f32 v17, v17, v21
  v_mul_f32 v18, v18, v22
  v_mul_f32 v19, v19, v23
  v_cvt_pk_bf16_f32 v14, v16, v17
  v_cvt_pk_bf16_f32 v15, v18, v19
  ds_write_b64 v12, v[14:15] offset:0
  v_and_b32 v13, 1, v1
  v_lshlrev_b32 v13, 6, v13
  v_lshrrev_b32 v3, 4, v1
  v_lshl_add_u32 v13, v3, 4, v13
  s_lshl_b32 s49, s5, 7
  s_add_u32 s49, s49, s58
  v_add_u32 v13, s49, v13
  v_and_b32 v14, 1, v1
  v_mul_u32_u24 v14, 1056, v14
  v_lshrrev_b32 v3, 4, v1
  v_lshl_add_u32 v14, v3, 4, v14
  v_lshrrev_b32 v2, 2, v1
  v_bfe_u32 v3, v1, 1, 1
  s_lshl_b32 s49, s5, 1
  v_or_b32 v3, s49, v3
  v_and_b32 v10, 6, v2
  v_xor_b32 v3, v3, v10
  v_lshlrev_b32 v2, 7, v2
  v_lshl_add_u32 v2, v3, 4, v2
  v_and_b32 v3, 1, v1
  v_lshl_add_u32 v2, v3, 3, v2
  v_add_u32 v2, 20480, v2
  s_waitcnt lgkmcnt(0)
  v_mov_b32 v9, 1
  s_mov_b64 exec, 1
  ds_add_u32 v38, v9 offset:6720
  s_mov_b64 exec, -1
  s_mov_b32 s70, 0
L_hs_57:
  ds_read_b32 v9, v38 offset:6720
  s_waitcnt lgkmcnt(0)
  v_cmp_gt_u32 vcc, 12, v9
  s_cmp_eq_u64 vcc, 0
  s_cbranch_scc1 L_hsd_58
  s_sleep 2
  s_add_u32 s70, s70, 1
  s_cmp_lt_u32 s70, 2097152
  s_cbranch_scc1 L_hs_57
L_hsd_58:
  ds_read_b64_tr_b16 v[40:41], v2 offset:0
  ds_read_b64_tr_b16 v[42:43], v2 offset:2048
  ds_read_b128 v[104:107], v14 offset:0
  ds_read_b64_tr_b16 v[44:45], v2 offset:4096
  ds_read_b64_tr_b16 v[46:47], v2 offset:6144
  ds_read_b128 v[108:111], v14 offset:64
  ds_read_b64_tr_b16 v[48:49], v2 offset:8192
  ds_read_b64_tr_b16 v[50:51], v2 offset:10240
  ds_read_b128 v[112:115], v14 offset:128
  ds_read_b64_tr_b16 v[52:53], v2 offset:12288
  ds_read_b64_tr_b16 v[54:55], v2 offset:14336
  ds_read_b128 v[116:119], v14 offset:192
  ds_read_b64_tr_b16 v[56:57], v2 offset:16384
  ds_read_b64_tr_b16 v[58:59], v2 offset:18432
  ds_read_b128 v[120:123], v14 offset:256
  s_waitcnt lgkmcnt(12)
  v_mfma_f32_16x16x32_bf16 v[8:11], v[40:43], v[104:107], 0
  ds_read_b64_tr_b16 v[60:61], v2 offset:20480
  ds_read_b64_tr_b16 v[62:63], v2 offset:22528
  ds_read_b128 v[124:127], v14 offset:320
  s_waitcnt lgkmcnt(12)
  v_mfma_f32_16x16x32_bf16 v[8:11], v[44:47], v[108:111], v[8:11]
  ds_read_b64_tr_b16 v[64:65], v2 offset:24576
  ds_read_b64_tr_b16 v[66:67], v2 offset:26624
  ds_read_b128 v[128:131], v14 offset:384
  s_waitcnt lgkmcnt(12)
  v_mfma_f32_16x16x32_bf16 v[8:11], v[48:51], v[112:115], v[8:11]
  ds_read_b64_tr_b16 v[68:69], v2 offset:28672
  ds_read_b64_tr_b16 v[70:71], v2 offset:30720
  ds_read_b128 v[132:135], v14 offset:448
  s_waitcnt lgkmcnt(12)
  v_mfma_f32_16x16x32_bf16 v[8:11], v[52:55], v[116:119], v[8:11]
  ds_read_b64_tr_b16 v[72:73], v2 offset:32768
  ds_read_b64_tr_b16 v[74:75], v2 offset:34816
  ds_read_b128 v[136:139], v14 offset:512
  s_waitcnt lgkmcnt(12)
  v_mfma_f32_16x16x32_bf16 v[8:11], v[56:59], v[120:123], v[8:11]
  ds_read_b64_tr_b16 v[76:77], v2 offset:36864
  ds_read_b64_tr_b16 v[78:79], v2 offset:38912
  ds_read_b128 v[140:143], v14 offset:576
  s_waitcnt lgkmcnt(12)
  v_mfma_f32_16x16x32_bf16 v[8:11], v[60:63], v[124:127], v[8:11]
  ds_read_b64_tr_b16 v[80:81], v2 offset:40960
  ds_read_b64_tr_b16 v[82:83], v2 offset:43008
  ds_read_b128 v[144:147], v14 offset:640
  s_waitcnt lgkmcnt(12)
  v_mfma_f32_16x16x32_bf16 v[8:11], v[64:67], v[128:131], v[8:11]
  ds_read_b64_tr_b16 v[84:85], v2 offset:45056
  ds_read_b64_tr_b16 v[86:87], v2 offset:47104
  ds_read_b128 v[148:151], v14 offset:704
  s_waitcnt lgkmcnt(12)
  v_mfma_f32_16x16x32_bf16 v[8:11], v[68:71], v[132:135], v[8:11]
  ds_read_b64_tr_b16 v[88:89], v2 offset:49152
  ds_read_b64_tr_b16 v[90:91], v2 offset:51200
  ds_read_b128 v[152:155], v14 offset:768
  s_waitcnt lgkmcnt(12)
  v_mfma_f32_16x16x32_bf16 v[8:11], v[72:75], v[136:139], v[8:11]
  ds_read_b64_tr_b16 v[92:93], v2 offset:53248
  ds_read_b64_tr_b16 v[94:95], v2 offset:55296
  ds_read_b128 v[156:159], v14 offset:832
  s_waitcnt lgkmcnt(12)
  v_mfma_f32_16x16x32_bf16 v[8:11], v[76:79], v[140:143], v[8:11]
  ds_read_b64_tr_b16 v[96:97], v2 offset:57344
  ds_read_b64_tr_b16 v[98:99], v2 offset:59392
  ds_read_b128 v[160:163], v14 offset:896
  s_waitcnt lgkmcnt(12)
  v_mfma_f32_16x16x32_bf16 v[8:11], v[80:83], v[144:147], v[8:11]
  ds_read_b64_tr_b16 v[100:101], v2 offset:61440
  ds_read_b64_tr_b16 v[102:103], v2 offset:63488
  ds_read_b128 v[164:167], v14 offset:960
  s_waitcnt lgkmcnt(12)
  v_mfma_f32_16x16x32_bf16 v[8:11], v[84:87], v[148:151], v[8:11]
  s_waitcnt lgkmcnt(9)
  v_mfma_f32_16x16x32_bf16 v[8:11], v[88:91], v[152:155], v[8:11]
  s_waitcnt lgkmcnt(6)
  v_mfma_f32_16x16x32_bf16 v[8:11], v[92:95], v[156:159], v[8:11]
  s_waitcnt lgkmcnt(3)
  v_mfma_f32_16x16x32_bf16 v[8:11], v[96:99], v[160:163], v[8:11]
  s_waitcnt lgkmcnt(0)
  v_mfma_f32_16x16x32_bf16 v[8:11], v[100:103], v[164:167], v[8:11]
  s_nop 7
  v_cvt_pk_bf16_f32 v8, v8, v9
  v_cvt_pk_bf16_f32 v10, v10, v11
  v_mov_b32 v9, s74
  v_mov_b32 v11, s74
  s_mov_b32 exec_lo, 0x00030003
  s_mov_b32 exec_hi, 0x00030003
  global_store_dwordx4 v13, v[8:11], s[42:43] sc1
  s_mov_b64 exec, -1
  s_mov_b32 s60, 0
  s_branch L_svc1
L_r_q:
  s_lshl_b32 s58, s61, 9
  s_add_u32 s58, s58, 32768
  global_load_dwordx2 v[14:15], v13, s[16:17]
  s_waitcnt lgkmcnt(0)
  s_mul_i32 s74, s74, 0x9e3779b1
  s_add_u32 s74, s74, 0x7f4a7c15
  s_add_u32 s76, s76, s74
  s_waitcnt vmcnt(0)
  v_bfe_u32 v6, v1, 2, 1
  v_lshlrev_b32 v6, 5, v6
  v_add_u32 v6, 11008, v6
  s_lshl_b32 s49, s5, 3
  v_add_u32 v5, s49, v6
  v_lshlrev_b32 v20, 16, v14
  v_and_b32 v21, s73, v14
  v_lshlrev_b32 v22, 16, v15
  v_and_b32 v23, s73, v15
  v_add_f32 v8, v20, v21
  v_mul_f32 v9, v20, v20
  v_add_f32 v10, v22, v23
  v_mul_f32 v11, v22, v22
  v_fmac_f32 v9, v21, v21
  v_fmac_f32 v11, v23, v23
  v_add_f32 v8, v8, v10
  v_add_f32 v9, v9, v11
  s_nop 0
  v_add_f32_dpp v8, v8, v8 quad_perm:[1,0,3,2] row_mask:0xf bank_mask:0xf
  v_add_f32_dpp v9, v9, v9 quad_perm:[1,0,3,2] row_mask:0xf bank_mask:0xf
  s_nop 0
  v_add_f32_dpp v8, v8, v8 quad_perm:[2,3,0,1] row_mask:0xf bank_mask:0xf
  v_add_f32_dpp v9, v9, v9 quad_perm:[2,3,0,1] row_mask:0xf bank_mask:0xf
  s_nop 0
  v_add_f32_dpp v8, v8, v8 row_ror:8 row_mask:0xf bank_mask:0xf
  v_add_f32_dpp v9, v9, v9 row_ror:8 row_mask:0xf bank_mask:0xf
  s_nop 0
  v_mov_b32 v10, v8
  v_mov_b32 v11, v9
  s_nop 0
  v_permlane16_swap_b32 v10, v8
  v_permlane16_swap_b32 v11, v9
  v_add_f32 v8, v8, v10
  v_add_f32 v9, v9, v11
  v_mov_b32 v10, v8
  v_mov_b32 v11, v9
  s_nop 0
  v_permlane32_swap_b32 v10, v8
  v_permlane32_swap_b32 v11, v9
  v_add_f32 v8, v8, v10
  v_add_f32 v9, v9, v11
  ds_write_b64 v5, v[8:9]
  s_waitcnt lgkmcnt(0)
  v_mov_b32 v9, 1
  s_mov_b64 exec, 1
  ds_add_u32 v38, v9 offset:6720
  s_mov_b64 exec, -1
  s_mov_b32 s70, 0
L_hs_59:
  ds_read_b32 v9, v38 offset:6720
  s_waitcnt lgkmcnt(0)
  v_cmp_gt_u32 vcc, 12, v9
  s_cmp_eq_u64 vcc, 0
  s_cbranch_scc1 L_hsd_60
  s_sleep 4
  s_add_u32 s70, s70, 1
  s_cmp_lt_u32 s70, 2097152
  s_cbranch_scc1 L_hs_59
L_hsd_60:
  ds_read_b128 v[24:27], v6
  ds_read_b128 v[28:31], v6 offset:16
  s_waitcnt lgkmcnt(0)
  v_pk_add_f32 v[24:25], v[24:25], v[26:27]
  v_pk_add_f32 v[28:29], v[28:29], v[30:31]
  v_pk_add_f32 v[24:25], v[24:25], v[28:29]
  v_mul_f32 v8, 0x3b000000, v24
  v_mul_f32 v9, 0x3b000000, v25
  v_fma_f32 v9, -v8, v8, v9
  v_cvt_pk_bf16_f32 v8, 0, v8
  v_max_f32 v9, 0, v9
  v_cvt_pk_bf16_f32 v9, 0, v9
  v_sub_f32 v20, v20, v8
  v_sub_f32 v21, v21, v8
  v_add_f32 v9, 0x3727c5ac, v9
  v_sub_f32 v22, v22, v8
  v_sub_f32 v23, v23, v8
  v_cvt_pk_bf16_f32 v9, 0, v9
  v_cvt_pk_bf16_f32 v20, 0, v20
  v_sqrt_f32 v9, v9
  v_cvt_pk_bf16_f32 v21, 0, v21
  v_cvt_pk_bf16_f32 v9, 0, v9
  v_cvt_pk_bf16_f32 v22, 0, v22
  v_rcp_f32 v9, v9
  v_cvt_pk_bf16_f32 v23, 0, v23
  v_mul_f32 v20, v20, v9
  v_mul_f32 v21, v21, v9
  v_mul_f32 v22, v22, v9
  v_mul_f32 v23, v23, v9
  v_cvt_pk_bf16_f32 v20, 0, v20
  v_cvt_pk_bf16_f32 v21, 0, v21
  v_cvt_pk_bf16_f32 v22, 0, v22
  v_cvt_pk_bf16_f32 v23, 0, v23
  v_lshrrev_b32 v2, 2, v1
  v_bfe_u32 v3, v1, 1, 1
  s_lshl_b32 s49, s5, 1
  v_or_b32 v3, s49, v3
  v_and_b32 v10, 6, v2
  v_xor_b32 v3, v3, v10
  v_lshlrev_b32 v2, 7, v2
  v_lshl_add_u32 v2, v3, 4, v2
  v_and_b32 v3, 1, v1
  v_lshl_add_u32 v2, v3, 3, v2
  v_add_u32 v2, 20480, v2
  ds_read_b64_tr_b16 v[40:41], v2 offset:0
  ds_read_b64_tr_b16 v[42:43], v2 offset:2048
  ds_read_b64_tr_b16 v[44:45], v2 offset:4096
  ds_read_b64_tr_b16 v[46:47], v2 offset:6144
  ds_read_b64_tr_b16 v[48:49], v2 offset:8192
  ds_read_b64_tr_b16 v[50:51], v2 offset:10240
  ds_read_b64_tr_b16 v[52:53], v2 offset:12288
  ds_read_b64_tr_b16 v[54:55], v2 offset:14336
  ds_read_b64_tr_b16 v[56:57], v2 offset:16384
  ds_read_b64_tr_b16 v[58:59], v2 offset:18432
  ds_read_b64_tr_b16 v[60:61], v2 offset:20480
  ds_read_b64_tr_b16 v[62:63], v2 offset:22528
  s_waitcnt lgkmcnt(10)
  ds_read_b64_tr_b16 v[64:65], v2 offset:24576
  ds_read_b64_tr_b16 v[66:67], v2 offset:26624
  s_waitcnt lgkmcnt(10)
  ds_read_b64_tr_b16 v[68:69], v2 offset:28672
  ds_read_b64_tr_b16 v[70:71], v2 offset:30720
  s_waitcnt lgkmcnt(10)
  ds_read_b64_tr_b16 v[72:73], v2 offset:32768
  ds_read_b64_tr_b16 v[74:75], v2 offset:34816
  s_waitcnt lgkmcnt(10)
  ds_read_b64_tr_b16 v[76:77], v2 offset:36864
  ds_read_b64_tr_b16 v[78:79], v2 offset:38912
  s_waitcnt lgkmcnt(10)
  ds_read_b64_tr_b16 v[80:81], v2 offset:40960
  ds_read_b64_tr_b16 v[82:83], v2 offset:43008
  s_waitcnt lgkmcnt(10)
  ds_read_b64_tr_b16 v[84:85], v2 offset:45056
  ds_read_b64_tr_b16 v[86:87], v2 offset:47104
  s_waitcnt lgkmcnt(10)
  ds_read_b64_tr_b16 v[88:89], v2 offset:49152
  ds_read_b64_tr_b16 v[90:91], v2 offset:51200
  s_waitcnt lgkmcnt(10)
  ds_read_b64_tr_b16 v[92:93], v2 offset:53248
  ds_read_b64_tr_b16 v[94:95], v2 offset:55296
  s_waitcnt lgkmcnt(10)
  ds_read_b64_tr_b16 v[96:97], v2 offset:57344
  ds_read_b64_tr_b16 v[98:99], v2 offset:59392
  s_waitcnt lgkmcnt(10)
  ds_read_b64_tr_b16 v[100:101], v2 offset:61440
  ds_read_b64_tr_b16 v[102:103], v2 offset:63488
  s_waitcnt lgkmcnt(10)
  s_waitcnt lgkmcnt(0)
  v_and_b32 v13, 1, v1
  v_lshlrev_b32 v13, 6, v13
  v_lshrrev_b32 v3, 4, v1
  v_lshl_add_u32 v13, v3, 4, v13
  s_lshl_b32 s49, s5, 7
  s_add_u32 s49, s49, s58
  v_add_u32 v13, s49, v13
  v_and_b32 v14, 1, v1
  v_mul_u32_u24 v14, 1056, v14
  v_lshrrev_b32 v3, 4, v1
  v_lshl_add_u32 v14, v3, 4, v14
  v_lshlrev_b32 v15, 4, v0
  v_add_u32 v15, 4096, v15
  v_add_u32 v36, 0x1000, v15
  s_mov_b32 s70, 0
L_pl_61:
  ds_read_b32 v8, v38 offset:6672
  s_waitcnt lgkmcnt(0)
  v_cmp_eq_u32 vcc, -1, v8
  s_cmp_eq_u64 vcc, 0
  s_cbranch_scc1 L_pld_62
  s_sleep 8
  s_add_u32 s70, s70, 1
  s_cmp_lt_u32 s70, 1048576
  s_cbranch_scc1 L_pl_61
L_pld_62:
  s_mov_b64 s[64:65], -1
  s_mov_b64 s[66:67], -1
  s_mov_b32 s70, 0
L_q_p:
  s_mov_b64 exec, s[64:65]
  global_load_dwordx4 v[16:19], v15, s[42:43] sc1
  s_mov_b64 exec, s[66:67]
  global_load_dwordx4 v[32:35], v36, s[42:43] sc1
  s_mov_b64 exec, -1
  s_waitcnt vmcnt(0)
  v_cmp_ne_u32 s[64:65], s74, v17
  v_cmp_ne_u32 s[68:69], s74, v19
  s_or_b64 s[64:65], s[64:65], s[68:69]
  v_cmp_ne_u32 s[66:67], s74, v33
  v_cmp_ne_u32 s[68:69], s74, v35
  s_or_b64 s[66:67], s[66:67], s[68:69]
  s_or_b64 vcc, s[64:65], s[66:67]
  s_cmp_eq_u64 vcc, 0
  s_cbranch_scc1 L_q_ok
  s_add_u32 s70, s70, 1
  s_cmp_lt_u32 s70, 262144
  s_cbranch_scc1 L_q_p
L_q_ok:
  v_lshlrev_b32 v28, 16, v32
  v_and_b32 v29, s73, v32
  v_lshlrev_b32 v30, 16, v34
  v_and_b32 v31, s73, v34
  v_lshlrev_b32 v24, 16, v16
  v_and_b32 v25, s73, v16
  v_lshlrev_b32 v26, 16, v18
  v_and_b32 v27, s73, v18
  v_add_f32 v28, 1.0, v28
  v_add_f32 v29, 1.0, v29
  v_add_f32 v30, 1.0, v30
  v_add_f32 v31, 1.0, v31
  v_cvt_pk_bf16_f32 v28, 0, v28
  v_cvt_pk_bf16_f32 v29, 0, v29
  v_cvt_pk_bf16_f32 v30, 0, v30
  v_cvt_pk_bf16_f32 v31, 0, v31
  v_mul_f32 v20, v20, v28
  v_mul_f32 v21, v21, v29
  v_mul_f32 v22, v22, v30
  v_mul_f32 v23, v23, v31
  v_cvt_pk_bf16_f32 v20, 0, v20
  v_cvt_pk_bf16_f32 v21, 0, v21
  v_cvt_pk_bf16_f32 v22, 0, v22
  v_cvt_pk_bf16_f32 v23, 0, v23
  v_add_f32 v20, v20, v24
  v_add_f32 v21, v21, v25
  v_add_f32 v22, v22, v26
  v_add_f32 v23, v23, v27
  v_cvt_pk_bf16_f32 v16, v20, v21
  v_cvt_pk_bf16_f32 v17, v22, v23
  ds_write_b64 v12, v[16:17] offset:0
  v_mov_b32 v9, 1
  s_mov_b64 exec, 1
  ds_add_u32 v38, v9 offset:6720
  s_mov_b64 exec, -1
  s_mov_b32 s70, 0
L_hs_63:
  ds_read_b32 v9, v38 offset:6720
  s_waitcnt lgkmcnt(0)
  v_cmp_gt_u32 vcc, 16, v9
  s_cmp_eq_u64 vcc, 0
  s_cbranch_scc1 L_hsd_64
  s_add_u32 s70, s70, 1
  s_cmp_lt_u32 s70, 2097152
  s_cbranch_scc1 L_hs_63
L_hsd_64:
  ds_read_b128 v[104:107], v14 offset:0
  ds_read_b128 v[108:111], v14 offset:64
  ds_read_b128 v[112:115], v14 offset:128
  ds_read_b128 v[116:119], v14 offset:192
  ds_read_b128 v[120:123], v14 offset:256
  ds_read_b128 v[124:127], v14 offset:320
  ds_read_b128 v[128:131], v14 offset:384
  ds_read_b128 v[132:135], v14 offset:448
  ds_read_b128 v[136:139], v14 offset:512
  ds_read_b128 v[140:143], v14 offset:576
  ds_read_b128 v[144:147], v14 offset:640
  ds_read_b128 v[148:151], v14 offset:704
  s_waitcnt lgkmcnt(11)
  v_mfma_f32_16x16x32_bf16 v[8:11], v[40:43], v[104:107], 0
  ds_read_b128 v[152:155], v14 offset:768
  s_waitcnt lgkmcnt(11)
  v_mfma_f32_16x16x32_bf16 v[8:11], v[44:47], v[108:111], v[8:11]
  ds_read_b128 v[156:159], v14 offset:832
  s_waitcnt lgkmcnt(11)
  v_mfma_f32_16x16x32_bf16 v[8:11], v[48:51], v[112:115], v[8:11]
  ds_read_b128 v[160:163], v14 offset:896
  s_waitcnt lgkmcnt(11)
  v_mfma_f32_16x16x32_bf16 v[8:11], v[52:55], v[116:119], v[8:11]
  ds_read_b128 v[164:167], v14 offset:960
  s_waitcnt lgkmcnt(11)
  v_mfma_f32_16x16x32_bf16 v[8:11], v[56:59], v[120:123], v[8:11]
  s_waitcnt lgkmcnt(10)
  v_mfma_f32_16x16x32_bf16 v[8:11], v[60:63], v[124:127], v[8:11]
  s_waitcnt lgkmcnt(9)
  v_mfma_f32_16x16x32_bf16 v[8:11], v[64:67], v[128:131], v[8:11]
  s_waitcnt lgkmcnt(8)
  v_mfma_f32_16x16x32_bf16 v[8:11], v[68:71], v[132:135], v[8:11]
  s_waitcnt lgkmcnt(7)
  v_mfma_f32_16x16x32_bf16 v[8:11], v[72:75], v[136:139], v[8:11]
  s_waitcnt lgkmcnt(6)
  v_mfma_f32_16x16x32_bf16 v[8:11], v[76:79], v[140:143], v[8:11]
  s_waitcnt lgkmcnt(5)
  v_mfma_f32_16x16x32_bf16 v[8:11], v[80:83], v[144:147], v[8:11]
  s_waitcnt lgkmcnt(4)
  v_mfma_f32_16x16x32_bf16 v[8:11], v[84:87], v[148:151], v[8:11]
  s_waitcnt lgkmcnt(3)
  v_mfma_f32_16x16x32_bf16 v[8:11], v[88:91], v[152:155], v[8:11]
  s_waitcnt lgkmcnt(2)
  v_mfma_f32_16x16x32_bf16 v[8:11], v[92:95], v[156:159], v[8:11]
  s_waitcnt lgkmcnt(1)
  v_mfma_f32_16x16x32_bf16 v[8:11], v[96:99], v[160:163], v[8:11]
  s_waitcnt lgkmcnt(0)
  v_mfma_f32_16x16x32_bf16 v[8:11], v[100:103], v[164:167], v[8:11]
  s_nop 7
  v_cvt_pk_bf16_f32 v8, v8, v9
  v_cvt_pk_bf16_f32 v10, v10, v11
  v_mov_b32 v9, s74
  v_mov_b32 v11, s74
  v_min_u32 v8, s72, v8
  v_min_u32 v10, s72, v10
  s_mov_b32 exec_lo, 0x00030003
  s_mov_b32 exec_hi, 0x00030003
  global_store_dwordx4 v13, v[8:11], s[42:43] sc1
  s_mov_b64 exec, -1
  s_mov_b32 s60, 0
  s_branch L_svc1
L_r_wo:
  s_and_b32 s66, s2, 7
  s_lshr_b32 s58, s66, 1
  s_lshl_b32 s58, s58, 14
  s_and_b32 s49, s66, 1
  s_lshl_b32 s49, s49, 12
  s_add_u32 s58, s58, s49
  s_lshl_b32 s49, s61, 9
  s_add_u32 s58, s58, s49
  s_add_u32 s58, s58, 327680
  s_waitcnt lgkmcnt(0)
  s_mul_i32 s74, s74, 0x9e3779b1
  s_add_u32 s74, s74, 0x7f4a7c15
  s_add_u32 s76, s76, s74
  s_cmp_lg_u32 s5, 3
  s_cbranch_scc1 L_nr_65
  s_lshl_b32 s49, s61, 14
  s_lshl_b32 s50, s8, 10
  s_add_u32 s49, s49, s50
  s_add_u32 s49, s49, 524288
  s_add_u32 s50, s49, 256
  s_mov_b32 s54, -1
  s_mov_b32 s55, -1
L_nrl_66:
  s_memtime s[64:65]
  s_waitcnt lgkmcnt(0)
  s_load_dword s51, s[42:43], s49
  s_waitcnt lgkmcnt(0)
  s_memtime s[68:69]
  s_waitcnt lgkmcnt(0)
  s_sub_u32 s68, s68, s64
  s_min_u32 s54, s54, s68
  s_xor_b32 s49, s49, 0x2000
  s_memtime s[64:65]
  s_waitcnt lgkmcnt(0)
  s_load_dword s51, s[42:43], s49
  s_waitcnt lgkmcnt(0)
  s_memtime s[68:69]
  s_waitcnt lgkmcnt(0)
  s_sub_u32 s68, s68, s64
  s_min_u32 s55, s55, s68
  s_xor_b32 s49, s49, 0x2000
  s_add_u32 s49, s49, 128
  s_cmp_lt_u32 s49, s50
  s_cbranch_scc1 L_nrl_66
  s_cmp_lt_u32 s55, s54
  s_cselect_b32 s54, 1, 0
  s_sub_u32 s55, s76, s74
  s_lshr_b32 s55, s55, 2
  s_xor_b32 s54, s54, s55
  s_and_b32 s54, s54, 1
  s_add_u32 s54, s54, s74
  s_lshl_b32 s55, s8, 3
  s_add_u32 s55, s55, s61
  s_lshl_b32 s55, s55, 5
  v_mov_b32 v8, s55
  v_mov_b32 v10, s76
  v_mov_b32 v11, s54
  s_mov_b64 exec, 1
  global_store_dwordx2 v8, v[10:11], s[42:43] offset:1024 sc1
  s_mov_b64 exec, -1
L_nr_65:
  s_mov_b32 s60, 1
  s_branch L_svc1
L_r_f1:
  s_lshl_b32 s48, s61, 6
  s_mul_i32 s49, s61, 47
  s_lshr_b32 s49, s49, 9
  s_mul_i32 s49, s49, 10752
  s_lshl_b32 s58, s61, 9
  s_add_u32 s58, s58, s49
  s_add_u32 s58, s58, 262144
  s_cmp_lt_u32 s5, 2
  s_cselect_b32 s44, s28, s30
  s_cselect_b32 s45, s29, s31
  s_mov_b32 s46, 1409024
  s_mov_b32 s47, 0x20000
  s_mov_b32 s60, 2
  s_waitcnt lgkmcnt(0)
  s_mul_i32 s74, s74, 0x9e3779b1
  s_add_u32 s74, s74, 0x7f4a7c15
  s_add_u32 s76, s76, s74
  s_branch L_svc1
L_r_f2:
  s_mov_b32 s44, s32
  s_mov_b32 s45, s33
  s_mov_b32 s46, 1409024
  s_mov_b32 s47, 0x20000
  s_waitcnt lgkmcnt(0)
  s_mul_i32 s74, s74, 0x9e3779b1
  s_add_u32 s74, s74, 0x7f4a7c15
  s_add_u32 s76, s76, s74
  s_mov_b32 s60, 3
  s_lshl_b32 s48, s61, 5
  global_load_dword v167, v38, s[38:39]
  s_branch L_svc1
L_r_none:
  s_mov_b32 s60, 0
  s_waitcnt lgkmcnt(0)
  s_mul_i32 s74, s74, 0x9e3779b1
  s_add_u32 s74, s74, 0x7f4a7c15
  s_add_u32 s76, s76, s74
L_svc1:
  s_cmp_lg_u32 s5, 0
  s_cbranch_scc1 L_disp3
  s_and_b32 s64, s6, 31
  s_lshl_b32 s64, s64, 10
  s_and_b32 s65, s6, 32
  s_lshl_b32 s65, s65, 1
  s_add_u32 s64, s64, s65
  s_add_u32 s64, s64, 32768
  v_bfe_u32 v16, v1, 2, 3
  v_lshl_add_u32 v16, v16, 7, s64
  v_and_b32 v17, 3, v1
  v_lshl_add_u32 v16, v17, 4, v16
  v_and_b32 v17, 31, v1
  v_lshlrev_b32 v17, 3, v17
  s_lshl_b32 s71, s8, 8
  v_and_b32 v18, 7, v1
  v_lshl_add_u32 v18, v18, 5, s71
  s_mov_b32 s70, 0
L_pl_67:
  ds_read_b32 v8, v38 offset:6664
  s_waitcnt lgkmcnt(0)
  v_cmp_eq_u32 vcc, -1, v8
  s_cmp_eq_u64 vcc, 0
  s_cbranch_scc1 L_pld_68
  s_sleep 8
  s_add_u32 s70, s70, 1
  s_cmp_lt_u32 s70, 1048576
  s_cbranch_scc1 L_pl_67
L_pld_68:
  global_load_dword v19, v18, s[42:43] offset:1024 sc1
  s_mov_b32 s70, 0
L_polt_69:
  global_load_dwordx4 v[20:23], v16, s[42:43] sc1
  s_waitcnt vmcnt(0)
  v_cmp_ne_u32 vcc, s74, v21
  v_cmp_ne_u32 s[68:69], s74, v23
  s_or_b64 vcc, vcc, s[68:69]
  s_cmp_eq_u64 vcc, 0
  s_cbranch_scc1 L_poltd_70
  s_add_u32 s70, s70, 1
  s_cmp_lt_u32 s70, 262144
  s_cbranch_scc1 L_polt_69
L_poltd_70:
  v_mov_b32 v21, v22
  ds_write_b64 v17, v[20:21] offset:6400
  v_cmp_ne_u32 vcc, s76, v19
  s_cmp_eq_u64 vcc, 0
  s_cselect_b32 s75, 1, 0
  v_mov_b32 v20, s74
  v_mov_b32 v21, s75
  ds_write_b64 v38, v[20:21] offset:6688
L_svc2:
  v_lshlrev_b32 v16, 4, v1
  s_lshl_b32 s64, s6, 9
  s_add_u32 s64, s64, 65536
  s_lshl_b32 s65, s7, 7
  s_add_u32 s65, s65, s64
  v_mov_b32 v18, s65
  s_mov_b32 s70, 0
L_pl_71:
  ds_read_b128 v[104:107], v16 offset:12032
  ds_read_b128 v[108:111], v16 offset:13056
  ds_read_b128 v[112:115], v16 offset:14080
  ds_read_b128 v[116:119], v16 offset:15104
  ds_read_b128 v[120:123], v16 offset:16128
  ds_read_b128 v[124:127], v16 offset:17152
  ds_read_b128 v[128:131], v16 offset:18176
  ds_read_b128 v[132:135], v16 offset:19200
  s_waitcnt lgkmcnt(0)
  v_max3_u32 v8, v104, v105, v106
  v_max3_u32 v8, v8, v108, v109
  v_max3_u32 v8, v8, v110, v112
  v_max3_u32 v8, v8, v113, v114
  v_max3_u32 v8, v8, v116, v117
  v_max3_u32 v8, v8, v118, v120
  v_max3_u32 v8, v8, v121, v122
  v_max3_u32 v8, v8, v124, v125
  v_max3_u32 v8, v8, v126, v128
  v_max3_u32 v8, v8, v129, v130
  v_max3_u32 v8, v8, v132, v133
  v_max_u32 v8, v8, v134
  v_cmp_eq_u32 vcc, -1, v8
  s_cmp_eq_u64 vcc, 0
  s_cbranch_scc1 L_pld_72
  s_sleep 4
  s_add_u32 s70, s70, 1
  s_cmp_lt_u32 s70, 1048576
  s_cbranch_scc1 L_pl_71
L_pld_72:
  v_max3_f32 v8, v104, v105, v106
  v_max3_f32 v8, v8, v108, v109
  v_max3_f32 v8, v8, v110, v112
  v_max3_f32 v8, v8, v113, v114
  v_max3_f32 v8, v8, v116, v117
  v_max3_f32 v8, v8, v118, v120
  v_max3_f32 v8, v8, v121, v122
  v_max3_f32 v8, v8, v124, v125
  v_max3_f32 v8, v8, v126, v128
  v_max3_f32 v8, v8, v129, v130
  v_max3_f32 v8, v8, v132, v133
  v_max_f32 v8, v8, v134
  s_nop 1
  v_max_f32_dpp v8, v8, v8 row_ror:8 row_mask:0xf bank_mask:0xf
  s_nop 1
  v_max_f32_dpp v8, v8, v8 row_ror:4 row_mask:0xf bank_mask:0xf
  s_nop 1
  v_max_f32_dpp v8, v8, v8 row_ror:2 row_mask:0xf bank_mask:0xf
  s_nop 1
  v_max_f32_dpp v8, v8, v8 row_ror:1 row_mask:0xf bank_mask:0xf
  v_mov_b32 v11, v8
  s_nop 1
  v_permlane16_swap_b32 v11, v8
  v_max_f32 v8, v8, v11
  v_mov_b32 v11, v8
  s_nop 1
  v_permlane32_swap_b32 v11, v8
  v_max_f32 v8, v8, v11
  v_min_u32 v9, s72, v8
  ds_write_b32 v38, v9 offset:6656
  v_sub_f32 v104, v104, v8
  v_sub_f32 v105, v105, v8
  v_sub_f32 v106, v106, v8
  v_sub_f32 v108, v108, v8
  v_sub_f32 v109, v109, v8
  v_sub_f32 v110, v110, v8
  v_sub_f32 v112, v112, v8
  v_sub_f32 v113, v113, v8
  v_sub_f32 v114, v114, v8
  v_sub_f32 v116, v116, v8
  v_sub_f32 v117, v117, v8
  v_sub_f32 v118, v118, v8
  v_sub_f32 v120, v120, v8
  v_sub_f32 v121, v121, v8
  v_sub_f32 v122, v122, v8
  v_sub_f32 v124, v124, v8
  v_sub_f32 v125, v125, v8
  v_sub_f32 v126, v126, v8
  v_sub_f32 v128, v128, v8
  v_sub_f32 v129, v129, v8
  v_sub_f32 v130, v130, v8
  v_sub_f32 v132, v132, v8
  v_sub_f32 v133, v133, v8
  v_sub_f32 v134, v134, v8
  v_mul_f32 v104, 0x3fb8aa3b, v104
  v_mul_f32 v105, 0x3fb8aa3b, v105
  v_mul_f32 v106, 0x3fb8aa3b, v106
  v_mul_f32 v108, 0x3fb8aa3b, v108
  v_mul_f32 v109, 0x3fb8aa3b, v109
  v_mul_f32 v110, 0x3fb8aa3b, v110
  v_mul_f32 v112, 0x3fb8aa3b, v112
  v_mul_f32 v113, 0x3fb8aa3b, v113
  v_mul_f32 v114, 0x3fb8aa3b, v114
  v_mul_f32 v116, 0x3fb8aa3b, v116
  v_mul_f32 v117, 0x3fb8aa3b, v117
  v_mul_f32 v118, 0x3fb8aa3b, v118
  v_mul_f32 v120, 0x3fb8aa3b, v120
  v_mul_f32 v121, 0x3fb8aa3b, v121
  v_mul_f32 v122, 0x3fb8aa3b, v122
  v_mul_f32 v124, 0x3fb8aa3b, v124
  v_mul_f32 v125, 0x3fb8aa3b, v125
  v_mul_f32 v126, 0x3fb8aa3b, v126
  v_mul_f32 v128, 0x3fb8aa3b, v128
  v_mul_f32 v129, 0x3fb8aa3b, v129
  v_mul_f32 v130, 0x3fb8aa3b, v130
  v_mul_f32 v132, 0x3fb8aa3b, v132
  v_mul_f32 v133, 0x3fb8aa3b, v133
  v_mul_f32 v134, 0x3fb8aa3b, v134
  v_exp_f32 v104, v104
  v_exp_f32 v105, v105
  v_exp_f32 v106, v106
  v_exp_f32 v108, v108
  v_exp_f32 v109, v109
  v_exp_f32 v110, v110
  v_exp_f32 v112, v112
  v_exp_f32 v113, v113
  v_exp_f32 v114, v114
  v_exp_f32 v116, v116
  v_exp_f32 v117, v117
  v_exp_f32 v118, v118
  v_exp_f32 v120, v120
  v_exp_f32 v121, v121
  v_exp_f32 v122, v122
  v_exp_f32 v124, v124
  v_exp_f32 v125, v125
  v_exp_f32 v126, v126
  v_exp_f32 v128, v128
  v_exp_f32 v129, v129
  v_exp_f32 v130, v130
  v_exp_f32 v132, v132
  v_exp_f32 v133, v133
  v_exp_f32 v134, v134
  s_nop 0
  v_add_f32 v104, v104, v120
  v_add_f32 v105, v105, v121
  v_add_f32 v106, v106, v122
  v_add_f32 v108, v108, v124
  v_add_f32 v109, v109, v125
  v_add_f32 v110, v110, v126
  v_add_f32 v112, v112, v128
  v_add_f32 v113, v113, v129
  v_add_f32 v114, v114, v130
  v_add_f32 v116, v116, v132
  v_add_f32 v117, v117, v133
  v_add_f32 v118, v118, v134
  v_add_f32 v104, v104, v112
  v_add_f32 v105, v105, v113
  v_add_f32 v106, v106, v114
  v_add_f32 v108, v108, v116
  v_add_f32 v109, v109, v117
  v_add_f32 v110, v110, v118
  v_add_f32 v104, v104, v108
  v_add_f32 v105, v105, v109
  v_add_f32 v106, v106, v110
  v_add_f32 v10, v104, v105
  v_add_f32 v10, v10, v106
  s_nop 1
  v_add_f32_dpp v10, v10, v10 row_ror:8 row_mask:0xf bank_mask:0xf
  s_nop 1
  v_add_f32_dpp v10, v10, v10 row_ror:4 row_mask:0xf bank_mask:0xf
  s_nop 1
  v_add_f32_dpp v10, v10, v10 row_ror:2 row_mask:0xf bank_mask:0xf
  s_nop 1
  v_add_f32_dpp v10, v10, v10 row_ror:1 row_mask:0xf bank_mask:0xf
  v_mov_b32 v11, v10
  s_nop 1
  v_permlane16_swap_b32 v11, v10
  v_add_f32 v10, v10, v11
  v_mov_b32 v11, v10
  s_nop 1
  v_permlane32_swap_b32 v11, v10
  v_add_f32 v10, v10, v11
  v_mov_b32 v9, s74
  v_mov_b32 v11, s74
  s_mov_b64 exec, 1
  s_cmp_eq_u32 s75, 1
  s_cbranch_scc0 L_pf_73
  global_store_dwordx4 v18, v[8:11], s[42:43]
  s_branch L_pe_74
L_pf_73:
  global_store_dwordx4 v18, v[8:11], s[42:43] sc1
L_pe_74:
  s_mov_b64 exec, -1
L_disp3:
  s_mov_b32 s77, 0
  s_bfe_u32 s62, s74, 0x80000
  s_bfe_u32 s63, s74, 0x80008
  s_bfe_u32 s64, s74, 0x80010
  s_bfe_u32 s65, s74, 0x80018
  s_cmp_lg_u32 s5, 1
  s_cbranch_scc1 L_dry_ret
  s_mov_b32 s77, 1
  v_mov_b32 v6, 11008
  v_mov_b32 v14, 11008
  v_mov_b32 v30, 11008
  v_mov_b32 v39, v0
  v_mov_b32 v0, 0
  v_mov_b32 v2, 0
  v_mov_b32 v3, 0
  v_mov_b32 v7, 0
  v_mov_b32 v5, 8440
  s_mov_b64 s[50:51], -1
  s_cmp_eq_u32 s60, 1
  s_cbranch_scc1 L_wo_ok
  s_cmp_eq_u32 s60, 2
  s_cbranch_scc1 L_f1_ok
  s_cmp_eq_u32 s60, 3
  s_cbranch_scc1 L_f2_ok
L_dry_end:
  s_mov_b64 exec, -1
  v_mov_b32 v0, v39
  s_mov_b64 exec, -1
  s_mov_b32 s77, 0
L_dry_ret:
  s_cmp_lg_u32 s5, 2
  s_cbranch_scc1 L_opt_75
  s_mov_b32 s70, 0
L_pl_76:
  ds_read_b32 v8, v38 offset:6656
  s_waitcnt lgkmcnt(0)
  v_cmp_eq_u32 vcc, -1, v8
  s_cmp_eq_u64 vcc, 0
  s_cbranch_scc1 L_pld_77
  s_sleep 32
  s_add_u32 s70, s70, 1
  s_cmp_lt_u32 s70, 1048576
  s_cbranch_scc1 L_pl_76
L_pld_77:
  s_lshl_b32 s56, s6, 2
  s_add_u32 s56, s56, s7
  s_lshl_b32 s57, s56, 9
  s_add_u32 s57, s57, 131072
  v_lshl_add_u32 v3, v1, 3, s57
  global_load_dword v167, v3, s[42:43] sc1
L_opt_75:
  s_cmp_eq_u32 s60, 2
  s_cbranch_scc1 L_pre_f1
  s_cmp_eq_u32 s60, 3
  s_cbranch_scc1 L_pre_f2
  s_cmp_eq_u32 s60, 1
  s_cbranch_scc1 L_pre_wo
  s_lshr_b32 s68, s14, 29
  s_mul_i32 s68, s68, 1
  s_xor_b32 s68, s68, s8
  s_lshl_b32 s68, s68, 3
  s_add_u32 s68, s68, L_gtab-L_pc2
  s_load_dwordx2 s[100:101], s[100:101], s68
  s_waitcnt lgkmcnt(0)
  s_lshr_b32 s68, s14, 26
  s_lshl_b32 s68, s68, 2
  s_add_u32 s68, s68, s5
  s_and_b32 s68, s68, 31
  s_and_b32 s69, s100, 0xffff
  s_lshr_b32 s100, s100, 16
  v_and_b32 v12, 3, v1
  v_lshl_add_u32 v12, v12, 7, s69
  v_min_u32 v12, s100, v12
  v_lshrrev_b32 v13, 2, v1
  v_mul_u32_u24 v13, 2752, v13
  s_mul_i32 s69, s68, 44032
  v_add3_u32 v12, v12, v13, s69
  v_min_u32 v13, 42, v1
  s_mul_i32 s68, s68, 44032
  s_add_u32 s68, s68, s101
  v_lshl_add_u32 v13, v13, 10, s68
  s_branch L_join
L_pre_wo:
  s_mov_b32 s70, 0
L_hs_78:
  ds_read_b32 v9, v38 offset:6720
  s_waitcnt lgkmcnt(0)
  v_cmp_gt_u32 vcc, 8, v9
  s_cmp_eq_u64 vcc, 0
  s_cbranch_scc1 L_hsd_79
  s_sleep 8
  s_add_u32 s70, s70, 1
  s_cmp_lt_u32 s70, 2097152
  s_cbranch_scc1 L_hs_78
L_hsd_79:
  v_lshrrev_b32 v2, 2, v1
  v_bfe_u32 v3, v1, 1, 1
  s_lshl_b32 s49, s5, 1
  v_or_b32 v3, s49, v3
  v_and_b32 v10, 6, v2
  v_xor_b32 v3, v3, v10
  v_lshlrev_b32 v2, 7, v2
  v_lshl_add_u32 v2, v3, 4, v2
  v_and_b32 v3, 1, v1
  v_lshl_add_u32 v2, v3, 3, v2
  v_add_u32 v2, 20480, v2
  s_add_u32 s49, s5, 0
  s_and_b32 s49, s49, 3
  s_mul_i32 s49, s49, 16384
  v_add_u32 v3, s49, v2
  ds_read_b64_tr_b16 v[40:41], v3 offset:0
  ds_read_b64_tr_b16 v[42:43], v3 offset:2048
  ds_read_b64_tr_b16 v[44:45], v3 offset:4096
  ds_read_b64_tr_b16 v[46:47], v3 offset:6144
  ds_read_b64_tr_b16 v[48:49], v3 offset:8192
  ds_read_b64_tr_b16 v[50:51], v3 offset:10240
  ds_read_b64_tr_b16 v[52:53], v3 offset:12288
  ds_read_b64_tr_b16 v[54:55], v3 offset:14336
  s_add_u32 s49, s5, 1
  s_and_b32 s49, s49, 3
  s_mul_i32 s49, s49, 16384
  v_add_u32 v3, s49, v2
  ds_read_b64_tr_b16 v[56:57], v3 offset:0
  ds_read_b64_tr_b16 v[58:59], v3 offset:2048
  ds_read_b64_tr_b16 v[60:61], v3 offset:4096
  ds_read_b64_tr_b16 v[62:63], v3 offset:6144
  s_waitcnt lgkmcnt(10)
  ds_read_b64_tr_b16 v[64:65], v3 offset:8192
  ds_read_b64_tr_b16 v[66:67], v3 offset:10240
  s_waitcnt lgkmcnt(10)
  ds_read_b64_tr_b16 v[68:69], v3 offset:12288
  ds_read_b64_tr_b16 v[70:71], v3 offset:14336
  s_waitcnt lgkmcnt(10)
  s_add_u32 s49, s5, 2
  s_and_b32 s49, s49, 3
  s_mul_i32 s49, s49, 16384
  v_add_u32 v3, s49, v2
  ds_read_b64_tr_b16 v[72:73], v3 offset:0
  ds_read_b64_tr_b16 v[74:75], v3 offset:2048
  s_waitcnt lgkmcnt(10)
  ds_read_b64_tr_b16 v[76:77], v3 offset:4096
  ds_read_b64_tr_b16 v[78:79], v3 offset:6144
  s_waitcnt lgkmcnt(10)
  ds_read_b64_tr_b16 v[80:81], v3 offset:8192
  ds_read_b64_tr_b16 v[82:83], v3 offset:10240
  s_waitcnt lgkmcnt(10)
  ds_read_b64_tr_b16 v[84:85], v3 offset:12288
  ds_read_b64_tr_b16 v[86:87], v3 offset:14336
  s_waitcnt lgkmcnt(10)
  s_add_u32 s49, s5, 3
  s_and_b32 s49, s49, 3
  s_mul_i32 s49, s49, 16384
  v_add_u32 v3, s49, v2
  ds_read_b64_tr_b16 v[88:89], v3 offset:0
  ds_read_b64_tr_b16 v[90:91], v3 offset:2048
  s_waitcnt lgkmcnt(10)
  ds_read_b64_tr_b16 v[92:93], v3 offset:4096
  ds_read_b64_tr_b16 v[94:95], v3 offset:6144
  s_waitcnt lgkmcnt(10)
  ds_read_b64_tr_b16 v[96:97], v3 offset:8192
  ds_read_b64_tr_b16 v[98:99], v3 offset:10240
  s_waitcnt lgkmcnt(10)
  ds_read_b64_tr_b16 v[100:101], v3 offset:12288
  ds_read_b64_tr_b16 v[102:103], v3 offset:14336
  s_waitcnt lgkmcnt(10)
  s_waitcnt lgkmcnt(0)
  s_lshl_b32 s49, s5, 3
  s_add_u32 s49, s49, s66
  s_lshl_b32 s50, s49, 9
  s_add_u32 s50, s50, 65536
  v_lshrrev_b32 v12, 5, v1
  v_lshl_add_u32 v15, v12, 14, s50
  v_and_b32 v16, 3, v1
  v_lshl_add_u32 v15, v16, 7, v15
  s_mov_b32 s70, 0
L_pl_80:
  ds_read_b32 v8, v38 offset:6676
  s_waitcnt lgkmcnt(0)
  v_cmp_eq_u32 vcc, -1, v8
  s_cmp_eq_u64 vcc, 0
  s_cbranch_scc1 L_pld_81
  s_sleep 16
  s_add_u32 s70, s70, 1
  s_cmp_lt_u32 s70, 1048576
  s_cbranch_scc1 L_pl_80
L_pld_81:
  s_mov_b32 s70, 0
L_polt_82:
  global_load_dwordx4 v[16:19], v15, s[42:43] sc1
  s_waitcnt vmcnt(0)
  v_cmp_ne_u32 vcc, s74, v17
  v_cmp_ne_u32 s[68:69], s74, v19
  s_or_b64 vcc, vcc, s[68:69]
  s_cmp_eq_u64 vcc, 0
  s_cbranch_scc1 L_poltd_83
  s_sleep 8
  s_add_u32 s70, s70, 1
  s_cmp_lt_u32 s70, 262144
  s_cbranch_scc1 L_polt_82
L_poltd_83:
  v_max_f32_dpp v10, v16, v16 quad_perm:[1,0,3,2] row_mask:0xf bank_mask:0xf
  s_nop 1
  v_max_f32_dpp v10, v10, v10 quad_perm:[2,3,0,1] row_mask:0xf bank_mask:0xf
  v_sub_f32 v8, v16, v10
  v_mul_f32 v8, 0x3fb8aa3b, v8
  v_exp_f32 v8, v8
  s_nop 0
  v_mul_f32 v9, v18, v8
  s_nop 1
  v_add_f32_dpp v9, v9, v9 quad_perm:[1,0,3,2] row_mask:0xf bank_mask:0xf
  s_nop 1
  v_add_f32_dpp v9, v9, v9 quad_perm:[2,3,0,1] row_mask:0xf bank_mask:0xf
  v_rcp_f32 v9, v9
  s_nop 0
  v_mul_f32 v8, v8, v9
  s_nop 1
  v_mov_b32_dpp v20, v8 quad_perm:[0,0,0,0] row_mask:0xf bank_mask:0xf
  v_mov_b32_dpp v21, v8 quad_perm:[1,1,1,1] row_mask:0xf bank_mask:0xf
  v_mov_b32_dpp v22, v8 quad_perm:[2,2,2,2] row_mask:0xf bank_mask:0xf
  v_mov_b32_dpp v23, v8 quad_perm:[3,3,3,3] row_mask:0xf bank_mask:0xf
  s_lshl_b32 s49, s49, 11
  s_add_u32 s49, s49, 131072
  v_lshrrev_b32 v12, 5, v1
  v_and_b32 v16, 31, v1
  v_lshlrev_b32 v15, 16, v12
  v_lshl_add_u32 v15, v16, 4, v15
  v_add_u32 v15, s49, v15
  v_mul_u32_u24 v12, 1056, v12
  v_bfe_u32 v16, v1, 3, 2
  v_lshl_add_u32 v12, v16, 6, v12
  v_and_b32 v16, 3, v1
  v_lshl_add_u32 v12, v16, 4, v12
  v_bfe_u32 v16, v1, 2, 1
  v_lshl_add_u32 v12, v16, 3, v12
  s_lshl_b32 s49, s5, 8
  v_add_u32 v12, s49, v12
  v_and_b32 v14, 1, v1
  v_mul_u32_u24 v14, 1056, v14
  v_lshrrev_b32 v3, 4, v1
  v_lshl_add_u32 v14, v3, 4, v14
  v_and_b32 v13, 1, v1
  v_lshlrev_b32 v13, 6, v13
  v_lshrrev_b32 v3, 4, v1
  v_lshl_add_u32 v13, v3, 4, v13
  s_lshl_b32 s49, s5, 7
  s_add_u32 s49, s49, s58
  v_add_u32 v13, s49, v13
  v_add_u32 v37, 0x2000, v13
  v_mov_b32 v36, 0xff
  s_add_u32 s49, s5, 1
  s_and_b32 s49, s49, 3
  s_lshl_b32 s49, s49, 8
  v_add_u32 v0, s49, v14
  s_add_u32 s49, s5, 2
  s_and_b32 s49, s49, 3
  s_lshl_b32 s49, s49, 8
  v_add_u32 v2, s49, v14
  s_add_u32 s49, s5, 3
  s_and_b32 s49, s49, 3
  s_lshl_b32 s49, s49, 8
  v_add_u32 v3, s49, v14
  s_add_u32 s49, s5, 0
  s_and_b32 s49, s49, 3
  s_lshl_b32 s49, s49, 8
  v_add_u32 v14, s49, v14
  s_branch L_join
L_pre_f1:
  s_cmp_lg_u32 s5, 3
  s_cbranch_scc1 L_hc_84
  s_mov_b32 s70, 0
L_pl_85:
  ds_read_b32 v8, v38 offset:6400
  s_waitcnt lgkmcnt(0)
  v_cmp_eq_u32 vcc, -1, v8
  s_cmp_eq_u64 vcc, 0
  s_cbranch_scc1 L_pld_86
  s_sleep 32
  s_add_u32 s70, s70, 1
  s_cmp_lt_u32 s70, 1048576
  s_cbranch_scc1 L_pl_85
L_pld_86:
  v_lshlrev_b32 v110, 5, v1
  global_load_dword v109, v110, s[42:43] offset:1028 sc1
  s_waitcnt vmcnt(0)
  v_subrev_u32 v109, s74, v109
  v_cmp_eq_u32 vcc, 1, v109
  s_bcnt1_i32_b64 s70, vcc
  v_cmp_eq_u32 vcc, 0, v109
  s_bcnt1_i32_b64 s71, vcc
  s_cmp_gt_u32 s70, s71
  s_cselect_b32 s71, 4, 0
  s_sub_u32 s68, s76, s74
  s_xor_b32 s71, s71, s68
  s_and_b32 s71, s71, 4
  s_lshl_b32 s71, s71, 11
  v_mov_b32 v104, s71
  ds_write_b32 v38, v104 offset:6668
L_hc_84:
  v_mov_b32 v31, v13
  v_lshlrev_b32 v15, 4, v0
  v_add_u32 v24, 12288, v15
  v_add_u32 v25, 16384, v15
  v_add_u32 v26, 20480, v15
  s_mov_b32 s70, 0
L_pl_87:
  ds_read_b32 v11, v38 offset:6668
  s_waitcnt lgkmcnt(0)
  v_cmp_eq_u32 vcc, -1, v11
  s_cmp_eq_u64 vcc, 0
  s_cbranch_scc1 L_pld_88
  s_sleep 8
  s_add_u32 s70, s70, 1
  s_cmp_lt_u32 s70, 1048576
  s_cbranch_scc1 L_pl_87
L_pld_88:
  v_add_u32 v15, 327680, v15
  v_add_u32 v15, v11, v15
  v_add_u32 v35, 4096, v15
  v_add_u32 v32, 16384, v15
  v_add_u32 v36, 20480, v15
  v_add_u32 v33, 32768, v15
  v_add_u32 v37, 36864, v15
  v_add_u32 v34, 49152, v15
  v_add_u32 v39, 53248, v15
  v_bfe_u32 v5, v1, 2, 1
  v_mul_u32_u24 v5, 1056, v5
  v_lshrrev_b32 v3, 3, v0
  v_lshl_add_u32 v5, v3, 5, v5
  v_and_b32 v3, 3, v1
  v_lshl_add_u32 v5, v3, 3, v5
  v_and_b32 v14, 7, v1
  v_mul_u32_u24 v14, 1056, v14
  v_lshrrev_b32 v3, 4, v1
  v_lshl_add_u32 v14, v3, 4, v14
  v_and_b32 v7, 1, v1
  v_mul_u32_u24 v7, 1056, v7
  v_lshrrev_b32 v3, 1, v1
  v_lshl_add_u32 v7, v3, 5, v7
  v_and_b32 v13, 3, v1
  v_lshlrev_b32 v13, 5, v13
  v_bfe_u32 v3, v1, 4, 1
  v_lshl_add_u32 v13, v3, 3, v13
  s_lshl_b32 s49, s5, 7
  s_add_u32 s49, s49, s58
  v_add_u32 v13, s49, v13
  v_lshrrev_b32 v3, 5, v1
  v_lshl_add_u32 v13, v3, 4, v13
  v_add_u32 v4, 0x2000, v13
  s_and_b32 s54, s61, 1
  s_mul_i32 s52, s54, -2
  s_add_u32 s52, s52, 1
  s_mul_i32 s53, s52, 16384
  s_sub_u32 s53, s53, 8192
  s_mul_i32 s52, s52, 2752
  s_sub_u32 s52, s52, 704512
  v_lshrrev_b32 v2, 2, v1
  v_mul_u32_u24 v2, 5504, v2
  s_and_b32 s49, s5, 2
  s_or_b32 s49, s49, s54
  v_xor_b32 v3, s49, v1
  v_and_b32 v3, 3, v3
  v_lshl_add_u32 v2, v3, 4, v2
  v_mov_b32 v0, v2
  v_lshrrev_b32 v6, 3, v1
  v_lshlrev_b32 v6, 6, v6
  v_bfe_u32 v3, v1, 2, 1
  v_lshl_add_u32 v6, v3, 14, v6
  v_and_b32 v8, 2, v1
  v_or_b32 v3, v3, v8
  v_xor_b32 v3, s5, v3
  v_lshl_add_u32 v6, v3, 4, v6
  v_lshl_add_u32 v6, v8, 14, v6
  v_and_b32 v3, 1, v1
  v_lshl_add_u32 v6, v3, 3, v6
  v_add_u32 v6, 20480, v6
  s_and_b32 s55, s5, 1
  s_mul_i32 s49, s55, 704512
  s_add_u32 s49, s49, s48
  s_mul_i32 s50, s54, 2752
  s_add_u32 s49, s49, s50
  s_lshr_b32 s50, s5, 1
  s_lshl_b32 s50, s50, 15
  s_lshl_b32 s54, s54, 14
  s_add_u32 s50, s50, s54
  s_lshl_b32 s55, s55, 13
  s_add_u32 s50, s50, s55
  s_add_u32 s50, s50, 20480
  s_mov_b32 s70, 0
L_pl_89:
  ds_read_b32 v8, v38 offset:6676
  s_waitcnt lgkmcnt(0)
  v_cmp_eq_u32 vcc, -1, v8
  s_cmp_eq_u64 vcc, 0
  s_cbranch_scc1 L_pld_90
  s_sleep 16
  s_add_u32 s70, s70, 1
  s_cmp_lt_u32 s70, 1048576
  s_cbranch_scc1 L_pl_89
L_pld_90:
  global_load_dwordx2 v[8:9], v31, s[16:17]
  s_mov_b32 s70, 0
L_polt_91:
  global_load_dwordx4 v[136:139], v24, s[42:43] sc1
  global_load_dwordx4 v[140:143], v25, s[42:43] sc1
  global_load_dwordx4 v[144:147], v26, s[42:43] sc1
  s_waitcnt vmcnt(0)
  v_cmp_ne_u32 vcc, s74, v137
  v_cmp_ne_u32 s[68:69], s74, v139
  s_or_b64 vcc, vcc, s[68:69]
  v_cmp_ne_u32 s[68:69], s74, v141
  s_or_b64 vcc, vcc, s[68:69]
  v_cmp_ne_u32 s[68:69], s74, v143
  s_or_b64 vcc, vcc, s[68:69]
  v_cmp_ne_u32 s[68:69], s74, v145
  s_or_b64 vcc, vcc, s[68:69]
  v_cmp_ne_u32 s[68:69], s74, v147
  s_or_b64 vcc, vcc, s[68:69]
  s_cmp_eq_u64 vcc, 0
  s_cbranch_scc1 L_poltd_92
  s_sleep 8
  s_add_u32 s70, s70, 1
  s_cmp_lt_u32 s70, 262144
  s_cbranch_scc1 L_polt_91
L_poltd_92:
  v_lshlrev_b32 v16, 16, v8
  v_and_b32 v17, s73, v8
  v_lshlrev_b32 v18, 16, v9
  v_and_b32 v19, s73, v9
  v_lshlrev_b32 v20, 16, v136
  v_and_b32 v21, s73, v136
  v_lshlrev_b32 v22, 16, v138
  v_and_b32 v23, s73, v138
  v_lshlrev_b32 v28, 16, v144
  v_and_b32 v29, s73, v144
  v_lshlrev_b32 v30, 16, v146
  v_and_b32 v31, s73, v146
  v_add_f32 v28, 1.0, v28
  v_add_f32 v29, 1.0, v29
  v_add_f32 v30, 1.0, v30
  v_add_f32 v31, 1.0, v31
  v_cvt_pk_bf16_f32 v8, v28, v29
  v_cvt_pk_bf16_f32 v9, v30, v31
  v_mov_b32 v141, v142
  ds_write_b64 v12, v[8:9] offset:2112
  ds_write_b64 v12, v[140:141] offset:4224
  v_cvt_pk_bf16_f32 v28, 0, v28
  v_cvt_pk_bf16_f32 v29, 0, v29
  v_cvt_pk_bf16_f32 v30, 0, v30
  v_cvt_pk_bf16_f32 v31, 0, v31
  v_mul_f32 v24, v20, v28
  v_mul_f32 v25, v21, v29
  v_mul_f32 v26, v22, v30
  v_mul_f32 v27, v23, v31
  v_mul_f32 v28, v16, v28
  v_mul_f32 v29, v17, v29
  v_mul_f32 v30, v18, v30
  v_mul_f32 v31, v19, v31
  s_branch L_join
L_pre_f2:
  s_cmp_lg_u32 s5, 3
  s_cbranch_scc1 L_hc_93
  s_mov_b32 s70, 0
L_pl_94:
  ds_read_b32 v8, v38 offset:6400
  s_waitcnt lgkmcnt(0)
  v_cmp_eq_u32 vcc, -1, v8
  s_cmp_eq_u64 vcc, 0
  s_cbranch_scc1 L_pld_95
  s_sleep 32
  s_add_u32 s70, s70, 1
  s_cmp_lt_u32 s70, 1048576
  s_cbranch_scc1 L_pl_94
L_pld_95:
  v_lshlrev_b32 v110, 5, v1
  global_load_dword v109, v110, s[42:43] offset:1028 sc1
  s_waitcnt vmcnt(0)
  v_subrev_u32 v109, s74, v109
  v_cmp_eq_u32 vcc, 1, v109
  s_bcnt1_i32_b64 s70, vcc
  v_cmp_eq_u32 vcc, 0, v109
  s_bcnt1_i32_b64 s71, vcc
  s_cmp_gt_u32 s70, s71
  s_cselect_b32 s71, 4, 0
  s_sub_u32 s68, s76, s74
  s_xor_b32 s71, s71, s68
  s_and_b32 s71, s71, 4
  s_lshl_b32 s71, s71, 11
  v_mov_b32 v104, s71
  ds_write_b32 v38, v104 offset:6668
L_hc_93:
  v_and_b32 v12, 1, v1
  v_lshrrev_b32 v14, 4, v1
  s_lshl_b32 s49, s61, 5
  v_lshl_add_u32 v3, v14, 3, s49
  v_lshl_add_u32 v13, v12, 10, v3
  v_mov_b32 v31, v13
  v_lshlrev_b32 v15, 6, v12
  v_lshl_add_u32 v15, v14, 4, v15
  s_lshl_b32 s49, s61, 7
  v_add_u32 v15, s49, v15
  v_add_u32 v24, 12288, v15
  v_add_u32 v25, 24576, v15
  s_mov_b32 s70, 0
L_pl_96:
  ds_read_b32 v11, v38 offset:6668
  s_waitcnt lgkmcnt(0)
  v_cmp_eq_u32 vcc, -1, v11
  s_cmp_eq_u64 vcc, 0
  s_cbranch_scc1 L_pld_97
  s_sleep 8
  s_add_u32 s70, s70, 1
  s_cmp_lt_u32 s70, 1048576
  s_cbranch_scc1 L_pl_96
L_pld_97:
  v_add_u32 v15, 327680, v15
  v_add_u32 v15, v11, v15
  v_add_u32 v35, 4096, v15
  v_add_u32 v32, 16384, v15
  v_add_u32 v36, 20480, v15
  v_add_u32 v33, 32768, v15
  v_add_u32 v37, 36864, v15
  v_add_u32 v34, 49152, v15
  v_add_u32 v39, 53248, v15
  s_lshl_b32 s49, s5, 14
  s_add_u32 s49, s49, 264192
  v_lshl_add_u32 v28, v14, 7, s49
  v_add_u32 v28, v11, v28
  v_lshl_add_u32 v28, v12, 5, v28
  v_and_b32 v3, 2, v1
  v_lshl_add_u32 v28, v3, 3, v28
  v_bfe_u32 v3, v1, 2, 2
  v_lshl_add_u32 v28, v3, 9, v28
  v_lshl_add_u32 v12, v14, 1, v12
  v_lshlrev_b32 v12, 4, v12
  v_add_u32 v12, 11008, v12
  s_lshl_b32 s49, s5, 7
  v_add_u32 v30, s49, v12
  v_lshrrev_b32 v2, 1, v1
  v_lshlrev_b32 v2, 10, v2
  v_and_b32 v3, 1, v1
  v_lshl_add_u32 v2, v3, 4, v2
  v_mov_b32 v29, v2
  v_lshlrev_b32 v6, 8, v14
  v_bfe_u32 v3, v1, 2, 2
  v_lshl_add_u32 v6, v3, 5, v6
  v_and_b32 v3, 3, v1
  v_lshl_add_u32 v6, v3, 3, v6
  s_mul_i32 s49, s5, 11264
  s_add_u32 s49, s49, 20480
  v_add_u32 v6, s49, v6
  s_mov_b32 s70, 0
L_pl_98:
  ds_read_b32 v8, v38 offset:6676
  s_waitcnt lgkmcnt(0)
  v_cmp_eq_u32 vcc, -1, v8
  s_cmp_eq_u64 vcc, 0
  s_cbranch_scc1 L_pld_99
  s_sleep 16
  s_add_u32 s70, s70, 1
  s_cmp_lt_u32 s70, 1048576
  s_cbranch_scc1 L_pl_98
L_pld_99:
  global_load_dwordx2 v[8:9], v31, s[16:17]
  s_mov_b32 s70, 0
L_polt_100:
  global_load_dwordx4 v[136:139], v24, s[42:43] sc1
  global_load_dwordx4 v[140:143], v25, s[42:43] sc1
  s_waitcnt vmcnt(0)
  v_cmp_ne_u32 vcc, s74, v137
  v_cmp_ne_u32 s[68:69], s74, v139
  s_or_b64 vcc, vcc, s[68:69]
  v_cmp_ne_u32 s[68:69], s74, v141
  s_or_b64 vcc, vcc, s[68:69]
  v_cmp_ne_u32 s[68:69], s74, v143
  s_or_b64 vcc, vcc, s[68:69]
  s_cmp_eq_u64 vcc, 0
  s_cbranch_scc1 L_poltd_101
  s_sleep 8
  s_add_u32 s70, s70, 1
  s_cmp_lt_u32 s70, 262144
  s_cbranch_scc1 L_polt_100
L_poltd_101:
  v_lshlrev_b32 v16, 16, v8
  v_and_b32 v17, s73, v8
  v_lshlrev_b32 v18, 16, v9
  v_and_b32 v19, s73, v9
  v_lshlrev_b32 v20, 16, v136
  v_and_b32 v21, s73, v136
  v_lshlrev_b32 v22, 16, v138
  v_and_b32 v23, s73, v138
  v_lshlrev_b32 v24, 16, v140
  v_and_b32 v25, s73, v140
  v_lshlrev_b32 v26, 16, v142
  v_and_b32 v27, s73, v142
L_join:
  s_waitcnt vmcnt(0) lgkmcnt(0)
  s_barrier
  s_cmp_eq_u32 s60, 1
  s_cbranch_scc1 L_t_wo
  s_cmp_eq_u32 s60, 2
  s_cbranch_scc1 L_t_f1
  s_cmp_eq_u32 s60, 3
  s_cbranch_scc1 L_t_f2
  global_load_dword v16, v12, s[28:29]
  global_load_dword v17, v12, s[30:31]
  global_load_dword v18, v13, s[32:33]
  s_branch L_fin
L_t_wo:
  s_mov_b32 s70, 0
L_wo_p:
  global_load_dwordx4 v[104:107], v15, s[42:43] offset:0 sc1
  global_load_dwordx4 v[108:111], v15, s[42:43] offset:512 sc1
  global_load_dwordx4 v[112:115], v15, s[42:43] offset:1024 sc1
  global_load_dwordx4 v[116:119], v15, s[42:43] offset:1536 sc1
  s_waitcnt vmcnt(3)
  v_xor_b32 v104, s62, v104
  v_xor_b32 v105, s63, v105
  v_xor_b32 v106, s64, v106
  v_xor_b32 v107, s65, v107
  s_waitcnt vmcnt(2)
  v_xor_b32 v108, s62, v108
  v_xor_b32 v109, s63, v109
  v_xor_b32 v110, s64, v110
  v_xor_b32 v111, s65, v111
  s_waitcnt vmcnt(1)
  v_xor_b32 v112, s62, v112
  v_xor_b32 v113, s63, v113
  v_xor_b32 v114, s64, v114
  v_xor_b32 v115, s65, v115
  s_waitcnt vmcnt(0)
  v_xor_b32 v116, s62, v116
  v_xor_b32 v117, s63, v117
  v_xor_b32 v118, s64, v118
  v_xor_b32 v119, s65, v119
  v_or3_b32 v28, v104, v105, v106
  v_or3_b32 v29, v107, v108, v109
  v_or3_b32 v30, v110, v111, v112
  v_or3_b32 v31, v113, v114, v115
  v_or3_b32 v28, v28, v29, v30
  v_or3_b32 v31, v31, v116, v117
  v_or3_b32 v28, v28, v118, v119
  v_or_b32 v28, v28, v31
  v_lshlrev_b32 v28, 24, v28
  v_cmp_ne_u32 vcc, 0, v28
  v_pk_mul_f32 v[16:17], v[104:105], v[20:21] op_sel:[0,0] op_sel_hi:[1,0]
  v_pk_mul_f32 v[18:19], v[106:107], v[20:21] op_sel:[0,0] op_sel_hi:[1,0]
  v_pk_fma_f32 v[16:17], v[108:109], v[20:21], v[16:17] op_sel:[0,1,0] op_sel_hi:[1,1,1]
  v_pk_fma_f32 v[18:19], v[110:111], v[20:21], v[18:19] op_sel:[0,1,0] op_sel_hi:[1,1,1]
  v_pk_fma_f32 v[16:17], v[112:113], v[22:23], v[16:17] op_sel:[0,0,0] op_sel_hi:[1,0,1]
  v_pk_fma_f32 v[18:19], v[114:115], v[22:23], v[18:19] op_sel:[0,0,0] op_sel_hi:[1,0,1]
  v_pk_fma_f32 v[16:17], v[116:117], v[22:23], v[16:17] op_sel:[0,1,0] op_sel_hi:[1,1,1]
  v_pk_fma_f32 v[18:19], v[118:119], v[22:23], v[18:19] op_sel:[0,1,0] op_sel_hi:[1,1,1]
  s_cmp_eq_u64 vcc, 0
  s_cbranch_scc1 L_wo_ok
  s_add_u32 s70, s70, 1
  s_cmp_lt_u32 s70, 262144
  s_cbranch_scc1 L_wo_p
L_wo_ok:
  v_cvt_pk_bf16_f32 v16, v16, v17
  v_cvt_pk_bf16_f32 v17, v18, v19
  ds_write_b64 v12, v[16:17] offset:0
  ds_read_b128 v[104:107], v14 offset:0
  ds_read_b128 v[108:111], v14 offset:64
  ds_read_b128 v[112:115], v14 offset:128
  ds_read_b128 v[116:119], v14 offset:192
  s_waitcnt lgkmcnt(4)
  s_cmp_eq_u32 s77, 1
  s_cbranch_scc1 L_nb_102
  s_barrier
L_nb_102:
  ds_read_b128 v[120:123], v0 offset:0
  ds_read_b128 v[124:127], v0 offset:64
  ds_read_b128 v[128:131], v0 offset:128
  ds_read_b128 v[132:135], v0 offset:192
  s_waitcnt lgkmcnt(4)
  v_mfma_f32_16x16x32_bf16 v[8:11], v[40:43], v[104:107], 0
  ds_read_b128 v[136:139], v2 offset:0
  ds_read_b128 v[140:143], v2 offset:64
  v_mfma_f32_16x16x32_bf16 v[8:11], v[44:47], v[108:111], v[8:11]
  ds_read_b128 v[144:147], v2 offset:128
  ds_read_b128 v[148:151], v2 offset:192
  v_mfma_f32_16x16x32_bf16 v[8:11], v[48:51], v[112:115], v[8:11]
  ds_read_b128 v[152:155], v3 offset:0
  ds_read_b128 v[156:159], v3 offset:64
  v_mfma_f32_16x16x32_bf16 v[8:11], v[52:55], v[116:119], v[8:11]
  ds_read_b128 v[160:163], v3 offset:128
  ds_read_b128 v[164:167], v3 offset:192
  s_waitcnt lgkmcnt(11)
  v_mfma_f32_16x16x32_bf16 v[8:11], v[56:59], v[120:123], v[8:11]
  s_waitcnt lgkmcnt(10)
  v_mfma_f32_16x16x32_bf16 v[8:11], v[60:63], v[124:127], v[8:11]
  s_waitcnt lgkmcnt(9)
  v_mfma_f32_16x16x32_bf16 v[8:11], v[64:67], v[128:131], v[8:11]
  s_waitcnt lgkmcnt(8)
  v_mfma_f32_16x16x32_bf16 v[8:11], v[68:71], v[132:135], v[8:11]
  s_waitcnt lgkmcnt(7)
  v_mfma_f32_16x16x32_bf16 v[8:11], v[72:75], v[136:139], v[8:11]
  s_waitcnt lgkmcnt(6)
  v_mfma_f32_16x16x32_bf16 v[8:11], v[76:79], v[140:143], v[8:11]
  s_waitcnt lgkmcnt(5)
  v_mfma_f32_16x16x32_bf16 v[8:11], v[80:83], v[144:147], v[8:11]
  s_waitcnt lgkmcnt(4)
  v_mfma_f32_16x16x32_bf16 v[8:11], v[84:87], v[148:151], v[8:11]
  s_waitcnt lgkmcnt(3)
  v_mfma_f32_16x16x32_bf16 v[8:11], v[88:91], v[152:155], v[8:11]
  s_waitcnt lgkmcnt(2)
  v_mfma_f32_16x16x32_bf16 v[8:11], v[92:95], v[156:159], v[8:11]
  s_waitcnt lgkmcnt(1)
  v_mfma_f32_16x16x32_bf16 v[8:11], v[96:99], v[160:163], v[8:11]
  s_waitcnt lgkmcnt(0)
  v_mfma_f32_16x16x32_bf16 v[8:11], v[100:103], v[164:167], v[8:11]
  s_nop 3
  s_cmp_eq_u32 s77, 1
  s_cbranch_scc1 L_dry_end
  s_mov_b32 exec_lo, 0x00030003
  s_mov_b32 exec_hi, 0x00030003
  v_bfi_b32 v8, v36, s62, v8
  v_bfi_b32 v9, v36, s63, v9
  v_bfi_b32 v10, v36, s64, v10
  v_bfi_b32 v11, v36, s65, v11
  global_store_dwordx4 v13, v[8:11], s[42:43] sc1
  global_store_dwordx4 v37, v[8:11], s[42:43] sc1
  s_branch L_fin
L_t_f1:
  v_mov_b32 v2, v0
  s_add_u32 s51, s50, 8192
L_dma_103:
  s_mov_b32 m0, s50
  s_add_u32 s50, s50, 1024
  buffer_load_dwordx4 v2, s[44:47], s49 offen  lds
  s_add_u32 s49, s49, 88064
  s_cmp_lt_u32 s50, s51
  s_cbranch_scc1 L_dma_103
L_dmae_104:
  v_xor_b32 v2, 16, v2
  s_add_u32 s49, s49, s52
  s_add_u32 s50, s50, s53
  s_add_u32 s51, s50, 8192
L_dma_105:
  s_mov_b32 m0, s50
  s_add_u32 s50, s50, 1024
  buffer_load_dwordx4 v2, s[44:47], s49 offen  lds
  s_add_u32 s49, s49, 88064
  s_cmp_lt_u32 s50, s51
  s_cbranch_scc1 L_dma_105
L_dmae_106:
  v_mov_b32 v2, v6
  s_waitcnt vmcnt(0)
  s_barrier
  global_load_dwordx4 v[104:107], v15, s[42:43] sc1
  global_load_dwordx4 v[108:111], v35, s[42:43] sc1
  global_load_dwordx4 v[112:115], v32, s[42:43] sc1
  global_load_dwordx4 v[116:119], v36, s[42:43] sc1
  global_load_dwordx4 v[120:123], v33, s[42:43] sc1
  global_load_dwordx4 v[124:127], v37, s[42:43] sc1
  global_load_dwordx4 v[128:131], v34, s[42:43] sc1
  global_load_dwordx4 v[132:135], v39, s[42:43] sc1
  s_add_u32 s49, s5, 0
  s_and_b32 s49, s49, 3
  s_mul_i32 s49, s49, 4096
  v_add_u32 v3, s49, v2
  ds_read_b64_tr_b16 v[40:41], v3 offset:0
  ds_read_b64_tr_b16 v[42:43], v3 offset:512
  ds_read_b64_tr_b16 v[44:45], v3 offset:1024
  ds_read_b64_tr_b16 v[46:47], v3 offset:1536
  ds_read_b64_tr_b16 v[48:49], v3 offset:2048
  ds_read_b64_tr_b16 v[50:51], v3 offset:2560
  ds_read_b64_tr_b16 v[52:53], v3 offset:3072
  ds_read_b64_tr_b16 v[54:55], v3 offset:3584
  s_add_u32 s49, s5, 1
  s_and_b32 s49, s49, 3
  s_mul_i32 s49, s49, 4096
  v_add_u32 v3, s49, v2
  ds_read_b64_tr_b16 v[56:57], v3 offset:0
  ds_read_b64_tr_b16 v[58:59], v3 offset:512
  ds_read_b64_tr_b16 v[60:61], v3 offset:1024
  ds_read_b64_tr_b16 v[62:63], v3 offset:1536
  s_waitcnt lgkmcnt(10)
  ds_read_b64_tr_b16 v[64:65], v3 offset:2048
  ds_read_b64_tr_b16 v[66:67], v3 offset:2560
  s_waitcnt lgkmcnt(10)
  ds_read_b64_tr_b16 v[68:69], v3 offset:3072
  ds_read_b64_tr_b16 v[70:71], v3 offset:3584
  s_waitcnt lgkmcnt(10)
  s_add_u32 s49, s5, 2
  s_and_b32 s49, s49, 3
  s_mul_i32 s49, s49, 4096
  v_add_u32 v3, s49, v2
  ds_read_b64_tr_b16 v[72:73], v3 offset:0
  ds_read_b64_tr_b16 v[74:75], v3 offset:512
  s_waitcnt lgkmcnt(10)
  ds_read_b64_tr_b16 v[76:77], v3 offset:1024
  ds_read_b64_tr_b16 v[78:79], v3 offset:1536
  s_waitcnt lgkmcnt(10)
  ds_read_b64_tr_b16 v[80:81], v3 offset:2048
  ds_read_b64_tr_b16 v[82:83], v3 offset:2560
  s_waitcnt lgkmcnt(10)
  ds_read_b64_tr_b16 v[84:85], v3 offset:3072
  ds_read_b64_tr_b16 v[86:87], v3 offset:3584
  s_waitcnt lgkmcnt(10)
  s_add_u32 s49, s5, 3
  s_and_b32 s49, s49, 3
  s_mul_i32 s49, s49, 4096
  v_add_u32 v3, s49, v2
  ds_read_b64_tr_b16 v[88:89], v3 offset:0
  ds_read_b64_tr_b16 v[90:91], v3 offset:512
  s_waitcnt lgkmcnt(10)
  ds_read_b64_tr_b16 v[92:93], v3 offset:1024
  ds_read_b64_tr_b16 v[94:95], v3 offset:1536
  s_waitcnt lgkmcnt(10)
  ds_read_b64_tr_b16 v[96:97], v3 offset:2048
  ds_read_b64_tr_b16 v[98:99], v3 offset:2560
  s_waitcnt lgkmcnt(10)
  ds_read_b64_tr_b16 v[100:101], v3 offset:3072
  ds_read_b64_tr_b16 v[102:103], v3 offset:3584
  s_waitcnt lgkmcnt(10)
  s_waitcnt lgkmcnt(0)
  s_add_u32 s49, s5, 1
  s_and_b32 s49, s49, 3
  s_lshl_b32 s49, s49, 8
  v_add_u32 v0, s49, v14
  s_add_u32 s49, s5, 2
  s_and_b32 s49, s49, 3
  s_lshl_b32 s49, s49, 8
  v_add_u32 v2, s49, v14
  s_add_u32 s49, s5, 3
  s_and_b32 s49, s49, 3
  s_lshl_b32 s49, s49, 8
  v_add_u32 v3, s49, v14
  s_add_u32 s49, s5, 0
  s_and_b32 s49, s49, 3
  s_lshl_b32 s49, s49, 8
  v_add_u32 v14, s49, v14
  s_mov_b32 s70, 0
  s_mov_b32 s71, 15
  s_branch L_f1_c
L_f1_p:
  s_add_u32 s70, s70, 1
  s_cmp_ge_u32 s70, 262144
  s_cbranch_scc1 L_f1_ok
  s_bitcmp1_b32 s71, 0
  s_cbranch_scc0 L_fl_107
  global_load_dwordx4 v[104:107], v15, s[42:43] sc1
  global_load_dwordx4 v[108:111], v35, s[42:43] sc1
L_fl_107:
  s_bitcmp1_b32 s71, 1
  s_cbranch_scc0 L_fl_108
  global_load_dwordx4 v[112:115], v32, s[42:43] sc1
  global_load_dwordx4 v[116:119], v36, s[42:43] sc1
L_fl_108:
  s_bitcmp1_b32 s71, 2
  s_cbranch_scc0 L_fl_109
  global_load_dwordx4 v[120:123], v33, s[42:43] sc1
  global_load_dwordx4 v[124:127], v37, s[42:43] sc1
L_fl_109:
  s_bitcmp1_b32 s71, 3
  s_cbranch_scc0 L_fl_110
  global_load_dwordx4 v[128:131], v34, s[42:43] sc1
  global_load_dwordx4 v[132:135], v39, s[42:43] sc1
L_fl_110:
L_f1_c:
  s_waitcnt vmcnt(0)
  s_bitcmp1_b32 s71, 0
  s_cbranch_scc0 L_fc_111
  v_xor_b32 v104, s62, v104
  v_xor_b32 v105, s63, v105
  v_xor_b32 v106, s64, v106
  v_xor_b32 v107, s65, v107
  v_xor_b32 v108, s62, v108
  v_xor_b32 v109, s63, v109
  v_xor_b32 v110, s64, v110
  v_xor_b32 v111, s65, v111
  v_or3_b32 v8, v104, v105, v106
  v_or3_b32 v9, v107, v108, v109
  v_or3_b32 v8, v8, v110, v111
  v_pk_add_f32 v[136:137], v[104:105], v[108:109]
  v_pk_add_f32 v[138:139], v[106:107], v[110:111]
  v_or_b32 v8, v8, v9
  v_lshlrev_b32 v8, 24, v8
  v_cmp_ne_u32 vcc, 0, v8
  s_cmp_lg_u64 vcc, 0
  s_cbranch_scc1 L_fc_111
  s_bitset0_b32 s71, 0
L_fc_111:
  s_bitcmp1_b32 s71, 1
  s_cbranch_scc0 L_fc_112
  v_xor_b32 v112, s62, v112
  v_xor_b32 v113, s63, v113
  v_xor_b32 v114, s64, v114
  v_xor_b32 v115, s65, v115
  v_xor_b32 v116, s62, v116
  v_xor_b32 v117, s63, v117
  v_xor_b32 v118, s64, v118
  v_xor_b32 v119, s65, v119
  v_or3_b32 v8, v112, v113, v114
  v_or3_b32 v9, v115, v116, v117
  v_or3_b32 v8, v8, v118, v119
  v_pk_add_f32 v[144:145], v[112:113], v[116:117]
  v_pk_add_f32 v[146:147], v[114:115], v[118:119]
  v_or_b32 v8, v8, v9
  v_lshlrev_b32 v8, 24, v8
  v_cmp_ne_u32 vcc, 0, v8
  s_cmp_lg_u64 vcc, 0
  s_cbranch_scc1 L_fc_112
  s_bitset0_b32 s71, 1
L_fc_112:
  s_bitcmp1_b32 s71, 2
  s_cbranch_scc0 L_fc_113
  v_xor_b32 v120, s62, v120
  v_xor_b32 v121, s63, v121
  v_xor_b32 v122, s64, v122
  v_xor_b32 v123, s65, v123
  v_xor_b32 v124, s62, v124
  v_xor_b32 v125, s63, v125
  v_xor_b32 v126, s64, v126
  v_xor_b32 v127, s65, v127
  v_or3_b32 v8, v120, v121, v122
  v_or3_b32 v9, v123, v124, v125
  v_or3_b32 v8, v8, v126, v127
  v_pk_add_f32 v[152:153], v[120:121], v[124:125]
  v_pk_add_f32 v[154:155], v[122:123], v[126:127]
  v_or_b32 v8, v8, v9
  v_lshlrev_b32 v8, 24, v8
  v_cmp_ne_u32 vcc, 0, v8
  s_cmp_lg_u64 vcc, 0
  s_cbranch_scc1 L_fc_113
  s_bitset0_b32 s71, 2
L_fc_113:
  s_bitcmp1_b32 s71, 3
  s_cbranch_scc0 L_fc_114
  v_xor_b32 v128, s62, v128
  v_xor_b32 v129, s63, v129
  v_xor_b32 v130, s64, v130
  v_xor_b32 v131, s65, v131
  v_xor_b32 v132, s62, v132
  v_xor_b32 v133, s63, v133
  v_xor_b32 v134, s64, v134
  v_xor_b32 v135, s65, v135
  v_or3_b32 v8, v128, v129, v130
  v_or3_b32 v9, v131, v132, v133
  v_or3_b32 v8, v8, v134, v135
  v_pk_add_f32 v[160:161], v[128:129], v[132:133]
  v_pk_add_f32 v[162:163], v[130:131], v[134:135]
  v_or_b32 v8, v8, v9
  v_lshlrev_b32 v8, 24, v8
  v_cmp_ne_u32 vcc, 0, v8
  s_cmp_lg_u64 vcc, 0
  s_cbranch_scc1 L_fc_114
  s_bitset0_b32 s71, 3
L_fc_114:
  s_cmp_lg_u32 s71, 0
  s_cbranch_scc1 L_f1_p
L_f1_ok:
  v_pk_add_f32 v[136:137], v[136:137], v[144:145]
  v_pk_add_f32 v[138:139], v[138:139], v[146:147]
  v_pk_add_f32 v[152:153], v[152:153], v[160:161]
  v_pk_add_f32 v[154:155], v[154:155], v[162:163]
  v_pk_add_f32 v[136:137], v[136:137], v[152:153]
  v_pk_add_f32 v[138:139], v[138:139], v[154:155]
  v_pk_fma_f32 v[8:9], v[136:137], v[24:25], v[28:29]
  v_pk_fma_f32 v[10:11], v[138:139], v[26:27], v[30:31]
  v_cvt_pk_bf16_f32 v8, v8, v9
  v_cvt_pk_bf16_f32 v9, v10, v11
  ds_write_b64 v12, v[8:9] offset:0
  ds_read_b128 v[104:107], v14 offset:0
  ds_read_b128 v[108:111], v14 offset:64
  ds_read_b128 v[112:115], v14 offset:128
  ds_read_b128 v[116:119], v14 offset:192
  v_pk_fma_f32 v[16:17], v[136:137], v[20:21], v[16:17]
  v_pk_fma_f32 v[18:19], v[138:139], v[22:23], v[18:19]
  v_pk_mul_f32 v[10:11], v[16:17], v[16:17]
  v_pk_add_f32 v[20:21], v[16:17], v[18:19]
  v_pk_fma_f32 v[10:11], v[18:19], v[18:19], v[10:11]
  v_add_f32 v20, v20, v21
  v_add_f32 v21, v10, v11
  ds_write_b64 v5, v[20:21] offset:12032
  s_waitcnt lgkmcnt(0)
  s_cmp_eq_u32 s77, 1
  s_cbranch_scc1 L_nb_115
  s_barrier
L_nb_115:
  ds_read_b128 v[120:123], v0 offset:0
  ds_read_b128 v[124:127], v0 offset:64
  ds_read_b128 v[128:131], v0 offset:128
  ds_read_b128 v[132:135], v0 offset:192
  ds_read_b128 v[20:23], v7 offset:12032
  ds_read_b128 v[24:27], v7 offset:12048
  v_mfma_f32_16x16x32_bf16 v[32:35], v[40:43], v[104:107], 0
  ds_read_b128 v[136:139], v2 offset:0
  ds_read_b128 v[140:143], v2 offset:64
  v_mfma_f32_16x16x32_bf16 v[32:35], v[44:47], v[108:111], v[32:35]
  ds_read_b128 v[144:147], v2 offset:128
  ds_read_b128 v[148:151], v2 offset:192
  v_mfma_f32_16x16x32_bf16 v[32:35], v[48:51], v[112:115], v[32:35]
  ds_read_b128 v[152:155], v3 offset:0
  ds_read_b128 v[156:159], v3 offset:64
  v_mfma_f32_16x16x32_bf16 v[32:35], v[52:55], v[116:119], v[32:35]
  ds_read_b128 v[160:163], v3 offset:128
  ds_read_b128 v[164:167], v3 offset:192
  s_waitcnt lgkmcnt(13)
  v_mfma_f32_16x16x32_bf16 v[32:35], v[56:59], v[120:123], v[32:35]
  s_waitcnt lgkmcnt(12)
  v_mfma_f32_16x16x32_bf16 v[32:35], v[60:63], v[124:127], v[32:35]
  s_waitcnt lgkmcnt(8)
  v_pk_add_f32 v[20:21], v[20:21], v[22:23]
  v_pk_add_f32 v[24:25], v[24:25], v[26:27]
  v_mfma_f32_16x16x32_bf16 v[32:35], v[64:67], v[128:131], v[32:35]
  v_pk_add_f32 v[20:21], v[20:21], v[24:25]
  s_nop 0
  v_mfma_f32_16x16x32_bf16 v[32:35], v[68:71], v[132:135], v[32:35]
  v_add_f32_dpp v20, v20, v20 quad_perm:[2,3,0,1] row_mask:0xf bank_mask:0xf
  v_add_f32_dpp v21, v21, v21 quad_perm:[2,3,0,1] row_mask:0xf bank_mask:0xf
  s_waitcnt lgkmcnt(7)
  v_mfma_f32_16x16x32_bf16 v[32:35], v[72:75], v[136:139], v[32:35]
  v_add_f32_dpp v20, v20, v20 row_ror:4 row_mask:0xf bank_mask:0xf
  v_add_f32_dpp v21, v21, v21 row_ror:4 row_mask:0xf bank_mask:0xf
  s_waitcnt lgkmcnt(6)
  v_mfma_f32_16x16x32_bf16 v[32:35], v[76:79], v[140:143], v[32:35]
  v_add_f32_dpp v20, v20, v20 row_ror:8 row_mask:0xf bank_mask:0xf
  v_add_f32_dpp v21, v21, v21 row_ror:8 row_mask:0xf bank_mask:0xf
  s_waitcnt lgkmcnt(5)
  v_mfma_f32_16x16x32_bf16 v[32:35], v[80:83], v[144:147], v[32:35]
  v_mov_b32 v22, v20
  v_mov_b32 v23, v21
  s_waitcnt lgkmcnt(4)
  v_mfma_f32_16x16x32_bf16 v[32:35], v[84:87], v[148:151], v[32:35]
  v_permlane16_swap_b32 v22, v20
  v_permlane16_swap_b32 v23, v21
  s_waitcnt lgkmcnt(3)
  v_mfma_f32_16x16x32_bf16 v[32:35], v[88:91], v[152:155], v[32:35]
  v_add_f32 v20, v20, v22
  v_add_f32 v21, v21, v23
  v_mov_b32 v22, v20
  v_mov_b32 v23, v21
  s_waitcnt lgkmcnt(2)
  v_mfma_f32_16x16x32_bf16 v[32:35], v[92:95], v[156:159], v[32:35]
  v_permlane32_swap_b32 v22, v20
  v_permlane32_swap_b32 v23, v21
  s_waitcnt lgkmcnt(1)
  v_mfma_f32_16x16x32_bf16 v[32:35], v[96:99], v[160:163], v[32:35]
  v_add_f32 v20, v20, v22
  v_add_f32 v21, v21, v23
  s_waitcnt lgkmcnt(0)
  v_mfma_f32_16x16x32_bf16 v[32:35], v[100:103], v[164:167], v[32:35]
  v_mul_f32 v20, 0xbb000000, v20
  v_mul_f32 v21, 0x3b000000, v21
  v_fma_f32 v21, -v20, v20, v21
  v_max_f32 v21, 0, v21
  v_add_f32 v21, 0x3727c5ac, v21
  v_rsq_f32 v21, v21
  s_nop 1
  v_fmac_f32_dpp v32, v32, v20 row_shl:2 row_mask:0xf bank_mask:0x1
  v_fmac_f32_dpp v33, v33, v20 row_shl:2 row_mask:0xf bank_mask:0x1
  v_fmac_f32_dpp v34, v34, v20 row_shl:2 row_mask:0xf bank_mask:0x1
  v_fmac_f32_dpp v35, v35, v20 row_shl:2 row_mask:0xf bank_mask:0x1
  v_mul_f32 v8, v32, v21
  v_mul_f32 v9, v33, v21
  v_mul_f32 v10, v34, v21
  v_mul_f32 v11, v35, v21
  v_add_f32_dpp v8, v32, v8 row_shl:4 row_mask:0xf bank_mask:0xf
  v_add_f32_dpp v9, v33, v9 row_shl:4 row_mask:0xf bank_mask:0xf
  v_add_f32_dpp v10, v34, v10 row_shl:4 row_mask:0xf bank_mask:0xf
  v_add_f32_dpp v11, v35, v11 row_shl:4 row_mask:0xf bank_mask:0xf
  s_mov_b32 s50, 0x000f000f
  s_mov_b32 s51, 0x000f000f
  v_permlane32_swap_b32 v8, v10
  v_permlane32_swap_b32 v9, v11
  v_mul_f32 v20, 0xbfb8aa3b, v8
  v_mul_f32 v21, 0xbfb8aa3b, v9
  v_exp_f32 v20, v20
  v_exp_f32 v21, v21
  v_mul_f32 v8, v8, v10
  v_mul_f32 v9, v9, v11
  v_add_f32 v20, 1.0, v20
  v_add_f32 v21, 1.0, v21
  v_rcp_f32 v20, v20
  v_rcp_f32 v21, v21
  s_mov_b64 exec, s[50:51]
  v_mul_f32 v8, v8, v20
  v_mul_f32 v9, v9, v21
  v_cvt_pk_bf16_f32 v8, v8, v9
  v_mov_b32 v9, s74
  s_cmp_eq_u32 s77, 1
  s_cbranch_scc1 L_dry_end
  global_store_dwordx2 v13, v[8:9], s[42:43] sc1
  global_store_dwordx2 v4, v[8:9], s[42:43] sc1
  s_branch L_fin
L_t_f2:
  v_mov_b32 v2, v29
  s_and_b32 s59, s61, 3
  s_mul_i32 s59, s59, 3072
  s_mul_i32 s49, s5, 360448
  s_add_u32 s49, s49, s48
  s_mul_i32 s50, s5, 11264
  s_add_u32 s50, s50, 20480
  s_lshl_b32 s52, s59, 5
  s_add_u32 s49, s49, s52
  s_add_u32 s50, s50, s59
  s_sub_u32 s52, 11264, s59
  s_add_u32 s51, s50, s52
  s_cmp_lt_u32 s50, s51
  s_cbranch_scc0 L_dmae_117
L_dma_116:
  s_mov_b32 m0, s50
  s_add_u32 s50, s50, 1024
  buffer_load_dwordx4 v2, s[44:47], s49 offen  lds
  s_add_u32 s49, s49, 32768
  s_cmp_lt_u32 s50, s51
  s_cbranch_scc1 L_dma_116
L_dmae_117:
  s_mul_i32 s49, s5, 360448
  s_add_u32 s49, s49, s48
  s_mul_i32 s50, s5, 11264
  s_add_u32 s50, s50, 20480
  s_add_u32 s51, s50, s59
  s_cmp_lt_u32 s50, s51
  s_cbranch_scc0 L_dmae_119
L_dma_118:
  s_mov_b32 m0, s50
  s_add_u32 s50, s50, 1024
  buffer_load_dwordx4 v2, s[44:47], s49 offen  lds
  s_add_u32 s49, s49, 32768
  s_cmp_lt_u32 s50, s51
  s_cbranch_scc1 L_dma_118
L_dmae_119:
  v_mov_b32 v2, v6
  s_mov_b32 s50, 0x00030003
  s_mov_b32 s51, 0x00030003
  s_mov_b32 s53, 0x0fff0fff
  s_cmp_eq_u32 s5, 3
  s_cselect_b32 s52, 0x00ff00ff, s53
  s_mov_b32 s53, s52
  s_cmp_lg_u32 s5, 0
  s_cbranch_scc1 L_f2_w
  s_mov_b64 exec, s[50:51]
  global_load_dwordx4 v[104:107], v15, s[42:43] sc1
  global_load_dwordx4 v[108:111], v35, s[42:43] sc1
  global_load_dwordx4 v[112:115], v32, s[42:43] sc1
  global_load_dwordx4 v[116:119], v36, s[42:43] sc1
  global_load_dwordx4 v[120:123], v33, s[42:43] sc1
  global_load_dwordx4 v[124:127], v37, s[42:43] sc1
  global_load_dwordx4 v[128:131], v34, s[42:43] sc1
  global_load_dwordx4 v[132:135], v39, s[42:43] sc1
  s_mov_b64 exec, -1
  s_waitcnt vmcnt(8)
  s_branch L_f2_w2
L_f2_w:
  s_waitcnt vmcnt(0)
L_f2_w2:
  ds_read_b64_tr_b16 v[40:41], v2 offset:0
  ds_read_b64_tr_b16 v[42:43], v2 offset:128
  ds_read_b64_tr_b16 v[44:45], v2 offset:1024
  ds_read_b64_tr_b16 v[46:47], v2 offset:1152
  ds_read_b64_tr_b16 v[48:49], v2 offset:2048
  ds_read_b64_tr_b16 v[50:51], v2 offset:2176
  ds_read_b64_tr_b16 v[52:53], v2 offset:3072
  ds_read_b64_tr_b16 v[54:55], v2 offset:3200
  ds_read_b64_tr_b16 v[56:57], v2 offset:4096
  ds_read_b64_tr_b16 v[58:59], v2 offset:4224
  ds_read_b64_tr_b16 v[60:61], v2 offset:5120
  ds_read_b64_tr_b16 v[62:63], v2 offset:5248
  s_waitcnt lgkmcnt(10)
  ds_read_b64_tr_b16 v[64:65], v2 offset:6144
  ds_read_b64_tr_b16 v[66:67], v2 offset:6272
  s_waitcnt lgkmcnt(10)
  ds_read_b64_tr_b16 v[68:69], v2 offset:7168
  ds_read_b64_tr_b16 v[70:71], v2 offset:7296
  s_waitcnt lgkmcnt(10)
  ds_read_b64_tr_b16 v[72:73], v2 offset:8192
  ds_read_b64_tr_b16 v[74:75], v2 offset:8320
  s_waitcnt lgkmcnt(10)
  ds_read_b64_tr_b16 v[76:77], v2 offset:9216
  ds_read_b64_tr_b16 v[78:79], v2 offset:9344
  s_waitcnt lgkmcnt(10)
  ds_read_b64_tr_b16 v[80:81], v2 offset:10240
  ds_read_b64_tr_b16 v[82:83], v2 offset:10368
  s_waitcnt lgkmcnt(10)
  s_waitcnt lgkmcnt(0)
  s_cmp_lg_u32 s5, 0
  s_cbranch_scc1 L_f2x_120
  s_mov_b32 s70, 0
  s_mov_b64 exec, s[50:51]
  s_branch L_f2_ac
L_f2_a:
  s_mov_b64 exec, s[50:51]
  global_load_dwordx4 v[104:107], v15, s[42:43] sc1
  global_load_dwordx4 v[108:111], v35, s[42:43] sc1
  global_load_dwordx4 v[112:115], v32, s[42:43] sc1
  global_load_dwordx4 v[116:119], v36, s[42:43] sc1
  global_load_dwordx4 v[120:123], v33, s[42:43] sc1
  global_load_dwordx4 v[124:127], v37, s[42:43] sc1
  global_load_dwordx4 v[128:131], v34, s[42:43] sc1
  global_load_dwordx4 v[132:135], v39, s[42:43] sc1
L_f2_ac:
  s_waitcnt vmcnt(0)
  v_xor_b32 v136, s62, v104
  v_xor_b32 v137, s63, v105
  v_xor_b32 v138, s64, v106
  v_xor_b32 v139, s65, v107
  v_xor_b32 v140, s62, v108
  v_xor_b32 v141, s63, v109
  v_xor_b32 v142, s64, v110
  v_xor_b32 v143, s65, v111
  v_xor_b32 v144, s62, v112
  v_xor_b32 v145, s63, v113
  v_xor_b32 v146, s64, v114
  v_xor_b32 v147, s65, v115
  v_xor_b32 v148, s62, v116
  v_xor_b32 v149, s63, v117
  v_xor_b32 v150, s64, v118
  v_xor_b32 v151, s65, v119
  v_xor_b32 v152, s62, v120
  v_xor_b32 v153, s63, v121
  v_xor_b32 v154, s64, v122
  v_xor_b32 v155, s65, v123
  v_xor_b32 v156, s62, v124
  v_xor_b32 v157, s63, v125
  v_xor_b32 v158, s64, v126
  v_xor_b32 v159, s65, v127
  v_xor_b32 v160, s62, v128
  v_xor_b32 v161, s63, v129
  v_xor_b32 v162, s64, v130
  v_xor_b32 v163, s65, v131
  v_xor_b32 v164, s62, v132
  v_xor_b32 v165, s63, v133
  v_xor_b32 v166, s64, v134
  v_xor_b32 v167, s65, v135
  v_or3_b32 v8, v136, v137, v138
  v_or3_b32 v9, v144, v145, v146
  v_or3_b32 v10, v152, v153, v154
  v_or3_b32 v11, v160, v161, v162
  v_or3_b32 v8, v8, v139, v140
  v_or3_b32 v9, v9, v147, v148
  v_or3_b32 v10, v10, v155, v156
  v_or3_b32 v11, v11, v163, v164
  v_or3_b32 v8, v8, v141, v142
  v_or3_b32 v9, v9, v149, v150
  v_or3_b32 v10, v10, v157, v158
  v_or3_b32 v11, v11, v165, v166
  v_or_b32 v8, v8, v143
  v_or_b32 v9, v9, v151
  v_or_b32 v10, v10, v159
  v_or_b32 v11, v11, v167
  v_or3_b32 v3, v8, v9, v10
  v_or_b32 v3, v3, v11
  v_lshlrev_b32 v3, 24, v3
  v_cmp_ne_u32 vcc, 0, v3
  s_cmp_eq_u64 vcc, 0
  s_cbranch_scc1 L_f2_ad
  s_sleep 2
  s_add_u32 s70, s70, 1
  s_cmp_lt_u32 s70, 262144
  s_cbranch_scc1 L_f2_a
L_f2_ad:
  s_mov_b64 exec, -1
  v_pk_add_f32 v[136:137], v[136:137], v[140:141]
  v_pk_add_f32 v[138:139], v[138:139], v[142:143]
  v_pk_add_f32 v[144:145], v[144:145], v[148:149]
  v_pk_add_f32 v[146:147], v[146:147], v[150:151]
  v_pk_add_f32 v[152:153], v[152:153], v[156:157]
  v_pk_add_f32 v[154:155], v[154:155], v[158:159]
  v_pk_add_f32 v[160:161], v[160:161], v[164:165]
  v_pk_add_f32 v[162:163], v[162:163], v[166:167]
  v_pk_add_f32 v[136:137], v[136:137], v[144:145]
  v_pk_add_f32 v[138:139], v[138:139], v[146:147]
  v_pk_add_f32 v[152:153], v[152:153], v[160:161]
  v_pk_add_f32 v[154:155], v[154:155], v[162:163]
  v_pk_add_f32 v[136:137], v[136:137], v[152:153]
  v_pk_add_f32 v[138:139], v[138:139], v[154:155]
  v_cvt_pk_bf16_f32 v136, 0, v136
  v_cvt_pk_bf16_f32 v137, 0, v137
  v_cvt_pk_bf16_f32 v138, 0, v138
  v_cvt_pk_bf16_f32 v139, 0, v139
  v_mul_f32 v136, v136, v20
  v_mul_f32 v137, v137, v21
  v_mul_f32 v138, v138, v22
  v_mul_f32 v139, v139, v23
  v_cvt_pk_bf16_f32 v136, 0, v136
  v_cvt_pk_bf16_f32 v137, 0, v137
  v_cvt_pk_bf16_f32 v138, 0, v138
  v_cvt_pk_bf16_f32 v139, 0, v139
  v_add_f32 v16, v16, v136
  v_add_f32 v17, v17, v137
  v_add_f32 v18, v18, v138
  v_add_f32 v19, v19, v139
  v_cvt_pk_bf16_f32 v16, 0, v16
  v_cvt_pk_bf16_f32 v17, 0, v17
  v_cvt_pk_bf16_f32 v18, 0, v18
  v_cvt_pk_bf16_f32 v19, 0, v19
L_f2x_120:
  v_mov_b32 v112, 0
  v_mov_b32 v113, 0
  v_mov_b32 v114, 0
  v_mov_b32 v115, 0
  s_mov_b32 s70, 0
L_f2_p:
  global_load_dwordx4 v[104:107], v28, s[42:43] offset:-2048 sc1
  global_load_dwordx4 v[108:111], v28, s[42:43] sc1
  s_mov_b64 exec, s[52:53]
  global_load_dwordx4 v[112:115], v28, s[42:43] offset:2048 sc1
  s_mov_b64 exec, -1
  s_waitcnt vmcnt(2)
  v_xor_b32 v105, s74, v105
  v_xor_b32 v107, s74, v107
  s_waitcnt vmcnt(1)
  v_xor_b32 v109, s74, v109
  v_xor_b32 v111, s74, v111
  s_waitcnt vmcnt(0)
  v_xor_b32 v113, s74, v113
  v_xor_b32 v115, s74, v115
  v_or3_b32 v31, v105, v107, v109
  v_or_b32 v3, v113, v115
  v_or_b32 v31, v111, v31
  v_cmp_ne_u32 s[68:69], 0, v3
  v_cmp_ne_u32 vcc, 0, v31
  v_mov_b32_dpp v105, v104 quad_perm:[2,3,2,3] row_mask:0xf bank_mask:0xf
  v_mov_b32_dpp v107, v106 quad_perm:[2,3,2,3] row_mask:0xf bank_mask:0xf
  v_mov_b32_dpp v109, v108 quad_perm:[2,3,2,3] row_mask:0xf bank_mask:0xf
  v_mov_b32_dpp v111, v110 quad_perm:[2,3,2,3] row_mask:0xf bank_mask:0xf
  v_mov_b32_dpp v113, v112 quad_perm:[2,3,2,3] row_mask:0xf bank_mask:0xf
  v_mov_b32_dpp v115, v114 quad_perm:[2,3,2,3] row_mask:0xf bank_mask:0xf
  s_and_b64 s[68:69], s[68:69], s[52:53]
  s_or_b64 vcc, vcc, s[68:69]
  v_mfma_f32_16x16x32_bf16 v[120:123], v[40:43], v[104:107], 0
  v_mfma_f32_16x16x32_bf16 v[124:127], v[44:47], v[104:107], 0
  v_mfma_f32_16x16x32_bf16 v[128:131], v[48:51], v[104:107], 0
  v_mfma_f32_16x16x32_bf16 v[132:135], v[52:55], v[104:107], 0
  s_cmp_eq_u64 vcc, 0
  s_cbranch_scc1 L_f2_ok
  s_add_u32 s70, s70, 1
  s_cmp_lt_u32 s70, 262144
  s_cbranch_scc1 L_f2_p
L_f2_ok:
  v_mfma_f32_16x16x32_bf16 v[120:123], v[56:59], v[108:111], v[120:123]
  v_mfma_f32_16x16x32_bf16 v[124:127], v[60:63], v[108:111], v[124:127]
  v_mfma_f32_16x16x32_bf16 v[128:131], v[64:67], v[108:111], v[128:131]
  v_mfma_f32_16x16x32_bf16 v[132:135], v[68:71], v[108:111], v[132:135]
  v_mfma_f32_16x16x32_bf16 v[120:123], v[72:75], v[112:115], v[120:123]
  v_mfma_f32_16x16x32_bf16 v[124:127], v[76:79], v[112:115], v[124:127]
  v_mfma_f32_16x16x32_bf16 v[128:131], v[80:83], v[112:115], v[128:131]
  s_nop 6
  v_add_f32_dpp v8, v124, v120 row_shl:4 row_mask:0xf bank_mask:0xf
  v_add_f32_dpp v9, v125, v121 row_shl:4 row_mask:0xf bank_mask:0xf
  v_add_f32_dpp v10, v126, v122 row_shl:4 row_mask:0xf bank_mask:0xf
  v_add_f32_dpp v11, v127, v123 row_shl:4 row_mask:0xf bank_mask:0xf
  v_add_f32_dpp v128, v132, v128 row_shl:4 row_mask:0xf bank_mask:0xf
  v_add_f32_dpp v129, v133, v129 row_shl:4 row_mask:0xf bank_mask:0xf
  v_add_f32_dpp v130, v134, v130 row_shl:4 row_mask:0xf bank_mask:0xf
  v_add_f32_dpp v131, v135, v131 row_shl:4 row_mask:0xf bank_mask:0xf
  v_add_f32_dpp v8, v128, v8 row_shl:8 row_mask:0xf bank_mask:0xf
  v_add_f32_dpp v9, v129, v9 row_shl:8 row_mask:0xf bank_mask:0xf
  v_add_f32_dpp v10, v130, v10 row_shl:8 row_mask:0xf bank_mask:0xf
  v_add_f32_dpp v11, v131, v11 row_shl:8 row_mask:0xf bank_mask:0xf
  s_mov_b64 exec, s[50:51]
  ds_write_b128 v30, v[8:11]
  s_waitcnt lgkmcnt(0)
  s_cmp_eq_u32 s77, 1
  s_cbranch_scc1 L_nb_121
  s_barrier
L_nb_121:
  s_cmp_lg_u32 s5, s77
  s_cbranch_scc1 L_fin
  ds_read_b128 v[104:107], v12 offset:128
  ds_read_b128 v[108:111], v12 offset:256
  ds_read_b128 v[112:115], v12 offset:384
  s_waitcnt lgkmcnt(2)
  v_pk_add_f32 v[8:9], v[8:9], v[104:105]
  v_pk_add_f32 v[10:11], v[10:11], v[106:107]
  s_waitcnt lgkmcnt(0)
  v_pk_add_f32 v[108:109], v[108:109], v[112:113]
  v_pk_add_f32 v[110:111], v[110:111], v[114:115]
  v_pk_add_f32 v[8:9], v[8:9], v[108:109]
  v_pk_add_f32 v[10:11], v[10:11], v[110:111]
  v_pk_fma_f32 v[8:9], v[8:9], v[24:25], v[16:17]
  v_pk_fma_f32 v[10:11], v[10:11], v[26:27], v[18:19]
  v_cvt_pk_bf16_f32 v8, v8, v9
  v_cvt_pk_bf16_f32 v9, v10, v11
  s_cmp_eq_u32 s77, 1
  s_cbranch_scc1 L_dry_end
  global_store_dwordx2 v13, v[8:9], s[38:39]
  s_mov_b64 exec, 1
  s_cmp_lg_u32 s61, 0
  s_cbranch_scc1 L_noep
  v_mov_b32 v10, s74
  global_store_dword v38, v10, s[42:43] offset:0
L_noep:
L_fin:
L_end:
  s_endpgm
.p2align 7
L_table:
  .long 0x038030ae, 0x038030fe, 0x03803706, 0x03803356, 0x03803886, 0x038030d6, 0x0380372e, 0x038030ee
  .long 0x07803e4d, 0x07803c09, 0x078037e6, 0x078014de, 0x07803e09, 0x07803c09, 0x0780403d, 0x07803e45
  .long 0x0b803666, 0x07803e55, 0x0b80314e, 0x0b803e11, 0x07803116, 0x07803c11, 0x0b803e11, 0x0b803e11
  .long 0x0f803786, 0x0b803626, 0x0f8036be, 0x0b80347e, 0x0b8037ae, 0x07803c35, 0x0b80119e, 0x0b8011de
  .long 0x1380373e, 0x0f80318e, 0x13803e21, 0x0f8033a6, 0x0f803e75, 0x0b803e7d, 0x0f803776, 0x0f80360e
  .long 0x17803816, 0x1380185d, 0x1380382e, 0x13803e6d, 0x13803766, 0x0f80155e, 0x138030e6, 0x13803056
  .long 0x1b803e31, 0x1780145e, 0x17803e15, 0x1780330e, 0x178036ce, 0x13803046, 0x17803696, 0x17803936
  .long 0x1b80181d, 0x1b80366e, 0x1b803676, 0x1b803c25, 0x1b80363e, 0x1780316e, 0x1b803006, 0x1b80377e
  .long 0x1f982ef6, 0x1f982eb6, 0x1f9b4001, 0x1f993436, 0x1f9c171e, 0x1b982ffe, 0x1f9b3e01, 0x1f982fc6
  .long 0x239f3e05, 0x239e3ca4, 0x1f9b3e09, 0x238a4009, 0x239f3f04, 0x1f9e3d0c, 0x1fa04009, 0x239f3e09
  .long 0x279b3e11, 0x279f3e0d, 0x1f982f96, 0x239f3f74, 0x27982ff6, 0x239e3d7c, 0x1f9f3f64, 0x239f3f6c
  .long 0x279b1c19, 0x2b9b39d6, 0x239b1c19, 0x279a1a19, 0x2b9b1c19, 0x279e348e, 0x23881619, 0x27881619
  .long 0x279b3e21, 0x2f982f46, 0x239f3eac, 0x279935ee, 0x2b9f3e2d, 0x2b9f3e21, 0x239b3e21, 0x279b3e21
  .long 0x279c161e, 0x338c3c29, 0x279c169e, 0x2b9f3e29, 0x2f9b4029, 0x2b8a3e29, 0x23982e4e, 0x27982ea6
  .long 0x2b9f3e94, 0x338a3e31, 0x2b9f3e65, 0x2b9934c6, 0x2f9b3e31, 0x2b982f26, 0x279b3c31, 0x2b9c4031
  .long 0x2f8c39ce, 0x339b3e39, 0x2f9b3e39, 0x2f9e3c39, 0x2f9b3e39, 0x2f982fb6, 0x27982fbe, 0x2b9b3c39
  .long 0x33af3801, 0x33af3801, 0x2fbb189c, 0x2fb33a01, 0x2fa74001, 0x33af3801, 0x2bba472a, 0x2baf3801
  .long 0x33be3e09, 0x33bc4442, 0x33ba465a, 0x2faa46aa, 0x2fbe3ebc, 0x33bc44e2, 0x2bc040cc, 0x2bbe3ed4
  .long 0x33ba4612, 0x33be3e11, 0x33af3811, 0x2fbe3efc, 0x33af3811, 0x33bc44ea, 0x2fbe3e84, 0x2fbe3e8c
  .long 0x33a93d2c, 0x33b71a19, 0x33a93cf4, 0x33a73cb4, 0x33a93d4c, 0x33b81a19, 0x33936ecb, 0x33936efb
  .long 0x37ba462a, 0x33af3821, 0x37be3f3c, 0x37b33a21, 0x37be3e21, 0x33be3ec4, 0x33ba470a, 0x33ba474a
  .long 0x37a74029, 0x33aa3d34, 0x3ba74029, 0x37be3f44, 0x37bb18dc, 0x37a93d54, 0x33af3829, 0x33af3829
  .long 0x37be3ee4, 0x37a93cec, 0x3bbe3e31, 0x3bb33a31, 0x3bba46ca, 0x3baf3831, 0x33b9191c, 0x33bc4124
  .long 0x3ba83e39, 0x3bba4632, 0x3bba466a, 0x3bbc4492, 0x3bba46da, 0x3baf3839, 0x37af3839, 0x37b9195c
  .long 0x3bcb6a03, 0x3bcb6a33, 0x3bc7724b, 0x3bd0607b, 0x3bc77283, 0x3bcb6aab, 0x37dd471a, 0x3bcb6aeb
  .long 0x3bdd4622, 0x3bde444a, 0x3bdd4672, 0x3bcd6663, 0x3bdd46b2, 0x3bde4502, 0x37e04114, 0x3bdd4742
  .long 0x3bdd4602, 0x3bdd463a, 0x3bcb6a5b, 0x3bdd469a, 0x3bcb6a93, 0x3bde44f2, 0x3bdd4712, 0x3bdd473a
  .long 0x3bc7720b, 0x3bc47800, 0x3bc77243, 0x3bc57600, 0x3bc7728b, 0x3bc57600, 0x3bca6cdb, 0x3bca6ce3
  .long 0x3bdd460a, 0x3fcb6a2b, 0x3bdd467a, 0x3fd06073, 0x3bdd46ba, 0x3fdd46fa, 0x3bdd4722, 0x3bdd4732
  .long 0x3bc77213, 0x3fc87023, 0x3bc77253, 0x3fdd468a, 0x3bc7729b, 0x3fc772b3, 0x3bcb6ad3, 0x3bcb6af3
  .long 0x3bdd461a, 0x3fc7723b, 0x3bdd4682, 0x3fd0606b, 0x3bdd46c2, 0x3fcb6aa3, 0x3bc57600, 0x3bdc4952
  .long 0x3bc7721b, 0x3fdd4652, 0x3bdd4662, 0x3fde44a2, 0x3bdd46d2, 0x3fcb6abb, 0x3fcb6ac3, 0x3bc57600
L_gtab:
  .long 0x017c0000, 0x00000000
  .long 0x02bc0180, 0x00000080
  .long 0x043c02c0, 0x00000100
  .long 0x057c0440, 0x00000180
  .long 0x06fc0580, 0x00000200
  .long 0x083c0700, 0x00000280
  .long 0x097c0840, 0x00000300
  .long 0x0abc0980, 0x00000380
.section .rodata,"a"
.p2align 6
.amdhsa_kernel adaLN_cond__sliding_block_cached__glu_gated_swiglu__decode_kernel
  .amdhsa_next_free_vgpr 168
  .amdhsa_next_free_sgpr 102
  .amdhsa_accum_offset 168
  .amdhsa_group_segment_fixed_size 0
  .amdhsa_kernarg_size 112
  .amdhsa_user_sgpr_count 2
  .amdhsa_user_sgpr_kernarg_segment_ptr 1
  .amdhsa_system_sgpr_workgroup_id_x 1
.end_amdhsa_kernel
```

```asm
; @launch grid=(256,1,1) block=(768,1,1) lds=151552
.amdgcn_target "amdgcn-amd-amdhsa--gfx950"
.text
.globl adaLN_cond__sliding_block_cached__glu_gated_swiglu__decode_kernel
.p2align 8
.type adaLN_cond__sliding_block_cached__glu_gated_swiglu__decode_kernel,@function
adaLN_cond__sliding_block_cached__glu_gated_swiglu__decode_kernel:
  s_cmpk_ge_u32 s2, 256
  s_cbranch_scc1 L_end
  s_load_dwordx2 s[44:45], s[0:1], 8
  v_readfirstlane_b32 s5, v0
  s_and_b32 s6, s2, 63
  s_lshr_b32 s7, s2, 6
  s_lshr_b32 s5, s5, 6
  v_and_b32 v1, 63, v0
  s_cmp_lt_u32 s5, 4
  s_cbranch_scc1 L_helper
  s_lshl_b32 s10, s6, 22
  s_mul_i32 s58, s7, 229376
  s_add_u32 s11, s10, 3141632
  v_lshl_add_u32 v2, v0, 4, s11
  s_lshl_b32 s46, 1, 28
  s_lshl_b32 s47, 1, 17
  s_mul_i32 s12, s6, 5
  s_and_b32 s12, s12, 15
  s_lshl_b32 s12, s12, 13
  s_add_u32 s12, s12, s58
  s_waitcnt lgkmcnt(0)
L_nb1:
  buffer_load_dwordx4 v[56:59], v2, s[44:47], s12 offen nt
  s_addk_i32 s12, 0x2000
  buffer_load_dwordx4 v[60:63], v2, s[44:47], s12 offen nt
  s_addk_i32 s12, 0x2000
  buffer_load_dwordx4 v[64:67], v2, s[44:47], s12 offen nt
  s_addk_i32 s12, 0x2000
  buffer_load_dwordx4 v[68:71], v2, s[44:47], s12 offen nt
  s_addk_i32 s12, 0x2000
  s_getpc_b64 s[56:57]
L_pc:
  s_lshl_b32 s3, s2, 2
  s_add_u32 s3, s3, L_table-L_pc
  s_load_dword s14, s[56:57], s3
  s_load_dwordx2 s[48:49], s[0:1], 16
  s_load_dwordx4 s[20:23], s[0:1], 24
  s_load_dwordx2 s[28:29], s[0:1], 80
  s_load_dwordx2 s[42:43], s[0:1], 104
  s_getreg_b32 s68, hwreg(HW_REG_XCC_ID, 0, 3)
  s_lshr_b32 s68, 85, s68
  buffer_load_dwordx4 v[72:75], v2, s[44:47], s12 offen nt
  s_addk_i32 s12, 0x2000
  s_barrier
  s_sub_u32 s9, s5, 4
  s_mov_b64 s[50:51], s[46:47]
  s_mov_b32 s52, 0xcccccccc
  s_mov_b32 s53, 0xcccccccc
  s_mov_b32 s54, 0xaaaaaaaa
  s_mov_b32 s55, 0xaaaaaaaa
  s_mul_i32 s15, s9, 8192
  s_add_u32 s15, s15, 86016
  s_add_u32 s59, s58, 229376
  v_mov_b32 v4, 0
  v_lshrrev_b32 v5, 3, v1
  v_and_b32 v6, 6, v5
  v_xor_b32 v6, v6, v1
  v_and_b32 v6, 7, v6
  s_lshl_b32 s33, s9, 6
  s_movk_i32 s26, 6144
  s_mov_b32 s30, 3145728
  s_mov_b32 s31, s47
  s_lshl_b32 s34, s9, 13
  s_add_u32 s34, s34, 20480
  s_add_u32 s35, s34, 8192
  s_and_b32 s36, s2, 7
  s_lshl_b32 s36, s36, 1
  s_and_b32 s37, s9, 1
  s_add_u32 s36, s36, s37
  s_lshr_b32 s37, s9, 1
  s_lshl_b32 s37, s37, 4
  s_add_u32 s36, s36, s37
  s_lshl_b32 s36, s36, 6
  s_waitcnt lgkmcnt(0)
  s_and_b32 s27, s14, 7
  s_cmp_eq_u32 s27, 6
  s_cselect_b64 s[28:29], s[20:21], s[28:29]
  s_cselect_b32 s26, 0x2000, s26
  s_cselect_b32 s30, 0x400000, s30
  s_cmp_eq_u32 s27, 1
  s_cselect_b64 s[28:29], s[22:23], s[28:29]
  s_cselect_b32 s26, 0x400, s26
  s_cselect_b32 s30, 0x400000, s30
  s_cselect_b32 s33, s36, s33
  s_cselect_b32 s27, 4, s27
  v_mul_u32_u24 v5, s26, v5
  v_lshl_add_u32 v5, v6, 4, v5
  v_mov_b32 v6, 1
  s_mul_i32 s33, s33, s26
  s_bfe_u32 s32, s14, 0x60003
  s_lshl_b32 s32, s32, 7
  s_add_u32 s33, s33, s32
  s_lshl_b32 s26, s26, 3
  s_cmp_lt_u32 s27, 4
  s_cbranch_scc1 L_we_2
L_wl_1:
  s_mov_b32 m0, s34
  s_cmp_eq_u32 s27, 5
  s_cbranch_scc1 L_wb_3
  s_waitcnt vmcnt(3)
  s_bitcmp0_b32 s68, 0
  s_cbranch_scc1 L_th_4
  s_waitcnt vmcnt(2)
L_th_4:
L_wb_3:
  buffer_load_dwordx4 v5, s[28:31], s33 offen nt lds
  s_add_u32 s33, s33, s26
  s_addk_i32 s34, 1024
  s_cmp_lt_u32 s34, s35
  s_cbranch_scc1 L_wl_1
L_we_2:
  s_waitcnt vmcnt(3)
  s_bitcmp0_b32 s68, 0
  s_cbranch_scc1 L_th_5
  s_waitcnt vmcnt(2)
L_th_5:
  buffer_load_dwordx4 v[76:79], v2, s[44:47], s12 offen nt
  s_addk_i32 s12, 0x2000
  s_waitcnt vmcnt(3)
  s_bitcmp0_b32 s68, 0
  s_cbranch_scc1 L_th_6
  s_waitcnt vmcnt(2)
L_th_6:
  buffer_load_dwordx4 v[80:83], v2, s[44:47], s12 offen nt
  s_addk_i32 s12, 0x2000
  s_waitcnt vmcnt(3)
  s_bitcmp0_b32 s68, 0
  s_cbranch_scc1 L_th_7
  s_waitcnt vmcnt(2)
L_th_7:
  buffer_load_dwordx4 v[84:87], v2, s[44:47], s12 offen nt
  s_addk_i32 s12, 0x2000
  s_waitcnt vmcnt(3)
  s_bitcmp0_b32 s68, 0
  s_cbranch_scc1 L_th_8
  s_waitcnt vmcnt(2)
L_th_8:
  buffer_load_dwordx4 v[88:91], v2, s[44:47], s12 offen nt
  s_addk_i32 s12, 0x2000
  s_cmp_lt_u32 s27, 4
  s_cbranch_scc1 L_ws_9
  s_mov_b64 exec, 1
  ds_add_u32 v4, v6 offset:6720
  s_mov_b64 exec, -1
L_ws_9:
  s_waitcnt vmcnt(3)
  s_bitcmp0_b32 s68, 0
  s_cbranch_scc1 L_th_10
  s_waitcnt vmcnt(2)
L_th_10:
  buffer_load_dwordx4 v[92:95], v2, s[44:47], s12 offen nt
  s_addk_i32 s12, 0x2000
  s_waitcnt vmcnt(3)
  s_bitcmp0_b32 s68, 0
  s_cbranch_scc1 L_th_11
  s_waitcnt vmcnt(2)
L_th_11:
  buffer_load_dwordx4 v[96:99], v2, s[44:47], s12 offen nt
  s_addk_i32 s12, 0x2000
  s_waitcnt vmcnt(3)
  s_bitcmp0_b32 s68, 0
  s_cbranch_scc1 L_th_12
  s_waitcnt vmcnt(2)
L_th_12:
  buffer_load_dwordx4 v[100:103], v2, s[44:47], s12 offen nt
  s_addk_i32 s12, 0x2000
  s_bfe_u32 s61, s14, 0xa0010
  s_lshl_b32 s61, s61, 10
  s_bfe_u32 s60, s14, 0x70009
  s_sub_u32 s60, s9, s60
  s_add_u32 s60, s60, 64
  s_lshr_b32 s60, s60, 3
  v_bfrev_b32 v3, v1
  v_lshrrev_b32 v3, 28, v3
  v_cmp_gt_u32 s[66:67], s60, v3
  v_and_b32 v3, 15, v1
  v_lshlrev_b32 v3, 4, v3
  s_mov_b32 s13, s61
  s_cmp_gt_u32 s60, 7
  s_cbranch_scc1 L_opts_13
  s_waitcnt vmcnt(3)
  s_bitcmp0_b32 s68, 0
  s_cbranch_scc1 L_th_14
  s_waitcnt vmcnt(2)
L_th_14:
  buffer_load_dwordx4 v[52:55], v2, s[44:47], s13 offen nt
  s_addk_i32 s13, 0x2000
  s_cmp_gt_u32 s60, 6
  s_cbranch_scc1 L_opts_13
  s_waitcnt vmcnt(3)
  s_bitcmp0_b32 s68, 0
  s_cbranch_scc1 L_th_15
  s_waitcnt vmcnt(2)
L_th_15:
  buffer_load_dwordx4 v[48:51], v2, s[44:47], s13 offen nt
  s_addk_i32 s13, 0x2000
  s_cmp_gt_u32 s60, 5
  s_cbranch_scc1 L_opts_13
  s_waitcnt vmcnt(3)
  s_bitcmp0_b32 s68, 0
  s_cbranch_scc1 L_th_16
  s_waitcnt vmcnt(2)
L_th_16:
  buffer_load_dwordx4 v[44:47], v2, s[44:47], s13 offen nt
  s_addk_i32 s13, 0x2000
  s_cmp_gt_u32 s60, 4
  s_cbranch_scc1 L_opts_13
  s_waitcnt vmcnt(3)
  s_bitcmp0_b32 s68, 0
  s_cbranch_scc1 L_th_17
  s_waitcnt vmcnt(2)
L_th_17:
  buffer_load_dwordx4 v[40:43], v2, s[44:47], s13 offen nt
  s_addk_i32 s13, 0x2000
  s_cmp_gt_u32 s60, 3
  s_cbranch_scc1 L_opts_13
  s_waitcnt vmcnt(3)
  s_bitcmp0_b32 s68, 0
  s_cbranch_scc1 L_th_18
  s_waitcnt vmcnt(2)
L_th_18:
  buffer_load_dwordx4 v[36:39], v2, s[44:47], s13 offen nt
  s_addk_i32 s13, 0x2000
  s_cmp_gt_u32 s60, 2
  s_cbranch_scc1 L_opts_13
  s_waitcnt vmcnt(3)
  s_bitcmp0_b32 s68, 0
  s_cbranch_scc1 L_th_19
  s_waitcnt vmcnt(2)
L_th_19:
  buffer_load_dwordx4 v[32:35], v2, s[44:47], s13 offen nt
  s_addk_i32 s13, 0x2000
  s_cmp_gt_u32 s60, 1
  s_cbranch_scc1 L_opts_13
  s_waitcnt vmcnt(3)
  s_bitcmp0_b32 s68, 0
  s_cbranch_scc1 L_th_20
  s_waitcnt vmcnt(2)
L_th_20:
  buffer_load_dwordx4 v[28:31], v2, s[44:47], s13 offen nt
  s_addk_i32 s13, 0x2000
  s_cmp_gt_u32 s60, 0
  s_cbranch_scc1 L_opts_13
  s_waitcnt vmcnt(3)
  s_bitcmp0_b32 s68, 0
  s_cbranch_scc1 L_th_21
  s_waitcnt vmcnt(2)
L_th_21:
  buffer_load_dwordx4 v[24:27], v2, s[44:47], s13 offen nt
  s_addk_i32 s13, 0x2000
L_opts_13:
  s_waitcnt vmcnt(3)
  s_bitcmp0_b32 s68, 0
  s_cbranch_scc1 L_th_22
  s_waitcnt vmcnt(2)
L_th_22:
  buffer_load_dwordx4 v[104:107], v2, s[44:47], s12 offen nt
  s_addk_i32 s12, 0x2000
  s_cmp_ge_u32 s12, s59
  s_cselect_b32 s12, s58, s12
  s_waitcnt vmcnt(3)
  s_bitcmp0_b32 s68, 0
  s_cbranch_scc1 L_th_23
  s_waitcnt vmcnt(2)
L_th_23:
  buffer_load_dwordx4 v[108:111], v2, s[44:47], s12 offen nt
  s_addk_i32 s12, 0x2000
  s_cmp_ge_u32 s12, s59
  s_cselect_b32 s12, s58, s12
  s_waitcnt vmcnt(3)
  s_bitcmp0_b32 s68, 0
  s_cbranch_scc1 L_th_24
  s_waitcnt vmcnt(2)
L_th_24:
  buffer_load_dwordx4 v[112:115], v2, s[44:47], s12 offen nt
  s_addk_i32 s12, 0x2000
  s_cmp_ge_u32 s12, s59
  s_cselect_b32 s12, s58, s12
  s_waitcnt vmcnt(3)
  s_bitcmp0_b32 s68, 0
  s_cbranch_scc1 L_th_25
  s_waitcnt vmcnt(2)
L_th_25:
  buffer_load_dwordx4 v[116:119], v2, s[44:47], s12 offen nt
  s_addk_i32 s12, 0x2000
  s_cmp_ge_u32 s12, s59
  s_cselect_b32 s12, s58, s12
  ds_write_b32 v4, v4 offset:6672
  s_waitcnt vmcnt(3)
  s_bitcmp0_b32 s68, 0
  s_cbranch_scc1 L_th_26
  s_waitcnt vmcnt(2)
L_th_26:
  buffer_load_dwordx4 v[120:123], v2, s[44:47], s12 offen nt
  s_addk_i32 s12, 0x2000
  s_cmp_ge_u32 s12, s59
  s_cselect_b32 s12, s58, s12
  s_waitcnt vmcnt(3)
  s_bitcmp0_b32 s68, 0
  s_cbranch_scc1 L_th_27
  s_waitcnt vmcnt(2)
L_th_27:
  buffer_load_dwordx4 v[124:127], v2, s[44:47], s12 offen nt
  s_addk_i32 s12, 0x2000
  s_cmp_ge_u32 s12, s59
  s_cselect_b32 s12, s58, s12
  s_waitcnt vmcnt(3)
  s_bitcmp0_b32 s68, 0
  s_cbranch_scc1 L_th_28
  s_waitcnt vmcnt(2)
L_th_28:
  buffer_load_dwordx4 v[128:131], v2, s[44:47], s12 offen nt
  s_addk_i32 s12, 0x2000
  s_cmp_ge_u32 s12, s59
  s_cselect_b32 s12, s58, s12
  s_waitcnt vmcnt(3)
  s_bitcmp0_b32 s68, 0
  s_cbranch_scc1 L_th_29
  s_waitcnt vmcnt(2)
L_th_29:
  buffer_load_dwordx4 v[132:135], v2, s[44:47], s12 offen nt
  s_addk_i32 s12, 0x2000
  s_cmp_ge_u32 s12, s59
  s_cselect_b32 s12, s58, s12
  s_waitcnt vmcnt(3)
  s_bitcmp0_b32 s68, 0
  s_cbranch_scc1 L_th_30
  s_waitcnt vmcnt(2)
L_th_30:
  buffer_load_dwordx4 v[136:139], v2, s[44:47], s12 offen nt
  s_addk_i32 s12, 0x2000
  s_cmp_ge_u32 s12, s59
  s_cselect_b32 s12, s58, s12
  s_waitcnt vmcnt(3)
  s_bitcmp0_b32 s68, 0
  s_cbranch_scc1 L_th_31
  s_waitcnt vmcnt(2)
L_th_31:
  buffer_load_dwordx4 v[140:143], v2, s[44:47], s12 offen nt
  s_addk_i32 s12, 0x2000
  s_cmp_ge_u32 s12, s59
  s_cselect_b32 s12, s58, s12
  s_waitcnt vmcnt(3)
  s_bitcmp0_b32 s68, 0
  s_cbranch_scc1 L_th_32
  s_waitcnt vmcnt(2)
L_th_32:
  buffer_load_dwordx4 v[144:147], v2, s[44:47], s12 offen nt
  s_addk_i32 s12, 0x2000
  s_cmp_ge_u32 s12, s59
  s_cselect_b32 s12, s58, s12
  s_waitcnt vmcnt(3)
  s_bitcmp0_b32 s68, 0
  s_cbranch_scc1 L_th_33
  s_waitcnt vmcnt(2)
L_th_33:
  buffer_load_dwordx4 v[148:151], v2, s[44:47], s12 offen nt
  s_addk_i32 s12, 0x2000
  s_cmp_ge_u32 s12, s59
  s_cselect_b32 s12, s58, s12
  s_waitcnt vmcnt(3)
  s_bitcmp0_b32 s68, 0
  s_cbranch_scc1 L_th_34
  s_waitcnt vmcnt(2)
L_th_34:
  buffer_load_dwordx4 v[152:155], v2, s[44:47], s12 offen nt
  s_addk_i32 s12, 0x2000
  s_cmp_ge_u32 s12, s59
  s_cselect_b32 s12, s58, s12
  s_waitcnt vmcnt(3)
  s_bitcmp0_b32 s68, 0
  s_cbranch_scc1 L_th_35
  s_waitcnt vmcnt(2)
L_th_35:
  buffer_load_dwordx4 v[156:159], v2, s[44:47], s12 offen nt
  s_addk_i32 s12, 0x2000
  s_cmp_ge_u32 s12, s59
  s_cselect_b32 s12, s58, s12
  s_waitcnt vmcnt(3)
  s_bitcmp0_b32 s68, 0
  s_cbranch_scc1 L_th_36
  s_waitcnt vmcnt(2)
L_th_36:
  buffer_load_dwordx4 v[160:163], v2, s[44:47], s12 offen nt
  s_addk_i32 s12, 0x2000
  s_cmp_ge_u32 s12, s59
  s_cselect_b32 s12, s58, s12
  s_waitcnt vmcnt(3)
  s_bitcmp0_b32 s68, 0
  s_cbranch_scc1 L_th_37
  s_waitcnt vmcnt(2)
L_th_37:
  buffer_load_dwordx4 v[164:167], v2, s[44:47], s12 offen nt
  s_addk_i32 s12, 0x2000
  s_cmp_ge_u32 s12, s59
  s_cselect_b32 s12, s58, s12
  s_waitcnt vmcnt(3)
  s_bitcmp0_b32 s68, 0
  s_cbranch_scc1 L_th_38
  s_waitcnt vmcnt(2)
L_th_38:
  s_add_u32 m0, s15, 0
  s_nop 0
  buffer_load_dwordx4 v2, s[48:51], s12 offen nt lds
  s_addk_i32 s12, 0x2000
  s_waitcnt vmcnt(3)
  s_bitcmp0_b32 s68, 0
  s_cbranch_scc1 L_th_39
  s_waitcnt vmcnt(2)
L_th_39:
  s_add_u32 m0, s15, 1024
  s_nop 0
  buffer_load_dwordx4 v2, s[48:51], s12 offen nt lds
  s_addk_i32 s12, 0x2000
  s_waitcnt vmcnt(3)
  s_bitcmp0_b32 s68, 0
  s_cbranch_scc1 L_th_40
  s_waitcnt vmcnt(2)
L_th_40:
  s_add_u32 m0, s15, 2048
  s_nop 0
  buffer_load_dwordx4 v2, s[48:51], s12 offen nt lds
  s_addk_i32 s12, 0x2000
  ds_write_b32 v4, v4 offset:6664
  s_waitcnt vmcnt(3)
  s_bitcmp0_b32 s68, 0
  s_cbranch_scc1 L_th_41
  s_waitcnt vmcnt(2)
L_th_41:
  s_add_u32 m0, s15, 3072
  s_nop 0
  buffer_load_dwordx4 v2, s[48:51], s12 offen nt lds
  s_addk_i32 s12, 0x2000
  s_waitcnt vmcnt(3)
  s_add_u32 m0, s15, 4096
  s_nop 0
  buffer_load_dwordx4 v2, s[48:51], s12 offen nt lds
  s_addk_i32 s12, 0x2000
  s_waitcnt vmcnt(3)
  s_add_u32 m0, s15, 5120
  s_nop 0
  buffer_load_dwordx4 v2, s[48:51], s12 offen nt lds
  s_addk_i32 s12, 0x2000
  s_waitcnt vmcnt(3)
  s_add_u32 m0, s15, 6144
  s_nop 0
  buffer_load_dwordx4 v2, s[48:51], s12 offen nt lds
  s_addk_i32 s12, 0x2000
  s_waitcnt vmcnt(3)
  s_add_u32 m0, s15, 7168
  s_nop 0
  buffer_load_dwordx4 v2, s[48:51], s12 offen nt lds
  s_addk_i32 s12, 0x2000
  s_mov_b32 s70, 0
L_pl_42:
  ds_read_b128 v[4:7], v3 offset:6400
  s_waitcnt lgkmcnt(0)
  v_max3_u32 v8, v4, v5, v6
  v_max_u32 v8, v8, v7
  v_cmp_eq_u32 vcc, -1, v8
  s_cmp_eq_u64 vcc, 0
  s_cbranch_scc1 L_pld_43
  s_sleep 2
  s_add_u32 s70, s70, 1
  s_cmp_lt_u32 s70, 1048576
  s_cbranch_scc1 L_pl_42
L_pld_43:
  s_waitcnt vmcnt(8)
  v_dot2_f32_bf16 v8, v56, v4, 0
  v_dot2_f32_bf16 v9, v60, v4, 0
  v_dot2_f32_bf16 v10, v64, v4, 0
  v_dot2_f32_bf16 v11, v68, v4, 0
  v_dot2_f32_bf16 v12, v72, v4, 0
  v_dot2_f32_bf16 v13, v76, v4, 0
  v_dot2_f32_bf16 v14, v80, v4, 0
  v_dot2_f32_bf16 v15, v84, v4, 0
  v_dot2_f32_bf16 v8, v57, v5, v8
  v_dot2_f32_bf16 v9, v61, v5, v9
  v_dot2_f32_bf16 v10, v65, v5, v10
  v_dot2_f32_bf16 v11, v69, v5, v11
  v_dot2_f32_bf16 v12, v73, v5, v12
  v_dot2_f32_bf16 v13, v77, v5, v13
  v_dot2_f32_bf16 v14, v81, v5, v14
  v_dot2_f32_bf16 v15, v85, v5, v15
  v_dot2_f32_bf16 v8, v58, v6, v8
  v_dot2_f32_bf16 v9, v62, v6, v9
  v_dot2_f32_bf16 v10, v66, v6, v10
  v_dot2_f32_bf16 v11, v70, v6, v11
  v_dot2_f32_bf16 v12, v74, v6, v12
  v_dot2_f32_bf16 v13, v78, v6, v13
  v_dot2_f32_bf16 v14, v82, v6, v14
  v_dot2_f32_bf16 v15, v86, v6, v15
  v_dot2_f32_bf16 v8, v59, v7, v8
  v_dot2_f32_bf16 v9, v63, v7, v9
  v_dot2_f32_bf16 v10, v67, v7, v10
  v_dot2_f32_bf16 v11, v71, v7, v11
  v_dot2_f32_bf16 v12, v75, v7, v12
  v_dot2_f32_bf16 v13, v79, v7, v13
  v_dot2_f32_bf16 v14, v83, v7, v14
  v_dot2_f32_bf16 v15, v87, v7, v15
  v_add_f32_dpp v8, v8, v8 row_ror:8 row_mask:0xf bank_mask:0x3
  v_add_f32_dpp v8, v9, v9 row_ror:8 row_mask:0xf bank_mask:0xc
  v_add_f32_dpp v10, v10, v10 row_ror:8 row_mask:0xf bank_mask:0x3
  v_add_f32_dpp v10, v11, v11 row_ror:8 row_mask:0xf bank_mask:0xc
  v_add_f32_dpp v12, v12, v12 row_ror:8 row_mask:0xf bank_mask:0x3
  v_add_f32_dpp v12, v13, v13 row_ror:8 row_mask:0xf bank_mask:0xc
  v_add_f32_dpp v14, v14, v14 row_ror:8 row_mask:0xf bank_mask:0x3
  v_add_f32_dpp v14, v15, v15 row_ror:8 row_mask:0xf bank_mask:0xc
  v_add_f32_dpp v18, v8, v8 row_shl:4 row_mask:0xf bank_mask:0x5
  v_add_f32_dpp v18, v10, v10 row_shr:4 row_mask:0xf bank_mask:0xa
  v_add_f32_dpp v19, v12, v12 row_shl:4 row_mask:0xf bank_mask:0x5
  v_add_f32_dpp v19, v14, v14 row_shr:4 row_mask:0xf bank_mask:0xa
  v_dot2_f32_bf16 v8, v88, v4, 0
  v_dot2_f32_bf16 v9, v92, v4, 0
  v_dot2_f32_bf16 v10, v96, v4, 0
  v_dot2_f32_bf16 v11, v100, v4, 0
  v_dot2_f32_bf16 v12, v104, v4, 0
  v_dot2_f32_bf16 v13, v108, v4, 0
  v_dot2_f32_bf16 v14, v112, v4, 0
  v_dot2_f32_bf16 v15, v116, v4, 0
  v_dot2_f32_bf16 v8, v89, v5, v8
  v_dot2_f32_bf16 v9, v93, v5, v9
  v_dot2_f32_bf16 v10, v97, v5, v10
  v_dot2_f32_bf16 v11, v101, v5, v11
  v_dot2_f32_bf16 v12, v105, v5, v12
  v_dot2_f32_bf16 v13, v109, v5, v13
  v_dot2_f32_bf16 v14, v113, v5, v14
  v_dot2_f32_bf16 v15, v117, v5, v15
  v_dot2_f32_bf16 v8, v90, v6, v8
  v_dot2_f32_bf16 v9, v94, v6, v9
  v_dot2_f32_bf16 v10, v98, v6, v10
  v_dot2_f32_bf16 v11, v102, v6, v11
  v_dot2_f32_bf16 v12, v106, v6, v12
  v_dot2_f32_bf16 v13, v110, v6, v13
  v_dot2_f32_bf16 v14, v114, v6, v14
  v_dot2_f32_bf16 v15, v118, v6, v15
  v_dot2_f32_bf16 v8, v91, v7, v8
  v_dot2_f32_bf16 v9, v95, v7, v9
  v_dot2_f32_bf16 v10, v99, v7, v10
  v_dot2_f32_bf16 v11, v103, v7, v11
  v_dot2_f32_bf16 v12, v107, v7, v12
  v_dot2_f32_bf16 v13, v111, v7, v13
  v_dot2_f32_bf16 v14, v115, v7, v14
  v_dot2_f32_bf16 v15, v119, v7, v15
  v_add_f32_dpp v8, v8, v8 row_ror:8 row_mask:0xf bank_mask:0x3
  v_add_f32_dpp v8, v9, v9 row_ror:8 row_mask:0xf bank_mask:0xc
  v_add_f32_dpp v10, v10, v10 row_ror:8 row_mask:0xf bank_mask:0x3
  v_add_f32_dpp v10, v11, v11 row_ror:8 row_mask:0xf bank_mask:0xc
  v_add_f32_dpp v12, v12, v12 row_ror:8 row_mask:0xf bank_mask:0x3
  v_add_f32_dpp v12, v13, v13 row_ror:8 row_mask:0xf bank_mask:0xc
  v_add_f32_dpp v14, v14, v14 row_ror:8 row_mask:0xf bank_mask:0x3
  v_add_f32_dpp v14, v15, v15 row_ror:8 row_mask:0xf bank_mask:0xc
  v_add_f32_dpp v20, v8, v8 row_shl:4 row_mask:0xf bank_mask:0x5
  v_add_f32_dpp v20, v10, v10 row_shr:4 row_mask:0xf bank_mask:0xa
  v_add_f32_dpp v21, v12, v12 row_shl:4 row_mask:0xf bank_mask:0x5
  v_add_f32_dpp v21, v14, v14 row_shr:4 row_mask:0xf bank_mask:0xa
  v_dot2_f32_bf16 v8, v120, v4, 0
  v_dot2_f32_bf16 v9, v124, v4, 0
  v_dot2_f32_bf16 v10, v128, v4, 0
  v_dot2_f32_bf16 v11, v132, v4, 0
  v_dot2_f32_bf16 v12, v136, v4, 0
  v_dot2_f32_bf16 v13, v140, v4, 0
  v_dot2_f32_bf16 v14, v144, v4, 0
  v_dot2_f32_bf16 v15, v148, v4, 0
  v_dot2_f32_bf16 v8, v121, v5, v8
  v_dot2_f32_bf16 v9, v125, v5, v9
  v_dot2_f32_bf16 v10, v129, v5, v10
  v_dot2_f32_bf16 v11, v133, v5, v11
  v_dot2_f32_bf16 v12, v137, v5, v12
  v_dot2_f32_bf16 v13, v141, v5, v13
  v_dot2_f32_bf16 v14, v145, v5, v14
  v_dot2_f32_bf16 v15, v149, v5, v15
  v_dot2_f32_bf16 v8, v122, v6, v8
  v_dot2_f32_bf16 v9, v126, v6, v9
  v_dot2_f32_bf16 v10, v130, v6, v10
  v_dot2_f32_bf16 v11, v134, v6, v11
  v_dot2_f32_bf16 v12, v138, v6, v12
  v_dot2_f32_bf16 v13, v142, v6, v13
  v_dot2_f32_bf16 v14, v146, v6, v14
  v_dot2_f32_bf16 v15, v150, v6, v15
  v_dot2_f32_bf16 v8, v123, v7, v8
  v_dot2_f32_bf16 v9, v127, v7, v9
  v_dot2_f32_bf16 v10, v131, v7, v10
  v_dot2_f32_bf16 v11, v135, v7, v11
  v_dot2_f32_bf16 v12, v139, v7, v12
  v_dot2_f32_bf16 v13, v143, v7, v13
  v_dot2_f32_bf16 v14, v147, v7, v14
  v_dot2_f32_bf16 v15, v151, v7, v15
  buffer_load_dwordx4 v[88:91], v2, s[48:51], s12 offen nt
  s_addk_i32 s12, 0x2000
  v_add_f32_dpp v8, v8, v8 row_ror:8 row_mask:0xf bank_mask:0x3
  v_add_f32_dpp v8, v9, v9 row_ror:8 row_mask:0xf bank_mask:0xc
  v_add_f32_dpp v10, v10, v10 row_ror:8 row_mask:0xf bank_mask:0x3
  v_add_f32_dpp v10, v11, v11 row_ror:8 row_mask:0xf bank_mask:0xc
  v_add_f32_dpp v12, v12, v12 row_ror:8 row_mask:0xf bank_mask:0x3
  v_add_f32_dpp v12, v13, v13 row_ror:8 row_mask:0xf bank_mask:0xc
  v_add_f32_dpp v14, v14, v14 row_ror:8 row_mask:0xf bank_mask:0x3
  v_add_f32_dpp v14, v15, v15 row_ror:8 row_mask:0xf bank_mask:0xc
  v_add_f32_dpp v22, v8, v8 row_shl:4 row_mask:0xf bank_mask:0x5
  v_add_f32_dpp v22, v10, v10 row_shr:4 row_mask:0xf bank_mask:0xa
  v_add_f32_dpp v23, v12, v12 row_shl:4 row_mask:0xf bank_mask:0x5
  v_add_f32_dpp v23, v14, v14 row_shr:4 row_mask:0xf bank_mask:0xa
  v_dot2_f32_bf16 v8, v152, v4, 0
  v_dot2_f32_bf16 v9, v156, v4, 0
  v_dot2_f32_bf16 v10, v160, v4, 0
  v_dot2_f32_bf16 v11, v164, v4, 0
  v_dot2_f32_bf16 v8, v153, v5, v8
  v_dot2_f32_bf16 v9, v157, v5, v9
  v_dot2_f32_bf16 v10, v161, v5, v10
  v_dot2_f32_bf16 v11, v165, v5, v11
  v_dot2_f32_bf16 v8, v154, v6, v8
  v_dot2_f32_bf16 v9, v158, v6, v9
  v_dot2_f32_bf16 v10, v162, v6, v10
  v_dot2_f32_bf16 v11, v166, v6, v11
  v_dot2_f32_bf16 v8, v155, v7, v8
  v_dot2_f32_bf16 v9, v159, v7, v9
  v_dot2_f32_bf16 v10, v163, v7, v10
  v_dot2_f32_bf16 v11, v167, v7, v11
  v_add_f32_dpp v8, v8, v8 row_ror:8 row_mask:0xf bank_mask:0x3
  v_add_f32_dpp v8, v9, v9 row_ror:8 row_mask:0xf bank_mask:0xc
  v_add_f32_dpp v10, v10, v10 row_ror:8 row_mask:0xf bank_mask:0x3
  v_add_f32_dpp v10, v11, v11 row_ror:8 row_mask:0xf bank_mask:0xc
  s_nop 0
  v_add_f32_dpp v3, v8, v8 row_shl:4 row_mask:0xf bank_mask:0x5
  v_add_f32_dpp v3, v10, v10 row_shr:4 row_mask:0xf bank_mask:0xa
  v_dot2_f32_bf16 v8, v24, v4, 0
  v_dot2_f32_bf16 v9, v28, v4, 0
  v_dot2_f32_bf16 v10, v32, v4, 0
  v_dot2_f32_bf16 v11, v36, v4, 0
  v_dot2_f32_bf16 v12, v40, v4, 0
  v_dot2_f32_bf16 v13, v44, v4, 0
  v_dot2_f32_bf16 v14, v48, v4, 0
  v_dot2_f32_bf16 v15, v52, v4, 0
  v_dot2_f32_bf16 v8, v25, v5, v8
  v_dot2_f32_bf16 v9, v29, v5, v9
  v_dot2_f32_bf16 v10, v33, v5, v10
  v_dot2_f32_bf16 v11, v37, v5, v11
  v_dot2_f32_bf16 v12, v41, v5, v12
  v_dot2_f32_bf16 v13, v45, v5, v13
  v_dot2_f32_bf16 v14, v49, v5, v14
  v_dot2_f32_bf16 v15, v53, v5, v15
  v_dot2_f32_bf16 v8, v26, v6, v8
  v_dot2_f32_bf16 v9, v30, v6, v9
  v_dot2_f32_bf16 v10, v34, v6, v10
  v_dot2_f32_bf16 v11, v38, v6, v11
  v_dot2_f32_bf16 v12, v42, v6, v12
  v_dot2_f32_bf16 v13, v46, v6, v13
  v_dot2_f32_bf16 v14, v50, v6, v14
  v_dot2_f32_bf16 v15, v54, v6, v15
  v_dot2_f32_bf16 v8, v27, v7, v8
  v_dot2_f32_bf16 v9, v31, v7, v9
  v_dot2_f32_bf16 v10, v35, v7, v10
  v_dot2_f32_bf16 v11, v39, v7, v11
  v_dot2_f32_bf16 v12, v43, v7, v12
  v_dot2_f32_bf16 v13, v47, v7, v13
  v_dot2_f32_bf16 v14, v51, v7, v14
  v_dot2_f32_bf16 v15, v55, v7, v15
  buffer_load_dwordx4 v[92:95], v2, s[48:51], s12 offen nt
  s_addk_i32 s12, 0x2000
  v_add_f32_dpp v8, v8, v8 row_ror:8 row_mask:0xf bank_mask:0x3
  v_add_f32_dpp v8, v9, v9 row_ror:8 row_mask:0xf bank_mask:0xc
  v_add_f32_dpp v10, v10, v10 row_ror:8 row_mask:0xf bank_mask:0x3
  v_add_f32_dpp v10, v11, v11 row_ror:8 row_mask:0xf bank_mask:0xc
  v_add_f32_dpp v12, v12, v12 row_ror:8 row_mask:0xf bank_mask:0x3
  v_add_f32_dpp v12, v13, v13 row_ror:8 row_mask:0xf bank_mask:0xc
  v_add_f32_dpp v14, v14, v14 row_ror:8 row_mask:0xf bank_mask:0x3
  v_add_f32_dpp v14, v15, v15 row_ror:8 row_mask:0xf bank_mask:0xc
  v_add_f32_dpp v16, v8, v8 row_shl:4 row_mask:0xf bank_mask:0x5
  v_add_f32_dpp v16, v10, v10 row_shr:4 row_mask:0xf bank_mask:0xa
  v_add_f32_dpp v17, v12, v12 row_shl:4 row_mask:0xf bank_mask:0x5
  v_add_f32_dpp v17, v14, v14 row_shr:4 row_mask:0xf bank_mask:0xa
  v_add_f32_dpp v3, v3, v3 quad_perm:[2,3,0,1] row_mask:0xf bank_mask:0xf
  v_add_f32_dpp v18, v18, v18 quad_perm:[2,3,0,1] row_mask:0xf bank_mask:0xf
  v_add_f32_dpp v19, v19, v19 quad_perm:[2,3,0,1] row_mask:0xf bank_mask:0xf
  v_add_f32_dpp v20, v20, v20 quad_perm:[2,3,0,1] row_mask:0xf bank_mask:0xf
  v_add_f32_dpp v21, v21, v21 quad_perm:[2,3,0,1] row_mask:0xf bank_mask:0xf
  v_add_f32_dpp v22, v22, v22 quad_perm:[2,3,0,1] row_mask:0xf bank_mask:0xf
  v_add_f32_dpp v23, v23, v23 quad_perm:[2,3,0,1] row_mask:0xf bank_mask:0xf
  v_add_f32_dpp v16, v16, v16 quad_perm:[2,3,0,1] row_mask:0xf bank_mask:0xf
  v_add_f32_dpp v17, v17, v17 quad_perm:[2,3,0,1] row_mask:0xf bank_mask:0xf
  v_cndmask_b32 v8, v16, v17, s[52:53]
  v_cndmask_b32 v9, v18, v19, s[52:53]
  v_cndmask_b32 v10, v20, v21, s[52:53]
  v_cndmask_b32 v11, v22, v23, s[52:53]
  v_add_f32_dpp v18, v3, v3 quad_perm:[1,0,3,2] row_mask:0xf bank_mask:0xf
  v_add_f32_dpp v8, v8, v8 quad_perm:[1,0,3,2] row_mask:0xf bank_mask:0xf
  v_add_f32_dpp v9, v9, v9 quad_perm:[1,0,3,2] row_mask:0xf bank_mask:0xf
  v_add_f32_dpp v10, v10, v10 quad_perm:[1,0,3,2] row_mask:0xf bank_mask:0xf
  v_add_f32_dpp v11, v11, v11 quad_perm:[1,0,3,2] row_mask:0xf bank_mask:0xf
  v_cndmask_b32 v16, v8, v9, s[54:55]
  v_cndmask_b32 v17, v10, v11, s[54:55]
  v_cvt_pk_bf16_f32 v16, 0, v16
  v_cvt_pk_bf16_f32 v17, 0, v17
  v_cvt_pk_bf16_f32 v18, 0, v18
  v_mul_f32 v16, 0x3db504f3, v16
  v_mul_f32 v17, 0x3db504f3, v17
  v_mul_f32 v18, 0x3db504f3, v18
  v_cvt_pk_bf16_f32 v16, 0, v16
  v_cvt_pk_bf16_f32 v17, 0, v17
  v_cvt_pk_bf16_f32 v18, 0, v18
  v_mov_b32 v19, 0xff800000
  s_mov_b32 s52, 0xeeeeeeee
  s_mov_b32 s53, 0xeeeeeeee
  v_cndmask_b32 v16, v16, v19, s[66:67]
  v_cndmask_b32 v18, v18, v19, s[52:53]
  s_lshl_b32 s11, s9, 10
  v_lshl_add_u32 v3, v1, 4, s11
  ds_write_b128 v3, v[16:19] offset:12032
  s_waitcnt vmcnt(3)
  buffer_load_dwordx4 v[96:99], v2, s[48:51], s12 offen nt
  s_addk_i32 s12, 0x2000
  s_waitcnt vmcnt(3)
  buffer_load_dwordx4 v[100:103], v2, s[48:51], s12 offen nt
  s_addk_i32 s12, 0x2000
  v_lshl_add_u32 v3, v1, 4, s15
  ds_read_b128 v[56:59], v3 offset:0
  ds_read_b128 v[60:63], v3 offset:1024
  ds_read_b128 v[64:67], v3 offset:2048
  ds_read_b128 v[68:71], v3 offset:3072
  ds_read_b128 v[72:75], v3 offset:4096
  ds_read_b128 v[76:79], v3 offset:5120
  ds_read_b128 v[80:83], v3 offset:6144
  ds_read_b128 v[84:87], v3 offset:7168
  v_max3_f32 v22, v16, v17, v18
  s_nop 1
  v_max_f32_dpp v22, v22, v22 row_ror:8 row_mask:0xf bank_mask:0xf
  s_nop 1
  v_max_f32_dpp v22, v22, v22 row_ror:4 row_mask:0xf bank_mask:0xf
  s_nop 1
  v_max_f32_dpp v22, v22, v22 row_ror:2 row_mask:0xf bank_mask:0xf
  s_nop 1
  v_max_f32_dpp v22, v22, v22 row_ror:1 row_mask:0xf bank_mask:0xf
  v_mov_b32 v23, v22
  s_nop 1
  v_permlane16_swap_b32 v23, v22
  v_max_f32 v22, v22, v23
  v_mov_b32 v23, v22
  s_nop 1
  v_permlane32_swap_b32 v23, v22
  v_max_f32 v22, v22, v23
  v_sub_f32 v16, v16, v22
  v_sub_f32 v17, v17, v22
  v_sub_f32 v18, v18, v22
  v_mul_f32 v16, 0x3fb8aa3b, v16
  v_mul_f32 v17, 0x3fb8aa3b, v17
  v_mul_f32 v18, 0x3fb8aa3b, v18
  v_exp_f32 v16, v16
  v_exp_f32 v17, v17
  v_exp_f32 v18, v18
  s_nop 0
  v_cvt_pk_bf16_f32 v4, v16, 0
  v_cvt_pk_bf16_f32 v5, 0, v16
  v_cvt_pk_bf16_f32 v6, v17, 0
  v_cvt_pk_bf16_f32 v7, 0, v17
  v_cvt_pk_bf16_f32 v20, v18, 0
  v_cvt_pk_bf16_f32 v21, 0, v18
  v_mov_b32 v8, 0
  v_mov_b32 v9, 0
  v_mov_b32 v10, 0
  v_mov_b32 v11, 0
  v_mov_b32 v12, 0
  v_mov_b32 v13, 0
  v_mov_b32 v14, 0
  v_mov_b32 v15, 0
  s_lshl_b32 s11, s9, 9
  v_and_b32 v3, 15, v1
  v_lshlrev_b32 v3, 5, v3
  v_lshrrev_b32 v16, 4, v1
  v_lshl_add_u32 v3, v16, 3, v3
  v_add_u32 v3, s11, v3
  v_mov_b32 v16, 6656
  s_waitcnt lgkmcnt(0)
  s_mov_b32 s13, s61
  s_cmp_gt_u32 s60, 7
  s_cbranch_scc1 L_opts_44
  s_waitcnt vmcnt(3)
  buffer_load_dwordx4 v[52:55], v2, s[48:51], s13 offen nt
  s_addk_i32 s13, 0x2000
  s_cmp_gt_u32 s60, 6
  s_cbranch_scc1 L_opts_44
  s_waitcnt vmcnt(3)
  buffer_load_dwordx4 v[48:51], v2, s[48:51], s13 offen nt
  s_addk_i32 s13, 0x2000
  s_cmp_gt_u32 s60, 5
  s_cbranch_scc1 L_opts_44
  s_waitcnt vmcnt(3)
  buffer_load_dwordx4 v[44:47], v2, s[48:51], s13 offen nt
  s_addk_i32 s13, 0x2000
  s_cmp_gt_u32 s60, 4
  s_cbranch_scc1 L_opts_44
  s_waitcnt vmcnt(3)
  buffer_load_dwordx4 v[40:43], v2, s[48:51], s13 offen nt
  s_addk_i32 s13, 0x2000
  s_cmp_gt_u32 s60, 3
  s_cbranch_scc1 L_opts_44
  s_waitcnt vmcnt(3)
  buffer_load_dwordx4 v[36:39], v2, s[48:51], s13 offen nt
  s_addk_i32 s13, 0x2000
  s_cmp_gt_u32 s60, 2
  s_cbranch_scc1 L_opts_44
  s_waitcnt vmcnt(3)
  buffer_load_dwordx4 v[32:35], v2, s[48:51], s13 offen nt
  s_addk_i32 s13, 0x2000
  s_cmp_gt_u32 s60, 1
  s_cbranch_scc1 L_opts_44
  s_waitcnt vmcnt(3)
  buffer_load_dwordx4 v[28:31], v2, s[48:51], s13 offen nt
  s_addk_i32 s13, 0x2000
  s_cmp_gt_u32 s60, 0
  s_cbranch_scc1 L_opts_44
  s_waitcnt vmcnt(3)
  buffer_load_dwordx4 v[24:27], v2, s[48:51], s13 offen nt
  s_addk_i32 s13, 0x2000
L_opts_44:
  s_waitcnt vmcnt(3)
  buffer_load_dwordx4 v[104:107], v2, s[48:51], s12 offen nt
  s_addk_i32 s12, 0x2000
  s_cmp_ge_u32 s12, s59
  s_cselect_b32 s12, s58, s12
  v_dot2c_f32_bf16_dpp v8, v4, v56 row_newbcast:1 row_mask:0xf bank_mask:0xf
  v_dot2c_f32_bf16_dpp v9, v5, v56 row_newbcast:1 row_mask:0xf bank_mask:0xf
  v_dot2c_f32_bf16_dpp v10, v4, v57 row_newbcast:1 row_mask:0xf bank_mask:0xf
  v_dot2c_f32_bf16_dpp v11, v5, v57 row_newbcast:1 row_mask:0xf bank_mask:0xf
  v_dot2c_f32_bf16_dpp v12, v4, v58 row_newbcast:1 row_mask:0xf bank_mask:0xf
  v_dot2c_f32_bf16_dpp v13, v5, v58 row_newbcast:1 row_mask:0xf bank_mask:0xf
  v_dot2c_f32_bf16_dpp v14, v4, v59 row_newbcast:1 row_mask:0xf bank_mask:0xf
  v_dot2c_f32_bf16_dpp v15, v5, v59 row_newbcast:1 row_mask:0xf bank_mask:0xf
  v_dot2c_f32_bf16_dpp v8, v4, v60 row_newbcast:9 row_mask:0xf bank_mask:0xf
  v_dot2c_f32_bf16_dpp v9, v5, v60 row_newbcast:9 row_mask:0xf bank_mask:0xf
  v_dot2c_f32_bf16_dpp v10, v4, v61 row_newbcast:9 row_mask:0xf bank_mask:0xf
  v_dot2c_f32_bf16_dpp v11, v5, v61 row_newbcast:9 row_mask:0xf bank_mask:0xf
  v_dot2c_f32_bf16_dpp v12, v4, v62 row_newbcast:9 row_mask:0xf bank_mask:0xf
  v_dot2c_f32_bf16_dpp v13, v5, v62 row_newbcast:9 row_mask:0xf bank_mask:0xf
  v_dot2c_f32_bf16_dpp v14, v4, v63 row_newbcast:9 row_mask:0xf bank_mask:0xf
  v_dot2c_f32_bf16_dpp v15, v5, v63 row_newbcast:9 row_mask:0xf bank_mask:0xf
  v_dot2c_f32_bf16_dpp v8, v4, v64 row_newbcast:5 row_mask:0xf bank_mask:0xf
  v_dot2c_f32_bf16_dpp v9, v5, v64 row_newbcast:5 row_mask:0xf bank_mask:0xf
  v_dot2c_f32_bf16_dpp v10, v4, v65 row_newbcast:5 row_mask:0xf bank_mask:0xf
  v_dot2c_f32_bf16_dpp v11, v5, v65 row_newbcast:5 row_mask:0xf bank_mask:0xf
  v_dot2c_f32_bf16_dpp v12, v4, v66 row_newbcast:5 row_mask:0xf bank_mask:0xf
  v_dot2c_f32_bf16_dpp v13, v5, v66 row_newbcast:5 row_mask:0xf bank_mask:0xf
  v_dot2c_f32_bf16_dpp v14, v4, v67 row_newbcast:5 row_mask:0xf bank_mask:0xf
  v_dot2c_f32_bf16_dpp v15, v5, v67 row_newbcast:5 row_mask:0xf bank_mask:0xf
  s_waitcnt vmcnt(3)
  buffer_load_dwordx4 v[108:111], v2, s[48:51], s12 offen nt
  s_addk_i32 s12, 0x2000
  s_cmp_ge_u32 s12, s59
  s_cselect_b32 s12, s58, s12
  v_dot2c_f32_bf16_dpp v8, v4, v68 row_newbcast:13 row_mask:0xf bank_mask:0xf
  v_dot2c_f32_bf16_dpp v9, v5, v68 row_newbcast:13 row_mask:0xf bank_mask:0xf
  v_dot2c_f32_bf16_dpp v10, v4, v69 row_newbcast:13 row_mask:0xf bank_mask:0xf
  v_dot2c_f32_bf16_dpp v11, v5, v69 row_newbcast:13 row_mask:0xf bank_mask:0xf
  v_dot2c_f32_bf16_dpp v12, v4, v70 row_newbcast:13 row_mask:0xf bank_mask:0xf
  v_dot2c_f32_bf16_dpp v13, v5, v70 row_newbcast:13 row_mask:0xf bank_mask:0xf
  v_dot2c_f32_bf16_dpp v14, v4, v71 row_newbcast:13 row_mask:0xf bank_mask:0xf
  v_dot2c_f32_bf16_dpp v15, v5, v71 row_newbcast:13 row_mask:0xf bank_mask:0xf
  v_dot2c_f32_bf16_dpp v8, v4, v72 row_newbcast:3 row_mask:0xf bank_mask:0xf
  v_dot2c_f32_bf16_dpp v9, v5, v72 row_newbcast:3 row_mask:0xf bank_mask:0xf
  v_dot2c_f32_bf16_dpp v10, v4, v73 row_newbcast:3 row_mask:0xf bank_mask:0xf
  v_dot2c_f32_bf16_dpp v11, v5, v73 row_newbcast:3 row_mask:0xf bank_mask:0xf
  v_dot2c_f32_bf16_dpp v12, v4, v74 row_newbcast:3 row_mask:0xf bank_mask:0xf
  v_dot2c_f32_bf16_dpp v13, v5, v74 row_newbcast:3 row_mask:0xf bank_mask:0xf
  v_dot2c_f32_bf16_dpp v14, v4, v75 row_newbcast:3 row_mask:0xf bank_mask:0xf
  v_dot2c_f32_bf16_dpp v15, v5, v75 row_newbcast:3 row_mask:0xf bank_mask:0xf
  v_dot2c_f32_bf16_dpp v8, v4, v76 row_newbcast:11 row_mask:0xf bank_mask:0xf
  v_dot2c_f32_bf16_dpp v9, v5, v76 row_newbcast:11 row_mask:0xf bank_mask:0xf
  v_dot2c_f32_bf16_dpp v10, v4, v77 row_newbcast:11 row_mask:0xf bank_mask:0xf
  v_dot2c_f32_bf16_dpp v11, v5, v77 row_newbcast:11 row_mask:0xf bank_mask:0xf
  v_dot2c_f32_bf16_dpp v12, v4, v78 row_newbcast:11 row_mask:0xf bank_mask:0xf
  v_dot2c_f32_bf16_dpp v13, v5, v78 row_newbcast:11 row_mask:0xf bank_mask:0xf
  v_dot2c_f32_bf16_dpp v14, v4, v79 row_newbcast:11 row_mask:0xf bank_mask:0xf
  v_dot2c_f32_bf16_dpp v15, v5, v79 row_newbcast:11 row_mask:0xf bank_mask:0xf
  s_waitcnt vmcnt(3)
  buffer_load_dwordx4 v[112:115], v2, s[48:51], s12 offen nt
  s_addk_i32 s12, 0x2000
  s_cmp_ge_u32 s12, s59
  s_cselect_b32 s12, s58, s12
  v_dot2c_f32_bf16_dpp v8, v4, v80 row_newbcast:7 row_mask:0xf bank_mask:0xf
  v_dot2c_f32_bf16_dpp v9, v5, v80 row_newbcast:7 row_mask:0xf bank_mask:0xf
  v_dot2c_f32_bf16_dpp v10, v4, v81 row_newbcast:7 row_mask:0xf bank_mask:0xf
  v_dot2c_f32_bf16_dpp v11, v5, v81 row_newbcast:7 row_mask:0xf bank_mask:0xf
  v_dot2c_f32_bf16_dpp v12, v4, v82 row_newbcast:7 row_mask:0xf bank_mask:0xf
  v_dot2c_f32_bf16_dpp v13, v5, v82 row_newbcast:7 row_mask:0xf bank_mask:0xf
  v_dot2c_f32_bf16_dpp v14, v4, v83 row_newbcast:7 row_mask:0xf bank_mask:0xf
  v_dot2c_f32_bf16_dpp v15, v5, v83 row_newbcast:7 row_mask:0xf bank_mask:0xf
  v_dot2c_f32_bf16_dpp v8, v4, v84 row_newbcast:15 row_mask:0xf bank_mask:0xf
  v_dot2c_f32_bf16_dpp v9, v5, v84 row_newbcast:15 row_mask:0xf bank_mask:0xf
  v_dot2c_f32_bf16_dpp v10, v4, v85 row_newbcast:15 row_mask:0xf bank_mask:0xf
  v_dot2c_f32_bf16_dpp v11, v5, v85 row_newbcast:15 row_mask:0xf bank_mask:0xf
  v_dot2c_f32_bf16_dpp v12, v4, v86 row_newbcast:15 row_mask:0xf bank_mask:0xf
  v_dot2c_f32_bf16_dpp v13, v5, v86 row_newbcast:15 row_mask:0xf bank_mask:0xf
  v_dot2c_f32_bf16_dpp v14, v4, v87 row_newbcast:15 row_mask:0xf bank_mask:0xf
  v_dot2c_f32_bf16_dpp v15, v5, v87 row_newbcast:15 row_mask:0xf bank_mask:0xf
  v_dot2c_f32_bf16_dpp v8, v6, v88 row_newbcast:0 row_mask:0xf bank_mask:0xf
  v_dot2c_f32_bf16_dpp v9, v7, v88 row_newbcast:0 row_mask:0xf bank_mask:0xf
  v_dot2c_f32_bf16_dpp v10, v6, v89 row_newbcast:0 row_mask:0xf bank_mask:0xf
  v_dot2c_f32_bf16_dpp v11, v7, v89 row_newbcast:0 row_mask:0xf bank_mask:0xf
  v_dot2c_f32_bf16_dpp v12, v6, v90 row_newbcast:0 row_mask:0xf bank_mask:0xf
  v_dot2c_f32_bf16_dpp v13, v7, v90 row_newbcast:0 row_mask:0xf bank_mask:0xf
  v_dot2c_f32_bf16_dpp v14, v6, v91 row_newbcast:0 row_mask:0xf bank_mask:0xf
  v_dot2c_f32_bf16_dpp v15, v7, v91 row_newbcast:0 row_mask:0xf bank_mask:0xf
  s_waitcnt vmcnt(3)
  buffer_load_dwordx4 v[116:119], v2, s[48:51], s12 offen nt
  s_addk_i32 s12, 0x2000
  s_cmp_ge_u32 s12, s59
  s_cselect_b32 s12, s58, s12
  v_dot2c_f32_bf16_dpp v8, v6, v92 row_newbcast:8 row_mask:0xf bank_mask:0xf
  v_dot2c_f32_bf16_dpp v9, v7, v92 row_newbcast:8 row_mask:0xf bank_mask:0xf
  v_dot2c_f32_bf16_dpp v10, v6, v93 row_newbcast:8 row_mask:0xf bank_mask:0xf
  v_dot2c_f32_bf16_dpp v11, v7, v93 row_newbcast:8 row_mask:0xf bank_mask:0xf
  v_dot2c_f32_bf16_dpp v12, v6, v94 row_newbcast:8 row_mask:0xf bank_mask:0xf
  v_dot2c_f32_bf16_dpp v13, v7, v94 row_newbcast:8 row_mask:0xf bank_mask:0xf
  v_dot2c_f32_bf16_dpp v14, v6, v95 row_newbcast:8 row_mask:0xf bank_mask:0xf
  v_dot2c_f32_bf16_dpp v15, v7, v95 row_newbcast:8 row_mask:0xf bank_mask:0xf
  v_dot2c_f32_bf16_dpp v8, v6, v96 row_newbcast:4 row_mask:0xf bank_mask:0xf
  v_dot2c_f32_bf16_dpp v9, v7, v96 row_newbcast:4 row_mask:0xf bank_mask:0xf
  v_dot2c_f32_bf16_dpp v10, v6, v97 row_newbcast:4 row_mask:0xf bank_mask:0xf
  v_dot2c_f32_bf16_dpp v11, v7, v97 row_newbcast:4 row_mask:0xf bank_mask:0xf
  v_dot2c_f32_bf16_dpp v12, v6, v98 row_newbcast:4 row_mask:0xf bank_mask:0xf
  v_dot2c_f32_bf16_dpp v13, v7, v98 row_newbcast:4 row_mask:0xf bank_mask:0xf
  v_dot2c_f32_bf16_dpp v14, v6, v99 row_newbcast:4 row_mask:0xf bank_mask:0xf
  v_dot2c_f32_bf16_dpp v15, v7, v99 row_newbcast:4 row_mask:0xf bank_mask:0xf
  v_dot2c_f32_bf16_dpp v8, v6, v100 row_newbcast:12 row_mask:0xf bank_mask:0xf
  v_dot2c_f32_bf16_dpp v9, v7, v100 row_newbcast:12 row_mask:0xf bank_mask:0xf
  v_dot2c_f32_bf16_dpp v10, v6, v101 row_newbcast:12 row_mask:0xf bank_mask:0xf
  v_dot2c_f32_bf16_dpp v11, v7, v101 row_newbcast:12 row_mask:0xf bank_mask:0xf
  v_dot2c_f32_bf16_dpp v12, v6, v102 row_newbcast:12 row_mask:0xf bank_mask:0xf
  v_dot2c_f32_bf16_dpp v13, v7, v102 row_newbcast:12 row_mask:0xf bank_mask:0xf
  v_dot2c_f32_bf16_dpp v14, v6, v103 row_newbcast:12 row_mask:0xf bank_mask:0xf
  v_dot2c_f32_bf16_dpp v15, v7, v103 row_newbcast:12 row_mask:0xf bank_mask:0xf
  s_waitcnt vmcnt(3)
  buffer_load_dwordx4 v[120:123], v2, s[48:51], s12 offen nt
  s_addk_i32 s12, 0x2000
  s_cmp_ge_u32 s12, s59
  s_cselect_b32 s12, s58, s12
  ds_write_b32 v16, v16 offset:20
  s_cmp_gt_u32 s60, 7
  s_cbranch_scc1 L_opt_45
  v_dot2c_f32_bf16_dpp v8, v4, v52 row_newbcast:14 row_mask:0xf bank_mask:0xf
  v_dot2c_f32_bf16_dpp v9, v5, v52 row_newbcast:14 row_mask:0xf bank_mask:0xf
  v_dot2c_f32_bf16_dpp v10, v4, v53 row_newbcast:14 row_mask:0xf bank_mask:0xf
  v_dot2c_f32_bf16_dpp v11, v5, v53 row_newbcast:14 row_mask:0xf bank_mask:0xf
  v_dot2c_f32_bf16_dpp v12, v4, v54 row_newbcast:14 row_mask:0xf bank_mask:0xf
  v_dot2c_f32_bf16_dpp v13, v5, v54 row_newbcast:14 row_mask:0xf bank_mask:0xf
  v_dot2c_f32_bf16_dpp v14, v4, v55 row_newbcast:14 row_mask:0xf bank_mask:0xf
  v_dot2c_f32_bf16_dpp v15, v5, v55 row_newbcast:14 row_mask:0xf bank_mask:0xf
L_opt_45:
  s_cmp_gt_u32 s60, 6
  s_cbranch_scc1 L_opt_46
  v_dot2c_f32_bf16_dpp v8, v4, v48 row_newbcast:6 row_mask:0xf bank_mask:0xf
  v_dot2c_f32_bf16_dpp v9, v5, v48 row_newbcast:6 row_mask:0xf bank_mask:0xf
  v_dot2c_f32_bf16_dpp v10, v4, v49 row_newbcast:6 row_mask:0xf bank_mask:0xf
  v_dot2c_f32_bf16_dpp v11, v5, v49 row_newbcast:6 row_mask:0xf bank_mask:0xf
  v_dot2c_f32_bf16_dpp v12, v4, v50 row_newbcast:6 row_mask:0xf bank_mask:0xf
  v_dot2c_f32_bf16_dpp v13, v5, v50 row_newbcast:6 row_mask:0xf bank_mask:0xf
  v_dot2c_f32_bf16_dpp v14, v4, v51 row_newbcast:6 row_mask:0xf bank_mask:0xf
  v_dot2c_f32_bf16_dpp v15, v5, v51 row_newbcast:6 row_mask:0xf bank_mask:0xf
L_opt_46:
  s_cmp_gt_u32 s60, 5
  s_cbranch_scc1 L_opt_47
  v_dot2c_f32_bf16_dpp v8, v4, v44 row_newbcast:10 row_mask:0xf bank_mask:0xf
  v_dot2c_f32_bf16_dpp v9, v5, v44 row_newbcast:10 row_mask:0xf bank_mask:0xf
  v_dot2c_f32_bf16_dpp v10, v4, v45 row_newbcast:10 row_mask:0xf bank_mask:0xf
  v_dot2c_f32_bf16_dpp v11, v5, v45 row_newbcast:10 row_mask:0xf bank_mask:0xf
  v_dot2c_f32_bf16_dpp v12, v4, v46 row_newbcast:10 row_mask:0xf bank_mask:0xf
  v_dot2c_f32_bf16_dpp v13, v5, v46 row_newbcast:10 row_mask:0xf bank_mask:0xf
  v_dot2c_f32_bf16_dpp v14, v4, v47 row_newbcast:10 row_mask:0xf bank_mask:0xf
  v_dot2c_f32_bf16_dpp v15, v5, v47 row_newbcast:10 row_mask:0xf bank_mask:0xf
L_opt_47:
  s_waitcnt vmcnt(3)
  buffer_load_dwordx4 v[124:127], v2, s[48:51], s12 offen nt
  s_addk_i32 s12, 0x2000
  s_cmp_ge_u32 s12, s59
  s_cselect_b32 s12, s58, s12
  s_cmp_gt_u32 s60, 4
  s_cbranch_scc1 L_opt_48
  v_dot2c_f32_bf16_dpp v8, v4, v40 row_newbcast:2 row_mask:0xf bank_mask:0xf
  v_dot2c_f32_bf16_dpp v9, v5, v40 row_newbcast:2 row_mask:0xf bank_mask:0xf
  v_dot2c_f32_bf16_dpp v10, v4, v41 row_newbcast:2 row_mask:0xf bank_mask:0xf
  v_dot2c_f32_bf16_dpp v11, v5, v41 row_newbcast:2 row_mask:0xf bank_mask:0xf
  v_dot2c_f32_bf16_dpp v12, v4, v42 row_newbcast:2 row_mask:0xf bank_mask:0xf
  v_dot2c_f32_bf16_dpp v13, v5, v42 row_newbcast:2 row_mask:0xf bank_mask:0xf
  v_dot2c_f32_bf16_dpp v14, v4, v43 row_newbcast:2 row_mask:0xf bank_mask:0xf
  v_dot2c_f32_bf16_dpp v15, v5, v43 row_newbcast:2 row_mask:0xf bank_mask:0xf
L_opt_48:
  s_cmp_gt_u32 s60, 3
  s_cbranch_scc1 L_opt_49
  v_dot2c_f32_bf16_dpp v8, v4, v36 row_newbcast:12 row_mask:0xf bank_mask:0xf
  v_dot2c_f32_bf16_dpp v9, v5, v36 row_newbcast:12 row_mask:0xf bank_mask:0xf
  v_dot2c_f32_bf16_dpp v10, v4, v37 row_newbcast:12 row_mask:0xf bank_mask:0xf
  v_dot2c_f32_bf16_dpp v11, v5, v37 row_newbcast:12 row_mask:0xf bank_mask:0xf
  v_dot2c_f32_bf16_dpp v12, v4, v38 row_newbcast:12 row_mask:0xf bank_mask:0xf
  v_dot2c_f32_bf16_dpp v13, v5, v38 row_newbcast:12 row_mask:0xf bank_mask:0xf
  v_dot2c_f32_bf16_dpp v14, v4, v39 row_newbcast:12 row_mask:0xf bank_mask:0xf
  v_dot2c_f32_bf16_dpp v15, v5, v39 row_newbcast:12 row_mask:0xf bank_mask:0xf
L_opt_49:
  s_cmp_gt_u32 s60, 2
  s_cbranch_scc1 L_opt_50
  v_dot2c_f32_bf16_dpp v8, v4, v32 row_newbcast:4 row_mask:0xf bank_mask:0xf
  v_dot2c_f32_bf16_dpp v9, v5, v32 row_newbcast:4 row_mask:0xf bank_mask:0xf
  v_dot2c_f32_bf16_dpp v10, v4, v33 row_newbcast:4 row_mask:0xf bank_mask:0xf
  v_dot2c_f32_bf16_dpp v11, v5, v33 row_newbcast:4 row_mask:0xf bank_mask:0xf
  v_dot2c_f32_bf16_dpp v12, v4, v34 row_newbcast:4 row_mask:0xf bank_mask:0xf
  v_dot2c_f32_bf16_dpp v13, v5, v34 row_newbcast:4 row_mask:0xf bank_mask:0xf
  v_dot2c_f32_bf16_dpp v14, v4, v35 row_newbcast:4 row_mask:0xf bank_mask:0xf
  v_dot2c_f32_bf16_dpp v15, v5, v35 row_newbcast:4 row_mask:0xf bank_mask:0xf
L_opt_50:
  s_waitcnt vmcnt(3)
  buffer_load_dwordx4 v[128:131], v2, s[48:51], s12 offen nt
  s_addk_i32 s12, 0x2000
  s_cmp_ge_u32 s12, s59
  s_cselect_b32 s12, s58, s12
  s_cmp_gt_u32 s60, 1
  s_cbranch_scc1 L_opt_51
  v_dot2c_f32_bf16_dpp v8, v4, v28 row_newbcast:8 row_mask:0xf bank_mask:0xf
  v_dot2c_f32_bf16_dpp v9, v5, v28 row_newbcast:8 row_mask:0xf bank_mask:0xf
  v_dot2c_f32_bf16_dpp v10, v4, v29 row_newbcast:8 row_mask:0xf bank_mask:0xf
  v_dot2c_f32_bf16_dpp v11, v5, v29 row_newbcast:8 row_mask:0xf bank_mask:0xf
  v_dot2c_f32_bf16_dpp v12, v4, v30 row_newbcast:8 row_mask:0xf bank_mask:0xf
  v_dot2c_f32_bf16_dpp v13, v5, v30 row_newbcast:8 row_mask:0xf bank_mask:0xf
  v_dot2c_f32_bf16_dpp v14, v4, v31 row_newbcast:8 row_mask:0xf bank_mask:0xf
  v_dot2c_f32_bf16_dpp v15, v5, v31 row_newbcast:8 row_mask:0xf bank_mask:0xf
L_opt_51:
  s_cmp_gt_u32 s60, 0
  s_cbranch_scc1 L_opt_52
  v_dot2c_f32_bf16_dpp v8, v4, v24 row_newbcast:0 row_mask:0xf bank_mask:0xf
  v_dot2c_f32_bf16_dpp v9, v5, v24 row_newbcast:0 row_mask:0xf bank_mask:0xf
  v_dot2c_f32_bf16_dpp v10, v4, v25 row_newbcast:0 row_mask:0xf bank_mask:0xf
  v_dot2c_f32_bf16_dpp v11, v5, v25 row_newbcast:0 row_mask:0xf bank_mask:0xf
  v_dot2c_f32_bf16_dpp v12, v4, v26 row_newbcast:0 row_mask:0xf bank_mask:0xf
  v_dot2c_f32_bf16_dpp v13, v5, v26 row_newbcast:0 row_mask:0xf bank_mask:0xf
  v_dot2c_f32_bf16_dpp v14, v4, v27 row_newbcast:0 row_mask:0xf bank_mask:0xf
  v_dot2c_f32_bf16_dpp v15, v5, v27 row_newbcast:0 row_mask:0xf bank_mask:0xf
L_opt_52:
  v_dot2c_f32_bf16_dpp v8, v6, v104 row_newbcast:2 row_mask:0xf bank_mask:0xf
  v_dot2c_f32_bf16_dpp v9, v7, v104 row_newbcast:2 row_mask:0xf bank_mask:0xf
  v_dot2c_f32_bf16_dpp v10, v6, v105 row_newbcast:2 row_mask:0xf bank_mask:0xf
  v_dot2c_f32_bf16_dpp v11, v7, v105 row_newbcast:2 row_mask:0xf bank_mask:0xf
  v_dot2c_f32_bf16_dpp v12, v6, v106 row_newbcast:2 row_mask:0xf bank_mask:0xf
  v_dot2c_f32_bf16_dpp v13, v7, v106 row_newbcast:2 row_mask:0xf bank_mask:0xf
  v_dot2c_f32_bf16_dpp v14, v6, v107 row_newbcast:2 row_mask:0xf bank_mask:0xf
  v_dot2c_f32_bf16_dpp v15, v7, v107 row_newbcast:2 row_mask:0xf bank_mask:0xf
  s_waitcnt vmcnt(3)
  buffer_load_dwordx4 v[132:135], v2, s[48:51], s12 offen nt
  s_addk_i32 s12, 0x2000
  s_cmp_ge_u32 s12, s59
  s_cselect_b32 s12, s58, s12
  v_dot2c_f32_bf16_dpp v8, v6, v108 row_newbcast:10 row_mask:0xf bank_mask:0xf
  v_dot2c_f32_bf16_dpp v9, v7, v108 row_newbcast:10 row_mask:0xf bank_mask:0xf
  v_dot2c_f32_bf16_dpp v10, v6, v109 row_newbcast:10 row_mask:0xf bank_mask:0xf
  v_dot2c_f32_bf16_dpp v11, v7, v109 row_newbcast:10 row_mask:0xf bank_mask:0xf
  v_dot2c_f32_bf16_dpp v12, v6, v110 row_newbcast:10 row_mask:0xf bank_mask:0xf
  v_dot2c_f32_bf16_dpp v13, v7, v110 row_newbcast:10 row_mask:0xf bank_mask:0xf
  v_dot2c_f32_bf16_dpp v14, v6, v111 row_newbcast:10 row_mask:0xf bank_mask:0xf
  v_dot2c_f32_bf16_dpp v15, v7, v111 row_newbcast:10 row_mask:0xf bank_mask:0xf
  v_dot2c_f32_bf16_dpp v8, v6, v112 row_newbcast:6 row_mask:0xf bank_mask:0xf
  v_dot2c_f32_bf16_dpp v9, v7, v112 row_newbcast:6 row_mask:0xf bank_mask:0xf
  v_dot2c_f32_bf16_dpp v10, v6, v113 row_newbcast:6 row_mask:0xf bank_mask:0xf
  v_dot2c_f32_bf16_dpp v11, v7, v113 row_newbcast:6 row_mask:0xf bank_mask:0xf
  v_dot2c_f32_bf16_dpp v12, v6, v114 row_newbcast:6 row_mask:0xf bank_mask:0xf
  v_dot2c_f32_bf16_dpp v13, v7, v114 row_newbcast:6 row_mask:0xf bank_mask:0xf
  v_dot2c_f32_bf16_dpp v14, v6, v115 row_newbcast:6 row_mask:0xf bank_mask:0xf
  v_dot2c_f32_bf16_dpp v15, v7, v115 row_newbcast:6 row_mask:0xf bank_mask:0xf
  v_dot2c_f32_bf16_dpp v8, v6, v116 row_newbcast:14 row_mask:0xf bank_mask:0xf
  v_dot2c_f32_bf16_dpp v9, v7, v116 row_newbcast:14 row_mask:0xf bank_mask:0xf
  v_dot2c_f32_bf16_dpp v10, v6, v117 row_newbcast:14 row_mask:0xf bank_mask:0xf
  v_dot2c_f32_bf16_dpp v11, v7, v117 row_newbcast:14 row_mask:0xf bank_mask:0xf
  v_dot2c_f32_bf16_dpp v12, v6, v118 row_newbcast:14 row_mask:0xf bank_mask:0xf
  v_dot2c_f32_bf16_dpp v13, v7, v118 row_newbcast:14 row_mask:0xf bank_mask:0xf
  v_dot2c_f32_bf16_dpp v14, v6, v119 row_newbcast:14 row_mask:0xf bank_mask:0xf
  v_dot2c_f32_bf16_dpp v15, v7, v119 row_newbcast:14 row_mask:0xf bank_mask:0xf
  s_waitcnt vmcnt(3)
  buffer_load_dwordx4 v[136:139], v2, s[48:51], s12 offen nt
  s_addk_i32 s12, 0x2000
  s_cmp_ge_u32 s12, s59
  s_cselect_b32 s12, s58, s12
  v_dot2c_f32_bf16_dpp v8, v6, v120 row_newbcast:1 row_mask:0xf bank_mask:0xf
  v_dot2c_f32_bf16_dpp v9, v7, v120 row_newbcast:1 row_mask:0xf bank_mask:0xf
  v_dot2c_f32_bf16_dpp v10, v6, v121 row_newbcast:1 row_mask:0xf bank_mask:0xf
  v_dot2c_f32_bf16_dpp v11, v7, v121 row_newbcast:1 row_mask:0xf bank_mask:0xf
  v_dot2c_f32_bf16_dpp v12, v6, v122 row_newbcast:1 row_mask:0xf bank_mask:0xf
  v_dot2c_f32_bf16_dpp v13, v7, v122 row_newbcast:1 row_mask:0xf bank_mask:0xf
  v_dot2c_f32_bf16_dpp v14, v6, v123 row_newbcast:1 row_mask:0xf bank_mask:0xf
  v_dot2c_f32_bf16_dpp v15, v7, v123 row_newbcast:1 row_mask:0xf bank_mask:0xf
  s_waitcnt vmcnt(3)
  buffer_load_dwordx4 v[140:143], v2, s[48:51], s12 offen nt
  s_addk_i32 s12, 0x2000
  s_cmp_ge_u32 s12, s59
  s_cselect_b32 s12, s58, s12
  v_dot2c_f32_bf16_dpp v8, v6, v124 row_newbcast:9 row_mask:0xf bank_mask:0xf
  v_dot2c_f32_bf16_dpp v9, v7, v124 row_newbcast:9 row_mask:0xf bank_mask:0xf
  v_dot2c_f32_bf16_dpp v10, v6, v125 row_newbcast:9 row_mask:0xf bank_mask:0xf
  v_dot2c_f32_bf16_dpp v11, v7, v125 row_newbcast:9 row_mask:0xf bank_mask:0xf
  v_dot2c_f32_bf16_dpp v12, v6, v126 row_newbcast:9 row_mask:0xf bank_mask:0xf
  v_dot2c_f32_bf16_dpp v13, v7, v126 row_newbcast:9 row_mask:0xf bank_mask:0xf
  v_dot2c_f32_bf16_dpp v14, v6, v127 row_newbcast:9 row_mask:0xf bank_mask:0xf
  v_dot2c_f32_bf16_dpp v15, v7, v127 row_newbcast:9 row_mask:0xf bank_mask:0xf
  s_waitcnt vmcnt(3)
  buffer_load_dwordx4 v[144:147], v2, s[48:51], s12 offen nt
  s_addk_i32 s12, 0x2000
  s_cmp_ge_u32 s12, s59
  s_cselect_b32 s12, s58, s12
  v_dot2c_f32_bf16_dpp v8, v6, v128 row_newbcast:5 row_mask:0xf bank_mask:0xf
  v_dot2c_f32_bf16_dpp v9, v7, v128 row_newbcast:5 row_mask:0xf bank_mask:0xf
  v_dot2c_f32_bf16_dpp v10, v6, v129 row_newbcast:5 row_mask:0xf bank_mask:0xf
  v_dot2c_f32_bf16_dpp v11, v7, v129 row_newbcast:5 row_mask:0xf bank_mask:0xf
  v_dot2c_f32_bf16_dpp v12, v6, v130 row_newbcast:5 row_mask:0xf bank_mask:0xf
  v_dot2c_f32_bf16_dpp v13, v7, v130 row_newbcast:5 row_mask:0xf bank_mask:0xf
  v_dot2c_f32_bf16_dpp v14, v6, v131 row_newbcast:5 row_mask:0xf bank_mask:0xf
  v_dot2c_f32_bf16_dpp v15, v7, v131 row_newbcast:5 row_mask:0xf bank_mask:0xf
  buffer_load_dwordx4 v[148:151], v2, s[48:51], s12 offen nt
  s_addk_i32 s12, 0x2000
  s_cmp_ge_u32 s12, s59
  s_cselect_b32 s12, s58, s12
  buffer_load_dwordx4 v[152:155], v2, s[48:51], s12 offen nt
  s_addk_i32 s12, 0x2000
  s_cmp_ge_u32 s12, s59
  s_cselect_b32 s12, s58, s12
  buffer_load_dwordx4 v[156:159], v2, s[48:51], s12 offen nt
  s_addk_i32 s12, 0x2000
  s_cmp_ge_u32 s12, s59
  s_cselect_b32 s12, s58, s12
  buffer_load_dwordx4 v[160:163], v2, s[48:51], s12 offen nt
  s_addk_i32 s12, 0x2000
  s_cmp_ge_u32 s12, s59
  s_cselect_b32 s12, s58, s12
  buffer_load_dwordx4 v[164:167], v2, s[48:51], s12 offen nt
  s_mov_b32 s70, 0
L_pl_53:
  ds_read_b32 v18, v16
  s_waitcnt lgkmcnt(0)
  v_cmp_eq_u32 vcc, -1, v18
  s_cmp_eq_u64 vcc, 0
  s_cbranch_scc1 L_pld_54
  s_sleep 2
  s_add_u32 s70, s70, 1
  s_cmp_lt_u32 s70, 1048576
  s_cbranch_scc1 L_pl_53
L_pld_54:
  v_sub_f32 v22, v22, v18
  v_mul_f32 v22, 0x3fb8aa3b, v22
  v_exp_f32 v22, v22
  ds_read_b64 v[18:19], v16 offset:32
  s_lshl_b32 s56, s6, 2
  s_add_u32 s56, s56, s7
  s_lshl_b32 s57, s56, 9
  s_add_u32 s57, s57, 131072
  v_lshl_add_u32 v2, v1, 3, s57
  v_and_b32 v17, 1, v1
  v_lshlrev_b32 v17, 4, v17
  v_lshlrev_b32 v1, 3, v1
  v_mov_b32 v0, 1
  s_movk_i32 s56, 0xff
  s_waitcnt lgkmcnt(0)
  v_readfirstlane_b32 s75, v19
  v_lshrrev_b32 v18, v17, v18
  v_lshrrev_b32 v19, 8, v18
  s_waitcnt vmcnt(8)
  v_dot2c_f32_bf16_dpp v8, v6, v132 row_newbcast:13 row_mask:0xf bank_mask:0xf
  v_dot2c_f32_bf16_dpp v9, v7, v132 row_newbcast:13 row_mask:0xf bank_mask:0xf
  v_dot2c_f32_bf16_dpp v10, v6, v133 row_newbcast:13 row_mask:0xf bank_mask:0xf
  v_dot2c_f32_bf16_dpp v11, v7, v133 row_newbcast:13 row_mask:0xf bank_mask:0xf
  v_dot2c_f32_bf16_dpp v12, v6, v134 row_newbcast:13 row_mask:0xf bank_mask:0xf
  v_dot2c_f32_bf16_dpp v13, v7, v134 row_newbcast:13 row_mask:0xf bank_mask:0xf
  v_dot2c_f32_bf16_dpp v14, v6, v135 row_newbcast:13 row_mask:0xf bank_mask:0xf
  v_dot2c_f32_bf16_dpp v15, v7, v135 row_newbcast:13 row_mask:0xf bank_mask:0xf
  s_waitcnt vmcnt(7)
  v_dot2c_f32_bf16_dpp v8, v6, v136 row_newbcast:3 row_mask:0xf bank_mask:0xf
  v_dot2c_f32_bf16_dpp v9, v7, v136 row_newbcast:3 row_mask:0xf bank_mask:0xf
  v_dot2c_f32_bf16_dpp v10, v6, v137 row_newbcast:3 row_mask:0xf bank_mask:0xf
  v_dot2c_f32_bf16_dpp v11, v7, v137 row_newbcast:3 row_mask:0xf bank_mask:0xf
  v_dot2c_f32_bf16_dpp v12, v6, v138 row_newbcast:3 row_mask:0xf bank_mask:0xf
  v_dot2c_f32_bf16_dpp v13, v7, v138 row_newbcast:3 row_mask:0xf bank_mask:0xf
  v_dot2c_f32_bf16_dpp v14, v6, v139 row_newbcast:3 row_mask:0xf bank_mask:0xf
  v_dot2c_f32_bf16_dpp v15, v7, v139 row_newbcast:3 row_mask:0xf bank_mask:0xf
  s_waitcnt vmcnt(6)
  v_dot2c_f32_bf16_dpp v8, v6, v140 row_newbcast:11 row_mask:0xf bank_mask:0xf
  v_dot2c_f32_bf16_dpp v9, v7, v140 row_newbcast:11 row_mask:0xf bank_mask:0xf
  v_dot2c_f32_bf16_dpp v10, v6, v141 row_newbcast:11 row_mask:0xf bank_mask:0xf
  v_dot2c_f32_bf16_dpp v11, v7, v141 row_newbcast:11 row_mask:0xf bank_mask:0xf
  v_dot2c_f32_bf16_dpp v12, v6, v142 row_newbcast:11 row_mask:0xf bank_mask:0xf
  v_dot2c_f32_bf16_dpp v13, v7, v142 row_newbcast:11 row_mask:0xf bank_mask:0xf
  v_dot2c_f32_bf16_dpp v14, v6, v143 row_newbcast:11 row_mask:0xf bank_mask:0xf
  v_dot2c_f32_bf16_dpp v15, v7, v143 row_newbcast:11 row_mask:0xf bank_mask:0xf
  s_waitcnt vmcnt(5)
  v_dot2c_f32_bf16_dpp v8, v6, v144 row_newbcast:7 row_mask:0xf bank_mask:0xf
  v_dot2c_f32_bf16_dpp v9, v7, v144 row_newbcast:7 row_mask:0xf bank_mask:0xf
  v_dot2c_f32_bf16_dpp v10, v6, v145 row_newbcast:7 row_mask:0xf bank_mask:0xf
  v_dot2c_f32_bf16_dpp v11, v7, v145 row_newbcast:7 row_mask:0xf bank_mask:0xf
  v_dot2c_f32_bf16_dpp v12, v6, v146 row_newbcast:7 row_mask:0xf bank_mask:0xf
  v_dot2c_f32_bf16_dpp v13, v7, v146 row_newbcast:7 row_mask:0xf bank_mask:0xf
  v_dot2c_f32_bf16_dpp v14, v6, v147 row_newbcast:7 row_mask:0xf bank_mask:0xf
  v_dot2c_f32_bf16_dpp v15, v7, v147 row_newbcast:7 row_mask:0xf bank_mask:0xf
  s_waitcnt vmcnt(4)
  v_dot2c_f32_bf16_dpp v8, v6, v148 row_newbcast:15 row_mask:0xf bank_mask:0xf
  v_dot2c_f32_bf16_dpp v9, v7, v148 row_newbcast:15 row_mask:0xf bank_mask:0xf
  v_dot2c_f32_bf16_dpp v10, v6, v149 row_newbcast:15 row_mask:0xf bank_mask:0xf
  v_dot2c_f32_bf16_dpp v11, v7, v149 row_newbcast:15 row_mask:0xf bank_mask:0xf
  v_dot2c_f32_bf16_dpp v12, v6, v150 row_newbcast:15 row_mask:0xf bank_mask:0xf
  v_dot2c_f32_bf16_dpp v13, v7, v150 row_newbcast:15 row_mask:0xf bank_mask:0xf
  v_dot2c_f32_bf16_dpp v14, v6, v151 row_newbcast:15 row_mask:0xf bank_mask:0xf
  v_dot2c_f32_bf16_dpp v15, v7, v151 row_newbcast:15 row_mask:0xf bank_mask:0xf
  s_waitcnt vmcnt(3)
  v_dot2c_f32_bf16_dpp v8, v20, v152 row_newbcast:0 row_mask:0xf bank_mask:0xf
  v_dot2c_f32_bf16_dpp v9, v21, v152 row_newbcast:0 row_mask:0xf bank_mask:0xf
  v_dot2c_f32_bf16_dpp v10, v20, v153 row_newbcast:0 row_mask:0xf bank_mask:0xf
  v_dot2c_f32_bf16_dpp v11, v21, v153 row_newbcast:0 row_mask:0xf bank_mask:0xf
  v_dot2c_f32_bf16_dpp v12, v20, v154 row_newbcast:0 row_mask:0xf bank_mask:0xf
  v_dot2c_f32_bf16_dpp v13, v21, v154 row_newbcast:0 row_mask:0xf bank_mask:0xf
  v_dot2c_f32_bf16_dpp v14, v20, v155 row_newbcast:0 row_mask:0xf bank_mask:0xf
  v_dot2c_f32_bf16_dpp v15, v21, v155 row_newbcast:0 row_mask:0xf bank_mask:0xf
  s_waitcnt vmcnt(2)
  v_dot2c_f32_bf16_dpp v8, v20, v156 row_newbcast:8 row_mask:0xf bank_mask:0xf
  v_dot2c_f32_bf16_dpp v9, v21, v156 row_newbcast:8 row_mask:0xf bank_mask:0xf
  v_dot2c_f32_bf16_dpp v10, v20, v157 row_newbcast:8 row_mask:0xf bank_mask:0xf
  v_dot2c_f32_bf16_dpp v11, v21, v157 row_newbcast:8 row_mask:0xf bank_mask:0xf
  v_dot2c_f32_bf16_dpp v12, v20, v158 row_newbcast:8 row_mask:0xf bank_mask:0xf
  v_dot2c_f32_bf16_dpp v13, v21, v158 row_newbcast:8 row_mask:0xf bank_mask:0xf
  v_dot2c_f32_bf16_dpp v14, v20, v159 row_newbcast:8 row_mask:0xf bank_mask:0xf
  v_dot2c_f32_bf16_dpp v15, v21, v159 row_newbcast:8 row_mask:0xf bank_mask:0xf
  s_waitcnt vmcnt(1)
  v_dot2c_f32_bf16_dpp v8, v20, v160 row_newbcast:4 row_mask:0xf bank_mask:0xf
  v_dot2c_f32_bf16_dpp v9, v21, v160 row_newbcast:4 row_mask:0xf bank_mask:0xf
  v_dot2c_f32_bf16_dpp v10, v20, v161 row_newbcast:4 row_mask:0xf bank_mask:0xf
  v_dot2c_f32_bf16_dpp v11, v21, v161 row_newbcast:4 row_mask:0xf bank_mask:0xf
  v_dot2c_f32_bf16_dpp v12, v20, v162 row_newbcast:4 row_mask:0xf bank_mask:0xf
  v_dot2c_f32_bf16_dpp v13, v21, v162 row_newbcast:4 row_mask:0xf bank_mask:0xf
  v_dot2c_f32_bf16_dpp v14, v20, v163 row_newbcast:4 row_mask:0xf bank_mask:0xf
  v_dot2c_f32_bf16_dpp v15, v21, v163 row_newbcast:4 row_mask:0xf bank_mask:0xf
  s_waitcnt vmcnt(0)
  v_dot2c_f32_bf16_dpp v8, v20, v164 row_newbcast:12 row_mask:0xf bank_mask:0xf
  v_dot2c_f32_bf16_dpp v9, v21, v164 row_newbcast:12 row_mask:0xf bank_mask:0xf
  v_dot2c_f32_bf16_dpp v10, v20, v165 row_newbcast:12 row_mask:0xf bank_mask:0xf
  v_dot2c_f32_bf16_dpp v11, v21, v165 row_newbcast:12 row_mask:0xf bank_mask:0xf
  v_dot2c_f32_bf16_dpp v12, v20, v166 row_newbcast:12 row_mask:0xf bank_mask:0xf
  v_dot2c_f32_bf16_dpp v13, v21, v166 row_newbcast:12 row_mask:0xf bank_mask:0xf
  v_dot2c_f32_bf16_dpp v14, v20, v167 row_newbcast:12 row_mask:0xf bank_mask:0xf
  v_dot2c_f32_bf16_dpp v15, v21, v167 row_newbcast:12 row_mask:0xf bank_mask:0xf
  s_nop 2
  v_permlane32_swap_b32 v8, v12
  v_permlane32_swap_b32 v9, v13
  v_permlane32_swap_b32 v10, v14
  v_permlane32_swap_b32 v11, v15
  v_add_f32 v8, v8, v12
  v_add_f32 v9, v9, v13
  v_add_f32 v10, v10, v14
  v_add_f32 v11, v11, v15
  s_nop 0
  v_permlane16_swap_b32 v8, v10
  v_permlane16_swap_b32 v9, v11
  v_add_f32 v8, v8, v10
  v_add_f32 v9, v9, v11
  v_mul_f32 v8, v8, v22
  v_mul_f32 v9, v9, v22
  ds_write_b64 v3, v[8:9] offset:6912
  s_mov_b64 exec, 1
  ds_add_rtn_u32 v17, v16, v0 offset:68
  s_mov_b64 exec, -1
  ds_read_b64 v[56:57], v1 offset:6912
  ds_read_b64 v[58:59], v1 offset:7424
  ds_read_b64 v[60:61], v1 offset:7936
  ds_read_b64 v[62:63], v1 offset:8448
  ds_read_b64 v[64:65], v1 offset:8960
  ds_read_b64 v[66:67], v1 offset:9472
  ds_read_b64 v[68:69], v1 offset:9984
  ds_read_b64 v[70:71], v1 offset:10496
  s_waitcnt lgkmcnt(6)
  v_readfirstlane_b32 s57, v17
  v_pk_add_f32 v[56:57], v[56:57], v[58:59]
  s_waitcnt lgkmcnt(4)
  v_pk_add_f32 v[60:61], v[60:61], v[62:63]
  s_waitcnt lgkmcnt(2)
  v_pk_add_f32 v[64:65], v[64:65], v[66:67]
  s_waitcnt lgkmcnt(0)
  v_pk_add_f32 v[68:69], v[68:69], v[70:71]
  v_pk_add_f32 v[56:57], v[56:57], v[60:61]
  v_pk_add_f32 v[64:65], v[64:65], v[68:69]
  s_cmp_lg_u32 s57, 7
  v_pk_add_f32 v[56:57], v[56:57], v[64:65]
  v_bfi_b32 v18, s56, v18, v56
  v_bfi_b32 v19, s56, v19, v57
  s_cbranch_scc1 L_send
  s_cmp_eq_u32 s75, 1
  s_cbranch_scc0 L_pf_55
  global_store_dwordx2 v2, v[18:19], s[42:43]
  s_branch L_pe_56
L_pf_55:
  global_store_dwordx2 v2, v[18:19], s[42:43] sc1
L_pe_56:
L_send:
  s_barrier
  s_endpgm
L_helper:
  v_mov_b32 v4, -1
  v_mov_b32 v5, -1
  v_mov_b32 v6, -1
  v_mov_b32 v7, -1
  v_lshlrev_b32 v2, 4, v0
  ds_write_b128 v2, v[4:7] offset:12032
  ds_write_b128 v2, v[4:7] offset:16128
  v_lshlrev_b32 v2, 2, v1
  ds_write_b32 v2, v4 offset:6400
  v_mov_b32 v38, 0
  ds_write_b128 v38, v[4:7] offset:6656
  ds_write_b128 v38, v[4:7] offset:6672
  v_mov_b32 v39, 0
  ds_write_b64 v38, v[38:39] offset:6720
  s_waitcnt lgkmcnt(0)
  s_barrier
  s_getpc_b64 s[56:57]
L_pc2:
  s_lshl_b32 s3, s2, 2
  s_add_u32 s3, s3, L_table-L_pc2
  s_load_dwordx16 s[16:31], s[0:1], 0
  s_load_dword s14, s[56:57], s3
  s_load_dwordx8 s[32:39], s[0:1], 64
  s_load_dwordx4 s[40:43], s[0:1], 96
  s_and_b32 s8, s2, 7
  s_mov_b64 s[100:101], s[56:57]
  s_mov_b32 s72, 0xfffffffe
  s_mov_b32 s73, 0xffff0000
  s_getreg_b32 s76, hwreg(HW_REG_XCC_ID, 0, 4)
  v_lshrrev_b32 v12, 3, v0
  v_lshlrev_b32 v12, 5, v12
  v_bfe_u32 v3, v1, 2, 1
  v_lshl_add_u32 v12, v3, 10, v12
  v_and_b32 v8, 3, v1
  v_lshl_add_u32 v13, v8, 3, v12
  v_and_b32 v12, 0xffffffdf, v12
  v_lshl_add_u32 v12, v8, 4, v12
  v_bfe_u32 v8, v1, 3, 1
  v_lshl_add_u32 v12, v8, 3, v12
  v_lshl_add_u32 v12, v3, 5, v12
  s_waitcnt lgkmcnt(0)
  s_load_dword s74, s[42:43], 0
  s_and_b32 s13, s14, 7
  s_bfe_u32 s61, s14, 0x60003
  s_cmp_eq_u32 s13, 6
  s_cbranch_scc1 L_r_q
  s_cmp_ge_u32 s13, 4
  s_cbranch_scc1 L_r_moda
  s_cmp_eq_u32 s13, 1
  s_cbranch_scc1 L_r_wo
  s_cmp_eq_u32 s13, 2
  s_cbranch_scc1 L_r_f1
  s_cmp_eq_u32 s13, 3
  s_cbranch_scc1 L_r_f2
  s_branch L_r_none
L_r_moda:
  s_lshl_b32 s58, s61, 9
  s_add_u32 s58, s58, 4096
  global_load_dwordx2 v[14:15], v13, s[34:35]
  s_waitcnt lgkmcnt(0)
  s_mul_i32 s74, s74, 0x9e3779b1
  s_add_u32 s74, s74, 0x7f4a7c15
  s_add_u32 s76, s76, s74
  s_waitcnt vmcnt(0)
  v_lshlrev_b32 v16, 16, v14
  v_and_b32 v17, s73, v14
  v_lshlrev_b32 v18, 16, v15
  v_and_b32 v19, s73, v15
  v_mul_f32 v20, 0xbfb8aa3b, v16
  v_mul_f32 v21, 0xbfb8aa3b, v17
  v_mul_f32 v22, 0xbfb8aa3b, v18
  v_mul_f32 v23, 0xbfb8aa3b, v19
  v_exp_f32 v20, v20
  v_exp_f32 v21, v21
  v_exp_f32 v22, v22
  v_exp_f32 v23, v23
  s_nop 0
  v_add_f32 v20, 1.0, v20
  v_add_f32 v21, 1.0, v21
  v_add_f32 v22, 1.0, v22
  v_add_f32 v23, 1.0, v23
  v_rcp_f32 v20, v20
  v_rcp_f32 v21, v21
  v_rcp_f32 v22, v22
  v_rcp_f32 v23, v23
  s_nop 0
  v_mul_f32 v16, v16, v20
  v_mul_f32 v17, v17, v21
  v_mul_f32 v18, v18, v22
  v_mul_f32 v19, v19, v23
  v_cvt_pk_bf16_f32 v14, v16, v17
  v_cvt_pk_bf16_f32 v15, v18, v19
  ds_write_b64 v12, v[14:15] offset:0
  v_and_b32 v13, 1, v1
  v_lshlrev_b32 v13, 6, v13
  v_lshrrev_b32 v3, 4, v1
  v_lshl_add_u32 v13, v3, 4, v13
  s_lshl_b32 s49, s5, 7
  s_add_u32 s49, s49, s58
  v_add_u32 v13, s49, v13
  v_and_b32 v14, 1, v1
  v_mul_u32_u24 v14, 1056, v14
  v_lshrrev_b32 v3, 4, v1
  v_lshl_add_u32 v14, v3, 4, v14
  v_lshrrev_b32 v2, 2, v1
  v_bfe_u32 v3, v1, 1, 1
  s_lshl_b32 s49, s5, 1
  v_or_b32 v3, s49, v3
  v_and_b32 v10, 6, v2
  v_xor_b32 v3, v3, v10
  v_lshlrev_b32 v2, 7, v2
  v_lshl_add_u32 v2, v3, 4, v2
  v_and_b32 v3, 1, v1
  v_lshl_add_u32 v2, v3, 3, v2
  v_add_u32 v2, 20480, v2
  s_waitcnt lgkmcnt(0)
  v_mov_b32 v9, 1
  s_mov_b64 exec, 1
  ds_add_u32 v38, v9 offset:6720
  s_mov_b64 exec, -1
  s_mov_b32 s70, 0
L_hs_57:
  ds_read_b32 v9, v38 offset:6720
  s_waitcnt lgkmcnt(0)
  v_cmp_gt_u32 vcc, 12, v9
  s_cmp_eq_u64 vcc, 0
  s_cbranch_scc1 L_hsd_58
  s_sleep 2
  s_add_u32 s70, s70, 1
  s_cmp_lt_u32 s70, 2097152
  s_cbranch_scc1 L_hs_57
L_hsd_58:
  ds_read_b64_tr_b16 v[40:41], v2 offset:0
  ds_read_b64_tr_b16 v[42:43], v2 offset:2048
  ds_read_b128 v[104:107], v14 offset:0
  ds_read_b64_tr_b16 v[44:45], v2 offset:4096
  ds_read_b64_tr_b16 v[46:47], v2 offset:6144
  ds_read_b128 v[108:111], v14 offset:64
  ds_read_b64_tr_b16 v[48:49], v2 offset:8192
  ds_read_b64_tr_b16 v[50:51], v2 offset:10240
  ds_read_b128 v[112:115], v14 offset:128
  ds_read_b64_tr_b16 v[52:53], v2 offset:12288
  ds_read_b64_tr_b16 v[54:55], v2 offset:14336
  ds_read_b128 v[116:119], v14 offset:192
  ds_read_b64_tr_b16 v[56:57], v2 offset:16384
  ds_read_b64_tr_b16 v[58:59], v2 offset:18432
  ds_read_b128 v[120:123], v14 offset:256
  s_waitcnt lgkmcnt(12)
  v_mfma_f32_16x16x32_bf16 v[8:11], v[40:43], v[104:107], 0
  ds_read_b64_tr_b16 v[60:61], v2 offset:20480
  ds_read_b64_tr_b16 v[62:63], v2 offset:22528
  ds_read_b128 v[124:127], v14 offset:320
  s_waitcnt lgkmcnt(12)
  v_mfma_f32_16x16x32_bf16 v[8:11], v[44:47], v[108:111], v[8:11]
  ds_read_b64_tr_b16 v[64:65], v2 offset:24576
  ds_read_b64_tr_b16 v[66:67], v2 offset:26624
  ds_read_b128 v[128:131], v14 offset:384
  s_waitcnt lgkmcnt(12)
  v_mfma_f32_16x16x32_bf16 v[8:11], v[48:51], v[112:115], v[8:11]
  ds_read_b64_tr_b16 v[68:69], v2 offset:28672
  ds_read_b64_tr_b16 v[70:71], v2 offset:30720
  ds_read_b128 v[132:135], v14 offset:448
  s_waitcnt lgkmcnt(12)
  v_mfma_f32_16x16x32_bf16 v[8:11], v[52:55], v[116:119], v[8:11]
  ds_read_b64_tr_b16 v[72:73], v2 offset:32768
  ds_read_b64_tr_b16 v[74:75], v2 offset:34816
  ds_read_b128 v[136:139], v14 offset:512
  s_waitcnt lgkmcnt(12)
  v_mfma_f32_16x16x32_bf16 v[8:11], v[56:59], v[120:123], v[8:11]
  ds_read_b64_tr_b16 v[76:77], v2 offset:36864
  ds_read_b64_tr_b16 v[78:79], v2 offset:38912
  ds_read_b128 v[140:143], v14 offset:576
  s_waitcnt lgkmcnt(12)
  v_mfma_f32_16x16x32_bf16 v[8:11], v[60:63], v[124:127], v[8:11]
  ds_read_b64_tr_b16 v[80:81], v2 offset:40960
  ds_read_b64_tr_b16 v[82:83], v2 offset:43008
  ds_read_b128 v[144:147], v14 offset:640
  s_waitcnt lgkmcnt(12)
  v_mfma_f32_16x16x32_bf16 v[8:11], v[64:67], v[128:131], v[8:11]
  ds_read_b64_tr_b16 v[84:85], v2 offset:45056
  ds_read_b64_tr_b16 v[86:87], v2 offset:47104
  ds_read_b128 v[148:151], v14 offset:704
  s_waitcnt lgkmcnt(12)
  v_mfma_f32_16x16x32_bf16 v[8:11], v[68:71], v[132:135], v[8:11]
  ds_read_b64_tr_b16 v[88:89], v2 offset:49152
  ds_read_b64_tr_b16 v[90:91], v2 offset:51200
  ds_read_b128 v[152:155], v14 offset:768
  s_waitcnt lgkmcnt(12)
  v_mfma_f32_16x16x32_bf16 v[8:11], v[72:75], v[136:139], v[8:11]
  ds_read_b64_tr_b16 v[92:93], v2 offset:53248
  ds_read_b64_tr_b16 v[94:95], v2 offset:55296
  ds_read_b128 v[156:159], v14 offset:832
  s_waitcnt lgkmcnt(12)
  v_mfma_f32_16x16x32_bf16 v[8:11], v[76:79], v[140:143], v[8:11]
  ds_read_b64_tr_b16 v[96:97], v2 offset:57344
  ds_read_b64_tr_b16 v[98:99], v2 offset:59392
  ds_read_b128 v[160:163], v14 offset:896
  s_waitcnt lgkmcnt(12)
  v_mfma_f32_16x16x32_bf16 v[8:11], v[80:83], v[144:147], v[8:11]
  ds_read_b64_tr_b16 v[100:101], v2 offset:61440
  ds_read_b64_tr_b16 v[102:103], v2 offset:63488
  ds_read_b128 v[164:167], v14 offset:960
  s_waitcnt lgkmcnt(12)
  v_mfma_f32_16x16x32_bf16 v[8:11], v[84:87], v[148:151], v[8:11]
  s_waitcnt lgkmcnt(9)
  v_mfma_f32_16x16x32_bf16 v[8:11], v[88:91], v[152:155], v[8:11]
  s_waitcnt lgkmcnt(6)
  v_mfma_f32_16x16x32_bf16 v[8:11], v[92:95], v[156:159], v[8:11]
  s_waitcnt lgkmcnt(3)
  v_mfma_f32_16x16x32_bf16 v[8:11], v[96:99], v[160:163], v[8:11]
  s_waitcnt lgkmcnt(0)
  v_mfma_f32_16x16x32_bf16 v[8:11], v[100:103], v[164:167], v[8:11]
  s_nop 7
  v_cvt_pk_bf16_f32 v8, v8, v9
  v_cvt_pk_bf16_f32 v10, v10, v11
  v_mov_b32 v9, s74
  v_mov_b32 v11, s74
  s_mov_b32 exec_lo, 0x00030003
  s_mov_b32 exec_hi, 0x00030003
  global_store_dwordx4 v13, v[8:11], s[42:43] sc1
L_sk1:
  s_mov_b64 exec, -1
  s_mov_b32 s60, 0
  s_branch L_svc1
L_r_q:
  s_lshl_b32 s58, s61, 9
  s_add_u32 s58, s58, 32768
  global_load_dwordx2 v[14:15], v13, s[16:17]
  s_waitcnt lgkmcnt(0)
  s_mul_i32 s74, s74, 0x9e3779b1
  s_add_u32 s74, s74, 0x7f4a7c15
  s_add_u32 s76, s76, s74
  s_waitcnt vmcnt(0)
  v_bfe_u32 v6, v1, 2, 1
  v_lshlrev_b32 v6, 5, v6
  v_add_u32 v6, 11008, v6
  s_lshl_b32 s49, s5, 3
  v_add_u32 v5, s49, v6
  v_lshlrev_b32 v20, 16, v14
  v_and_b32 v21, s73, v14
  v_lshlrev_b32 v22, 16, v15
  v_and_b32 v23, s73, v15
  v_add_f32 v8, v20, v21
  v_mul_f32 v9, v20, v20
  v_add_f32 v10, v22, v23
  v_mul_f32 v11, v22, v22
  v_fmac_f32 v9, v21, v21
  v_fmac_f32 v11, v23, v23
  v_add_f32 v8, v8, v10
  v_add_f32 v9, v9, v11
  s_nop 0
  v_add_f32_dpp v8, v8, v8 quad_perm:[1,0,3,2] row_mask:0xf bank_mask:0xf
  v_add_f32_dpp v9, v9, v9 quad_perm:[1,0,3,2] row_mask:0xf bank_mask:0xf
  s_nop 0
  v_add_f32_dpp v8, v8, v8 quad_perm:[2,3,0,1] row_mask:0xf bank_mask:0xf
  v_add_f32_dpp v9, v9, v9 quad_perm:[2,3,0,1] row_mask:0xf bank_mask:0xf
  s_nop 0
  v_add_f32_dpp v8, v8, v8 row_ror:8 row_mask:0xf bank_mask:0xf
  v_add_f32_dpp v9, v9, v9 row_ror:8 row_mask:0xf bank_mask:0xf
  s_nop 0
  v_mov_b32 v10, v8
  v_mov_b32 v11, v9
  s_nop 0
  v_permlane16_swap_b32 v10, v8
  v_permlane16_swap_b32 v11, v9
  v_add_f32 v8, v8, v10
  v_add_f32 v9, v9, v11
  v_mov_b32 v10, v8
  v_mov_b32 v11, v9
  s_nop 0
  v_permlane32_swap_b32 v10, v8
  v_permlane32_swap_b32 v11, v9
  v_add_f32 v8, v8, v10
  v_add_f32 v9, v9, v11
  ds_write_b64 v5, v[8:9]
  s_waitcnt lgkmcnt(0)
  v_mov_b32 v9, 1
  s_mov_b64 exec, 1
  ds_add_u32 v38, v9 offset:6720
  s_mov_b64 exec, -1
  s_mov_b32 s70, 0
L_hs_59:
  ds_read_b32 v9, v38 offset:6720
  s_waitcnt lgkmcnt(0)
  v_cmp_gt_u32 vcc, 12, v9
  s_cmp_eq_u64 vcc, 0
  s_cbranch_scc1 L_hsd_60
  s_sleep 4
  s_add_u32 s70, s70, 1
  s_cmp_lt_u32 s70, 2097152
  s_cbranch_scc1 L_hs_59
L_hsd_60:
  ds_read_b128 v[24:27], v6
  ds_read_b128 v[28:31], v6 offset:16
  s_waitcnt lgkmcnt(0)
  v_pk_add_f32 v[24:25], v[24:25], v[26:27]
  v_pk_add_f32 v[28:29], v[28:29], v[30:31]
  v_pk_add_f32 v[24:25], v[24:25], v[28:29]
  v_mul_f32 v8, 0x3b000000, v24
  v_mul_f32 v9, 0x3b000000, v25
  v_fma_f32 v9, -v8, v8, v9
  v_cvt_pk_bf16_f32 v8, 0, v8
  v_max_f32 v9, 0, v9
  v_cvt_pk_bf16_f32 v9, 0, v9
  v_sub_f32 v20, v20, v8
  v_sub_f32 v21, v21, v8
  v_add_f32 v9, 0x3727c5ac, v9
  v_sub_f32 v22, v22, v8
  v_sub_f32 v23, v23, v8
  v_cvt_pk_bf16_f32 v9, 0, v9
  v_cvt_pk_bf16_f32 v20, 0, v20
  v_sqrt_f32 v9, v9
  v_cvt_pk_bf16_f32 v21, 0, v21
  v_cvt_pk_bf16_f32 v9, 0, v9
  v_cvt_pk_bf16_f32 v22, 0, v22
  v_rcp_f32 v9, v9
  v_cvt_pk_bf16_f32 v23, 0, v23
  v_mul_f32 v20, v20, v9
  v_mul_f32 v21, v21, v9
  v_mul_f32 v22, v22, v9
  v_mul_f32 v23, v23, v9
  v_cvt_pk_bf16_f32 v20, 0, v20
  v_cvt_pk_bf16_f32 v21, 0, v21
  v_cvt_pk_bf16_f32 v22, 0, v22
  v_cvt_pk_bf16_f32 v23, 0, v23
  v_lshrrev_b32 v2, 2, v1
  v_bfe_u32 v3, v1, 1, 1
  s_lshl_b32 s49, s5, 1
  v_or_b32 v3, s49, v3
  v_and_b32 v10, 6, v2
  v_xor_b32 v3, v3, v10
  v_lshlrev_b32 v2, 7, v2
  v_lshl_add_u32 v2, v3, 4, v2
  v_and_b32 v3, 1, v1
  v_lshl_add_u32 v2, v3, 3, v2
  v_add_u32 v2, 20480, v2
  ds_read_b64_tr_b16 v[40:41], v2 offset:0
  ds_read_b64_tr_b16 v[42:43], v2 offset:2048
  ds_read_b64_tr_b16 v[44:45], v2 offset:4096
  ds_read_b64_tr_b16 v[46:47], v2 offset:6144
  ds_read_b64_tr_b16 v[48:49], v2 offset:8192
  ds_read_b64_tr_b16 v[50:51], v2 offset:10240
  ds_read_b64_tr_b16 v[52:53], v2 offset:12288
  ds_read_b64_tr_b16 v[54:55], v2 offset:14336
  ds_read_b64_tr_b16 v[56:57], v2 offset:16384
  ds_read_b64_tr_b16 v[58:59], v2 offset:18432
  ds_read_b64_tr_b16 v[60:61], v2 offset:20480
  ds_read_b64_tr_b16 v[62:63], v2 offset:22528
  s_waitcnt lgkmcnt(10)
  ds_read_b64_tr_b16 v[64:65], v2 offset:24576
  ds_read_b64_tr_b16 v[66:67], v2 offset:26624
  s_waitcnt lgkmcnt(10)
  ds_read_b64_tr_b16 v[68:69], v2 offset:28672
  ds_read_b64_tr_b16 v[70:71], v2 offset:30720
  s_waitcnt lgkmcnt(10)
  ds_read_b64_tr_b16 v[72:73], v2 offset:32768
  ds_read_b64_tr_b16 v[74:75], v2 offset:34816
  s_waitcnt lgkmcnt(10)
  ds_read_b64_tr_b16 v[76:77], v2 offset:36864
  ds_read_b64_tr_b16 v[78:79], v2 offset:38912
  s_waitcnt lgkmcnt(10)
  ds_read_b64_tr_b16 v[80:81], v2 offset:40960
  ds_read_b64_tr_b16 v[82:83], v2 offset:43008
  s_waitcnt lgkmcnt(10)
  ds_read_b64_tr_b16 v[84:85], v2 offset:45056
  ds_read_b64_tr_b16 v[86:87], v2 offset:47104
  s_waitcnt lgkmcnt(10)
  ds_read_b64_tr_b16 v[88:89], v2 offset:49152
  ds_read_b64_tr_b16 v[90:91], v2 offset:51200
  s_waitcnt lgkmcnt(10)
  ds_read_b64_tr_b16 v[92:93], v2 offset:53248
  ds_read_b64_tr_b16 v[94:95], v2 offset:55296
  s_waitcnt lgkmcnt(10)
  ds_read_b64_tr_b16 v[96:97], v2 offset:57344
  ds_read_b64_tr_b16 v[98:99], v2 offset:59392
  s_waitcnt lgkmcnt(10)
  ds_read_b64_tr_b16 v[100:101], v2 offset:61440
  ds_read_b64_tr_b16 v[102:103], v2 offset:63488
  s_waitcnt lgkmcnt(10)
  s_waitcnt lgkmcnt(0)
  v_and_b32 v13, 1, v1
  v_lshlrev_b32 v13, 6, v13
  v_lshrrev_b32 v3, 4, v1
  v_lshl_add_u32 v13, v3, 4, v13
  s_lshl_b32 s49, s5, 7
  s_add_u32 s49, s49, s58
  v_add_u32 v13, s49, v13
  v_and_b32 v14, 1, v1
  v_mul_u32_u24 v14, 1056, v14
  v_lshrrev_b32 v3, 4, v1
  v_lshl_add_u32 v14, v3, 4, v14
  v_lshlrev_b32 v15, 4, v0
  v_add_u32 v15, 4096, v15
  v_add_u32 v36, 0x1000, v15
  s_mov_b32 s70, 0
L_pl_61:
  ds_read_b32 v8, v38 offset:6672
  s_waitcnt lgkmcnt(0)
  v_cmp_eq_u32 vcc, -1, v8
  s_cmp_eq_u64 vcc, 0
  s_cbranch_scc1 L_pld_62
  s_sleep 8
  s_add_u32 s70, s70, 1
  s_cmp_lt_u32 s70, 1048576
  s_cbranch_scc1 L_pl_61
L_pld_62:
  s_mov_b64 s[64:65], -1
  s_mov_b64 s[66:67], -1
  s_mov_b32 s70, 0
L_q_p:
  s_mov_b64 exec, s[64:65]
  global_load_dwordx4 v[16:19], v15, s[42:43] sc1
  s_mov_b64 exec, s[66:67]
  global_load_dwordx4 v[32:35], v36, s[42:43] sc1
  s_mov_b64 exec, -1
  s_waitcnt vmcnt(0)
  v_cmp_ne_u32 s[64:65], s74, v17
  v_cmp_ne_u32 s[68:69], s74, v19
  s_or_b64 s[64:65], s[64:65], s[68:69]
  v_cmp_ne_u32 s[66:67], s74, v33
  v_cmp_ne_u32 s[68:69], s74, v35
  s_or_b64 s[66:67], s[66:67], s[68:69]
  s_or_b64 vcc, s[64:65], s[66:67]
  s_cmp_eq_u64 vcc, 0
  s_cbranch_scc1 L_q_ok
  s_add_u32 s70, s70, 1
  s_cmp_lt_u32 s70, 262144
  s_cbranch_scc1 L_q_p
L_q_ok:
  v_lshlrev_b32 v28, 16, v32
  v_and_b32 v29, s73, v32
  v_lshlrev_b32 v30, 16, v34
  v_and_b32 v31, s73, v34
  v_lshlrev_b32 v24, 16, v16
  v_and_b32 v25, s73, v16
  v_lshlrev_b32 v26, 16, v18
  v_and_b32 v27, s73, v18
  v_add_f32 v28, 1.0, v28
  v_add_f32 v29, 1.0, v29
  v_add_f32 v30, 1.0, v30
  v_add_f32 v31, 1.0, v31
  v_cvt_pk_bf16_f32 v28, 0, v28
  v_cvt_pk_bf16_f32 v29, 0, v29
  v_cvt_pk_bf16_f32 v30, 0, v30
  v_cvt_pk_bf16_f32 v31, 0, v31
  v_mul_f32 v20, v20, v28
  v_mul_f32 v21, v21, v29
  v_mul_f32 v22, v22, v30
  v_mul_f32 v23, v23, v31
  v_cvt_pk_bf16_f32 v20, 0, v20
  v_cvt_pk_bf16_f32 v21, 0, v21
  v_cvt_pk_bf16_f32 v22, 0, v22
  v_cvt_pk_bf16_f32 v23, 0, v23
  v_add_f32 v20, v20, v24
  v_add_f32 v21, v21, v25
  v_add_f32 v22, v22, v26
  v_add_f32 v23, v23, v27
  v_cvt_pk_bf16_f32 v16, v20, v21
  v_cvt_pk_bf16_f32 v17, v22, v23
  ds_write_b64 v12, v[16:17] offset:0
  v_mov_b32 v9, 1
  s_mov_b64 exec, 1
  ds_add_u32 v38, v9 offset:6720
  s_mov_b64 exec, -1
  s_mov_b32 s70, 0
L_hs_63:
  ds_read_b32 v9, v38 offset:6720
  s_waitcnt lgkmcnt(0)
  v_cmp_gt_u32 vcc, 16, v9
  s_cmp_eq_u64 vcc, 0
  s_cbranch_scc1 L_hsd_64
  s_add_u32 s70, s70, 1
  s_cmp_lt_u32 s70, 2097152
  s_cbranch_scc1 L_hs_63
L_hsd_64:
  ds_read_b128 v[104:107], v14 offset:0
  ds_read_b128 v[108:111], v14 offset:64
  ds_read_b128 v[112:115], v14 offset:128
  ds_read_b128 v[116:119], v14 offset:192
  ds_read_b128 v[120:123], v14 offset:256
  ds_read_b128 v[124:127], v14 offset:320
  ds_read_b128 v[128:131], v14 offset:384
  ds_read_b128 v[132:135], v14 offset:448
  ds_read_b128 v[136:139], v14 offset:512
  ds_read_b128 v[140:143], v14 offset:576
  ds_read_b128 v[144:147], v14 offset:640
  ds_read_b128 v[148:151], v14 offset:704
  s_waitcnt lgkmcnt(11)
  v_mfma_f32_16x16x32_bf16 v[8:11], v[40:43], v[104:107], 0
  ds_read_b128 v[152:155], v14 offset:768
  s_waitcnt lgkmcnt(11)
  v_mfma_f32_16x16x32_bf16 v[8:11], v[44:47], v[108:111], v[8:11]
  ds_read_b128 v[156:159], v14 offset:832
  s_waitcnt lgkmcnt(11)
  v_mfma_f32_16x16x32_bf16 v[8:11], v[48:51], v[112:115], v[8:11]
  ds_read_b128 v[160:163], v14 offset:896
  s_waitcnt lgkmcnt(11)
  v_mfma_f32_16x16x32_bf16 v[8:11], v[52:55], v[116:119], v[8:11]
  ds_read_b128 v[164:167], v14 offset:960
  s_waitcnt lgkmcnt(11)
  v_mfma_f32_16x16x32_bf16 v[8:11], v[56:59], v[120:123], v[8:11]
  s_waitcnt lgkmcnt(10)
  v_mfma_f32_16x16x32_bf16 v[8:11], v[60:63], v[124:127], v[8:11]
  s_waitcnt lgkmcnt(9)
  v_mfma_f32_16x16x32_bf16 v[8:11], v[64:67], v[128:131], v[8:11]
  s_waitcnt lgkmcnt(8)
  v_mfma_f32_16x16x32_bf16 v[8:11], v[68:71], v[132:135], v[8:11]
  s_waitcnt lgkmcnt(7)
  v_mfma_f32_16x16x32_bf16 v[8:11], v[72:75], v[136:139], v[8:11]
  s_waitcnt lgkmcnt(6)
  v_mfma_f32_16x16x32_bf16 v[8:11], v[76:79], v[140:143], v[8:11]
  s_waitcnt lgkmcnt(5)
  v_mfma_f32_16x16x32_bf16 v[8:11], v[80:83], v[144:147], v[8:11]
  s_waitcnt lgkmcnt(4)
  v_mfma_f32_16x16x32_bf16 v[8:11], v[84:87], v[148:151], v[8:11]
  s_waitcnt lgkmcnt(3)
  v_mfma_f32_16x16x32_bf16 v[8:11], v[88:91], v[152:155], v[8:11]
  s_waitcnt lgkmcnt(2)
  v_mfma_f32_16x16x32_bf16 v[8:11], v[92:95], v[156:159], v[8:11]
  s_waitcnt lgkmcnt(1)
  v_mfma_f32_16x16x32_bf16 v[8:11], v[96:99], v[160:163], v[8:11]
  s_waitcnt lgkmcnt(0)
  v_mfma_f32_16x16x32_bf16 v[8:11], v[100:103], v[164:167], v[8:11]
  s_nop 7
  v_cvt_pk_bf16_f32 v8, v8, v9
  v_cvt_pk_bf16_f32 v10, v10, v11
  v_mov_b32 v9, s74
  v_mov_b32 v11, s74
  v_min_u32 v8, s72, v8
  v_min_u32 v10, s72, v10
  s_mov_b32 exec_lo, 0x00030003
  s_mov_b32 exec_hi, 0x00030003
  global_store_dwordx4 v13, v[8:11], s[42:43] sc1
  s_mov_b64 exec, -1
  s_mov_b32 s60, 0
  s_branch L_svc1
L_r_wo:
  s_and_b32 s66, s2, 7
  s_lshr_b32 s58, s66, 1
  s_lshl_b32 s58, s58, 14
  s_and_b32 s49, s66, 1
  s_lshl_b32 s49, s49, 12
  s_add_u32 s58, s58, s49
  s_lshl_b32 s49, s61, 9
  s_add_u32 s58, s58, s49
  s_add_u32 s58, s58, 327680
  s_waitcnt lgkmcnt(0)
  s_mul_i32 s74, s74, 0x9e3779b1
  s_add_u32 s74, s74, 0x7f4a7c15
  s_add_u32 s76, s76, s74
  s_cmp_lg_u32 s5, 3
  s_cbranch_scc1 L_nr_65
  s_lshl_b32 s49, s61, 14
  s_lshl_b32 s50, s8, 10
  s_add_u32 s49, s49, s50
  s_add_u32 s49, s49, 524288
  s_add_u32 s50, s49, 256
  s_mov_b32 s54, -1
  s_mov_b32 s55, -1
L_nrl_66:
  s_memtime s[64:65]
  s_waitcnt lgkmcnt(0)
  s_load_dword s51, s[42:43], s49
  s_waitcnt lgkmcnt(0)
  s_memtime s[68:69]
  s_waitcnt lgkmcnt(0)
  s_sub_u32 s68, s68, s64
  s_min_u32 s54, s54, s68
  s_xor_b32 s49, s49, 0x2000
  s_memtime s[64:65]
  s_waitcnt lgkmcnt(0)
  s_load_dword s51, s[42:43], s49
  s_waitcnt lgkmcnt(0)
  s_memtime s[68:69]
  s_waitcnt lgkmcnt(0)
  s_sub_u32 s68, s68, s64
  s_min_u32 s55, s55, s68
  s_xor_b32 s49, s49, 0x2000
  s_add_u32 s49, s49, 128
  s_cmp_lt_u32 s49, s50
  s_cbranch_scc1 L_nrl_66
  s_cmp_lt_u32 s55, s54
  s_cselect_b32 s54, 1, 0
  s_sub_u32 s55, s76, s74
  s_lshr_b32 s55, s55, 2
  s_xor_b32 s54, s54, s55
  s_and_b32 s54, s54, 1
  s_add_u32 s54, s54, s74
  s_lshl_b32 s55, s8, 3
  s_add_u32 s55, s55, s61
  s_lshl_b32 s55, s55, 5
  v_mov_b32 v8, s55
  v_mov_b32 v10, s76
  v_mov_b32 v11, s54
  s_mov_b64 exec, 1
  global_store_dwordx2 v8, v[10:11], s[42:43] offset:1024 sc1
  s_mov_b64 exec, -1
L_nr_65:
  s_mov_b32 s60, 1
  s_branch L_svc1
L_r_f1:
  s_lshl_b32 s48, s61, 6
  s_mul_i32 s49, s61, 47
  s_lshr_b32 s49, s49, 9
  s_mul_i32 s49, s49, 10752
  s_lshl_b32 s58, s61, 9
  s_add_u32 s58, s58, s49
  s_add_u32 s58, s58, 262144
  s_cmp_lt_u32 s5, 2
  s_cselect_b32 s44, s28, s30
  s_cselect_b32 s45, s29, s31
  s_mov_b32 s46, 1409024
  s_mov_b32 s47, 0x20000
  s_mov_b32 s60, 2
  s_waitcnt lgkmcnt(0)
  s_mul_i32 s74, s74, 0x9e3779b1
  s_add_u32 s74, s74, 0x7f4a7c15
  s_add_u32 s76, s76, s74
  s_branch L_svc1
L_r_f2:
  s_mov_b32 s44, s32
  s_mov_b32 s45, s33
  s_mov_b32 s46, 1409024
  s_mov_b32 s47, 0x20000
  s_waitcnt lgkmcnt(0)
  s_mul_i32 s74, s74, 0x9e3779b1
  s_add_u32 s74, s74, 0x7f4a7c15
  s_add_u32 s76, s76, s74
  s_mov_b32 s60, 3
  s_lshl_b32 s48, s61, 5
  global_load_dword v167, v38, s[38:39]
  s_branch L_svc1
L_r_none:
  s_mov_b32 s60, 0
  s_waitcnt lgkmcnt(0)
  s_mul_i32 s74, s74, 0x9e3779b1
  s_add_u32 s74, s74, 0x7f4a7c15
  s_add_u32 s76, s76, s74
L_svc1:
  s_cmp_lg_u32 s5, 0
  s_cbranch_scc1 L_disp3
  s_and_b32 s64, s6, 31
  s_lshl_b32 s64, s64, 10
  s_and_b32 s65, s6, 32
  s_lshl_b32 s65, s65, 1
  s_add_u32 s64, s64, s65
  s_add_u32 s64, s64, 32768
  v_bfe_u32 v16, v1, 2, 3
  v_lshl_add_u32 v16, v16, 7, s64
  v_and_b32 v17, 3, v1
  v_lshl_add_u32 v16, v17, 4, v16
  v_and_b32 v17, 31, v1
  v_lshlrev_b32 v17, 3, v17
  s_lshl_b32 s71, s8, 8
  v_and_b32 v18, 7, v1
  v_lshl_add_u32 v18, v18, 5, s71
  s_mov_b32 s70, 0
L_pl_67:
  ds_read_b32 v8, v38 offset:6664
  s_waitcnt lgkmcnt(0)
  v_cmp_eq_u32 vcc, -1, v8
  s_cmp_eq_u64 vcc, 0
  s_cbranch_scc1 L_pld_68
  s_sleep 8
  s_add_u32 s70, s70, 1
  s_cmp_lt_u32 s70, 1048576
  s_cbranch_scc1 L_pl_67
L_pld_68:
  global_load_dword v19, v18, s[42:43] offset:1024 sc1
  s_mov_b32 s70, 0
L_polt_69:
  global_load_dwordx4 v[20:23], v16, s[42:43] sc1
  s_waitcnt vmcnt(0)
  v_cmp_ne_u32 vcc, s74, v21
  v_cmp_ne_u32 s[68:69], s74, v23
  s_or_b64 vcc, vcc, s[68:69]
  s_cmp_eq_u64 vcc, 0
  s_cbranch_scc1 L_poltd_70
  s_add_u32 s70, s70, 1
  s_cmp_lt_u32 s70, 262144
  s_cbranch_scc1 L_polt_69
L_poltd_70:
  v_mov_b32 v21, v22
  ds_write_b64 v17, v[20:21] offset:6400
  v_cmp_ne_u32 vcc, s76, v19
  s_cmp_eq_u64 vcc, 0
  s_cselect_b32 s75, 1, 0
  v_mov_b32 v20, s74
  v_mov_b32 v21, s75
  ds_write_b64 v38, v[20:21] offset:6688
L_svc2:
  v_lshlrev_b32 v16, 4, v1
  s_lshl_b32 s64, s6, 9
  s_add_u32 s64, s64, 65536
  s_lshl_b32 s65, s7, 7
  s_add_u32 s65, s65, s64
  v_mov_b32 v18, s65
  s_mov_b32 s70, 0
L_pl_71:
  ds_read_b128 v[104:107], v16 offset:12032
  ds_read_b128 v[108:111], v16 offset:13056
  ds_read_b128 v[112:115], v16 offset:14080
  ds_read_b128 v[116:119], v16 offset:15104
  ds_read_b128 v[120:123], v16 offset:16128
  ds_read_b128 v[124:127], v16 offset:17152
  ds_read_b128 v[128:131], v16 offset:18176
  ds_read_b128 v[132:135], v16 offset:19200
  s_waitcnt lgkmcnt(0)
  v_max3_u32 v8, v104, v105, v106
  v_max3_u32 v8, v8, v108, v109
  v_max3_u32 v8, v8, v110, v112
  v_max3_u32 v8, v8, v113, v114
  v_max3_u32 v8, v8, v116, v117
  v_max3_u32 v8, v8, v118, v120
  v_max3_u32 v8, v8, v121, v122
  v_max3_u32 v8, v8, v124, v125
  v_max3_u32 v8, v8, v126, v128
  v_max3_u32 v8, v8, v129, v130
  v_max3_u32 v8, v8, v132, v133
  v_max_u32 v8, v8, v134
  v_cmp_eq_u32 vcc, -1, v8
  s_cmp_eq_u64 vcc, 0
  s_cbranch_scc1 L_pld_72
  s_sleep 4
  s_add_u32 s70, s70, 1
  s_cmp_lt_u32 s70, 1048576
  s_cbranch_scc1 L_pl_71
L_pld_72:
  v_max3_f32 v8, v104, v105, v106
  v_max3_f32 v8, v8, v108, v109
  v_max3_f32 v8, v8, v110, v112
  v_max3_f32 v8, v8, v113, v114
  v_max3_f32 v8, v8, v116, v117
  v_max3_f32 v8, v8, v118, v120
  v_max3_f32 v8, v8, v121, v122
  v_max3_f32 v8, v8, v124, v125
  v_max3_f32 v8, v8, v126, v128
  v_max3_f32 v8, v8, v129, v130
  v_max3_f32 v8, v8, v132, v133
  v_max_f32 v8, v8, v134
  s_nop 1
  v_max_f32_dpp v8, v8, v8 row_ror:8 row_mask:0xf bank_mask:0xf
  s_nop 1
  v_max_f32_dpp v8, v8, v8 row_ror:4 row_mask:0xf bank_mask:0xf
  s_nop 1
  v_max_f32_dpp v8, v8, v8 row_ror:2 row_mask:0xf bank_mask:0xf
  s_nop 1
  v_max_f32_dpp v8, v8, v8 row_ror:1 row_mask:0xf bank_mask:0xf
  v_mov_b32 v11, v8
  s_nop 1
  v_permlane16_swap_b32 v11, v8
  v_max_f32 v8, v8, v11
  v_mov_b32 v11, v8
  s_nop 1
  v_permlane32_swap_b32 v11, v8
  v_max_f32 v8, v8, v11
  v_min_u32 v9, s72, v8
  ds_write_b32 v38, v9 offset:6656
  v_sub_f32 v104, v104, v8
  v_sub_f32 v105, v105, v8
  v_sub_f32 v106, v106, v8
  v_sub_f32 v108, v108, v8
  v_sub_f32 v109, v109, v8
  v_sub_f32 v110, v110, v8
  v_sub_f32 v112, v112, v8
  v_sub_f32 v113, v113, v8
  v_sub_f32 v114, v114, v8
  v_sub_f32 v116, v116, v8
  v_sub_f32 v117, v117, v8
  v_sub_f32 v118, v118, v8
  v_sub_f32 v120, v120, v8
  v_sub_f32 v121, v121, v8
  v_sub_f32 v122, v122, v8
  v_sub_f32 v124, v124, v8
  v_sub_f32 v125, v125, v8
  v_sub_f32 v126, v126, v8
  v_sub_f32 v128, v128, v8
  v_sub_f32 v129, v129, v8
  v_sub_f32 v130, v130, v8
  v_sub_f32 v132, v132, v8
  v_sub_f32 v133, v133, v8
  v_sub_f32 v134, v134, v8
  v_mul_f32 v104, 0x3fb8aa3b, v104
  v_mul_f32 v105, 0x3fb8aa3b, v105
  v_mul_f32 v106, 0x3fb8aa3b, v106
  v_mul_f32 v108, 0x3fb8aa3b, v108
  v_mul_f32 v109, 0x3fb8aa3b, v109
  v_mul_f32 v110, 0x3fb8aa3b, v110
  v_mul_f32 v112, 0x3fb8aa3b, v112
  v_mul_f32 v113, 0x3fb8aa3b, v113
  v_mul_f32 v114, 0x3fb8aa3b, v114
  v_mul_f32 v116, 0x3fb8aa3b, v116
  v_mul_f32 v117, 0x3fb8aa3b, v117
  v_mul_f32 v118, 0x3fb8aa3b, v118
  v_mul_f32 v120, 0x3fb8aa3b, v120
  v_mul_f32 v121, 0x3fb8aa3b, v121
  v_mul_f32 v122, 0x3fb8aa3b, v122
  v_mul_f32 v124, 0x3fb8aa3b, v124
  v_mul_f32 v125, 0x3fb8aa3b, v125
  v_mul_f32 v126, 0x3fb8aa3b, v126
  v_mul_f32 v128, 0x3fb8aa3b, v128
  v_mul_f32 v129, 0x3fb8aa3b, v129
  v_mul_f32 v130, 0x3fb8aa3b, v130
  v_mul_f32 v132, 0x3fb8aa3b, v132
  v_mul_f32 v133, 0x3fb8aa3b, v133
  v_mul_f32 v134, 0x3fb8aa3b, v134
  v_exp_f32 v104, v104
  v_exp_f32 v105, v105
  v_exp_f32 v106, v106
  v_exp_f32 v108, v108
  v_exp_f32 v109, v109
  v_exp_f32 v110, v110
  v_exp_f32 v112, v112
  v_exp_f32 v113, v113
  v_exp_f32 v114, v114
  v_exp_f32 v116, v116
  v_exp_f32 v117, v117
  v_exp_f32 v118, v118
  v_exp_f32 v120, v120
  v_exp_f32 v121, v121
  v_exp_f32 v122, v122
  v_exp_f32 v124, v124
  v_exp_f32 v125, v125
  v_exp_f32 v126, v126
  v_exp_f32 v128, v128
  v_exp_f32 v129, v129
  v_exp_f32 v130, v130
  v_exp_f32 v132, v132
  v_exp_f32 v133, v133
  v_exp_f32 v134, v134
  s_nop 0
  v_add_f32 v104, v104, v120
  v_add_f32 v105, v105, v121
  v_add_f32 v106, v106, v122
  v_add_f32 v108, v108, v124
  v_add_f32 v109, v109, v125
  v_add_f32 v110, v110, v126
  v_add_f32 v112, v112, v128
  v_add_f32 v113, v113, v129
  v_add_f32 v114, v114, v130
  v_add_f32 v116, v116, v132
  v_add_f32 v117, v117, v133
  v_add_f32 v118, v118, v134
  v_add_f32 v104, v104, v112
  v_add_f32 v105, v105, v113
  v_add_f32 v106, v106, v114
  v_add_f32 v108, v108, v116
  v_add_f32 v109, v109, v117
  v_add_f32 v110, v110, v118
  v_add_f32 v104, v104, v108
  v_add_f32 v105, v105, v109
  v_add_f32 v106, v106, v110
  v_add_f32 v10, v104, v105
  v_add_f32 v10, v10, v106
  s_nop 1
  v_add_f32_dpp v10, v10, v10 row_ror:8 row_mask:0xf bank_mask:0xf
  s_nop 1
  v_add_f32_dpp v10, v10, v10 row_ror:4 row_mask:0xf bank_mask:0xf
  s_nop 1
  v_add_f32_dpp v10, v10, v10 row_ror:2 row_mask:0xf bank_mask:0xf
  s_nop 1
  v_add_f32_dpp v10, v10, v10 row_ror:1 row_mask:0xf bank_mask:0xf
  v_mov_b32 v11, v10
  s_nop 1
  v_permlane16_swap_b32 v11, v10
  v_add_f32 v10, v10, v11
  v_mov_b32 v11, v10
  s_nop 1
  v_permlane32_swap_b32 v11, v10
  v_add_f32 v10, v10, v11
  v_mov_b32 v9, s74
  v_mov_b32 v11, s74
  s_mov_b64 exec, 1
  s_cmp_eq_u32 s75, 1
  s_cbranch_scc0 L_pf_73
  global_store_dwordx4 v18, v[8:11], s[42:43]
  s_branch L_pe_74
L_pf_73:
  global_store_dwordx4 v18, v[8:11], s[42:43] sc1
L_pe_74:
  s_mov_b64 exec, -1
L_disp3:
  s_mov_b32 s77, 0
  s_bfe_u32 s62, s74, 0x80000
  s_bfe_u32 s63, s74, 0x80008
  s_bfe_u32 s64, s74, 0x80010
  s_bfe_u32 s65, s74, 0x80018
  s_cmp_lg_u32 s5, 2
  s_cbranch_scc1 L_opt_75
  s_mov_b32 s70, 0
L_pl_76:
  ds_read_b32 v8, v38 offset:6656
  s_waitcnt lgkmcnt(0)
  v_cmp_eq_u32 vcc, -1, v8
  s_cmp_eq_u64 vcc, 0
  s_cbranch_scc1 L_pld_77
  s_sleep 32
  s_add_u32 s70, s70, 1
  s_cmp_lt_u32 s70, 1048576
  s_cbranch_scc1 L_pl_76
L_pld_77:
  s_lshl_b32 s56, s6, 2
  s_add_u32 s56, s56, s7
  s_lshl_b32 s57, s56, 9
  s_add_u32 s57, s57, 131072
  v_lshl_add_u32 v3, v1, 3, s57
  global_load_dword v167, v3, s[42:43] sc1
L_opt_75:
  s_cmp_eq_u32 s60, 2
  s_cbranch_scc1 L_pre_f1
  s_cmp_eq_u32 s60, 3
  s_cbranch_scc1 L_pre_f2
  s_cmp_eq_u32 s60, 1
  s_cbranch_scc1 L_pre_wo
  s_lshr_b32 s68, s14, 29
  s_mul_i32 s68, s68, 1
  s_xor_b32 s68, s68, s8
  s_lshl_b32 s68, s68, 3
  s_add_u32 s68, s68, L_gtab-L_pc2
  s_load_dwordx2 s[100:101], s[100:101], s68
  s_waitcnt lgkmcnt(0)
  s_lshr_b32 s68, s14, 26
  s_lshl_b32 s68, s68, 2
  s_add_u32 s68, s68, s5
  s_and_b32 s68, s68, 31
  s_and_b32 s69, s100, 0xffff
  s_lshr_b32 s100, s100, 16
  v_and_b32 v12, 3, v1
  v_lshl_add_u32 v12, v12, 7, s69
  v_min_u32 v12, s100, v12
  v_lshrrev_b32 v13, 2, v1
  v_mul_u32_u24 v13, 2752, v13
  s_mul_i32 s69, s68, 44032
  v_add3_u32 v12, v12, v13, s69
  v_min_u32 v13, 42, v1
  s_mul_i32 s68, s68, 44032
  s_add_u32 s68, s68, s101
  v_lshl_add_u32 v13, v13, 10, s68
  s_branch L_join
L_pre_wo:
  s_mov_b32 s70, 0
L_hs_78:
  ds_read_b32 v9, v38 offset:6720
  s_waitcnt lgkmcnt(0)
  v_cmp_gt_u32 vcc, 8, v9
  s_cmp_eq_u64 vcc, 0
  s_cbranch_scc1 L_hsd_79
  s_sleep 8
  s_add_u32 s70, s70, 1
  s_cmp_lt_u32 s70, 2097152
  s_cbranch_scc1 L_hs_78
L_hsd_79:
  v_lshrrev_b32 v2, 2, v1
  v_bfe_u32 v3, v1, 1, 1
  s_lshl_b32 s49, s5, 1
  v_or_b32 v3, s49, v3
  v_and_b32 v10, 6, v2
  v_xor_b32 v3, v3, v10
  v_lshlrev_b32 v2, 7, v2
  v_lshl_add_u32 v2, v3, 4, v2
  v_and_b32 v3, 1, v1
  v_lshl_add_u32 v2, v3, 3, v2
  v_add_u32 v2, 20480, v2
  s_add_u32 s49, s5, 0
  s_and_b32 s49, s49, 3
  s_mul_i32 s49, s49, 16384
  v_add_u32 v3, s49, v2
  ds_read_b64_tr_b16 v[40:41], v3 offset:0
  ds_read_b64_tr_b16 v[42:43], v3 offset:2048
  ds_read_b64_tr_b16 v[44:45], v3 offset:4096
  ds_read_b64_tr_b16 v[46:47], v3 offset:6144
  ds_read_b64_tr_b16 v[48:49], v3 offset:8192
  ds_read_b64_tr_b16 v[50:51], v3 offset:10240
  ds_read_b64_tr_b16 v[52:53], v3 offset:12288
  ds_read_b64_tr_b16 v[54:55], v3 offset:14336
  s_add_u32 s49, s5, 1
  s_and_b32 s49, s49, 3
  s_mul_i32 s49, s49, 16384
  v_add_u32 v3, s49, v2
  ds_read_b64_tr_b16 v[56:57], v3 offset:0
  ds_read_b64_tr_b16 v[58:59], v3 offset:2048
  ds_read_b64_tr_b16 v[60:61], v3 offset:4096
  ds_read_b64_tr_b16 v[62:63], v3 offset:6144
  s_waitcnt lgkmcnt(10)
  ds_read_b64_tr_b16 v[64:65], v3 offset:8192
  ds_read_b64_tr_b16 v[66:67], v3 offset:10240
  s_waitcnt lgkmcnt(10)
  ds_read_b64_tr_b16 v[68:69], v3 offset:12288
  ds_read_b64_tr_b16 v[70:71], v3 offset:14336
  s_waitcnt lgkmcnt(10)
  s_add_u32 s49, s5, 2
  s_and_b32 s49, s49, 3
  s_mul_i32 s49, s49, 16384
  v_add_u32 v3, s49, v2
  ds_read_b64_tr_b16 v[72:73], v3 offset:0
  ds_read_b64_tr_b16 v[74:75], v3 offset:2048
  s_waitcnt lgkmcnt(10)
  ds_read_b64_tr_b16 v[76:77], v3 offset:4096
  ds_read_b64_tr_b16 v[78:79], v3 offset:6144
  s_waitcnt lgkmcnt(10)
  ds_read_b64_tr_b16 v[80:81], v3 offset:8192
  ds_read_b64_tr_b16 v[82:83], v3 offset:10240
  s_waitcnt lgkmcnt(10)
  ds_read_b64_tr_b16 v[84:85], v3 offset:12288
  ds_read_b64_tr_b16 v[86:87], v3 offset:14336
  s_waitcnt lgkmcnt(10)
  s_add_u32 s49, s5, 3
  s_and_b32 s49, s49, 3
  s_mul_i32 s49, s49, 16384
  v_add_u32 v3, s49, v2
  ds_read_b64_tr_b16 v[88:89], v3 offset:0
  ds_read_b64_tr_b16 v[90:91], v3 offset:2048
  s_waitcnt lgkmcnt(10)
  ds_read_b64_tr_b16 v[92:93], v3 offset:4096
  ds_read_b64_tr_b16 v[94:95], v3 offset:6144
  s_waitcnt lgkmcnt(10)
  ds_read_b64_tr_b16 v[96:97], v3 offset:8192
  ds_read_b64_tr_b16 v[98:99], v3 offset:10240
  s_waitcnt lgkmcnt(10)
  ds_read_b64_tr_b16 v[100:101], v3 offset:12288
  ds_read_b64_tr_b16 v[102:103], v3 offset:14336
  s_waitcnt lgkmcnt(10)
  s_waitcnt lgkmcnt(0)
  s_lshl_b32 s49, s5, 3
  s_add_u32 s49, s49, s66
  s_lshl_b32 s50, s49, 9
  s_add_u32 s50, s50, 65536
  v_lshrrev_b32 v12, 5, v1
  v_lshl_add_u32 v15, v12, 14, s50
  v_and_b32 v16, 3, v1
  v_lshl_add_u32 v15, v16, 7, v15
  s_mov_b32 s70, 0
L_pl_80:
  ds_read_b32 v8, v38 offset:6676
  s_waitcnt lgkmcnt(0)
  v_cmp_eq_u32 vcc, -1, v8
  s_cmp_eq_u64 vcc, 0
  s_cbranch_scc1 L_pld_81
  s_sleep 16
  s_add_u32 s70, s70, 1
  s_cmp_lt_u32 s70, 1048576
  s_cbranch_scc1 L_pl_80
L_pld_81:
  s_mov_b32 s70, 0
L_polt_82:
  global_load_dwordx4 v[16:19], v15, s[42:43] sc1
  s_waitcnt vmcnt(0)
  v_cmp_ne_u32 vcc, s74, v17
  v_cmp_ne_u32 s[68:69], s74, v19
  s_or_b64 vcc, vcc, s[68:69]
  s_cmp_eq_u64 vcc, 0
  s_cbranch_scc1 L_poltd_83
  s_sleep 8
  s_add_u32 s70, s70, 1
  s_cmp_lt_u32 s70, 262144
  s_cbranch_scc1 L_polt_82
L_poltd_83:
  v_max_f32_dpp v10, v16, v16 quad_perm:[1,0,3,2] row_mask:0xf bank_mask:0xf
  s_nop 1
  v_max_f32_dpp v10, v10, v10 quad_perm:[2,3,0,1] row_mask:0xf bank_mask:0xf
  v_sub_f32 v8, v16, v10
  v_mul_f32 v8, 0x3fb8aa3b, v8
  v_exp_f32 v8, v8
  s_nop 0
  v_mul_f32 v9, v18, v8
  s_nop 1
  v_add_f32_dpp v9, v9, v9 quad_perm:[1,0,3,2] row_mask:0xf bank_mask:0xf
  s_nop 1
  v_add_f32_dpp v9, v9, v9 quad_perm:[2,3,0,1] row_mask:0xf bank_mask:0xf
  v_rcp_f32 v9, v9
  s_nop 0
  v_mul_f32 v8, v8, v9
  s_nop 1
  v_mov_b32_dpp v20, v8 quad_perm:[0,0,0,0] row_mask:0xf bank_mask:0xf
  v_mov_b32_dpp v21, v8 quad_perm:[1,1,1,1] row_mask:0xf bank_mask:0xf
  v_mov_b32_dpp v22, v8 quad_perm:[2,2,2,2] row_mask:0xf bank_mask:0xf
  v_mov_b32_dpp v23, v8 quad_perm:[3,3,3,3] row_mask:0xf bank_mask:0xf
  s_lshl_b32 s49, s49, 11
  s_add_u32 s49, s49, 131072
  v_lshrrev_b32 v12, 5, v1
  v_and_b32 v16, 31, v1
  v_lshlrev_b32 v15, 16, v12
  v_lshl_add_u32 v15, v16, 4, v15
  v_add_u32 v15, s49, v15
  v_mul_u32_u24 v12, 1056, v12
  v_bfe_u32 v16, v1, 3, 2
  v_lshl_add_u32 v12, v16, 6, v12
  v_and_b32 v16, 3, v1
  v_lshl_add_u32 v12, v16, 4, v12
  v_bfe_u32 v16, v1, 2, 1
  v_lshl_add_u32 v12, v16, 3, v12
  s_lshl_b32 s49, s5, 8
  v_add_u32 v12, s49, v12
  v_and_b32 v14, 1, v1
  v_mul_u32_u24 v14, 1056, v14
  v_lshrrev_b32 v3, 4, v1
  v_lshl_add_u32 v14, v3, 4, v14
  v_and_b32 v13, 1, v1
  v_lshlrev_b32 v13, 6, v13
  v_lshrrev_b32 v3, 4, v1
  v_lshl_add_u32 v13, v3, 4, v13
  s_lshl_b32 s49, s5, 7
  s_add_u32 s49, s49, s58
  v_add_u32 v13, s49, v13
  v_add_u32 v37, 0x2000, v13
  v_mov_b32 v36, 0xff
  s_add_u32 s49, s5, 1
  s_and_b32 s49, s49, 3
  s_lshl_b32 s49, s49, 8
  v_add_u32 v0, s49, v14
  s_add_u32 s49, s5, 2
  s_and_b32 s49, s49, 3
  s_lshl_b32 s49, s49, 8
  v_add_u32 v2, s49, v14
  s_add_u32 s49, s5, 3
  s_and_b32 s49, s49, 3
  s_lshl_b32 s49, s49, 8
  v_add_u32 v3, s49, v14
  s_add_u32 s49, s5, 0
  s_and_b32 s49, s49, 3
  s_lshl_b32 s49, s49, 8
  v_add_u32 v14, s49, v14
  s_branch L_join
L_pre_f1:
  s_cmp_lg_u32 s5, 3
  s_cbranch_scc1 L_hc_84
  s_mov_b32 s70, 0
L_pl_85:
  ds_read_b32 v8, v38 offset:6400
  s_waitcnt lgkmcnt(0)
  v_cmp_eq_u32 vcc, -1, v8
  s_cmp_eq_u64 vcc, 0
  s_cbranch_scc1 L_pld_86
  s_sleep 32
  s_add_u32 s70, s70, 1
  s_cmp_lt_u32 s70, 1048576
  s_cbranch_scc1 L_pl_85
L_pld_86:
  v_lshlrev_b32 v110, 5, v1
  global_load_dword v109, v110, s[42:43] offset:1028 sc1
  s_waitcnt vmcnt(0)
  v_subrev_u32 v109, s74, v109
  v_cmp_eq_u32 vcc, 1, v109
  s_bcnt1_i32_b64 s70, vcc
  v_cmp_eq_u32 vcc, 0, v109
  s_bcnt1_i32_b64 s71, vcc
  s_cmp_gt_u32 s70, s71
  s_cselect_b32 s71, 4, 0
  s_sub_u32 s68, s76, s74
  s_xor_b32 s71, s71, s68
  s_and_b32 s71, s71, 4
  s_lshl_b32 s71, s71, 11
  v_mov_b32 v104, s71
  ds_write_b32 v38, v104 offset:6668
L_hc_84:
  v_mov_b32 v31, v13
  v_lshlrev_b32 v15, 4, v0
  v_add_u32 v24, 12288, v15
  v_add_u32 v25, 16384, v15
  v_add_u32 v26, 20480, v15
  s_mov_b32 s70, 0
L_pl_87:
  ds_read_b32 v11, v38 offset:6668
  s_waitcnt lgkmcnt(0)
  v_cmp_eq_u32 vcc, -1, v11
  s_cmp_eq_u64 vcc, 0
  s_cbranch_scc1 L_pld_88
  s_sleep 8
  s_add_u32 s70, s70, 1
  s_cmp_lt_u32 s70, 1048576
  s_cbranch_scc1 L_pl_87
L_pld_88:
  v_add_u32 v15, 327680, v15
  v_add_u32 v15, v11, v15
  v_add_u32 v35, 4096, v15
  v_add_u32 v32, 16384, v15
  v_add_u32 v36, 20480, v15
  v_add_u32 v33, 32768, v15
  v_add_u32 v37, 36864, v15
  v_add_u32 v34, 49152, v15
  v_add_u32 v39, 53248, v15
  v_bfe_u32 v5, v1, 2, 1
  v_mul_u32_u24 v5, 1056, v5
  v_lshrrev_b32 v3, 3, v0
  v_lshl_add_u32 v5, v3, 5, v5
  v_and_b32 v3, 3, v1
  v_lshl_add_u32 v5, v3, 3, v5
  v_and_b32 v14, 7, v1
  v_mul_u32_u24 v14, 1056, v14
  v_lshrrev_b32 v3, 4, v1
  v_lshl_add_u32 v14, v3, 4, v14
  v_and_b32 v7, 1, v1
  v_mul_u32_u24 v7, 1056, v7
  v_lshrrev_b32 v3, 1, v1
  v_lshl_add_u32 v7, v3, 5, v7
  v_and_b32 v13, 3, v1
  v_lshlrev_b32 v13, 5, v13
  v_bfe_u32 v3, v1, 4, 1
  v_lshl_add_u32 v13, v3, 3, v13
  s_lshl_b32 s49, s5, 7
  s_add_u32 s49, s49, s58
  v_add_u32 v13, s49, v13
  v_lshrrev_b32 v3, 5, v1
  v_lshl_add_u32 v13, v3, 4, v13
  v_add_u32 v4, 0x2000, v13
  s_and_b32 s54, s61, 1
  s_mul_i32 s52, s54, -2
  s_add_u32 s52, s52, 1
  s_mul_i32 s53, s52, 16384
  s_sub_u32 s53, s53, 8192
  s_mul_i32 s52, s52, 2752
  s_sub_u32 s52, s52, 704512
  v_lshrrev_b32 v2, 2, v1
  v_mul_u32_u24 v2, 5504, v2
  s_and_b32 s49, s5, 2
  s_or_b32 s49, s49, s54
  v_xor_b32 v3, s49, v1
  v_and_b32 v3, 3, v3
  v_lshl_add_u32 v2, v3, 4, v2
  v_mov_b32 v0, v2
  v_lshrrev_b32 v6, 3, v1
  v_lshlrev_b32 v6, 6, v6
  v_bfe_u32 v3, v1, 2, 1
  v_lshl_add_u32 v6, v3, 14, v6
  v_and_b32 v8, 2, v1
  v_or_b32 v3, v3, v8
  v_xor_b32 v3, s5, v3
  v_lshl_add_u32 v6, v3, 4, v6
  v_lshl_add_u32 v6, v8, 14, v6
  v_and_b32 v3, 1, v1
  v_lshl_add_u32 v6, v3, 3, v6
  v_add_u32 v6, 20480, v6
  s_and_b32 s55, s5, 1
  s_mul_i32 s49, s55, 704512
  s_add_u32 s49, s49, s48
  s_mul_i32 s50, s54, 2752
  s_add_u32 s49, s49, s50
  s_lshr_b32 s50, s5, 1
  s_lshl_b32 s50, s50, 15
  s_lshl_b32 s54, s54, 14
  s_add_u32 s50, s50, s54
  s_lshl_b32 s55, s55, 13
  s_add_u32 s50, s50, s55
  s_add_u32 s50, s50, 20480
  s_mov_b32 s70, 0
L_pl_89:
  ds_read_b32 v8, v38 offset:6676
  s_waitcnt lgkmcnt(0)
  v_cmp_eq_u32 vcc, -1, v8
  s_cmp_eq_u64 vcc, 0
  s_cbranch_scc1 L_pld_90
  s_sleep 16
  s_add_u32 s70, s70, 1
  s_cmp_lt_u32 s70, 1048576
  s_cbranch_scc1 L_pl_89
L_pld_90:
  global_load_dwordx2 v[8:9], v31, s[16:17]
  s_mov_b32 s70, 0
L_polt_91:
  global_load_dwordx4 v[136:139], v24, s[42:43] sc1
  global_load_dwordx4 v[140:143], v25, s[42:43] sc1
  global_load_dwordx4 v[144:147], v26, s[42:43] sc1
  s_waitcnt vmcnt(0)
  v_cmp_ne_u32 vcc, s74, v137
  v_cmp_ne_u32 s[68:69], s74, v139
  s_or_b64 vcc, vcc, s[68:69]
  v_cmp_ne_u32 s[68:69], s74, v141
  s_or_b64 vcc, vcc, s[68:69]
  v_cmp_ne_u32 s[68:69], s74, v143
  s_or_b64 vcc, vcc, s[68:69]
  v_cmp_ne_u32 s[68:69], s74, v145
  s_or_b64 vcc, vcc, s[68:69]
  v_cmp_ne_u32 s[68:69], s74, v147
  s_or_b64 vcc, vcc, s[68:69]
  s_cmp_eq_u64 vcc, 0
  s_cbranch_scc1 L_poltd_92
  s_sleep 8
  s_add_u32 s70, s70, 1
  s_cmp_lt_u32 s70, 262144
  s_cbranch_scc1 L_polt_91
L_poltd_92:
  v_lshlrev_b32 v16, 16, v8
  v_and_b32 v17, s73, v8
  v_lshlrev_b32 v18, 16, v9
  v_and_b32 v19, s73, v9
  v_lshlrev_b32 v20, 16, v136
  v_and_b32 v21, s73, v136
  v_lshlrev_b32 v22, 16, v138
  v_and_b32 v23, s73, v138
  v_lshlrev_b32 v28, 16, v144
  v_and_b32 v29, s73, v144
  v_lshlrev_b32 v30, 16, v146
  v_and_b32 v31, s73, v146
  v_add_f32 v28, 1.0, v28
  v_add_f32 v29, 1.0, v29
  v_add_f32 v30, 1.0, v30
  v_add_f32 v31, 1.0, v31
  v_cvt_pk_bf16_f32 v8, v28, v29
  v_cvt_pk_bf16_f32 v9, v30, v31
  v_mov_b32 v141, v142
  ds_write_b64 v12, v[8:9] offset:2112
  ds_write_b64 v12, v[140:141] offset:4224
  v_cvt_pk_bf16_f32 v28, 0, v28
  v_cvt_pk_bf16_f32 v29, 0, v29
  v_cvt_pk_bf16_f32 v30, 0, v30
  v_cvt_pk_bf16_f32 v31, 0, v31
  v_mul_f32 v24, v20, v28
  v_mul_f32 v25, v21, v29
  v_mul_f32 v26, v22, v30
  v_mul_f32 v27, v23, v31
  v_mul_f32 v28, v16, v28
  v_mul_f32 v29, v17, v29
  v_mul_f32 v30, v18, v30
  v_mul_f32 v31, v19, v31
  s_branch L_join
L_pre_f2:
  s_cmp_lg_u32 s5, 3
  s_cbranch_scc1 L_hc_93
  s_mov_b32 s70, 0
L_pl_94:
  ds_read_b32 v8, v38 offset:6400
  s_waitcnt lgkmcnt(0)
  v_cmp_eq_u32 vcc, -1, v8
  s_cmp_eq_u64 vcc, 0
  s_cbranch_scc1 L_pld_95
  s_sleep 32
  s_add_u32 s70, s70, 1
  s_cmp_lt_u32 s70, 1048576
  s_cbranch_scc1 L_pl_94
L_pld_95:
  v_lshlrev_b32 v110, 5, v1
  global_load_dword v109, v110, s[42:43] offset:1028 sc1
  s_waitcnt vmcnt(0)
  v_subrev_u32 v109, s74, v109
  v_cmp_eq_u32 vcc, 1, v109
  s_bcnt1_i32_b64 s70, vcc
  v_cmp_eq_u32 vcc, 0, v109
  s_bcnt1_i32_b64 s71, vcc
  s_cmp_gt_u32 s70, s71
  s_cselect_b32 s71, 4, 0
  s_sub_u32 s68, s76, s74
  s_xor_b32 s71, s71, s68
  s_and_b32 s71, s71, 4
  s_lshl_b32 s71, s71, 11
  v_mov_b32 v104, s71
  ds_write_b32 v38, v104 offset:6668
L_hc_93:
  v_and_b32 v12, 1, v1
  v_lshrrev_b32 v14, 4, v1
  s_lshl_b32 s49, s61, 5
  v_lshl_add_u32 v3, v14, 3, s49
  v_lshl_add_u32 v13, v12, 10, v3
  v_mov_b32 v31, v13
  v_lshlrev_b32 v15, 6, v12
  v_lshl_add_u32 v15, v14, 4, v15
  s_lshl_b32 s49, s61, 7
  v_add_u32 v15, s49, v15
  v_add_u32 v24, 12288, v15
  v_add_u32 v25, 24576, v15
  s_mov_b32 s70, 0
L_pl_96:
  ds_read_b32 v11, v38 offset:6668
  s_waitcnt lgkmcnt(0)
  v_cmp_eq_u32 vcc, -1, v11
  s_cmp_eq_u64 vcc, 0
  s_cbranch_scc1 L_pld_97
  s_sleep 8
  s_add_u32 s70, s70, 1
  s_cmp_lt_u32 s70, 1048576
  s_cbranch_scc1 L_pl_96
L_pld_97:
  v_add_u32 v15, 327680, v15
  v_add_u32 v15, v11, v15
  v_add_u32 v35, 4096, v15
  v_add_u32 v32, 16384, v15
  v_add_u32 v36, 20480, v15
  v_add_u32 v33, 32768, v15
  v_add_u32 v37, 36864, v15
  v_add_u32 v34, 49152, v15
  v_add_u32 v39, 53248, v15
  s_lshl_b32 s49, s5, 14
  s_add_u32 s49, s49, 264192
  v_lshl_add_u32 v28, v14, 7, s49
  v_add_u32 v28, v11, v28
  v_lshl_add_u32 v28, v12, 5, v28
  v_and_b32 v3, 2, v1
  v_lshl_add_u32 v28, v3, 3, v28
  v_bfe_u32 v3, v1, 2, 2
  v_lshl_add_u32 v28, v3, 9, v28
  v_lshl_add_u32 v12, v14, 1, v12
  v_lshlrev_b32 v12, 4, v12
  v_add_u32 v12, 11008, v12
  s_lshl_b32 s49, s5, 7
  v_add_u32 v30, s49, v12
  v_lshrrev_b32 v2, 1, v1
  v_lshlrev_b32 v2, 10, v2
  v_and_b32 v3, 1, v1
  v_lshl_add_u32 v2, v3, 4, v2
  v_mov_b32 v29, v2
  v_lshlrev_b32 v6, 8, v14
  v_bfe_u32 v3, v1, 2, 2
  v_lshl_add_u32 v6, v3, 5, v6
  v_and_b32 v3, 3, v1
  v_lshl_add_u32 v6, v3, 3, v6
  s_mul_i32 s49, s5, 11264
  s_add_u32 s49, s49, 20480
  v_add_u32 v6, s49, v6
  s_mov_b32 s70, 0
L_pl_98:
  ds_read_b32 v8, v38 offset:6676
  s_waitcnt lgkmcnt(0)
  v_cmp_eq_u32 vcc, -1, v8
  s_cmp_eq_u64 vcc, 0
  s_cbranch_scc1 L_pld_99
  s_sleep 16
  s_add_u32 s70, s70, 1
  s_cmp_lt_u32 s70, 1048576
  s_cbranch_scc1 L_pl_98
L_pld_99:
  global_load_dwordx2 v[8:9], v31, s[16:17]
  s_mov_b32 s70, 0
L_polt_100:
  global_load_dwordx4 v[136:139], v24, s[42:43] sc1
  global_load_dwordx4 v[140:143], v25, s[42:43] sc1
  s_waitcnt vmcnt(0)
  v_cmp_ne_u32 vcc, s74, v137
  v_cmp_ne_u32 s[68:69], s74, v139
  s_or_b64 vcc, vcc, s[68:69]
  v_cmp_ne_u32 s[68:69], s74, v141
  s_or_b64 vcc, vcc, s[68:69]
  v_cmp_ne_u32 s[68:69], s74, v143
  s_or_b64 vcc, vcc, s[68:69]
  s_cmp_eq_u64 vcc, 0
  s_cbranch_scc1 L_poltd_101
  s_sleep 8
  s_add_u32 s70, s70, 1
  s_cmp_lt_u32 s70, 262144
  s_cbranch_scc1 L_polt_100
L_poltd_101:
  s_cmp_lg_u32 s5, 2
  s_cbranch_scc1 L_apw_102
  s_and_b32 s49, s61, 3
  s_lshl_b32 s49, s49, 14
  s_add_u32 s49, s49, 327680
  v_lshl_add_u32 v3, v1, 7, s49
  v_add_u32 v3, v11, v3
  global_load_dword v167, v3, s[42:43] sc1
L_apw_102:
  v_lshlrev_b32 v16, 16, v8
  v_and_b32 v17, s73, v8
  v_lshlrev_b32 v18, 16, v9
  v_and_b32 v19, s73, v9
  v_lshlrev_b32 v20, 16, v136
  v_and_b32 v21, s73, v136
  v_lshlrev_b32 v22, 16, v138
  v_and_b32 v23, s73, v138
  v_lshlrev_b32 v24, 16, v140
  v_and_b32 v25, s73, v140
  v_lshlrev_b32 v26, 16, v142
  v_and_b32 v27, s73, v142
L_join:
  s_waitcnt vmcnt(0) lgkmcnt(0)
  s_barrier
  s_cmp_eq_u32 s60, 1
  s_cbranch_scc1 L_t_wo
  s_cmp_eq_u32 s60, 2
  s_cbranch_scc1 L_t_f1
  s_cmp_eq_u32 s60, 3
  s_cbranch_scc1 L_t_f2
  global_load_dword v16, v12, s[28:29]
  global_load_dword v17, v12, s[30:31]
  global_load_dword v18, v13, s[32:33]
  s_branch L_fin
L_t_wo:
  s_mov_b32 s70, 0
L_wo_p:
  global_load_dwordx4 v[104:107], v15, s[42:43] offset:0 sc1
  global_load_dwordx4 v[108:111], v15, s[42:43] offset:512 sc1
  global_load_dwordx4 v[112:115], v15, s[42:43] offset:1024 sc1
  global_load_dwordx4 v[116:119], v15, s[42:43] offset:1536 sc1
  s_waitcnt vmcnt(3)
  v_xor_b32 v104, s62, v104
  v_xor_b32 v105, s63, v105
  v_xor_b32 v106, s64, v106
  v_xor_b32 v107, s65, v107
  s_waitcnt vmcnt(2)
  v_xor_b32 v108, s62, v108
  v_xor_b32 v109, s63, v109
  v_xor_b32 v110, s64, v110
  v_xor_b32 v111, s65, v111
  s_waitcnt vmcnt(1)
  v_xor_b32 v112, s62, v112
  v_xor_b32 v113, s63, v113
  v_xor_b32 v114, s64, v114
  v_xor_b32 v115, s65, v115
  s_waitcnt vmcnt(0)
  v_xor_b32 v116, s62, v116
  v_xor_b32 v117, s63, v117
  v_xor_b32 v118, s64, v118
  v_xor_b32 v119, s65, v119
  v_or3_b32 v28, v104, v105, v106
  v_or3_b32 v29, v107, v108, v109
  v_or3_b32 v30, v110, v111, v112
  v_or3_b32 v31, v113, v114, v115
  v_or3_b32 v28, v28, v29, v30
  v_or3_b32 v31, v31, v116, v117
  v_or3_b32 v28, v28, v118, v119
  v_or_b32 v28, v28, v31
  v_lshlrev_b32 v28, 24, v28
  v_cmp_ne_u32 vcc, 0, v28
  v_pk_mul_f32 v[16:17], v[104:105], v[20:21] op_sel:[0,0] op_sel_hi:[1,0]
  v_pk_mul_f32 v[18:19], v[106:107], v[20:21] op_sel:[0,0] op_sel_hi:[1,0]
  v_pk_fma_f32 v[16:17], v[108:109], v[20:21], v[16:17] op_sel:[0,1,0] op_sel_hi:[1,1,1]
  v_pk_fma_f32 v[18:19], v[110:111], v[20:21], v[18:19] op_sel:[0,1,0] op_sel_hi:[1,1,1]
  v_pk_fma_f32 v[16:17], v[112:113], v[22:23], v[16:17] op_sel:[0,0,0] op_sel_hi:[1,0,1]
  v_pk_fma_f32 v[18:19], v[114:115], v[22:23], v[18:19] op_sel:[0,0,0] op_sel_hi:[1,0,1]
  v_pk_fma_f32 v[16:17], v[116:117], v[22:23], v[16:17] op_sel:[0,1,0] op_sel_hi:[1,1,1]
  v_pk_fma_f32 v[18:19], v[118:119], v[22:23], v[18:19] op_sel:[0,1,0] op_sel_hi:[1,1,1]
  s_cmp_eq_u64 vcc, 0
  s_cbranch_scc1 L_wo_ok
  s_add_u32 s70, s70, 1
  s_cmp_lt_u32 s70, 262144
  s_cbranch_scc1 L_wo_p
L_wo_ok:
  v_cvt_pk_bf16_f32 v16, v16, v17
  v_cvt_pk_bf16_f32 v17, v18, v19
  ds_write_b64 v12, v[16:17] offset:0
  ds_read_b128 v[104:107], v14 offset:0
  ds_read_b128 v[108:111], v14 offset:64
  ds_read_b128 v[112:115], v14 offset:128
  ds_read_b128 v[116:119], v14 offset:192
  s_waitcnt lgkmcnt(4)
  s_barrier
  ds_read_b128 v[120:123], v0 offset:0
  ds_read_b128 v[124:127], v0 offset:64
  ds_read_b128 v[128:131], v0 offset:128
  ds_read_b128 v[132:135], v0 offset:192
  s_waitcnt lgkmcnt(4)
  v_mfma_f32_16x16x32_bf16 v[8:11], v[40:43], v[104:107], 0
  ds_read_b128 v[136:139], v2 offset:0
  ds_read_b128 v[140:143], v2 offset:64
  v_mfma_f32_16x16x32_bf16 v[8:11], v[44:47], v[108:111], v[8:11]
  ds_read_b128 v[144:147], v2 offset:128
  ds_read_b128 v[148:151], v2 offset:192
  v_mfma_f32_16x16x32_bf16 v[8:11], v[48:51], v[112:115], v[8:11]
  ds_read_b128 v[152:155], v3 offset:0
  ds_read_b128 v[156:159], v3 offset:64
  v_mfma_f32_16x16x32_bf16 v[8:11], v[52:55], v[116:119], v[8:11]
  ds_read_b128 v[160:163], v3 offset:128
  ds_read_b128 v[164:167], v3 offset:192
  s_waitcnt lgkmcnt(11)
  v_mfma_f32_16x16x32_bf16 v[8:11], v[56:59], v[120:123], v[8:11]
  s_waitcnt lgkmcnt(10)
  v_mfma_f32_16x16x32_bf16 v[8:11], v[60:63], v[124:127], v[8:11]
  s_waitcnt lgkmcnt(9)
  v_mfma_f32_16x16x32_bf16 v[8:11], v[64:67], v[128:131], v[8:11]
  s_waitcnt lgkmcnt(8)
  v_mfma_f32_16x16x32_bf16 v[8:11], v[68:71], v[132:135], v[8:11]
  s_waitcnt lgkmcnt(7)
  v_mfma_f32_16x16x32_bf16 v[8:11], v[72:75], v[136:139], v[8:11]
  s_waitcnt lgkmcnt(6)
  v_mfma_f32_16x16x32_bf16 v[8:11], v[76:79], v[140:143], v[8:11]
  s_waitcnt lgkmcnt(5)
  v_mfma_f32_16x16x32_bf16 v[8:11], v[80:83], v[144:147], v[8:11]
  s_waitcnt lgkmcnt(4)
  v_mfma_f32_16x16x32_bf16 v[8:11], v[84:87], v[148:151], v[8:11]
  s_waitcnt lgkmcnt(3)
  v_mfma_f32_16x16x32_bf16 v[8:11], v[88:91], v[152:155], v[8:11]
  s_waitcnt lgkmcnt(2)
  v_mfma_f32_16x16x32_bf16 v[8:11], v[92:95], v[156:159], v[8:11]
  s_waitcnt lgkmcnt(1)
  v_mfma_f32_16x16x32_bf16 v[8:11], v[96:99], v[160:163], v[8:11]
  s_waitcnt lgkmcnt(0)
  v_mfma_f32_16x16x32_bf16 v[8:11], v[100:103], v[164:167], v[8:11]
  s_nop 5
  s_mov_b32 exec_lo, 0x00030003
  s_mov_b32 exec_hi, 0x00030003
  v_bfi_b32 v8, v36, s62, v8
  v_bfi_b32 v9, v36, s63, v9
  v_bfi_b32 v10, v36, s64, v10
  v_bfi_b32 v11, v36, s65, v11
  global_store_dwordx4 v13, v[8:11], s[42:43] sc1
  global_store_dwordx4 v37, v[8:11], s[42:43] sc1
  s_branch L_fin
L_t_f1:
  v_mov_b32 v2, v0
  s_add_u32 s51, s50, 8192
L_dma_103:
  s_mov_b32 m0, s50
  s_add_u32 s50, s50, 1024
  buffer_load_dwordx4 v2, s[44:47], s49 offen  lds
  s_add_u32 s49, s49, 88064
  s_cmp_lt_u32 s50, s51
  s_cbranch_scc1 L_dma_103
L_dmae_104:
  v_xor_b32 v2, 16, v2
  s_add_u32 s49, s49, s52
  s_add_u32 s50, s50, s53
  s_add_u32 s51, s50, 8192
L_dma_105:
  s_mov_b32 m0, s50
  s_add_u32 s50, s50, 1024
  buffer_load_dwordx4 v2, s[44:47], s49 offen  lds
  s_add_u32 s49, s49, 88064
  s_cmp_lt_u32 s50, s51
  s_cbranch_scc1 L_dma_105
L_dmae_106:
  v_mov_b32 v2, v6
  s_waitcnt vmcnt(0)
  s_barrier
  global_load_dwordx4 v[104:107], v15, s[42:43] sc1
  global_load_dwordx4 v[108:111], v35, s[42:43] sc1
  global_load_dwordx4 v[112:115], v32, s[42:43] sc1
  global_load_dwordx4 v[116:119], v36, s[42:43] sc1
  global_load_dwordx4 v[120:123], v33, s[42:43] sc1
  global_load_dwordx4 v[124:127], v37, s[42:43] sc1
  global_load_dwordx4 v[128:131], v34, s[42:43] sc1
  global_load_dwordx4 v[132:135], v39, s[42:43] sc1
  s_add_u32 s49, s5, 0
  s_and_b32 s49, s49, 3
  s_mul_i32 s49, s49, 4096
  v_add_u32 v3, s49, v2
  ds_read_b64_tr_b16 v[40:41], v3 offset:0
  ds_read_b64_tr_b16 v[42:43], v3 offset:512
  ds_read_b64_tr_b16 v[44:45], v3 offset:1024
  ds_read_b64_tr_b16 v[46:47], v3 offset:1536
  ds_read_b64_tr_b16 v[48:49], v3 offset:2048
  ds_read_b64_tr_b16 v[50:51], v3 offset:2560
  ds_read_b64_tr_b16 v[52:53], v3 offset:3072
  ds_read_b64_tr_b16 v[54:55], v3 offset:3584
  s_add_u32 s49, s5, 1
  s_and_b32 s49, s49, 3
  s_mul_i32 s49, s49, 4096
  v_add_u32 v3, s49, v2
  ds_read_b64_tr_b16 v[56:57], v3 offset:0
  ds_read_b64_tr_b16 v[58:59], v3 offset:512
  ds_read_b64_tr_b16 v[60:61], v3 offset:1024
  ds_read_b64_tr_b16 v[62:63], v3 offset:1536
  s_waitcnt lgkmcnt(10)
  ds_read_b64_tr_b16 v[64:65], v3 offset:2048
  ds_read_b64_tr_b16 v[66:67], v3 offset:2560
  s_waitcnt lgkmcnt(10)
  ds_read_b64_tr_b16 v[68:69], v3 offset:3072
  ds_read_b64_tr_b16 v[70:71], v3 offset:3584
  s_waitcnt lgkmcnt(10)
  s_add_u32 s49, s5, 2
  s_and_b32 s49, s49, 3
  s_mul_i32 s49, s49, 4096
  v_add_u32 v3, s49, v2
  ds_read_b64_tr_b16 v[72:73], v3 offset:0
  ds_read_b64_tr_b16 v[74:75], v3 offset:512
  s_waitcnt lgkmcnt(10)
  ds_read_b64_tr_b16 v[76:77], v3 offset:1024
  ds_read_b64_tr_b16 v[78:79], v3 offset:1536
  s_waitcnt lgkmcnt(10)
  ds_read_b64_tr_b16 v[80:81], v3 offset:2048
  ds_read_b64_tr_b16 v[82:83], v3 offset:2560
  s_waitcnt lgkmcnt(10)
  ds_read_b64_tr_b16 v[84:85], v3 offset:3072
  ds_read_b64_tr_b16 v[86:87], v3 offset:3584
  s_waitcnt lgkmcnt(10)
  s_add_u32 s49, s5, 3
  s_and_b32 s49, s49, 3
  s_mul_i32 s49, s49, 4096
  v_add_u32 v3, s49, v2
  ds_read_b64_tr_b16 v[88:89], v3 offset:0
  ds_read_b64_tr_b16 v[90:91], v3 offset:512
  s_waitcnt lgkmcnt(10)
  ds_read_b64_tr_b16 v[92:93], v3 offset:1024
  ds_read_b64_tr_b16 v[94:95], v3 offset:1536
  s_waitcnt lgkmcnt(10)
  ds_read_b64_tr_b16 v[96:97], v3 offset:2048
  ds_read_b64_tr_b16 v[98:99], v3 offset:2560
  s_waitcnt lgkmcnt(10)
  ds_read_b64_tr_b16 v[100:101], v3 offset:3072
  ds_read_b64_tr_b16 v[102:103], v3 offset:3584
  s_waitcnt lgkmcnt(10)
  s_waitcnt lgkmcnt(0)
  s_add_u32 s49, s5, 1
  s_and_b32 s49, s49, 3
  s_lshl_b32 s49, s49, 8
  v_add_u32 v0, s49, v14
  s_add_u32 s49, s5, 2
  s_and_b32 s49, s49, 3
  s_lshl_b32 s49, s49, 8
  v_add_u32 v2, s49, v14
  s_add_u32 s49, s5, 3
  s_and_b32 s49, s49, 3
  s_lshl_b32 s49, s49, 8
  v_add_u32 v3, s49, v14
  s_add_u32 s49, s5, 0
  s_and_b32 s49, s49, 3
  s_lshl_b32 s49, s49, 8
  v_add_u32 v14, s49, v14
  s_mov_b32 s70, 0
  s_mov_b32 s71, 15
  s_branch L_f1_c
L_f1_p:
  s_add_u32 s70, s70, 1
  s_cmp_ge_u32 s70, 262144
  s_cbranch_scc1 L_f1_ok
  s_bitcmp1_b32 s71, 0
  s_cbranch_scc0 L_fl_107
  global_load_dwordx4 v[104:107], v15, s[42:43] sc1
  global_load_dwordx4 v[108:111], v35, s[42:43] sc1
L_fl_107:
  s_bitcmp1_b32 s71, 1
  s_cbranch_scc0 L_fl_108
  global_load_dwordx4 v[112:115], v32, s[42:43] sc1
  global_load_dwordx4 v[116:119], v36, s[42:43] sc1
L_fl_108:
  s_bitcmp1_b32 s71, 2
  s_cbranch_scc0 L_fl_109
  global_load_dwordx4 v[120:123], v33, s[42:43] sc1
  global_load_dwordx4 v[124:127], v37, s[42:43] sc1
L_fl_109:
  s_bitcmp1_b32 s71, 3
  s_cbranch_scc0 L_fl_110
  global_load_dwordx4 v[128:131], v34, s[42:43] sc1
  global_load_dwordx4 v[132:135], v39, s[42:43] sc1
L_fl_110:
L_f1_c:
  s_waitcnt vmcnt(0)
  s_bitcmp1_b32 s71, 0
  s_cbranch_scc0 L_fc_111
  v_xor_b32 v104, s62, v104
  v_xor_b32 v105, s63, v105
  v_xor_b32 v106, s64, v106
  v_xor_b32 v107, s65, v107
  v_xor_b32 v108, s62, v108
  v_xor_b32 v109, s63, v109
  v_xor_b32 v110, s64, v110
  v_xor_b32 v111, s65, v111
  v_or3_b32 v8, v104, v105, v106
  v_or3_b32 v9, v107, v108, v109
  v_or3_b32 v8, v8, v110, v111
  v_pk_add_f32 v[136:137], v[104:105], v[108:109]
  v_pk_add_f32 v[138:139], v[106:107], v[110:111]
  v_or_b32 v8, v8, v9
  v_lshlrev_b32 v8, 24, v8
  v_cmp_ne_u32 vcc, 0, v8
  s_cmp_lg_u64 vcc, 0
  s_cbranch_scc1 L_fc_111
  s_bitset0_b32 s71, 0
L_fc_111:
  s_bitcmp1_b32 s71, 1
  s_cbranch_scc0 L_fc_112
  v_xor_b32 v112, s62, v112
  v_xor_b32 v113, s63, v113
  v_xor_b32 v114, s64, v114
  v_xor_b32 v115, s65, v115
  v_xor_b32 v116, s62, v116
  v_xor_b32 v117, s63, v117
  v_xor_b32 v118, s64, v118
  v_xor_b32 v119, s65, v119
  v_or3_b32 v8, v112, v113, v114
  v_or3_b32 v9, v115, v116, v117
  v_or3_b32 v8, v8, v118, v119
  v_pk_add_f32 v[144:145], v[112:113], v[116:117]
  v_pk_add_f32 v[146:147], v[114:115], v[118:119]
  v_or_b32 v8, v8, v9
  v_lshlrev_b32 v8, 24, v8
  v_cmp_ne_u32 vcc, 0, v8
  s_cmp_lg_u64 vcc, 0
  s_cbranch_scc1 L_fc_112
  s_bitset0_b32 s71, 1
L_fc_112:
  s_bitcmp1_b32 s71, 2
  s_cbranch_scc0 L_fc_113
  v_xor_b32 v120, s62, v120
  v_xor_b32 v121, s63, v121
  v_xor_b32 v122, s64, v122
  v_xor_b32 v123, s65, v123
  v_xor_b32 v124, s62, v124
  v_xor_b32 v125, s63, v125
  v_xor_b32 v126, s64, v126
  v_xor_b32 v127, s65, v127
  v_or3_b32 v8, v120, v121, v122
  v_or3_b32 v9, v123, v124, v125
  v_or3_b32 v8, v8, v126, v127
  v_pk_add_f32 v[152:153], v[120:121], v[124:125]
  v_pk_add_f32 v[154:155], v[122:123], v[126:127]
  v_or_b32 v8, v8, v9
  v_lshlrev_b32 v8, 24, v8
  v_cmp_ne_u32 vcc, 0, v8
  s_cmp_lg_u64 vcc, 0
  s_cbranch_scc1 L_fc_113
  s_bitset0_b32 s71, 2
L_fc_113:
  s_bitcmp1_b32 s71, 3
  s_cbranch_scc0 L_fc_114
  v_xor_b32 v128, s62, v128
  v_xor_b32 v129, s63, v129
  v_xor_b32 v130, s64, v130
  v_xor_b32 v131, s65, v131
  v_xor_b32 v132, s62, v132
  v_xor_b32 v133, s63, v133
  v_xor_b32 v134, s64, v134
  v_xor_b32 v135, s65, v135
  v_or3_b32 v8, v128, v129, v130
  v_or3_b32 v9, v131, v132, v133
  v_or3_b32 v8, v8, v134, v135
  v_pk_add_f32 v[160:161], v[128:129], v[132:133]
  v_pk_add_f32 v[162:163], v[130:131], v[134:135]
  v_or_b32 v8, v8, v9
  v_lshlrev_b32 v8, 24, v8
  v_cmp_ne_u32 vcc, 0, v8
  s_cmp_lg_u64 vcc, 0
  s_cbranch_scc1 L_fc_114
  s_bitset0_b32 s71, 3
L_fc_114:
  s_cmp_lg_u32 s71, 0
  s_cbranch_scc1 L_f1_p
L_f1_ok:
  v_pk_add_f32 v[136:137], v[136:137], v[144:145]
  v_pk_add_f32 v[138:139], v[138:139], v[146:147]
  v_pk_add_f32 v[152:153], v[152:153], v[160:161]
  v_pk_add_f32 v[154:155], v[154:155], v[162:163]
  v_pk_add_f32 v[136:137], v[136:137], v[152:153]
  v_pk_add_f32 v[138:139], v[138:139], v[154:155]
  v_pk_fma_f32 v[8:9], v[136:137], v[24:25], v[28:29]
  v_pk_fma_f32 v[10:11], v[138:139], v[26:27], v[30:31]
  v_cvt_pk_bf16_f32 v8, v8, v9
  v_cvt_pk_bf16_f32 v9, v10, v11
  ds_write_b64 v12, v[8:9] offset:0
  ds_read_b128 v[104:107], v14 offset:0
  ds_read_b128 v[108:111], v14 offset:64
  ds_read_b128 v[112:115], v14 offset:128
  ds_read_b128 v[116:119], v14 offset:192
  v_pk_fma_f32 v[16:17], v[136:137], v[20:21], v[16:17]
  v_pk_fma_f32 v[18:19], v[138:139], v[22:23], v[18:19]
  v_pk_mul_f32 v[10:11], v[16:17], v[16:17]
  v_pk_add_f32 v[20:21], v[16:17], v[18:19]
  v_pk_fma_f32 v[10:11], v[18:19], v[18:19], v[10:11]
  v_add_f32 v20, v20, v21
  v_add_f32 v21, v10, v11
  ds_write_b64 v5, v[20:21] offset:12032
  s_waitcnt lgkmcnt(0)
  s_barrier
  ds_read_b128 v[120:123], v0 offset:0
  ds_read_b128 v[124:127], v0 offset:64
  ds_read_b128 v[128:131], v0 offset:128
  ds_read_b128 v[132:135], v0 offset:192
  ds_read_b128 v[20:23], v7 offset:12032
  ds_read_b128 v[24:27], v7 offset:12048
  v_mfma_f32_16x16x32_bf16 v[32:35], v[40:43], v[104:107], 0
  ds_read_b128 v[136:139], v2 offset:0
  ds_read_b128 v[140:143], v2 offset:64
  v_mfma_f32_16x16x32_bf16 v[32:35], v[44:47], v[108:111], v[32:35]
  ds_read_b128 v[144:147], v2 offset:128
  ds_read_b128 v[148:151], v2 offset:192
  v_mfma_f32_16x16x32_bf16 v[32:35], v[48:51], v[112:115], v[32:35]
  ds_read_b128 v[152:155], v3 offset:0
  ds_read_b128 v[156:159], v3 offset:64
  v_mfma_f32_16x16x32_bf16 v[32:35], v[52:55], v[116:119], v[32:35]
  ds_read_b128 v[160:163], v3 offset:128
  ds_read_b128 v[164:167], v3 offset:192
  s_waitcnt lgkmcnt(13)
  v_mfma_f32_16x16x32_bf16 v[32:35], v[56:59], v[120:123], v[32:35]
  s_waitcnt lgkmcnt(12)
  v_mfma_f32_16x16x32_bf16 v[32:35], v[60:63], v[124:127], v[32:35]
  s_waitcnt lgkmcnt(8)
  v_pk_add_f32 v[20:21], v[20:21], v[22:23]
  v_pk_add_f32 v[24:25], v[24:25], v[26:27]
  v_mfma_f32_16x16x32_bf16 v[32:35], v[64:67], v[128:131], v[32:35]
  v_pk_add_f32 v[20:21], v[20:21], v[24:25]
  s_nop 0
  v_mfma_f32_16x16x32_bf16 v[32:35], v[68:71], v[132:135], v[32:35]
  v_add_f32_dpp v20, v20, v20 quad_perm:[2,3,0,1] row_mask:0xf bank_mask:0xf
  v_add_f32_dpp v21, v21, v21 quad_perm:[2,3,0,1] row_mask:0xf bank_mask:0xf
  s_waitcnt lgkmcnt(7)
  v_mfma_f32_16x16x32_bf16 v[32:35], v[72:75], v[136:139], v[32:35]
  v_add_f32_dpp v20, v20, v20 row_ror:4 row_mask:0xf bank_mask:0xf
  v_add_f32_dpp v21, v21, v21 row_ror:4 row_mask:0xf bank_mask:0xf
  s_waitcnt lgkmcnt(6)
  v_mfma_f32_16x16x32_bf16 v[32:35], v[76:79], v[140:143], v[32:35]
  v_add_f32_dpp v20, v20, v20 row_ror:8 row_mask:0xf bank_mask:0xf
  v_add_f32_dpp v21, v21, v21 row_ror:8 row_mask:0xf bank_mask:0xf
  s_waitcnt lgkmcnt(5)
  v_mfma_f32_16x16x32_bf16 v[32:35], v[80:83], v[144:147], v[32:35]
  v_mov_b32 v22, v20
  v_mov_b32 v23, v21
  s_waitcnt lgkmcnt(4)
  v_mfma_f32_16x16x32_bf16 v[32:35], v[84:87], v[148:151], v[32:35]
  v_permlane16_swap_b32 v22, v20
  v_permlane16_swap_b32 v23, v21
  s_waitcnt lgkmcnt(3)
  v_mfma_f32_16x16x32_bf16 v[32:35], v[88:91], v[152:155], v[32:35]
  v_add_f32 v20, v20, v22
  v_add_f32 v21, v21, v23
  v_mov_b32 v22, v20
  v_mov_b32 v23, v21
  s_waitcnt lgkmcnt(2)
  v_mfma_f32_16x16x32_bf16 v[32:35], v[92:95], v[156:159], v[32:35]
  v_permlane32_swap_b32 v22, v20
  v_permlane32_swap_b32 v23, v21
  s_waitcnt lgkmcnt(1)
  v_mfma_f32_16x16x32_bf16 v[32:35], v[96:99], v[160:163], v[32:35]
  v_add_f32 v20, v20, v22
  v_add_f32 v21, v21, v23
  s_waitcnt lgkmcnt(0)
  v_mfma_f32_16x16x32_bf16 v[32:35], v[100:103], v[164:167], v[32:35]
  v_mul_f32 v20, 0xbb000000, v20
  v_mul_f32 v21, 0x3b000000, v21
  v_fma_f32 v21, -v20, v20, v21
  v_max_f32 v21, 0, v21
  v_add_f32 v21, 0x3727c5ac, v21
  v_rsq_f32 v21, v21
  s_nop 1
  v_fmac_f32_dpp v32, v32, v20 row_shl:2 row_mask:0xf bank_mask:0x1
  v_fmac_f32_dpp v33, v33, v20 row_shl:2 row_mask:0xf bank_mask:0x1
  v_fmac_f32_dpp v34, v34, v20 row_shl:2 row_mask:0xf bank_mask:0x1
  v_fmac_f32_dpp v35, v35, v20 row_shl:2 row_mask:0xf bank_mask:0x1
  v_mul_f32 v8, v32, v21
  v_mul_f32 v9, v33, v21
  v_mul_f32 v10, v34, v21
  v_mul_f32 v11, v35, v21
  v_add_f32_dpp v8, v32, v8 row_shl:4 row_mask:0xf bank_mask:0xf
  v_add_f32_dpp v9, v33, v9 row_shl:4 row_mask:0xf bank_mask:0xf
  v_add_f32_dpp v10, v34, v10 row_shl:4 row_mask:0xf bank_mask:0xf
  v_add_f32_dpp v11, v35, v11 row_shl:4 row_mask:0xf bank_mask:0xf
  s_mov_b32 s50, 0x000f000f
  s_mov_b32 s51, 0x000f000f
  v_permlane32_swap_b32 v8, v10
  v_permlane32_swap_b32 v9, v11
  v_mul_f32 v20, 0xbfb8aa3b, v8
  v_mul_f32 v21, 0xbfb8aa3b, v9
  v_exp_f32 v20, v20
  v_exp_f32 v21, v21
  v_mul_f32 v8, v8, v10
  v_mul_f32 v9, v9, v11
  v_add_f32 v20, 1.0, v20
  v_add_f32 v21, 1.0, v21
  v_rcp_f32 v20, v20
  v_rcp_f32 v21, v21
  s_mov_b64 exec, s[50:51]
  v_mul_f32 v8, v8, v20
  v_mul_f32 v9, v9, v21
  v_cvt_pk_bf16_f32 v8, v8, v9
  v_mov_b32 v9, s74
  global_store_dwordx2 v13, v[8:9], s[42:43] sc1
  global_store_dwordx2 v4, v[8:9], s[42:43] sc1
  s_branch L_fin
L_t_f2:
  v_mov_b32 v2, v29
  s_and_b32 s59, s61, 3
  s_mul_i32 s59, s59, 3072
  s_mul_i32 s49, s5, 360448
  s_add_u32 s49, s49, s48
  s_mul_i32 s50, s5, 11264
  s_add_u32 s50, s50, 20480
  s_lshl_b32 s52, s59, 5
  s_add_u32 s49, s49, s52
  s_add_u32 s50, s50, s59
  s_sub_u32 s52, 11264, s59
  s_add_u32 s51, s50, s52
  s_cmp_lt_u32 s50, s51
  s_cbranch_scc0 L_dmae_116
L_dma_115:
  s_mov_b32 m0, s50
  s_add_u32 s50, s50, 1024
  buffer_load_dwordx4 v2, s[44:47], s49 offen  lds
  s_add_u32 s49, s49, 32768
  s_cmp_lt_u32 s50, s51
  s_cbranch_scc1 L_dma_115
L_dmae_116:
  s_mul_i32 s49, s5, 360448
  s_add_u32 s49, s49, s48
  s_mul_i32 s50, s5, 11264
  s_add_u32 s50, s50, 20480
  s_add_u32 s51, s50, s59
  s_cmp_lt_u32 s50, s51
  s_cbranch_scc0 L_dmae_118
L_dma_117:
  s_mov_b32 m0, s50
  s_add_u32 s50, s50, 1024
  buffer_load_dwordx4 v2, s[44:47], s49 offen  lds
  s_add_u32 s49, s49, 32768
  s_cmp_lt_u32 s50, s51
  s_cbranch_scc1 L_dma_117
L_dmae_118:
  v_mov_b32 v2, v6
  s_mov_b32 s50, 0x00030003
  s_mov_b32 s51, 0x00030003
  s_mov_b32 s53, 0x0fff0fff
  s_cmp_eq_u32 s5, 3
  s_cselect_b32 s52, 0x00ff00ff, s53
  s_mov_b32 s53, s52
  s_cmp_lg_u32 s5, 0
  s_cbranch_scc1 L_f2_w
  s_mov_b64 exec, s[50:51]
  global_load_dwordx4 v[104:107], v15, s[42:43] sc1
  global_load_dwordx4 v[108:111], v35, s[42:43] sc1
  global_load_dwordx4 v[112:115], v32, s[42:43] sc1
  global_load_dwordx4 v[116:119], v36, s[42:43] sc1
  global_load_dwordx4 v[120:123], v33, s[42:43] sc1
  global_load_dwordx4 v[124:127], v37, s[42:43] sc1
  global_load_dwordx4 v[128:131], v34, s[42:43] sc1
  global_load_dwordx4 v[132:135], v39, s[42:43] sc1
  s_mov_b64 exec, -1
  s_waitcnt vmcnt(8)
  s_branch L_f2_w2
L_f2_w:
  s_waitcnt vmcnt(0)
L_f2_w2:
  ds_read_b64_tr_b16 v[40:41], v2 offset:0
  ds_read_b64_tr_b16 v[42:43], v2 offset:128
  ds_read_b64_tr_b16 v[44:45], v2 offset:1024
  ds_read_b64_tr_b16 v[46:47], v2 offset:1152
  ds_read_b64_tr_b16 v[48:49], v2 offset:2048
  ds_read_b64_tr_b16 v[50:51], v2 offset:2176
  ds_read_b64_tr_b16 v[52:53], v2 offset:3072
  ds_read_b64_tr_b16 v[54:55], v2 offset:3200
  ds_read_b64_tr_b16 v[56:57], v2 offset:4096
  ds_read_b64_tr_b16 v[58:59], v2 offset:4224
  ds_read_b64_tr_b16 v[60:61], v2 offset:5120
  ds_read_b64_tr_b16 v[62:63], v2 offset:5248
  s_waitcnt lgkmcnt(10)
  ds_read_b64_tr_b16 v[64:65], v2 offset:6144
  ds_read_b64_tr_b16 v[66:67], v2 offset:6272
  s_waitcnt lgkmcnt(10)
  ds_read_b64_tr_b16 v[68:69], v2 offset:7168
  ds_read_b64_tr_b16 v[70:71], v2 offset:7296
  s_waitcnt lgkmcnt(10)
  ds_read_b64_tr_b16 v[72:73], v2 offset:8192
  ds_read_b64_tr_b16 v[74:75], v2 offset:8320
  s_waitcnt lgkmcnt(10)
  ds_read_b64_tr_b16 v[76:77], v2 offset:9216
  ds_read_b64_tr_b16 v[78:79], v2 offset:9344
  s_waitcnt lgkmcnt(10)
  ds_read_b64_tr_b16 v[80:81], v2 offset:10240
  ds_read_b64_tr_b16 v[82:83], v2 offset:10368
  s_waitcnt lgkmcnt(10)
  s_waitcnt lgkmcnt(0)
  s_cmp_lg_u32 s5, 0
  s_cbranch_scc1 L_f2x_119
  s_mov_b32 s70, 0
  s_mov_b64 exec, s[50:51]
  s_branch L_f2_ac
L_f2_a:
  s_mov_b64 exec, s[50:51]
  global_load_dwordx4 v[104:107], v15, s[42:43] sc1
  global_load_dwordx4 v[108:111], v35, s[42:43] sc1
  global_load_dwordx4 v[112:115], v32, s[42:43] sc1
  global_load_dwordx4 v[116:119], v36, s[42:43] sc1
  global_load_dwordx4 v[120:123], v33, s[42:43] sc1
  global_load_dwordx4 v[124:127], v37, s[42:43] sc1
  global_load_dwordx4 v[128:131], v34, s[42:43] sc1
  global_load_dwordx4 v[132:135], v39, s[42:43] sc1
L_f2_ac:
  s_waitcnt vmcnt(0)
  v_xor_b32 v136, s62, v104
  v_xor_b32 v137, s63, v105
  v_xor_b32 v138, s64, v106
  v_xor_b32 v139, s65, v107
  v_xor_b32 v140, s62, v108
  v_xor_b32 v141, s63, v109
  v_xor_b32 v142, s64, v110
  v_xor_b32 v143, s65, v111
  v_xor_b32 v144, s62, v112
  v_xor_b32 v145, s63, v113
  v_xor_b32 v146, s64, v114
  v_xor_b32 v147, s65, v115
  v_xor_b32 v148, s62, v116
  v_xor_b32 v149, s63, v117
  v_xor_b32 v150, s64, v118
  v_xor_b32 v151, s65, v119
  v_xor_b32 v152, s62, v120
  v_xor_b32 v153, s63, v121
  v_xor_b32 v154, s64, v122
  v_xor_b32 v155, s65, v123
  v_xor_b32 v156, s62, v124
  v_xor_b32 v157, s63, v125
  v_xor_b32 v158, s64, v126
  v_xor_b32 v159, s65, v127
  v_xor_b32 v160, s62, v128
  v_xor_b32 v161, s63, v129
  v_xor_b32 v162, s64, v130
  v_xor_b32 v163, s65, v131
  v_xor_b32 v164, s62, v132
  v_xor_b32 v165, s63, v133
  v_xor_b32 v166, s64, v134
  v_xor_b32 v167, s65, v135
  v_or3_b32 v8, v136, v137, v138
  v_or3_b32 v9, v144, v145, v146
  v_or3_b32 v10, v152, v153, v154
  v_or3_b32 v11, v160, v161, v162
  v_or3_b32 v8, v8, v139, v140
  v_or3_b32 v9, v9, v147, v148
  v_or3_b32 v10, v10, v155, v156
  v_or3_b32 v11, v11, v163, v164
  v_or3_b32 v8, v8, v141, v142
  v_or3_b32 v9, v9, v149, v150
  v_or3_b32 v10, v10, v157, v158
  v_or3_b32 v11, v11, v165, v166
  v_or_b32 v8, v8, v143
  v_or_b32 v9, v9, v151
  v_or_b32 v10, v10, v159
  v_or_b32 v11, v11, v167
  v_or3_b32 v3, v8, v9, v10
  v_or_b32 v3, v3, v11
  v_lshlrev_b32 v3, 24, v3
  v_cmp_ne_u32 vcc, 0, v3
  s_cmp_eq_u64 vcc, 0
  s_cbranch_scc1 L_f2_ad
  s_sleep 2
  s_add_u32 s70, s70, 1
  s_cmp_lt_u32 s70, 262144
  s_cbranch_scc1 L_f2_a
L_f2_ad:
  s_mov_b64 exec, -1
  v_pk_add_f32 v[136:137], v[136:137], v[140:141]
  v_pk_add_f32 v[138:139], v[138:139], v[142:143]
  v_pk_add_f32 v[144:145], v[144:145], v[148:149]
  v_pk_add_f32 v[146:147], v[146:147], v[150:151]
  v_pk_add_f32 v[152:153], v[152:153], v[156:157]
  v_pk_add_f32 v[154:155], v[154:155], v[158:159]
  v_pk_add_f32 v[160:161], v[160:161], v[164:165]
  v_pk_add_f32 v[162:163], v[162:163], v[166:167]
  v_pk_add_f32 v[136:137], v[136:137], v[144:145]
  v_pk_add_f32 v[138:139], v[138:139], v[146:147]
  v_pk_add_f32 v[152:153], v[152:153], v[160:161]
  v_pk_add_f32 v[154:155], v[154:155], v[162:163]
  v_pk_add_f32 v[136:137], v[136:137], v[152:153]
  v_pk_add_f32 v[138:139], v[138:139], v[154:155]
  v_cvt_pk_bf16_f32 v136, 0, v136
  v_cvt_pk_bf16_f32 v137, 0, v137
  v_cvt_pk_bf16_f32 v138, 0, v138
  v_cvt_pk_bf16_f32 v139, 0, v139
  v_mul_f32 v136, v136, v20
  v_mul_f32 v137, v137, v21
  v_mul_f32 v138, v138, v22
  v_mul_f32 v139, v139, v23
  v_cvt_pk_bf16_f32 v136, 0, v136
  v_cvt_pk_bf16_f32 v137, 0, v137
  v_cvt_pk_bf16_f32 v138, 0, v138
  v_cvt_pk_bf16_f32 v139, 0, v139
  v_add_f32 v16, v16, v136
  v_add_f32 v17, v17, v137
  v_add_f32 v18, v18, v138
  v_add_f32 v19, v19, v139
  v_cvt_pk_bf16_f32 v16, 0, v16
  v_cvt_pk_bf16_f32 v17, 0, v17
  v_cvt_pk_bf16_f32 v18, 0, v18
  v_cvt_pk_bf16_f32 v19, 0, v19
L_f2x_119:
  v_mov_b32 v112, 0
  v_mov_b32 v113, 0
  v_mov_b32 v114, 0
  v_mov_b32 v115, 0
  s_mov_b32 s70, 0
L_f2_p:
  global_load_dwordx4 v[104:107], v28, s[42:43] offset:-2048 sc1
  global_load_dwordx4 v[108:111], v28, s[42:43] sc1
  s_mov_b64 exec, s[52:53]
  global_load_dwordx4 v[112:115], v28, s[42:43] offset:2048 sc1
  s_mov_b64 exec, -1
  s_waitcnt vmcnt(2)
  v_xor_b32 v105, s74, v105
  v_xor_b32 v107, s74, v107
  s_waitcnt vmcnt(1)
  v_xor_b32 v109, s74, v109
  v_xor_b32 v111, s74, v111
  s_waitcnt vmcnt(0)
  v_xor_b32 v113, s74, v113
  v_xor_b32 v115, s74, v115
  v_or3_b32 v31, v105, v107, v109
  v_or_b32 v3, v113, v115
  v_or_b32 v31, v111, v31
  v_cmp_ne_u32 s[68:69], 0, v3
  v_cmp_ne_u32 vcc, 0, v31
  v_mov_b32_dpp v105, v104 quad_perm:[2,3,2,3] row_mask:0xf bank_mask:0xf
  v_mov_b32_dpp v107, v106 quad_perm:[2,3,2,3] row_mask:0xf bank_mask:0xf
  v_mov_b32_dpp v109, v108 quad_perm:[2,3,2,3] row_mask:0xf bank_mask:0xf
  v_mov_b32_dpp v111, v110 quad_perm:[2,3,2,3] row_mask:0xf bank_mask:0xf
  v_mov_b32_dpp v113, v112 quad_perm:[2,3,2,3] row_mask:0xf bank_mask:0xf
  v_mov_b32_dpp v115, v114 quad_perm:[2,3,2,3] row_mask:0xf bank_mask:0xf
  s_and_b64 s[68:69], s[68:69], s[52:53]
  s_or_b64 vcc, vcc, s[68:69]
  v_mfma_f32_16x16x32_bf16 v[120:123], v[40:43], v[104:107], 0
  v_mfma_f32_16x16x32_bf16 v[124:127], v[44:47], v[104:107], 0
  v_mfma_f32_16x16x32_bf16 v[128:131], v[48:51], v[104:107], 0
  v_mfma_f32_16x16x32_bf16 v[132:135], v[52:55], v[104:107], 0
  s_cmp_eq_u64 vcc, 0
  s_cbranch_scc1 L_f2_ok
  s_add_u32 s70, s70, 1
  s_cmp_lt_u32 s70, 262144
  s_cbranch_scc1 L_f2_p
L_f2_ok:
  v_mfma_f32_16x16x32_bf16 v[120:123], v[56:59], v[108:111], v[120:123]
  v_mfma_f32_16x16x32_bf16 v[124:127], v[60:63], v[108:111], v[124:127]
  v_mfma_f32_16x16x32_bf16 v[128:131], v[64:67], v[108:111], v[128:131]
  v_mfma_f32_16x16x32_bf16 v[132:135], v[68:71], v[108:111], v[132:135]
  v_mfma_f32_16x16x32_bf16 v[120:123], v[72:75], v[112:115], v[120:123]
  v_mfma_f32_16x16x32_bf16 v[124:127], v[76:79], v[112:115], v[124:127]
  v_mfma_f32_16x16x32_bf16 v[128:131], v[80:83], v[112:115], v[128:131]
  s_nop 6
  v_add_f32_dpp v8, v124, v120 row_shl:4 row_mask:0xf bank_mask:0xf
  v_add_f32_dpp v9, v125, v121 row_shl:4 row_mask:0xf bank_mask:0xf
  v_add_f32_dpp v10, v126, v122 row_shl:4 row_mask:0xf bank_mask:0xf
  v_add_f32_dpp v11, v127, v123 row_shl:4 row_mask:0xf bank_mask:0xf
  v_add_f32_dpp v128, v132, v128 row_shl:4 row_mask:0xf bank_mask:0xf
  v_add_f32_dpp v129, v133, v129 row_shl:4 row_mask:0xf bank_mask:0xf
  v_add_f32_dpp v130, v134, v130 row_shl:4 row_mask:0xf bank_mask:0xf
  v_add_f32_dpp v131, v135, v131 row_shl:4 row_mask:0xf bank_mask:0xf
  v_add_f32_dpp v8, v128, v8 row_shl:8 row_mask:0xf bank_mask:0xf
  v_add_f32_dpp v9, v129, v9 row_shl:8 row_mask:0xf bank_mask:0xf
  v_add_f32_dpp v10, v130, v10 row_shl:8 row_mask:0xf bank_mask:0xf
  v_add_f32_dpp v11, v131, v11 row_shl:8 row_mask:0xf bank_mask:0xf
  s_mov_b64 exec, s[50:51]
  ds_write_b128 v30, v[8:11]
  s_waitcnt lgkmcnt(0)
  s_barrier
  s_cmp_lg_u32 s5, s77
  s_cbranch_scc1 L_fin
  ds_read_b128 v[104:107], v12 offset:128
  ds_read_b128 v[108:111], v12 offset:256
  ds_read_b128 v[112:115], v12 offset:384
  s_waitcnt lgkmcnt(2)
  v_pk_add_f32 v[8:9], v[8:9], v[104:105]
  v_pk_add_f32 v[10:11], v[10:11], v[106:107]
  s_waitcnt lgkmcnt(0)
  v_pk_add_f32 v[108:109], v[108:109], v[112:113]
  v_pk_add_f32 v[110:111], v[110:111], v[114:115]
  v_pk_add_f32 v[8:9], v[8:9], v[108:109]
  v_pk_add_f32 v[10:11], v[10:11], v[110:111]
  v_pk_fma_f32 v[8:9], v[8:9], v[24:25], v[16:17]
  v_pk_fma_f32 v[10:11], v[10:11], v[26:27], v[18:19]
  v_cvt_pk_bf16_f32 v8, v8, v9
  v_cvt_pk_bf16_f32 v9, v10, v11
  global_store_dwordx2 v13, v[8:9], s[38:39]
  s_mov_b64 exec, 1
  s_cmp_lg_u32 s61, 0
  s_cbranch_scc1 L_noep
  v_mov_b32 v10, s74
  global_store_dword v38, v10, s[42:43] offset:0
L_noep:
L_fin:
L_end:
  s_endpgm
.p2align 7
L_table:
  .long 0x038030ae, 0x038030fe, 0x03803706, 0x03803356, 0x03803886, 0x038030d6, 0x0380372e, 0x038030ee
  .long 0x07803e4d, 0x07803c09, 0x078037e6, 0x078014de, 0x07803e09, 0x07803c09, 0x0780403d, 0x07803e45
  .long 0x0b803666, 0x07803e55, 0x0b80314e, 0x0b803e11, 0x07803116, 0x07803c11, 0x0b803e11, 0x0b803e11
  .long 0x0f803786, 0x0b803626, 0x0f8036be, 0x0b80347e, 0x0b8037ae, 0x07803c35, 0x0b80119e, 0x0b8011de
  .long 0x1380373e, 0x0f80318e, 0x13803e21, 0x0f8033a6, 0x0f803e75, 0x0b803e7d, 0x0f803776, 0x0f80360e
  .long 0x17803816, 0x1380185d, 0x1380382e, 0x13803e6d, 0x13803766, 0x0f80155e, 0x138030e6, 0x13803056
  .long 0x1b803e31, 0x1780145e, 0x17803e15, 0x1780330e, 0x178036ce, 0x13803046, 0x17803696, 0x17803936
  .long 0x1b80181d, 0x1b80366e, 0x1b803676, 0x1b803c25, 0x1b80363e, 0x1780316e, 0x1b803006, 0x1b80377e
  .long 0x1f982ef6, 0x1f982eb6, 0x1f9b4001, 0x1f993436, 0x1f9c171e, 0x1b982ffe, 0x1f9b3e01, 0x1f982fc6
  .long 0x239f3e05, 0x239e3ca4, 0x1f9b3e09, 0x238a4009, 0x239f3f04, 0x1f9e3d0c, 0x1fa04009, 0x239f3e09
  .long 0x279b3e11, 0x279f3e0d, 0x1f982f96, 0x239f3f74, 0x27982ff6, 0x239e3d7c, 0x1f9f3f64, 0x239f3f6c
  .long 0x279b1c19, 0x2b9b39d6, 0x239b1c19, 0x279a1a19, 0x2b9b1c19, 0x279e348e, 0x23881619, 0x27881619
  .long 0x279b3e21, 0x2f982f46, 0x239f3eac, 0x279935ee, 0x2b9f3e2d, 0x2b9f3e21, 0x239b3e21, 0x279b3e21
  .long 0x279c161e, 0x338c3c29, 0x279c169e, 0x2b9f3e29, 0x2f9b4029, 0x2b8a3e29, 0x23982e4e, 0x27982ea6
  .long 0x2b9f3e94, 0x338a3e31, 0x2b9f3e65, 0x2b9934c6, 0x2f9b3e31, 0x2b982f26, 0x279b3c31, 0x2b9c4031
  .long 0x2f8c39ce, 0x339b3e39, 0x2f9b3e39, 0x2f9e3c39, 0x2f9b3e39, 0x2f982fb6, 0x27982fbe, 0x2b9b3c39
  .long 0x33af3801, 0x33af3801, 0x2fbb189c, 0x2fb33a01, 0x2fa74001, 0x33af3801, 0x2bba472a, 0x2baf3801
  .long 0x33be3e09, 0x33bc4442, 0x33ba465a, 0x2faa46aa, 0x2fbe3ebc, 0x33bc44e2, 0x2bc040cc, 0x2bbe3ed4
  .long 0x33ba4612, 0x33be3e11, 0x33af3811, 0x2fbe3efc, 0x33af3811, 0x33bc44ea, 0x2fbe3e84, 0x2fbe3e8c
  .long 0x33a93d2c, 0x33b71a19, 0x33a93cf4, 0x33a73cb4, 0x33a93d4c, 0x33b81a19, 0x33936ecb, 0x33936efb
  .long 0x37ba462a, 0x33af3821, 0x37be3f3c, 0x37b33a21, 0x37be3e21, 0x33be3ec4, 0x33ba470a, 0x33ba474a
  .long 0x37a74029, 0x33aa3d34, 0x3ba74029, 0x37be3f44, 0x37bb18dc, 0x37a93d54, 0x33af3829, 0x33af3829
  .long 0x37be3ee4, 0x37a93cec, 0x3bbe3e31, 0x3bb33a31, 0x3bba46ca, 0x3baf3831, 0x33b9191c, 0x33bc4124
  .long 0x3ba83e39, 0x3bba4632, 0x3bba466a, 0x3bbc4492, 0x3bba46da, 0x3baf3839, 0x37af3839, 0x37b9195c
  .long 0x3bcb6a03, 0x3bcb6a33, 0x3bc7724b, 0x3bd0607b, 0x3bc77283, 0x3bcb6aab, 0x37dd471a, 0x3bcb6aeb
  .long 0x3bdd4622, 0x3bde444a, 0x3bdd4672, 0x3bcd6663, 0x3bdd46b2, 0x3bde4502, 0x37e04114, 0x3bdd4742
  .long 0x3bdd4602, 0x3bdd463a, 0x3bcb6a5b, 0x3bdd469a, 0x3bcb6a93, 0x3bde44f2, 0x3bdd4712, 0x3bdd473a
  .long 0x3bc7720b, 0x3bc47800, 0x3bc77243, 0x3bc57600, 0x3bc7728b, 0x3bc57600, 0x3bca6cdb, 0x3bca6ce3
  .long 0x3bdd460a, 0x3fcb6a2b, 0x3bdd467a, 0x3fd06073, 0x3bdd46ba, 0x3fdd46fa, 0x3bdd4722, 0x3bdd4732
  .long 0x3bc77213, 0x3fc87023, 0x3bc77253, 0x3fdd468a, 0x3bc7729b, 0x3fc772b3, 0x3bcb6ad3, 0x3bcb6af3
  .long 0x3bdd461a, 0x3fc7723b, 0x3bdd4682, 0x3fd0606b, 0x3bdd46c2, 0x3fcb6aa3, 0x3bc57600, 0x3bdc4952
  .long 0x3bc7721b, 0x3fdd4652, 0x3bdd4662, 0x3fde44a2, 0x3bdd46d2, 0x3fcb6abb, 0x3fcb6ac3, 0x3bc57600
L_gtab:
  .long 0x017c0000, 0x00000000
  .long 0x02bc0180, 0x00000080
  .long 0x043c02c0, 0x00000100
  .long 0x057c0440, 0x00000180
  .long 0x06fc0580, 0x00000200
  .long 0x083c0700, 0x00000280
  .long 0x097c0840, 0x00000300
  .long 0x0abc0980, 0x00000380
.section .rodata,"a"
.p2align 6
.amdhsa_kernel adaLN_cond__sliding_block_cached__glu_gated_swiglu__decode_kernel
  .amdhsa_next_free_vgpr 168
  .amdhsa_next_free_sgpr 102
  .amdhsa_accum_offset 168
  .amdhsa_group_segment_fixed_size 0
  .amdhsa_kernarg_size 112
  .amdhsa_user_sgpr_count 2
  .amdhsa_user_sgpr_kernarg_segment_ptr 1
  .amdhsa_system_sgpr_workgroup_id_x 1
.end_amdhsa_kernel
```

```asm
; @launch grid=(256,1,1) block=(768,1,1) lds=151552
.amdgcn_target "amdgcn-amd-amdhsa--gfx950"
.text
.globl adaLN_cond__sliding_block_cached__glu_gated_swiglu__decode_kernel
.p2align 8
.type adaLN_cond__sliding_block_cached__glu_gated_swiglu__decode_kernel,@function
adaLN_cond__sliding_block_cached__glu_gated_swiglu__decode_kernel:
  s_cmpk_ge_u32 s2, 256
  s_cbranch_scc1 L_end
  s_load_dwordx2 s[44:45], s[0:1], 8
  v_readfirstlane_b32 s5, v0
  s_and_b32 s6, s2, 63
  s_lshr_b32 s7, s2, 6
  s_lshr_b32 s5, s5, 6
  v_and_b32 v1, 63, v0
  s_cmp_lt_u32 s5, 4
  s_cbranch_scc1 L_helper
  s_lshl_b32 s10, s6, 22
  s_lshl_b32 s11, s5, 9
  s_add_u32 s11, s11, s10
  s_add_u32 s11, s11, 3143680
  v_lshrrev_b32 v3, 5, v1
  v_lshl_add_u32 v2, v1, 4, s11
  v_mul_u32_u24 v3, 32256, v3
  s_mul_i32 s12, s2, 9
  s_lshr_b32 s12, s12, 3
  s_and_b32 s12, s12, 15
  s_mul_i32 s58, s7, 28
  v_add_u32 v2, v2, v3
  s_add_u32 s12, s12, s58
  s_and_b32 s13, s12, -8
  s_add_u32 s12, s12, s13
  s_lshl_b32 s12, s12, 12
  s_lshl_b32 s46, 1, 28
  s_lshl_b32 s47, 1, 17
  s_mov_b32 s19, 36864
  s_waitcnt lgkmcnt(0)
L_nb1:
  buffer_load_dwordx4 v[56:59], v2, s[44:47], s12 offen nt
  s_add_u32 s12, s12, s19
  s_bitset0_b32 s12, 15
  buffer_load_dwordx4 v[60:63], v2, s[44:47], s12 offen nt
  s_add_u32 s12, s12, s19
  s_bitset0_b32 s12, 15
  buffer_load_dwordx4 v[64:67], v2, s[44:47], s12 offen nt
  s_add_u32 s12, s12, s19
  s_bitset0_b32 s12, 15
  s_getpc_b64 s[56:57]
L_pc:
  s_lshl_b32 s3, s2, 2
  s_add_u32 s3, s3, L_table-L_pc
  s_load_dword s14, s[56:57], s3
  s_load_dwordx2 s[48:49], s[0:1], 16
  s_load_dwordx4 s[20:23], s[0:1], 24
  s_load_dwordx2 s[28:29], s[0:1], 80
  s_load_dwordx2 s[42:43], s[0:1], 104
  s_getreg_b32 s68, hwreg(HW_REG_XCC_ID, 0, 3)
  s_lshr_b32 s68, 85, s68
  s_barrier
  s_sub_u32 s9, s5, 4
  s_mov_b64 s[50:51], s[46:47]
  s_mov_b32 s52, 0xcccccccc
  s_mov_b32 s53, 0xcccccccc
  s_mov_b32 s54, 0xaaaaaaaa
  s_mov_b32 s55, 0xaaaaaaaa
  s_mul_i32 s15, s9, 8192
  s_add_u32 s15, s15, 86016
  s_add_u32 s59, s58, 28
  s_and_b32 s13, s58, -8
  s_add_u32 s58, s58, s13
  s_lshl_b32 s58, s58, 12
  s_and_b32 s13, s59, -8
  s_add_u32 s59, s59, s13
  s_lshl_b32 s59, s59, 12
  s_lshl_b32 s13, s9, 9
  v_subrev_u32 v0, s13, v2
  v_mov_b32 v4, 0
  v_lshrrev_b32 v5, 3, v1
  v_and_b32 v6, 6, v5
  v_xor_b32 v6, v6, v1
  v_and_b32 v6, 7, v6
  s_lshl_b32 s33, s9, 6
  s_movk_i32 s26, 6144
  s_mov_b32 s30, 3145728
  s_mov_b32 s31, s47
  s_lshl_b32 s34, s9, 13
  s_add_u32 s34, s34, 20480
  s_add_u32 s35, s34, 8192
  s_and_b32 s36, s2, 7
  s_lshl_b32 s36, s36, 1
  s_and_b32 s37, s9, 1
  s_add_u32 s36, s36, s37
  s_lshr_b32 s37, s9, 1
  s_lshl_b32 s37, s37, 4
  s_add_u32 s36, s36, s37
  s_lshl_b32 s36, s36, 6
  s_waitcnt lgkmcnt(0)
  s_and_b32 s27, s14, 7
  s_cmp_eq_u32 s27, 6
  s_cselect_b64 s[28:29], s[20:21], s[28:29]
  s_cselect_b32 s26, 0x2000, s26
  s_cselect_b32 s30, 0x400000, s30
  s_cmp_eq_u32 s27, 1
  s_cselect_b64 s[28:29], s[22:23], s[28:29]
  s_cselect_b32 s26, 0x400, s26
  s_cselect_b32 s30, 0x400000, s30
  s_cselect_b32 s33, s36, s33
  s_cselect_b32 s27, 4, s27
  v_mul_u32_u24 v5, s26, v5
  v_lshl_add_u32 v5, v6, 4, v5
  v_mov_b32 v6, 1
  s_mul_i32 s33, s33, s26
  s_bfe_u32 s32, s14, 0x60003
  s_lshl_b32 s32, s32, 7
  s_add_u32 s33, s33, s32
  s_lshl_b32 s26, s26, 3
  s_cmp_lt_u32 s27, 4
  s_cbranch_scc1 L_we_2
L_wl_1:
  s_mov_b32 m0, s34
  s_waitcnt vmcnt(4)
  buffer_load_dwordx4 v5, s[28:31], s33 offen nt lds
  s_add_u32 s33, s33, s26
  s_addk_i32 s34, 1024
  s_cmp_lt_u32 s34, s35
  s_cbranch_scc1 L_wl_1
L_we_2:
  s_waitcnt vmcnt(2)
  buffer_load_dwordx4 v[68:71], v2, s[44:47], s12 offen nt
  s_add_u32 s12, s12, s19
  s_bitset0_b32 s12, 15
  s_waitcnt vmcnt(2)
  buffer_load_dwordx4 v[72:75], v2, s[44:47], s12 offen nt
  s_add_u32 s12, s12, s19
  s_bitset0_b32 s12, 15
  s_waitcnt vmcnt(2)
  s_bitcmp0_b32 s68, 0
  s_cbranch_scc1 L_th_3
  s_waitcnt vmcnt(1)
L_th_3:
  buffer_load_dwordx4 v[76:79], v2, s[44:47], s12 offen nt
  s_add_u32 s12, s12, s19
  s_bitset0_b32 s12, 15
  s_cmp_lt_u32 s27, 4
  s_cbranch_scc1 L_ws_4
  s_mov_b64 exec, 1
  ds_add_u32 v4, v6 offset:6720
  s_mov_b64 exec, -1
L_ws_4:
  s_waitcnt vmcnt(2)
  buffer_load_dwordx4 v[80:83], v2, s[44:47], s12 offen nt
  s_add_u32 s12, s12, s19
  s_bitset0_b32 s12, 15
  s_waitcnt vmcnt(2)
  buffer_load_dwordx4 v[84:87], v2, s[44:47], s12 offen nt
  s_add_u32 s12, s12, s19
  s_bitset0_b32 s12, 15
  s_waitcnt vmcnt(2)
  s_bitcmp0_b32 s68, 0
  s_cbranch_scc1 L_th_5
  s_waitcnt vmcnt(1)
L_th_5:
  buffer_load_dwordx4 v[88:91], v2, s[44:47], s12 offen nt
  s_add_u32 s12, s12, s19
  s_bitset0_b32 s12, 15
  s_waitcnt vmcnt(2)
  buffer_load_dwordx4 v[92:95], v2, s[44:47], s12 offen nt
  s_add_u32 s12, s12, s19
  s_bitset0_b32 s12, 15
  s_waitcnt vmcnt(2)
  buffer_load_dwordx4 v[96:99], v2, s[44:47], s12 offen nt
  s_add_u32 s12, s12, s19
  s_bitset0_b32 s12, 15
  s_waitcnt vmcnt(2)
  s_bitcmp0_b32 s68, 0
  s_cbranch_scc1 L_th_6
  s_waitcnt vmcnt(1)
L_th_6:
  buffer_load_dwordx4 v[100:103], v2, s[44:47], s12 offen nt
  s_add_u32 s12, s12, s19
  s_bitset0_b32 s12, 15
  s_waitcnt vmcnt(2)
  buffer_load_dwordx4 v[104:107], v2, s[44:47], s12 offen nt
  s_add_u32 s12, s12, s19
  s_bitset0_b32 s12, 15
  s_cmp_ge_u32 s12, s59
  s_cselect_b32 s12, s58, s12
  s_waitcnt vmcnt(2)
  buffer_load_dwordx4 v[108:111], v2, s[44:47], s12 offen nt
  s_add_u32 s12, s12, s19
  s_bitset0_b32 s12, 15
  s_cmp_ge_u32 s12, s59
  s_cselect_b32 s12, s58, s12
  s_waitcnt vmcnt(2)
  s_bitcmp0_b32 s68, 0
  s_cbranch_scc1 L_th_7
  s_waitcnt vmcnt(1)
L_th_7:
  buffer_load_dwordx4 v[112:115], v2, s[44:47], s12 offen nt
  s_add_u32 s12, s12, s19
  s_bitset0_b32 s12, 15
  s_cmp_ge_u32 s12, s59
  s_cselect_b32 s12, s58, s12
  s_waitcnt vmcnt(2)
  buffer_load_dwordx4 v[116:119], v2, s[44:47], s12 offen nt
  s_add_u32 s12, s12, s19
  s_bitset0_b32 s12, 15
  s_cmp_ge_u32 s12, s59
  s_cselect_b32 s12, s58, s12
  s_waitcnt vmcnt(2)
  buffer_load_dwordx4 v[120:123], v2, s[44:47], s12 offen nt
  s_add_u32 s12, s12, s19
  s_bitset0_b32 s12, 15
  s_cmp_ge_u32 s12, s59
  s_cselect_b32 s12, s58, s12
  s_waitcnt vmcnt(2)
  s_bitcmp0_b32 s68, 0
  s_cbranch_scc1 L_th_8
  s_waitcnt vmcnt(1)
L_th_8:
  buffer_load_dwordx4 v[124:127], v2, s[44:47], s12 offen nt
  s_add_u32 s12, s12, s19
  s_bitset0_b32 s12, 15
  s_cmp_ge_u32 s12, s59
  s_cselect_b32 s12, s58, s12
  s_waitcnt vmcnt(2)
  buffer_load_dwordx4 v[128:131], v2, s[44:47], s12 offen nt
  s_add_u32 s12, s12, s19
  s_bitset0_b32 s12, 15
  s_cmp_ge_u32 s12, s59
  s_cselect_b32 s12, s58, s12
  ds_write_b32 v4, v4 offset:6672
  s_waitcnt vmcnt(2)
  buffer_load_dwordx4 v[132:135], v2, s[44:47], s12 offen nt
  s_add_u32 s12, s12, s19
  s_bitset0_b32 s12, 15
  s_cmp_ge_u32 s12, s59
  s_cselect_b32 s12, s58, s12
  s_waitcnt vmcnt(2)
  s_bitcmp0_b32 s68, 0
  s_cbranch_scc1 L_th_9
  s_waitcnt vmcnt(1)
L_th_9:
  buffer_load_dwordx4 v[136:139], v2, s[44:47], s12 offen nt
  s_add_u32 s12, s12, s19
  s_bitset0_b32 s12, 15
  s_cmp_ge_u32 s12, s59
  s_cselect_b32 s12, s58, s12
  s_waitcnt vmcnt(2)
  buffer_load_dwordx4 v[140:143], v2, s[44:47], s12 offen nt
  s_add_u32 s12, s12, s19
  s_bitset0_b32 s12, 15
  s_cmp_ge_u32 s12, s59
  s_cselect_b32 s12, s58, s12
  s_waitcnt vmcnt(2)
  buffer_load_dwordx4 v[144:147], v2, s[44:47], s12 offen nt
  s_add_u32 s12, s12, s19
  s_bitset0_b32 s12, 15
  s_cmp_ge_u32 s12, s59
  s_cselect_b32 s12, s58, s12
  s_bfe_u32 s61, s14, 0xa0010
  s_add_u32 s61, s61, s9
  s_and_b32 s13, s61, -64
  s_add_u32 s61, s61, s13
  s_lshl_b32 s61, s61, 9
  s_bfe_u32 s60, s14, 0x70009
  s_sub_u32 s60, s9, s60
  s_add_u32 s60, s60, 64
  s_lshr_b32 s60, s60, 3
  v_bfrev_b32 v3, v1
  v_lshrrev_b32 v3, 28, v3
  v_cmp_gt_u32 s[66:67], s60, v3
  v_and_b32 v3, 15, v1
  v_lshlrev_b32 v3, 4, v3
  s_mov_b32 s13, s61
  s_cmp_gt_u32 s60, 7
  s_cbranch_scc1 L_opts_10
  s_waitcnt vmcnt(2)
  s_bitcmp0_b32 s68, 0
  s_cbranch_scc1 L_th_11
  s_waitcnt vmcnt(1)
L_th_11:
  buffer_load_dwordx4 v[52:55], v0, s[44:47], s13 offen nt
  s_add_u32 s13, s13, s19
  s_bitset0_b32 s13, 15
  s_cmp_gt_u32 s60, 6
  s_cbranch_scc1 L_opts_10
  s_waitcnt vmcnt(2)
  buffer_load_dwordx4 v[48:51], v0, s[44:47], s13 offen nt
  s_add_u32 s13, s13, s19
  s_bitset0_b32 s13, 15
  s_cmp_gt_u32 s60, 5
  s_cbranch_scc1 L_opts_10
  s_waitcnt vmcnt(2)
  buffer_load_dwordx4 v[44:47], v0, s[44:47], s13 offen nt
  s_add_u32 s13, s13, s19
  s_bitset0_b32 s13, 15
  s_cmp_gt_u32 s60, 4
  s_cbranch_scc1 L_opts_10
  s_waitcnt vmcnt(2)
  s_bitcmp0_b32 s68, 0
  s_cbranch_scc1 L_th_12
  s_waitcnt vmcnt(1)
L_th_12:
  buffer_load_dwordx4 v[40:43], v0, s[44:47], s13 offen nt
  s_add_u32 s13, s13, s19
  s_bitset0_b32 s13, 15
  s_cmp_gt_u32 s60, 3
  s_cbranch_scc1 L_opts_10
  s_waitcnt vmcnt(2)
  buffer_load_dwordx4 v[36:39], v0, s[44:47], s13 offen nt
  s_add_u32 s13, s13, s19
  s_bitset0_b32 s13, 15
  s_cmp_gt_u32 s60, 2
  s_cbranch_scc1 L_opts_10
  s_waitcnt vmcnt(2)
  buffer_load_dwordx4 v[32:35], v0, s[44:47], s13 offen nt
  s_add_u32 s13, s13, s19
  s_bitset0_b32 s13, 15
  s_cmp_gt_u32 s60, 1
  s_cbranch_scc1 L_opts_10
  s_waitcnt vmcnt(2)
  s_bitcmp0_b32 s68, 0
  s_cbranch_scc1 L_th_13
  s_waitcnt vmcnt(1)
L_th_13:
  buffer_load_dwordx4 v[28:31], v0, s[44:47], s13 offen nt
  s_add_u32 s13, s13, s19
  s_bitset0_b32 s13, 15
  s_cmp_gt_u32 s60, 0
  s_cbranch_scc1 L_opts_10
  s_waitcnt vmcnt(2)
  buffer_load_dwordx4 v[24:27], v0, s[44:47], s13 offen nt
  s_add_u32 s13, s13, s19
  s_bitset0_b32 s13, 15
L_opts_10:
  s_waitcnt vmcnt(2)
  buffer_load_dwordx4 v[148:151], v2, s[44:47], s12 offen nt
  s_add_u32 s12, s12, s19
  s_bitset0_b32 s12, 15
  s_cmp_ge_u32 s12, s59
  s_cselect_b32 s12, s58, s12
  s_waitcnt vmcnt(2)
  s_bitcmp0_b32 s68, 0
  s_cbranch_scc1 L_th_14
  s_waitcnt vmcnt(1)
L_th_14:
  buffer_load_dwordx4 v[152:155], v2, s[44:47], s12 offen nt
  s_add_u32 s12, s12, s19
  s_bitset0_b32 s12, 15
  s_cmp_ge_u32 s12, s59
  s_cselect_b32 s12, s58, s12
  s_waitcnt vmcnt(2)
  buffer_load_dwordx4 v[156:159], v2, s[44:47], s12 offen nt
  s_add_u32 s12, s12, s19
  s_bitset0_b32 s12, 15
  s_cmp_ge_u32 s12, s59
  s_cselect_b32 s12, s58, s12
  s_waitcnt vmcnt(2)
  buffer_load_dwordx4 v[160:163], v2, s[44:47], s12 offen nt
  s_add_u32 s12, s12, s19
  s_bitset0_b32 s12, 15
  s_cmp_ge_u32 s12, s59
  s_cselect_b32 s12, s58, s12
  s_waitcnt vmcnt(2)
  s_bitcmp0_b32 s68, 0
  s_cbranch_scc1 L_th_15
  s_waitcnt vmcnt(1)
L_th_15:
  buffer_load_dwordx4 v[164:167], v2, s[44:47], s12 offen nt
  s_add_u32 s12, s12, s19
  s_bitset0_b32 s12, 15
  s_cmp_ge_u32 s12, s59
  s_cselect_b32 s12, s58, s12
  s_waitcnt vmcnt(2)
  s_add_u32 m0, s15, 0
  s_nop 0
  buffer_load_dwordx4 v2, s[48:51], s12 offen nt lds
  s_add_u32 s12, s12, s19
  s_bitset0_b32 s12, 15
  s_waitcnt vmcnt(2)
  s_add_u32 m0, s15, 1024
  s_nop 0
  buffer_load_dwordx4 v2, s[48:51], s12 offen nt lds
  s_add_u32 s12, s12, s19
  s_bitset0_b32 s12, 15
  s_waitcnt vmcnt(2)
  s_bitcmp0_b32 s68, 0
  s_cbranch_scc1 L_th_16
  s_waitcnt vmcnt(1)
L_th_16:
  s_add_u32 m0, s15, 2048
  s_nop 0
  buffer_load_dwordx4 v2, s[48:51], s12 offen nt lds
  s_add_u32 s12, s12, s19
  s_bitset0_b32 s12, 15
  ds_write_b32 v4, v4 offset:6664
  s_waitcnt vmcnt(2)
  s_add_u32 m0, s15, 3072
  s_nop 0
  buffer_load_dwordx4 v2, s[48:51], s12 offen nt lds
  s_add_u32 s12, s12, s19
  s_bitset0_b32 s12, 15
  s_waitcnt vmcnt(2)
  s_add_u32 m0, s15, 4096
  s_nop 0
  buffer_load_dwordx4 v2, s[48:51], s12 offen nt lds
  s_add_u32 s12, s12, s19
  s_bitset0_b32 s12, 15
  s_waitcnt vmcnt(2)
  s_bitcmp0_b32 s68, 0
  s_cbranch_scc1 L_th_17
  s_waitcnt vmcnt(1)
L_th_17:
  s_add_u32 m0, s15, 5120
  s_nop 0
  buffer_load_dwordx4 v2, s[48:51], s12 offen nt lds
  s_add_u32 s12, s12, s19
  s_bitset0_b32 s12, 15
  s_waitcnt vmcnt(2)
  s_add_u32 m0, s15, 6144
  s_nop 0
  buffer_load_dwordx4 v2, s[48:51], s12 offen nt lds
  s_add_u32 s12, s12, s19
  s_bitset0_b32 s12, 15
  s_waitcnt vmcnt(2)
  s_add_u32 m0, s15, 7168
  s_nop 0
  buffer_load_dwordx4 v2, s[48:51], s12 offen nt lds
  s_add_u32 s12, s12, s19
  s_bitset0_b32 s12, 15
  s_mov_b32 s70, 0
L_pl_18:
  ds_read_b128 v[4:7], v3 offset:6400
  s_waitcnt lgkmcnt(0)
  v_max3_u32 v8, v4, v5, v6
  v_max_u32 v8, v8, v7
  v_cmp_eq_u32 vcc, -1, v8
  s_cmp_eq_u64 vcc, 0
  s_cbranch_scc1 L_pld_19
  s_sleep 2
  s_add_u32 s70, s70, 1
  s_cmp_lt_u32 s70, 1048576
  s_cbranch_scc1 L_pl_18
L_pld_19:
  s_waitcnt vmcnt(8)
  v_dot2_f32_bf16 v8, v56, v4, 0
  v_dot2_f32_bf16 v9, v60, v4, 0
  v_dot2_f32_bf16 v10, v64, v4, 0
  v_dot2_f32_bf16 v11, v68, v4, 0
  v_dot2_f32_bf16 v12, v72, v4, 0
  v_dot2_f32_bf16 v13, v76, v4, 0
  v_dot2_f32_bf16 v14, v80, v4, 0
  v_dot2_f32_bf16 v15, v84, v4, 0
  v_dot2_f32_bf16 v8, v57, v5, v8
  v_dot2_f32_bf16 v9, v61, v5, v9
  v_dot2_f32_bf16 v10, v65, v5, v10
  v_dot2_f32_bf16 v11, v69, v5, v11
  v_dot2_f32_bf16 v12, v73, v5, v12
  v_dot2_f32_bf16 v13, v77, v5, v13
  v_dot2_f32_bf16 v14, v81, v5, v14
  v_dot2_f32_bf16 v15, v85, v5, v15
  v_dot2_f32_bf16 v8, v58, v6, v8
  v_dot2_f32_bf16 v9, v62, v6, v9
  v_dot2_f32_bf16 v10, v66, v6, v10
  v_dot2_f32_bf16 v11, v70, v6, v11
  v_dot2_f32_bf16 v12, v74, v6, v12
  v_dot2_f32_bf16 v13, v78, v6, v13
  v_dot2_f32_bf16 v14, v82, v6, v14
  v_dot2_f32_bf16 v15, v86, v6, v15
  v_dot2_f32_bf16 v8, v59, v7, v8
  v_dot2_f32_bf16 v9, v63, v7, v9
  v_dot2_f32_bf16 v10, v67, v7, v10
  v_dot2_f32_bf16 v11, v71, v7, v11
  v_dot2_f32_bf16 v12, v75, v7, v12
  v_dot2_f32_bf16 v13, v79, v7, v13
  v_dot2_f32_bf16 v14, v83, v7, v14
  v_dot2_f32_bf16 v15, v87, v7, v15
  v_add_f32_dpp v8, v8, v8 row_ror:8 row_mask:0xf bank_mask:0x3
  v_add_f32_dpp v8, v9, v9 row_ror:8 row_mask:0xf bank_mask:0xc
  v_add_f32_dpp v10, v10, v10 row_ror:8 row_mask:0xf bank_mask:0x3
  v_add_f32_dpp v10, v11, v11 row_ror:8 row_mask:0xf bank_mask:0xc
  v_add_f32_dpp v12, v12, v12 row_ror:8 row_mask:0xf bank_mask:0x3
  v_add_f32_dpp v12, v13, v13 row_ror:8 row_mask:0xf bank_mask:0xc
  v_add_f32_dpp v14, v14, v14 row_ror:8 row_mask:0xf bank_mask:0x3
  v_add_f32_dpp v14, v15, v15 row_ror:8 row_mask:0xf bank_mask:0xc
  v_add_f32_dpp v18, v8, v8 row_shl:4 row_mask:0xf bank_mask:0x5
  v_add_f32_dpp v18, v10, v10 row_shr:4 row_mask:0xf bank_mask:0xa
  v_add_f32_dpp v19, v12, v12 row_shl:4 row_mask:0xf bank_mask:0x5
  v_add_f32_dpp v19, v14, v14 row_shr:4 row_mask:0xf bank_mask:0xa
  v_dot2_f32_bf16 v8, v88, v4, 0
  v_dot2_f32_bf16 v9, v92, v4, 0
  v_dot2_f32_bf16 v10, v96, v4, 0
  v_dot2_f32_bf16 v11, v100, v4, 0
  v_dot2_f32_bf16 v12, v104, v4, 0
  v_dot2_f32_bf16 v13, v108, v4, 0
  v_dot2_f32_bf16 v14, v112, v4, 0
  v_dot2_f32_bf16 v15, v116, v4, 0
  v_dot2_f32_bf16 v8, v89, v5, v8
  v_dot2_f32_bf16 v9, v93, v5, v9
  v_dot2_f32_bf16 v10, v97, v5, v10
  v_dot2_f32_bf16 v11, v101, v5, v11
  v_dot2_f32_bf16 v12, v105, v5, v12
  v_dot2_f32_bf16 v13, v109, v5, v13
  v_dot2_f32_bf16 v14, v113, v5, v14
  v_dot2_f32_bf16 v15, v117, v5, v15
  v_dot2_f32_bf16 v8, v90, v6, v8
  v_dot2_f32_bf16 v9, v94, v6, v9
  v_dot2_f32_bf16 v10, v98, v6, v10
  v_dot2_f32_bf16 v11, v102, v6, v11
  v_dot2_f32_bf16 v12, v106, v6, v12
  v_dot2_f32_bf16 v13, v110, v6, v13
  v_dot2_f32_bf16 v14, v114, v6, v14
  v_dot2_f32_bf16 v15, v118, v6, v15
  v_dot2_f32_bf16 v8, v91, v7, v8
  v_dot2_f32_bf16 v9, v95, v7, v9
  v_dot2_f32_bf16 v10, v99, v7, v10
  v_dot2_f32_bf16 v11, v103, v7, v11
  v_dot2_f32_bf16 v12, v107, v7, v12
  v_dot2_f32_bf16 v13, v111, v7, v13
  v_dot2_f32_bf16 v14, v115, v7, v14
  v_dot2_f32_bf16 v15, v119, v7, v15
  v_add_f32_dpp v8, v8, v8 row_ror:8 row_mask:0xf bank_mask:0x3
  v_add_f32_dpp v8, v9, v9 row_ror:8 row_mask:0xf bank_mask:0xc
  v_add_f32_dpp v10, v10, v10 row_ror:8 row_mask:0xf bank_mask:0x3
  v_add_f32_dpp v10, v11, v11 row_ror:8 row_mask:0xf bank_mask:0xc
  v_add_f32_dpp v12, v12, v12 row_ror:8 row_mask:0xf bank_mask:0x3
  v_add_f32_dpp v12, v13, v13 row_ror:8 row_mask:0xf bank_mask:0xc
  v_add_f32_dpp v14, v14, v14 row_ror:8 row_mask:0xf bank_mask:0x3
  v_add_f32_dpp v14, v15, v15 row_ror:8 row_mask:0xf bank_mask:0xc
  v_add_f32_dpp v20, v8, v8 row_shl:4 row_mask:0xf bank_mask:0x5
  v_add_f32_dpp v20, v10, v10 row_shr:4 row_mask:0xf bank_mask:0xa
  v_add_f32_dpp v21, v12, v12 row_shl:4 row_mask:0xf bank_mask:0x5
  v_add_f32_dpp v21, v14, v14 row_shr:4 row_mask:0xf bank_mask:0xa
  v_dot2_f32_bf16 v8, v120, v4, 0
  v_dot2_f32_bf16 v9, v124, v4, 0
  v_dot2_f32_bf16 v10, v128, v4, 0
  v_dot2_f32_bf16 v11, v132, v4, 0
  v_dot2_f32_bf16 v12, v136, v4, 0
  v_dot2_f32_bf16 v13, v140, v4, 0
  v_dot2_f32_bf16 v14, v144, v4, 0
  v_dot2_f32_bf16 v15, v148, v4, 0
  v_dot2_f32_bf16 v8, v121, v5, v8
  v_dot2_f32_bf16 v9, v125, v5, v9
  v_dot2_f32_bf16 v10, v129, v5, v10
  v_dot2_f32_bf16 v11, v133, v5, v11
  v_dot2_f32_bf16 v12, v137, v5, v12
  v_dot2_f32_bf16 v13, v141, v5, v13
  v_dot2_f32_bf16 v14, v145, v5, v14
  v_dot2_f32_bf16 v15, v149, v5, v15
  v_dot2_f32_bf16 v8, v122, v6, v8
  v_dot2_f32_bf16 v9, v126, v6, v9
  v_dot2_f32_bf16 v10, v130, v6, v10
  v_dot2_f32_bf16 v11, v134, v6, v11
  v_dot2_f32_bf16 v12, v138, v6, v12
  v_dot2_f32_bf16 v13, v142, v6, v13
  v_dot2_f32_bf16 v14, v146, v6, v14
  v_dot2_f32_bf16 v15, v150, v6, v15
  v_dot2_f32_bf16 v8, v123, v7, v8
  v_dot2_f32_bf16 v9, v127, v7, v9
  v_dot2_f32_bf16 v10, v131, v7, v10
  v_dot2_f32_bf16 v11, v135, v7, v11
  v_dot2_f32_bf16 v12, v139, v7, v12
  v_dot2_f32_bf16 v13, v143, v7, v13
  v_dot2_f32_bf16 v14, v147, v7, v14
  v_dot2_f32_bf16 v15, v151, v7, v15
  buffer_load_dwordx4 v[88:91], v2, s[48:51], s12 offen nt
  s_add_u32 s12, s12, s19
  s_bitset0_b32 s12, 15
  v_add_f32_dpp v8, v8, v8 row_ror:8 row_mask:0xf bank_mask:0x3
  v_add_f32_dpp v8, v9, v9 row_ror:8 row_mask:0xf bank_mask:0xc
  v_add_f32_dpp v10, v10, v10 row_ror:8 row_mask:0xf bank_mask:0x3
  v_add_f32_dpp v10, v11, v11 row_ror:8 row_mask:0xf bank_mask:0xc
  v_add_f32_dpp v12, v12, v12 row_ror:8 row_mask:0xf bank_mask:0x3
  v_add_f32_dpp v12, v13, v13 row_ror:8 row_mask:0xf bank_mask:0xc
  v_add_f32_dpp v14, v14, v14 row_ror:8 row_mask:0xf bank_mask:0x3
  v_add_f32_dpp v14, v15, v15 row_ror:8 row_mask:0xf bank_mask:0xc
  v_add_f32_dpp v22, v8, v8 row_shl:4 row_mask:0xf bank_mask:0x5
  v_add_f32_dpp v22, v10, v10 row_shr:4 row_mask:0xf bank_mask:0xa
  v_add_f32_dpp v23, v12, v12 row_shl:4 row_mask:0xf bank_mask:0x5
  v_add_f32_dpp v23, v14, v14 row_shr:4 row_mask:0xf bank_mask:0xa
  v_dot2_f32_bf16 v8, v152, v4, 0
  v_dot2_f32_bf16 v9, v156, v4, 0
  v_dot2_f32_bf16 v10, v160, v4, 0
  v_dot2_f32_bf16 v11, v164, v4, 0
  v_dot2_f32_bf16 v8, v153, v5, v8
  v_dot2_f32_bf16 v9, v157, v5, v9
  v_dot2_f32_bf16 v10, v161, v5, v10
  v_dot2_f32_bf16 v11, v165, v5, v11
  v_dot2_f32_bf16 v8, v154, v6, v8
  v_dot2_f32_bf16 v9, v158, v6, v9
  v_dot2_f32_bf16 v10, v162, v6, v10
  v_dot2_f32_bf16 v11, v166, v6, v11
  v_dot2_f32_bf16 v8, v155, v7, v8
  v_dot2_f32_bf16 v9, v159, v7, v9
  v_dot2_f32_bf16 v10, v163, v7, v10
  v_dot2_f32_bf16 v11, v167, v7, v11
  v_add_f32_dpp v8, v8, v8 row_ror:8 row_mask:0xf bank_mask:0x3
  v_add_f32_dpp v8, v9, v9 row_ror:8 row_mask:0xf bank_mask:0xc
  v_add_f32_dpp v10, v10, v10 row_ror:8 row_mask:0xf bank_mask:0x3
  v_add_f32_dpp v10, v11, v11 row_ror:8 row_mask:0xf bank_mask:0xc
  s_nop 0
  v_add_f32_dpp v3, v8, v8 row_shl:4 row_mask:0xf bank_mask:0x5
  v_add_f32_dpp v3, v10, v10 row_shr:4 row_mask:0xf bank_mask:0xa
  v_dot2_f32_bf16 v8, v24, v4, 0
  v_dot2_f32_bf16 v9, v28, v4, 0
  v_dot2_f32_bf16 v10, v32, v4, 0
  v_dot2_f32_bf16 v11, v36, v4, 0
  v_dot2_f32_bf16 v12, v40, v4, 0
  v_dot2_f32_bf16 v13, v44, v4, 0
  v_dot2_f32_bf16 v14, v48, v4, 0
  v_dot2_f32_bf16 v15, v52, v4, 0
  v_dot2_f32_bf16 v8, v25, v5, v8
  v_dot2_f32_bf16 v9, v29, v5, v9
  v_dot2_f32_bf16 v10, v33, v5, v10
  v_dot2_f32_bf16 v11, v37, v5, v11
  v_dot2_f32_bf16 v12, v41, v5, v12
  v_dot2_f32_bf16 v13, v45, v5, v13
  v_dot2_f32_bf16 v14, v49, v5, v14
  v_dot2_f32_bf16 v15, v53, v5, v15
  v_dot2_f32_bf16 v8, v26, v6, v8
  v_dot2_f32_bf16 v9, v30, v6, v9
  v_dot2_f32_bf16 v10, v34, v6, v10
  v_dot2_f32_bf16 v11, v38, v6, v11
  v_dot2_f32_bf16 v12, v42, v6, v12
  v_dot2_f32_bf16 v13, v46, v6, v13
  v_dot2_f32_bf16 v14, v50, v6, v14
  v_dot2_f32_bf16 v15, v54, v6, v15
  v_dot2_f32_bf16 v8, v27, v7, v8
  v_dot2_f32_bf16 v9, v31, v7, v9
  v_dot2_f32_bf16 v10, v35, v7, v10
  v_dot2_f32_bf16 v11, v39, v7, v11
  v_dot2_f32_bf16 v12, v43, v7, v12
  v_dot2_f32_bf16 v13, v47, v7, v13
  v_dot2_f32_bf16 v14, v51, v7, v14
  v_dot2_f32_bf16 v15, v55, v7, v15
  buffer_load_dwordx4 v[92:95], v2, s[48:51], s12 offen nt
  s_add_u32 s12, s12, s19
  s_bitset0_b32 s12, 15
  v_add_f32_dpp v8, v8, v8 row_ror:8 row_mask:0xf bank_mask:0x3
  v_add_f32_dpp v8, v9, v9 row_ror:8 row_mask:0xf bank_mask:0xc
  v_add_f32_dpp v10, v10, v10 row_ror:8 row_mask:0xf bank_mask:0x3
  v_add_f32_dpp v10, v11, v11 row_ror:8 row_mask:0xf bank_mask:0xc
  v_add_f32_dpp v12, v12, v12 row_ror:8 row_mask:0xf bank_mask:0x3
  v_add_f32_dpp v12, v13, v13 row_ror:8 row_mask:0xf bank_mask:0xc
  v_add_f32_dpp v14, v14, v14 row_ror:8 row_mask:0xf bank_mask:0x3
  v_add_f32_dpp v14, v15, v15 row_ror:8 row_mask:0xf bank_mask:0xc
  v_add_f32_dpp v16, v8, v8 row_shl:4 row_mask:0xf bank_mask:0x5
  v_add_f32_dpp v16, v10, v10 row_shr:4 row_mask:0xf bank_mask:0xa
  v_add_f32_dpp v17, v12, v12 row_shl:4 row_mask:0xf bank_mask:0x5
  v_add_f32_dpp v17, v14, v14 row_shr:4 row_mask:0xf bank_mask:0xa
  v_add_f32_dpp v3, v3, v3 quad_perm:[2,3,0,1] row_mask:0xf bank_mask:0xf
  v_add_f32_dpp v18, v18, v18 quad_perm:[2,3,0,1] row_mask:0xf bank_mask:0xf
  v_add_f32_dpp v19, v19, v19 quad_perm:[2,3,0,1] row_mask:0xf bank_mask:0xf
  v_add_f32_dpp v20, v20, v20 quad_perm:[2,3,0,1] row_mask:0xf bank_mask:0xf
  v_add_f32_dpp v21, v21, v21 quad_perm:[2,3,0,1] row_mask:0xf bank_mask:0xf
  v_add_f32_dpp v22, v22, v22 quad_perm:[2,3,0,1] row_mask:0xf bank_mask:0xf
  v_add_f32_dpp v23, v23, v23 quad_perm:[2,3,0,1] row_mask:0xf bank_mask:0xf
  v_add_f32_dpp v16, v16, v16 quad_perm:[2,3,0,1] row_mask:0xf bank_mask:0xf
  v_add_f32_dpp v17, v17, v17 quad_perm:[2,3,0,1] row_mask:0xf bank_mask:0xf
  v_cndmask_b32 v8, v16, v17, s[52:53]
  v_cndmask_b32 v9, v18, v19, s[52:53]
  v_cndmask_b32 v10, v20, v21, s[52:53]
  v_cndmask_b32 v11, v22, v23, s[52:53]
  v_add_f32_dpp v18, v3, v3 quad_perm:[1,0,3,2] row_mask:0xf bank_mask:0xf
  v_add_f32_dpp v8, v8, v8 quad_perm:[1,0,3,2] row_mask:0xf bank_mask:0xf
  v_add_f32_dpp v9, v9, v9 quad_perm:[1,0,3,2] row_mask:0xf bank_mask:0xf
  v_add_f32_dpp v10, v10, v10 quad_perm:[1,0,3,2] row_mask:0xf bank_mask:0xf
  v_add_f32_dpp v11, v11, v11 quad_perm:[1,0,3,2] row_mask:0xf bank_mask:0xf
  v_cndmask_b32 v16, v8, v9, s[54:55]
  v_cndmask_b32 v17, v10, v11, s[54:55]
  v_cvt_pk_bf16_f32 v16, 0, v16
  v_cvt_pk_bf16_f32 v17, 0, v17
  v_cvt_pk_bf16_f32 v18, 0, v18
  v_mul_f32 v16, 0x3db504f3, v16
  v_mul_f32 v17, 0x3db504f3, v17
  v_mul_f32 v18, 0x3db504f3, v18
  v_cvt_pk_bf16_f32 v16, 0, v16
  v_cvt_pk_bf16_f32 v17, 0, v17
  v_cvt_pk_bf16_f32 v18, 0, v18
  v_mov_b32 v19, 0xff800000
  s_mov_b32 s52, 0xeeeeeeee
  s_mov_b32 s53, 0xeeeeeeee
  v_cndmask_b32 v16, v16, v19, s[66:67]
  v_cndmask_b32 v18, v18, v19, s[52:53]
  s_lshl_b32 s11, s9, 10
  v_lshl_add_u32 v3, v1, 4, s11
  ds_write_b128 v3, v[16:19] offset:12032
  s_waitcnt vmcnt(2)
  s_bitcmp0_b32 s68, 0
  s_cbranch_scc1 L_th_20
  s_waitcnt vmcnt(1)
L_th_20:
  buffer_load_dwordx4 v[96:99], v2, s[48:51], s12 offen nt
  s_add_u32 s12, s12, s19
  s_bitset0_b32 s12, 15
  v_lshl_add_u32 v3, v1, 4, s15
  ds_read_b128 v[56:59], v3 offset:0
  ds_read_b128 v[60:63], v3 offset:1024
  ds_read_b128 v[64:67], v3 offset:2048
  ds_read_b128 v[68:71], v3 offset:3072
  ds_read_b128 v[72:75], v3 offset:4096
  ds_read_b128 v[76:79], v3 offset:5120
  ds_read_b128 v[80:83], v3 offset:6144
  ds_read_b128 v[84:87], v3 offset:7168
  v_max3_f32 v22, v16, v17, v18
  s_nop 1
  v_max_f32_dpp v22, v22, v22 row_ror:8 row_mask:0xf bank_mask:0xf
  s_nop 1
  v_max_f32_dpp v22, v22, v22 row_ror:4 row_mask:0xf bank_mask:0xf
  s_nop 1
  v_max_f32_dpp v22, v22, v22 row_ror:2 row_mask:0xf bank_mask:0xf
  s_nop 1
  v_max_f32_dpp v22, v22, v22 row_ror:1 row_mask:0xf bank_mask:0xf
  v_mov_b32 v23, v22
  s_nop 1
  v_permlane16_swap_b32 v23, v22
  v_max_f32 v22, v22, v23
  v_mov_b32 v23, v22
  s_nop 1
  v_permlane32_swap_b32 v23, v22
  v_max_f32 v22, v22, v23
  v_sub_f32 v16, v16, v22
  v_sub_f32 v17, v17, v22
  v_sub_f32 v18, v18, v22
  v_mul_f32 v16, 0x3fb8aa3b, v16
  v_mul_f32 v17, 0x3fb8aa3b, v17
  v_mul_f32 v18, 0x3fb8aa3b, v18
  v_exp_f32 v16, v16
  v_exp_f32 v17, v17
  v_exp_f32 v18, v18
  s_nop 0
  v_cvt_pk_bf16_f32 v4, v16, 0
  v_cvt_pk_bf16_f32 v5, 0, v16
  v_cvt_pk_bf16_f32 v6, v17, 0
  v_cvt_pk_bf16_f32 v7, 0, v17
  v_cvt_pk_bf16_f32 v20, v18, 0
  v_cvt_pk_bf16_f32 v21, 0, v18
  v_mov_b32 v8, 0
  v_mov_b32 v9, 0
  v_mov_b32 v10, 0
  v_mov_b32 v11, 0
  v_mov_b32 v12, 0
  v_mov_b32 v13, 0
  v_mov_b32 v14, 0
  v_mov_b32 v15, 0
  s_lshl_b32 s11, s9, 9
  v_and_b32 v3, 15, v1
  v_lshlrev_b32 v3, 5, v3
  v_lshrrev_b32 v16, 4, v1
  v_lshl_add_u32 v3, v16, 3, v3
  v_add_u32 v3, s11, v3
  v_mov_b32 v16, 6656
  s_waitcnt lgkmcnt(0)
  s_mov_b32 s13, s61
  s_cmp_gt_u32 s60, 7
  s_cbranch_scc1 L_opts_21
  s_waitcnt vmcnt(2)
  buffer_load_dwordx4 v[52:55], v0, s[48:51], s13 offen nt
  s_add_u32 s13, s13, s19
  s_bitset0_b32 s13, 15
  s_cmp_gt_u32 s60, 6
  s_cbranch_scc1 L_opts_21
  s_waitcnt vmcnt(2)
  buffer_load_dwordx4 v[48:51], v0, s[48:51], s13 offen nt
  s_add_u32 s13, s13, s19
  s_bitset0_b32 s13, 15
  s_cmp_gt_u32 s60, 5
  s_cbranch_scc1 L_opts_21
  s_waitcnt vmcnt(2)
  s_bitcmp0_b32 s68, 0
  s_cbranch_scc1 L_th_22
  s_waitcnt vmcnt(1)
L_th_22:
  buffer_load_dwordx4 v[44:47], v0, s[48:51], s13 offen nt
  s_add_u32 s13, s13, s19
  s_bitset0_b32 s13, 15
  s_cmp_gt_u32 s60, 4
  s_cbranch_scc1 L_opts_21
  s_waitcnt vmcnt(2)
  buffer_load_dwordx4 v[40:43], v0, s[48:51], s13 offen nt
  s_add_u32 s13, s13, s19
  s_bitset0_b32 s13, 15
  s_cmp_gt_u32 s60, 3
  s_cbranch_scc1 L_opts_21
  s_waitcnt vmcnt(2)
  buffer_load_dwordx4 v[36:39], v0, s[48:51], s13 offen nt
  s_add_u32 s13, s13, s19
  s_bitset0_b32 s13, 15
  s_cmp_gt_u32 s60, 2
  s_cbranch_scc1 L_opts_21
  s_waitcnt vmcnt(2)
  s_bitcmp0_b32 s68, 0
  s_cbranch_scc1 L_th_23
  s_waitcnt vmcnt(1)
L_th_23:
  buffer_load_dwordx4 v[32:35], v0, s[48:51], s13 offen nt
  s_add_u32 s13, s13, s19
  s_bitset0_b32 s13, 15
  s_cmp_gt_u32 s60, 1
  s_cbranch_scc1 L_opts_21
  s_waitcnt vmcnt(2)
  buffer_load_dwordx4 v[28:31], v0, s[48:51], s13 offen nt
  s_add_u32 s13, s13, s19
  s_bitset0_b32 s13, 15
  s_cmp_gt_u32 s60, 0
  s_cbranch_scc1 L_opts_21
  s_waitcnt vmcnt(2)
  buffer_load_dwordx4 v[24:27], v0, s[48:51], s13 offen nt
  s_add_u32 s13, s13, s19
  s_bitset0_b32 s13, 15
L_opts_21:
  s_waitcnt vmcnt(2)
  s_bitcmp0_b32 s68, 0
  s_cbranch_scc1 L_th_24
  s_waitcnt vmcnt(1)
L_th_24:
  buffer_load_dwordx4 v[100:103], v2, s[48:51], s12 offen nt
  s_add_u32 s12, s12, s19
  s_bitset0_b32 s12, 15
  v_dot2c_f32_bf16_dpp v8, v4, v56 row_newbcast:1 row_mask:0xf bank_mask:0xf
  v_dot2c_f32_bf16_dpp v9, v5, v56 row_newbcast:1 row_mask:0xf bank_mask:0xf
  v_dot2c_f32_bf16_dpp v10, v4, v57 row_newbcast:1 row_mask:0xf bank_mask:0xf
  v_dot2c_f32_bf16_dpp v11, v5, v57 row_newbcast:1 row_mask:0xf bank_mask:0xf
  v_dot2c_f32_bf16_dpp v12, v4, v58 row_newbcast:1 row_mask:0xf bank_mask:0xf
  v_dot2c_f32_bf16_dpp v13, v5, v58 row_newbcast:1 row_mask:0xf bank_mask:0xf
  v_dot2c_f32_bf16_dpp v14, v4, v59 row_newbcast:1 row_mask:0xf bank_mask:0xf
  v_dot2c_f32_bf16_dpp v15, v5, v59 row_newbcast:1 row_mask:0xf bank_mask:0xf
  v_dot2c_f32_bf16_dpp v8, v4, v60 row_newbcast:9 row_mask:0xf bank_mask:0xf
  v_dot2c_f32_bf16_dpp v9, v5, v60 row_newbcast:9 row_mask:0xf bank_mask:0xf
  v_dot2c_f32_bf16_dpp v10, v4, v61 row_newbcast:9 row_mask:0xf bank_mask:0xf
  v_dot2c_f32_bf16_dpp v11, v5, v61 row_newbcast:9 row_mask:0xf bank_mask:0xf
  v_dot2c_f32_bf16_dpp v12, v4, v62 row_newbcast:9 row_mask:0xf bank_mask:0xf
  v_dot2c_f32_bf16_dpp v13, v5, v62 row_newbcast:9 row_mask:0xf bank_mask:0xf
  v_dot2c_f32_bf16_dpp v14, v4, v63 row_newbcast:9 row_mask:0xf bank_mask:0xf
  v_dot2c_f32_bf16_dpp v15, v5, v63 row_newbcast:9 row_mask:0xf bank_mask:0xf
  v_dot2c_f32_bf16_dpp v8, v4, v64 row_newbcast:5 row_mask:0xf bank_mask:0xf
  v_dot2c_f32_bf16_dpp v9, v5, v64 row_newbcast:5 row_mask:0xf bank_mask:0xf
  v_dot2c_f32_bf16_dpp v10, v4, v65 row_newbcast:5 row_mask:0xf bank_mask:0xf
  v_dot2c_f32_bf16_dpp v11, v5, v65 row_newbcast:5 row_mask:0xf bank_mask:0xf
  v_dot2c_f32_bf16_dpp v12, v4, v66 row_newbcast:5 row_mask:0xf bank_mask:0xf
  v_dot2c_f32_bf16_dpp v13, v5, v66 row_newbcast:5 row_mask:0xf bank_mask:0xf
  v_dot2c_f32_bf16_dpp v14, v4, v67 row_newbcast:5 row_mask:0xf bank_mask:0xf
  v_dot2c_f32_bf16_dpp v15, v5, v67 row_newbcast:5 row_mask:0xf bank_mask:0xf
  s_waitcnt vmcnt(2)
  buffer_load_dwordx4 v[104:107], v2, s[48:51], s12 offen nt
  s_add_u32 s12, s12, s19
  s_bitset0_b32 s12, 15
  s_cmp_ge_u32 s12, s59
  s_cselect_b32 s12, s58, s12
  v_dot2c_f32_bf16_dpp v8, v4, v68 row_newbcast:13 row_mask:0xf bank_mask:0xf
  v_dot2c_f32_bf16_dpp v9, v5, v68 row_newbcast:13 row_mask:0xf bank_mask:0xf
  v_dot2c_f32_bf16_dpp v10, v4, v69 row_newbcast:13 row_mask:0xf bank_mask:0xf
  v_dot2c_f32_bf16_dpp v11, v5, v69 row_newbcast:13 row_mask:0xf bank_mask:0xf
  v_dot2c_f32_bf16_dpp v12, v4, v70 row_newbcast:13 row_mask:0xf bank_mask:0xf
  v_dot2c_f32_bf16_dpp v13, v5, v70 row_newbcast:13 row_mask:0xf bank_mask:0xf
  v_dot2c_f32_bf16_dpp v14, v4, v71 row_newbcast:13 row_mask:0xf bank_mask:0xf
  v_dot2c_f32_bf16_dpp v15, v5, v71 row_newbcast:13 row_mask:0xf bank_mask:0xf
  v_dot2c_f32_bf16_dpp v8, v4, v72 row_newbcast:3 row_mask:0xf bank_mask:0xf
  v_dot2c_f32_bf16_dpp v9, v5, v72 row_newbcast:3 row_mask:0xf bank_mask:0xf
  v_dot2c_f32_bf16_dpp v10, v4, v73 row_newbcast:3 row_mask:0xf bank_mask:0xf
  v_dot2c_f32_bf16_dpp v11, v5, v73 row_newbcast:3 row_mask:0xf bank_mask:0xf
  v_dot2c_f32_bf16_dpp v12, v4, v74 row_newbcast:3 row_mask:0xf bank_mask:0xf
  v_dot2c_f32_bf16_dpp v13, v5, v74 row_newbcast:3 row_mask:0xf bank_mask:0xf
  v_dot2c_f32_bf16_dpp v14, v4, v75 row_newbcast:3 row_mask:0xf bank_mask:0xf
  v_dot2c_f32_bf16_dpp v15, v5, v75 row_newbcast:3 row_mask:0xf bank_mask:0xf
  v_dot2c_f32_bf16_dpp v8, v4, v76 row_newbcast:11 row_mask:0xf bank_mask:0xf
  v_dot2c_f32_bf16_dpp v9, v5, v76 row_newbcast:11 row_mask:0xf bank_mask:0xf
  v_dot2c_f32_bf16_dpp v10, v4, v77 row_newbcast:11 row_mask:0xf bank_mask:0xf
  v_dot2c_f32_bf16_dpp v11, v5, v77 row_newbcast:11 row_mask:0xf bank_mask:0xf
  v_dot2c_f32_bf16_dpp v12, v4, v78 row_newbcast:11 row_mask:0xf bank_mask:0xf
  v_dot2c_f32_bf16_dpp v13, v5, v78 row_newbcast:11 row_mask:0xf bank_mask:0xf
  v_dot2c_f32_bf16_dpp v14, v4, v79 row_newbcast:11 row_mask:0xf bank_mask:0xf
  v_dot2c_f32_bf16_dpp v15, v5, v79 row_newbcast:11 row_mask:0xf bank_mask:0xf
  s_waitcnt vmcnt(2)
  buffer_load_dwordx4 v[108:111], v2, s[48:51], s12 offen nt
  s_add_u32 s12, s12, s19
  s_bitset0_b32 s12, 15
  s_cmp_ge_u32 s12, s59
  s_cselect_b32 s12, s58, s12
  v_dot2c_f32_bf16_dpp v8, v4, v80 row_newbcast:7 row_mask:0xf bank_mask:0xf
  v_dot2c_f32_bf16_dpp v9, v5, v80 row_newbcast:7 row_mask:0xf bank_mask:0xf
  v_dot2c_f32_bf16_dpp v10, v4, v81 row_newbcast:7 row_mask:0xf bank_mask:0xf
  v_dot2c_f32_bf16_dpp v11, v5, v81 row_newbcast:7 row_mask:0xf bank_mask:0xf
  v_dot2c_f32_bf16_dpp v12, v4, v82 row_newbcast:7 row_mask:0xf bank_mask:0xf
  v_dot2c_f32_bf16_dpp v13, v5, v82 row_newbcast:7 row_mask:0xf bank_mask:0xf
  v_dot2c_f32_bf16_dpp v14, v4, v83 row_newbcast:7 row_mask:0xf bank_mask:0xf
  v_dot2c_f32_bf16_dpp v15, v5, v83 row_newbcast:7 row_mask:0xf bank_mask:0xf
  v_dot2c_f32_bf16_dpp v8, v4, v84 row_newbcast:15 row_mask:0xf bank_mask:0xf
  v_dot2c_f32_bf16_dpp v9, v5, v84 row_newbcast:15 row_mask:0xf bank_mask:0xf
  v_dot2c_f32_bf16_dpp v10, v4, v85 row_newbcast:15 row_mask:0xf bank_mask:0xf
  v_dot2c_f32_bf16_dpp v11, v5, v85 row_newbcast:15 row_mask:0xf bank_mask:0xf
  v_dot2c_f32_bf16_dpp v12, v4, v86 row_newbcast:15 row_mask:0xf bank_mask:0xf
  v_dot2c_f32_bf16_dpp v13, v5, v86 row_newbcast:15 row_mask:0xf bank_mask:0xf
  v_dot2c_f32_bf16_dpp v14, v4, v87 row_newbcast:15 row_mask:0xf bank_mask:0xf
  v_dot2c_f32_bf16_dpp v15, v5, v87 row_newbcast:15 row_mask:0xf bank_mask:0xf
  v_dot2c_f32_bf16_dpp v8, v6, v88 row_newbcast:0 row_mask:0xf bank_mask:0xf
  v_dot2c_f32_bf16_dpp v9, v7, v88 row_newbcast:0 row_mask:0xf bank_mask:0xf
  v_dot2c_f32_bf16_dpp v10, v6, v89 row_newbcast:0 row_mask:0xf bank_mask:0xf
  v_dot2c_f32_bf16_dpp v11, v7, v89 row_newbcast:0 row_mask:0xf bank_mask:0xf
  v_dot2c_f32_bf16_dpp v12, v6, v90 row_newbcast:0 row_mask:0xf bank_mask:0xf
  v_dot2c_f32_bf16_dpp v13, v7, v90 row_newbcast:0 row_mask:0xf bank_mask:0xf
  v_dot2c_f32_bf16_dpp v14, v6, v91 row_newbcast:0 row_mask:0xf bank_mask:0xf
  v_dot2c_f32_bf16_dpp v15, v7, v91 row_newbcast:0 row_mask:0xf bank_mask:0xf
  s_waitcnt vmcnt(2)
  s_bitcmp0_b32 s68, 0
  s_cbranch_scc1 L_th_25
  s_waitcnt vmcnt(1)
L_th_25:
  buffer_load_dwordx4 v[112:115], v2, s[48:51], s12 offen nt
  s_add_u32 s12, s12, s19
  s_bitset0_b32 s12, 15
  s_cmp_ge_u32 s12, s59
  s_cselect_b32 s12, s58, s12
  v_dot2c_f32_bf16_dpp v8, v6, v92 row_newbcast:8 row_mask:0xf bank_mask:0xf
  v_dot2c_f32_bf16_dpp v9, v7, v92 row_newbcast:8 row_mask:0xf bank_mask:0xf
  v_dot2c_f32_bf16_dpp v10, v6, v93 row_newbcast:8 row_mask:0xf bank_mask:0xf
  v_dot2c_f32_bf16_dpp v11, v7, v93 row_newbcast:8 row_mask:0xf bank_mask:0xf
  v_dot2c_f32_bf16_dpp v12, v6, v94 row_newbcast:8 row_mask:0xf bank_mask:0xf
  v_dot2c_f32_bf16_dpp v13, v7, v94 row_newbcast:8 row_mask:0xf bank_mask:0xf
  v_dot2c_f32_bf16_dpp v14, v6, v95 row_newbcast:8 row_mask:0xf bank_mask:0xf
  v_dot2c_f32_bf16_dpp v15, v7, v95 row_newbcast:8 row_mask:0xf bank_mask:0xf
  v_dot2c_f32_bf16_dpp v8, v6, v96 row_newbcast:4 row_mask:0xf bank_mask:0xf
  v_dot2c_f32_bf16_dpp v9, v7, v96 row_newbcast:4 row_mask:0xf bank_mask:0xf
  v_dot2c_f32_bf16_dpp v10, v6, v97 row_newbcast:4 row_mask:0xf bank_mask:0xf
  v_dot2c_f32_bf16_dpp v11, v7, v97 row_newbcast:4 row_mask:0xf bank_mask:0xf
  v_dot2c_f32_bf16_dpp v12, v6, v98 row_newbcast:4 row_mask:0xf bank_mask:0xf
  v_dot2c_f32_bf16_dpp v13, v7, v98 row_newbcast:4 row_mask:0xf bank_mask:0xf
  v_dot2c_f32_bf16_dpp v14, v6, v99 row_newbcast:4 row_mask:0xf bank_mask:0xf
  v_dot2c_f32_bf16_dpp v15, v7, v99 row_newbcast:4 row_mask:0xf bank_mask:0xf
  s_cmp_gt_u32 s60, 7
  s_cbranch_scc1 L_opt_26
  v_dot2c_f32_bf16_dpp v8, v4, v52 row_newbcast:14 row_mask:0xf bank_mask:0xf
  v_dot2c_f32_bf16_dpp v9, v5, v52 row_newbcast:14 row_mask:0xf bank_mask:0xf
  v_dot2c_f32_bf16_dpp v10, v4, v53 row_newbcast:14 row_mask:0xf bank_mask:0xf
  v_dot2c_f32_bf16_dpp v11, v5, v53 row_newbcast:14 row_mask:0xf bank_mask:0xf
  v_dot2c_f32_bf16_dpp v12, v4, v54 row_newbcast:14 row_mask:0xf bank_mask:0xf
  v_dot2c_f32_bf16_dpp v13, v5, v54 row_newbcast:14 row_mask:0xf bank_mask:0xf
  v_dot2c_f32_bf16_dpp v14, v4, v55 row_newbcast:14 row_mask:0xf bank_mask:0xf
  v_dot2c_f32_bf16_dpp v15, v5, v55 row_newbcast:14 row_mask:0xf bank_mask:0xf
L_opt_26:
  s_waitcnt vmcnt(2)
  buffer_load_dwordx4 v[116:119], v2, s[48:51], s12 offen nt
  s_add_u32 s12, s12, s19
  s_bitset0_b32 s12, 15
  s_cmp_ge_u32 s12, s59
  s_cselect_b32 s12, s58, s12
  s_cmp_gt_u32 s60, 6
  s_cbranch_scc1 L_opt_27
  v_dot2c_f32_bf16_dpp v8, v4, v48 row_newbcast:6 row_mask:0xf bank_mask:0xf
  v_dot2c_f32_bf16_dpp v9, v5, v48 row_newbcast:6 row_mask:0xf bank_mask:0xf
  v_dot2c_f32_bf16_dpp v10, v4, v49 row_newbcast:6 row_mask:0xf bank_mask:0xf
  v_dot2c_f32_bf16_dpp v11, v5, v49 row_newbcast:6 row_mask:0xf bank_mask:0xf
  v_dot2c_f32_bf16_dpp v12, v4, v50 row_newbcast:6 row_mask:0xf bank_mask:0xf
  v_dot2c_f32_bf16_dpp v13, v5, v50 row_newbcast:6 row_mask:0xf bank_mask:0xf
  v_dot2c_f32_bf16_dpp v14, v4, v51 row_newbcast:6 row_mask:0xf bank_mask:0xf
  v_dot2c_f32_bf16_dpp v15, v5, v51 row_newbcast:6 row_mask:0xf bank_mask:0xf
L_opt_27:
  s_cmp_gt_u32 s60, 5
  s_cbranch_scc1 L_opt_28
  v_dot2c_f32_bf16_dpp v8, v4, v44 row_newbcast:10 row_mask:0xf bank_mask:0xf
  v_dot2c_f32_bf16_dpp v9, v5, v44 row_newbcast:10 row_mask:0xf bank_mask:0xf
  v_dot2c_f32_bf16_dpp v10, v4, v45 row_newbcast:10 row_mask:0xf bank_mask:0xf
  v_dot2c_f32_bf16_dpp v11, v5, v45 row_newbcast:10 row_mask:0xf bank_mask:0xf
  v_dot2c_f32_bf16_dpp v12, v4, v46 row_newbcast:10 row_mask:0xf bank_mask:0xf
  v_dot2c_f32_bf16_dpp v13, v5, v46 row_newbcast:10 row_mask:0xf bank_mask:0xf
  v_dot2c_f32_bf16_dpp v14, v4, v47 row_newbcast:10 row_mask:0xf bank_mask:0xf
  v_dot2c_f32_bf16_dpp v15, v5, v47 row_newbcast:10 row_mask:0xf bank_mask:0xf
L_opt_28:
  s_cmp_gt_u32 s60, 4
  s_cbranch_scc1 L_opt_29
  v_dot2c_f32_bf16_dpp v8, v4, v40 row_newbcast:2 row_mask:0xf bank_mask:0xf
  v_dot2c_f32_bf16_dpp v9, v5, v40 row_newbcast:2 row_mask:0xf bank_mask:0xf
  v_dot2c_f32_bf16_dpp v10, v4, v41 row_newbcast:2 row_mask:0xf bank_mask:0xf
  v_dot2c_f32_bf16_dpp v11, v5, v41 row_newbcast:2 row_mask:0xf bank_mask:0xf
  v_dot2c_f32_bf16_dpp v12, v4, v42 row_newbcast:2 row_mask:0xf bank_mask:0xf
  v_dot2c_f32_bf16_dpp v13, v5, v42 row_newbcast:2 row_mask:0xf bank_mask:0xf
  v_dot2c_f32_bf16_dpp v14, v4, v43 row_newbcast:2 row_mask:0xf bank_mask:0xf
  v_dot2c_f32_bf16_dpp v15, v5, v43 row_newbcast:2 row_mask:0xf bank_mask:0xf
L_opt_29:
  s_waitcnt vmcnt(2)
  buffer_load_dwordx4 v[120:123], v2, s[48:51], s12 offen nt
  s_add_u32 s12, s12, s19
  s_bitset0_b32 s12, 15
  s_cmp_ge_u32 s12, s59
  s_cselect_b32 s12, s58, s12
  ds_write_b32 v16, v16 offset:20
  s_cmp_gt_u32 s60, 3
  s_cbranch_scc1 L_opt_30
  v_dot2c_f32_bf16_dpp v8, v4, v36 row_newbcast:12 row_mask:0xf bank_mask:0xf
  v_dot2c_f32_bf16_dpp v9, v5, v36 row_newbcast:12 row_mask:0xf bank_mask:0xf
  v_dot2c_f32_bf16_dpp v10, v4, v37 row_newbcast:12 row_mask:0xf bank_mask:0xf
  v_dot2c_f32_bf16_dpp v11, v5, v37 row_newbcast:12 row_mask:0xf bank_mask:0xf
  v_dot2c_f32_bf16_dpp v12, v4, v38 row_newbcast:12 row_mask:0xf bank_mask:0xf
  v_dot2c_f32_bf16_dpp v13, v5, v38 row_newbcast:12 row_mask:0xf bank_mask:0xf
  v_dot2c_f32_bf16_dpp v14, v4, v39 row_newbcast:12 row_mask:0xf bank_mask:0xf
  v_dot2c_f32_bf16_dpp v15, v5, v39 row_newbcast:12 row_mask:0xf bank_mask:0xf
L_opt_30:
  s_cmp_gt_u32 s60, 2
  s_cbranch_scc1 L_opt_31
  v_dot2c_f32_bf16_dpp v8, v4, v32 row_newbcast:4 row_mask:0xf bank_mask:0xf
  v_dot2c_f32_bf16_dpp v9, v5, v32 row_newbcast:4 row_mask:0xf bank_mask:0xf
  v_dot2c_f32_bf16_dpp v10, v4, v33 row_newbcast:4 row_mask:0xf bank_mask:0xf
  v_dot2c_f32_bf16_dpp v11, v5, v33 row_newbcast:4 row_mask:0xf bank_mask:0xf
  v_dot2c_f32_bf16_dpp v12, v4, v34 row_newbcast:4 row_mask:0xf bank_mask:0xf
  v_dot2c_f32_bf16_dpp v13, v5, v34 row_newbcast:4 row_mask:0xf bank_mask:0xf
  v_dot2c_f32_bf16_dpp v14, v4, v35 row_newbcast:4 row_mask:0xf bank_mask:0xf
  v_dot2c_f32_bf16_dpp v15, v5, v35 row_newbcast:4 row_mask:0xf bank_mask:0xf
L_opt_31:
  s_cmp_gt_u32 s60, 1
  s_cbranch_scc1 L_opt_32
  v_dot2c_f32_bf16_dpp v8, v4, v28 row_newbcast:8 row_mask:0xf bank_mask:0xf
  v_dot2c_f32_bf16_dpp v9, v5, v28 row_newbcast:8 row_mask:0xf bank_mask:0xf
  v_dot2c_f32_bf16_dpp v10, v4, v29 row_newbcast:8 row_mask:0xf bank_mask:0xf
  v_dot2c_f32_bf16_dpp v11, v5, v29 row_newbcast:8 row_mask:0xf bank_mask:0xf
  v_dot2c_f32_bf16_dpp v12, v4, v30 row_newbcast:8 row_mask:0xf bank_mask:0xf
  v_dot2c_f32_bf16_dpp v13, v5, v30 row_newbcast:8 row_mask:0xf bank_mask:0xf
  v_dot2c_f32_bf16_dpp v14, v4, v31 row_newbcast:8 row_mask:0xf bank_mask:0xf
  v_dot2c_f32_bf16_dpp v15, v5, v31 row_newbcast:8 row_mask:0xf bank_mask:0xf
L_opt_32:
  s_waitcnt vmcnt(2)
  s_bitcmp0_b32 s68, 0
  s_cbranch_scc1 L_th_33
  s_waitcnt vmcnt(1)
L_th_33:
  buffer_load_dwordx4 v[124:127], v2, s[48:51], s12 offen nt
  s_add_u32 s12, s12, s19
  s_bitset0_b32 s12, 15
  s_cmp_ge_u32 s12, s59
  s_cselect_b32 s12, s58, s12
  s_cmp_gt_u32 s60, 0
  s_cbranch_scc1 L_opt_34
  v_dot2c_f32_bf16_dpp v8, v4, v24 row_newbcast:0 row_mask:0xf bank_mask:0xf
  v_dot2c_f32_bf16_dpp v9, v5, v24 row_newbcast:0 row_mask:0xf bank_mask:0xf
  v_dot2c_f32_bf16_dpp v10, v4, v25 row_newbcast:0 row_mask:0xf bank_mask:0xf
  v_dot2c_f32_bf16_dpp v11, v5, v25 row_newbcast:0 row_mask:0xf bank_mask:0xf
  v_dot2c_f32_bf16_dpp v12, v4, v26 row_newbcast:0 row_mask:0xf bank_mask:0xf
  v_dot2c_f32_bf16_dpp v13, v5, v26 row_newbcast:0 row_mask:0xf bank_mask:0xf
  v_dot2c_f32_bf16_dpp v14, v4, v27 row_newbcast:0 row_mask:0xf bank_mask:0xf
  v_dot2c_f32_bf16_dpp v15, v5, v27 row_newbcast:0 row_mask:0xf bank_mask:0xf
L_opt_34:
  v_dot2c_f32_bf16_dpp v8, v6, v100 row_newbcast:12 row_mask:0xf bank_mask:0xf
  v_dot2c_f32_bf16_dpp v9, v7, v100 row_newbcast:12 row_mask:0xf bank_mask:0xf
  v_dot2c_f32_bf16_dpp v10, v6, v101 row_newbcast:12 row_mask:0xf bank_mask:0xf
  v_dot2c_f32_bf16_dpp v11, v7, v101 row_newbcast:12 row_mask:0xf bank_mask:0xf
  v_dot2c_f32_bf16_dpp v12, v6, v102 row_newbcast:12 row_mask:0xf bank_mask:0xf
  v_dot2c_f32_bf16_dpp v13, v7, v102 row_newbcast:12 row_mask:0xf bank_mask:0xf
  v_dot2c_f32_bf16_dpp v14, v6, v103 row_newbcast:12 row_mask:0xf bank_mask:0xf
  v_dot2c_f32_bf16_dpp v15, v7, v103 row_newbcast:12 row_mask:0xf bank_mask:0xf
  v_dot2c_f32_bf16_dpp v8, v6, v104 row_newbcast:2 row_mask:0xf bank_mask:0xf
  v_dot2c_f32_bf16_dpp v9, v7, v104 row_newbcast:2 row_mask:0xf bank_mask:0xf
  v_dot2c_f32_bf16_dpp v10, v6, v105 row_newbcast:2 row_mask:0xf bank_mask:0xf
  v_dot2c_f32_bf16_dpp v11, v7, v105 row_newbcast:2 row_mask:0xf bank_mask:0xf
  v_dot2c_f32_bf16_dpp v12, v6, v106 row_newbcast:2 row_mask:0xf bank_mask:0xf
  v_dot2c_f32_bf16_dpp v13, v7, v106 row_newbcast:2 row_mask:0xf bank_mask:0xf
  v_dot2c_f32_bf16_dpp v14, v6, v107 row_newbcast:2 row_mask:0xf bank_mask:0xf
  v_dot2c_f32_bf16_dpp v15, v7, v107 row_newbcast:2 row_mask:0xf bank_mask:0xf
  s_waitcnt vmcnt(2)
  buffer_load_dwordx4 v[128:131], v2, s[48:51], s12 offen nt
  s_add_u32 s12, s12, s19
  s_bitset0_b32 s12, 15
  s_cmp_ge_u32 s12, s59
  s_cselect_b32 s12, s58, s12
  v_dot2c_f32_bf16_dpp v8, v6, v108 row_newbcast:10 row_mask:0xf bank_mask:0xf
  v_dot2c_f32_bf16_dpp v9, v7, v108 row_newbcast:10 row_mask:0xf bank_mask:0xf
  v_dot2c_f32_bf16_dpp v10, v6, v109 row_newbcast:10 row_mask:0xf bank_mask:0xf
  v_dot2c_f32_bf16_dpp v11, v7, v109 row_newbcast:10 row_mask:0xf bank_mask:0xf
  v_dot2c_f32_bf16_dpp v12, v6, v110 row_newbcast:10 row_mask:0xf bank_mask:0xf
  v_dot2c_f32_bf16_dpp v13, v7, v110 row_newbcast:10 row_mask:0xf bank_mask:0xf
  v_dot2c_f32_bf16_dpp v14, v6, v111 row_newbcast:10 row_mask:0xf bank_mask:0xf
  v_dot2c_f32_bf16_dpp v15, v7, v111 row_newbcast:10 row_mask:0xf bank_mask:0xf
  v_dot2c_f32_bf16_dpp v8, v6, v112 row_newbcast:6 row_mask:0xf bank_mask:0xf
  v_dot2c_f32_bf16_dpp v9, v7, v112 row_newbcast:6 row_mask:0xf bank_mask:0xf
  v_dot2c_f32_bf16_dpp v10, v6, v113 row_newbcast:6 row_mask:0xf bank_mask:0xf
  v_dot2c_f32_bf16_dpp v11, v7, v113 row_newbcast:6 row_mask:0xf bank_mask:0xf
  v_dot2c_f32_bf16_dpp v12, v6, v114 row_newbcast:6 row_mask:0xf bank_mask:0xf
  v_dot2c_f32_bf16_dpp v13, v7, v114 row_newbcast:6 row_mask:0xf bank_mask:0xf
  v_dot2c_f32_bf16_dpp v14, v6, v115 row_newbcast:6 row_mask:0xf bank_mask:0xf
  v_dot2c_f32_bf16_dpp v15, v7, v115 row_newbcast:6 row_mask:0xf bank_mask:0xf
  v_dot2c_f32_bf16_dpp v8, v6, v116 row_newbcast:14 row_mask:0xf bank_mask:0xf
  v_dot2c_f32_bf16_dpp v9, v7, v116 row_newbcast:14 row_mask:0xf bank_mask:0xf
  v_dot2c_f32_bf16_dpp v10, v6, v117 row_newbcast:14 row_mask:0xf bank_mask:0xf
  v_dot2c_f32_bf16_dpp v11, v7, v117 row_newbcast:14 row_mask:0xf bank_mask:0xf
  v_dot2c_f32_bf16_dpp v12, v6, v118 row_newbcast:14 row_mask:0xf bank_mask:0xf
  v_dot2c_f32_bf16_dpp v13, v7, v118 row_newbcast:14 row_mask:0xf bank_mask:0xf
  v_dot2c_f32_bf16_dpp v14, v6, v119 row_newbcast:14 row_mask:0xf bank_mask:0xf
  v_dot2c_f32_bf16_dpp v15, v7, v119 row_newbcast:14 row_mask:0xf bank_mask:0xf
  s_waitcnt vmcnt(2)
  buffer_load_dwordx4 v[132:135], v2, s[48:51], s12 offen nt
  s_add_u32 s12, s12, s19
  s_bitset0_b32 s12, 15
  s_cmp_ge_u32 s12, s59
  s_cselect_b32 s12, s58, s12
  v_dot2c_f32_bf16_dpp v8, v6, v120 row_newbcast:1 row_mask:0xf bank_mask:0xf
  v_dot2c_f32_bf16_dpp v9, v7, v120 row_newbcast:1 row_mask:0xf bank_mask:0xf
  v_dot2c_f32_bf16_dpp v10, v6, v121 row_newbcast:1 row_mask:0xf bank_mask:0xf
  v_dot2c_f32_bf16_dpp v11, v7, v121 row_newbcast:1 row_mask:0xf bank_mask:0xf
  v_dot2c_f32_bf16_dpp v12, v6, v122 row_newbcast:1 row_mask:0xf bank_mask:0xf
  v_dot2c_f32_bf16_dpp v13, v7, v122 row_newbcast:1 row_mask:0xf bank_mask:0xf
  v_dot2c_f32_bf16_dpp v14, v6, v123 row_newbcast:1 row_mask:0xf bank_mask:0xf
  v_dot2c_f32_bf16_dpp v15, v7, v123 row_newbcast:1 row_mask:0xf bank_mask:0xf
  s_waitcnt vmcnt(2)
  s_bitcmp0_b32 s68, 0
  s_cbranch_scc1 L_th_35
  s_waitcnt vmcnt(1)
L_th_35:
  buffer_load_dwordx4 v[136:139], v2, s[48:51], s12 offen nt
  s_add_u32 s12, s12, s19
  s_bitset0_b32 s12, 15
  s_cmp_ge_u32 s12, s59
  s_cselect_b32 s12, s58, s12
  v_dot2c_f32_bf16_dpp v8, v6, v124 row_newbcast:9 row_mask:0xf bank_mask:0xf
  v_dot2c_f32_bf16_dpp v9, v7, v124 row_newbcast:9 row_mask:0xf bank_mask:0xf
  v_dot2c_f32_bf16_dpp v10, v6, v125 row_newbcast:9 row_mask:0xf bank_mask:0xf
  v_dot2c_f32_bf16_dpp v11, v7, v125 row_newbcast:9 row_mask:0xf bank_mask:0xf
  v_dot2c_f32_bf16_dpp v12, v6, v126 row_newbcast:9 row_mask:0xf bank_mask:0xf
  v_dot2c_f32_bf16_dpp v13, v7, v126 row_newbcast:9 row_mask:0xf bank_mask:0xf
  v_dot2c_f32_bf16_dpp v14, v6, v127 row_newbcast:9 row_mask:0xf bank_mask:0xf
  v_dot2c_f32_bf16_dpp v15, v7, v127 row_newbcast:9 row_mask:0xf bank_mask:0xf
  s_waitcnt vmcnt(2)
  buffer_load_dwordx4 v[140:143], v2, s[48:51], s12 offen nt
  s_add_u32 s12, s12, s19
  s_bitset0_b32 s12, 15
  s_cmp_ge_u32 s12, s59
  s_cselect_b32 s12, s58, s12
  v_dot2c_f32_bf16_dpp v8, v6, v128 row_newbcast:5 row_mask:0xf bank_mask:0xf
  v_dot2c_f32_bf16_dpp v9, v7, v128 row_newbcast:5 row_mask:0xf bank_mask:0xf
  v_dot2c_f32_bf16_dpp v10, v6, v129 row_newbcast:5 row_mask:0xf bank_mask:0xf
  v_dot2c_f32_bf16_dpp v11, v7, v129 row_newbcast:5 row_mask:0xf bank_mask:0xf
  v_dot2c_f32_bf16_dpp v12, v6, v130 row_newbcast:5 row_mask:0xf bank_mask:0xf
  v_dot2c_f32_bf16_dpp v13, v7, v130 row_newbcast:5 row_mask:0xf bank_mask:0xf
  v_dot2c_f32_bf16_dpp v14, v6, v131 row_newbcast:5 row_mask:0xf bank_mask:0xf
  v_dot2c_f32_bf16_dpp v15, v7, v131 row_newbcast:5 row_mask:0xf bank_mask:0xf
  s_waitcnt vmcnt(2)
  buffer_load_dwordx4 v[144:147], v2, s[48:51], s12 offen nt
  s_add_u32 s12, s12, s19
  s_bitset0_b32 s12, 15
  s_cmp_ge_u32 s12, s59
  s_cselect_b32 s12, s58, s12
  v_dot2c_f32_bf16_dpp v8, v6, v132 row_newbcast:13 row_mask:0xf bank_mask:0xf
  v_dot2c_f32_bf16_dpp v9, v7, v132 row_newbcast:13 row_mask:0xf bank_mask:0xf
  v_dot2c_f32_bf16_dpp v10, v6, v133 row_newbcast:13 row_mask:0xf bank_mask:0xf
  v_dot2c_f32_bf16_dpp v11, v7, v133 row_newbcast:13 row_mask:0xf bank_mask:0xf
  v_dot2c_f32_bf16_dpp v12, v6, v134 row_newbcast:13 row_mask:0xf bank_mask:0xf
  v_dot2c_f32_bf16_dpp v13, v7, v134 row_newbcast:13 row_mask:0xf bank_mask:0xf
  v_dot2c_f32_bf16_dpp v14, v6, v135 row_newbcast:13 row_mask:0xf bank_mask:0xf
  v_dot2c_f32_bf16_dpp v15, v7, v135 row_newbcast:13 row_mask:0xf bank_mask:0xf
  buffer_load_dwordx4 v[148:151], v2, s[48:51], s12 offen nt
  s_add_u32 s12, s12, s19
  s_bitset0_b32 s12, 15
  s_cmp_ge_u32 s12, s59
  s_cselect_b32 s12, s58, s12
  buffer_load_dwordx4 v[152:155], v2, s[48:51], s12 offen nt
  s_add_u32 s12, s12, s19
  s_bitset0_b32 s12, 15
  s_cmp_ge_u32 s12, s59
  s_cselect_b32 s12, s58, s12
  buffer_load_dwordx4 v[156:159], v2, s[48:51], s12 offen nt
  s_add_u32 s12, s12, s19
  s_bitset0_b32 s12, 15
  s_cmp_ge_u32 s12, s59
  s_cselect_b32 s12, s58, s12
  buffer_load_dwordx4 v[160:163], v2, s[48:51], s12 offen nt
  s_add_u32 s12, s12, s19
  s_bitset0_b32 s12, 15
  s_cmp_ge_u32 s12, s59
  s_cselect_b32 s12, s58, s12
  buffer_load_dwordx4 v[164:167], v2, s[48:51], s12 offen nt
  s_mov_b32 s70, 0
L_pl_36:
  ds_read_b32 v18, v16
  s_waitcnt lgkmcnt(0)
  v_cmp_eq_u32 vcc, -1, v18
  s_cmp_eq_u64 vcc, 0
  s_cbranch_scc1 L_pld_37
  s_sleep 2
  s_add_u32 s70, s70, 1
  s_cmp_lt_u32 s70, 1048576
  s_cbranch_scc1 L_pl_36
L_pld_37:
  v_sub_f32 v22, v22, v18
  v_mul_f32 v22, 0x3fb8aa3b, v22
  v_exp_f32 v22, v22
  ds_read_b64 v[18:19], v16 offset:32
  s_lshl_b32 s56, s6, 2
  s_add_u32 s56, s56, s7
  s_lshl_b32 s57, s56, 9
  s_add_u32 s57, s57, 131072
  v_lshl_add_u32 v2, v1, 3, s57
  v_and_b32 v17, 1, v1
  v_lshlrev_b32 v17, 4, v17
  v_lshlrev_b32 v1, 3, v1
  v_mov_b32 v0, 1
  s_movk_i32 s56, 0xff
  s_waitcnt lgkmcnt(0)
  v_readfirstlane_b32 s75, v19
  v_lshrrev_b32 v18, v17, v18
  v_lshrrev_b32 v19, 8, v18
  s_waitcnt vmcnt(7)
  v_dot2c_f32_bf16_dpp v8, v6, v136 row_newbcast:3 row_mask:0xf bank_mask:0xf
  v_dot2c_f32_bf16_dpp v9, v7, v136 row_newbcast:3 row_mask:0xf bank_mask:0xf
  v_dot2c_f32_bf16_dpp v10, v6, v137 row_newbcast:3 row_mask:0xf bank_mask:0xf
  v_dot2c_f32_bf16_dpp v11, v7, v137 row_newbcast:3 row_mask:0xf bank_mask:0xf
  v_dot2c_f32_bf16_dpp v12, v6, v138 row_newbcast:3 row_mask:0xf bank_mask:0xf
  v_dot2c_f32_bf16_dpp v13, v7, v138 row_newbcast:3 row_mask:0xf bank_mask:0xf
  v_dot2c_f32_bf16_dpp v14, v6, v139 row_newbcast:3 row_mask:0xf bank_mask:0xf
  v_dot2c_f32_bf16_dpp v15, v7, v139 row_newbcast:3 row_mask:0xf bank_mask:0xf
  s_waitcnt vmcnt(6)
  v_dot2c_f32_bf16_dpp v8, v6, v140 row_newbcast:11 row_mask:0xf bank_mask:0xf
  v_dot2c_f32_bf16_dpp v9, v7, v140 row_newbcast:11 row_mask:0xf bank_mask:0xf
  v_dot2c_f32_bf16_dpp v10, v6, v141 row_newbcast:11 row_mask:0xf bank_mask:0xf
  v_dot2c_f32_bf16_dpp v11, v7, v141 row_newbcast:11 row_mask:0xf bank_mask:0xf
  v_dot2c_f32_bf16_dpp v12, v6, v142 row_newbcast:11 row_mask:0xf bank_mask:0xf
  v_dot2c_f32_bf16_dpp v13, v7, v142 row_newbcast:11 row_mask:0xf bank_mask:0xf
  v_dot2c_f32_bf16_dpp v14, v6, v143 row_newbcast:11 row_mask:0xf bank_mask:0xf
  v_dot2c_f32_bf16_dpp v15, v7, v143 row_newbcast:11 row_mask:0xf bank_mask:0xf
  s_waitcnt vmcnt(5)
  v_dot2c_f32_bf16_dpp v8, v6, v144 row_newbcast:7 row_mask:0xf bank_mask:0xf
  v_dot2c_f32_bf16_dpp v9, v7, v144 row_newbcast:7 row_mask:0xf bank_mask:0xf
  v_dot2c_f32_bf16_dpp v10, v6, v145 row_newbcast:7 row_mask:0xf bank_mask:0xf
  v_dot2c_f32_bf16_dpp v11, v7, v145 row_newbcast:7 row_mask:0xf bank_mask:0xf
  v_dot2c_f32_bf16_dpp v12, v6, v146 row_newbcast:7 row_mask:0xf bank_mask:0xf
  v_dot2c_f32_bf16_dpp v13, v7, v146 row_newbcast:7 row_mask:0xf bank_mask:0xf
  v_dot2c_f32_bf16_dpp v14, v6, v147 row_newbcast:7 row_mask:0xf bank_mask:0xf
  v_dot2c_f32_bf16_dpp v15, v7, v147 row_newbcast:7 row_mask:0xf bank_mask:0xf
  s_waitcnt vmcnt(4)
  v_dot2c_f32_bf16_dpp v8, v6, v148 row_newbcast:15 row_mask:0xf bank_mask:0xf
  v_dot2c_f32_bf16_dpp v9, v7, v148 row_newbcast:15 row_mask:0xf bank_mask:0xf
  v_dot2c_f32_bf16_dpp v10, v6, v149 row_newbcast:15 row_mask:0xf bank_mask:0xf
  v_dot2c_f32_bf16_dpp v11, v7, v149 row_newbcast:15 row_mask:0xf bank_mask:0xf
  v_dot2c_f32_bf16_dpp v12, v6, v150 row_newbcast:15 row_mask:0xf bank_mask:0xf
  v_dot2c_f32_bf16_dpp v13, v7, v150 row_newbcast:15 row_mask:0xf bank_mask:0xf
  v_dot2c_f32_bf16_dpp v14, v6, v151 row_newbcast:15 row_mask:0xf bank_mask:0xf
  v_dot2c_f32_bf16_dpp v15, v7, v151 row_newbcast:15 row_mask:0xf bank_mask:0xf
  s_waitcnt vmcnt(3)
  v_dot2c_f32_bf16_dpp v8, v20, v152 row_newbcast:0 row_mask:0xf bank_mask:0xf
  v_dot2c_f32_bf16_dpp v9, v21, v152 row_newbcast:0 row_mask:0xf bank_mask:0xf
  v_dot2c_f32_bf16_dpp v10, v20, v153 row_newbcast:0 row_mask:0xf bank_mask:0xf
  v_dot2c_f32_bf16_dpp v11, v21, v153 row_newbcast:0 row_mask:0xf bank_mask:0xf
  v_dot2c_f32_bf16_dpp v12, v20, v154 row_newbcast:0 row_mask:0xf bank_mask:0xf
  v_dot2c_f32_bf16_dpp v13, v21, v154 row_newbcast:0 row_mask:0xf bank_mask:0xf
  v_dot2c_f32_bf16_dpp v14, v20, v155 row_newbcast:0 row_mask:0xf bank_mask:0xf
  v_dot2c_f32_bf16_dpp v15, v21, v155 row_newbcast:0 row_mask:0xf bank_mask:0xf
  s_waitcnt vmcnt(2)
  v_dot2c_f32_bf16_dpp v8, v20, v156 row_newbcast:8 row_mask:0xf bank_mask:0xf
  v_dot2c_f32_bf16_dpp v9, v21, v156 row_newbcast:8 row_mask:0xf bank_mask:0xf
  v_dot2c_f32_bf16_dpp v10, v20, v157 row_newbcast:8 row_mask:0xf bank_mask:0xf
  v_dot2c_f32_bf16_dpp v11, v21, v157 row_newbcast:8 row_mask:0xf bank_mask:0xf
  v_dot2c_f32_bf16_dpp v12, v20, v158 row_newbcast:8 row_mask:0xf bank_mask:0xf
  v_dot2c_f32_bf16_dpp v13, v21, v158 row_newbcast:8 row_mask:0xf bank_mask:0xf
  v_dot2c_f32_bf16_dpp v14, v20, v159 row_newbcast:8 row_mask:0xf bank_mask:0xf
  v_dot2c_f32_bf16_dpp v15, v21, v159 row_newbcast:8 row_mask:0xf bank_mask:0xf
  s_waitcnt vmcnt(1)
  v_dot2c_f32_bf16_dpp v8, v20, v160 row_newbcast:4 row_mask:0xf bank_mask:0xf
  v_dot2c_f32_bf16_dpp v9, v21, v160 row_newbcast:4 row_mask:0xf bank_mask:0xf
  v_dot2c_f32_bf16_dpp v10, v20, v161 row_newbcast:4 row_mask:0xf bank_mask:0xf
  v_dot2c_f32_bf16_dpp v11, v21, v161 row_newbcast:4 row_mask:0xf bank_mask:0xf
  v_dot2c_f32_bf16_dpp v12, v20, v162 row_newbcast:4 row_mask:0xf bank_mask:0xf
  v_dot2c_f32_bf16_dpp v13, v21, v162 row_newbcast:4 row_mask:0xf bank_mask:0xf
  v_dot2c_f32_bf16_dpp v14, v20, v163 row_newbcast:4 row_mask:0xf bank_mask:0xf
  v_dot2c_f32_bf16_dpp v15, v21, v163 row_newbcast:4 row_mask:0xf bank_mask:0xf
  s_waitcnt vmcnt(0)
  v_dot2c_f32_bf16_dpp v8, v20, v164 row_newbcast:12 row_mask:0xf bank_mask:0xf
  v_dot2c_f32_bf16_dpp v9, v21, v164 row_newbcast:12 row_mask:0xf bank_mask:0xf
  v_dot2c_f32_bf16_dpp v10, v20, v165 row_newbcast:12 row_mask:0xf bank_mask:0xf
  v_dot2c_f32_bf16_dpp v11, v21, v165 row_newbcast:12 row_mask:0xf bank_mask:0xf
  v_dot2c_f32_bf16_dpp v12, v20, v166 row_newbcast:12 row_mask:0xf bank_mask:0xf
  v_dot2c_f32_bf16_dpp v13, v21, v166 row_newbcast:12 row_mask:0xf bank_mask:0xf
  v_dot2c_f32_bf16_dpp v14, v20, v167 row_newbcast:12 row_mask:0xf bank_mask:0xf
  v_dot2c_f32_bf16_dpp v15, v21, v167 row_newbcast:12 row_mask:0xf bank_mask:0xf
  s_nop 2
  v_permlane32_swap_b32 v8, v12
  v_permlane32_swap_b32 v9, v13
  v_permlane32_swap_b32 v10, v14
  v_permlane32_swap_b32 v11, v15
  v_add_f32 v8, v8, v12
  v_add_f32 v9, v9, v13
  v_add_f32 v10, v10, v14
  v_add_f32 v11, v11, v15
  s_nop 0
  v_permlane16_swap_b32 v8, v10
  v_permlane16_swap_b32 v9, v11
  v_add_f32 v8, v8, v10
  v_add_f32 v9, v9, v11
  v_mul_f32 v8, v8, v22
  v_mul_f32 v9, v9, v22
  ds_write_b64 v3, v[8:9] offset:6912
  s_mov_b64 exec, 1
  ds_add_rtn_u32 v17, v16, v0 offset:68
  s_mov_b64 exec, -1
  ds_read_b64 v[56:57], v1 offset:6912
  ds_read_b64 v[58:59], v1 offset:7424
  ds_read_b64 v[60:61], v1 offset:7936
  ds_read_b64 v[62:63], v1 offset:8448
  ds_read_b64 v[64:65], v1 offset:8960
  ds_read_b64 v[66:67], v1 offset:9472
  ds_read_b64 v[68:69], v1 offset:9984
  ds_read_b64 v[70:71], v1 offset:10496
  s_waitcnt lgkmcnt(6)
  v_readfirstlane_b32 s57, v17
  v_pk_add_f32 v[56:57], v[56:57], v[58:59]
  s_waitcnt lgkmcnt(4)
  v_pk_add_f32 v[60:61], v[60:61], v[62:63]
  s_waitcnt lgkmcnt(2)
  v_pk_add_f32 v[64:65], v[64:65], v[66:67]
  s_waitcnt lgkmcnt(0)
  v_pk_add_f32 v[68:69], v[68:69], v[70:71]
  v_pk_add_f32 v[56:57], v[56:57], v[60:61]
  v_pk_add_f32 v[64:65], v[64:65], v[68:69]
  s_cmp_lg_u32 s57, 7
  v_pk_add_f32 v[56:57], v[56:57], v[64:65]
  v_bfi_b32 v18, s56, v18, v56
  v_bfi_b32 v19, s56, v19, v57
  s_cbranch_scc1 L_send
  s_cmp_eq_u32 s75, 1
  s_cbranch_scc0 L_pf_38
  global_store_dwordx2 v2, v[18:19], s[42:43]
  s_branch L_pe_39
L_pf_38:
  global_store_dwordx2 v2, v[18:19], s[42:43] sc1
L_pe_39:
L_send:
  s_barrier
  s_endpgm
L_helper:
  v_mov_b32 v4, -1
  v_mov_b32 v5, -1
  v_mov_b32 v6, -1
  v_mov_b32 v7, -1
  v_lshlrev_b32 v2, 4, v0
  ds_write_b128 v2, v[4:7] offset:12032
  ds_write_b128 v2, v[4:7] offset:16128
  v_lshlrev_b32 v2, 2, v1
  ds_write_b32 v2, v4 offset:6400
  v_mov_b32 v38, 0
  ds_write_b128 v38, v[4:7] offset:6656
  ds_write_b128 v38, v[4:7] offset:6672
  v_mov_b32 v39, 0
  ds_write_b64 v38, v[38:39] offset:6720
  ds_write_b32 v38, v38 offset:6728
  s_waitcnt lgkmcnt(0)
  s_barrier
  s_getpc_b64 s[56:57]
L_pc2:
  s_lshl_b32 s3, s2, 2
  s_add_u32 s3, s3, L_table-L_pc2
  s_load_dwordx16 s[16:31], s[0:1], 0
  s_load_dword s14, s[56:57], s3
  s_load_dwordx8 s[32:39], s[0:1], 64
  s_load_dwordx4 s[40:43], s[0:1], 96
  s_and_b32 s8, s2, 7
  s_mov_b64 s[100:101], s[56:57]
  s_mov_b32 s72, 0xfffffffe
  s_mov_b32 s73, 0xffff0000
  s_getreg_b32 s76, hwreg(HW_REG_XCC_ID, 0, 4)
  v_lshrrev_b32 v12, 3, v0
  v_lshlrev_b32 v12, 5, v12
  v_bfe_u32 v3, v1, 2, 1
  v_lshl_add_u32 v12, v3, 10, v12
  v_and_b32 v8, 3, v1
  v_lshl_add_u32 v13, v8, 3, v12
  v_and_b32 v12, 0xffffffdf, v12
  v_lshl_add_u32 v12, v8, 4, v12
  v_bfe_u32 v8, v1, 3, 1
  v_lshl_add_u32 v12, v8, 3, v12
  v_lshl_add_u32 v12, v3, 5, v12
  s_waitcnt lgkmcnt(0)
  s_load_dword s74, s[42:43], 0
  s_and_b32 s13, s14, 7
  s_bfe_u32 s61, s14, 0x60003
  s_cmp_eq_u32 s13, 6
  s_cbranch_scc1 L_r_q
  s_cmp_ge_u32 s13, 4
  s_cbranch_scc1 L_r_moda
  s_cmp_eq_u32 s13, 1
  s_cbranch_scc1 L_r_wo
  s_lshr_b32 s48, s14, 30
  s_cmp_eq_u32 s48, 0
  s_cbranch_scc1 L_noas
  s_bfe_u32 s49, s14, 0x1001a
  s_lshl_b32 s49, s49, 2
  s_add_u32 s49, s49, s5
  s_lshl_b32 s50, s49, 6
  s_lshr_b32 s51, s49, 1
  s_lshl_b32 s51, s51, 4
  s_and_b32 s49, s49, 1
  s_add_u32 s51, s51, s49
  s_lshl_b32 s49, s8, 1
  s_add_u32 s51, s51, s49
  s_lshl_b32 s51, s51, 6
  s_movk_i32 s52, 6144
  s_mov_b64 s[54:55], s[36:37]
  s_cmp_eq_u32 s48, 1
  s_cselect_b32 s52, 0x2000, s52
  s_cselect_b64 s[54:55], s[22:23], s[54:55]
  s_cmp_eq_u32 s48, 2
  s_cselect_b32 s52, 0x400, s52
  s_cselect_b64 s[54:55], s[24:25], s[54:55]
  s_cselect_b32 s50, s51, s50
  s_bfe_u32 s49, s14, 0x3001b
  s_lshl_b32 s49, s49, 10
  s_add_u32 s49, s49, 384
  v_max_u32 v2, 24, v1
  v_add_u32 v2, s50, v2
  v_mul_u32_u24 v2, s52, v2
  v_add_u32 v2, s49, v2
  global_load_dword v167, v2, s[54:55]
L_noas:
  s_cmp_eq_u32 s13, 2
  s_cbranch_scc1 L_r_f1
  s_cmp_eq_u32 s13, 3
  s_cbranch_scc1 L_r_f2
  s_branch L_r_none
L_r_moda:
  s_lshl_b32 s58, s61, 9
  s_add_u32 s58, s58, 4096
  global_load_dwordx2 v[14:15], v13, s[34:35]
  s_waitcnt lgkmcnt(0)
  s_mul_i32 s74, s74, 0x9e3779b1
  s_add_u32 s74, s74, 0x7f4a7c15
  s_add_u32 s76, s76, s74
  s_waitcnt vmcnt(0)
  v_lshlrev_b32 v16, 16, v14
  v_and_b32 v17, s73, v14
  v_lshlrev_b32 v18, 16, v15
  v_and_b32 v19, s73, v15
  v_mul_f32 v20, 0xbfb8aa3b, v16
  v_mul_f32 v21, 0xbfb8aa3b, v17
  v_mul_f32 v22, 0xbfb8aa3b, v18
  v_mul_f32 v23, 0xbfb8aa3b, v19
  v_exp_f32 v20, v20
  v_exp_f32 v21, v21
  v_exp_f32 v22, v22
  v_exp_f32 v23, v23
  s_nop 0
  v_add_f32 v20, 1.0, v20
  v_add_f32 v21, 1.0, v21
  v_add_f32 v22, 1.0, v22
  v_add_f32 v23, 1.0, v23
  v_rcp_f32 v20, v20
  v_rcp_f32 v21, v21
  v_rcp_f32 v22, v22
  v_rcp_f32 v23, v23
  s_nop 0
  v_mul_f32 v16, v16, v20
  v_mul_f32 v17, v17, v21
  v_mul_f32 v18, v18, v22
  v_mul_f32 v19, v19, v23
  v_cvt_pk_bf16_f32 v14, v16, v17
  v_cvt_pk_bf16_f32 v15, v18, v19
  ds_write_b64 v12, v[14:15] offset:0
  v_and_b32 v13, 1, v1
  v_lshlrev_b32 v13, 6, v13
  v_lshrrev_b32 v3, 4, v1
  v_lshl_add_u32 v13, v3, 4, v13
  s_lshl_b32 s49, s5, 7
  s_add_u32 s49, s49, s58
  v_add_u32 v13, s49, v13
  v_and_b32 v14, 1, v1
  v_mul_u32_u24 v14, 1056, v14
  v_lshrrev_b32 v3, 4, v1
  v_lshl_add_u32 v14, v3, 4, v14
  v_lshrrev_b32 v2, 2, v1
  v_bfe_u32 v3, v1, 1, 1
  s_lshl_b32 s49, s5, 1
  v_or_b32 v3, s49, v3
  v_and_b32 v10, 6, v2
  v_xor_b32 v3, v3, v10
  v_lshlrev_b32 v2, 7, v2
  v_lshl_add_u32 v2, v3, 4, v2
  v_and_b32 v3, 1, v1
  v_lshl_add_u32 v2, v3, 3, v2
  v_add_u32 v2, 20480, v2
  s_waitcnt lgkmcnt(0)
  v_mov_b32 v9, 1
  s_mov_b64 exec, 1
  ds_add_u32 v38, v9 offset:6720
  s_mov_b64 exec, -1
  s_mov_b32 s70, 0
L_hs_40:
  ds_read_b32 v9, v38 offset:6720
  s_waitcnt lgkmcnt(0)
  v_cmp_gt_u32 vcc, 12, v9
  s_cmp_eq_u64 vcc, 0
  s_cbranch_scc1 L_hsd_41
  s_sleep 2
  s_add_u32 s70, s70, 1
  s_cmp_lt_u32 s70, 2097152
  s_cbranch_scc1 L_hs_40
L_hsd_41:
  ds_read_b64_tr_b16 v[40:41], v2 offset:0
  ds_read_b64_tr_b16 v[42:43], v2 offset:2048
  ds_read_b128 v[104:107], v14 offset:0
  ds_read_b64_tr_b16 v[44:45], v2 offset:4096
  ds_read_b64_tr_b16 v[46:47], v2 offset:6144
  ds_read_b128 v[108:111], v14 offset:64
  ds_read_b64_tr_b16 v[48:49], v2 offset:8192
  ds_read_b64_tr_b16 v[50:51], v2 offset:10240
  ds_read_b128 v[112:115], v14 offset:128
  ds_read_b64_tr_b16 v[52:53], v2 offset:12288
  ds_read_b64_tr_b16 v[54:55], v2 offset:14336
  ds_read_b128 v[116:119], v14 offset:192
  ds_read_b64_tr_b16 v[56:57], v2 offset:16384
  ds_read_b64_tr_b16 v[58:59], v2 offset:18432
  ds_read_b128 v[120:123], v14 offset:256
  s_waitcnt lgkmcnt(12)
  v_mfma_f32_16x16x32_bf16 v[8:11], v[40:43], v[104:107], 0
  ds_read_b64_tr_b16 v[60:61], v2 offset:20480
  ds_read_b64_tr_b16 v[62:63], v2 offset:22528
  ds_read_b128 v[124:127], v14 offset:320
  s_waitcnt lgkmcnt(12)
  v_mfma_f32_16x16x32_bf16 v[8:11], v[44:47], v[108:111], v[8:11]
  ds_read_b64_tr_b16 v[64:65], v2 offset:24576
  ds_read_b64_tr_b16 v[66:67], v2 offset:26624
  ds_read_b128 v[128:131], v14 offset:384
  s_waitcnt lgkmcnt(12)
  v_mfma_f32_16x16x32_bf16 v[8:11], v[48:51], v[112:115], v[8:11]
  ds_read_b64_tr_b16 v[68:69], v2 offset:28672
  ds_read_b64_tr_b16 v[70:71], v2 offset:30720
  ds_read_b128 v[132:135], v14 offset:448
  s_waitcnt lgkmcnt(12)
  v_mfma_f32_16x16x32_bf16 v[8:11], v[52:55], v[116:119], v[8:11]
  ds_read_b64_tr_b16 v[72:73], v2 offset:32768
  ds_read_b64_tr_b16 v[74:75], v2 offset:34816
  ds_read_b128 v[136:139], v14 offset:512
  s_waitcnt lgkmcnt(12)
  v_mfma_f32_16x16x32_bf16 v[8:11], v[56:59], v[120:123], v[8:11]
  ds_read_b64_tr_b16 v[76:77], v2 offset:36864
  ds_read_b64_tr_b16 v[78:79], v2 offset:38912
  ds_read_b128 v[140:143], v14 offset:576
  s_waitcnt lgkmcnt(12)
  v_mfma_f32_16x16x32_bf16 v[8:11], v[60:63], v[124:127], v[8:11]
  ds_read_b64_tr_b16 v[80:81], v2 offset:40960
  ds_read_b64_tr_b16 v[82:83], v2 offset:43008
  ds_read_b128 v[144:147], v14 offset:640
  s_waitcnt lgkmcnt(12)
  v_mfma_f32_16x16x32_bf16 v[8:11], v[64:67], v[128:131], v[8:11]
  ds_read_b64_tr_b16 v[84:85], v2 offset:45056
  ds_read_b64_tr_b16 v[86:87], v2 offset:47104
  ds_read_b128 v[148:151], v14 offset:704
  s_waitcnt lgkmcnt(12)
  v_mfma_f32_16x16x32_bf16 v[8:11], v[68:71], v[132:135], v[8:11]
  ds_read_b64_tr_b16 v[88:89], v2 offset:49152
  ds_read_b64_tr_b16 v[90:91], v2 offset:51200
  ds_read_b128 v[152:155], v14 offset:768
  s_waitcnt lgkmcnt(12)
  v_mfma_f32_16x16x32_bf16 v[8:11], v[72:75], v[136:139], v[8:11]
  ds_read_b64_tr_b16 v[92:93], v2 offset:53248
  ds_read_b64_tr_b16 v[94:95], v2 offset:55296
  ds_read_b128 v[156:159], v14 offset:832
  s_waitcnt lgkmcnt(12)
  v_mfma_f32_16x16x32_bf16 v[8:11], v[76:79], v[140:143], v[8:11]
  ds_read_b64_tr_b16 v[96:97], v2 offset:57344
  ds_read_b64_tr_b16 v[98:99], v2 offset:59392
  ds_read_b128 v[160:163], v14 offset:896
  s_waitcnt lgkmcnt(12)
  v_mfma_f32_16x16x32_bf16 v[8:11], v[80:83], v[144:147], v[8:11]
  ds_read_b64_tr_b16 v[100:101], v2 offset:61440
  ds_read_b64_tr_b16 v[102:103], v2 offset:63488
  ds_read_b128 v[164:167], v14 offset:960
  s_waitcnt lgkmcnt(12)
  v_mfma_f32_16x16x32_bf16 v[8:11], v[84:87], v[148:151], v[8:11]
  s_waitcnt lgkmcnt(9)
  v_mfma_f32_16x16x32_bf16 v[8:11], v[88:91], v[152:155], v[8:11]
  s_waitcnt lgkmcnt(6)
  v_mfma_f32_16x16x32_bf16 v[8:11], v[92:95], v[156:159], v[8:11]
  s_waitcnt lgkmcnt(3)
  v_mfma_f32_16x16x32_bf16 v[8:11], v[96:99], v[160:163], v[8:11]
  s_waitcnt lgkmcnt(0)
  v_mfma_f32_16x16x32_bf16 v[8:11], v[100:103], v[164:167], v[8:11]
  s_nop 7
  v_cvt_pk_bf16_f32 v8, v8, v9
  v_cvt_pk_bf16_f32 v10, v10, v11
  v_mov_b32 v9, s74
  v_mov_b32 v11, s74
  s_mov_b32 exec_lo, 0x00030003
  s_mov_b32 exec_hi, 0x00030003
  global_store_dwordx4 v13, v[8:11], s[42:43] sc1
L_sk1:
  s_mov_b64 exec, -1
  s_mov_b32 s60, 0
  s_branch L_svc1
L_r_q:
  s_lshl_b32 s58, s61, 9
  s_add_u32 s58, s58, 32768
  global_load_dwordx2 v[14:15], v13, s[16:17]
  s_waitcnt lgkmcnt(0)
  s_mul_i32 s74, s74, 0x9e3779b1
  s_add_u32 s74, s74, 0x7f4a7c15
  s_add_u32 s76, s76, s74
  s_waitcnt vmcnt(0)
  v_bfe_u32 v6, v1, 2, 1
  v_lshlrev_b32 v6, 5, v6
  v_add_u32 v6, 11008, v6
  s_lshl_b32 s49, s5, 3
  v_add_u32 v5, s49, v6
  v_lshlrev_b32 v20, 16, v14
  v_and_b32 v21, s73, v14
  v_lshlrev_b32 v22, 16, v15
  v_and_b32 v23, s73, v15
  v_add_f32 v8, v20, v21
  v_mul_f32 v9, v20, v20
  v_add_f32 v10, v22, v23
  v_mul_f32 v11, v22, v22
  v_fmac_f32 v9, v21, v21
  v_fmac_f32 v11, v23, v23
  v_add_f32 v8, v8, v10
  v_add_f32 v9, v9, v11
  s_nop 0
  v_add_f32_dpp v8, v8, v8 quad_perm:[1,0,3,2] row_mask:0xf bank_mask:0xf
  v_add_f32_dpp v9, v9, v9 quad_perm:[1,0,3,2] row_mask:0xf bank_mask:0xf
  s_nop 0
  v_add_f32_dpp v8, v8, v8 quad_perm:[2,3,0,1] row_mask:0xf bank_mask:0xf
  v_add_f32_dpp v9, v9, v9 quad_perm:[2,3,0,1] row_mask:0xf bank_mask:0xf
  s_nop 0
  v_add_f32_dpp v8, v8, v8 row_ror:8 row_mask:0xf bank_mask:0xf
  v_add_f32_dpp v9, v9, v9 row_ror:8 row_mask:0xf bank_mask:0xf
  s_nop 0
  v_mov_b32 v10, v8
  v_mov_b32 v11, v9
  s_nop 0
  v_permlane16_swap_b32 v10, v8
  v_permlane16_swap_b32 v11, v9
  v_add_f32 v8, v8, v10
  v_add_f32 v9, v9, v11
  v_mov_b32 v10, v8
  v_mov_b32 v11, v9
  s_nop 0
  v_permlane32_swap_b32 v10, v8
  v_permlane32_swap_b32 v11, v9
  v_add_f32 v8, v8, v10
  v_add_f32 v9, v9, v11
  ds_write_b64 v5, v[8:9]
  s_waitcnt lgkmcnt(0)
  v_mov_b32 v9, 1
  s_mov_b64 exec, 1
  ds_add_u32 v38, v9 offset:6720
  s_mov_b64 exec, -1
  s_mov_b32 s70, 0
L_hs_42:
  ds_read_b32 v9, v38 offset:6720
  s_waitcnt lgkmcnt(0)
  v_cmp_gt_u32 vcc, 12, v9
  s_cmp_eq_u64 vcc, 0
  s_cbranch_scc1 L_hsd_43
  s_sleep 4
  s_add_u32 s70, s70, 1
  s_cmp_lt_u32 s70, 2097152
  s_cbranch_scc1 L_hs_42
L_hsd_43:
  ds_read_b128 v[24:27], v6
  ds_read_b128 v[28:31], v6 offset:16
  s_waitcnt lgkmcnt(0)
  v_pk_add_f32 v[24:25], v[24:25], v[26:27]
  v_pk_add_f32 v[28:29], v[28:29], v[30:31]
  v_pk_add_f32 v[24:25], v[24:25], v[28:29]
  v_mul_f32 v8, 0x3b000000, v24
  v_mul_f32 v9, 0x3b000000, v25
  v_fma_f32 v9, -v8, v8, v9
  v_cvt_pk_bf16_f32 v8, 0, v8
  v_max_f32 v9, 0, v9
  v_cvt_pk_bf16_f32 v9, 0, v9
  v_sub_f32 v20, v20, v8
  v_sub_f32 v21, v21, v8
  v_add_f32 v9, 0x3727c5ac, v9
  v_sub_f32 v22, v22, v8
  v_sub_f32 v23, v23, v8
  v_cvt_pk_bf16_f32 v9, 0, v9
  v_cvt_pk_bf16_f32 v20, 0, v20
  v_sqrt_f32 v9, v9
  v_cvt_pk_bf16_f32 v21, 0, v21
  v_cvt_pk_bf16_f32 v9, 0, v9
  v_cvt_pk_bf16_f32 v22, 0, v22
  v_rcp_f32 v9, v9
  v_cvt_pk_bf16_f32 v23, 0, v23
  v_mul_f32 v20, v20, v9
  v_mul_f32 v21, v21, v9
  v_mul_f32 v22, v22, v9
  v_mul_f32 v23, v23, v9
  v_cvt_pk_bf16_f32 v20, 0, v20
  v_cvt_pk_bf16_f32 v21, 0, v21
  v_cvt_pk_bf16_f32 v22, 0, v22
  v_cvt_pk_bf16_f32 v23, 0, v23
  v_lshrrev_b32 v2, 2, v1
  v_bfe_u32 v3, v1, 1, 1
  s_lshl_b32 s49, s5, 1
  v_or_b32 v3, s49, v3
  v_and_b32 v10, 6, v2
  v_xor_b32 v3, v3, v10
  v_lshlrev_b32 v2, 7, v2
  v_lshl_add_u32 v2, v3, 4, v2
  v_and_b32 v3, 1, v1
  v_lshl_add_u32 v2, v3, 3, v2
  v_add_u32 v2, 20480, v2
  ds_read_b64_tr_b16 v[40:41], v2 offset:0
  ds_read_b64_tr_b16 v[42:43], v2 offset:2048
  ds_read_b64_tr_b16 v[44:45], v2 offset:4096
  ds_read_b64_tr_b16 v[46:47], v2 offset:6144
  ds_read_b64_tr_b16 v[48:49], v2 offset:8192
  ds_read_b64_tr_b16 v[50:51], v2 offset:10240
  ds_read_b64_tr_b16 v[52:53], v2 offset:12288
  ds_read_b64_tr_b16 v[54:55], v2 offset:14336
  ds_read_b64_tr_b16 v[56:57], v2 offset:16384
  ds_read_b64_tr_b16 v[58:59], v2 offset:18432
  ds_read_b64_tr_b16 v[60:61], v2 offset:20480
  ds_read_b64_tr_b16 v[62:63], v2 offset:22528
  s_waitcnt lgkmcnt(10)
  ds_read_b64_tr_b16 v[64:65], v2 offset:24576
  ds_read_b64_tr_b16 v[66:67], v2 offset:26624
  s_waitcnt lgkmcnt(10)
  ds_read_b64_tr_b16 v[68:69], v2 offset:28672
  ds_read_b64_tr_b16 v[70:71], v2 offset:30720
  s_waitcnt lgkmcnt(10)
  ds_read_b64_tr_b16 v[72:73], v2 offset:32768
  ds_read_b64_tr_b16 v[74:75], v2 offset:34816
  s_waitcnt lgkmcnt(10)
  ds_read_b64_tr_b16 v[76:77], v2 offset:36864
  ds_read_b64_tr_b16 v[78:79], v2 offset:38912
  s_waitcnt lgkmcnt(10)
  ds_read_b64_tr_b16 v[80:81], v2 offset:40960
  ds_read_b64_tr_b16 v[82:83], v2 offset:43008
  s_waitcnt lgkmcnt(10)
  ds_read_b64_tr_b16 v[84:85], v2 offset:45056
  ds_read_b64_tr_b16 v[86:87], v2 offset:47104
  s_waitcnt lgkmcnt(10)
  ds_read_b64_tr_b16 v[88:89], v2 offset:49152
  ds_read_b64_tr_b16 v[90:91], v2 offset:51200
  s_waitcnt lgkmcnt(10)
  ds_read_b64_tr_b16 v[92:93], v2 offset:53248
  ds_read_b64_tr_b16 v[94:95], v2 offset:55296
  s_waitcnt lgkmcnt(10)
  ds_read_b64_tr_b16 v[96:97], v2 offset:57344
  ds_read_b64_tr_b16 v[98:99], v2 offset:59392
  s_waitcnt lgkmcnt(10)
  ds_read_b64_tr_b16 v[100:101], v2 offset:61440
  ds_read_b64_tr_b16 v[102:103], v2 offset:63488
  s_waitcnt lgkmcnt(10)
  s_waitcnt lgkmcnt(0)
  v_and_b32 v13, 1, v1
  v_lshlrev_b32 v13, 6, v13
  v_lshrrev_b32 v3, 4, v1
  v_lshl_add_u32 v13, v3, 4, v13
  s_lshl_b32 s49, s5, 7
  s_add_u32 s49, s49, s58
  v_add_u32 v13, s49, v13
  v_and_b32 v14, 1, v1
  v_mul_u32_u24 v14, 1056, v14
  v_lshrrev_b32 v3, 4, v1
  v_lshl_add_u32 v14, v3, 4, v14
  v_lshlrev_b32 v15, 4, v0
  v_add_u32 v15, 4096, v15
  v_add_u32 v36, 0x1000, v15
  s_mov_b32 s70, 0
L_pl_44:
  ds_read_b32 v8, v38 offset:6672
  s_waitcnt lgkmcnt(0)
  v_cmp_eq_u32 vcc, -1, v8
  s_cmp_eq_u64 vcc, 0
  s_cbranch_scc1 L_pld_45
  s_sleep 8
  s_add_u32 s70, s70, 1
  s_cmp_lt_u32 s70, 1048576
  s_cbranch_scc1 L_pl_44
L_pld_45:
  s_mov_b64 s[64:65], -1
  s_mov_b64 s[66:67], -1
  s_mov_b32 s70, 0
L_q_p:
  s_mov_b64 exec, s[64:65]
  global_load_dwordx4 v[16:19], v15, s[42:43] sc1
  s_mov_b64 exec, s[66:67]
  global_load_dwordx4 v[32:35], v36, s[42:43] sc1
  s_mov_b64 exec, -1
  s_waitcnt vmcnt(0)
  v_cmp_ne_u32 s[64:65], s74, v17
  v_cmp_ne_u32 s[68:69], s74, v19
  s_or_b64 s[64:65], s[64:65], s[68:69]
  v_cmp_ne_u32 s[66:67], s74, v33
  v_cmp_ne_u32 s[68:69], s74, v35
  s_or_b64 s[66:67], s[66:67], s[68:69]
  s_or_b64 vcc, s[64:65], s[66:67]
  s_cmp_eq_u64 vcc, 0
  s_cbranch_scc1 L_q_ok
  s_add_u32 s70, s70, 1
  s_cmp_lt_u32 s70, 262144
  s_cbranch_scc1 L_q_p
L_q_ok:
  v_lshlrev_b32 v28, 16, v32
  v_and_b32 v29, s73, v32
  v_lshlrev_b32 v30, 16, v34
  v_and_b32 v31, s73, v34
  v_lshlrev_b32 v24, 16, v16
  v_and_b32 v25, s73, v16
  v_lshlrev_b32 v26, 16, v18
  v_and_b32 v27, s73, v18
  v_add_f32 v28, 1.0, v28
  v_add_f32 v29, 1.0, v29
  v_add_f32 v30, 1.0, v30
  v_add_f32 v31, 1.0, v31
  v_cvt_pk_bf16_f32 v28, 0, v28
  v_cvt_pk_bf16_f32 v29, 0, v29
  v_cvt_pk_bf16_f32 v30, 0, v30
  v_cvt_pk_bf16_f32 v31, 0, v31
  v_mul_f32 v20, v20, v28
  v_mul_f32 v21, v21, v29
  v_mul_f32 v22, v22, v30
  v_mul_f32 v23, v23, v31
  v_cvt_pk_bf16_f32 v20, 0, v20
  v_cvt_pk_bf16_f32 v21, 0, v21
  v_cvt_pk_bf16_f32 v22, 0, v22
  v_cvt_pk_bf16_f32 v23, 0, v23
  v_add_f32 v20, v20, v24
  v_add_f32 v21, v21, v25
  v_add_f32 v22, v22, v26
  v_add_f32 v23, v23, v27
  v_cvt_pk_bf16_f32 v16, v20, v21
  v_cvt_pk_bf16_f32 v17, v22, v23
  ds_write_b64 v12, v[16:17] offset:0
  v_mov_b32 v9, 1
  s_mov_b64 exec, 1
  ds_add_u32 v38, v9 offset:6720
  s_mov_b64 exec, -1
  s_mov_b32 s70, 0
L_hs_46:
  ds_read_b32 v9, v38 offset:6720
  s_waitcnt lgkmcnt(0)
  v_cmp_gt_u32 vcc, 16, v9
  s_cmp_eq_u64 vcc, 0
  s_cbranch_scc1 L_hsd_47
  s_add_u32 s70, s70, 1
  s_cmp_lt_u32 s70, 2097152
  s_cbranch_scc1 L_hs_46
L_hsd_47:
  ds_read_b128 v[104:107], v14 offset:0
  ds_read_b128 v[108:111], v14 offset:64
  ds_read_b128 v[112:115], v14 offset:128
  ds_read_b128 v[116:119], v14 offset:192
  ds_read_b128 v[120:123], v14 offset:256
  ds_read_b128 v[124:127], v14 offset:320
  ds_read_b128 v[128:131], v14 offset:384
  ds_read_b128 v[132:135], v14 offset:448
  ds_read_b128 v[136:139], v14 offset:512
  ds_read_b128 v[140:143], v14 offset:576
  ds_read_b128 v[144:147], v14 offset:640
  ds_read_b128 v[148:151], v14 offset:704
  s_waitcnt lgkmcnt(11)
  v_mfma_f32_16x16x32_bf16 v[8:11], v[40:43], v[104:107], 0
  ds_read_b128 v[152:155], v14 offset:768
  s_waitcnt lgkmcnt(11)
  v_mfma_f32_16x16x32_bf16 v[8:11], v[44:47], v[108:111], v[8:11]
  ds_read_b128 v[156:159], v14 offset:832
  s_waitcnt lgkmcnt(11)
  v_mfma_f32_16x16x32_bf16 v[8:11], v[48:51], v[112:115], v[8:11]
  ds_read_b128 v[160:163], v14 offset:896
  s_waitcnt lgkmcnt(11)
  v_mfma_f32_16x16x32_bf16 v[8:11], v[52:55], v[116:119], v[8:11]
  ds_read_b128 v[164:167], v14 offset:960
  s_waitcnt lgkmcnt(11)
  v_mfma_f32_16x16x32_bf16 v[8:11], v[56:59], v[120:123], v[8:11]
  s_waitcnt lgkmcnt(10)
  v_mfma_f32_16x16x32_bf16 v[8:11], v[60:63], v[124:127], v[8:11]
  s_waitcnt lgkmcnt(9)
  v_mfma_f32_16x16x32_bf16 v[8:11], v[64:67], v[128:131], v[8:11]
  s_waitcnt lgkmcnt(8)
  v_mfma_f32_16x16x32_bf16 v[8:11], v[68:71], v[132:135], v[8:11]
  s_waitcnt lgkmcnt(7)
  v_mfma_f32_16x16x32_bf16 v[8:11], v[72:75], v[136:139], v[8:11]
  s_waitcnt lgkmcnt(6)
  v_mfma_f32_16x16x32_bf16 v[8:11], v[76:79], v[140:143], v[8:11]
  s_waitcnt lgkmcnt(5)
  v_mfma_f32_16x16x32_bf16 v[8:11], v[80:83], v[144:147], v[8:11]
  s_waitcnt lgkmcnt(4)
  v_mfma_f32_16x16x32_bf16 v[8:11], v[84:87], v[148:151], v[8:11]
  s_waitcnt lgkmcnt(3)
  v_mfma_f32_16x16x32_bf16 v[8:11], v[88:91], v[152:155], v[8:11]
  s_waitcnt lgkmcnt(2)
  v_mfma_f32_16x16x32_bf16 v[8:11], v[92:95], v[156:159], v[8:11]
  s_waitcnt lgkmcnt(1)
  v_mfma_f32_16x16x32_bf16 v[8:11], v[96:99], v[160:163], v[8:11]
  s_waitcnt lgkmcnt(0)
  v_mfma_f32_16x16x32_bf16 v[8:11], v[100:103], v[164:167], v[8:11]
  s_nop 7
  v_cvt_pk_bf16_f32 v8, v8, v9
  v_cvt_pk_bf16_f32 v10, v10, v11
  v_mov_b32 v9, s74
  v_mov_b32 v11, s74
  v_min_u32 v8, s72, v8
  v_min_u32 v10, s72, v10
  s_mov_b32 exec_lo, 0x00030003
  s_mov_b32 exec_hi, 0x00030003
  global_store_dwordx4 v13, v[8:11], s[42:43] sc1
  s_mov_b64 exec, -1
  s_mov_b32 s60, 0
  s_branch L_svc1
L_r_wo:
  s_and_b32 s66, s2, 7
  s_lshr_b32 s58, s66, 1
  s_lshl_b32 s58, s58, 14
  s_and_b32 s49, s66, 1
  s_lshl_b32 s49, s49, 12
  s_add_u32 s58, s58, s49
  s_lshl_b32 s49, s61, 9
  s_add_u32 s58, s58, s49
  s_add_u32 s58, s58, 327680
  s_waitcnt lgkmcnt(0)
  s_mul_i32 s74, s74, 0x9e3779b1
  s_add_u32 s74, s74, 0x7f4a7c15
  s_add_u32 s76, s76, s74
  s_cmp_lg_u32 s5, 3
  s_cbranch_scc1 L_nr_48
  s_lshl_b32 s49, s61, 14
  s_lshl_b32 s50, s8, 10
  s_add_u32 s49, s49, s50
  s_add_u32 s49, s49, 524288
  s_add_u32 s50, s49, 256
  s_mov_b32 s54, -1
  s_mov_b32 s55, -1
L_nrl_49:
  s_memtime s[64:65]
  s_waitcnt lgkmcnt(0)
  s_load_dword s51, s[42:43], s49
  s_waitcnt lgkmcnt(0)
  s_memtime s[68:69]
  s_waitcnt lgkmcnt(0)
  s_sub_u32 s68, s68, s64
  s_min_u32 s54, s54, s68
  s_xor_b32 s49, s49, 0x2000
  s_memtime s[64:65]
  s_waitcnt lgkmcnt(0)
  s_load_dword s51, s[42:43], s49
  s_waitcnt lgkmcnt(0)
  s_memtime s[68:69]
  s_waitcnt lgkmcnt(0)
  s_sub_u32 s68, s68, s64
  s_min_u32 s55, s55, s68
  s_xor_b32 s49, s49, 0x2000
  s_add_u32 s49, s49, 128
  s_cmp_lt_u32 s49, s50
  s_cbranch_scc1 L_nrl_49
  s_cmp_lt_u32 s55, s54
  s_cselect_b32 s54, 1, 0
  s_sub_u32 s55, s76, s74
  s_lshr_b32 s55, s55, 2
  s_xor_b32 s54, s54, s55
  s_and_b32 s54, s54, 1
  s_add_u32 s54, s54, s74
  s_lshl_b32 s55, s8, 3
  s_add_u32 s55, s55, s61
  s_lshl_b32 s55, s55, 5
  v_mov_b32 v8, s55
  v_mov_b32 v10, s76
  v_mov_b32 v11, s54
  s_mov_b64 exec, 1
  global_store_dwordx2 v8, v[10:11], s[42:43] offset:1024 sc1
  s_mov_b64 exec, -1
L_nr_48:
  s_mov_b32 s60, 1
  s_branch L_svc1
L_r_f1:
  s_lshl_b32 s48, s61, 6
  s_mul_i32 s49, s61, 47
  s_lshr_b32 s49, s49, 9
  s_mul_i32 s49, s49, 10752
  s_lshl_b32 s58, s61, 9
  s_add_u32 s58, s58, s49
  s_add_u32 s58, s58, 262144
  s_cmp_lt_u32 s5, 2
  s_cselect_b32 s44, s28, s30
  s_cselect_b32 s45, s29, s31
  s_mov_b32 s46, 1409024
  s_mov_b32 s47, 0x20000
  s_mov_b32 s60, 2
  s_waitcnt lgkmcnt(0)
  s_mul_i32 s74, s74, 0x9e3779b1
  s_add_u32 s74, s74, 0x7f4a7c15
  s_add_u32 s76, s76, s74
  s_branch L_svc1
L_r_f2:
  s_mov_b32 s44, s32
  s_mov_b32 s45, s33
  s_mov_b32 s46, 1409024
  s_mov_b32 s47, 0x20000
  s_waitcnt lgkmcnt(0)
  s_mul_i32 s74, s74, 0x9e3779b1
  s_add_u32 s74, s74, 0x7f4a7c15
  s_add_u32 s76, s76, s74
  s_mov_b32 s60, 3
  s_lshl_b32 s48, s61, 5
  global_load_dword v167, v38, s[38:39]
  s_branch L_svc1
L_r_none:
  s_mov_b32 s60, 0
  s_waitcnt lgkmcnt(0)
  s_mul_i32 s74, s74, 0x9e3779b1
  s_add_u32 s74, s74, 0x7f4a7c15
  s_add_u32 s76, s76, s74
L_svc1:
  s_cmp_lg_u32 s5, 0
  s_cbranch_scc1 L_disp3
  s_and_b32 s64, s6, 31
  s_lshl_b32 s64, s64, 10
  s_and_b32 s65, s6, 32
  s_lshl_b32 s65, s65, 1
  s_add_u32 s64, s64, s65
  s_add_u32 s64, s64, 32768
  v_bfe_u32 v16, v1, 2, 3
  v_lshl_add_u32 v16, v16, 7, s64
  v_and_b32 v17, 3, v1
  v_lshl_add_u32 v16, v17, 4, v16
  v_and_b32 v17, 31, v1
  v_lshlrev_b32 v17, 3, v17
  s_lshl_b32 s71, s8, 8
  v_and_b32 v18, 7, v1
  v_lshl_add_u32 v18, v18, 5, s71
  s_mov_b32 s70, 0
L_pl_50:
  ds_read_b32 v8, v38 offset:6664
  s_waitcnt lgkmcnt(0)
  v_cmp_eq_u32 vcc, -1, v8
  s_cmp_eq_u64 vcc, 0
  s_cbranch_scc1 L_pld_51
  s_sleep 8
  s_add_u32 s70, s70, 1
  s_cmp_lt_u32 s70, 1048576
  s_cbranch_scc1 L_pl_50
L_pld_51:
  global_load_dword v19, v18, s[42:43] offset:1024 sc1
  s_mov_b32 s70, 0
L_polt_52:
  global_load_dwordx4 v[20:23], v16, s[42:43] sc1
  s_waitcnt vmcnt(0)
  v_cmp_ne_u32 vcc, s74, v21
  v_cmp_ne_u32 s[68:69], s74, v23
  s_or_b64 vcc, vcc, s[68:69]
  s_cmp_eq_u64 vcc, 0
  s_cbranch_scc1 L_poltd_53
  s_add_u32 s70, s70, 1
  s_cmp_lt_u32 s70, 262144
  s_cbranch_scc1 L_polt_52
L_poltd_53:
  v_mov_b32 v21, v22
  ds_write_b64 v17, v[20:21] offset:6400
  v_cmp_ne_u32 vcc, s76, v19
  s_cmp_eq_u64 vcc, 0
  s_cselect_b32 s75, 1, 0
  v_mov_b32 v20, s74
  v_mov_b32 v21, s75
  ds_write_b64 v38, v[20:21] offset:6688
L_svc2:
  v_lshlrev_b32 v16, 4, v1
  s_lshl_b32 s64, s6, 9
  s_add_u32 s64, s64, 65536
  s_lshl_b32 s65, s7, 7
  s_add_u32 s65, s65, s64
  v_mov_b32 v18, s65
  s_mov_b32 s70, 0
L_pl_54:
  ds_read_b128 v[104:107], v16 offset:12032
  ds_read_b128 v[108:111], v16 offset:13056
  ds_read_b128 v[112:115], v16 offset:14080
  ds_read_b128 v[116:119], v16 offset:15104
  ds_read_b128 v[120:123], v16 offset:16128
  ds_read_b128 v[124:127], v16 offset:17152
  ds_read_b128 v[128:131], v16 offset:18176
  ds_read_b128 v[132:135], v16 offset:19200
  s_waitcnt lgkmcnt(0)
  v_max3_u32 v8, v104, v105, v106
  v_max3_u32 v8, v8, v108, v109
  v_max3_u32 v8, v8, v110, v112
  v_max3_u32 v8, v8, v113, v114
  v_max3_u32 v8, v8, v116, v117
  v_max3_u32 v8, v8, v118, v120
  v_max3_u32 v8, v8, v121, v122
  v_max3_u32 v8, v8, v124, v125
  v_max3_u32 v8, v8, v126, v128
  v_max3_u32 v8, v8, v129, v130
  v_max3_u32 v8, v8, v132, v133
  v_max_u32 v8, v8, v134
  v_cmp_eq_u32 vcc, -1, v8
  s_cmp_eq_u64 vcc, 0
  s_cbranch_scc1 L_pld_55
  s_sleep 4
  s_add_u32 s70, s70, 1
  s_cmp_lt_u32 s70, 1048576
  s_cbranch_scc1 L_pl_54
L_pld_55:
  v_max3_f32 v8, v104, v105, v106
  v_max3_f32 v8, v8, v108, v109
  v_max3_f32 v8, v8, v110, v112
  v_max3_f32 v8, v8, v113, v114
  v_max3_f32 v8, v8, v116, v117
  v_max3_f32 v8, v8, v118, v120
  v_max3_f32 v8, v8, v121, v122
  v_max3_f32 v8, v8, v124, v125
  v_max3_f32 v8, v8, v126, v128
  v_max3_f32 v8, v8, v129, v130
  v_max3_f32 v8, v8, v132, v133
  v_max_f32 v8, v8, v134
  s_nop 1
  v_max_f32_dpp v8, v8, v8 row_ror:8 row_mask:0xf bank_mask:0xf
  s_nop 1
  v_max_f32_dpp v8, v8, v8 row_ror:4 row_mask:0xf bank_mask:0xf
  s_nop 1
  v_max_f32_dpp v8, v8, v8 row_ror:2 row_mask:0xf bank_mask:0xf
  s_nop 1
  v_max_f32_dpp v8, v8, v8 row_ror:1 row_mask:0xf bank_mask:0xf
  v_mov_b32 v11, v8
  s_nop 1
  v_permlane16_swap_b32 v11, v8
  v_max_f32 v8, v8, v11
  v_mov_b32 v11, v8
  s_nop 1
  v_permlane32_swap_b32 v11, v8
  v_max_f32 v8, v8, v11
  v_min_u32 v9, s72, v8
  ds_write_b32 v38, v9 offset:6656
  v_sub_f32 v104, v104, v8
  v_sub_f32 v105, v105, v8
  v_sub_f32 v106, v106, v8
  v_sub_f32 v108, v108, v8
  v_sub_f32 v109, v109, v8
  v_sub_f32 v110, v110, v8
  v_sub_f32 v112, v112, v8
  v_sub_f32 v113, v113, v8
  v_sub_f32 v114, v114, v8
  v_sub_f32 v116, v116, v8
  v_sub_f32 v117, v117, v8
  v_sub_f32 v118, v118, v8
  v_sub_f32 v120, v120, v8
  v_sub_f32 v121, v121, v8
  v_sub_f32 v122, v122, v8
  v_sub_f32 v124, v124, v8
  v_sub_f32 v125, v125, v8
  v_sub_f32 v126, v126, v8
  v_sub_f32 v128, v128, v8
  v_sub_f32 v129, v129, v8
  v_sub_f32 v130, v130, v8
  v_sub_f32 v132, v132, v8
  v_sub_f32 v133, v133, v8
  v_sub_f32 v134, v134, v8
  v_mul_f32 v104, 0x3fb8aa3b, v104
  v_mul_f32 v105, 0x3fb8aa3b, v105
  v_mul_f32 v106, 0x3fb8aa3b, v106
  v_mul_f32 v108, 0x3fb8aa3b, v108
  v_mul_f32 v109, 0x3fb8aa3b, v109
  v_mul_f32 v110, 0x3fb8aa3b, v110
  v_mul_f32 v112, 0x3fb8aa3b, v112
  v_mul_f32 v113, 0x3fb8aa3b, v113
  v_mul_f32 v114, 0x3fb8aa3b, v114
  v_mul_f32 v116, 0x3fb8aa3b, v116
  v_mul_f32 v117, 0x3fb8aa3b, v117
  v_mul_f32 v118, 0x3fb8aa3b, v118
  v_mul_f32 v120, 0x3fb8aa3b, v120
  v_mul_f32 v121, 0x3fb8aa3b, v121
  v_mul_f32 v122, 0x3fb8aa3b, v122
  v_mul_f32 v124, 0x3fb8aa3b, v124
  v_mul_f32 v125, 0x3fb8aa3b, v125
  v_mul_f32 v126, 0x3fb8aa3b, v126
  v_mul_f32 v128, 0x3fb8aa3b, v128
  v_mul_f32 v129, 0x3fb8aa3b, v129
  v_mul_f32 v130, 0x3fb8aa3b, v130
  v_mul_f32 v132, 0x3fb8aa3b, v132
  v_mul_f32 v133, 0x3fb8aa3b, v133
  v_mul_f32 v134, 0x3fb8aa3b, v134
  v_exp_f32 v104, v104
  v_exp_f32 v105, v105
  v_exp_f32 v106, v106
  v_exp_f32 v108, v108
  v_exp_f32 v109, v109
  v_exp_f32 v110, v110
  v_exp_f32 v112, v112
  v_exp_f32 v113, v113
  v_exp_f32 v114, v114
  v_exp_f32 v116, v116
  v_exp_f32 v117, v117
  v_exp_f32 v118, v118
  v_exp_f32 v120, v120
  v_exp_f32 v121, v121
  v_exp_f32 v122, v122
  v_exp_f32 v124, v124
  v_exp_f32 v125, v125
  v_exp_f32 v126, v126
  v_exp_f32 v128, v128
  v_exp_f32 v129, v129
  v_exp_f32 v130, v130
  v_exp_f32 v132, v132
  v_exp_f32 v133, v133
  v_exp_f32 v134, v134
  s_nop 0
  v_add_f32 v104, v104, v120
  v_add_f32 v105, v105, v121
  v_add_f32 v106, v106, v122
  v_add_f32 v108, v108, v124
  v_add_f32 v109, v109, v125
  v_add_f32 v110, v110, v126
  v_add_f32 v112, v112, v128
  v_add_f32 v113, v113, v129
  v_add_f32 v114, v114, v130
  v_add_f32 v116, v116, v132
  v_add_f32 v117, v117, v133
  v_add_f32 v118, v118, v134
  v_add_f32 v104, v104, v112
  v_add_f32 v105, v105, v113
  v_add_f32 v106, v106, v114
  v_add_f32 v108, v108, v116
  v_add_f32 v109, v109, v117
  v_add_f32 v110, v110, v118
  v_add_f32 v104, v104, v108
  v_add_f32 v105, v105, v109
  v_add_f32 v106, v106, v110
  v_add_f32 v10, v104, v105
  v_add_f32 v10, v10, v106
  s_nop 1
  v_add_f32_dpp v10, v10, v10 row_ror:8 row_mask:0xf bank_mask:0xf
  s_nop 1
  v_add_f32_dpp v10, v10, v10 row_ror:4 row_mask:0xf bank_mask:0xf
  s_nop 1
  v_add_f32_dpp v10, v10, v10 row_ror:2 row_mask:0xf bank_mask:0xf
  s_nop 1
  v_add_f32_dpp v10, v10, v10 row_ror:1 row_mask:0xf bank_mask:0xf
  v_mov_b32 v11, v10
  s_nop 1
  v_permlane16_swap_b32 v11, v10
  v_add_f32 v10, v10, v11
  v_mov_b32 v11, v10
  s_nop 1
  v_permlane32_swap_b32 v11, v10
  v_add_f32 v10, v10, v11
  v_mov_b32 v9, s74
  v_mov_b32 v11, s74
  s_mov_b64 exec, 1
  s_cmp_eq_u32 s75, 1
  s_cbranch_scc0 L_pf_56
  global_store_dwordx4 v18, v[8:11], s[42:43]
  s_branch L_pe_57
L_pf_56:
  global_store_dwordx4 v18, v[8:11], s[42:43] sc1
L_pe_57:
  s_mov_b64 exec, -1
L_disp3:
  s_mov_b32 s77, 0
  s_bfe_u32 s62, s74, 0x80000
  s_bfe_u32 s63, s74, 0x80008
  s_bfe_u32 s64, s74, 0x80010
  s_bfe_u32 s65, s74, 0x80018
  s_cmp_lg_u32 s5, 2
  s_cbranch_scc1 L_opt_58
  s_mov_b32 s70, 0
L_pl_59:
  ds_read_b32 v8, v38 offset:6656
  s_waitcnt lgkmcnt(0)
  v_cmp_eq_u32 vcc, -1, v8
  s_cmp_eq_u64 vcc, 0
  s_cbranch_scc1 L_pld_60
  s_sleep 32
  s_add_u32 s70, s70, 1
  s_cmp_lt_u32 s70, 1048576
  s_cbranch_scc1 L_pl_59
L_pld_60:
  s_lshl_b32 s56, s6, 2
  s_add_u32 s56, s56, s7
  s_lshl_b32 s57, s56, 9
  s_add_u32 s57, s57, 131072
  v_lshl_add_u32 v3, v1, 3, s57
  global_load_dword v167, v3, s[42:43] sc1
L_opt_58:
  s_cmp_eq_u32 s60, 2
  s_cbranch_scc1 L_pre_f1
  s_cmp_eq_u32 s60, 3
  s_cbranch_scc1 L_pre_f2
  s_cmp_eq_u32 s60, 1
  s_cbranch_scc1 L_pre_wo
  s_lshr_b32 s68, s14, 29
  s_mul_i32 s68, s68, 1
  s_xor_b32 s68, s68, s8
  s_lshl_b32 s68, s68, 3
  s_add_u32 s68, s68, L_gtab-L_pc2
  s_load_dwordx2 s[100:101], s[100:101], s68
  s_waitcnt lgkmcnt(0)
  s_lshr_b32 s68, s14, 26
  s_lshl_b32 s68, s68, 2
  s_add_u32 s68, s68, s5
  s_and_b32 s68, s68, 31
  s_and_b32 s69, s100, 0xffff
  s_lshr_b32 s100, s100, 16
  v_and_b32 v12, 3, v1
  v_lshl_add_u32 v12, v12, 7, s69
  v_min_u32 v12, s100, v12
  v_lshrrev_b32 v13, 2, v1
  v_mul_u32_u24 v13, 2752, v13
  s_mul_i32 s69, s68, 44032
  v_add3_u32 v12, v12, v13, s69
  v_min_u32 v13, 42, v1
  s_mul_i32 s68, s68, 44032
  s_add_u32 s68, s68, s101
  v_lshl_add_u32 v13, v13, 10, s68
  s_branch L_join
L_pre_wo:
  s_mov_b32 s70, 0
L_hs_61:
  ds_read_b32 v9, v38 offset:6720
  s_waitcnt lgkmcnt(0)
  v_cmp_gt_u32 vcc, 8, v9
  s_cmp_eq_u64 vcc, 0
  s_cbranch_scc1 L_hsd_62
  s_sleep 8
  s_add_u32 s70, s70, 1
  s_cmp_lt_u32 s70, 2097152
  s_cbranch_scc1 L_hs_61
L_hsd_62:
  v_lshrrev_b32 v2, 2, v1
  v_bfe_u32 v3, v1, 1, 1
  s_lshl_b32 s49, s5, 1
  v_or_b32 v3, s49, v3
  v_and_b32 v10, 6, v2
  v_xor_b32 v3, v3, v10
  v_lshlrev_b32 v2, 7, v2
  v_lshl_add_u32 v2, v3, 4, v2
  v_and_b32 v3, 1, v1
  v_lshl_add_u32 v2, v3, 3, v2
  v_add_u32 v2, 20480, v2
  s_add_u32 s49, s5, 0
  s_and_b32 s49, s49, 3
  s_mul_i32 s49, s49, 16384
  v_add_u32 v3, s49, v2
  ds_read_b64_tr_b16 v[40:41], v3 offset:0
  ds_read_b64_tr_b16 v[42:43], v3 offset:2048
  ds_read_b64_tr_b16 v[44:45], v3 offset:4096
  ds_read_b64_tr_b16 v[46:47], v3 offset:6144
  ds_read_b64_tr_b16 v[48:49], v3 offset:8192
  ds_read_b64_tr_b16 v[50:51], v3 offset:10240
  ds_read_b64_tr_b16 v[52:53], v3 offset:12288
  ds_read_b64_tr_b16 v[54:55], v3 offset:14336
  s_add_u32 s49, s5, 1
  s_and_b32 s49, s49, 3
  s_mul_i32 s49, s49, 16384
  v_add_u32 v3, s49, v2
  ds_read_b64_tr_b16 v[56:57], v3 offset:0
  ds_read_b64_tr_b16 v[58:59], v3 offset:2048
  ds_read_b64_tr_b16 v[60:61], v3 offset:4096
  ds_read_b64_tr_b16 v[62:63], v3 offset:6144
  s_waitcnt lgkmcnt(10)
  ds_read_b64_tr_b16 v[64:65], v3 offset:8192
  ds_read_b64_tr_b16 v[66:67], v3 offset:10240
  s_waitcnt lgkmcnt(10)
  ds_read_b64_tr_b16 v[68:69], v3 offset:12288
  ds_read_b64_tr_b16 v[70:71], v3 offset:14336
  s_waitcnt lgkmcnt(10)
  s_add_u32 s49, s5, 2
  s_and_b32 s49, s49, 3
  s_mul_i32 s49, s49, 16384
  v_add_u32 v3, s49, v2
  ds_read_b64_tr_b16 v[72:73], v3 offset:0
  ds_read_b64_tr_b16 v[74:75], v3 offset:2048
  s_waitcnt lgkmcnt(10)
  ds_read_b64_tr_b16 v[76:77], v3 offset:4096
  ds_read_b64_tr_b16 v[78:79], v3 offset:6144
  s_waitcnt lgkmcnt(10)
  ds_read_b64_tr_b16 v[80:81], v3 offset:8192
  ds_read_b64_tr_b16 v[82:83], v3 offset:10240
  s_waitcnt lgkmcnt(10)
  ds_read_b64_tr_b16 v[84:85], v3 offset:12288
  ds_read_b64_tr_b16 v[86:87], v3 offset:14336
  s_waitcnt lgkmcnt(10)
  s_add_u32 s49, s5, 3
  s_and_b32 s49, s49, 3
  s_mul_i32 s49, s49, 16384
  v_add_u32 v3, s49, v2
  ds_read_b64_tr_b16 v[88:89], v3 offset:0
  ds_read_b64_tr_b16 v[90:91], v3 offset:2048
  s_waitcnt lgkmcnt(10)
  ds_read_b64_tr_b16 v[92:93], v3 offset:4096
  ds_read_b64_tr_b16 v[94:95], v3 offset:6144
  s_waitcnt lgkmcnt(10)
  ds_read_b64_tr_b16 v[96:97], v3 offset:8192
  ds_read_b64_tr_b16 v[98:99], v3 offset:10240
  s_waitcnt lgkmcnt(10)
  ds_read_b64_tr_b16 v[100:101], v3 offset:12288
  ds_read_b64_tr_b16 v[102:103], v3 offset:14336
  s_waitcnt lgkmcnt(10)
  s_waitcnt lgkmcnt(0)
  s_lshl_b32 s49, s5, 3
  s_add_u32 s49, s49, s66
  s_lshl_b32 s50, s49, 9
  s_add_u32 s50, s50, 65536
  v_lshrrev_b32 v12, 5, v1
  v_lshl_add_u32 v15, v12, 14, s50
  v_and_b32 v16, 3, v1
  v_lshl_add_u32 v15, v16, 7, v15
  s_mov_b32 s70, 0
L_pl_63:
  ds_read_b32 v8, v38 offset:6676
  s_waitcnt lgkmcnt(0)
  v_cmp_eq_u32 vcc, -1, v8
  s_cmp_eq_u64 vcc, 0
  s_cbranch_scc1 L_pld_64
  s_sleep 16
  s_add_u32 s70, s70, 1
  s_cmp_lt_u32 s70, 1048576
  s_cbranch_scc1 L_pl_63
L_pld_64:
  s_mov_b32 s70, 0
L_polt_65:
  global_load_dwordx4 v[16:19], v15, s[42:43] sc1
  s_waitcnt vmcnt(0)
  v_cmp_ne_u32 vcc, s74, v17
  v_cmp_ne_u32 s[68:69], s74, v19
  s_or_b64 vcc, vcc, s[68:69]
  s_cmp_eq_u64 vcc, 0
  s_cbranch_scc1 L_poltd_66
  s_sleep 8
  s_add_u32 s70, s70, 1
  s_cmp_lt_u32 s70, 262144
  s_cbranch_scc1 L_polt_65
L_poltd_66:
  v_max_f32_dpp v10, v16, v16 quad_perm:[1,0,3,2] row_mask:0xf bank_mask:0xf
  s_nop 1
  v_max_f32_dpp v10, v10, v10 quad_perm:[2,3,0,1] row_mask:0xf bank_mask:0xf
  v_sub_f32 v8, v16, v10
  v_mul_f32 v8, 0x3fb8aa3b, v8
  v_exp_f32 v8, v8
  s_nop 0
  v_mul_f32 v9, v18, v8
  s_nop 1
  v_add_f32_dpp v9, v9, v9 quad_perm:[1,0,3,2] row_mask:0xf bank_mask:0xf
  s_nop 1
  v_add_f32_dpp v9, v9, v9 quad_perm:[2,3,0,1] row_mask:0xf bank_mask:0xf
  v_rcp_f32 v9, v9
  s_nop 0
  v_mul_f32 v8, v8, v9
  s_nop 1
  v_mov_b32_dpp v20, v8 quad_perm:[0,0,0,0] row_mask:0xf bank_mask:0xf
  v_mov_b32_dpp v21, v8 quad_perm:[1,1,1,1] row_mask:0xf bank_mask:0xf
  v_mov_b32_dpp v22, v8 quad_perm:[2,2,2,2] row_mask:0xf bank_mask:0xf
  v_mov_b32_dpp v23, v8 quad_perm:[3,3,3,3] row_mask:0xf bank_mask:0xf
  s_lshl_b32 s49, s49, 11
  s_add_u32 s49, s49, 131072
  v_lshrrev_b32 v12, 5, v1
  v_and_b32 v16, 31, v1
  v_lshlrev_b32 v15, 16, v12
  v_lshl_add_u32 v15, v16, 4, v15
  v_add_u32 v15, s49, v15
  v_mul_u32_u24 v12, 1056, v12
  v_bfe_u32 v16, v1, 3, 2
  v_lshl_add_u32 v12, v16, 6, v12
  v_and_b32 v16, 3, v1
  v_lshl_add_u32 v12, v16, 4, v12
  v_bfe_u32 v16, v1, 2, 1
  v_lshl_add_u32 v12, v16, 3, v12
  s_lshl_b32 s49, s5, 8
  v_add_u32 v12, s49, v12
  v_and_b32 v14, 1, v1
  v_mul_u32_u24 v14, 1056, v14
  v_lshrrev_b32 v3, 4, v1
  v_lshl_add_u32 v14, v3, 4, v14
  v_and_b32 v13, 1, v1
  v_lshlrev_b32 v13, 6, v13
  v_lshrrev_b32 v3, 4, v1
  v_lshl_add_u32 v13, v3, 4, v13
  s_lshl_b32 s49, s5, 7
  s_add_u32 s49, s49, s58
  v_add_u32 v13, s49, v13
  v_add_u32 v37, 0x2000, v13
  v_mov_b32 v36, 0xff
  s_add_u32 s49, s5, 1
  s_and_b32 s49, s49, 3
  s_lshl_b32 s49, s49, 8
  v_add_u32 v0, s49, v14
  s_add_u32 s49, s5, 2
  s_and_b32 s49, s49, 3
  s_lshl_b32 s49, s49, 8
  v_add_u32 v2, s49, v14
  s_add_u32 s49, s5, 3
  s_and_b32 s49, s49, 3
  s_lshl_b32 s49, s49, 8
  v_add_u32 v3, s49, v14
  s_add_u32 s49, s5, 0
  s_and_b32 s49, s49, 3
  s_lshl_b32 s49, s49, 8
  v_add_u32 v14, s49, v14
  s_branch L_join
L_pre_f1:
  s_cmp_lg_u32 s5, 3
  s_cbranch_scc1 L_hc_67
  s_mov_b32 s70, 0
L_pl_68:
  ds_read_b32 v8, v38 offset:6400
  s_waitcnt lgkmcnt(0)
  v_cmp_eq_u32 vcc, -1, v8
  s_cmp_eq_u64 vcc, 0
  s_cbranch_scc1 L_pld_69
  s_sleep 32
  s_add_u32 s70, s70, 1
  s_cmp_lt_u32 s70, 1048576
  s_cbranch_scc1 L_pl_68
L_pld_69:
  v_lshlrev_b32 v110, 5, v1
  global_load_dword v109, v110, s[42:43] offset:1028 sc1
  s_waitcnt vmcnt(0)
  v_subrev_u32 v109, s74, v109
  v_cmp_eq_u32 vcc, 1, v109
  s_bcnt1_i32_b64 s70, vcc
  v_cmp_eq_u32 vcc, 0, v109
  s_bcnt1_i32_b64 s71, vcc
  s_cmp_gt_u32 s70, s71
  s_cselect_b32 s71, 4, 0
  s_sub_u32 s68, s76, s74
  s_xor_b32 s71, s71, s68
  s_and_b32 s71, s71, 4
  s_lshl_b32 s71, s71, 11
  v_mov_b32 v104, s71
  ds_write_b32 v38, v104 offset:6668
L_hc_67:
  v_mov_b32 v31, v13
  v_lshlrev_b32 v15, 4, v0
  v_add_u32 v24, 12288, v15
  v_add_u32 v25, 16384, v15
  v_add_u32 v26, 20480, v15
  s_mov_b32 s70, 0
L_pl_70:
  ds_read_b32 v11, v38 offset:6668
  s_waitcnt lgkmcnt(0)
  v_cmp_eq_u32 vcc, -1, v11
  s_cmp_eq_u64 vcc, 0
  s_cbranch_scc1 L_pld_71
  s_sleep 8
  s_add_u32 s70, s70, 1
  s_cmp_lt_u32 s70, 1048576
  s_cbranch_scc1 L_pl_70
L_pld_71:
  v_add_u32 v15, 327680, v15
  v_add_u32 v15, v11, v15
  v_add_u32 v35, 4096, v15
  v_add_u32 v32, 16384, v15
  v_add_u32 v36, 20480, v15
  v_add_u32 v33, 32768, v15
  v_add_u32 v37, 36864, v15
  v_add_u32 v34, 49152, v15
  v_add_u32 v39, 53248, v15
  v_bfe_u32 v5, v1, 2, 1
  v_mul_u32_u24 v5, 1056, v5
  v_lshrrev_b32 v3, 3, v0
  v_lshl_add_u32 v5, v3, 5, v5
  v_and_b32 v3, 3, v1
  v_lshl_add_u32 v5, v3, 3, v5
  v_and_b32 v14, 7, v1
  v_mul_u32_u24 v14, 1056, v14
  v_lshrrev_b32 v3, 4, v1
  v_lshl_add_u32 v14, v3, 4, v14
  v_and_b32 v7, 1, v1
  v_mul_u32_u24 v7, 1056, v7
  v_lshrrev_b32 v3, 1, v1
  v_lshl_add_u32 v7, v3, 5, v7
  v_and_b32 v13, 3, v1
  v_lshlrev_b32 v13, 5, v13
  v_bfe_u32 v3, v1, 4, 1
  v_lshl_add_u32 v13, v3, 3, v13
  s_lshl_b32 s49, s5, 7
  s_add_u32 s49, s49, s58
  v_add_u32 v13, s49, v13
  v_lshrrev_b32 v3, 5, v1
  v_lshl_add_u32 v13, v3, 4, v13
  v_add_u32 v4, 0x2000, v13
  s_and_b32 s54, s61, 1
  s_mul_i32 s52, s54, -2
  s_add_u32 s52, s52, 1
  s_mul_i32 s53, s52, 16384
  s_sub_u32 s53, s53, 8192
  s_mul_i32 s52, s52, 2752
  s_sub_u32 s52, s52, 704512
  v_lshrrev_b32 v2, 2, v1
  v_mul_u32_u24 v2, 5504, v2
  s_and_b32 s49, s5, 2
  s_or_b32 s49, s49, s54
  v_xor_b32 v3, s49, v1
  v_and_b32 v3, 3, v3
  v_lshl_add_u32 v2, v3, 4, v2
  v_mov_b32 v0, v2
  v_lshrrev_b32 v6, 3, v1
  v_lshlrev_b32 v6, 6, v6
  v_bfe_u32 v3, v1, 2, 1
  v_lshl_add_u32 v6, v3, 14, v6
  v_and_b32 v8, 2, v1
  v_or_b32 v3, v3, v8
  v_xor_b32 v3, s5, v3
  v_lshl_add_u32 v6, v3, 4, v6
  v_lshl_add_u32 v6, v8, 14, v6
  v_and_b32 v3, 1, v1
  v_lshl_add_u32 v6, v3, 3, v6
  v_add_u32 v6, 20480, v6
  s_and_b32 s55, s5, 1
  s_mul_i32 s49, s55, 704512
  s_add_u32 s49, s49, s48
  s_mul_i32 s50, s54, 2752
  s_add_u32 s49, s49, s50
  s_lshr_b32 s50, s5, 1
  s_lshl_b32 s50, s50, 15
  s_lshl_b32 s54, s54, 14
  s_add_u32 s50, s50, s54
  s_lshl_b32 s55, s55, 13
  s_add_u32 s50, s50, s55
  s_add_u32 s50, s50, 20480
  s_mov_b32 s70, 0
L_pl_72:
  ds_read_b32 v8, v38 offset:6676
  s_waitcnt lgkmcnt(0)
  v_cmp_eq_u32 vcc, -1, v8
  s_cmp_eq_u64 vcc, 0
  s_cbranch_scc1 L_pld_73
  s_sleep 16
  s_add_u32 s70, s70, 1
  s_cmp_lt_u32 s70, 1048576
  s_cbranch_scc1 L_pl_72
L_pld_73:
  global_load_dwordx2 v[8:9], v31, s[16:17]
  s_mov_b32 s70, 0
L_polt_74:
  global_load_dwordx4 v[136:139], v24, s[42:43] sc1
  global_load_dwordx4 v[140:143], v25, s[42:43] sc1
  global_load_dwordx4 v[144:147], v26, s[42:43] sc1
  s_waitcnt vmcnt(0)
  v_cmp_ne_u32 vcc, s74, v137
  v_cmp_ne_u32 s[68:69], s74, v139
  s_or_b64 vcc, vcc, s[68:69]
  v_cmp_ne_u32 s[68:69], s74, v141
  s_or_b64 vcc, vcc, s[68:69]
  v_cmp_ne_u32 s[68:69], s74, v143
  s_or_b64 vcc, vcc, s[68:69]
  v_cmp_ne_u32 s[68:69], s74, v145
  s_or_b64 vcc, vcc, s[68:69]
  v_cmp_ne_u32 s[68:69], s74, v147
  s_or_b64 vcc, vcc, s[68:69]
  s_cmp_eq_u64 vcc, 0
  s_cbranch_scc1 L_poltd_75
  s_sleep 8
  s_add_u32 s70, s70, 1
  s_cmp_lt_u32 s70, 262144
  s_cbranch_scc1 L_polt_74
L_poltd_75:
  v_lshlrev_b32 v16, 16, v8
  v_and_b32 v17, s73, v8
  v_lshlrev_b32 v18, 16, v9
  v_and_b32 v19, s73, v9
  v_lshlrev_b32 v20, 16, v136
  v_and_b32 v21, s73, v136
  v_lshlrev_b32 v22, 16, v138
  v_and_b32 v23, s73, v138
  v_lshlrev_b32 v28, 16, v144
  v_and_b32 v29, s73, v144
  v_lshlrev_b32 v30, 16, v146
  v_and_b32 v31, s73, v146
  v_add_f32 v28, 1.0, v28
  v_add_f32 v29, 1.0, v29
  v_add_f32 v30, 1.0, v30
  v_add_f32 v31, 1.0, v31
  v_cvt_pk_bf16_f32 v8, v28, v29
  v_cvt_pk_bf16_f32 v9, v30, v31
  v_mov_b32 v141, v142
  ds_write_b64 v12, v[8:9] offset:2112
  ds_write_b64 v12, v[140:141] offset:4224
  v_cvt_pk_bf16_f32 v28, 0, v28
  v_cvt_pk_bf16_f32 v29, 0, v29
  v_cvt_pk_bf16_f32 v30, 0, v30
  v_cvt_pk_bf16_f32 v31, 0, v31
  v_mul_f32 v24, v20, v28
  v_mul_f32 v25, v21, v29
  v_mul_f32 v26, v22, v30
  v_mul_f32 v27, v23, v31
  v_mul_f32 v28, v16, v28
  v_mul_f32 v29, v17, v29
  v_mul_f32 v30, v18, v30
  v_mul_f32 v31, v19, v31
  s_branch L_join
L_pre_f2:
  s_cmp_lg_u32 s5, 3
  s_cbranch_scc1 L_hc_76
  s_mov_b32 s70, 0
L_pl_77:
  ds_read_b32 v8, v38 offset:6400
  s_waitcnt lgkmcnt(0)
  v_cmp_eq_u32 vcc, -1, v8
  s_cmp_eq_u64 vcc, 0
  s_cbranch_scc1 L_pld_78
  s_sleep 32
  s_add_u32 s70, s70, 1
  s_cmp_lt_u32 s70, 1048576
  s_cbranch_scc1 L_pl_77
L_pld_78:
  v_lshlrev_b32 v110, 5, v1
  global_load_dword v109, v110, s[42:43] offset:1028 sc1
  s_waitcnt vmcnt(0)
  v_subrev_u32 v109, s74, v109
  v_cmp_eq_u32 vcc, 1, v109
  s_bcnt1_i32_b64 s70, vcc
  v_cmp_eq_u32 vcc, 0, v109
  s_bcnt1_i32_b64 s71, vcc
  s_cmp_gt_u32 s70, s71
  s_cselect_b32 s71, 4, 0
  s_sub_u32 s68, s76, s74
  s_xor_b32 s71, s71, s68
  s_and_b32 s71, s71, 4
  s_lshl_b32 s71, s71, 11
  v_mov_b32 v104, s71
  ds_write_b32 v38, v104 offset:6668
L_hc_76:
  v_and_b32 v12, 1, v1
  v_lshrrev_b32 v14, 4, v1
  s_lshl_b32 s49, s61, 5
  v_lshl_add_u32 v3, v14, 3, s49
  v_lshl_add_u32 v13, v12, 10, v3
  v_mov_b32 v31, v13
  v_lshlrev_b32 v15, 6, v12
  v_lshl_add_u32 v15, v14, 4, v15
  s_lshl_b32 s49, s61, 7
  v_add_u32 v15, s49, v15
  v_add_u32 v24, 12288, v15
  v_add_u32 v25, 24576, v15
  s_mov_b32 s70, 0
L_pl_79:
  ds_read_b32 v11, v38 offset:6668
  s_waitcnt lgkmcnt(0)
  v_cmp_eq_u32 vcc, -1, v11
  s_cmp_eq_u64 vcc, 0
  s_cbranch_scc1 L_pld_80
  s_sleep 8
  s_add_u32 s70, s70, 1
  s_cmp_lt_u32 s70, 1048576
  s_cbranch_scc1 L_pl_79
L_pld_80:
  v_add_u32 v15, 327680, v15
  v_add_u32 v15, v11, v15
  v_add_u32 v35, 4096, v15
  v_add_u32 v32, 16384, v15
  v_add_u32 v36, 20480, v15
  v_add_u32 v33, 32768, v15
  v_add_u32 v37, 36864, v15
  v_add_u32 v34, 49152, v15
  v_add_u32 v39, 53248, v15
  s_lshl_b32 s49, s5, 14
  s_add_u32 s49, s49, 264192
  v_lshl_add_u32 v28, v14, 7, s49
  v_add_u32 v28, v11, v28
  v_lshl_add_u32 v28, v12, 5, v28
  v_and_b32 v3, 2, v1
  v_lshl_add_u32 v28, v3, 3, v28
  v_bfe_u32 v3, v1, 2, 2
  v_lshl_add_u32 v28, v3, 9, v28
  v_lshl_add_u32 v12, v14, 1, v12
  v_lshlrev_b32 v12, 4, v12
  v_add_u32 v12, 11008, v12
  s_lshl_b32 s49, s5, 7
  v_add_u32 v30, s49, v12
  v_lshrrev_b32 v2, 1, v1
  v_lshlrev_b32 v2, 10, v2
  v_and_b32 v3, 1, v1
  v_lshl_add_u32 v2, v3, 4, v2
  v_mov_b32 v29, v2
  v_lshlrev_b32 v6, 8, v14
  v_bfe_u32 v3, v1, 2, 2
  v_lshl_add_u32 v6, v3, 5, v6
  v_and_b32 v3, 3, v1
  v_lshl_add_u32 v6, v3, 3, v6
  s_mul_i32 s49, s5, 11264
  s_add_u32 s49, s49, 20480
  v_add_u32 v6, s49, v6
  s_mov_b32 s70, 0
L_pl_81:
  ds_read_b32 v8, v38 offset:6676
  s_waitcnt lgkmcnt(0)
  v_cmp_eq_u32 vcc, -1, v8
  s_cmp_eq_u64 vcc, 0
  s_cbranch_scc1 L_pld_82
  s_sleep 16
  s_add_u32 s70, s70, 1
  s_cmp_lt_u32 s70, 1048576
  s_cbranch_scc1 L_pl_81
L_pld_82:
  global_load_dwordx2 v[8:9], v31, s[16:17]
  s_mov_b32 s70, 0
L_polt_83:
  global_load_dwordx4 v[136:139], v24, s[42:43] sc1
  global_load_dwordx4 v[140:143], v25, s[42:43] sc1
  s_waitcnt vmcnt(0)
  v_cmp_ne_u32 vcc, s74, v137
  v_cmp_ne_u32 s[68:69], s74, v139
  s_or_b64 vcc, vcc, s[68:69]
  v_cmp_ne_u32 s[68:69], s74, v141
  s_or_b64 vcc, vcc, s[68:69]
  v_cmp_ne_u32 s[68:69], s74, v143
  s_or_b64 vcc, vcc, s[68:69]
  s_cmp_eq_u64 vcc, 0
  s_cbranch_scc1 L_poltd_84
  s_sleep 8
  s_add_u32 s70, s70, 1
  s_cmp_lt_u32 s70, 262144
  s_cbranch_scc1 L_polt_83
L_poltd_84:
  s_cmp_lg_u32 s5, 2
  s_cbranch_scc1 L_apw_85
  s_and_b32 s49, s61, 3
  s_lshl_b32 s49, s49, 14
  s_add_u32 s49, s49, 327680
  v_lshl_add_u32 v3, v1, 7, s49
  v_add_u32 v3, v11, v3
  global_load_dword v167, v3, s[42:43] sc1
L_apw_85:
  v_lshlrev_b32 v16, 16, v8
  v_and_b32 v17, s73, v8
  v_lshlrev_b32 v18, 16, v9
  v_and_b32 v19, s73, v9
  v_lshlrev_b32 v20, 16, v136
  v_and_b32 v21, s73, v136
  v_lshlrev_b32 v22, 16, v138
  v_and_b32 v23, s73, v138
  v_lshlrev_b32 v24, 16, v140
  v_and_b32 v25, s73, v140
  v_lshlrev_b32 v26, 16, v142
  v_and_b32 v27, s73, v142
L_join:
  s_waitcnt vmcnt(0) lgkmcnt(0)
  s_barrier
  s_cmp_eq_u32 s60, 1
  s_cbranch_scc1 L_t_wo
  s_cmp_eq_u32 s60, 2
  s_cbranch_scc1 L_t_f1
  s_cmp_eq_u32 s60, 3
  s_cbranch_scc1 L_t_f2
  global_load_dword v16, v12, s[28:29]
  global_load_dword v17, v12, s[30:31]
  global_load_dword v18, v13, s[32:33]
  s_branch L_fin
L_t_wo:
  s_mov_b32 s70, 0
L_wo_p:
  global_load_dwordx4 v[104:107], v15, s[42:43] offset:0 sc1
  global_load_dwordx4 v[108:111], v15, s[42:43] offset:512 sc1
  global_load_dwordx4 v[112:115], v15, s[42:43] offset:1024 sc1
  global_load_dwordx4 v[116:119], v15, s[42:43] offset:1536 sc1
  s_waitcnt vmcnt(3)
  v_xor_b32 v104, s62, v104
  v_xor_b32 v105, s63, v105
  v_xor_b32 v106, s64, v106
  v_xor_b32 v107, s65, v107
  s_waitcnt vmcnt(2)
  v_xor_b32 v108, s62, v108
  v_xor_b32 v109, s63, v109
  v_xor_b32 v110, s64, v110
  v_xor_b32 v111, s65, v111
  s_waitcnt vmcnt(1)
  v_xor_b32 v112, s62, v112
  v_xor_b32 v113, s63, v113
  v_xor_b32 v114, s64, v114
  v_xor_b32 v115, s65, v115
  s_waitcnt vmcnt(0)
  v_xor_b32 v116, s62, v116
  v_xor_b32 v117, s63, v117
  v_xor_b32 v118, s64, v118
  v_xor_b32 v119, s65, v119
  v_or3_b32 v28, v104, v105, v106
  v_or3_b32 v29, v107, v108, v109
  v_or3_b32 v30, v110, v111, v112
  v_or3_b32 v31, v113, v114, v115
  v_or3_b32 v28, v28, v29, v30
  v_or3_b32 v31, v31, v116, v117
  v_or3_b32 v28, v28, v118, v119
  v_or_b32 v28, v28, v31
  v_lshlrev_b32 v28, 24, v28
  v_cmp_ne_u32 vcc, 0, v28
  v_pk_mul_f32 v[16:17], v[104:105], v[20:21] op_sel:[0,0] op_sel_hi:[1,0]
  v_pk_mul_f32 v[18:19], v[106:107], v[20:21] op_sel:[0,0] op_sel_hi:[1,0]
  v_pk_fma_f32 v[16:17], v[108:109], v[20:21], v[16:17] op_sel:[0,1,0] op_sel_hi:[1,1,1]
  v_pk_fma_f32 v[18:19], v[110:111], v[20:21], v[18:19] op_sel:[0,1,0] op_sel_hi:[1,1,1]
  v_pk_fma_f32 v[16:17], v[112:113], v[22:23], v[16:17] op_sel:[0,0,0] op_sel_hi:[1,0,1]
  v_pk_fma_f32 v[18:19], v[114:115], v[22:23], v[18:19] op_sel:[0,0,0] op_sel_hi:[1,0,1]
  v_pk_fma_f32 v[16:17], v[116:117], v[22:23], v[16:17] op_sel:[0,1,0] op_sel_hi:[1,1,1]
  v_pk_fma_f32 v[18:19], v[118:119], v[22:23], v[18:19] op_sel:[0,1,0] op_sel_hi:[1,1,1]
  s_cmp_eq_u64 vcc, 0
  s_cbranch_scc1 L_wo_ok
  s_add_u32 s70, s70, 1
  s_cmp_lt_u32 s70, 262144
  s_cbranch_scc1 L_wo_p
L_wo_ok:
  v_cvt_pk_bf16_f32 v16, v16, v17
  v_cvt_pk_bf16_f32 v17, v18, v19
  ds_write_b64 v12, v[16:17] offset:0
  ds_read_b128 v[104:107], v14 offset:0
  ds_read_b128 v[108:111], v14 offset:64
  ds_read_b128 v[112:115], v14 offset:128
  ds_read_b128 v[116:119], v14 offset:192
  s_waitcnt lgkmcnt(4)
  s_barrier
  ds_read_b128 v[120:123], v0 offset:0
  ds_read_b128 v[124:127], v0 offset:64
  ds_read_b128 v[128:131], v0 offset:128
  ds_read_b128 v[132:135], v0 offset:192
  s_waitcnt lgkmcnt(4)
  v_mfma_f32_16x16x32_bf16 v[8:11], v[40:43], v[104:107], 0
  ds_read_b128 v[136:139], v2 offset:0
  ds_read_b128 v[140:143], v2 offset:64
  v_mfma_f32_16x16x32_bf16 v[8:11], v[44:47], v[108:111], v[8:11]
  ds_read_b128 v[144:147], v2 offset:128
  ds_read_b128 v[148:151], v2 offset:192
  v_mfma_f32_16x16x32_bf16 v[8:11], v[48:51], v[112:115], v[8:11]
  ds_read_b128 v[152:155], v3 offset:0
  ds_read_b128 v[156:159], v3 offset:64
  v_mfma_f32_16x16x32_bf16 v[8:11], v[52:55], v[116:119], v[8:11]
  ds_read_b128 v[160:163], v3 offset:128
  ds_read_b128 v[164:167], v3 offset:192
  s_waitcnt lgkmcnt(11)
  v_mfma_f32_16x16x32_bf16 v[8:11], v[56:59], v[120:123], v[8:11]
  s_waitcnt lgkmcnt(10)
  v_mfma_f32_16x16x32_bf16 v[8:11], v[60:63], v[124:127], v[8:11]
  s_waitcnt lgkmcnt(9)
  v_mfma_f32_16x16x32_bf16 v[8:11], v[64:67], v[128:131], v[8:11]
  s_waitcnt lgkmcnt(8)
  v_mfma_f32_16x16x32_bf16 v[8:11], v[68:71], v[132:135], v[8:11]
  s_waitcnt lgkmcnt(7)
  v_mfma_f32_16x16x32_bf16 v[8:11], v[72:75], v[136:139], v[8:11]
  s_waitcnt lgkmcnt(6)
  v_mfma_f32_16x16x32_bf16 v[8:11], v[76:79], v[140:143], v[8:11]
  s_waitcnt lgkmcnt(5)
  v_mfma_f32_16x16x32_bf16 v[8:11], v[80:83], v[144:147], v[8:11]
  s_waitcnt lgkmcnt(4)
  v_mfma_f32_16x16x32_bf16 v[8:11], v[84:87], v[148:151], v[8:11]
  s_waitcnt lgkmcnt(3)
  v_mfma_f32_16x16x32_bf16 v[8:11], v[88:91], v[152:155], v[8:11]
  s_waitcnt lgkmcnt(2)
  v_mfma_f32_16x16x32_bf16 v[8:11], v[92:95], v[156:159], v[8:11]
  s_waitcnt lgkmcnt(1)
  v_mfma_f32_16x16x32_bf16 v[8:11], v[96:99], v[160:163], v[8:11]
  s_waitcnt lgkmcnt(0)
  v_mfma_f32_16x16x32_bf16 v[8:11], v[100:103], v[164:167], v[8:11]
  s_nop 5
  s_mov_b32 exec_lo, 0x00030003
  s_mov_b32 exec_hi, 0x00030003
  v_bfi_b32 v8, v36, s62, v8
  v_bfi_b32 v9, v36, s63, v9
  v_bfi_b32 v10, v36, s64, v10
  v_bfi_b32 v11, v36, s65, v11
  global_store_dwordx4 v13, v[8:11], s[42:43] sc1
  global_store_dwordx4 v37, v[8:11], s[42:43] sc1
  s_branch L_fin
L_t_f1:
  v_mov_b32 v2, v0
  s_add_u32 s51, s50, 8192
L_dma_86:
  s_mov_b32 m0, s50
  s_add_u32 s50, s50, 1024
  buffer_load_dwordx4 v2, s[44:47], s49 offen  lds
  s_add_u32 s49, s49, 88064
  s_cmp_lt_u32 s50, s51
  s_cbranch_scc1 L_dma_86
L_dmae_87:
  v_xor_b32 v2, 16, v2
  s_add_u32 s49, s49, s52
  s_add_u32 s50, s50, s53
  s_add_u32 s51, s50, 8192
L_dma_88:
  s_mov_b32 m0, s50
  s_add_u32 s50, s50, 1024
  buffer_load_dwordx4 v2, s[44:47], s49 offen  lds
  s_add_u32 s49, s49, 88064
  s_cmp_lt_u32 s50, s51
  s_cbranch_scc1 L_dma_88
L_dmae_89:
  v_mov_b32 v2, v6
  s_waitcnt vmcnt(0)
  s_barrier
  global_load_dwordx4 v[104:107], v15, s[42:43] sc1
  global_load_dwordx4 v[108:111], v35, s[42:43] sc1
  global_load_dwordx4 v[112:115], v32, s[42:43] sc1
  global_load_dwordx4 v[116:119], v36, s[42:43] sc1
  global_load_dwordx4 v[120:123], v33, s[42:43] sc1
  global_load_dwordx4 v[124:127], v37, s[42:43] sc1
  global_load_dwordx4 v[128:131], v34, s[42:43] sc1
  global_load_dwordx4 v[132:135], v39, s[42:43] sc1
  s_add_u32 s49, s5, 0
  s_and_b32 s49, s49, 3
  s_mul_i32 s49, s49, 4096
  v_add_u32 v3, s49, v2
  ds_read_b64_tr_b16 v[40:41], v3 offset:0
  ds_read_b64_tr_b16 v[42:43], v3 offset:512
  ds_read_b64_tr_b16 v[44:45], v3 offset:1024
  ds_read_b64_tr_b16 v[46:47], v3 offset:1536
  ds_read_b64_tr_b16 v[48:49], v3 offset:2048
  ds_read_b64_tr_b16 v[50:51], v3 offset:2560
  ds_read_b64_tr_b16 v[52:53], v3 offset:3072
  ds_read_b64_tr_b16 v[54:55], v3 offset:3584
  s_add_u32 s49, s5, 1
  s_and_b32 s49, s49, 3
  s_mul_i32 s49, s49, 4096
  v_add_u32 v3, s49, v2
  ds_read_b64_tr_b16 v[56:57], v3 offset:0
  ds_read_b64_tr_b16 v[58:59], v3 offset:512
  ds_read_b64_tr_b16 v[60:61], v3 offset:1024
  ds_read_b64_tr_b16 v[62:63], v3 offset:1536
  s_waitcnt lgkmcnt(10)
  ds_read_b64_tr_b16 v[64:65], v3 offset:2048
  ds_read_b64_tr_b16 v[66:67], v3 offset:2560
  s_waitcnt lgkmcnt(10)
  ds_read_b64_tr_b16 v[68:69], v3 offset:3072
  ds_read_b64_tr_b16 v[70:71], v3 offset:3584
  s_waitcnt lgkmcnt(10)
  s_add_u32 s49, s5, 2
  s_and_b32 s49, s49, 3
  s_mul_i32 s49, s49, 4096
  v_add_u32 v3, s49, v2
  ds_read_b64_tr_b16 v[72:73], v3 offset:0
  ds_read_b64_tr_b16 v[74:75], v3 offset:512
  s_waitcnt lgkmcnt(10)
  ds_read_b64_tr_b16 v[76:77], v3 offset:1024
  ds_read_b64_tr_b16 v[78:79], v3 offset:1536
  s_waitcnt lgkmcnt(10)
  ds_read_b64_tr_b16 v[80:81], v3 offset:2048
  ds_read_b64_tr_b16 v[82:83], v3 offset:2560
  s_waitcnt lgkmcnt(10)
  ds_read_b64_tr_b16 v[84:85], v3 offset:3072
  ds_read_b64_tr_b16 v[86:87], v3 offset:3584
  s_waitcnt lgkmcnt(10)
  s_add_u32 s49, s5, 3
  s_and_b32 s49, s49, 3
  s_mul_i32 s49, s49, 4096
  v_add_u32 v3, s49, v2
  ds_read_b64_tr_b16 v[88:89], v3 offset:0
  ds_read_b64_tr_b16 v[90:91], v3 offset:512
  s_waitcnt lgkmcnt(10)
  ds_read_b64_tr_b16 v[92:93], v3 offset:1024
  ds_read_b64_tr_b16 v[94:95], v3 offset:1536
  s_waitcnt lgkmcnt(10)
  ds_read_b64_tr_b16 v[96:97], v3 offset:2048
  ds_read_b64_tr_b16 v[98:99], v3 offset:2560
  s_waitcnt lgkmcnt(10)
  ds_read_b64_tr_b16 v[100:101], v3 offset:3072
  ds_read_b64_tr_b16 v[102:103], v3 offset:3584
  s_waitcnt lgkmcnt(10)
  s_waitcnt lgkmcnt(0)
  s_add_u32 s49, s5, 1
  s_and_b32 s49, s49, 3
  s_lshl_b32 s49, s49, 8
  v_add_u32 v0, s49, v14
  s_add_u32 s49, s5, 2
  s_and_b32 s49, s49, 3
  s_lshl_b32 s49, s49, 8
  v_add_u32 v2, s49, v14
  s_add_u32 s49, s5, 3
  s_and_b32 s49, s49, 3
  s_lshl_b32 s49, s49, 8
  v_add_u32 v3, s49, v14
  s_add_u32 s49, s5, 0
  s_and_b32 s49, s49, 3
  s_lshl_b32 s49, s49, 8
  v_add_u32 v14, s49, v14
  s_mov_b32 s70, 0
  s_mov_b32 s71, 15
  s_branch L_f1_c
L_f1_p:
  s_add_u32 s70, s70, 1
  s_cmp_ge_u32 s70, 262144
  s_cbranch_scc1 L_f1_ok
  s_bitcmp1_b32 s71, 0
  s_cbranch_scc0 L_fl_90
  global_load_dwordx4 v[104:107], v15, s[42:43] sc1
  global_load_dwordx4 v[108:111], v35, s[42:43] sc1
L_fl_90:
  s_bitcmp1_b32 s71, 1
  s_cbranch_scc0 L_fl_91
  global_load_dwordx4 v[112:115], v32, s[42:43] sc1
  global_load_dwordx4 v[116:119], v36, s[42:43] sc1
L_fl_91:
  s_bitcmp1_b32 s71, 2
  s_cbranch_scc0 L_fl_92
  global_load_dwordx4 v[120:123], v33, s[42:43] sc1
  global_load_dwordx4 v[124:127], v37, s[42:43] sc1
L_fl_92:
  s_bitcmp1_b32 s71, 3
  s_cbranch_scc0 L_fl_93
  global_load_dwordx4 v[128:131], v34, s[42:43] sc1
  global_load_dwordx4 v[132:135], v39, s[42:43] sc1
L_fl_93:
L_f1_c:
  s_waitcnt vmcnt(0)
  s_bitcmp1_b32 s71, 0
  s_cbranch_scc0 L_fc_94
  v_xor_b32 v104, s62, v104
  v_xor_b32 v105, s63, v105
  v_xor_b32 v106, s64, v106
  v_xor_b32 v107, s65, v107
  v_xor_b32 v108, s62, v108
  v_xor_b32 v109, s63, v109
  v_xor_b32 v110, s64, v110
  v_xor_b32 v111, s65, v111
  v_or3_b32 v8, v104, v105, v106
  v_or3_b32 v9, v107, v108, v109
  v_or3_b32 v8, v8, v110, v111
  v_pk_add_f32 v[136:137], v[104:105], v[108:109]
  v_pk_add_f32 v[138:139], v[106:107], v[110:111]
  v_or_b32 v8, v8, v9
  v_lshlrev_b32 v8, 24, v8
  v_cmp_ne_u32 vcc, 0, v8
  s_cmp_lg_u64 vcc, 0
  s_cbranch_scc1 L_fc_94
  s_bitset0_b32 s71, 0
L_fc_94:
  s_bitcmp1_b32 s71, 1
  s_cbranch_scc0 L_fc_95
  v_xor_b32 v112, s62, v112
  v_xor_b32 v113, s63, v113
  v_xor_b32 v114, s64, v114
  v_xor_b32 v115, s65, v115
  v_xor_b32 v116, s62, v116
  v_xor_b32 v117, s63, v117
  v_xor_b32 v118, s64, v118
  v_xor_b32 v119, s65, v119
  v_or3_b32 v8, v112, v113, v114
  v_or3_b32 v9, v115, v116, v117
  v_or3_b32 v8, v8, v118, v119
  v_pk_add_f32 v[144:145], v[112:113], v[116:117]
  v_pk_add_f32 v[146:147], v[114:115], v[118:119]
  v_or_b32 v8, v8, v9
  v_lshlrev_b32 v8, 24, v8
  v_cmp_ne_u32 vcc, 0, v8
  s_cmp_lg_u64 vcc, 0
  s_cbranch_scc1 L_fc_95
  s_bitset0_b32 s71, 1
L_fc_95:
  s_bitcmp1_b32 s71, 2
  s_cbranch_scc0 L_fc_96
  v_xor_b32 v120, s62, v120
  v_xor_b32 v121, s63, v121
  v_xor_b32 v122, s64, v122
  v_xor_b32 v123, s65, v123
  v_xor_b32 v124, s62, v124
  v_xor_b32 v125, s63, v125
  v_xor_b32 v126, s64, v126
  v_xor_b32 v127, s65, v127
  v_or3_b32 v8, v120, v121, v122
  v_or3_b32 v9, v123, v124, v125
  v_or3_b32 v8, v8, v126, v127
  v_pk_add_f32 v[152:153], v[120:121], v[124:125]
  v_pk_add_f32 v[154:155], v[122:123], v[126:127]
  v_or_b32 v8, v8, v9
  v_lshlrev_b32 v8, 24, v8
  v_cmp_ne_u32 vcc, 0, v8
  s_cmp_lg_u64 vcc, 0
  s_cbranch_scc1 L_fc_96
  s_bitset0_b32 s71, 2
L_fc_96:
  s_bitcmp1_b32 s71, 3
  s_cbranch_scc0 L_fc_97
  v_xor_b32 v128, s62, v128
  v_xor_b32 v129, s63, v129
  v_xor_b32 v130, s64, v130
  v_xor_b32 v131, s65, v131
  v_xor_b32 v132, s62, v132
  v_xor_b32 v133, s63, v133
  v_xor_b32 v134, s64, v134
  v_xor_b32 v135, s65, v135
  v_or3_b32 v8, v128, v129, v130
  v_or3_b32 v9, v131, v132, v133
  v_or3_b32 v8, v8, v134, v135
  v_pk_add_f32 v[160:161], v[128:129], v[132:133]
  v_pk_add_f32 v[162:163], v[130:131], v[134:135]
  v_or_b32 v8, v8, v9
  v_lshlrev_b32 v8, 24, v8
  v_cmp_ne_u32 vcc, 0, v8
  s_cmp_lg_u64 vcc, 0
  s_cbranch_scc1 L_fc_97
  s_bitset0_b32 s71, 3
L_fc_97:
  s_cmp_lg_u32 s71, 0
  s_cbranch_scc1 L_f1_p
L_f1_ok:
  v_pk_add_f32 v[136:137], v[136:137], v[144:145]
  v_pk_add_f32 v[138:139], v[138:139], v[146:147]
  v_pk_add_f32 v[152:153], v[152:153], v[160:161]
  v_pk_add_f32 v[154:155], v[154:155], v[162:163]
  v_pk_add_f32 v[136:137], v[136:137], v[152:153]
  v_pk_add_f32 v[138:139], v[138:139], v[154:155]
  v_pk_fma_f32 v[8:9], v[136:137], v[24:25], v[28:29]
  v_pk_fma_f32 v[10:11], v[138:139], v[26:27], v[30:31]
  v_cvt_pk_bf16_f32 v8, v8, v9
  v_cvt_pk_bf16_f32 v9, v10, v11
  ds_write_b64 v12, v[8:9] offset:0
  ds_read_b128 v[104:107], v14 offset:0
  ds_read_b128 v[108:111], v14 offset:64
  ds_read_b128 v[112:115], v14 offset:128
  ds_read_b128 v[116:119], v14 offset:192
  v_pk_fma_f32 v[16:17], v[136:137], v[20:21], v[16:17]
  v_pk_fma_f32 v[18:19], v[138:139], v[22:23], v[18:19]
  v_pk_mul_f32 v[10:11], v[16:17], v[16:17]
  v_pk_add_f32 v[20:21], v[16:17], v[18:19]
  v_pk_fma_f32 v[10:11], v[18:19], v[18:19], v[10:11]
  v_add_f32 v20, v20, v21
  v_add_f32 v21, v10, v11
  ds_write_b64 v5, v[20:21] offset:12032
  s_waitcnt lgkmcnt(0)
  s_barrier
  ds_read_b128 v[120:123], v0 offset:0
  ds_read_b128 v[124:127], v0 offset:64
  ds_read_b128 v[128:131], v0 offset:128
  ds_read_b128 v[132:135], v0 offset:192
  ds_read_b128 v[20:23], v7 offset:12032
  ds_read_b128 v[24:27], v7 offset:12048
  v_mfma_f32_16x16x32_bf16 v[32:35], v[40:43], v[104:107], 0
  ds_read_b128 v[136:139], v2 offset:0
  ds_read_b128 v[140:143], v2 offset:64
  v_mfma_f32_16x16x32_bf16 v[32:35], v[44:47], v[108:111], v[32:35]
  ds_read_b128 v[144:147], v2 offset:128
  ds_read_b128 v[148:151], v2 offset:192
  v_mfma_f32_16x16x32_bf16 v[32:35], v[48:51], v[112:115], v[32:35]
  ds_read_b128 v[152:155], v3 offset:0
  ds_read_b128 v[156:159], v3 offset:64
  v_mfma_f32_16x16x32_bf16 v[32:35], v[52:55], v[116:119], v[32:35]
  ds_read_b128 v[160:163], v3 offset:128
  ds_read_b128 v[164:167], v3 offset:192
  s_waitcnt lgkmcnt(13)
  v_mfma_f32_16x16x32_bf16 v[32:35], v[56:59], v[120:123], v[32:35]
  s_waitcnt lgkmcnt(12)
  v_mfma_f32_16x16x32_bf16 v[32:35], v[60:63], v[124:127], v[32:35]
  s_waitcnt lgkmcnt(8)
  v_pk_add_f32 v[20:21], v[20:21], v[22:23]
  v_pk_add_f32 v[24:25], v[24:25], v[26:27]
  v_mfma_f32_16x16x32_bf16 v[32:35], v[64:67], v[128:131], v[32:35]
  v_pk_add_f32 v[20:21], v[20:21], v[24:25]
  s_nop 0
  v_mfma_f32_16x16x32_bf16 v[32:35], v[68:71], v[132:135], v[32:35]
  v_add_f32_dpp v20, v20, v20 quad_perm:[2,3,0,1] row_mask:0xf bank_mask:0xf
  v_add_f32_dpp v21, v21, v21 quad_perm:[2,3,0,1] row_mask:0xf bank_mask:0xf
  s_waitcnt lgkmcnt(7)
  v_mfma_f32_16x16x32_bf16 v[32:35], v[72:75], v[136:139], v[32:35]
  v_add_f32_dpp v20, v20, v20 row_ror:4 row_mask:0xf bank_mask:0xf
  v_add_f32_dpp v21, v21, v21 row_ror:4 row_mask:0xf bank_mask:0xf
  s_waitcnt lgkmcnt(6)
  v_mfma_f32_16x16x32_bf16 v[32:35], v[76:79], v[140:143], v[32:35]
  v_add_f32_dpp v20, v20, v20 row_ror:8 row_mask:0xf bank_mask:0xf
  v_add_f32_dpp v21, v21, v21 row_ror:8 row_mask:0xf bank_mask:0xf
  s_waitcnt lgkmcnt(5)
  v_mfma_f32_16x16x32_bf16 v[32:35], v[80:83], v[144:147], v[32:35]
  v_mov_b32 v22, v20
  v_mov_b32 v23, v21
  s_waitcnt lgkmcnt(4)
  v_mfma_f32_16x16x32_bf16 v[32:35], v[84:87], v[148:151], v[32:35]
  v_permlane16_swap_b32 v22, v20
  v_permlane16_swap_b32 v23, v21
  s_waitcnt lgkmcnt(3)
  v_mfma_f32_16x16x32_bf16 v[32:35], v[88:91], v[152:155], v[32:35]
  v_add_f32 v20, v20, v22
  v_add_f32 v21, v21, v23
  v_mov_b32 v22, v20
  v_mov_b32 v23, v21
  s_waitcnt lgkmcnt(2)
  v_mfma_f32_16x16x32_bf16 v[32:35], v[92:95], v[156:159], v[32:35]
  v_permlane32_swap_b32 v22, v20
  v_permlane32_swap_b32 v23, v21
  s_waitcnt lgkmcnt(1)
  v_mfma_f32_16x16x32_bf16 v[32:35], v[96:99], v[160:163], v[32:35]
  v_add_f32 v20, v20, v22
  v_add_f32 v21, v21, v23
  s_waitcnt lgkmcnt(0)
  v_mfma_f32_16x16x32_bf16 v[32:35], v[100:103], v[164:167], v[32:35]
  v_mul_f32 v20, 0xbb000000, v20
  v_mul_f32 v21, 0x3b000000, v21
  v_fma_f32 v21, -v20, v20, v21
  v_max_f32 v21, 0, v21
  v_add_f32 v21, 0x3727c5ac, v21
  v_rsq_f32 v21, v21
  s_nop 1
  v_fmac_f32_dpp v32, v32, v20 row_shl:2 row_mask:0xf bank_mask:0x1
  v_fmac_f32_dpp v33, v33, v20 row_shl:2 row_mask:0xf bank_mask:0x1
  v_fmac_f32_dpp v34, v34, v20 row_shl:2 row_mask:0xf bank_mask:0x1
  v_fmac_f32_dpp v35, v35, v20 row_shl:2 row_mask:0xf bank_mask:0x1
  v_mul_f32 v8, v32, v21
  v_mul_f32 v9, v33, v21
  v_mul_f32 v10, v34, v21
  v_mul_f32 v11, v35, v21
  v_add_f32_dpp v8, v32, v8 row_shl:4 row_mask:0xf bank_mask:0xf
  v_add_f32_dpp v9, v33, v9 row_shl:4 row_mask:0xf bank_mask:0xf
  v_add_f32_dpp v10, v34, v10 row_shl:4 row_mask:0xf bank_mask:0xf
  v_add_f32_dpp v11, v35, v11 row_shl:4 row_mask:0xf bank_mask:0xf
  s_mov_b32 s50, 0x000f000f
  s_mov_b32 s51, 0x000f000f
  v_permlane32_swap_b32 v8, v10
  v_permlane32_swap_b32 v9, v11
  v_mul_f32 v20, 0xbfb8aa3b, v8
  v_mul_f32 v21, 0xbfb8aa3b, v9
  v_exp_f32 v20, v20
  v_exp_f32 v21, v21
  v_mul_f32 v8, v8, v10
  v_mul_f32 v9, v9, v11
  v_add_f32 v20, 1.0, v20
  v_add_f32 v21, 1.0, v21
  v_rcp_f32 v20, v20
  v_rcp_f32 v21, v21
  s_mov_b64 exec, s[50:51]
  v_mul_f32 v8, v8, v20
  v_mul_f32 v9, v9, v21
  v_cvt_pk_bf16_f32 v8, v8, v9
  v_mov_b32 v9, s74
  global_store_dwordx2 v13, v[8:9], s[42:43] sc1
  global_store_dwordx2 v4, v[8:9], s[42:43] sc1
  s_branch L_fin
L_t_f2:
  v_mov_b32 v2, v29
  s_and_b32 s59, s61, 3
  s_mul_i32 s59, s59, 3072
  s_mul_i32 s49, s5, 360448
  s_add_u32 s49, s49, s48
  s_mul_i32 s50, s5, 11264
  s_add_u32 s50, s50, 20480
  s_lshl_b32 s52, s59, 5
  s_add_u32 s49, s49, s52
  s_add_u32 s50, s50, s59
  s_sub_u32 s52, 11264, s59
  s_add_u32 s51, s50, s52
  s_cmp_lt_u32 s50, s51
  s_cbranch_scc0 L_dmae_99
L_dma_98:
  s_mov_b32 m0, s50
  s_add_u32 s50, s50, 1024
  buffer_load_dwordx4 v2, s[44:47], s49 offen  lds
  s_add_u32 s49, s49, 32768
  s_cmp_lt_u32 s50, s51
  s_cbranch_scc1 L_dma_98
L_dmae_99:
  s_mul_i32 s49, s5, 360448
  s_add_u32 s49, s49, s48
  s_mul_i32 s50, s5, 11264
  s_add_u32 s50, s50, 20480
  s_add_u32 s51, s50, s59
  s_cmp_lt_u32 s50, s51
  s_cbranch_scc0 L_dmae_101
L_dma_100:
  s_mov_b32 m0, s50
  s_add_u32 s50, s50, 1024
  buffer_load_dwordx4 v2, s[44:47], s49 offen  lds
  s_add_u32 s49, s49, 32768
  s_cmp_lt_u32 s50, s51
  s_cbranch_scc1 L_dma_100
L_dmae_101:
  v_mov_b32 v2, v6
  s_mov_b32 s50, 0x00030003
  s_mov_b32 s51, 0x00030003
  s_mov_b32 s53, 0x0fff0fff
  s_cmp_eq_u32 s5, 3
  s_cselect_b32 s52, 0x00ff00ff, s53
  s_mov_b32 s53, s52
  s_cmp_lg_u32 s5, 0
  s_cbranch_scc1 L_f2_w
  s_mov_b64 exec, s[50:51]
  global_load_dwordx4 v[104:107], v15, s[42:43] sc1
  global_load_dwordx4 v[108:111], v35, s[42:43] sc1
  global_load_dwordx4 v[112:115], v32, s[42:43] sc1
  global_load_dwordx4 v[116:119], v36, s[42:43] sc1
  global_load_dwordx4 v[120:123], v33, s[42:43] sc1
  global_load_dwordx4 v[124:127], v37, s[42:43] sc1
  global_load_dwordx4 v[128:131], v34, s[42:43] sc1
  global_load_dwordx4 v[132:135], v39, s[42:43] sc1
  s_mov_b64 exec, -1
  s_waitcnt vmcnt(8)
  s_branch L_f2_w2
L_f2_w:
  s_waitcnt vmcnt(0)
L_f2_w2:
  ds_read_b64_tr_b16 v[40:41], v2 offset:0
  ds_read_b64_tr_b16 v[42:43], v2 offset:128
  ds_read_b64_tr_b16 v[44:45], v2 offset:1024
  ds_read_b64_tr_b16 v[46:47], v2 offset:1152
  ds_read_b64_tr_b16 v[48:49], v2 offset:2048
  ds_read_b64_tr_b16 v[50:51], v2 offset:2176
  ds_read_b64_tr_b16 v[52:53], v2 offset:3072
  ds_read_b64_tr_b16 v[54:55], v2 offset:3200
  ds_read_b64_tr_b16 v[56:57], v2 offset:4096
  ds_read_b64_tr_b16 v[58:59], v2 offset:4224
  ds_read_b64_tr_b16 v[60:61], v2 offset:5120
  ds_read_b64_tr_b16 v[62:63], v2 offset:5248
  s_waitcnt lgkmcnt(10)
  ds_read_b64_tr_b16 v[64:65], v2 offset:6144
  ds_read_b64_tr_b16 v[66:67], v2 offset:6272
  s_waitcnt lgkmcnt(10)
  ds_read_b64_tr_b16 v[68:69], v2 offset:7168
  ds_read_b64_tr_b16 v[70:71], v2 offset:7296
  s_waitcnt lgkmcnt(10)
  ds_read_b64_tr_b16 v[72:73], v2 offset:8192
  ds_read_b64_tr_b16 v[74:75], v2 offset:8320
  s_waitcnt lgkmcnt(10)
  ds_read_b64_tr_b16 v[76:77], v2 offset:9216
  ds_read_b64_tr_b16 v[78:79], v2 offset:9344
  s_waitcnt lgkmcnt(10)
  ds_read_b64_tr_b16 v[80:81], v2 offset:10240
  ds_read_b64_tr_b16 v[82:83], v2 offset:10368
  s_waitcnt lgkmcnt(10)
  s_waitcnt lgkmcnt(0)
  s_cmp_lg_u32 s5, 0
  s_cbranch_scc1 L_f2x_102
  s_mov_b32 s70, 0
  s_mov_b64 exec, s[50:51]
  s_branch L_f2_ac
L_f2_a:
  s_mov_b64 exec, s[50:51]
  global_load_dwordx4 v[104:107], v15, s[42:43] sc1
  global_load_dwordx4 v[108:111], v35, s[42:43] sc1
  global_load_dwordx4 v[112:115], v32, s[42:43] sc1
  global_load_dwordx4 v[116:119], v36, s[42:43] sc1
  global_load_dwordx4 v[120:123], v33, s[42:43] sc1
  global_load_dwordx4 v[124:127], v37, s[42:43] sc1
  global_load_dwordx4 v[128:131], v34, s[42:43] sc1
  global_load_dwordx4 v[132:135], v39, s[42:43] sc1
L_f2_ac:
  s_waitcnt vmcnt(0)
  v_xor_b32 v136, s62, v104
  v_xor_b32 v137, s63, v105
  v_xor_b32 v138, s64, v106
  v_xor_b32 v139, s65, v107
  v_xor_b32 v140, s62, v108
  v_xor_b32 v141, s63, v109
  v_xor_b32 v142, s64, v110
  v_xor_b32 v143, s65, v111
  v_xor_b32 v144, s62, v112
  v_xor_b32 v145, s63, v113
  v_xor_b32 v146, s64, v114
  v_xor_b32 v147, s65, v115
  v_xor_b32 v148, s62, v116
  v_xor_b32 v149, s63, v117
  v_xor_b32 v150, s64, v118
  v_xor_b32 v151, s65, v119
  v_xor_b32 v152, s62, v120
  v_xor_b32 v153, s63, v121
  v_xor_b32 v154, s64, v122
  v_xor_b32 v155, s65, v123
  v_xor_b32 v156, s62, v124
  v_xor_b32 v157, s63, v125
  v_xor_b32 v158, s64, v126
  v_xor_b32 v159, s65, v127
  v_xor_b32 v160, s62, v128
  v_xor_b32 v161, s63, v129
  v_xor_b32 v162, s64, v130
  v_xor_b32 v163, s65, v131
  v_xor_b32 v164, s62, v132
  v_xor_b32 v165, s63, v133
  v_xor_b32 v166, s64, v134
  v_xor_b32 v167, s65, v135
  v_or3_b32 v8, v136, v137, v138
  v_or3_b32 v9, v144, v145, v146
  v_or3_b32 v10, v152, v153, v154
  v_or3_b32 v11, v160, v161, v162
  v_or3_b32 v8, v8, v139, v140
  v_or3_b32 v9, v9, v147, v148
  v_or3_b32 v10, v10, v155, v156
  v_or3_b32 v11, v11, v163, v164
  v_or3_b32 v8, v8, v141, v142
  v_or3_b32 v9, v9, v149, v150
  v_or3_b32 v10, v10, v157, v158
  v_or3_b32 v11, v11, v165, v166
  v_or_b32 v8, v8, v143
  v_or_b32 v9, v9, v151
  v_or_b32 v10, v10, v159
  v_or_b32 v11, v11, v167
  v_or3_b32 v3, v8, v9, v10
  v_or_b32 v3, v3, v11
  v_lshlrev_b32 v3, 24, v3
  v_cmp_ne_u32 vcc, 0, v3
  s_cmp_eq_u64 vcc, 0
  s_cbranch_scc1 L_f2_ad
  s_sleep 2
  s_add_u32 s70, s70, 1
  s_cmp_lt_u32 s70, 262144
  s_cbranch_scc1 L_f2_a
L_f2_ad:
  s_mov_b64 exec, -1
  v_pk_add_f32 v[136:137], v[136:137], v[140:141]
  v_pk_add_f32 v[138:139], v[138:139], v[142:143]
  v_pk_add_f32 v[144:145], v[144:145], v[148:149]
  v_pk_add_f32 v[146:147], v[146:147], v[150:151]
  v_pk_add_f32 v[152:153], v[152:153], v[156:157]
  v_pk_add_f32 v[154:155], v[154:155], v[158:159]
  v_pk_add_f32 v[160:161], v[160:161], v[164:165]
  v_pk_add_f32 v[162:163], v[162:163], v[166:167]
  v_pk_add_f32 v[136:137], v[136:137], v[144:145]
  v_pk_add_f32 v[138:139], v[138:139], v[146:147]
  v_pk_add_f32 v[152:153], v[152:153], v[160:161]
  v_pk_add_f32 v[154:155], v[154:155], v[162:163]
  v_pk_add_f32 v[136:137], v[136:137], v[152:153]
  v_pk_add_f32 v[138:139], v[138:139], v[154:155]
  v_cvt_pk_bf16_f32 v136, 0, v136
  v_cvt_pk_bf16_f32 v137, 0, v137
  v_cvt_pk_bf16_f32 v138, 0, v138
  v_cvt_pk_bf16_f32 v139, 0, v139
  v_mul_f32 v136, v136, v20
  v_mul_f32 v137, v137, v21
  v_mul_f32 v138, v138, v22
  v_mul_f32 v139, v139, v23
  v_cvt_pk_bf16_f32 v136, 0, v136
  v_cvt_pk_bf16_f32 v137, 0, v137
  v_cvt_pk_bf16_f32 v138, 0, v138
  v_cvt_pk_bf16_f32 v139, 0, v139
  v_add_f32 v16, v16, v136
  v_add_f32 v17, v17, v137
  v_add_f32 v18, v18, v138
  v_add_f32 v19, v19, v139
  v_cvt_pk_bf16_f32 v16, 0, v16
  v_cvt_pk_bf16_f32 v17, 0, v17
  v_cvt_pk_bf16_f32 v18, 0, v18
  v_cvt_pk_bf16_f32 v19, 0, v19
L_f2x_102:
  v_mov_b32 v112, 0
  v_mov_b32 v113, 0
  v_mov_b32 v114, 0
  v_mov_b32 v115, 0
  s_mov_b32 s70, 0
L_f2_p:
  global_load_dwordx4 v[104:107], v28, s[42:43] offset:-2048 sc1
  global_load_dwordx4 v[108:111], v28, s[42:43] sc1
  s_mov_b64 exec, s[52:53]
  global_load_dwordx4 v[112:115], v28, s[42:43] offset:2048 sc1
  s_mov_b64 exec, -1
  s_waitcnt vmcnt(2)
  v_xor_b32 v105, s74, v105
  v_xor_b32 v107, s74, v107
  s_waitcnt vmcnt(1)
  v_xor_b32 v109, s74, v109
  v_xor_b32 v111, s74, v111
  s_waitcnt vmcnt(0)
  v_xor_b32 v113, s74, v113
  v_xor_b32 v115, s74, v115
  v_or3_b32 v31, v105, v107, v109
  v_or_b32 v3, v113, v115
  v_or_b32 v31, v111, v31
  v_cmp_ne_u32 s[68:69], 0, v3
  v_cmp_ne_u32 vcc, 0, v31
  v_mov_b32_dpp v105, v104 quad_perm:[2,3,2,3] row_mask:0xf bank_mask:0xf
  v_mov_b32_dpp v107, v106 quad_perm:[2,3,2,3] row_mask:0xf bank_mask:0xf
  v_mov_b32_dpp v109, v108 quad_perm:[2,3,2,3] row_mask:0xf bank_mask:0xf
  v_mov_b32_dpp v111, v110 quad_perm:[2,3,2,3] row_mask:0xf bank_mask:0xf
  v_mov_b32_dpp v113, v112 quad_perm:[2,3,2,3] row_mask:0xf bank_mask:0xf
  v_mov_b32_dpp v115, v114 quad_perm:[2,3,2,3] row_mask:0xf bank_mask:0xf
  s_and_b64 s[68:69], s[68:69], s[52:53]
  s_or_b64 vcc, vcc, s[68:69]
  v_mfma_f32_16x16x32_bf16 v[120:123], v[40:43], v[104:107], 0
  v_mfma_f32_16x16x32_bf16 v[124:127], v[44:47], v[104:107], 0
  v_mfma_f32_16x16x32_bf16 v[128:131], v[48:51], v[104:107], 0
  v_mfma_f32_16x16x32_bf16 v[132:135], v[52:55], v[104:107], 0
  s_cmp_eq_u64 vcc, 0
  s_cbranch_scc1 L_f2_ok
  s_add_u32 s70, s70, 1
  s_cmp_lt_u32 s70, 262144
  s_cbranch_scc1 L_f2_p
L_f2_ok:
  v_mfma_f32_16x16x32_bf16 v[120:123], v[56:59], v[108:111], v[120:123]
  v_mfma_f32_16x16x32_bf16 v[124:127], v[60:63], v[108:111], v[124:127]
  v_mfma_f32_16x16x32_bf16 v[128:131], v[64:67], v[108:111], v[128:131]
  v_mfma_f32_16x16x32_bf16 v[132:135], v[68:71], v[108:111], v[132:135]
  v_mfma_f32_16x16x32_bf16 v[120:123], v[72:75], v[112:115], v[120:123]
  v_mfma_f32_16x16x32_bf16 v[124:127], v[76:79], v[112:115], v[124:127]
  v_mfma_f32_16x16x32_bf16 v[128:131], v[80:83], v[112:115], v[128:131]
  s_nop 6
  v_add_f32_dpp v8, v124, v120 row_shl:4 row_mask:0xf bank_mask:0xf
  v_add_f32_dpp v9, v125, v121 row_shl:4 row_mask:0xf bank_mask:0xf
  v_add_f32_dpp v10, v126, v122 row_shl:4 row_mask:0xf bank_mask:0xf
  v_add_f32_dpp v11, v127, v123 row_shl:4 row_mask:0xf bank_mask:0xf
  v_add_f32_dpp v128, v132, v128 row_shl:4 row_mask:0xf bank_mask:0xf
  v_add_f32_dpp v129, v133, v129 row_shl:4 row_mask:0xf bank_mask:0xf
  v_add_f32_dpp v130, v134, v130 row_shl:4 row_mask:0xf bank_mask:0xf
  v_add_f32_dpp v131, v135, v131 row_shl:4 row_mask:0xf bank_mask:0xf
  v_add_f32_dpp v8, v128, v8 row_shl:8 row_mask:0xf bank_mask:0xf
  v_add_f32_dpp v9, v129, v9 row_shl:8 row_mask:0xf bank_mask:0xf
  v_add_f32_dpp v10, v130, v10 row_shl:8 row_mask:0xf bank_mask:0xf
  v_add_f32_dpp v11, v131, v11 row_shl:8 row_mask:0xf bank_mask:0xf
  s_mov_b64 exec, s[50:51]
  ds_write_b128 v30, v[8:11]
  s_waitcnt lgkmcnt(0)
  s_barrier
  s_cmp_lg_u32 s5, s77
  s_cbranch_scc1 L_fin
  ds_read_b128 v[104:107], v12 offset:128
  ds_read_b128 v[108:111], v12 offset:256
  ds_read_b128 v[112:115], v12 offset:384
  s_waitcnt lgkmcnt(2)
  v_pk_add_f32 v[8:9], v[8:9], v[104:105]
  v_pk_add_f32 v[10:11], v[10:11], v[106:107]
  s_waitcnt lgkmcnt(0)
  v_pk_add_f32 v[108:109], v[108:109], v[112:113]
  v_pk_add_f32 v[110:111], v[110:111], v[114:115]
  v_pk_add_f32 v[8:9], v[8:9], v[108:109]
  v_pk_add_f32 v[10:11], v[10:11], v[110:111]
  v_pk_fma_f32 v[8:9], v[8:9], v[24:25], v[16:17]
  v_pk_fma_f32 v[10:11], v[10:11], v[26:27], v[18:19]
  v_cvt_pk_bf16_f32 v8, v8, v9
  v_cvt_pk_bf16_f32 v9, v10, v11
  global_store_dwordx2 v13, v[8:9], s[38:39]
  s_mov_b64 exec, 1
  s_cmp_lg_u32 s61, 0
  s_cbranch_scc1 L_noep
  v_mov_b32 v10, s74
  global_store_dword v38, v10, s[42:43] offset:0
L_noep:
L_fin:
L_end:
  s_endpgm
.p2align 7
L_table:
  .long 0x03803816, 0x0380300d, 0x03803065, 0x03802825, 0x03803075, 0x0380388e, 0x0380303d, 0x0380397e
  .long 0x07803866, 0x078038b6, 0x0780389e, 0x078038c6, 0x03803809, 0x078038d6, 0x0780392e, 0x07803856
  .long 0x0b803005, 0x0b80305d, 0x0b80382e, 0x0b803836, 0x07803916, 0x0b80395e, 0x0b803806, 0x03803811
  .long 0x0f80301d, 0x0f80386e, 0x0f804196, 0x0f8039ee, 0x0b80302d, 0x0f80396e, 0x0f803896, 0x0b8038ee
  .long 0x1380381e, 0x13802855, 0x138039e6, 0x138038de, 0x0f8038ce, 0x138039b6, 0x13803976, 0x0f803045
  .long 0x1780304d, 0x178039d6, 0x178038be, 0x178039a6, 0x13803886, 0x17802835, 0x178039be, 0x138038a6
  .long 0x1b8039ce, 0x1b80398e, 0x03803831, 0x1b80286d, 0x1780391e, 0x1b803846, 0x03803831, 0x17803936
  .long 0x1f803986, 0x1f80385e, 0x1b803015, 0x1f803956, 0x1b80383e, 0x1f80287d, 0x1b80384e, 0x1b8031c6
  .long 0x039c4001, 0x03983801, 0x1f983876, 0x03943801, 0x1f9839ae, 0x039c4001, 0x03983801, 0x1f9c380e
  .long 0x239c38f6, 0x039c4009, 0x039c4009, 0x039c4009, 0x239c28dc, 0x239c3926, 0x039c4009, 0x039c4009
  .long 0x03983811, 0x03983811, 0x239c3906, 0x239c387e, 0x039c4011, 0x279c39fe, 0x1f9c38e6, 0x239c295c
  .long 0x03983819, 0x239c38fe, 0x03a03819, 0x039c3019, 0x03983819, 0x039c3019, 0x039c3019, 0x279c39de
  .long 0x039c4021, 0x27943026, 0x279c394e, 0x279c390e, 0x039c4021, 0x039c4021, 0x039c4021, 0x03983821
  .long 0x279838ae, 0x039c4029, 0x039c4029, 0x039c4029, 0x279c3966, 0x03943829, 0x239c399e, 0x039c4029
  .long 0x2b9c393e, 0x039c4031, 0x2b9c289c, 0x03943831, 0x039c4031, 0x039c4031, 0x279c291c, 0x039c4031
  .long 0x039c4039, 0x2b9c3946, 0x03983839, 0x039c4039, 0x2b9c39f6, 0x03943839, 0x039c4039, 0x03983839
  .long 0x2fbc3094, 0x83b4404a, 0x03b44001, 0x03b050aa, 0x03b44001, 0x2bbc3154, 0x83b44122, 0x03b83801
  .long 0x03b83809, 0x2fbc30ec, 0x2fbc30f4, 0x2bbc30fc, 0x83b048ba, 0x03b83809, 0x2bbc3114, 0x2bbc316c
  .long 0x83b4400a, 0x87b4403a, 0x03b83811, 0x03b83811, 0x2fbc3104, 0x03b83811, 0x03b83811, 0x83b0493a
  .long 0x87b4402a, 0x03b83819, 0x33bc30ac, 0x2fb428b4, 0x87b440c2, 0x2fb4297c, 0x2fb428cc, 0x03b83819
  .long 0x33bc312c, 0x03ac3821, 0x03b83821, 0x03b83821, 0x33bc30bc, 0x33bc30c4, 0x33bc3084, 0x87b4414a
  .long 0x03b44029, 0x33bc3134, 0x37bc313c, 0x33bc3144, 0x03b83829, 0x03b050ea, 0x03b83829, 0x2fbc30d4
  .long 0x03b83831, 0x37bc30a4, 0x83b0487a, 0x03b0509a, 0x37bc314c, 0x37bc310c, 0x87b0491a, 0x33bc3124
  .long 0x37bc30e4, 0x03b83839, 0x87b4406a, 0x37bc3174, 0x03b83839, 0x03b050e2, 0x37bc3164, 0x37b4288c
  .long 0x43d4580b, 0x03d45842, 0x53d45843, 0x03d850a2, 0x63d4589b, 0x6bd458bb, 0x03d4590a, 0x03d45952
  .long 0x03d45812, 0x4bd45833, 0x57d45853, 0x5bd45873, 0x03d458d2, 0x03d458fa, 0x73d458cb, 0x7bd458e3
  .long 0x03d4581a, 0x03d45852, 0x03d45882, 0x03d45892, 0x67d45893, 0x6fd458ab, 0x03d45912, 0x03d45942
  .long 0x03d45802, 0x03d45832, 0xd3d4584b, 0x3bc87000, 0x03d458da, 0x3bc87000, 0x3bc87000, 0x7fd458eb
  .long 0x47d4581b, 0x3bc87000, 0x03d45862, 0x5fd4586b, 0xdbd45883, 0x83d458b3, 0x77d458d3, 0x03d45932
  .long 0xc3d45803, 0x4fd4582b, 0xd7d4585b, 0x83d4587b, 0x03d458b2, 0x03d85102, 0xe3d458c3, 0xebd458f3
  .long 0x03d45822, 0xcbd4583b, 0x03d4585a, 0x03d8508a, 0xdfd4588b, 0x87d458a3, 0x03d4592a, 0xefd458fb
  .long 0xc7d45813, 0xcfd45823, 0x03d45872, 0x87d45863, 0x03d458ca, 0x03d850f2, 0xe7d458db, 0x3bc87000
L_gtab:
  .long 0x017c0000, 0x00000000
  .long 0x02bc0180, 0x00000080
  .long 0x043c02c0, 0x00000100
  .long 0x057c0440, 0x00000180
  .long 0x06fc0580, 0x00000200
  .long 0x083c0700, 0x00000280
  .long 0x097c0840, 0x00000300
  .long 0x0abc0980, 0x00000380
.section .rodata,"a"
.p2align 6
.amdhsa_kernel adaLN_cond__sliding_block_cached__glu_gated_swiglu__decode_kernel
  .amdhsa_next_free_vgpr 168
  .amdhsa_next_free_sgpr 102
  .amdhsa_accum_offset 168
  .amdhsa_group_segment_fixed_size 0
  .amdhsa_kernarg_size 112
  .amdhsa_user_sgpr_count 2
  .amdhsa_user_sgpr_kernarg_segment_ptr 1
  .amdhsa_system_sgpr_workgroup_id_x 1
.end_amdhsa_kernel
```

```asm
; @launch grid=(256,1,1) block=(768,1,1) lds=151552
.amdgcn_target "amdgcn-amd-amdhsa--gfx950"
.text
.globl adaLN_cond__sliding_block_cached__glu_gated_swiglu__decode_kernel
.p2align 8
.type adaLN_cond__sliding_block_cached__glu_gated_swiglu__decode_kernel,@function
adaLN_cond__sliding_block_cached__glu_gated_swiglu__decode_kernel:
  s_cmpk_ge_u32 s2, 256
  s_cbranch_scc1 L_end
  s_load_dwordx2 s[44:45], s[0:1], 8
  v_readfirstlane_b32 s5, v0
  s_and_b32 s6, s2, 63
  s_lshr_b32 s7, s2, 6
  s_lshr_b32 s5, s5, 6
  v_and_b32 v1, 63, v0
  s_cmp_lt_u32 s5, 4
  s_cbranch_scc1 L_helper
  s_lshl_b32 s10, s6, 22
  s_lshl_b32 s11, s5, 9
  s_add_u32 s11, s11, s10
  s_add_u32 s11, s11, 3143680
  v_lshrrev_b32 v3, 5, v1
  v_lshl_add_u32 v2, v1, 4, s11
  v_mul_u32_u24 v3, 32256, v3
  s_mul_i32 s12, s2, 9
  s_lshr_b32 s12, s12, 3
  s_and_b32 s12, s12, 15
  s_mul_i32 s58, s7, 28
  v_add_u32 v2, v2, v3
  s_add_u32 s12, s12, s58
  s_and_b32 s13, s12, -8
  s_add_u32 s12, s12, s13
  s_lshl_b32 s12, s12, 12
  s_lshl_b32 s46, 1, 28
  s_lshl_b32 s47, 1, 17
  s_mov_b32 s19, 36864
  s_waitcnt lgkmcnt(0)
L_nb1:
  buffer_load_dwordx4 v[56:59], v2, s[44:47], s12 offen nt
  s_add_u32 s12, s12, s19
  s_bitset0_b32 s12, 15
  buffer_load_dwordx4 v[60:63], v2, s[44:47], s12 offen nt
  s_add_u32 s12, s12, s19
  s_bitset0_b32 s12, 15
  buffer_load_dwordx4 v[64:67], v2, s[44:47], s12 offen nt
  s_add_u32 s12, s12, s19
  s_bitset0_b32 s12, 15
  s_getpc_b64 s[56:57]
L_pc:
  s_lshl_b32 s3, s2, 2
  s_add_u32 s3, s3, L_table-L_pc
  s_load_dword s14, s[56:57], s3
  s_load_dwordx2 s[48:49], s[0:1], 16
  s_load_dwordx4 s[20:23], s[0:1], 24
  s_load_dwordx2 s[28:29], s[0:1], 80
  s_load_dwordx2 s[42:43], s[0:1], 104
  s_getreg_b32 s68, hwreg(HW_REG_XCC_ID, 0, 3)
  s_lshr_b32 s68, 85, s68
  s_barrier
  s_sub_u32 s9, s5, 4
  s_mov_b64 s[50:51], s[46:47]
  s_mov_b32 s52, 0xcccccccc
  s_mov_b32 s53, 0xcccccccc
  s_mov_b32 s54, 0xaaaaaaaa
  s_mov_b32 s55, 0xaaaaaaaa
  s_mul_i32 s15, s9, 8192
  s_add_u32 s15, s15, 86016
  s_add_u32 s59, s58, 28
  s_and_b32 s13, s58, -8
  s_add_u32 s58, s58, s13
  s_lshl_b32 s58, s58, 12
  s_and_b32 s13, s59, -8
  s_add_u32 s59, s59, s13
  s_lshl_b32 s59, s59, 12
  s_lshl_b32 s13, s9, 9
  v_subrev_u32 v0, s13, v2
  v_mov_b32 v4, 0
  v_lshrrev_b32 v5, 3, v1
  v_and_b32 v6, 6, v5
  v_xor_b32 v6, v6, v1
  v_and_b32 v6, 7, v6
  s_lshl_b32 s33, s9, 6
  s_movk_i32 s26, 6144
  s_mov_b32 s30, 3145728
  s_mov_b32 s31, s47
  s_lshl_b32 s34, s9, 13
  s_add_u32 s34, s34, 20480
  s_add_u32 s35, s34, 8192
  s_and_b32 s36, s2, 7
  s_lshl_b32 s36, s36, 1
  s_and_b32 s37, s9, 1
  s_add_u32 s36, s36, s37
  s_lshr_b32 s37, s9, 1
  s_lshl_b32 s37, s37, 4
  s_add_u32 s36, s36, s37
  s_lshl_b32 s36, s36, 6
  s_waitcnt lgkmcnt(0)
  s_and_b32 s27, s14, 7
  s_cmp_eq_u32 s27, 6
  s_cselect_b64 s[28:29], s[20:21], s[28:29]
  s_cselect_b32 s26, 0x2000, s26
  s_cselect_b32 s30, 0x400000, s30
  s_cmp_eq_u32 s27, 1
  s_cselect_b64 s[28:29], s[22:23], s[28:29]
  s_cselect_b32 s26, 0x400, s26
  s_cselect_b32 s30, 0x400000, s30
  s_cselect_b32 s33, s36, s33
  s_cselect_b32 s27, 4, s27
  v_mul_u32_u24 v5, s26, v5
  v_lshl_add_u32 v5, v6, 4, v5
  v_mov_b32 v6, 1
  s_mul_i32 s33, s33, s26
  s_bfe_u32 s32, s14, 0x60003
  s_lshl_b32 s32, s32, 7
  s_add_u32 s33, s33, s32
  s_lshl_b32 s26, s26, 3
  s_cmp_lt_u32 s27, 4
  s_cbranch_scc1 L_we_2
L_wl_1:
  s_mov_b32 m0, s34
  s_waitcnt vmcnt(4)
  buffer_load_dwordx4 v5, s[28:31], s33 offen nt lds
  s_add_u32 s33, s33, s26
  s_addk_i32 s34, 1024
  s_cmp_lt_u32 s34, s35
  s_cbranch_scc1 L_wl_1
L_we_2:
  s_waitcnt vmcnt(2)
  buffer_load_dwordx4 v[68:71], v2, s[44:47], s12 offen nt
  s_add_u32 s12, s12, s19
  s_bitset0_b32 s12, 15
  s_waitcnt vmcnt(2)
  buffer_load_dwordx4 v[72:75], v2, s[44:47], s12 offen nt
  s_add_u32 s12, s12, s19
  s_bitset0_b32 s12, 15
  s_waitcnt vmcnt(2)
  s_bitcmp0_b32 s68, 0
  s_cbranch_scc1 L_th_3
  s_waitcnt vmcnt(1)
L_th_3:
  buffer_load_dwordx4 v[76:79], v2, s[44:47], s12 offen nt
  s_add_u32 s12, s12, s19
  s_bitset0_b32 s12, 15
  s_cmp_lt_u32 s27, 4
  s_cbranch_scc1 L_ws_4
  s_mov_b64 exec, 1
  ds_add_u32 v4, v6 offset:6720
  s_mov_b64 exec, -1
L_ws_4:
  s_waitcnt vmcnt(2)
  buffer_load_dwordx4 v[80:83], v2, s[44:47], s12 offen nt
  s_add_u32 s12, s12, s19
  s_bitset0_b32 s12, 15
  s_waitcnt vmcnt(2)
  buffer_load_dwordx4 v[84:87], v2, s[44:47], s12 offen nt
  s_add_u32 s12, s12, s19
  s_bitset0_b32 s12, 15
  s_waitcnt vmcnt(2)
  s_bitcmp0_b32 s68, 0
  s_cbranch_scc1 L_th_5
  s_waitcnt vmcnt(1)
L_th_5:
  buffer_load_dwordx4 v[88:91], v2, s[44:47], s12 offen nt
  s_add_u32 s12, s12, s19
  s_bitset0_b32 s12, 15
  s_waitcnt vmcnt(2)
  buffer_load_dwordx4 v[92:95], v2, s[44:47], s12 offen nt
  s_add_u32 s12, s12, s19
  s_bitset0_b32 s12, 15
  s_waitcnt vmcnt(2)
  buffer_load_dwordx4 v[96:99], v2, s[44:47], s12 offen nt
  s_add_u32 s12, s12, s19
  s_bitset0_b32 s12, 15
  s_waitcnt vmcnt(2)
  s_bitcmp0_b32 s68, 0
  s_cbranch_scc1 L_th_6
  s_waitcnt vmcnt(1)
L_th_6:
  buffer_load_dwordx4 v[100:103], v2, s[44:47], s12 offen nt
  s_add_u32 s12, s12, s19
  s_bitset0_b32 s12, 15
  s_waitcnt vmcnt(2)
  buffer_load_dwordx4 v[104:107], v2, s[44:47], s12 offen nt
  s_add_u32 s12, s12, s19
  s_bitset0_b32 s12, 15
  s_cmp_ge_u32 s12, s59
  s_cselect_b32 s12, s58, s12
  s_waitcnt vmcnt(2)
  buffer_load_dwordx4 v[108:111], v2, s[44:47], s12 offen nt
  s_add_u32 s12, s12, s19
  s_bitset0_b32 s12, 15
  s_cmp_ge_u32 s12, s59
  s_cselect_b32 s12, s58, s12
  s_waitcnt vmcnt(2)
  s_bitcmp0_b32 s68, 0
  s_cbranch_scc1 L_th_7
  s_waitcnt vmcnt(1)
L_th_7:
  buffer_load_dwordx4 v[112:115], v2, s[44:47], s12 offen nt
  s_add_u32 s12, s12, s19
  s_bitset0_b32 s12, 15
  s_cmp_ge_u32 s12, s59
  s_cselect_b32 s12, s58, s12
  s_waitcnt vmcnt(2)
  buffer_load_dwordx4 v[116:119], v2, s[44:47], s12 offen nt
  s_add_u32 s12, s12, s19
  s_bitset0_b32 s12, 15
  s_cmp_ge_u32 s12, s59
  s_cselect_b32 s12, s58, s12
  s_waitcnt vmcnt(2)
  buffer_load_dwordx4 v[120:123], v2, s[44:47], s12 offen nt
  s_add_u32 s12, s12, s19
  s_bitset0_b32 s12, 15
  s_cmp_ge_u32 s12, s59
  s_cselect_b32 s12, s58, s12
  s_waitcnt vmcnt(2)
  s_bitcmp0_b32 s68, 0
  s_cbranch_scc1 L_th_8
  s_waitcnt vmcnt(1)
L_th_8:
  buffer_load_dwordx4 v[124:127], v2, s[44:47], s12 offen nt
  s_add_u32 s12, s12, s19
  s_bitset0_b32 s12, 15
  s_cmp_ge_u32 s12, s59
  s_cselect_b32 s12, s58, s12
  s_waitcnt vmcnt(2)
  buffer_load_dwordx4 v[128:131], v2, s[44:47], s12 offen nt
  s_add_u32 s12, s12, s19
  s_bitset0_b32 s12, 15
  s_cmp_ge_u32 s12, s59
  s_cselect_b32 s12, s58, s12
  ds_write_b32 v4, v4 offset:6672
  s_waitcnt vmcnt(2)
  buffer_load_dwordx4 v[132:135], v2, s[44:47], s12 offen nt
  s_add_u32 s12, s12, s19
  s_bitset0_b32 s12, 15
  s_cmp_ge_u32 s12, s59
  s_cselect_b32 s12, s58, s12
  s_waitcnt vmcnt(2)
  s_bitcmp0_b32 s68, 0
  s_cbranch_scc1 L_th_9
  s_waitcnt vmcnt(1)
L_th_9:
  buffer_load_dwordx4 v[136:139], v2, s[44:47], s12 offen nt
  s_add_u32 s12, s12, s19
  s_bitset0_b32 s12, 15
  s_cmp_ge_u32 s12, s59
  s_cselect_b32 s12, s58, s12
  s_waitcnt vmcnt(2)
  buffer_load_dwordx4 v[140:143], v2, s[44:47], s12 offen nt
  s_add_u32 s12, s12, s19
  s_bitset0_b32 s12, 15
  s_cmp_ge_u32 s12, s59
  s_cselect_b32 s12, s58, s12
  s_waitcnt vmcnt(2)
  buffer_load_dwordx4 v[144:147], v2, s[44:47], s12 offen nt
  s_add_u32 s12, s12, s19
  s_bitset0_b32 s12, 15
  s_cmp_ge_u32 s12, s59
  s_cselect_b32 s12, s58, s12
  s_bfe_u32 s61, s14, 0xa0010
  s_add_u32 s61, s61, s9
  s_and_b32 s13, s61, -64
  s_add_u32 s61, s61, s13
  s_lshl_b32 s61, s61, 9
  s_bfe_u32 s60, s14, 0x70009
  s_sub_u32 s60, s9, s60
  s_add_u32 s60, s60, 64
  s_lshr_b32 s60, s60, 3
  v_bfrev_b32 v3, v1
  v_lshrrev_b32 v3, 28, v3
  v_cmp_gt_u32 s[66:67], s60, v3
  v_and_b32 v3, 15, v1
  v_lshlrev_b32 v3, 4, v3
  s_mov_b32 s13, s61
  s_cmp_gt_u32 s60, 7
  s_cbranch_scc1 L_opts_10
  s_waitcnt vmcnt(2)
  s_bitcmp0_b32 s68, 0
  s_cbranch_scc1 L_th_11
  s_waitcnt vmcnt(1)
L_th_11:
  buffer_load_dwordx4 v[52:55], v0, s[44:47], s13 offen nt
  s_add_u32 s13, s13, s19
  s_bitset0_b32 s13, 15
  s_cmp_gt_u32 s60, 6
  s_cbranch_scc1 L_opts_10
  s_waitcnt vmcnt(2)
  buffer_load_dwordx4 v[48:51], v0, s[44:47], s13 offen nt
  s_add_u32 s13, s13, s19
  s_bitset0_b32 s13, 15
  s_cmp_gt_u32 s60, 5
  s_cbranch_scc1 L_opts_10
  s_waitcnt vmcnt(2)
  buffer_load_dwordx4 v[44:47], v0, s[44:47], s13 offen nt
  s_add_u32 s13, s13, s19
  s_bitset0_b32 s13, 15
  s_cmp_gt_u32 s60, 4
  s_cbranch_scc1 L_opts_10
  s_waitcnt vmcnt(2)
  s_bitcmp0_b32 s68, 0
  s_cbranch_scc1 L_th_12
  s_waitcnt vmcnt(1)
L_th_12:
  buffer_load_dwordx4 v[40:43], v0, s[44:47], s13 offen nt
  s_add_u32 s13, s13, s19
  s_bitset0_b32 s13, 15
  s_cmp_gt_u32 s60, 3
  s_cbranch_scc1 L_opts_10
  s_waitcnt vmcnt(2)
  buffer_load_dwordx4 v[36:39], v0, s[44:47], s13 offen nt
  s_add_u32 s13, s13, s19
  s_bitset0_b32 s13, 15
  s_cmp_gt_u32 s60, 2
  s_cbranch_scc1 L_opts_10
  s_waitcnt vmcnt(2)
  buffer_load_dwordx4 v[32:35], v0, s[44:47], s13 offen nt
  s_add_u32 s13, s13, s19
  s_bitset0_b32 s13, 15
  s_cmp_gt_u32 s60, 1
  s_cbranch_scc1 L_opts_10
  s_waitcnt vmcnt(2)
  s_bitcmp0_b32 s68, 0
  s_cbranch_scc1 L_th_13
  s_waitcnt vmcnt(1)
L_th_13:
  buffer_load_dwordx4 v[28:31], v0, s[44:47], s13 offen nt
  s_add_u32 s13, s13, s19
  s_bitset0_b32 s13, 15
  s_cmp_gt_u32 s60, 0
  s_cbranch_scc1 L_opts_10
  s_waitcnt vmcnt(2)
  buffer_load_dwordx4 v[24:27], v0, s[44:47], s13 offen nt
  s_add_u32 s13, s13, s19
  s_bitset0_b32 s13, 15
L_opts_10:
  s_waitcnt vmcnt(2)
  buffer_load_dwordx4 v[148:151], v2, s[44:47], s12 offen nt
  s_add_u32 s12, s12, s19
  s_bitset0_b32 s12, 15
  s_cmp_ge_u32 s12, s59
  s_cselect_b32 s12, s58, s12
  s_waitcnt vmcnt(2)
  s_bitcmp0_b32 s68, 0
  s_cbranch_scc1 L_th_14
  s_waitcnt vmcnt(1)
L_th_14:
  buffer_load_dwordx4 v[152:155], v2, s[44:47], s12 offen nt
  s_add_u32 s12, s12, s19
  s_bitset0_b32 s12, 15
  s_cmp_ge_u32 s12, s59
  s_cselect_b32 s12, s58, s12
  s_waitcnt vmcnt(2)
  buffer_load_dwordx4 v[156:159], v2, s[44:47], s12 offen nt
  s_add_u32 s12, s12, s19
  s_bitset0_b32 s12, 15
  s_cmp_ge_u32 s12, s59
  s_cselect_b32 s12, s58, s12
  s_waitcnt vmcnt(2)
  buffer_load_dwordx4 v[160:163], v2, s[44:47], s12 offen nt
  s_add_u32 s12, s12, s19
  s_bitset0_b32 s12, 15
  s_cmp_ge_u32 s12, s59
  s_cselect_b32 s12, s58, s12
  s_waitcnt vmcnt(2)
  s_bitcmp0_b32 s68, 0
  s_cbranch_scc1 L_th_15
  s_waitcnt vmcnt(1)
L_th_15:
  buffer_load_dwordx4 v[164:167], v2, s[44:47], s12 offen nt
  s_add_u32 s12, s12, s19
  s_bitset0_b32 s12, 15
  s_cmp_ge_u32 s12, s59
  s_cselect_b32 s12, s58, s12
  s_waitcnt vmcnt(2)
  s_add_u32 m0, s15, 0
  s_nop 0
  buffer_load_dwordx4 v2, s[48:51], s12 offen nt lds
  s_add_u32 s12, s12, s19
  s_bitset0_b32 s12, 15
  s_waitcnt vmcnt(2)
  s_add_u32 m0, s15, 1024
  s_nop 0
  buffer_load_dwordx4 v2, s[48:51], s12 offen nt lds
  s_add_u32 s12, s12, s19
  s_bitset0_b32 s12, 15
  s_waitcnt vmcnt(2)
  s_bitcmp0_b32 s68, 0
  s_cbranch_scc1 L_th_16
  s_waitcnt vmcnt(1)
L_th_16:
  s_add_u32 m0, s15, 2048
  s_nop 0
  buffer_load_dwordx4 v2, s[48:51], s12 offen nt lds
  s_add_u32 s12, s12, s19
  s_bitset0_b32 s12, 15
  ds_write_b32 v4, v4 offset:6664
  s_waitcnt vmcnt(2)
  s_add_u32 m0, s15, 3072
  s_nop 0
  buffer_load_dwordx4 v2, s[48:51], s12 offen nt lds
  s_add_u32 s12, s12, s19
  s_bitset0_b32 s12, 15
  s_waitcnt vmcnt(2)
  s_add_u32 m0, s15, 4096
  s_nop 0
  buffer_load_dwordx4 v2, s[48:51], s12 offen nt lds
  s_add_u32 s12, s12, s19
  s_bitset0_b32 s12, 15
  s_waitcnt vmcnt(2)
  s_bitcmp0_b32 s68, 0
  s_cbranch_scc1 L_th_17
  s_waitcnt vmcnt(1)
L_th_17:
  s_add_u32 m0, s15, 5120
  s_nop 0
  buffer_load_dwordx4 v2, s[48:51], s12 offen nt lds
  s_add_u32 s12, s12, s19
  s_bitset0_b32 s12, 15
  s_waitcnt vmcnt(2)
  s_add_u32 m0, s15, 6144
  s_nop 0
  buffer_load_dwordx4 v2, s[48:51], s12 offen nt lds
  s_add_u32 s12, s12, s19
  s_bitset0_b32 s12, 15
  s_waitcnt vmcnt(2)
  s_add_u32 m0, s15, 7168
  s_nop 0
  buffer_load_dwordx4 v2, s[48:51], s12 offen nt lds
  s_add_u32 s12, s12, s19
  s_bitset0_b32 s12, 15
  s_mov_b32 s70, 0
L_pl_18:
  ds_read_b128 v[4:7], v3 offset:6400
  s_waitcnt lgkmcnt(0)
  v_max3_u32 v8, v4, v5, v6
  v_max_u32 v8, v8, v7
  v_cmp_eq_u32 vcc, -1, v8
  s_cmp_eq_u64 vcc, 0
  s_cbranch_scc1 L_pld_19
  s_sleep 2
  s_add_u32 s70, s70, 1
  s_cmp_lt_u32 s70, 1048576
  s_cbranch_scc1 L_pl_18
L_pld_19:
  s_waitcnt vmcnt(8)
  v_dot2_f32_bf16 v8, v56, v4, 0
  v_dot2_f32_bf16 v9, v60, v4, 0
  v_dot2_f32_bf16 v10, v64, v4, 0
  v_dot2_f32_bf16 v11, v68, v4, 0
  v_dot2_f32_bf16 v12, v72, v4, 0
  v_dot2_f32_bf16 v13, v76, v4, 0
  v_dot2_f32_bf16 v14, v80, v4, 0
  v_dot2_f32_bf16 v15, v84, v4, 0
  v_dot2_f32_bf16 v8, v57, v5, v8
  v_dot2_f32_bf16 v9, v61, v5, v9
  v_dot2_f32_bf16 v10, v65, v5, v10
  v_dot2_f32_bf16 v11, v69, v5, v11
  v_dot2_f32_bf16 v12, v73, v5, v12
  v_dot2_f32_bf16 v13, v77, v5, v13
  v_dot2_f32_bf16 v14, v81, v5, v14
  v_dot2_f32_bf16 v15, v85, v5, v15
  v_dot2_f32_bf16 v8, v58, v6, v8
  v_dot2_f32_bf16 v9, v62, v6, v9
  v_dot2_f32_bf16 v10, v66, v6, v10
  v_dot2_f32_bf16 v11, v70, v6, v11
  v_dot2_f32_bf16 v12, v74, v6, v12
  v_dot2_f32_bf16 v13, v78, v6, v13
  v_dot2_f32_bf16 v14, v82, v6, v14
  v_dot2_f32_bf16 v15, v86, v6, v15
  v_dot2_f32_bf16 v8, v59, v7, v8
  v_dot2_f32_bf16 v9, v63, v7, v9
  v_dot2_f32_bf16 v10, v67, v7, v10
  v_dot2_f32_bf16 v11, v71, v7, v11
  v_dot2_f32_bf16 v12, v75, v7, v12
  v_dot2_f32_bf16 v13, v79, v7, v13
  v_dot2_f32_bf16 v14, v83, v7, v14
  v_dot2_f32_bf16 v15, v87, v7, v15
  v_add_f32_dpp v8, v8, v8 row_ror:8 row_mask:0xf bank_mask:0x3
  v_add_f32_dpp v8, v9, v9 row_ror:8 row_mask:0xf bank_mask:0xc
  v_add_f32_dpp v10, v10, v10 row_ror:8 row_mask:0xf bank_mask:0x3
  v_add_f32_dpp v10, v11, v11 row_ror:8 row_mask:0xf bank_mask:0xc
  v_add_f32_dpp v12, v12, v12 row_ror:8 row_mask:0xf bank_mask:0x3
  v_add_f32_dpp v12, v13, v13 row_ror:8 row_mask:0xf bank_mask:0xc
  v_add_f32_dpp v14, v14, v14 row_ror:8 row_mask:0xf bank_mask:0x3
  v_add_f32_dpp v14, v15, v15 row_ror:8 row_mask:0xf bank_mask:0xc
  v_add_f32_dpp v18, v8, v8 row_shl:4 row_mask:0xf bank_mask:0x5
  v_add_f32_dpp v18, v10, v10 row_shr:4 row_mask:0xf bank_mask:0xa
  v_add_f32_dpp v19, v12, v12 row_shl:4 row_mask:0xf bank_mask:0x5
  v_add_f32_dpp v19, v14, v14 row_shr:4 row_mask:0xf bank_mask:0xa
  v_dot2_f32_bf16 v8, v88, v4, 0
  v_dot2_f32_bf16 v9, v92, v4, 0
  v_dot2_f32_bf16 v10, v96, v4, 0
  v_dot2_f32_bf16 v11, v100, v4, 0
  v_dot2_f32_bf16 v12, v104, v4, 0
  v_dot2_f32_bf16 v13, v108, v4, 0
  v_dot2_f32_bf16 v14, v112, v4, 0
  v_dot2_f32_bf16 v15, v116, v4, 0
  v_dot2_f32_bf16 v8, v89, v5, v8
  v_dot2_f32_bf16 v9, v93, v5, v9
  v_dot2_f32_bf16 v10, v97, v5, v10
  v_dot2_f32_bf16 v11, v101, v5, v11
  v_dot2_f32_bf16 v12, v105, v5, v12
  v_dot2_f32_bf16 v13, v109, v5, v13
  v_dot2_f32_bf16 v14, v113, v5, v14
  v_dot2_f32_bf16 v15, v117, v5, v15
  v_dot2_f32_bf16 v8, v90, v6, v8
  v_dot2_f32_bf16 v9, v94, v6, v9
  v_dot2_f32_bf16 v10, v98, v6, v10
  v_dot2_f32_bf16 v11, v102, v6, v11
  v_dot2_f32_bf16 v12, v106, v6, v12
  v_dot2_f32_bf16 v13, v110, v6, v13
  v_dot2_f32_bf16 v14, v114, v6, v14
  v_dot2_f32_bf16 v15, v118, v6, v15
  v_dot2_f32_bf16 v8, v91, v7, v8
  v_dot2_f32_bf16 v9, v95, v7, v9
  v_dot2_f32_bf16 v10, v99, v7, v10
  v_dot2_f32_bf16 v11, v103, v7, v11
  v_dot2_f32_bf16 v12, v107, v7, v12
  v_dot2_f32_bf16 v13, v111, v7, v13
  v_dot2_f32_bf16 v14, v115, v7, v14
  v_dot2_f32_bf16 v15, v119, v7, v15
  v_add_f32_dpp v8, v8, v8 row_ror:8 row_mask:0xf bank_mask:0x3
  v_add_f32_dpp v8, v9, v9 row_ror:8 row_mask:0xf bank_mask:0xc
  v_add_f32_dpp v10, v10, v10 row_ror:8 row_mask:0xf bank_mask:0x3
  v_add_f32_dpp v10, v11, v11 row_ror:8 row_mask:0xf bank_mask:0xc
  v_add_f32_dpp v12, v12, v12 row_ror:8 row_mask:0xf bank_mask:0x3
  v_add_f32_dpp v12, v13, v13 row_ror:8 row_mask:0xf bank_mask:0xc
  v_add_f32_dpp v14, v14, v14 row_ror:8 row_mask:0xf bank_mask:0x3
  v_add_f32_dpp v14, v15, v15 row_ror:8 row_mask:0xf bank_mask:0xc
  v_add_f32_dpp v20, v8, v8 row_shl:4 row_mask:0xf bank_mask:0x5
  v_add_f32_dpp v20, v10, v10 row_shr:4 row_mask:0xf bank_mask:0xa
  v_add_f32_dpp v21, v12, v12 row_shl:4 row_mask:0xf bank_mask:0x5
  v_add_f32_dpp v21, v14, v14 row_shr:4 row_mask:0xf bank_mask:0xa
  v_dot2_f32_bf16 v8, v120, v4, 0
  v_dot2_f32_bf16 v9, v124, v4, 0
  v_dot2_f32_bf16 v10, v128, v4, 0
  v_dot2_f32_bf16 v11, v132, v4, 0
  v_dot2_f32_bf16 v12, v136, v4, 0
  v_dot2_f32_bf16 v13, v140, v4, 0
  v_dot2_f32_bf16 v14, v144, v4, 0
  v_dot2_f32_bf16 v15, v148, v4, 0
  v_dot2_f32_bf16 v8, v121, v5, v8
  v_dot2_f32_bf16 v9, v125, v5, v9
  v_dot2_f32_bf16 v10, v129, v5, v10
  v_dot2_f32_bf16 v11, v133, v5, v11
  v_dot2_f32_bf16 v12, v137, v5, v12
  v_dot2_f32_bf16 v13, v141, v5, v13
  v_dot2_f32_bf16 v14, v145, v5, v14
  v_dot2_f32_bf16 v15, v149, v5, v15
  v_dot2_f32_bf16 v8, v122, v6, v8
  v_dot2_f32_bf16 v9, v126, v6, v9
  v_dot2_f32_bf16 v10, v130, v6, v10
  v_dot2_f32_bf16 v11, v134, v6, v11
  v_dot2_f32_bf16 v12, v138, v6, v12
  v_dot2_f32_bf16 v13, v142, v6, v13
  v_dot2_f32_bf16 v14, v146, v6, v14
  v_dot2_f32_bf16 v15, v150, v6, v15
  v_dot2_f32_bf16 v8, v123, v7, v8
  v_dot2_f32_bf16 v9, v127, v7, v9
  v_dot2_f32_bf16 v10, v131, v7, v10
  v_dot2_f32_bf16 v11, v135, v7, v11
  v_dot2_f32_bf16 v12, v139, v7, v12
  v_dot2_f32_bf16 v13, v143, v7, v13
  v_dot2_f32_bf16 v14, v147, v7, v14
  v_dot2_f32_bf16 v15, v151, v7, v15
  buffer_load_dwordx4 v[88:91], v2, s[48:51], s12 offen nt
  s_add_u32 s12, s12, s19
  s_bitset0_b32 s12, 15
  v_add_f32_dpp v8, v8, v8 row_ror:8 row_mask:0xf bank_mask:0x3
  v_add_f32_dpp v8, v9, v9 row_ror:8 row_mask:0xf bank_mask:0xc
  v_add_f32_dpp v10, v10, v10 row_ror:8 row_mask:0xf bank_mask:0x3
  v_add_f32_dpp v10, v11, v11 row_ror:8 row_mask:0xf bank_mask:0xc
  v_add_f32_dpp v12, v12, v12 row_ror:8 row_mask:0xf bank_mask:0x3
  v_add_f32_dpp v12, v13, v13 row_ror:8 row_mask:0xf bank_mask:0xc
  v_add_f32_dpp v14, v14, v14 row_ror:8 row_mask:0xf bank_mask:0x3
  v_add_f32_dpp v14, v15, v15 row_ror:8 row_mask:0xf bank_mask:0xc
  v_add_f32_dpp v22, v8, v8 row_shl:4 row_mask:0xf bank_mask:0x5
  v_add_f32_dpp v22, v10, v10 row_shr:4 row_mask:0xf bank_mask:0xa
  v_add_f32_dpp v23, v12, v12 row_shl:4 row_mask:0xf bank_mask:0x5
  v_add_f32_dpp v23, v14, v14 row_shr:4 row_mask:0xf bank_mask:0xa
  v_dot2_f32_bf16 v8, v152, v4, 0
  v_dot2_f32_bf16 v9, v156, v4, 0
  v_dot2_f32_bf16 v10, v160, v4, 0
  v_dot2_f32_bf16 v11, v164, v4, 0
  v_dot2_f32_bf16 v8, v153, v5, v8
  v_dot2_f32_bf16 v9, v157, v5, v9
  v_dot2_f32_bf16 v10, v161, v5, v10
  v_dot2_f32_bf16 v11, v165, v5, v11
  v_dot2_f32_bf16 v8, v154, v6, v8
  v_dot2_f32_bf16 v9, v158, v6, v9
  v_dot2_f32_bf16 v10, v162, v6, v10
  v_dot2_f32_bf16 v11, v166, v6, v11
  v_dot2_f32_bf16 v8, v155, v7, v8
  v_dot2_f32_bf16 v9, v159, v7, v9
  v_dot2_f32_bf16 v10, v163, v7, v10
  v_dot2_f32_bf16 v11, v167, v7, v11
  v_add_f32_dpp v8, v8, v8 row_ror:8 row_mask:0xf bank_mask:0x3
  v_add_f32_dpp v8, v9, v9 row_ror:8 row_mask:0xf bank_mask:0xc
  v_add_f32_dpp v10, v10, v10 row_ror:8 row_mask:0xf bank_mask:0x3
  v_add_f32_dpp v10, v11, v11 row_ror:8 row_mask:0xf bank_mask:0xc
  s_nop 0
  v_add_f32_dpp v3, v8, v8 row_shl:4 row_mask:0xf bank_mask:0x5
  v_add_f32_dpp v3, v10, v10 row_shr:4 row_mask:0xf bank_mask:0xa
  v_dot2_f32_bf16 v8, v24, v4, 0
  v_dot2_f32_bf16 v9, v28, v4, 0
  v_dot2_f32_bf16 v10, v32, v4, 0
  v_dot2_f32_bf16 v11, v36, v4, 0
  v_dot2_f32_bf16 v12, v40, v4, 0
  v_dot2_f32_bf16 v13, v44, v4, 0
  v_dot2_f32_bf16 v14, v48, v4, 0
  v_dot2_f32_bf16 v15, v52, v4, 0
  v_dot2_f32_bf16 v8, v25, v5, v8
  v_dot2_f32_bf16 v9, v29, v5, v9
  v_dot2_f32_bf16 v10, v33, v5, v10
  v_dot2_f32_bf16 v11, v37, v5, v11
  v_dot2_f32_bf16 v12, v41, v5, v12
  v_dot2_f32_bf16 v13, v45, v5, v13
  v_dot2_f32_bf16 v14, v49, v5, v14
  v_dot2_f32_bf16 v15, v53, v5, v15
  v_dot2_f32_bf16 v8, v26, v6, v8
  v_dot2_f32_bf16 v9, v30, v6, v9
  v_dot2_f32_bf16 v10, v34, v6, v10
  v_dot2_f32_bf16 v11, v38, v6, v11
  v_dot2_f32_bf16 v12, v42, v6, v12
  v_dot2_f32_bf16 v13, v46, v6, v13
  v_dot2_f32_bf16 v14, v50, v6, v14
  v_dot2_f32_bf16 v15, v54, v6, v15
  v_dot2_f32_bf16 v8, v27, v7, v8
  v_dot2_f32_bf16 v9, v31, v7, v9
  v_dot2_f32_bf16 v10, v35, v7, v10
  v_dot2_f32_bf16 v11, v39, v7, v11
  v_dot2_f32_bf16 v12, v43, v7, v12
  v_dot2_f32_bf16 v13, v47, v7, v13
  v_dot2_f32_bf16 v14, v51, v7, v14
  v_dot2_f32_bf16 v15, v55, v7, v15
  buffer_load_dwordx4 v[92:95], v2, s[48:51], s12 offen nt
  s_add_u32 s12, s12, s19
  s_bitset0_b32 s12, 15
  v_add_f32_dpp v8, v8, v8 row_ror:8 row_mask:0xf bank_mask:0x3
  v_add_f32_dpp v8, v9, v9 row_ror:8 row_mask:0xf bank_mask:0xc
  v_add_f32_dpp v10, v10, v10 row_ror:8 row_mask:0xf bank_mask:0x3
  v_add_f32_dpp v10, v11, v11 row_ror:8 row_mask:0xf bank_mask:0xc
  v_add_f32_dpp v12, v12, v12 row_ror:8 row_mask:0xf bank_mask:0x3
  v_add_f32_dpp v12, v13, v13 row_ror:8 row_mask:0xf bank_mask:0xc
  v_add_f32_dpp v14, v14, v14 row_ror:8 row_mask:0xf bank_mask:0x3
  v_add_f32_dpp v14, v15, v15 row_ror:8 row_mask:0xf bank_mask:0xc
  v_add_f32_dpp v16, v8, v8 row_shl:4 row_mask:0xf bank_mask:0x5
  v_add_f32_dpp v16, v10, v10 row_shr:4 row_mask:0xf bank_mask:0xa
  v_add_f32_dpp v17, v12, v12 row_shl:4 row_mask:0xf bank_mask:0x5
  v_add_f32_dpp v17, v14, v14 row_shr:4 row_mask:0xf bank_mask:0xa
  v_add_f32_dpp v3, v3, v3 quad_perm:[2,3,0,1] row_mask:0xf bank_mask:0xf
  v_add_f32_dpp v18, v18, v18 quad_perm:[2,3,0,1] row_mask:0xf bank_mask:0xf
  v_add_f32_dpp v19, v19, v19 quad_perm:[2,3,0,1] row_mask:0xf bank_mask:0xf
  v_add_f32_dpp v20, v20, v20 quad_perm:[2,3,0,1] row_mask:0xf bank_mask:0xf
  v_add_f32_dpp v21, v21, v21 quad_perm:[2,3,0,1] row_mask:0xf bank_mask:0xf
  v_add_f32_dpp v22, v22, v22 quad_perm:[2,3,0,1] row_mask:0xf bank_mask:0xf
  v_add_f32_dpp v23, v23, v23 quad_perm:[2,3,0,1] row_mask:0xf bank_mask:0xf
  v_add_f32_dpp v16, v16, v16 quad_perm:[2,3,0,1] row_mask:0xf bank_mask:0xf
  v_add_f32_dpp v17, v17, v17 quad_perm:[2,3,0,1] row_mask:0xf bank_mask:0xf
  v_cndmask_b32 v8, v16, v17, s[52:53]
  v_cndmask_b32 v9, v18, v19, s[52:53]
  v_cndmask_b32 v10, v20, v21, s[52:53]
  v_cndmask_b32 v11, v22, v23, s[52:53]
  v_add_f32_dpp v18, v3, v3 quad_perm:[1,0,3,2] row_mask:0xf bank_mask:0xf
  v_add_f32_dpp v8, v8, v8 quad_perm:[1,0,3,2] row_mask:0xf bank_mask:0xf
  v_add_f32_dpp v9, v9, v9 quad_perm:[1,0,3,2] row_mask:0xf bank_mask:0xf
  v_add_f32_dpp v10, v10, v10 quad_perm:[1,0,3,2] row_mask:0xf bank_mask:0xf
  v_add_f32_dpp v11, v11, v11 quad_perm:[1,0,3,2] row_mask:0xf bank_mask:0xf
  v_cndmask_b32 v16, v8, v9, s[54:55]
  v_cndmask_b32 v17, v10, v11, s[54:55]
  v_cvt_pk_bf16_f32 v16, 0, v16
  v_cvt_pk_bf16_f32 v17, 0, v17
  v_cvt_pk_bf16_f32 v18, 0, v18
  v_mul_f32 v16, 0x3db504f3, v16
  v_mul_f32 v17, 0x3db504f3, v17
  v_mul_f32 v18, 0x3db504f3, v18
  v_cvt_pk_bf16_f32 v16, 0, v16
  v_cvt_pk_bf16_f32 v17, 0, v17
  v_cvt_pk_bf16_f32 v18, 0, v18
  v_mov_b32 v19, 0xff800000
  s_mov_b32 s52, 0xeeeeeeee
  s_mov_b32 s53, 0xeeeeeeee
  v_cndmask_b32 v16, v16, v19, s[66:67]
  v_cndmask_b32 v18, v18, v19, s[52:53]
  s_lshl_b32 s11, s9, 10
  v_lshl_add_u32 v3, v1, 4, s11
  ds_write_b128 v3, v[16:19] offset:12032
  s_waitcnt vmcnt(2)
  s_bitcmp0_b32 s68, 0
  s_cbranch_scc1 L_th_20
  s_waitcnt vmcnt(1)
L_th_20:
  buffer_load_dwordx4 v[96:99], v2, s[48:51], s12 offen nt
  s_add_u32 s12, s12, s19
  s_bitset0_b32 s12, 15
  v_lshl_add_u32 v3, v1, 4, s15
  ds_read_b128 v[56:59], v3 offset:0
  ds_read_b128 v[60:63], v3 offset:1024
  ds_read_b128 v[64:67], v3 offset:2048
  ds_read_b128 v[68:71], v3 offset:3072
  ds_read_b128 v[72:75], v3 offset:4096
  ds_read_b128 v[76:79], v3 offset:5120
  ds_read_b128 v[80:83], v3 offset:6144
  ds_read_b128 v[84:87], v3 offset:7168
  v_max3_f32 v22, v16, v17, v18
  s_nop 1
  v_max_f32_dpp v22, v22, v22 row_ror:8 row_mask:0xf bank_mask:0xf
  s_nop 1
  v_max_f32_dpp v22, v22, v22 row_ror:4 row_mask:0xf bank_mask:0xf
  s_nop 1
  v_max_f32_dpp v22, v22, v22 row_ror:2 row_mask:0xf bank_mask:0xf
  s_nop 1
  v_max_f32_dpp v22, v22, v22 row_ror:1 row_mask:0xf bank_mask:0xf
  v_mov_b32 v23, v22
  s_nop 1
  v_permlane16_swap_b32 v23, v22
  v_max_f32 v22, v22, v23
  v_mov_b32 v23, v22
  s_nop 1
  v_permlane32_swap_b32 v23, v22
  v_max_f32 v22, v22, v23
  v_sub_f32 v16, v16, v22
  v_sub_f32 v17, v17, v22
  v_sub_f32 v18, v18, v22
  v_mul_f32 v16, 0x3fb8aa3b, v16
  v_mul_f32 v17, 0x3fb8aa3b, v17
  v_mul_f32 v18, 0x3fb8aa3b, v18
  v_exp_f32 v16, v16
  v_exp_f32 v17, v17
  v_exp_f32 v18, v18
  s_nop 0
  v_cvt_pk_bf16_f32 v4, v16, 0
  v_cvt_pk_bf16_f32 v5, 0, v16
  v_cvt_pk_bf16_f32 v6, v17, 0
  v_cvt_pk_bf16_f32 v7, 0, v17
  v_cvt_pk_bf16_f32 v20, v18, 0
  v_cvt_pk_bf16_f32 v21, 0, v18
  v_mov_b32 v8, 0
  v_mov_b32 v9, 0
  v_mov_b32 v10, 0
  v_mov_b32 v11, 0
  v_mov_b32 v12, 0
  v_mov_b32 v13, 0
  v_mov_b32 v14, 0
  v_mov_b32 v15, 0
  s_lshl_b32 s11, s9, 9
  v_and_b32 v3, 15, v1
  v_lshlrev_b32 v3, 5, v3
  v_lshrrev_b32 v16, 4, v1
  v_lshl_add_u32 v3, v16, 3, v3
  v_add_u32 v3, s11, v3
  v_mov_b32 v16, 6656
  s_waitcnt lgkmcnt(0)
  s_mov_b32 s13, s61
  s_cmp_gt_u32 s60, 7
  s_cbranch_scc1 L_opts_21
  s_waitcnt vmcnt(2)
  buffer_load_dwordx4 v[52:55], v0, s[48:51], s13 offen nt
  s_add_u32 s13, s13, s19
  s_bitset0_b32 s13, 15
  s_cmp_gt_u32 s60, 6
  s_cbranch_scc1 L_opts_21
  s_waitcnt vmcnt(2)
  buffer_load_dwordx4 v[48:51], v0, s[48:51], s13 offen nt
  s_add_u32 s13, s13, s19
  s_bitset0_b32 s13, 15
  s_cmp_gt_u32 s60, 5
  s_cbranch_scc1 L_opts_21
  s_waitcnt vmcnt(2)
  s_bitcmp0_b32 s68, 0
  s_cbranch_scc1 L_th_22
  s_waitcnt vmcnt(1)
L_th_22:
  buffer_load_dwordx4 v[44:47], v0, s[48:51], s13 offen nt
  s_add_u32 s13, s13, s19
  s_bitset0_b32 s13, 15
  s_cmp_gt_u32 s60, 4
  s_cbranch_scc1 L_opts_21
  s_waitcnt vmcnt(2)
  buffer_load_dwordx4 v[40:43], v0, s[48:51], s13 offen nt
  s_add_u32 s13, s13, s19
  s_bitset0_b32 s13, 15
  s_cmp_gt_u32 s60, 3
  s_cbranch_scc1 L_opts_21
  s_waitcnt vmcnt(2)
  buffer_load_dwordx4 v[36:39], v0, s[48:51], s13 offen nt
  s_add_u32 s13, s13, s19
  s_bitset0_b32 s13, 15
  s_cmp_gt_u32 s60, 2
  s_cbranch_scc1 L_opts_21
  s_waitcnt vmcnt(2)
  s_bitcmp0_b32 s68, 0
  s_cbranch_scc1 L_th_23
  s_waitcnt vmcnt(1)
L_th_23:
  buffer_load_dwordx4 v[32:35], v0, s[48:51], s13 offen nt
  s_add_u32 s13, s13, s19
  s_bitset0_b32 s13, 15
  s_cmp_gt_u32 s60, 1
  s_cbranch_scc1 L_opts_21
  s_waitcnt vmcnt(2)
  buffer_load_dwordx4 v[28:31], v0, s[48:51], s13 offen nt
  s_add_u32 s13, s13, s19
  s_bitset0_b32 s13, 15
  s_cmp_gt_u32 s60, 0
  s_cbranch_scc1 L_opts_21
  s_waitcnt vmcnt(2)
  buffer_load_dwordx4 v[24:27], v0, s[48:51], s13 offen nt
  s_add_u32 s13, s13, s19
  s_bitset0_b32 s13, 15
L_opts_21:
  s_waitcnt vmcnt(2)
  s_bitcmp0_b32 s68, 0
  s_cbranch_scc1 L_th_24
  s_waitcnt vmcnt(1)
L_th_24:
  buffer_load_dwordx4 v[100:103], v2, s[48:51], s12 offen nt
  s_add_u32 s12, s12, s19
  s_bitset0_b32 s12, 15
  v_dot2c_f32_bf16_dpp v8, v4, v56 row_newbcast:1 row_mask:0xf bank_mask:0xf
  v_dot2c_f32_bf16_dpp v9, v5, v56 row_newbcast:1 row_mask:0xf bank_mask:0xf
  v_dot2c_f32_bf16_dpp v10, v4, v57 row_newbcast:1 row_mask:0xf bank_mask:0xf
  v_dot2c_f32_bf16_dpp v11, v5, v57 row_newbcast:1 row_mask:0xf bank_mask:0xf
  v_dot2c_f32_bf16_dpp v12, v4, v58 row_newbcast:1 row_mask:0xf bank_mask:0xf
  v_dot2c_f32_bf16_dpp v13, v5, v58 row_newbcast:1 row_mask:0xf bank_mask:0xf
  v_dot2c_f32_bf16_dpp v14, v4, v59 row_newbcast:1 row_mask:0xf bank_mask:0xf
  v_dot2c_f32_bf16_dpp v15, v5, v59 row_newbcast:1 row_mask:0xf bank_mask:0xf
  v_dot2c_f32_bf16_dpp v8, v4, v60 row_newbcast:9 row_mask:0xf bank_mask:0xf
  v_dot2c_f32_bf16_dpp v9, v5, v60 row_newbcast:9 row_mask:0xf bank_mask:0xf
  v_dot2c_f32_bf16_dpp v10, v4, v61 row_newbcast:9 row_mask:0xf bank_mask:0xf
  v_dot2c_f32_bf16_dpp v11, v5, v61 row_newbcast:9 row_mask:0xf bank_mask:0xf
  v_dot2c_f32_bf16_dpp v12, v4, v62 row_newbcast:9 row_mask:0xf bank_mask:0xf
  v_dot2c_f32_bf16_dpp v13, v5, v62 row_newbcast:9 row_mask:0xf bank_mask:0xf
  v_dot2c_f32_bf16_dpp v14, v4, v63 row_newbcast:9 row_mask:0xf bank_mask:0xf
  v_dot2c_f32_bf16_dpp v15, v5, v63 row_newbcast:9 row_mask:0xf bank_mask:0xf
  v_dot2c_f32_bf16_dpp v8, v4, v64 row_newbcast:5 row_mask:0xf bank_mask:0xf
  v_dot2c_f32_bf16_dpp v9, v5, v64 row_newbcast:5 row_mask:0xf bank_mask:0xf
  v_dot2c_f32_bf16_dpp v10, v4, v65 row_newbcast:5 row_mask:0xf bank_mask:0xf
  v_dot2c_f32_bf16_dpp v11, v5, v65 row_newbcast:5 row_mask:0xf bank_mask:0xf
  v_dot2c_f32_bf16_dpp v12, v4, v66 row_newbcast:5 row_mask:0xf bank_mask:0xf
  v_dot2c_f32_bf16_dpp v13, v5, v66 row_newbcast:5 row_mask:0xf bank_mask:0xf
  v_dot2c_f32_bf16_dpp v14, v4, v67 row_newbcast:5 row_mask:0xf bank_mask:0xf
  v_dot2c_f32_bf16_dpp v15, v5, v67 row_newbcast:5 row_mask:0xf bank_mask:0xf
  s_waitcnt vmcnt(2)
  buffer_load_dwordx4 v[104:107], v2, s[48:51], s12 offen nt
  s_add_u32 s12, s12, s19
  s_bitset0_b32 s12, 15
  s_cmp_ge_u32 s12, s59
  s_cselect_b32 s12, s58, s12
  v_dot2c_f32_bf16_dpp v8, v4, v68 row_newbcast:13 row_mask:0xf bank_mask:0xf
  v_dot2c_f32_bf16_dpp v9, v5, v68 row_newbcast:13 row_mask:0xf bank_mask:0xf
  v_dot2c_f32_bf16_dpp v10, v4, v69 row_newbcast:13 row_mask:0xf bank_mask:0xf
  v_dot2c_f32_bf16_dpp v11, v5, v69 row_newbcast:13 row_mask:0xf bank_mask:0xf
  v_dot2c_f32_bf16_dpp v12, v4, v70 row_newbcast:13 row_mask:0xf bank_mask:0xf
  v_dot2c_f32_bf16_dpp v13, v5, v70 row_newbcast:13 row_mask:0xf bank_mask:0xf
  v_dot2c_f32_bf16_dpp v14, v4, v71 row_newbcast:13 row_mask:0xf bank_mask:0xf
  v_dot2c_f32_bf16_dpp v15, v5, v71 row_newbcast:13 row_mask:0xf bank_mask:0xf
  v_dot2c_f32_bf16_dpp v8, v4, v72 row_newbcast:3 row_mask:0xf bank_mask:0xf
  v_dot2c_f32_bf16_dpp v9, v5, v72 row_newbcast:3 row_mask:0xf bank_mask:0xf
  v_dot2c_f32_bf16_dpp v10, v4, v73 row_newbcast:3 row_mask:0xf bank_mask:0xf
  v_dot2c_f32_bf16_dpp v11, v5, v73 row_newbcast:3 row_mask:0xf bank_mask:0xf
  v_dot2c_f32_bf16_dpp v12, v4, v74 row_newbcast:3 row_mask:0xf bank_mask:0xf
  v_dot2c_f32_bf16_dpp v13, v5, v74 row_newbcast:3 row_mask:0xf bank_mask:0xf
  v_dot2c_f32_bf16_dpp v14, v4, v75 row_newbcast:3 row_mask:0xf bank_mask:0xf
  v_dot2c_f32_bf16_dpp v15, v5, v75 row_newbcast:3 row_mask:0xf bank_mask:0xf
  v_dot2c_f32_bf16_dpp v8, v4, v76 row_newbcast:11 row_mask:0xf bank_mask:0xf
  v_dot2c_f32_bf16_dpp v9, v5, v76 row_newbcast:11 row_mask:0xf bank_mask:0xf
  v_dot2c_f32_bf16_dpp v10, v4, v77 row_newbcast:11 row_mask:0xf bank_mask:0xf
  v_dot2c_f32_bf16_dpp v11, v5, v77 row_newbcast:11 row_mask:0xf bank_mask:0xf
  v_dot2c_f32_bf16_dpp v12, v4, v78 row_newbcast:11 row_mask:0xf bank_mask:0xf
  v_dot2c_f32_bf16_dpp v13, v5, v78 row_newbcast:11 row_mask:0xf bank_mask:0xf
  v_dot2c_f32_bf16_dpp v14, v4, v79 row_newbcast:11 row_mask:0xf bank_mask:0xf
  v_dot2c_f32_bf16_dpp v15, v5, v79 row_newbcast:11 row_mask:0xf bank_mask:0xf
  s_waitcnt vmcnt(2)
  buffer_load_dwordx4 v[108:111], v2, s[48:51], s12 offen nt
  s_add_u32 s12, s12, s19
  s_bitset0_b32 s12, 15
  s_cmp_ge_u32 s12, s59
  s_cselect_b32 s12, s58, s12
  v_dot2c_f32_bf16_dpp v8, v4, v80 row_newbcast:7 row_mask:0xf bank_mask:0xf
  v_dot2c_f32_bf16_dpp v9, v5, v80 row_newbcast:7 row_mask:0xf bank_mask:0xf
  v_dot2c_f32_bf16_dpp v10, v4, v81 row_newbcast:7 row_mask:0xf bank_mask:0xf
  v_dot2c_f32_bf16_dpp v11, v5, v81 row_newbcast:7 row_mask:0xf bank_mask:0xf
  v_dot2c_f32_bf16_dpp v12, v4, v82 row_newbcast:7 row_mask:0xf bank_mask:0xf
  v_dot2c_f32_bf16_dpp v13, v5, v82 row_newbcast:7 row_mask:0xf bank_mask:0xf
  v_dot2c_f32_bf16_dpp v14, v4, v83 row_newbcast:7 row_mask:0xf bank_mask:0xf
  v_dot2c_f32_bf16_dpp v15, v5, v83 row_newbcast:7 row_mask:0xf bank_mask:0xf
  v_dot2c_f32_bf16_dpp v8, v4, v84 row_newbcast:15 row_mask:0xf bank_mask:0xf
  v_dot2c_f32_bf16_dpp v9, v5, v84 row_newbcast:15 row_mask:0xf bank_mask:0xf
  v_dot2c_f32_bf16_dpp v10, v4, v85 row_newbcast:15 row_mask:0xf bank_mask:0xf
  v_dot2c_f32_bf16_dpp v11, v5, v85 row_newbcast:15 row_mask:0xf bank_mask:0xf
  v_dot2c_f32_bf16_dpp v12, v4, v86 row_newbcast:15 row_mask:0xf bank_mask:0xf
  v_dot2c_f32_bf16_dpp v13, v5, v86 row_newbcast:15 row_mask:0xf bank_mask:0xf
  v_dot2c_f32_bf16_dpp v14, v4, v87 row_newbcast:15 row_mask:0xf bank_mask:0xf
  v_dot2c_f32_bf16_dpp v15, v5, v87 row_newbcast:15 row_mask:0xf bank_mask:0xf
  v_dot2c_f32_bf16_dpp v8, v6, v88 row_newbcast:0 row_mask:0xf bank_mask:0xf
  v_dot2c_f32_bf16_dpp v9, v7, v88 row_newbcast:0 row_mask:0xf bank_mask:0xf
  v_dot2c_f32_bf16_dpp v10, v6, v89 row_newbcast:0 row_mask:0xf bank_mask:0xf
  v_dot2c_f32_bf16_dpp v11, v7, v89 row_newbcast:0 row_mask:0xf bank_mask:0xf
  v_dot2c_f32_bf16_dpp v12, v6, v90 row_newbcast:0 row_mask:0xf bank_mask:0xf
  v_dot2c_f32_bf16_dpp v13, v7, v90 row_newbcast:0 row_mask:0xf bank_mask:0xf
  v_dot2c_f32_bf16_dpp v14, v6, v91 row_newbcast:0 row_mask:0xf bank_mask:0xf
  v_dot2c_f32_bf16_dpp v15, v7, v91 row_newbcast:0 row_mask:0xf bank_mask:0xf
  s_waitcnt vmcnt(2)
  s_bitcmp0_b32 s68, 0
  s_cbranch_scc1 L_th_25
  s_waitcnt vmcnt(1)
L_th_25:
  buffer_load_dwordx4 v[112:115], v2, s[48:51], s12 offen nt
  s_add_u32 s12, s12, s19
  s_bitset0_b32 s12, 15
  s_cmp_ge_u32 s12, s59
  s_cselect_b32 s12, s58, s12
  v_dot2c_f32_bf16_dpp v8, v6, v92 row_newbcast:8 row_mask:0xf bank_mask:0xf
  v_dot2c_f32_bf16_dpp v9, v7, v92 row_newbcast:8 row_mask:0xf bank_mask:0xf
  v_dot2c_f32_bf16_dpp v10, v6, v93 row_newbcast:8 row_mask:0xf bank_mask:0xf
  v_dot2c_f32_bf16_dpp v11, v7, v93 row_newbcast:8 row_mask:0xf bank_mask:0xf
  v_dot2c_f32_bf16_dpp v12, v6, v94 row_newbcast:8 row_mask:0xf bank_mask:0xf
  v_dot2c_f32_bf16_dpp v13, v7, v94 row_newbcast:8 row_mask:0xf bank_mask:0xf
  v_dot2c_f32_bf16_dpp v14, v6, v95 row_newbcast:8 row_mask:0xf bank_mask:0xf
  v_dot2c_f32_bf16_dpp v15, v7, v95 row_newbcast:8 row_mask:0xf bank_mask:0xf
  v_dot2c_f32_bf16_dpp v8, v6, v96 row_newbcast:4 row_mask:0xf bank_mask:0xf
  v_dot2c_f32_bf16_dpp v9, v7, v96 row_newbcast:4 row_mask:0xf bank_mask:0xf
  v_dot2c_f32_bf16_dpp v10, v6, v97 row_newbcast:4 row_mask:0xf bank_mask:0xf
  v_dot2c_f32_bf16_dpp v11, v7, v97 row_newbcast:4 row_mask:0xf bank_mask:0xf
  v_dot2c_f32_bf16_dpp v12, v6, v98 row_newbcast:4 row_mask:0xf bank_mask:0xf
  v_dot2c_f32_bf16_dpp v13, v7, v98 row_newbcast:4 row_mask:0xf bank_mask:0xf
  v_dot2c_f32_bf16_dpp v14, v6, v99 row_newbcast:4 row_mask:0xf bank_mask:0xf
  v_dot2c_f32_bf16_dpp v15, v7, v99 row_newbcast:4 row_mask:0xf bank_mask:0xf
  s_cmp_gt_u32 s60, 7
  s_cbranch_scc1 L_opt_26
  v_dot2c_f32_bf16_dpp v8, v4, v52 row_newbcast:14 row_mask:0xf bank_mask:0xf
  v_dot2c_f32_bf16_dpp v9, v5, v52 row_newbcast:14 row_mask:0xf bank_mask:0xf
  v_dot2c_f32_bf16_dpp v10, v4, v53 row_newbcast:14 row_mask:0xf bank_mask:0xf
  v_dot2c_f32_bf16_dpp v11, v5, v53 row_newbcast:14 row_mask:0xf bank_mask:0xf
  v_dot2c_f32_bf16_dpp v12, v4, v54 row_newbcast:14 row_mask:0xf bank_mask:0xf
  v_dot2c_f32_bf16_dpp v13, v5, v54 row_newbcast:14 row_mask:0xf bank_mask:0xf
  v_dot2c_f32_bf16_dpp v14, v4, v55 row_newbcast:14 row_mask:0xf bank_mask:0xf
  v_dot2c_f32_bf16_dpp v15, v5, v55 row_newbcast:14 row_mask:0xf bank_mask:0xf
L_opt_26:
  s_waitcnt vmcnt(2)
  buffer_load_dwordx4 v[116:119], v2, s[48:51], s12 offen nt
  s_add_u32 s12, s12, s19
  s_bitset0_b32 s12, 15
  s_cmp_ge_u32 s12, s59
  s_cselect_b32 s12, s58, s12
  s_cmp_gt_u32 s60, 6
  s_cbranch_scc1 L_opt_27
  v_dot2c_f32_bf16_dpp v8, v4, v48 row_newbcast:6 row_mask:0xf bank_mask:0xf
  v_dot2c_f32_bf16_dpp v9, v5, v48 row_newbcast:6 row_mask:0xf bank_mask:0xf
  v_dot2c_f32_bf16_dpp v10, v4, v49 row_newbcast:6 row_mask:0xf bank_mask:0xf
  v_dot2c_f32_bf16_dpp v11, v5, v49 row_newbcast:6 row_mask:0xf bank_mask:0xf
  v_dot2c_f32_bf16_dpp v12, v4, v50 row_newbcast:6 row_mask:0xf bank_mask:0xf
  v_dot2c_f32_bf16_dpp v13, v5, v50 row_newbcast:6 row_mask:0xf bank_mask:0xf
  v_dot2c_f32_bf16_dpp v14, v4, v51 row_newbcast:6 row_mask:0xf bank_mask:0xf
  v_dot2c_f32_bf16_dpp v15, v5, v51 row_newbcast:6 row_mask:0xf bank_mask:0xf
L_opt_27:
  s_cmp_gt_u32 s60, 5
  s_cbranch_scc1 L_opt_28
  v_dot2c_f32_bf16_dpp v8, v4, v44 row_newbcast:10 row_mask:0xf bank_mask:0xf
  v_dot2c_f32_bf16_dpp v9, v5, v44 row_newbcast:10 row_mask:0xf bank_mask:0xf
  v_dot2c_f32_bf16_dpp v10, v4, v45 row_newbcast:10 row_mask:0xf bank_mask:0xf
  v_dot2c_f32_bf16_dpp v11, v5, v45 row_newbcast:10 row_mask:0xf bank_mask:0xf
  v_dot2c_f32_bf16_dpp v12, v4, v46 row_newbcast:10 row_mask:0xf bank_mask:0xf
  v_dot2c_f32_bf16_dpp v13, v5, v46 row_newbcast:10 row_mask:0xf bank_mask:0xf
  v_dot2c_f32_bf16_dpp v14, v4, v47 row_newbcast:10 row_mask:0xf bank_mask:0xf
  v_dot2c_f32_bf16_dpp v15, v5, v47 row_newbcast:10 row_mask:0xf bank_mask:0xf
L_opt_28:
  s_cmp_gt_u32 s60, 4
  s_cbranch_scc1 L_opt_29
  v_dot2c_f32_bf16_dpp v8, v4, v40 row_newbcast:2 row_mask:0xf bank_mask:0xf
  v_dot2c_f32_bf16_dpp v9, v5, v40 row_newbcast:2 row_mask:0xf bank_mask:0xf
  v_dot2c_f32_bf16_dpp v10, v4, v41 row_newbcast:2 row_mask:0xf bank_mask:0xf
  v_dot2c_f32_bf16_dpp v11, v5, v41 row_newbcast:2 row_mask:0xf bank_mask:0xf
  v_dot2c_f32_bf16_dpp v12, v4, v42 row_newbcast:2 row_mask:0xf bank_mask:0xf
  v_dot2c_f32_bf16_dpp v13, v5, v42 row_newbcast:2 row_mask:0xf bank_mask:0xf
  v_dot2c_f32_bf16_dpp v14, v4, v43 row_newbcast:2 row_mask:0xf bank_mask:0xf
  v_dot2c_f32_bf16_dpp v15, v5, v43 row_newbcast:2 row_mask:0xf bank_mask:0xf
L_opt_29:
  s_waitcnt vmcnt(2)
  buffer_load_dwordx4 v[120:123], v2, s[48:51], s12 offen nt
  s_add_u32 s12, s12, s19
  s_bitset0_b32 s12, 15
  s_cmp_ge_u32 s12, s59
  s_cselect_b32 s12, s58, s12
  ds_write_b32 v16, v16 offset:20
  s_cmp_gt_u32 s60, 3
  s_cbranch_scc1 L_opt_30
  v_dot2c_f32_bf16_dpp v8, v4, v36 row_newbcast:12 row_mask:0xf bank_mask:0xf
  v_dot2c_f32_bf16_dpp v9, v5, v36 row_newbcast:12 row_mask:0xf bank_mask:0xf
  v_dot2c_f32_bf16_dpp v10, v4, v37 row_newbcast:12 row_mask:0xf bank_mask:0xf
  v_dot2c_f32_bf16_dpp v11, v5, v37 row_newbcast:12 row_mask:0xf bank_mask:0xf
  v_dot2c_f32_bf16_dpp v12, v4, v38 row_newbcast:12 row_mask:0xf bank_mask:0xf
  v_dot2c_f32_bf16_dpp v13, v5, v38 row_newbcast:12 row_mask:0xf bank_mask:0xf
  v_dot2c_f32_bf16_dpp v14, v4, v39 row_newbcast:12 row_mask:0xf bank_mask:0xf
  v_dot2c_f32_bf16_dpp v15, v5, v39 row_newbcast:12 row_mask:0xf bank_mask:0xf
L_opt_30:
  s_cmp_gt_u32 s60, 2
  s_cbranch_scc1 L_opt_31
  v_dot2c_f32_bf16_dpp v8, v4, v32 row_newbcast:4 row_mask:0xf bank_mask:0xf
  v_dot2c_f32_bf16_dpp v9, v5, v32 row_newbcast:4 row_mask:0xf bank_mask:0xf
  v_dot2c_f32_bf16_dpp v10, v4, v33 row_newbcast:4 row_mask:0xf bank_mask:0xf
  v_dot2c_f32_bf16_dpp v11, v5, v33 row_newbcast:4 row_mask:0xf bank_mask:0xf
  v_dot2c_f32_bf16_dpp v12, v4, v34 row_newbcast:4 row_mask:0xf bank_mask:0xf
  v_dot2c_f32_bf16_dpp v13, v5, v34 row_newbcast:4 row_mask:0xf bank_mask:0xf
  v_dot2c_f32_bf16_dpp v14, v4, v35 row_newbcast:4 row_mask:0xf bank_mask:0xf
  v_dot2c_f32_bf16_dpp v15, v5, v35 row_newbcast:4 row_mask:0xf bank_mask:0xf
L_opt_31:
  s_cmp_gt_u32 s60, 1
  s_cbranch_scc1 L_opt_32
  v_dot2c_f32_bf16_dpp v8, v4, v28 row_newbcast:8 row_mask:0xf bank_mask:0xf
  v_dot2c_f32_bf16_dpp v9, v5, v28 row_newbcast:8 row_mask:0xf bank_mask:0xf
  v_dot2c_f32_bf16_dpp v10, v4, v29 row_newbcast:8 row_mask:0xf bank_mask:0xf
  v_dot2c_f32_bf16_dpp v11, v5, v29 row_newbcast:8 row_mask:0xf bank_mask:0xf
  v_dot2c_f32_bf16_dpp v12, v4, v30 row_newbcast:8 row_mask:0xf bank_mask:0xf
  v_dot2c_f32_bf16_dpp v13, v5, v30 row_newbcast:8 row_mask:0xf bank_mask:0xf
  v_dot2c_f32_bf16_dpp v14, v4, v31 row_newbcast:8 row_mask:0xf bank_mask:0xf
  v_dot2c_f32_bf16_dpp v15, v5, v31 row_newbcast:8 row_mask:0xf bank_mask:0xf
L_opt_32:
  s_waitcnt vmcnt(2)
  s_bitcmp0_b32 s68, 0
  s_cbranch_scc1 L_th_33
  s_waitcnt vmcnt(1)
L_th_33:
  buffer_load_dwordx4 v[124:127], v2, s[48:51], s12 offen nt
  s_add_u32 s12, s12, s19
  s_bitset0_b32 s12, 15
  s_cmp_ge_u32 s12, s59
  s_cselect_b32 s12, s58, s12
  s_cmp_gt_u32 s60, 0
  s_cbranch_scc1 L_opt_34
  v_dot2c_f32_bf16_dpp v8, v4, v24 row_newbcast:0 row_mask:0xf bank_mask:0xf
  v_dot2c_f32_bf16_dpp v9, v5, v24 row_newbcast:0 row_mask:0xf bank_mask:0xf
  v_dot2c_f32_bf16_dpp v10, v4, v25 row_newbcast:0 row_mask:0xf bank_mask:0xf
  v_dot2c_f32_bf16_dpp v11, v5, v25 row_newbcast:0 row_mask:0xf bank_mask:0xf
  v_dot2c_f32_bf16_dpp v12, v4, v26 row_newbcast:0 row_mask:0xf bank_mask:0xf
  v_dot2c_f32_bf16_dpp v13, v5, v26 row_newbcast:0 row_mask:0xf bank_mask:0xf
  v_dot2c_f32_bf16_dpp v14, v4, v27 row_newbcast:0 row_mask:0xf bank_mask:0xf
  v_dot2c_f32_bf16_dpp v15, v5, v27 row_newbcast:0 row_mask:0xf bank_mask:0xf
L_opt_34:
  v_dot2c_f32_bf16_dpp v8, v6, v100 row_newbcast:12 row_mask:0xf bank_mask:0xf
  v_dot2c_f32_bf16_dpp v9, v7, v100 row_newbcast:12 row_mask:0xf bank_mask:0xf
  v_dot2c_f32_bf16_dpp v10, v6, v101 row_newbcast:12 row_mask:0xf bank_mask:0xf
  v_dot2c_f32_bf16_dpp v11, v7, v101 row_newbcast:12 row_mask:0xf bank_mask:0xf
  v_dot2c_f32_bf16_dpp v12, v6, v102 row_newbcast:12 row_mask:0xf bank_mask:0xf
  v_dot2c_f32_bf16_dpp v13, v7, v102 row_newbcast:12 row_mask:0xf bank_mask:0xf
  v_dot2c_f32_bf16_dpp v14, v6, v103 row_newbcast:12 row_mask:0xf bank_mask:0xf
  v_dot2c_f32_bf16_dpp v15, v7, v103 row_newbcast:12 row_mask:0xf bank_mask:0xf
  v_dot2c_f32_bf16_dpp v8, v6, v104 row_newbcast:2 row_mask:0xf bank_mask:0xf
  v_dot2c_f32_bf16_dpp v9, v7, v104 row_newbcast:2 row_mask:0xf bank_mask:0xf
  v_dot2c_f32_bf16_dpp v10, v6, v105 row_newbcast:2 row_mask:0xf bank_mask:0xf
  v_dot2c_f32_bf16_dpp v11, v7, v105 row_newbcast:2 row_mask:0xf bank_mask:0xf
  v_dot2c_f32_bf16_dpp v12, v6, v106 row_newbcast:2 row_mask:0xf bank_mask:0xf
  v_dot2c_f32_bf16_dpp v13, v7, v106 row_newbcast:2 row_mask:0xf bank_mask:0xf
  v_dot2c_f32_bf16_dpp v14, v6, v107 row_newbcast:2 row_mask:0xf bank_mask:0xf
  v_dot2c_f32_bf16_dpp v15, v7, v107 row_newbcast:2 row_mask:0xf bank_mask:0xf
  s_waitcnt vmcnt(2)
  buffer_load_dwordx4 v[128:131], v2, s[48:51], s12 offen nt
  s_add_u32 s12, s12, s19
  s_bitset0_b32 s12, 15
  s_cmp_ge_u32 s12, s59
  s_cselect_b32 s12, s58, s12
  v_dot2c_f32_bf16_dpp v8, v6, v108 row_newbcast:10 row_mask:0xf bank_mask:0xf
  v_dot2c_f32_bf16_dpp v9, v7, v108 row_newbcast:10 row_mask:0xf bank_mask:0xf
  v_dot2c_f32_bf16_dpp v10, v6, v109 row_newbcast:10 row_mask:0xf bank_mask:0xf
  v_dot2c_f32_bf16_dpp v11, v7, v109 row_newbcast:10 row_mask:0xf bank_mask:0xf
  v_dot2c_f32_bf16_dpp v12, v6, v110 row_newbcast:10 row_mask:0xf bank_mask:0xf
  v_dot2c_f32_bf16_dpp v13, v7, v110 row_newbcast:10 row_mask:0xf bank_mask:0xf
  v_dot2c_f32_bf16_dpp v14, v6, v111 row_newbcast:10 row_mask:0xf bank_mask:0xf
  v_dot2c_f32_bf16_dpp v15, v7, v111 row_newbcast:10 row_mask:0xf bank_mask:0xf
  v_dot2c_f32_bf16_dpp v8, v6, v112 row_newbcast:6 row_mask:0xf bank_mask:0xf
  v_dot2c_f32_bf16_dpp v9, v7, v112 row_newbcast:6 row_mask:0xf bank_mask:0xf
  v_dot2c_f32_bf16_dpp v10, v6, v113 row_newbcast:6 row_mask:0xf bank_mask:0xf
  v_dot2c_f32_bf16_dpp v11, v7, v113 row_newbcast:6 row_mask:0xf bank_mask:0xf
  v_dot2c_f32_bf16_dpp v12, v6, v114 row_newbcast:6 row_mask:0xf bank_mask:0xf
  v_dot2c_f32_bf16_dpp v13, v7, v114 row_newbcast:6 row_mask:0xf bank_mask:0xf
  v_dot2c_f32_bf16_dpp v14, v6, v115 row_newbcast:6 row_mask:0xf bank_mask:0xf
  v_dot2c_f32_bf16_dpp v15, v7, v115 row_newbcast:6 row_mask:0xf bank_mask:0xf
  v_dot2c_f32_bf16_dpp v8, v6, v116 row_newbcast:14 row_mask:0xf bank_mask:0xf
  v_dot2c_f32_bf16_dpp v9, v7, v116 row_newbcast:14 row_mask:0xf bank_mask:0xf
  v_dot2c_f32_bf16_dpp v10, v6, v117 row_newbcast:14 row_mask:0xf bank_mask:0xf
  v_dot2c_f32_bf16_dpp v11, v7, v117 row_newbcast:14 row_mask:0xf bank_mask:0xf
  v_dot2c_f32_bf16_dpp v12, v6, v118 row_newbcast:14 row_mask:0xf bank_mask:0xf
  v_dot2c_f32_bf16_dpp v13, v7, v118 row_newbcast:14 row_mask:0xf bank_mask:0xf
  v_dot2c_f32_bf16_dpp v14, v6, v119 row_newbcast:14 row_mask:0xf bank_mask:0xf
  v_dot2c_f32_bf16_dpp v15, v7, v119 row_newbcast:14 row_mask:0xf bank_mask:0xf
  s_waitcnt vmcnt(2)
  buffer_load_dwordx4 v[132:135], v2, s[48:51], s12 offen nt
  s_add_u32 s12, s12, s19
  s_bitset0_b32 s12, 15
  s_cmp_ge_u32 s12, s59
  s_cselect_b32 s12, s58, s12
  v_dot2c_f32_bf16_dpp v8, v6, v120 row_newbcast:1 row_mask:0xf bank_mask:0xf
  v_dot2c_f32_bf16_dpp v9, v7, v120 row_newbcast:1 row_mask:0xf bank_mask:0xf
  v_dot2c_f32_bf16_dpp v10, v6, v121 row_newbcast:1 row_mask:0xf bank_mask:0xf
  v_dot2c_f32_bf16_dpp v11, v7, v121 row_newbcast:1 row_mask:0xf bank_mask:0xf
  v_dot2c_f32_bf16_dpp v12, v6, v122 row_newbcast:1 row_mask:0xf bank_mask:0xf
  v_dot2c_f32_bf16_dpp v13, v7, v122 row_newbcast:1 row_mask:0xf bank_mask:0xf
  v_dot2c_f32_bf16_dpp v14, v6, v123 row_newbcast:1 row_mask:0xf bank_mask:0xf
  v_dot2c_f32_bf16_dpp v15, v7, v123 row_newbcast:1 row_mask:0xf bank_mask:0xf
  s_waitcnt vmcnt(2)
  s_bitcmp0_b32 s68, 0
  s_cbranch_scc1 L_th_35
  s_waitcnt vmcnt(1)
L_th_35:
  buffer_load_dwordx4 v[136:139], v2, s[48:51], s12 offen nt
  s_add_u32 s12, s12, s19
  s_bitset0_b32 s12, 15
  s_cmp_ge_u32 s12, s59
  s_cselect_b32 s12, s58, s12
  v_dot2c_f32_bf16_dpp v8, v6, v124 row_newbcast:9 row_mask:0xf bank_mask:0xf
  v_dot2c_f32_bf16_dpp v9, v7, v124 row_newbcast:9 row_mask:0xf bank_mask:0xf
  v_dot2c_f32_bf16_dpp v10, v6, v125 row_newbcast:9 row_mask:0xf bank_mask:0xf
  v_dot2c_f32_bf16_dpp v11, v7, v125 row_newbcast:9 row_mask:0xf bank_mask:0xf
  v_dot2c_f32_bf16_dpp v12, v6, v126 row_newbcast:9 row_mask:0xf bank_mask:0xf
  v_dot2c_f32_bf16_dpp v13, v7, v126 row_newbcast:9 row_mask:0xf bank_mask:0xf
  v_dot2c_f32_bf16_dpp v14, v6, v127 row_newbcast:9 row_mask:0xf bank_mask:0xf
  v_dot2c_f32_bf16_dpp v15, v7, v127 row_newbcast:9 row_mask:0xf bank_mask:0xf
  s_waitcnt vmcnt(2)
  buffer_load_dwordx4 v[140:143], v2, s[48:51], s12 offen nt
  s_add_u32 s12, s12, s19
  s_bitset0_b32 s12, 15
  s_cmp_ge_u32 s12, s59
  s_cselect_b32 s12, s58, s12
  v_dot2c_f32_bf16_dpp v8, v6, v128 row_newbcast:5 row_mask:0xf bank_mask:0xf
  v_dot2c_f32_bf16_dpp v9, v7, v128 row_newbcast:5 row_mask:0xf bank_mask:0xf
  v_dot2c_f32_bf16_dpp v10, v6, v129 row_newbcast:5 row_mask:0xf bank_mask:0xf
  v_dot2c_f32_bf16_dpp v11, v7, v129 row_newbcast:5 row_mask:0xf bank_mask:0xf
  v_dot2c_f32_bf16_dpp v12, v6, v130 row_newbcast:5 row_mask:0xf bank_mask:0xf
  v_dot2c_f32_bf16_dpp v13, v7, v130 row_newbcast:5 row_mask:0xf bank_mask:0xf
  v_dot2c_f32_bf16_dpp v14, v6, v131 row_newbcast:5 row_mask:0xf bank_mask:0xf
  v_dot2c_f32_bf16_dpp v15, v7, v131 row_newbcast:5 row_mask:0xf bank_mask:0xf
  s_waitcnt vmcnt(2)
  buffer_load_dwordx4 v[144:147], v2, s[48:51], s12 offen nt
  s_add_u32 s12, s12, s19
  s_bitset0_b32 s12, 15
  s_cmp_ge_u32 s12, s59
  s_cselect_b32 s12, s58, s12
  v_dot2c_f32_bf16_dpp v8, v6, v132 row_newbcast:13 row_mask:0xf bank_mask:0xf
  v_dot2c_f32_bf16_dpp v9, v7, v132 row_newbcast:13 row_mask:0xf bank_mask:0xf
  v_dot2c_f32_bf16_dpp v10, v6, v133 row_newbcast:13 row_mask:0xf bank_mask:0xf
  v_dot2c_f32_bf16_dpp v11, v7, v133 row_newbcast:13 row_mask:0xf bank_mask:0xf
  v_dot2c_f32_bf16_dpp v12, v6, v134 row_newbcast:13 row_mask:0xf bank_mask:0xf
  v_dot2c_f32_bf16_dpp v13, v7, v134 row_newbcast:13 row_mask:0xf bank_mask:0xf
  v_dot2c_f32_bf16_dpp v14, v6, v135 row_newbcast:13 row_mask:0xf bank_mask:0xf
  v_dot2c_f32_bf16_dpp v15, v7, v135 row_newbcast:13 row_mask:0xf bank_mask:0xf
  buffer_load_dwordx4 v[148:151], v2, s[48:51], s12 offen nt
  s_add_u32 s12, s12, s19
  s_bitset0_b32 s12, 15
  s_cmp_ge_u32 s12, s59
  s_cselect_b32 s12, s58, s12
  buffer_load_dwordx4 v[152:155], v2, s[48:51], s12 offen nt
  s_add_u32 s12, s12, s19
  s_bitset0_b32 s12, 15
  s_cmp_ge_u32 s12, s59
  s_cselect_b32 s12, s58, s12
  buffer_load_dwordx4 v[156:159], v2, s[48:51], s12 offen nt
  s_add_u32 s12, s12, s19
  s_bitset0_b32 s12, 15
  s_cmp_ge_u32 s12, s59
  s_cselect_b32 s12, s58, s12
  buffer_load_dwordx4 v[160:163], v2, s[48:51], s12 offen nt
  s_add_u32 s12, s12, s19
  s_bitset0_b32 s12, 15
  s_cmp_ge_u32 s12, s59
  s_cselect_b32 s12, s58, s12
  buffer_load_dwordx4 v[164:167], v2, s[48:51], s12 offen nt
  s_mov_b32 s70, 0
L_pl_36:
  ds_read_b32 v18, v16
  s_waitcnt lgkmcnt(0)
  v_cmp_eq_u32 vcc, -1, v18
  s_cmp_eq_u64 vcc, 0
  s_cbranch_scc1 L_pld_37
  s_sleep 2
  s_add_u32 s70, s70, 1
  s_cmp_lt_u32 s70, 1048576
  s_cbranch_scc1 L_pl_36
L_pld_37:
  v_sub_f32 v22, v22, v18
  v_mul_f32 v22, 0x3fb8aa3b, v22
  v_exp_f32 v22, v22
  ds_read_b64 v[18:19], v16 offset:32
  s_lshl_b32 s56, s6, 2
  s_add_u32 s56, s56, s7
  s_lshl_b32 s57, s56, 9
  s_add_u32 s57, s57, 131072
  v_lshl_add_u32 v2, v1, 3, s57
  v_and_b32 v17, 1, v1
  v_lshlrev_b32 v17, 4, v17
  v_lshlrev_b32 v1, 3, v1
  v_mov_b32 v0, 1
  s_movk_i32 s56, 0xff
  s_waitcnt lgkmcnt(0)
  v_readfirstlane_b32 s75, v19
  v_lshrrev_b32 v18, v17, v18
  v_lshrrev_b32 v19, 8, v18
  s_waitcnt vmcnt(7)
  v_dot2c_f32_bf16_dpp v8, v6, v136 row_newbcast:3 row_mask:0xf bank_mask:0xf
  v_dot2c_f32_bf16_dpp v9, v7, v136 row_newbcast:3 row_mask:0xf bank_mask:0xf
  v_dot2c_f32_bf16_dpp v10, v6, v137 row_newbcast:3 row_mask:0xf bank_mask:0xf
  v_dot2c_f32_bf16_dpp v11, v7, v137 row_newbcast:3 row_mask:0xf bank_mask:0xf
  v_dot2c_f32_bf16_dpp v12, v6, v138 row_newbcast:3 row_mask:0xf bank_mask:0xf
  v_dot2c_f32_bf16_dpp v13, v7, v138 row_newbcast:3 row_mask:0xf bank_mask:0xf
  v_dot2c_f32_bf16_dpp v14, v6, v139 row_newbcast:3 row_mask:0xf bank_mask:0xf
  v_dot2c_f32_bf16_dpp v15, v7, v139 row_newbcast:3 row_mask:0xf bank_mask:0xf
  s_waitcnt vmcnt(6)
  v_dot2c_f32_bf16_dpp v8, v6, v140 row_newbcast:11 row_mask:0xf bank_mask:0xf
  v_dot2c_f32_bf16_dpp v9, v7, v140 row_newbcast:11 row_mask:0xf bank_mask:0xf
  v_dot2c_f32_bf16_dpp v10, v6, v141 row_newbcast:11 row_mask:0xf bank_mask:0xf
  v_dot2c_f32_bf16_dpp v11, v7, v141 row_newbcast:11 row_mask:0xf bank_mask:0xf
  v_dot2c_f32_bf16_dpp v12, v6, v142 row_newbcast:11 row_mask:0xf bank_mask:0xf
  v_dot2c_f32_bf16_dpp v13, v7, v142 row_newbcast:11 row_mask:0xf bank_mask:0xf
  v_dot2c_f32_bf16_dpp v14, v6, v143 row_newbcast:11 row_mask:0xf bank_mask:0xf
  v_dot2c_f32_bf16_dpp v15, v7, v143 row_newbcast:11 row_mask:0xf bank_mask:0xf
  s_waitcnt vmcnt(5)
  v_dot2c_f32_bf16_dpp v8, v6, v144 row_newbcast:7 row_mask:0xf bank_mask:0xf
  v_dot2c_f32_bf16_dpp v9, v7, v144 row_newbcast:7 row_mask:0xf bank_mask:0xf
  v_dot2c_f32_bf16_dpp v10, v6, v145 row_newbcast:7 row_mask:0xf bank_mask:0xf
  v_dot2c_f32_bf16_dpp v11, v7, v145 row_newbcast:7 row_mask:0xf bank_mask:0xf
  v_dot2c_f32_bf16_dpp v12, v6, v146 row_newbcast:7 row_mask:0xf bank_mask:0xf
  v_dot2c_f32_bf16_dpp v13, v7, v146 row_newbcast:7 row_mask:0xf bank_mask:0xf
  v_dot2c_f32_bf16_dpp v14, v6, v147 row_newbcast:7 row_mask:0xf bank_mask:0xf
  v_dot2c_f32_bf16_dpp v15, v7, v147 row_newbcast:7 row_mask:0xf bank_mask:0xf
  s_waitcnt vmcnt(4)
  v_dot2c_f32_bf16_dpp v8, v6, v148 row_newbcast:15 row_mask:0xf bank_mask:0xf
  v_dot2c_f32_bf16_dpp v9, v7, v148 row_newbcast:15 row_mask:0xf bank_mask:0xf
  v_dot2c_f32_bf16_dpp v10, v6, v149 row_newbcast:15 row_mask:0xf bank_mask:0xf
  v_dot2c_f32_bf16_dpp v11, v7, v149 row_newbcast:15 row_mask:0xf bank_mask:0xf
  v_dot2c_f32_bf16_dpp v12, v6, v150 row_newbcast:15 row_mask:0xf bank_mask:0xf
  v_dot2c_f32_bf16_dpp v13, v7, v150 row_newbcast:15 row_mask:0xf bank_mask:0xf
  v_dot2c_f32_bf16_dpp v14, v6, v151 row_newbcast:15 row_mask:0xf bank_mask:0xf
  v_dot2c_f32_bf16_dpp v15, v7, v151 row_newbcast:15 row_mask:0xf bank_mask:0xf
  s_waitcnt vmcnt(3)
  v_dot2c_f32_bf16_dpp v8, v20, v152 row_newbcast:0 row_mask:0xf bank_mask:0xf
  v_dot2c_f32_bf16_dpp v9, v21, v152 row_newbcast:0 row_mask:0xf bank_mask:0xf
  v_dot2c_f32_bf16_dpp v10, v20, v153 row_newbcast:0 row_mask:0xf bank_mask:0xf
  v_dot2c_f32_bf16_dpp v11, v21, v153 row_newbcast:0 row_mask:0xf bank_mask:0xf
  v_dot2c_f32_bf16_dpp v12, v20, v154 row_newbcast:0 row_mask:0xf bank_mask:0xf
  v_dot2c_f32_bf16_dpp v13, v21, v154 row_newbcast:0 row_mask:0xf bank_mask:0xf
  v_dot2c_f32_bf16_dpp v14, v20, v155 row_newbcast:0 row_mask:0xf bank_mask:0xf
  v_dot2c_f32_bf16_dpp v15, v21, v155 row_newbcast:0 row_mask:0xf bank_mask:0xf
  s_waitcnt vmcnt(2)
  v_dot2c_f32_bf16_dpp v8, v20, v156 row_newbcast:8 row_mask:0xf bank_mask:0xf
  v_dot2c_f32_bf16_dpp v9, v21, v156 row_newbcast:8 row_mask:0xf bank_mask:0xf
  v_dot2c_f32_bf16_dpp v10, v20, v157 row_newbcast:8 row_mask:0xf bank_mask:0xf
  v_dot2c_f32_bf16_dpp v11, v21, v157 row_newbcast:8 row_mask:0xf bank_mask:0xf
  v_dot2c_f32_bf16_dpp v12, v20, v158 row_newbcast:8 row_mask:0xf bank_mask:0xf
  v_dot2c_f32_bf16_dpp v13, v21, v158 row_newbcast:8 row_mask:0xf bank_mask:0xf
  v_dot2c_f32_bf16_dpp v14, v20, v159 row_newbcast:8 row_mask:0xf bank_mask:0xf
  v_dot2c_f32_bf16_dpp v15, v21, v159 row_newbcast:8 row_mask:0xf bank_mask:0xf
  s_waitcnt vmcnt(1)
  v_dot2c_f32_bf16_dpp v8, v20, v160 row_newbcast:4 row_mask:0xf bank_mask:0xf
  v_dot2c_f32_bf16_dpp v9, v21, v160 row_newbcast:4 row_mask:0xf bank_mask:0xf
  v_dot2c_f32_bf16_dpp v10, v20, v161 row_newbcast:4 row_mask:0xf bank_mask:0xf
  v_dot2c_f32_bf16_dpp v11, v21, v161 row_newbcast:4 row_mask:0xf bank_mask:0xf
  v_dot2c_f32_bf16_dpp v12, v20, v162 row_newbcast:4 row_mask:0xf bank_mask:0xf
  v_dot2c_f32_bf16_dpp v13, v21, v162 row_newbcast:4 row_mask:0xf bank_mask:0xf
  v_dot2c_f32_bf16_dpp v14, v20, v163 row_newbcast:4 row_mask:0xf bank_mask:0xf
  v_dot2c_f32_bf16_dpp v15, v21, v163 row_newbcast:4 row_mask:0xf bank_mask:0xf
  s_waitcnt vmcnt(0)
  v_dot2c_f32_bf16_dpp v8, v20, v164 row_newbcast:12 row_mask:0xf bank_mask:0xf
  v_dot2c_f32_bf16_dpp v9, v21, v164 row_newbcast:12 row_mask:0xf bank_mask:0xf
  v_dot2c_f32_bf16_dpp v10, v20, v165 row_newbcast:12 row_mask:0xf bank_mask:0xf
  v_dot2c_f32_bf16_dpp v11, v21, v165 row_newbcast:12 row_mask:0xf bank_mask:0xf
  v_dot2c_f32_bf16_dpp v12, v20, v166 row_newbcast:12 row_mask:0xf bank_mask:0xf
  v_dot2c_f32_bf16_dpp v13, v21, v166 row_newbcast:12 row_mask:0xf bank_mask:0xf
  v_dot2c_f32_bf16_dpp v14, v20, v167 row_newbcast:12 row_mask:0xf bank_mask:0xf
  v_dot2c_f32_bf16_dpp v15, v21, v167 row_newbcast:12 row_mask:0xf bank_mask:0xf
  s_nop 2
  v_permlane32_swap_b32 v8, v12
  v_permlane32_swap_b32 v9, v13
  v_permlane32_swap_b32 v10, v14
  v_permlane32_swap_b32 v11, v15
  v_add_f32 v8, v8, v12
  v_add_f32 v9, v9, v13
  v_add_f32 v10, v10, v14
  v_add_f32 v11, v11, v15
  s_nop 0
  v_permlane16_swap_b32 v8, v10
  v_permlane16_swap_b32 v9, v11
  v_add_f32 v8, v8, v10
  v_add_f32 v9, v9, v11
  v_mul_f32 v8, v8, v22
  v_mul_f32 v9, v9, v22
  ds_write_b64 v3, v[8:9] offset:6912
  s_mov_b64 exec, 1
  ds_add_rtn_u32 v17, v16, v0 offset:68
  s_mov_b64 exec, -1
  ds_read_b64 v[56:57], v1 offset:6912
  ds_read_b64 v[58:59], v1 offset:7424
  ds_read_b64 v[60:61], v1 offset:7936
  ds_read_b64 v[62:63], v1 offset:8448
  ds_read_b64 v[64:65], v1 offset:8960
  ds_read_b64 v[66:67], v1 offset:9472
  ds_read_b64 v[68:69], v1 offset:9984
  ds_read_b64 v[70:71], v1 offset:10496
  s_waitcnt lgkmcnt(6)
  v_readfirstlane_b32 s57, v17
  v_pk_add_f32 v[56:57], v[56:57], v[58:59]
  s_waitcnt lgkmcnt(4)
  v_pk_add_f32 v[60:61], v[60:61], v[62:63]
  s_waitcnt lgkmcnt(2)
  v_pk_add_f32 v[64:65], v[64:65], v[66:67]
  s_waitcnt lgkmcnt(0)
  v_pk_add_f32 v[68:69], v[68:69], v[70:71]
  v_pk_add_f32 v[56:57], v[56:57], v[60:61]
  v_pk_add_f32 v[64:65], v[64:65], v[68:69]
  s_cmp_lg_u32 s57, 7
  v_pk_add_f32 v[56:57], v[56:57], v[64:65]
  v_bfi_b32 v18, s56, v18, v56
  v_bfi_b32 v19, s56, v19, v57
  s_cbranch_scc1 L_send
  s_cmp_eq_u32 s75, 1
  s_cbranch_scc0 L_pf_38
  global_store_dwordx2 v2, v[18:19], s[42:43]
  s_branch L_pe_39
L_pf_38:
  global_store_dwordx2 v2, v[18:19], s[42:43] sc1
L_pe_39:
L_send:
  s_barrier
  s_endpgm
L_helper:
  v_mov_b32 v4, -1
  v_mov_b32 v5, -1
  v_mov_b32 v6, -1
  v_mov_b32 v7, -1
  v_lshlrev_b32 v2, 4, v0
  ds_write_b128 v2, v[4:7] offset:12032
  ds_write_b128 v2, v[4:7] offset:16128
  v_lshlrev_b32 v2, 2, v1
  ds_write_b32 v2, v4 offset:6400
  v_mov_b32 v38, 0
  ds_write_b128 v38, v[4:7] offset:6656
  ds_write_b128 v38, v[4:7] offset:6672
  v_mov_b32 v39, 0
  ds_write_b64 v38, v[38:39] offset:6720
  ds_write_b32 v38, v38 offset:6728
  s_waitcnt lgkmcnt(0)
  s_barrier
  s_getpc_b64 s[56:57]
L_pc2:
  s_lshl_b32 s3, s2, 2
  s_add_u32 s3, s3, L_table-L_pc2
  s_load_dwordx16 s[16:31], s[0:1], 0
  s_load_dword s14, s[56:57], s3
  s_load_dwordx8 s[32:39], s[0:1], 64
  s_load_dwordx4 s[40:43], s[0:1], 96
  s_and_b32 s8, s2, 7
  s_mov_b64 s[100:101], s[56:57]
  s_mov_b32 s72, 0xfffffffe
  s_mov_b32 s73, 0xffff0000
  s_getreg_b32 s76, hwreg(HW_REG_XCC_ID, 0, 4)
  v_lshrrev_b32 v12, 3, v0
  v_lshlrev_b32 v12, 5, v12
  v_bfe_u32 v3, v1, 2, 1
  v_lshl_add_u32 v12, v3, 10, v12
  v_and_b32 v8, 3, v1
  v_lshl_add_u32 v13, v8, 3, v12
  v_and_b32 v12, 0xffffffdf, v12
  v_lshl_add_u32 v12, v8, 4, v12
  v_bfe_u32 v8, v1, 3, 1
  v_lshl_add_u32 v12, v8, 3, v12
  v_lshl_add_u32 v12, v3, 5, v12
  s_waitcnt lgkmcnt(0)
  s_load_dword s74, s[42:43], 0
  s_and_b32 s13, s14, 7
  s_bfe_u32 s61, s14, 0x60003
  s_cmp_eq_u32 s13, 6
  s_cbranch_scc1 L_r_q
  s_cmp_ge_u32 s13, 4
  s_cbranch_scc1 L_r_moda
  s_cmp_eq_u32 s13, 1
  s_cbranch_scc1 L_r_wo
  s_lshr_b32 s48, s14, 30
  s_cmp_eq_u32 s48, 0
  s_cbranch_scc1 L_noas
  s_bfe_u32 s49, s14, 0x1001a
  s_lshl_b32 s49, s49, 2
  s_add_u32 s49, s49, s5
  s_lshl_b32 s50, s49, 6
  s_lshr_b32 s51, s49, 1
  s_lshl_b32 s51, s51, 4
  s_and_b32 s49, s49, 1
  s_add_u32 s51, s51, s49
  s_lshl_b32 s49, s8, 1
  s_add_u32 s51, s51, s49
  s_lshl_b32 s51, s51, 6
  s_movk_i32 s52, 6144
  s_mov_b64 s[54:55], s[36:37]
  s_cmp_eq_u32 s48, 1
  s_cselect_b32 s52, 0x2000, s52
  s_cselect_b64 s[54:55], s[22:23], s[54:55]
  s_cmp_eq_u32 s48, 2
  s_cselect_b32 s52, 0x400, s52
  s_cselect_b64 s[54:55], s[24:25], s[54:55]
  s_cselect_b32 s50, s51, s50
  s_bfe_u32 s49, s14, 0x3001b
  s_lshl_b32 s49, s49, 10
  s_add_u32 s49, s49, 384
  v_max_u32 v2, 24, v1
  v_add_u32 v2, s50, v2
  v_mul_u32_u24 v2, s52, v2
  v_add_u32 v2, s49, v2
  global_load_dword v167, v2, s[54:55]
L_noas:
  s_cmp_eq_u32 s13, 2
  s_cbranch_scc1 L_r_f1
  s_cmp_eq_u32 s13, 3
  s_cbranch_scc1 L_r_f2
  s_branch L_r_none
L_r_moda:
  s_lshl_b32 s58, s61, 9
  s_add_u32 s58, s58, 4096
  global_load_dwordx2 v[14:15], v13, s[34:35]
  s_waitcnt lgkmcnt(0)
  s_mul_i32 s74, s74, 0x9e3779b1
  s_add_u32 s74, s74, 0x7f4a7c15
  s_add_u32 s76, s76, s74
  s_waitcnt vmcnt(0)
  v_lshlrev_b32 v16, 16, v14
  v_and_b32 v17, s73, v14
  v_lshlrev_b32 v18, 16, v15
  v_and_b32 v19, s73, v15
  v_mul_f32 v20, 0xbfb8aa3b, v16
  v_mul_f32 v21, 0xbfb8aa3b, v17
  v_mul_f32 v22, 0xbfb8aa3b, v18
  v_mul_f32 v23, 0xbfb8aa3b, v19
  v_exp_f32 v20, v20
  v_exp_f32 v21, v21
  v_exp_f32 v22, v22
  v_exp_f32 v23, v23
  s_nop 0
  v_add_f32 v20, 1.0, v20
  v_add_f32 v21, 1.0, v21
  v_add_f32 v22, 1.0, v22
  v_add_f32 v23, 1.0, v23
  v_rcp_f32 v20, v20
  v_rcp_f32 v21, v21
  v_rcp_f32 v22, v22
  v_rcp_f32 v23, v23
  s_nop 0
  v_mul_f32 v16, v16, v20
  v_mul_f32 v17, v17, v21
  v_mul_f32 v18, v18, v22
  v_mul_f32 v19, v19, v23
  v_cvt_pk_bf16_f32 v14, v16, v17
  v_cvt_pk_bf16_f32 v15, v18, v19
  ds_write_b64 v12, v[14:15] offset:0
  v_and_b32 v13, 1, v1
  v_lshlrev_b32 v13, 6, v13
  v_lshrrev_b32 v3, 4, v1
  v_lshl_add_u32 v13, v3, 4, v13
  s_lshl_b32 s49, s5, 7
  s_add_u32 s49, s49, s58
  v_add_u32 v13, s49, v13
  v_and_b32 v14, 1, v1
  v_mul_u32_u24 v14, 1056, v14
  v_lshrrev_b32 v3, 4, v1
  v_lshl_add_u32 v14, v3, 4, v14
  v_lshrrev_b32 v2, 2, v1
  v_bfe_u32 v3, v1, 1, 1
  s_lshl_b32 s49, s5, 1
  v_or_b32 v3, s49, v3
  v_and_b32 v10, 6, v2
  v_xor_b32 v3, v3, v10
  v_lshlrev_b32 v2, 7, v2
  v_lshl_add_u32 v2, v3, 4, v2
  v_and_b32 v3, 1, v1
  v_lshl_add_u32 v2, v3, 3, v2
  v_add_u32 v2, 20480, v2
  s_waitcnt lgkmcnt(0)
  v_mov_b32 v9, 1
  s_mov_b64 exec, 1
  ds_add_u32 v38, v9 offset:6720
  s_mov_b64 exec, -1
  s_mov_b32 s70, 0
L_hs_40:
  ds_read_b32 v9, v38 offset:6720
  s_waitcnt lgkmcnt(0)
  v_cmp_gt_u32 vcc, 12, v9
  s_cmp_eq_u64 vcc, 0
  s_cbranch_scc1 L_hsd_41
  s_sleep 2
  s_add_u32 s70, s70, 1
  s_cmp_lt_u32 s70, 2097152
  s_cbranch_scc1 L_hs_40
L_hsd_41:
  ds_read_b64_tr_b16 v[40:41], v2 offset:0
  ds_read_b64_tr_b16 v[42:43], v2 offset:2048
  ds_read_b128 v[104:107], v14 offset:0
  ds_read_b64_tr_b16 v[44:45], v2 offset:4096
  ds_read_b64_tr_b16 v[46:47], v2 offset:6144
  ds_read_b128 v[108:111], v14 offset:64
  ds_read_b64_tr_b16 v[48:49], v2 offset:8192
  ds_read_b64_tr_b16 v[50:51], v2 offset:10240
  ds_read_b128 v[112:115], v14 offset:128
  ds_read_b64_tr_b16 v[52:53], v2 offset:12288
  ds_read_b64_tr_b16 v[54:55], v2 offset:14336
  ds_read_b128 v[116:119], v14 offset:192
  ds_read_b64_tr_b16 v[56:57], v2 offset:16384
  ds_read_b64_tr_b16 v[58:59], v2 offset:18432
  ds_read_b128 v[120:123], v14 offset:256
  s_waitcnt lgkmcnt(12)
  v_mfma_f32_16x16x32_bf16 v[8:11], v[40:43], v[104:107], 0
  ds_read_b64_tr_b16 v[60:61], v2 offset:20480
  ds_read_b64_tr_b16 v[62:63], v2 offset:22528
  ds_read_b128 v[124:127], v14 offset:320
  s_waitcnt lgkmcnt(12)
  v_mfma_f32_16x16x32_bf16 v[8:11], v[44:47], v[108:111], v[8:11]
  ds_read_b64_tr_b16 v[64:65], v2 offset:24576
  ds_read_b64_tr_b16 v[66:67], v2 offset:26624
  ds_read_b128 v[128:131], v14 offset:384
  s_waitcnt lgkmcnt(12)
  v_mfma_f32_16x16x32_bf16 v[8:11], v[48:51], v[112:115], v[8:11]
  ds_read_b64_tr_b16 v[68:69], v2 offset:28672
  ds_read_b64_tr_b16 v[70:71], v2 offset:30720
  ds_read_b128 v[132:135], v14 offset:448
  s_waitcnt lgkmcnt(12)
  v_mfma_f32_16x16x32_bf16 v[8:11], v[52:55], v[116:119], v[8:11]
  ds_read_b64_tr_b16 v[72:73], v2 offset:32768
  ds_read_b64_tr_b16 v[74:75], v2 offset:34816
  ds_read_b128 v[136:139], v14 offset:512
  s_waitcnt lgkmcnt(12)
  v_mfma_f32_16x16x32_bf16 v[8:11], v[56:59], v[120:123], v[8:11]
  ds_read_b64_tr_b16 v[76:77], v2 offset:36864
  ds_read_b64_tr_b16 v[78:79], v2 offset:38912
  ds_read_b128 v[140:143], v14 offset:576
  s_waitcnt lgkmcnt(12)
  v_mfma_f32_16x16x32_bf16 v[8:11], v[60:63], v[124:127], v[8:11]
  ds_read_b64_tr_b16 v[80:81], v2 offset:40960
  ds_read_b64_tr_b16 v[82:83], v2 offset:43008
  ds_read_b128 v[144:147], v14 offset:640
  s_waitcnt lgkmcnt(12)
  v_mfma_f32_16x16x32_bf16 v[8:11], v[64:67], v[128:131], v[8:11]
  ds_read_b64_tr_b16 v[84:85], v2 offset:45056
  ds_read_b64_tr_b16 v[86:87], v2 offset:47104
  ds_read_b128 v[148:151], v14 offset:704
  s_waitcnt lgkmcnt(12)
  v_mfma_f32_16x16x32_bf16 v[8:11], v[68:71], v[132:135], v[8:11]
  ds_read_b64_tr_b16 v[88:89], v2 offset:49152
  ds_read_b64_tr_b16 v[90:91], v2 offset:51200
  ds_read_b128 v[152:155], v14 offset:768
  s_waitcnt lgkmcnt(12)
  v_mfma_f32_16x16x32_bf16 v[8:11], v[72:75], v[136:139], v[8:11]
  ds_read_b64_tr_b16 v[92:93], v2 offset:53248
  ds_read_b64_tr_b16 v[94:95], v2 offset:55296
  ds_read_b128 v[156:159], v14 offset:832
  s_waitcnt lgkmcnt(12)
  v_mfma_f32_16x16x32_bf16 v[8:11], v[76:79], v[140:143], v[8:11]
  ds_read_b64_tr_b16 v[96:97], v2 offset:57344
  ds_read_b64_tr_b16 v[98:99], v2 offset:59392
  ds_read_b128 v[160:163], v14 offset:896
  s_waitcnt lgkmcnt(12)
  v_mfma_f32_16x16x32_bf16 v[8:11], v[80:83], v[144:147], v[8:11]
  ds_read_b64_tr_b16 v[100:101], v2 offset:61440
  ds_read_b64_tr_b16 v[102:103], v2 offset:63488
  ds_read_b128 v[164:167], v14 offset:960
  s_waitcnt lgkmcnt(12)
  v_mfma_f32_16x16x32_bf16 v[8:11], v[84:87], v[148:151], v[8:11]
  s_waitcnt lgkmcnt(9)
  v_mfma_f32_16x16x32_bf16 v[8:11], v[88:91], v[152:155], v[8:11]
  s_waitcnt lgkmcnt(6)
  v_mfma_f32_16x16x32_bf16 v[8:11], v[92:95], v[156:159], v[8:11]
  s_waitcnt lgkmcnt(3)
  v_mfma_f32_16x16x32_bf16 v[8:11], v[96:99], v[160:163], v[8:11]
  s_waitcnt lgkmcnt(0)
  v_mfma_f32_16x16x32_bf16 v[8:11], v[100:103], v[164:167], v[8:11]
  s_nop 7
  v_cvt_pk_bf16_f32 v8, v8, v9
  v_cvt_pk_bf16_f32 v10, v10, v11
  v_mov_b32 v9, s74
  v_mov_b32 v11, s74
  s_mov_b32 exec_lo, 0x00030003
  s_mov_b32 exec_hi, 0x00030003
  global_store_dwordx4 v13, v[8:11], s[42:43] sc1
L_sk1:
  s_mov_b64 exec, -1
  s_mov_b32 s60, 0
  s_branch L_svc1
L_r_q:
  s_lshl_b32 s58, s61, 9
  s_add_u32 s58, s58, 32768
  global_load_dwordx2 v[14:15], v13, s[16:17]
  s_waitcnt lgkmcnt(0)
  s_mul_i32 s74, s74, 0x9e3779b1
  s_add_u32 s74, s74, 0x7f4a7c15
  s_add_u32 s76, s76, s74
  s_waitcnt vmcnt(0)
  v_bfe_u32 v6, v1, 2, 1
  v_lshlrev_b32 v6, 5, v6
  v_add_u32 v6, 11008, v6
  s_lshl_b32 s49, s5, 3
  v_add_u32 v5, s49, v6
  v_lshlrev_b32 v20, 16, v14
  v_and_b32 v21, s73, v14
  v_lshlrev_b32 v22, 16, v15
  v_and_b32 v23, s73, v15
  v_add_f32 v8, v20, v21
  v_mul_f32 v9, v20, v20
  v_add_f32 v10, v22, v23
  v_mul_f32 v11, v22, v22
  v_fmac_f32 v9, v21, v21
  v_fmac_f32 v11, v23, v23
  v_add_f32 v8, v8, v10
  v_add_f32 v9, v9, v11
  s_nop 0
  v_add_f32_dpp v8, v8, v8 quad_perm:[1,0,3,2] row_mask:0xf bank_mask:0xf
  v_add_f32_dpp v9, v9, v9 quad_perm:[1,0,3,2] row_mask:0xf bank_mask:0xf
  s_nop 0
  v_add_f32_dpp v8, v8, v8 quad_perm:[2,3,0,1] row_mask:0xf bank_mask:0xf
  v_add_f32_dpp v9, v9, v9 quad_perm:[2,3,0,1] row_mask:0xf bank_mask:0xf
  s_nop 0
  v_add_f32_dpp v8, v8, v8 row_ror:8 row_mask:0xf bank_mask:0xf
  v_add_f32_dpp v9, v9, v9 row_ror:8 row_mask:0xf bank_mask:0xf
  s_nop 0
  v_mov_b32 v10, v8
  v_mov_b32 v11, v9
  s_nop 0
  v_permlane16_swap_b32 v10, v8
  v_permlane16_swap_b32 v11, v9
  v_add_f32 v8, v8, v10
  v_add_f32 v9, v9, v11
  v_mov_b32 v10, v8
  v_mov_b32 v11, v9
  s_nop 0
  v_permlane32_swap_b32 v10, v8
  v_permlane32_swap_b32 v11, v9
  v_add_f32 v8, v8, v10
  v_add_f32 v9, v9, v11
  ds_write_b64 v5, v[8:9]
  s_waitcnt lgkmcnt(0)
  v_mov_b32 v9, 1
  s_mov_b64 exec, 1
  ds_add_u32 v38, v9 offset:6720
  s_mov_b64 exec, -1
  s_mov_b32 s70, 0
L_hs_42:
  ds_read_b32 v9, v38 offset:6720
  s_waitcnt lgkmcnt(0)
  v_cmp_gt_u32 vcc, 12, v9
  s_cmp_eq_u64 vcc, 0
  s_cbranch_scc1 L_hsd_43
  s_sleep 4
  s_add_u32 s70, s70, 1
  s_cmp_lt_u32 s70, 2097152
  s_cbranch_scc1 L_hs_42
L_hsd_43:
  ds_read_b128 v[24:27], v6
  ds_read_b128 v[28:31], v6 offset:16
  s_waitcnt lgkmcnt(0)
  v_pk_add_f32 v[24:25], v[24:25], v[26:27]
  v_pk_add_f32 v[28:29], v[28:29], v[30:31]
  v_pk_add_f32 v[24:25], v[24:25], v[28:29]
  v_mul_f32 v8, 0x3b000000, v24
  v_mul_f32 v9, 0x3b000000, v25
  v_fma_f32 v9, -v8, v8, v9
  v_cvt_pk_bf16_f32 v8, 0, v8
  v_max_f32 v9, 0, v9
  v_cvt_pk_bf16_f32 v9, 0, v9
  v_sub_f32 v20, v20, v8
  v_sub_f32 v21, v21, v8
  v_add_f32 v9, 0x3727c5ac, v9
  v_sub_f32 v22, v22, v8
  v_sub_f32 v23, v23, v8
  v_cvt_pk_bf16_f32 v9, 0, v9
  v_cvt_pk_bf16_f32 v20, 0, v20
  v_sqrt_f32 v9, v9
  v_cvt_pk_bf16_f32 v21, 0, v21
  v_cvt_pk_bf16_f32 v9, 0, v9
  v_cvt_pk_bf16_f32 v22, 0, v22
  v_rcp_f32 v9, v9
  v_cvt_pk_bf16_f32 v23, 0, v23
  v_mul_f32 v20, v20, v9
  v_mul_f32 v21, v21, v9
  v_mul_f32 v22, v22, v9
  v_mul_f32 v23, v23, v9
  v_cvt_pk_bf16_f32 v20, 0, v20
  v_cvt_pk_bf16_f32 v21, 0, v21
  v_cvt_pk_bf16_f32 v22, 0, v22
  v_cvt_pk_bf16_f32 v23, 0, v23
  v_lshrrev_b32 v2, 2, v1
  v_bfe_u32 v3, v1, 1, 1
  s_lshl_b32 s49, s5, 1
  v_or_b32 v3, s49, v3
  v_and_b32 v10, 6, v2
  v_xor_b32 v3, v3, v10
  v_lshlrev_b32 v2, 7, v2
  v_lshl_add_u32 v2, v3, 4, v2
  v_and_b32 v3, 1, v1
  v_lshl_add_u32 v2, v3, 3, v2
  v_add_u32 v2, 20480, v2
  ds_read_b64_tr_b16 v[40:41], v2 offset:0
  ds_read_b64_tr_b16 v[42:43], v2 offset:2048
  ds_read_b64_tr_b16 v[44:45], v2 offset:4096
  ds_read_b64_tr_b16 v[46:47], v2 offset:6144
  ds_read_b64_tr_b16 v[48:49], v2 offset:8192
  ds_read_b64_tr_b16 v[50:51], v2 offset:10240
  ds_read_b64_tr_b16 v[52:53], v2 offset:12288
  ds_read_b64_tr_b16 v[54:55], v2 offset:14336
  ds_read_b64_tr_b16 v[56:57], v2 offset:16384
  ds_read_b64_tr_b16 v[58:59], v2 offset:18432
  ds_read_b64_tr_b16 v[60:61], v2 offset:20480
  ds_read_b64_tr_b16 v[62:63], v2 offset:22528
  s_waitcnt lgkmcnt(10)
  ds_read_b64_tr_b16 v[64:65], v2 offset:24576
  ds_read_b64_tr_b16 v[66:67], v2 offset:26624
  s_waitcnt lgkmcnt(10)
  ds_read_b64_tr_b16 v[68:69], v2 offset:28672
  ds_read_b64_tr_b16 v[70:71], v2 offset:30720
  s_waitcnt lgkmcnt(10)
  ds_read_b64_tr_b16 v[72:73], v2 offset:32768
  ds_read_b64_tr_b16 v[74:75], v2 offset:34816
  s_waitcnt lgkmcnt(10)
  ds_read_b64_tr_b16 v[76:77], v2 offset:36864
  ds_read_b64_tr_b16 v[78:79], v2 offset:38912
  s_waitcnt lgkmcnt(10)
  ds_read_b64_tr_b16 v[80:81], v2 offset:40960
  ds_read_b64_tr_b16 v[82:83], v2 offset:43008
  s_waitcnt lgkmcnt(10)
  ds_read_b64_tr_b16 v[84:85], v2 offset:45056
  ds_read_b64_tr_b16 v[86:87], v2 offset:47104
  s_waitcnt lgkmcnt(10)
  ds_read_b64_tr_b16 v[88:89], v2 offset:49152
  ds_read_b64_tr_b16 v[90:91], v2 offset:51200
  s_waitcnt lgkmcnt(10)
  ds_read_b64_tr_b16 v[92:93], v2 offset:53248
  ds_read_b64_tr_b16 v[94:95], v2 offset:55296
  s_waitcnt lgkmcnt(10)
  ds_read_b64_tr_b16 v[96:97], v2 offset:57344
  ds_read_b64_tr_b16 v[98:99], v2 offset:59392
  s_waitcnt lgkmcnt(10)
  ds_read_b64_tr_b16 v[100:101], v2 offset:61440
  ds_read_b64_tr_b16 v[102:103], v2 offset:63488
  s_waitcnt lgkmcnt(10)
  s_waitcnt lgkmcnt(0)
  v_and_b32 v13, 1, v1
  v_lshlrev_b32 v13, 6, v13
  v_lshrrev_b32 v3, 4, v1
  v_lshl_add_u32 v13, v3, 4, v13
  s_lshl_b32 s49, s5, 7
  s_add_u32 s49, s49, s58
  v_add_u32 v13, s49, v13
  v_and_b32 v14, 1, v1
  v_mul_u32_u24 v14, 1056, v14
  v_lshrrev_b32 v3, 4, v1
  v_lshl_add_u32 v14, v3, 4, v14
  v_lshlrev_b32 v15, 4, v0
  v_add_u32 v15, 4096, v15
  v_add_u32 v36, 0x1000, v15
  s_mov_b32 s70, 0
L_pl_44:
  ds_read_b32 v8, v38 offset:6672
  s_waitcnt lgkmcnt(0)
  v_cmp_eq_u32 vcc, -1, v8
  s_cmp_eq_u64 vcc, 0
  s_cbranch_scc1 L_pld_45
  s_sleep 8
  s_add_u32 s70, s70, 1
  s_cmp_lt_u32 s70, 1048576
  s_cbranch_scc1 L_pl_44
L_pld_45:
  s_mov_b64 s[64:65], -1
  s_mov_b64 s[66:67], -1
  s_mov_b32 s70, 0
L_q_p:
  s_mov_b64 exec, s[64:65]
  global_load_dwordx4 v[16:19], v15, s[42:43] sc1
  s_mov_b64 exec, s[66:67]
  global_load_dwordx4 v[32:35], v36, s[42:43] sc1
  s_mov_b64 exec, -1
  s_waitcnt vmcnt(0)
  v_cmp_ne_u32 s[64:65], s74, v17
  v_cmp_ne_u32 s[68:69], s74, v19
  s_or_b64 s[64:65], s[64:65], s[68:69]
  v_cmp_ne_u32 s[66:67], s74, v33
  v_cmp_ne_u32 s[68:69], s74, v35
  s_or_b64 s[66:67], s[66:67], s[68:69]
  s_or_b64 vcc, s[64:65], s[66:67]
  s_cmp_eq_u64 vcc, 0
  s_cbranch_scc1 L_q_ok
  s_add_u32 s70, s70, 1
  s_cmp_lt_u32 s70, 262144
  s_cbranch_scc1 L_q_p
L_q_ok:
  v_lshlrev_b32 v28, 16, v32
  v_and_b32 v29, s73, v32
  v_lshlrev_b32 v30, 16, v34
  v_and_b32 v31, s73, v34
  v_lshlrev_b32 v24, 16, v16
  v_and_b32 v25, s73, v16
  v_lshlrev_b32 v26, 16, v18
  v_and_b32 v27, s73, v18
  v_add_f32 v28, 1.0, v28
  v_add_f32 v29, 1.0, v29
  v_add_f32 v30, 1.0, v30
  v_add_f32 v31, 1.0, v31
  v_cvt_pk_bf16_f32 v28, 0, v28
  v_cvt_pk_bf16_f32 v29, 0, v29
  v_cvt_pk_bf16_f32 v30, 0, v30
  v_cvt_pk_bf16_f32 v31, 0, v31
  v_mul_f32 v20, v20, v28
  v_mul_f32 v21, v21, v29
  v_mul_f32 v22, v22, v30
  v_mul_f32 v23, v23, v31
  v_cvt_pk_bf16_f32 v20, 0, v20
  v_cvt_pk_bf16_f32 v21, 0, v21
  v_cvt_pk_bf16_f32 v22, 0, v22
  v_cvt_pk_bf16_f32 v23, 0, v23
  v_add_f32 v20, v20, v24
  v_add_f32 v21, v21, v25
  v_add_f32 v22, v22, v26
  v_add_f32 v23, v23, v27
  v_cvt_pk_bf16_f32 v16, v20, v21
  v_cvt_pk_bf16_f32 v17, v22, v23
  ds_write_b64 v12, v[16:17] offset:0
  v_mov_b32 v9, 1
  s_mov_b64 exec, 1
  ds_add_u32 v38, v9 offset:6720
  s_mov_b64 exec, -1
  s_mov_b32 s70, 0
L_hs_46:
  ds_read_b32 v9, v38 offset:6720
  s_waitcnt lgkmcnt(0)
  v_cmp_gt_u32 vcc, 16, v9
  s_cmp_eq_u64 vcc, 0
  s_cbranch_scc1 L_hsd_47
  s_add_u32 s70, s70, 1
  s_cmp_lt_u32 s70, 2097152
  s_cbranch_scc1 L_hs_46
L_hsd_47:
  ds_read_b128 v[104:107], v14 offset:0
  ds_read_b128 v[108:111], v14 offset:64
  ds_read_b128 v[112:115], v14 offset:128
  ds_read_b128 v[116:119], v14 offset:192
  ds_read_b128 v[120:123], v14 offset:256
  ds_read_b128 v[124:127], v14 offset:320
  ds_read_b128 v[128:131], v14 offset:384
  ds_read_b128 v[132:135], v14 offset:448
  ds_read_b128 v[136:139], v14 offset:512
  ds_read_b128 v[140:143], v14 offset:576
  ds_read_b128 v[144:147], v14 offset:640
  ds_read_b128 v[148:151], v14 offset:704
  s_waitcnt lgkmcnt(11)
  v_mfma_f32_16x16x32_bf16 v[8:11], v[40:43], v[104:107], 0
  ds_read_b128 v[152:155], v14 offset:768
  s_waitcnt lgkmcnt(11)
  v_mfma_f32_16x16x32_bf16 v[8:11], v[44:47], v[108:111], v[8:11]
  ds_read_b128 v[156:159], v14 offset:832
  s_waitcnt lgkmcnt(11)
  v_mfma_f32_16x16x32_bf16 v[8:11], v[48:51], v[112:115], v[8:11]
  ds_read_b128 v[160:163], v14 offset:896
  s_waitcnt lgkmcnt(11)
  v_mfma_f32_16x16x32_bf16 v[8:11], v[52:55], v[116:119], v[8:11]
  ds_read_b128 v[164:167], v14 offset:960
  s_waitcnt lgkmcnt(11)
  v_mfma_f32_16x16x32_bf16 v[8:11], v[56:59], v[120:123], v[8:11]
  s_waitcnt lgkmcnt(10)
  v_mfma_f32_16x16x32_bf16 v[8:11], v[60:63], v[124:127], v[8:11]
  s_waitcnt lgkmcnt(9)
  v_mfma_f32_16x16x32_bf16 v[8:11], v[64:67], v[128:131], v[8:11]
  s_waitcnt lgkmcnt(8)
  v_mfma_f32_16x16x32_bf16 v[8:11], v[68:71], v[132:135], v[8:11]
  s_waitcnt lgkmcnt(7)
  v_mfma_f32_16x16x32_bf16 v[8:11], v[72:75], v[136:139], v[8:11]
  s_waitcnt lgkmcnt(6)
  v_mfma_f32_16x16x32_bf16 v[8:11], v[76:79], v[140:143], v[8:11]
  s_waitcnt lgkmcnt(5)
  v_mfma_f32_16x16x32_bf16 v[8:11], v[80:83], v[144:147], v[8:11]
  s_waitcnt lgkmcnt(4)
  v_mfma_f32_16x16x32_bf16 v[8:11], v[84:87], v[148:151], v[8:11]
  s_waitcnt lgkmcnt(3)
  v_mfma_f32_16x16x32_bf16 v[8:11], v[88:91], v[152:155], v[8:11]
  s_waitcnt lgkmcnt(2)
  v_mfma_f32_16x16x32_bf16 v[8:11], v[92:95], v[156:159], v[8:11]
  s_waitcnt lgkmcnt(1)
  v_mfma_f32_16x16x32_bf16 v[8:11], v[96:99], v[160:163], v[8:11]
  s_waitcnt lgkmcnt(0)
  v_mfma_f32_16x16x32_bf16 v[8:11], v[100:103], v[164:167], v[8:11]
  s_nop 7
  v_cvt_pk_bf16_f32 v8, v8, v9
  v_cvt_pk_bf16_f32 v10, v10, v11
  v_mov_b32 v9, s74
  v_mov_b32 v11, s74
  v_min_u32 v8, s72, v8
  v_min_u32 v10, s72, v10
  s_mov_b32 exec_lo, 0x00030003
  s_mov_b32 exec_hi, 0x00030003
  global_store_dwordx4 v13, v[8:11], s[42:43] sc1
  s_mov_b64 exec, -1
  s_mov_b32 s60, 0
  s_branch L_svc1
L_r_wo:
  s_and_b32 s66, s2, 7
  s_lshr_b32 s58, s66, 1
  s_lshl_b32 s58, s58, 14
  s_and_b32 s49, s66, 1
  s_lshl_b32 s49, s49, 12
  s_add_u32 s58, s58, s49
  s_lshl_b32 s49, s61, 9
  s_add_u32 s58, s58, s49
  s_add_u32 s58, s58, 327680
  s_waitcnt lgkmcnt(0)
  s_mul_i32 s74, s74, 0x9e3779b1
  s_add_u32 s74, s74, 0x7f4a7c15
  s_add_u32 s76, s76, s74
  s_cmp_lg_u32 s5, 3
  s_cbranch_scc1 L_nr_48
  s_lshl_b32 s49, s61, 14
  s_lshl_b32 s50, s8, 10
  s_add_u32 s49, s49, s50
  s_add_u32 s49, s49, 524288
  s_add_u32 s50, s49, 256
  s_mov_b32 s54, 0
L_nrl_49:
  s_xor_b32 s55, s49, 0x2000
  s_mov_b32 s51, s74
  s_mov_b32 s52, s74
  s_load_dword s51, s[42:43], s49
  s_load_dword s52, s[42:43], s55
  s_waitcnt lgkmcnt(1)
  s_cmp_lg_u32 s52, s74
  s_addc_u32 s54, s54, 0
  s_cmp_lg_u32 s51, s74
  s_subb_u32 s54, s54, 0
  s_waitcnt lgkmcnt(0)
  s_add_u32 s49, s49, 128
  s_xor_b32 s55, s49, 0x2000
  s_mov_b32 s51, s74
  s_mov_b32 s52, s74
  s_load_dword s52, s[42:43], s55
  s_load_dword s51, s[42:43], s49
  s_waitcnt lgkmcnt(1)
  s_cmp_lg_u32 s52, s74
  s_addc_u32 s54, s54, 0
  s_cmp_lg_u32 s51, s74
  s_subb_u32 s54, s54, 0
  s_waitcnt lgkmcnt(0)
  s_add_u32 s49, s49, 128
  s_cmp_lt_u32 s49, s50
  s_cbranch_scc1 L_nrl_49
  s_cmp_lg_u32 s54, 0
  s_cselect_b32 s53, 0, 2
  s_cmp_gt_i32 s54, 0
  s_cselect_b32 s54, 1, 0
  s_sub_u32 s55, s76, s74
  s_lshr_b32 s55, s55, 2
  s_xor_b32 s54, s54, s55
  s_and_b32 s54, s54, 1
  s_or_b32 s54, s54, s53
  s_add_u32 s54, s54, s74
  s_lshl_b32 s55, s8, 3
  s_add_u32 s55, s55, s61
  s_lshl_b32 s55, s55, 5
  v_mov_b32 v8, s55
  v_mov_b32 v10, s76
  v_mov_b32 v11, s54
  s_mov_b64 exec, 1
  global_store_dwordx2 v8, v[10:11], s[42:43] offset:1024 sc1
  s_mov_b64 exec, -1
L_nr_48:
  s_mov_b32 s60, 1
  s_branch L_svc1
L_r_f1:
  s_lshl_b32 s48, s61, 6
  s_mul_i32 s49, s61, 47
  s_lshr_b32 s49, s49, 9
  s_mul_i32 s49, s49, 10752
  s_lshl_b32 s58, s61, 9
  s_add_u32 s58, s58, s49
  s_add_u32 s58, s58, 262144
  s_cmp_lt_u32 s5, 2
  s_cselect_b32 s44, s28, s30
  s_cselect_b32 s45, s29, s31
  s_mov_b32 s46, 1409024
  s_mov_b32 s47, 0x20000
  s_mov_b32 s60, 2
  s_waitcnt lgkmcnt(0)
  s_mul_i32 s74, s74, 0x9e3779b1
  s_add_u32 s74, s74, 0x7f4a7c15
  s_add_u32 s76, s76, s74
  s_branch L_svc1
L_r_f2:
  s_mov_b32 s44, s32
  s_mov_b32 s45, s33
  s_mov_b32 s46, 1409024
  s_mov_b32 s47, 0x20000
  s_waitcnt lgkmcnt(0)
  s_mul_i32 s74, s74, 0x9e3779b1
  s_add_u32 s74, s74, 0x7f4a7c15
  s_add_u32 s76, s76, s74
  s_mov_b32 s60, 3
  s_lshl_b32 s48, s61, 5
  global_load_dword v167, v38, s[38:39]
  s_branch L_svc1
L_r_none:
  s_mov_b32 s60, 0
  s_waitcnt lgkmcnt(0)
  s_mul_i32 s74, s74, 0x9e3779b1
  s_add_u32 s74, s74, 0x7f4a7c15
  s_add_u32 s76, s76, s74
L_svc1:
  s_cmp_lg_u32 s5, 0
  s_cbranch_scc1 L_disp3
  s_and_b32 s64, s6, 31
  s_lshl_b32 s64, s64, 10
  s_and_b32 s65, s6, 32
  s_lshl_b32 s65, s65, 1
  s_add_u32 s64, s64, s65
  s_add_u32 s64, s64, 32768
  v_bfe_u32 v16, v1, 2, 3
  v_lshl_add_u32 v16, v16, 7, s64
  v_and_b32 v17, 3, v1
  v_lshl_add_u32 v16, v17, 4, v16
  v_and_b32 v17, 31, v1
  v_lshlrev_b32 v17, 3, v17
  s_lshl_b32 s71, s8, 8
  v_and_b32 v18, 7, v1
  v_lshl_add_u32 v18, v18, 5, s71
  s_mov_b32 s70, 0
L_pl_50:
  ds_read_b32 v8, v38 offset:6664
  s_waitcnt lgkmcnt(0)
  v_cmp_eq_u32 vcc, -1, v8
  s_cmp_eq_u64 vcc, 0
  s_cbranch_scc1 L_pld_51
  s_sleep 8
  s_add_u32 s70, s70, 1
  s_cmp_lt_u32 s70, 1048576
  s_cbranch_scc1 L_pl_50
L_pld_51:
  global_load_dword v19, v18, s[42:43] offset:1024 sc1
  s_mov_b32 s70, 0
L_polt_52:
  global_load_dwordx4 v[20:23], v16, s[42:43] sc1
  s_waitcnt vmcnt(0)
  v_cmp_ne_u32 vcc, s74, v21
  v_cmp_ne_u32 s[68:69], s74, v23
  s_or_b64 vcc, vcc, s[68:69]
  s_cmp_eq_u64 vcc, 0
  s_cbranch_scc1 L_poltd_53
  s_add_u32 s70, s70, 1
  s_cmp_lt_u32 s70, 262144
  s_cbranch_scc1 L_polt_52
L_poltd_53:
  v_mov_b32 v21, v22
  ds_write_b64 v17, v[20:21] offset:6400
  v_cmp_ne_u32 vcc, s76, v19
  s_cmp_eq_u64 vcc, 0
  s_cselect_b32 s75, 1, 0
  v_mov_b32 v20, s74
  v_mov_b32 v21, s75
  ds_write_b64 v38, v[20:21] offset:6688
L_svc2:
  v_lshlrev_b32 v16, 4, v1
  s_lshl_b32 s64, s6, 9
  s_add_u32 s64, s64, 65536
  s_lshl_b32 s65, s7, 7
  s_add_u32 s65, s65, s64
  v_mov_b32 v18, s65
  s_mov_b32 s70, 0
L_pl_54:
  ds_read_b128 v[104:107], v16 offset:12032
  ds_read_b128 v[108:111], v16 offset:13056
  ds_read_b128 v[112:115], v16 offset:14080
  ds_read_b128 v[116:119], v16 offset:15104
  ds_read_b128 v[120:123], v16 offset:16128
  ds_read_b128 v[124:127], v16 offset:17152
  ds_read_b128 v[128:131], v16 offset:18176
  ds_read_b128 v[132:135], v16 offset:19200
  s_waitcnt lgkmcnt(0)
  v_max3_u32 v8, v104, v105, v106
  v_max3_u32 v8, v8, v108, v109
  v_max3_u32 v8, v8, v110, v112
  v_max3_u32 v8, v8, v113, v114
  v_max3_u32 v8, v8, v116, v117
  v_max3_u32 v8, v8, v118, v120
  v_max3_u32 v8, v8, v121, v122
  v_max3_u32 v8, v8, v124, v125
  v_max3_u32 v8, v8, v126, v128
  v_max3_u32 v8, v8, v129, v130
  v_max3_u32 v8, v8, v132, v133
  v_max_u32 v8, v8, v134
  v_cmp_eq_u32 vcc, -1, v8
  s_cmp_eq_u64 vcc, 0
  s_cbranch_scc1 L_pld_55
  s_sleep 4
  s_add_u32 s70, s70, 1
  s_cmp_lt_u32 s70, 1048576
  s_cbranch_scc1 L_pl_54
L_pld_55:
  v_max3_f32 v8, v104, v105, v106
  v_max3_f32 v8, v8, v108, v109
  v_max3_f32 v8, v8, v110, v112
  v_max3_f32 v8, v8, v113, v114
  v_max3_f32 v8, v8, v116, v117
  v_max3_f32 v8, v8, v118, v120
  v_max3_f32 v8, v8, v121, v122
  v_max3_f32 v8, v8, v124, v125
  v_max3_f32 v8, v8, v126, v128
  v_max3_f32 v8, v8, v129, v130
  v_max3_f32 v8, v8, v132, v133
  v_max_f32 v8, v8, v134
  s_nop 1
  v_max_f32_dpp v8, v8, v8 row_ror:8 row_mask:0xf bank_mask:0xf
  s_nop 1
  v_max_f32_dpp v8, v8, v8 row_ror:4 row_mask:0xf bank_mask:0xf
  s_nop 1
  v_max_f32_dpp v8, v8, v8 row_ror:2 row_mask:0xf bank_mask:0xf
  s_nop 1
  v_max_f32_dpp v8, v8, v8 row_ror:1 row_mask:0xf bank_mask:0xf
  v_mov_b32 v11, v8
  s_nop 1
  v_permlane16_swap_b32 v11, v8
  v_max_f32 v8, v8, v11
  v_mov_b32 v11, v8
  s_nop 1
  v_permlane32_swap_b32 v11, v8
  v_max_f32 v8, v8, v11
  v_min_u32 v9, s72, v8
  ds_write_b32 v38, v9 offset:6656
  v_sub_f32 v104, v104, v8
  v_sub_f32 v105, v105, v8
  v_sub_f32 v106, v106, v8
  v_sub_f32 v108, v108, v8
  v_sub_f32 v109, v109, v8
  v_sub_f32 v110, v110, v8
  v_sub_f32 v112, v112, v8
  v_sub_f32 v113, v113, v8
  v_sub_f32 v114, v114, v8
  v_sub_f32 v116, v116, v8
  v_sub_f32 v117, v117, v8
  v_sub_f32 v118, v118, v8
  v_sub_f32 v120, v120, v8
  v_sub_f32 v121, v121, v8
  v_sub_f32 v122, v122, v8
  v_sub_f32 v124, v124, v8
  v_sub_f32 v125, v125, v8
  v_sub_f32 v126, v126, v8
  v_sub_f32 v128, v128, v8
  v_sub_f32 v129, v129, v8
  v_sub_f32 v130, v130, v8
  v_sub_f32 v132, v132, v8
  v_sub_f32 v133, v133, v8
  v_sub_f32 v134, v134, v8
  v_mul_f32 v104, 0x3fb8aa3b, v104
  v_mul_f32 v105, 0x3fb8aa3b, v105
  v_mul_f32 v106, 0x3fb8aa3b, v106
  v_mul_f32 v108, 0x3fb8aa3b, v108
  v_mul_f32 v109, 0x3fb8aa3b, v109
  v_mul_f32 v110, 0x3fb8aa3b, v110
  v_mul_f32 v112, 0x3fb8aa3b, v112
  v_mul_f32 v113, 0x3fb8aa3b, v113
  v_mul_f32 v114, 0x3fb8aa3b, v114
  v_mul_f32 v116, 0x3fb8aa3b, v116
  v_mul_f32 v117, 0x3fb8aa3b, v117
  v_mul_f32 v118, 0x3fb8aa3b, v118
  v_mul_f32 v120, 0x3fb8aa3b, v120
  v_mul_f32 v121, 0x3fb8aa3b, v121
  v_mul_f32 v122, 0x3fb8aa3b, v122
  v_mul_f32 v124, 0x3fb8aa3b, v124
  v_mul_f32 v125, 0x3fb8aa3b, v125
  v_mul_f32 v126, 0x3fb8aa3b, v126
  v_mul_f32 v128, 0x3fb8aa3b, v128
  v_mul_f32 v129, 0x3fb8aa3b, v129
  v_mul_f32 v130, 0x3fb8aa3b, v130
  v_mul_f32 v132, 0x3fb8aa3b, v132
  v_mul_f32 v133, 0x3fb8aa3b, v133
  v_mul_f32 v134, 0x3fb8aa3b, v134
  v_exp_f32 v104, v104
  v_exp_f32 v105, v105
  v_exp_f32 v106, v106
  v_exp_f32 v108, v108
  v_exp_f32 v109, v109
  v_exp_f32 v110, v110
  v_exp_f32 v112, v112
  v_exp_f32 v113, v113
  v_exp_f32 v114, v114
  v_exp_f32 v116, v116
  v_exp_f32 v117, v117
  v_exp_f32 v118, v118
  v_exp_f32 v120, v120
  v_exp_f32 v121, v121
  v_exp_f32 v122, v122
  v_exp_f32 v124, v124
  v_exp_f32 v125, v125
  v_exp_f32 v126, v126
  v_exp_f32 v128, v128
  v_exp_f32 v129, v129
  v_exp_f32 v130, v130
  v_exp_f32 v132, v132
  v_exp_f32 v133, v133
  v_exp_f32 v134, v134
  s_nop 0
  v_add_f32 v104, v104, v120
  v_add_f32 v105, v105, v121
  v_add_f32 v106, v106, v122
  v_add_f32 v108, v108, v124
  v_add_f32 v109, v109, v125
  v_add_f32 v110, v110, v126
  v_add_f32 v112, v112, v128
  v_add_f32 v113, v113, v129
  v_add_f32 v114, v114, v130
  v_add_f32 v116, v116, v132
  v_add_f32 v117, v117, v133
  v_add_f32 v118, v118, v134
  v_add_f32 v104, v104, v112
  v_add_f32 v105, v105, v113
  v_add_f32 v106, v106, v114
  v_add_f32 v108, v108, v116
  v_add_f32 v109, v109, v117
  v_add_f32 v110, v110, v118
  v_add_f32 v104, v104, v108
  v_add_f32 v105, v105, v109
  v_add_f32 v106, v106, v110
  v_add_f32 v10, v104, v105
  v_add_f32 v10, v10, v106
  s_nop 1
  v_add_f32_dpp v10, v10, v10 row_ror:8 row_mask:0xf bank_mask:0xf
  s_nop 1
  v_add_f32_dpp v10, v10, v10 row_ror:4 row_mask:0xf bank_mask:0xf
  s_nop 1
  v_add_f32_dpp v10, v10, v10 row_ror:2 row_mask:0xf bank_mask:0xf
  s_nop 1
  v_add_f32_dpp v10, v10, v10 row_ror:1 row_mask:0xf bank_mask:0xf
  v_mov_b32 v11, v10
  s_nop 1
  v_permlane16_swap_b32 v11, v10
  v_add_f32 v10, v10, v11
  v_mov_b32 v11, v10
  s_nop 1
  v_permlane32_swap_b32 v11, v10
  v_add_f32 v10, v10, v11
  v_mov_b32 v9, s74
  v_mov_b32 v11, s74
  s_mov_b64 exec, 1
  s_cmp_eq_u32 s75, 1
  s_cbranch_scc0 L_pf_56
  global_store_dwordx4 v18, v[8:11], s[42:43]
  s_branch L_pe_57
L_pf_56:
  global_store_dwordx4 v18, v[8:11], s[42:43] sc1
L_pe_57:
  s_mov_b64 exec, -1
L_disp3:
  s_mov_b32 s77, 0
  s_bfe_u32 s62, s74, 0x80000
  s_bfe_u32 s63, s74, 0x80008
  s_bfe_u32 s64, s74, 0x80010
  s_bfe_u32 s65, s74, 0x80018
  s_cmp_lg_u32 s5, 2
  s_cbranch_scc1 L_opt_58
  s_mov_b32 s70, 0
L_pl_59:
  ds_read_b32 v8, v38 offset:6656
  s_waitcnt lgkmcnt(0)
  v_cmp_eq_u32 vcc, -1, v8
  s_cmp_eq_u64 vcc, 0
  s_cbranch_scc1 L_pld_60
  s_sleep 32
  s_add_u32 s70, s70, 1
  s_cmp_lt_u32 s70, 1048576
  s_cbranch_scc1 L_pl_59
L_pld_60:
  s_lshl_b32 s56, s6, 2
  s_add_u32 s56, s56, s7
  s_lshl_b32 s57, s56, 9
  s_add_u32 s57, s57, 131072
  v_lshl_add_u32 v3, v1, 3, s57
  global_load_dword v167, v3, s[42:43] sc1
L_opt_58:
  s_cmp_eq_u32 s60, 2
  s_cbranch_scc1 L_pre_f1
  s_cmp_eq_u32 s60, 3
  s_cbranch_scc1 L_pre_f2
  s_cmp_eq_u32 s60, 1
  s_cbranch_scc1 L_pre_wo
  s_lshr_b32 s68, s14, 29
  s_mul_i32 s68, s68, 1
  s_xor_b32 s68, s68, s8
  s_lshl_b32 s68, s68, 3
  s_add_u32 s68, s68, L_gtab-L_pc2
  s_load_dwordx2 s[100:101], s[100:101], s68
  s_waitcnt lgkmcnt(0)
  s_lshr_b32 s68, s14, 26
  s_lshl_b32 s68, s68, 2
  s_add_u32 s68, s68, s5
  s_and_b32 s68, s68, 31
  s_and_b32 s69, s100, 0xffff
  s_lshr_b32 s100, s100, 16
  v_and_b32 v12, 3, v1
  v_lshl_add_u32 v12, v12, 7, s69
  v_min_u32 v12, s100, v12
  v_lshrrev_b32 v13, 2, v1
  v_mul_u32_u24 v13, 2752, v13
  s_mul_i32 s69, s68, 44032
  v_add3_u32 v12, v12, v13, s69
  v_min_u32 v13, 42, v1
  s_mul_i32 s68, s68, 44032
  s_add_u32 s68, s68, s101
  v_lshl_add_u32 v13, v13, 10, s68
  s_branch L_join
L_pre_wo:
  s_mov_b32 s70, 0
L_hs_61:
  ds_read_b32 v9, v38 offset:6720
  s_waitcnt lgkmcnt(0)
  v_cmp_gt_u32 vcc, 8, v9
  s_cmp_eq_u64 vcc, 0
  s_cbranch_scc1 L_hsd_62
  s_sleep 8
  s_add_u32 s70, s70, 1
  s_cmp_lt_u32 s70, 2097152
  s_cbranch_scc1 L_hs_61
L_hsd_62:
  v_lshrrev_b32 v2, 2, v1
  v_bfe_u32 v3, v1, 1, 1
  s_lshl_b32 s49, s5, 1
  v_or_b32 v3, s49, v3
  v_and_b32 v10, 6, v2
  v_xor_b32 v3, v3, v10
  v_lshlrev_b32 v2, 7, v2
  v_lshl_add_u32 v2, v3, 4, v2
  v_and_b32 v3, 1, v1
  v_lshl_add_u32 v2, v3, 3, v2
  v_add_u32 v2, 20480, v2
  s_add_u32 s49, s5, 0
  s_and_b32 s49, s49, 3
  s_mul_i32 s49, s49, 16384
  v_add_u32 v3, s49, v2
  ds_read_b64_tr_b16 v[40:41], v3 offset:0
  ds_read_b64_tr_b16 v[42:43], v3 offset:2048
  ds_read_b64_tr_b16 v[44:45], v3 offset:4096
  ds_read_b64_tr_b16 v[46:47], v3 offset:6144
  ds_read_b64_tr_b16 v[48:49], v3 offset:8192
  ds_read_b64_tr_b16 v[50:51], v3 offset:10240
  ds_read_b64_tr_b16 v[52:53], v3 offset:12288
  ds_read_b64_tr_b16 v[54:55], v3 offset:14336
  s_add_u32 s49, s5, 1
  s_and_b32 s49, s49, 3
  s_mul_i32 s49, s49, 16384
  v_add_u32 v3, s49, v2
  ds_read_b64_tr_b16 v[56:57], v3 offset:0
  ds_read_b64_tr_b16 v[58:59], v3 offset:2048
  ds_read_b64_tr_b16 v[60:61], v3 offset:4096
  ds_read_b64_tr_b16 v[62:63], v3 offset:6144
  s_waitcnt lgkmcnt(10)
  ds_read_b64_tr_b16 v[64:65], v3 offset:8192
  ds_read_b64_tr_b16 v[66:67], v3 offset:10240
  s_waitcnt lgkmcnt(10)
  ds_read_b64_tr_b16 v[68:69], v3 offset:12288
  ds_read_b64_tr_b16 v[70:71], v3 offset:14336
  s_waitcnt lgkmcnt(10)
  s_add_u32 s49, s5, 2
  s_and_b32 s49, s49, 3
  s_mul_i32 s49, s49, 16384
  v_add_u32 v3, s49, v2
  ds_read_b64_tr_b16 v[72:73], v3 offset:0
  ds_read_b64_tr_b16 v[74:75], v3 offset:2048
  s_waitcnt lgkmcnt(10)
  ds_read_b64_tr_b16 v[76:77], v3 offset:4096
  ds_read_b64_tr_b16 v[78:79], v3 offset:6144
  s_waitcnt lgkmcnt(10)
  ds_read_b64_tr_b16 v[80:81], v3 offset:8192
  ds_read_b64_tr_b16 v[82:83], v3 offset:10240
  s_waitcnt lgkmcnt(10)
  ds_read_b64_tr_b16 v[84:85], v3 offset:12288
  ds_read_b64_tr_b16 v[86:87], v3 offset:14336
  s_waitcnt lgkmcnt(10)
  s_add_u32 s49, s5, 3
  s_and_b32 s49, s49, 3
  s_mul_i32 s49, s49, 16384
  v_add_u32 v3, s49, v2
  ds_read_b64_tr_b16 v[88:89], v3 offset:0
  ds_read_b64_tr_b16 v[90:91], v3 offset:2048
  s_waitcnt lgkmcnt(10)
  ds_read_b64_tr_b16 v[92:93], v3 offset:4096
  ds_read_b64_tr_b16 v[94:95], v3 offset:6144
  s_waitcnt lgkmcnt(10)
  ds_read_b64_tr_b16 v[96:97], v3 offset:8192
  ds_read_b64_tr_b16 v[98:99], v3 offset:10240
  s_waitcnt lgkmcnt(10)
  ds_read_b64_tr_b16 v[100:101], v3 offset:12288
  ds_read_b64_tr_b16 v[102:103], v3 offset:14336
  s_waitcnt lgkmcnt(10)
  s_waitcnt lgkmcnt(0)
  s_lshl_b32 s49, s5, 3
  s_add_u32 s49, s49, s66
  s_lshl_b32 s50, s49, 9
  s_add_u32 s50, s50, 65536
  v_lshrrev_b32 v12, 5, v1
  v_lshl_add_u32 v15, v12, 14, s50
  v_and_b32 v16, 3, v1
  v_lshl_add_u32 v15, v16, 7, v15
  s_mov_b32 s70, 0
L_pl_63:
  ds_read_b32 v8, v38 offset:6676
  s_waitcnt lgkmcnt(0)
  v_cmp_eq_u32 vcc, -1, v8
  s_cmp_eq_u64 vcc, 0
  s_cbranch_scc1 L_pld_64
  s_sleep 16
  s_add_u32 s70, s70, 1
  s_cmp_lt_u32 s70, 1048576
  s_cbranch_scc1 L_pl_63
L_pld_64:
  s_mov_b32 s70, 0
L_polt_65:
  global_load_dwordx4 v[16:19], v15, s[42:43] sc1
  s_waitcnt vmcnt(0)
  v_cmp_ne_u32 vcc, s74, v17
  v_cmp_ne_u32 s[68:69], s74, v19
  s_or_b64 vcc, vcc, s[68:69]
  s_cmp_eq_u64 vcc, 0
  s_cbranch_scc1 L_poltd_66
  s_sleep 8
  s_add_u32 s70, s70, 1
  s_cmp_lt_u32 s70, 262144
  s_cbranch_scc1 L_polt_65
L_poltd_66:
  v_max_f32_dpp v10, v16, v16 quad_perm:[1,0,3,2] row_mask:0xf bank_mask:0xf
  s_nop 1
  v_max_f32_dpp v10, v10, v10 quad_perm:[2,3,0,1] row_mask:0xf bank_mask:0xf
  v_sub_f32 v8, v16, v10
  v_mul_f32 v8, 0x3fb8aa3b, v8
  v_exp_f32 v8, v8
  s_nop 0
  v_mul_f32 v9, v18, v8
  s_nop 1
  v_add_f32_dpp v9, v9, v9 quad_perm:[1,0,3,2] row_mask:0xf bank_mask:0xf
  s_nop 1
  v_add_f32_dpp v9, v9, v9 quad_perm:[2,3,0,1] row_mask:0xf bank_mask:0xf
  v_rcp_f32 v9, v9
  s_nop 0
  v_mul_f32 v8, v8, v9
  s_nop 1
  v_mov_b32_dpp v20, v8 quad_perm:[0,0,0,0] row_mask:0xf bank_mask:0xf
  v_mov_b32_dpp v21, v8 quad_perm:[1,1,1,1] row_mask:0xf bank_mask:0xf
  v_mov_b32_dpp v22, v8 quad_perm:[2,2,2,2] row_mask:0xf bank_mask:0xf
  v_mov_b32_dpp v23, v8 quad_perm:[3,3,3,3] row_mask:0xf bank_mask:0xf
  s_lshl_b32 s49, s49, 11
  s_add_u32 s49, s49, 131072
  v_lshrrev_b32 v12, 5, v1
  v_and_b32 v16, 31, v1
  v_lshlrev_b32 v15, 16, v12
  v_lshl_add_u32 v15, v16, 4, v15
  v_add_u32 v15, s49, v15
  v_mul_u32_u24 v12, 1056, v12
  v_bfe_u32 v16, v1, 3, 2
  v_lshl_add_u32 v12, v16, 6, v12
  v_and_b32 v16, 3, v1
  v_lshl_add_u32 v12, v16, 4, v12
  v_bfe_u32 v16, v1, 2, 1
  v_lshl_add_u32 v12, v16, 3, v12
  s_lshl_b32 s49, s5, 8
  v_add_u32 v12, s49, v12
  v_and_b32 v14, 1, v1
  v_mul_u32_u24 v14, 1056, v14
  v_lshrrev_b32 v3, 4, v1
  v_lshl_add_u32 v14, v3, 4, v14
  v_and_b32 v13, 1, v1
  v_lshlrev_b32 v13, 6, v13
  v_lshrrev_b32 v3, 4, v1
  v_lshl_add_u32 v13, v3, 4, v13
  s_lshl_b32 s49, s5, 7
  s_add_u32 s49, s49, s58
  v_add_u32 v13, s49, v13
  v_add_u32 v37, 0x2000, v13
  v_mov_b32 v36, 0xff
  s_add_u32 s49, s5, 1
  s_and_b32 s49, s49, 3
  s_lshl_b32 s49, s49, 8
  v_add_u32 v0, s49, v14
  s_add_u32 s49, s5, 2
  s_and_b32 s49, s49, 3
  s_lshl_b32 s49, s49, 8
  v_add_u32 v2, s49, v14
  s_add_u32 s49, s5, 3
  s_and_b32 s49, s49, 3
  s_lshl_b32 s49, s49, 8
  v_add_u32 v3, s49, v14
  s_add_u32 s49, s5, 0
  s_and_b32 s49, s49, 3
  s_lshl_b32 s49, s49, 8
  v_add_u32 v14, s49, v14
  s_branch L_join
L_pre_f1:
  s_cmp_lg_u32 s5, 3
  s_cbranch_scc1 L_hc_67
  s_mov_b32 s70, 0
L_pl_68:
  ds_read_b32 v8, v38 offset:6400
  s_waitcnt lgkmcnt(0)
  v_cmp_eq_u32 vcc, -1, v8
  s_cmp_eq_u64 vcc, 0
  s_cbranch_scc1 L_pld_69
  s_sleep 32
  s_add_u32 s70, s70, 1
  s_cmp_lt_u32 s70, 1048576
  s_cbranch_scc1 L_pl_68
L_pld_69:
  v_lshlrev_b32 v110, 5, v1
  global_load_dword v109, v110, s[42:43] offset:1028 sc1
  s_waitcnt vmcnt(0)
  v_subrev_u32 v109, s74, v109
  v_cmp_eq_u32 vcc, 1, v109
  s_bcnt1_i32_b64 s70, vcc
  v_cmp_eq_u32 vcc, 0, v109
  s_bcnt1_i32_b64 s71, vcc
  s_cmp_gt_u32 s70, s71
  s_cselect_b32 s71, 4, 0
  s_sub_u32 s68, s76, s74
  s_xor_b32 s71, s71, s68
  s_and_b32 s71, s71, 4
  s_lshl_b32 s71, s71, 11
  v_mov_b32 v104, s71
  ds_write_b32 v38, v104 offset:6668
L_hc_67:
  v_mov_b32 v31, v13
  v_lshlrev_b32 v15, 4, v0
  v_add_u32 v24, 12288, v15
  v_add_u32 v25, 16384, v15
  v_add_u32 v26, 20480, v15
  s_mov_b32 s70, 0
L_pl_70:
  ds_read_b32 v11, v38 offset:6668
  s_waitcnt lgkmcnt(0)
  v_cmp_eq_u32 vcc, -1, v11
  s_cmp_eq_u64 vcc, 0
  s_cbranch_scc1 L_pld_71
  s_sleep 8
  s_add_u32 s70, s70, 1
  s_cmp_lt_u32 s70, 1048576
  s_cbranch_scc1 L_pl_70
L_pld_71:
  v_add_u32 v15, 327680, v15
  v_add_u32 v15, v11, v15
  v_add_u32 v35, 4096, v15
  v_add_u32 v32, 16384, v15
  v_add_u32 v36, 20480, v15
  v_add_u32 v33, 32768, v15
  v_add_u32 v37, 36864, v15
  v_add_u32 v34, 49152, v15
  v_add_u32 v39, 53248, v15
  v_bfe_u32 v5, v1, 2, 1
  v_mul_u32_u24 v5, 1056, v5
  v_lshrrev_b32 v3, 3, v0
  v_lshl_add_u32 v5, v3, 5, v5
  v_and_b32 v3, 3, v1
  v_lshl_add_u32 v5, v3, 3, v5
  v_and_b32 v14, 7, v1
  v_mul_u32_u24 v14, 1056, v14
  v_lshrrev_b32 v3, 4, v1
  v_lshl_add_u32 v14, v3, 4, v14
  v_and_b32 v7, 1, v1
  v_mul_u32_u24 v7, 1056, v7
  v_lshrrev_b32 v3, 1, v1
  v_lshl_add_u32 v7, v3, 5, v7
  v_and_b32 v13, 3, v1
  v_lshlrev_b32 v13, 5, v13
  v_bfe_u32 v3, v1, 4, 1
  v_lshl_add_u32 v13, v3, 3, v13
  s_lshl_b32 s49, s5, 7
  s_add_u32 s49, s49, s58
  v_add_u32 v13, s49, v13
  v_lshrrev_b32 v3, 5, v1
  v_lshl_add_u32 v13, v3, 4, v13
  v_add_u32 v4, 0x2000, v13
  s_and_b32 s54, s61, 1
  s_mul_i32 s52, s54, -2
  s_add_u32 s52, s52, 1
  s_mul_i32 s53, s52, 16384
  s_sub_u32 s53, s53, 8192
  s_mul_i32 s52, s52, 2752
  s_sub_u32 s52, s52, 704512
  v_lshrrev_b32 v2, 2, v1
  v_mul_u32_u24 v2, 5504, v2
  s_and_b32 s49, s5, 2
  s_or_b32 s49, s49, s54
  v_xor_b32 v3, s49, v1
  v_and_b32 v3, 3, v3
  v_lshl_add_u32 v2, v3, 4, v2
  v_mov_b32 v0, v2
  v_lshrrev_b32 v6, 3, v1
  v_lshlrev_b32 v6, 6, v6
  v_bfe_u32 v3, v1, 2, 1
  v_lshl_add_u32 v6, v3, 14, v6
  v_and_b32 v8, 2, v1
  v_or_b32 v3, v3, v8
  v_xor_b32 v3, s5, v3
  v_lshl_add_u32 v6, v3, 4, v6
  v_lshl_add_u32 v6, v8, 14, v6
  v_and_b32 v3, 1, v1
  v_lshl_add_u32 v6, v3, 3, v6
  v_add_u32 v6, 20480, v6
  s_and_b32 s55, s5, 1
  s_mul_i32 s49, s55, 704512
  s_add_u32 s49, s49, s48
  s_mul_i32 s50, s54, 2752
  s_add_u32 s49, s49, s50
  s_lshr_b32 s50, s5, 1
  s_lshl_b32 s50, s50, 15
  s_lshl_b32 s54, s54, 14
  s_add_u32 s50, s50, s54
  s_lshl_b32 s55, s55, 13
  s_add_u32 s50, s50, s55
  s_add_u32 s50, s50, 20480
  s_mov_b32 s70, 0
L_pl_72:
  ds_read_b32 v8, v38 offset:6676
  s_waitcnt lgkmcnt(0)
  v_cmp_eq_u32 vcc, -1, v8
  s_cmp_eq_u64 vcc, 0
  s_cbranch_scc1 L_pld_73
  s_sleep 16
  s_add_u32 s70, s70, 1
  s_cmp_lt_u32 s70, 1048576
  s_cbranch_scc1 L_pl_72
L_pld_73:
  global_load_dwordx2 v[8:9], v31, s[16:17]
  s_mov_b32 s70, 0
L_polt_74:
  global_load_dwordx4 v[136:139], v24, s[42:43] sc1
  global_load_dwordx4 v[140:143], v25, s[42:43] sc1
  global_load_dwordx4 v[144:147], v26, s[42:43] sc1
  s_waitcnt vmcnt(0)
  v_cmp_ne_u32 vcc, s74, v137
  v_cmp_ne_u32 s[68:69], s74, v139
  s_or_b64 vcc, vcc, s[68:69]
  v_cmp_ne_u32 s[68:69], s74, v141
  s_or_b64 vcc, vcc, s[68:69]
  v_cmp_ne_u32 s[68:69], s74, v143
  s_or_b64 vcc, vcc, s[68:69]
  v_cmp_ne_u32 s[68:69], s74, v145
  s_or_b64 vcc, vcc, s[68:69]
  v_cmp_ne_u32 s[68:69], s74, v147
  s_or_b64 vcc, vcc, s[68:69]
  s_cmp_eq_u64 vcc, 0
  s_cbranch_scc1 L_poltd_75
  s_sleep 8
  s_add_u32 s70, s70, 1
  s_cmp_lt_u32 s70, 262144
  s_cbranch_scc1 L_polt_74
L_poltd_75:
  v_lshlrev_b32 v16, 16, v8
  v_and_b32 v17, s73, v8
  v_lshlrev_b32 v18, 16, v9
  v_and_b32 v19, s73, v9
  v_lshlrev_b32 v20, 16, v136
  v_and_b32 v21, s73, v136
  v_lshlrev_b32 v22, 16, v138
  v_and_b32 v23, s73, v138
  v_lshlrev_b32 v28, 16, v144
  v_and_b32 v29, s73, v144
  v_lshlrev_b32 v30, 16, v146
  v_and_b32 v31, s73, v146
  v_add_f32 v28, 1.0, v28
  v_add_f32 v29, 1.0, v29
  v_add_f32 v30, 1.0, v30
  v_add_f32 v31, 1.0, v31
  v_cvt_pk_bf16_f32 v8, v28, v29
  v_cvt_pk_bf16_f32 v9, v30, v31
  v_mov_b32 v141, v142
  ds_write_b64 v12, v[8:9] offset:2112
  ds_write_b64 v12, v[140:141] offset:4224
  v_cvt_pk_bf16_f32 v28, 0, v28
  v_cvt_pk_bf16_f32 v29, 0, v29
  v_cvt_pk_bf16_f32 v30, 0, v30
  v_cvt_pk_bf16_f32 v31, 0, v31
  v_mul_f32 v24, v20, v28
  v_mul_f32 v25, v21, v29
  v_mul_f32 v26, v22, v30
  v_mul_f32 v27, v23, v31
  v_mul_f32 v28, v16, v28
  v_mul_f32 v29, v17, v29
  v_mul_f32 v30, v18, v30
  v_mul_f32 v31, v19, v31
  s_branch L_join
L_pre_f2:
  s_cmp_lg_u32 s5, 3
  s_cbranch_scc1 L_hc_76
  s_mov_b32 s70, 0
L_pl_77:
  ds_read_b32 v8, v38 offset:6400
  s_waitcnt lgkmcnt(0)
  v_cmp_eq_u32 vcc, -1, v8
  s_cmp_eq_u64 vcc, 0
  s_cbranch_scc1 L_pld_78
  s_sleep 32
  s_add_u32 s70, s70, 1
  s_cmp_lt_u32 s70, 1048576
  s_cbranch_scc1 L_pl_77
L_pld_78:
  v_lshlrev_b32 v110, 5, v1
  global_load_dword v109, v110, s[42:43] offset:1028 sc1
  s_waitcnt vmcnt(0)
  v_subrev_u32 v109, s74, v109
  v_cmp_eq_u32 vcc, 1, v109
  s_bcnt1_i32_b64 s70, vcc
  v_cmp_eq_u32 vcc, 0, v109
  s_bcnt1_i32_b64 s71, vcc
  s_cmp_gt_u32 s70, s71
  s_cselect_b32 s71, 4, 0
  s_sub_u32 s68, s76, s74
  s_xor_b32 s71, s71, s68
  s_and_b32 s71, s71, 4
  s_lshl_b32 s71, s71, 11
  v_mov_b32 v104, s71
  ds_write_b32 v38, v104 offset:6668
L_hc_76:
  v_and_b32 v12, 1, v1
  v_lshrrev_b32 v14, 4, v1
  s_lshl_b32 s49, s61, 5
  v_lshl_add_u32 v3, v14, 3, s49
  v_lshl_add_u32 v13, v12, 10, v3
  v_mov_b32 v31, v13
  v_lshlrev_b32 v15, 6, v12
  v_lshl_add_u32 v15, v14, 4, v15
  s_lshl_b32 s49, s61, 7
  v_add_u32 v15, s49, v15
  v_add_u32 v24, 12288, v15
  v_add_u32 v25, 24576, v15
  s_mov_b32 s70, 0
L_pl_79:
  ds_read_b32 v11, v38 offset:6668
  s_waitcnt lgkmcnt(0)
  v_cmp_eq_u32 vcc, -1, v11
  s_cmp_eq_u64 vcc, 0
  s_cbranch_scc1 L_pld_80
  s_sleep 8
  s_add_u32 s70, s70, 1
  s_cmp_lt_u32 s70, 1048576
  s_cbranch_scc1 L_pl_79
L_pld_80:
  v_add_u32 v15, 327680, v15
  v_add_u32 v15, v11, v15
  v_add_u32 v35, 4096, v15
  v_add_u32 v32, 16384, v15
  v_add_u32 v36, 20480, v15
  v_add_u32 v33, 32768, v15
  v_add_u32 v37, 36864, v15
  v_add_u32 v34, 49152, v15
  v_add_u32 v39, 53248, v15
  s_lshl_b32 s49, s5, 14
  s_add_u32 s49, s49, 264192
  v_lshl_add_u32 v28, v14, 7, s49
  v_add_u32 v28, v11, v28
  v_lshl_add_u32 v28, v12, 5, v28
  v_and_b32 v3, 2, v1
  v_lshl_add_u32 v28, v3, 3, v28
  v_bfe_u32 v3, v1, 2, 2
  v_lshl_add_u32 v28, v3, 9, v28
  v_lshl_add_u32 v12, v14, 1, v12
  v_lshlrev_b32 v12, 4, v12
  v_add_u32 v12, 11008, v12
  s_lshl_b32 s49, s5, 7
  v_add_u32 v30, s49, v12
  v_lshrrev_b32 v2, 1, v1
  v_lshlrev_b32 v2, 10, v2
  v_and_b32 v3, 1, v1
  v_lshl_add_u32 v2, v3, 4, v2
  v_mov_b32 v29, v2
  v_lshlrev_b32 v6, 8, v14
  v_bfe_u32 v3, v1, 2, 2
  v_lshl_add_u32 v6, v3, 5, v6
  v_and_b32 v3, 3, v1
  v_lshl_add_u32 v6, v3, 3, v6
  s_mul_i32 s49, s5, 11264
  s_add_u32 s49, s49, 20480
  v_add_u32 v6, s49, v6
  s_mov_b32 s70, 0
L_pl_81:
  ds_read_b32 v8, v38 offset:6676
  s_waitcnt lgkmcnt(0)
  v_cmp_eq_u32 vcc, -1, v8
  s_cmp_eq_u64 vcc, 0
  s_cbranch_scc1 L_pld_82
  s_sleep 16
  s_add_u32 s70, s70, 1
  s_cmp_lt_u32 s70, 1048576
  s_cbranch_scc1 L_pl_81
L_pld_82:
  global_load_dwordx2 v[8:9], v31, s[16:17]
  s_mov_b32 s70, 0
L_polt_83:
  global_load_dwordx4 v[136:139], v24, s[42:43] sc1
  global_load_dwordx4 v[140:143], v25, s[42:43] sc1
  s_waitcnt vmcnt(0)
  v_cmp_ne_u32 vcc, s74, v137
  v_cmp_ne_u32 s[68:69], s74, v139
  s_or_b64 vcc, vcc, s[68:69]
  v_cmp_ne_u32 s[68:69], s74, v141
  s_or_b64 vcc, vcc, s[68:69]
  v_cmp_ne_u32 s[68:69], s74, v143
  s_or_b64 vcc, vcc, s[68:69]
  s_cmp_eq_u64 vcc, 0
  s_cbranch_scc1 L_poltd_84
  s_sleep 8
  s_add_u32 s70, s70, 1
  s_cmp_lt_u32 s70, 262144
  s_cbranch_scc1 L_polt_83
L_poltd_84:
  s_cmp_lg_u32 s5, 2
  s_cbranch_scc1 L_apw_85
  s_and_b32 s49, s61, 3
  s_lshl_b32 s49, s49, 14
  s_add_u32 s49, s49, 327680
  v_lshl_add_u32 v3, v1, 7, s49
  v_add_u32 v3, v11, v3
  global_load_dword v167, v3, s[42:43] sc1
L_apw_85:
  v_lshlrev_b32 v16, 16, v8
  v_and_b32 v17, s73, v8
  v_lshlrev_b32 v18, 16, v9
  v_and_b32 v19, s73, v9
  v_lshlrev_b32 v20, 16, v136
  v_and_b32 v21, s73, v136
  v_lshlrev_b32 v22, 16, v138
  v_and_b32 v23, s73, v138
  v_lshlrev_b32 v24, 16, v140
  v_and_b32 v25, s73, v140
  v_lshlrev_b32 v26, 16, v142
  v_and_b32 v27, s73, v142
L_join:
  s_waitcnt vmcnt(0) lgkmcnt(0)
  s_barrier
  s_cmp_eq_u32 s60, 1
  s_cbranch_scc1 L_t_wo
  s_cmp_eq_u32 s60, 2
  s_cbranch_scc1 L_t_f1
  s_cmp_eq_u32 s60, 3
  s_cbranch_scc1 L_t_f2
  global_load_dword v16, v12, s[28:29]
  global_load_dword v17, v12, s[30:31]
  global_load_dword v18, v13, s[32:33]
  s_branch L_fin
L_t_wo:
  s_mov_b32 s70, 0
L_wo_p:
  global_load_dwordx4 v[104:107], v15, s[42:43] offset:0 sc1
  global_load_dwordx4 v[108:111], v15, s[42:43] offset:512 sc1
  global_load_dwordx4 v[112:115], v15, s[42:43] offset:1024 sc1
  global_load_dwordx4 v[116:119], v15, s[42:43] offset:1536 sc1
  s_waitcnt vmcnt(3)
  v_xor_b32 v104, s62, v104
  v_xor_b32 v105, s63, v105
  v_xor_b32 v106, s64, v106
  v_xor_b32 v107, s65, v107
  s_waitcnt vmcnt(2)
  v_xor_b32 v108, s62, v108
  v_xor_b32 v109, s63, v109
  v_xor_b32 v110, s64, v110
  v_xor_b32 v111, s65, v111
  s_waitcnt vmcnt(1)
  v_xor_b32 v112, s62, v112
  v_xor_b32 v113, s63, v113
  v_xor_b32 v114, s64, v114
  v_xor_b32 v115, s65, v115
  s_waitcnt vmcnt(0)
  v_xor_b32 v116, s62, v116
  v_xor_b32 v117, s63, v117
  v_xor_b32 v118, s64, v118
  v_xor_b32 v119, s65, v119
  v_or3_b32 v28, v104, v105, v106
  v_or3_b32 v29, v107, v108, v109
  v_or3_b32 v30, v110, v111, v112
  v_or3_b32 v31, v113, v114, v115
  v_or3_b32 v28, v28, v29, v30
  v_or3_b32 v31, v31, v116, v117
  v_or3_b32 v28, v28, v118, v119
  v_or_b32 v28, v28, v31
  v_lshlrev_b32 v28, 24, v28
  v_cmp_ne_u32 vcc, 0, v28
  v_pk_mul_f32 v[16:17], v[104:105], v[20:21] op_sel:[0,0] op_sel_hi:[1,0]
  v_pk_mul_f32 v[18:19], v[106:107], v[20:21] op_sel:[0,0] op_sel_hi:[1,0]
  v_pk_fma_f32 v[16:17], v[108:109], v[20:21], v[16:17] op_sel:[0,1,0] op_sel_hi:[1,1,1]
  v_pk_fma_f32 v[18:19], v[110:111], v[20:21], v[18:19] op_sel:[0,1,0] op_sel_hi:[1,1,1]
  v_pk_fma_f32 v[16:17], v[112:113], v[22:23], v[16:17] op_sel:[0,0,0] op_sel_hi:[1,0,1]
  v_pk_fma_f32 v[18:19], v[114:115], v[22:23], v[18:19] op_sel:[0,0,0] op_sel_hi:[1,0,1]
  v_pk_fma_f32 v[16:17], v[116:117], v[22:23], v[16:17] op_sel:[0,1,0] op_sel_hi:[1,1,1]
  v_pk_fma_f32 v[18:19], v[118:119], v[22:23], v[18:19] op_sel:[0,1,0] op_sel_hi:[1,1,1]
  s_cmp_eq_u64 vcc, 0
  s_cbranch_scc1 L_wo_ok
  s_add_u32 s70, s70, 1
  s_cmp_lt_u32 s70, 262144
  s_cbranch_scc1 L_wo_p
L_wo_ok:
  v_cvt_pk_bf16_f32 v16, v16, v17
  v_cvt_pk_bf16_f32 v17, v18, v19
  ds_write_b64 v12, v[16:17] offset:0
  ds_read_b128 v[104:107], v14 offset:0
  ds_read_b128 v[108:111], v14 offset:64
  ds_read_b128 v[112:115], v14 offset:128
  ds_read_b128 v[116:119], v14 offset:192
  s_waitcnt lgkmcnt(4)
  s_barrier
  ds_read_b128 v[120:123], v0 offset:0
  ds_read_b128 v[124:127], v0 offset:64
  ds_read_b128 v[128:131], v0 offset:128
  ds_read_b128 v[132:135], v0 offset:192
  s_waitcnt lgkmcnt(4)
  v_mfma_f32_16x16x32_bf16 v[8:11], v[40:43], v[104:107], 0
  ds_read_b128 v[136:139], v2 offset:0
  ds_read_b128 v[140:143], v2 offset:64
  v_mfma_f32_16x16x32_bf16 v[8:11], v[44:47], v[108:111], v[8:11]
  ds_read_b128 v[144:147], v2 offset:128
  ds_read_b128 v[148:151], v2 offset:192
  v_mfma_f32_16x16x32_bf16 v[8:11], v[48:51], v[112:115], v[8:11]
  ds_read_b128 v[152:155], v3 offset:0
  ds_read_b128 v[156:159], v3 offset:64
  v_mfma_f32_16x16x32_bf16 v[8:11], v[52:55], v[116:119], v[8:11]
  ds_read_b128 v[160:163], v3 offset:128
  ds_read_b128 v[164:167], v3 offset:192
  s_waitcnt lgkmcnt(11)
  v_mfma_f32_16x16x32_bf16 v[8:11], v[56:59], v[120:123], v[8:11]
  s_waitcnt lgkmcnt(10)
  v_mfma_f32_16x16x32_bf16 v[8:11], v[60:63], v[124:127], v[8:11]
  s_waitcnt lgkmcnt(9)
  v_mfma_f32_16x16x32_bf16 v[8:11], v[64:67], v[128:131], v[8:11]
  s_waitcnt lgkmcnt(8)
  v_mfma_f32_16x16x32_bf16 v[8:11], v[68:71], v[132:135], v[8:11]
  s_waitcnt lgkmcnt(7)
  v_mfma_f32_16x16x32_bf16 v[8:11], v[72:75], v[136:139], v[8:11]
  s_waitcnt lgkmcnt(6)
  v_mfma_f32_16x16x32_bf16 v[8:11], v[76:79], v[140:143], v[8:11]
  s_waitcnt lgkmcnt(5)
  v_mfma_f32_16x16x32_bf16 v[8:11], v[80:83], v[144:147], v[8:11]
  s_waitcnt lgkmcnt(4)
  v_mfma_f32_16x16x32_bf16 v[8:11], v[84:87], v[148:151], v[8:11]
  s_waitcnt lgkmcnt(3)
  v_mfma_f32_16x16x32_bf16 v[8:11], v[88:91], v[152:155], v[8:11]
  s_waitcnt lgkmcnt(2)
  v_mfma_f32_16x16x32_bf16 v[8:11], v[92:95], v[156:159], v[8:11]
  s_waitcnt lgkmcnt(1)
  v_mfma_f32_16x16x32_bf16 v[8:11], v[96:99], v[160:163], v[8:11]
  s_waitcnt lgkmcnt(0)
  v_mfma_f32_16x16x32_bf16 v[8:11], v[100:103], v[164:167], v[8:11]
  s_nop 5
  s_mov_b32 exec_lo, 0x00030003
  s_mov_b32 exec_hi, 0x00030003
  v_bfi_b32 v8, v36, s62, v8
  v_bfi_b32 v9, v36, s63, v9
  v_bfi_b32 v10, v36, s64, v10
  v_bfi_b32 v11, v36, s65, v11
  global_store_dwordx4 v13, v[8:11], s[42:43] sc1
  global_store_dwordx4 v37, v[8:11], s[42:43] sc1
  s_branch L_fin
L_t_f1:
  v_mov_b32 v2, v0
  s_add_u32 s51, s50, 8192
L_dma_86:
  s_mov_b32 m0, s50
  s_add_u32 s50, s50, 1024
  buffer_load_dwordx4 v2, s[44:47], s49 offen  lds
  s_add_u32 s49, s49, 88064
  s_cmp_lt_u32 s50, s51
  s_cbranch_scc1 L_dma_86
L_dmae_87:
  v_xor_b32 v2, 16, v2
  s_add_u32 s49, s49, s52
  s_add_u32 s50, s50, s53
  s_add_u32 s51, s50, 8192
L_dma_88:
  s_mov_b32 m0, s50
  s_add_u32 s50, s50, 1024
  buffer_load_dwordx4 v2, s[44:47], s49 offen  lds
  s_add_u32 s49, s49, 88064
  s_cmp_lt_u32 s50, s51
  s_cbranch_scc1 L_dma_88
L_dmae_89:
  v_mov_b32 v2, v6
  s_waitcnt vmcnt(0)
  s_barrier
  global_load_dwordx4 v[104:107], v15, s[42:43] sc1
  global_load_dwordx4 v[108:111], v35, s[42:43] sc1
  global_load_dwordx4 v[112:115], v32, s[42:43] sc1
  global_load_dwordx4 v[116:119], v36, s[42:43] sc1
  global_load_dwordx4 v[120:123], v33, s[42:43] sc1
  global_load_dwordx4 v[124:127], v37, s[42:43] sc1
  global_load_dwordx4 v[128:131], v34, s[42:43] sc1
  global_load_dwordx4 v[132:135], v39, s[42:43] sc1
  s_add_u32 s49, s5, 0
  s_and_b32 s49, s49, 3
  s_mul_i32 s49, s49, 4096
  v_add_u32 v3, s49, v2
  ds_read_b64_tr_b16 v[40:41], v3 offset:0
  ds_read_b64_tr_b16 v[42:43], v3 offset:512
  ds_read_b64_tr_b16 v[44:45], v3 offset:1024
  ds_read_b64_tr_b16 v[46:47], v3 offset:1536
  ds_read_b64_tr_b16 v[48:49], v3 offset:2048
  ds_read_b64_tr_b16 v[50:51], v3 offset:2560
  ds_read_b64_tr_b16 v[52:53], v3 offset:3072
  ds_read_b64_tr_b16 v[54:55], v3 offset:3584
  s_add_u32 s49, s5, 1
  s_and_b32 s49, s49, 3
  s_mul_i32 s49, s49, 4096
  v_add_u32 v3, s49, v2
  ds_read_b64_tr_b16 v[56:57], v3 offset:0
  ds_read_b64_tr_b16 v[58:59], v3 offset:512
  ds_read_b64_tr_b16 v[60:61], v3 offset:1024
  ds_read_b64_tr_b16 v[62:63], v3 offset:1536
  s_waitcnt lgkmcnt(10)
  ds_read_b64_tr_b16 v[64:65], v3 offset:2048
  ds_read_b64_tr_b16 v[66:67], v3 offset:2560
  s_waitcnt lgkmcnt(10)
  ds_read_b64_tr_b16 v[68:69], v3 offset:3072
  ds_read_b64_tr_b16 v[70:71], v3 offset:3584
  s_waitcnt lgkmcnt(10)
  s_add_u32 s49, s5, 2
  s_and_b32 s49, s49, 3
  s_mul_i32 s49, s49, 4096
  v_add_u32 v3, s49, v2
  ds_read_b64_tr_b16 v[72:73], v3 offset:0
  ds_read_b64_tr_b16 v[74:75], v3 offset:512
  s_waitcnt lgkmcnt(10)
  ds_read_b64_tr_b16 v[76:77], v3 offset:1024
  ds_read_b64_tr_b16 v[78:79], v3 offset:1536
  s_waitcnt lgkmcnt(10)
  ds_read_b64_tr_b16 v[80:81], v3 offset:2048
  ds_read_b64_tr_b16 v[82:83], v3 offset:2560
  s_waitcnt lgkmcnt(10)
  ds_read_b64_tr_b16 v[84:85], v3 offset:3072
  ds_read_b64_tr_b16 v[86:87], v3 offset:3584
  s_waitcnt lgkmcnt(10)
  s_add_u32 s49, s5, 3
  s_and_b32 s49, s49, 3
  s_mul_i32 s49, s49, 4096
  v_add_u32 v3, s49, v2
  ds_read_b64_tr_b16 v[88:89], v3 offset:0
  ds_read_b64_tr_b16 v[90:91], v3 offset:512
  s_waitcnt lgkmcnt(10)
  ds_read_b64_tr_b16 v[92:93], v3 offset:1024
  ds_read_b64_tr_b16 v[94:95], v3 offset:1536
  s_waitcnt lgkmcnt(10)
  ds_read_b64_tr_b16 v[96:97], v3 offset:2048
  ds_read_b64_tr_b16 v[98:99], v3 offset:2560
  s_waitcnt lgkmcnt(10)
  ds_read_b64_tr_b16 v[100:101], v3 offset:3072
  ds_read_b64_tr_b16 v[102:103], v3 offset:3584
  s_waitcnt lgkmcnt(10)
  s_waitcnt lgkmcnt(0)
  s_add_u32 s49, s5, 1
  s_and_b32 s49, s49, 3
  s_lshl_b32 s49, s49, 8
  v_add_u32 v0, s49, v14
  s_add_u32 s49, s5, 2
  s_and_b32 s49, s49, 3
  s_lshl_b32 s49, s49, 8
  v_add_u32 v2, s49, v14
  s_add_u32 s49, s5, 3
  s_and_b32 s49, s49, 3
  s_lshl_b32 s49, s49, 8
  v_add_u32 v3, s49, v14
  s_add_u32 s49, s5, 0
  s_and_b32 s49, s49, 3
  s_lshl_b32 s49, s49, 8
  v_add_u32 v14, s49, v14
  s_mov_b32 s70, 0
  s_mov_b32 s71, 15
  s_branch L_f1_c
L_f1_p:
  s_add_u32 s70, s70, 1
  s_cmp_ge_u32 s70, 262144
  s_cbranch_scc1 L_f1_ok
  s_bitcmp1_b32 s71, 0
  s_cbranch_scc0 L_fl_90
  global_load_dwordx4 v[104:107], v15, s[42:43] sc1
  global_load_dwordx4 v[108:111], v35, s[42:43] sc1
L_fl_90:
  s_bitcmp1_b32 s71, 1
  s_cbranch_scc0 L_fl_91
  global_load_dwordx4 v[112:115], v32, s[42:43] sc1
  global_load_dwordx4 v[116:119], v36, s[42:43] sc1
L_fl_91:
  s_bitcmp1_b32 s71, 2
  s_cbranch_scc0 L_fl_92
  global_load_dwordx4 v[120:123], v33, s[42:43] sc1
  global_load_dwordx4 v[124:127], v37, s[42:43] sc1
L_fl_92:
  s_bitcmp1_b32 s71, 3
  s_cbranch_scc0 L_fl_93
  global_load_dwordx4 v[128:131], v34, s[42:43] sc1
  global_load_dwordx4 v[132:135], v39, s[42:43] sc1
L_fl_93:
L_f1_c:
  s_waitcnt vmcnt(0)
  s_bitcmp1_b32 s71, 0
  s_cbranch_scc0 L_fc_94
  v_xor_b32 v104, s62, v104
  v_xor_b32 v105, s63, v105
  v_xor_b32 v106, s64, v106
  v_xor_b32 v107, s65, v107
  v_xor_b32 v108, s62, v108
  v_xor_b32 v109, s63, v109
  v_xor_b32 v110, s64, v110
  v_xor_b32 v111, s65, v111
  v_or3_b32 v8, v104, v105, v106
  v_or3_b32 v9, v107, v108, v109
  v_or3_b32 v8, v8, v110, v111
  v_pk_add_f32 v[136:137], v[104:105], v[108:109]
  v_pk_add_f32 v[138:139], v[106:107], v[110:111]
  v_or_b32 v8, v8, v9
  v_lshlrev_b32 v8, 24, v8
  v_cmp_ne_u32 vcc, 0, v8
  s_cmp_lg_u64 vcc, 0
  s_cbranch_scc1 L_fc_94
  s_bitset0_b32 s71, 0
L_fc_94:
  s_bitcmp1_b32 s71, 1
  s_cbranch_scc0 L_fc_95
  v_xor_b32 v112, s62, v112
  v_xor_b32 v113, s63, v113
  v_xor_b32 v114, s64, v114
  v_xor_b32 v115, s65, v115
  v_xor_b32 v116, s62, v116
  v_xor_b32 v117, s63, v117
  v_xor_b32 v118, s64, v118
  v_xor_b32 v119, s65, v119
  v_or3_b32 v8, v112, v113, v114
  v_or3_b32 v9, v115, v116, v117
  v_or3_b32 v8, v8, v118, v119
  v_pk_add_f32 v[144:145], v[112:113], v[116:117]
  v_pk_add_f32 v[146:147], v[114:115], v[118:119]
  v_or_b32 v8, v8, v9
  v_lshlrev_b32 v8, 24, v8
  v_cmp_ne_u32 vcc, 0, v8
  s_cmp_lg_u64 vcc, 0
  s_cbranch_scc1 L_fc_95
  s_bitset0_b32 s71, 1
L_fc_95:
  s_bitcmp1_b32 s71, 2
  s_cbranch_scc0 L_fc_96
  v_xor_b32 v120, s62, v120
  v_xor_b32 v121, s63, v121
  v_xor_b32 v122, s64, v122
  v_xor_b32 v123, s65, v123
  v_xor_b32 v124, s62, v124
  v_xor_b32 v125, s63, v125
  v_xor_b32 v126, s64, v126
  v_xor_b32 v127, s65, v127
  v_or3_b32 v8, v120, v121, v122
  v_or3_b32 v9, v123, v124, v125
  v_or3_b32 v8, v8, v126, v127
  v_pk_add_f32 v[152:153], v[120:121], v[124:125]
  v_pk_add_f32 v[154:155], v[122:123], v[126:127]
  v_or_b32 v8, v8, v9
  v_lshlrev_b32 v8, 24, v8
  v_cmp_ne_u32 vcc, 0, v8
  s_cmp_lg_u64 vcc, 0
  s_cbranch_scc1 L_fc_96
  s_bitset0_b32 s71, 2
L_fc_96:
  s_bitcmp1_b32 s71, 3
  s_cbranch_scc0 L_fc_97
  v_xor_b32 v128, s62, v128
  v_xor_b32 v129, s63, v129
  v_xor_b32 v130, s64, v130
  v_xor_b32 v131, s65, v131
  v_xor_b32 v132, s62, v132
  v_xor_b32 v133, s63, v133
  v_xor_b32 v134, s64, v134
  v_xor_b32 v135, s65, v135
  v_or3_b32 v8, v128, v129, v130
  v_or3_b32 v9, v131, v132, v133
  v_or3_b32 v8, v8, v134, v135
  v_pk_add_f32 v[160:161], v[128:129], v[132:133]
  v_pk_add_f32 v[162:163], v[130:131], v[134:135]
  v_or_b32 v8, v8, v9
  v_lshlrev_b32 v8, 24, v8
  v_cmp_ne_u32 vcc, 0, v8
  s_cmp_lg_u64 vcc, 0
  s_cbranch_scc1 L_fc_97
  s_bitset0_b32 s71, 3
L_fc_97:
  s_cmp_lg_u32 s71, 0
  s_cbranch_scc1 L_f1_p
L_f1_ok:
  v_pk_add_f32 v[136:137], v[136:137], v[144:145]
  v_pk_add_f32 v[138:139], v[138:139], v[146:147]
  v_pk_add_f32 v[152:153], v[152:153], v[160:161]
  v_pk_add_f32 v[154:155], v[154:155], v[162:163]
  v_pk_add_f32 v[136:137], v[136:137], v[152:153]
  v_pk_add_f32 v[138:139], v[138:139], v[154:155]
  v_pk_fma_f32 v[8:9], v[136:137], v[24:25], v[28:29]
  v_pk_fma_f32 v[10:11], v[138:139], v[26:27], v[30:31]
  v_cvt_pk_bf16_f32 v8, v8, v9
  v_cvt_pk_bf16_f32 v9, v10, v11
  ds_write_b64 v12, v[8:9] offset:0
  ds_read_b128 v[104:107], v14 offset:0
  ds_read_b128 v[108:111], v14 offset:64
  ds_read_b128 v[112:115], v14 offset:128
  ds_read_b128 v[116:119], v14 offset:192
  v_pk_fma_f32 v[16:17], v[136:137], v[20:21], v[16:17]
  v_pk_fma_f32 v[18:19], v[138:139], v[22:23], v[18:19]
  v_pk_mul_f32 v[10:11], v[16:17], v[16:17]
  v_pk_add_f32 v[20:21], v[16:17], v[18:19]
  v_pk_fma_f32 v[10:11], v[18:19], v[18:19], v[10:11]
  v_add_f32 v20, v20, v21
  v_add_f32 v21, v10, v11
  ds_write_b64 v5, v[20:21] offset:12032
  s_waitcnt lgkmcnt(0)
  s_barrier
  ds_read_b128 v[120:123], v0 offset:0
  ds_read_b128 v[124:127], v0 offset:64
  ds_read_b128 v[128:131], v0 offset:128
  ds_read_b128 v[132:135], v0 offset:192
  ds_read_b128 v[20:23], v7 offset:12032
  ds_read_b128 v[24:27], v7 offset:12048
  v_mfma_f32_16x16x32_bf16 v[32:35], v[40:43], v[104:107], 0
  ds_read_b128 v[136:139], v2 offset:0
  ds_read_b128 v[140:143], v2 offset:64
  v_mfma_f32_16x16x32_bf16 v[32:35], v[44:47], v[108:111], v[32:35]
  ds_read_b128 v[144:147], v2 offset:128
  ds_read_b128 v[148:151], v2 offset:192
  v_mfma_f32_16x16x32_bf16 v[32:35], v[48:51], v[112:115], v[32:35]
  ds_read_b128 v[152:155], v3 offset:0
  ds_read_b128 v[156:159], v3 offset:64
  v_mfma_f32_16x16x32_bf16 v[32:35], v[52:55], v[116:119], v[32:35]
  ds_read_b128 v[160:163], v3 offset:128
  ds_read_b128 v[164:167], v3 offset:192
  s_waitcnt lgkmcnt(13)
  v_mfma_f32_16x16x32_bf16 v[32:35], v[56:59], v[120:123], v[32:35]
  s_waitcnt lgkmcnt(12)
  v_mfma_f32_16x16x32_bf16 v[32:35], v[60:63], v[124:127], v[32:35]
  s_waitcnt lgkmcnt(8)
  v_pk_add_f32 v[20:21], v[20:21], v[22:23]
  v_pk_add_f32 v[24:25], v[24:25], v[26:27]
  v_mfma_f32_16x16x32_bf16 v[32:35], v[64:67], v[128:131], v[32:35]
  v_pk_add_f32 v[20:21], v[20:21], v[24:25]
  s_nop 0
  v_mfma_f32_16x16x32_bf16 v[32:35], v[68:71], v[132:135], v[32:35]
  v_add_f32_dpp v20, v20, v20 quad_perm:[2,3,0,1] row_mask:0xf bank_mask:0xf
  v_add_f32_dpp v21, v21, v21 quad_perm:[2,3,0,1] row_mask:0xf bank_mask:0xf
  s_waitcnt lgkmcnt(7)
  v_mfma_f32_16x16x32_bf16 v[32:35], v[72:75], v[136:139], v[32:35]
  v_add_f32_dpp v20, v20, v20 row_ror:4 row_mask:0xf bank_mask:0xf
  v_add_f32_dpp v21, v21, v21 row_ror:4 row_mask:0xf bank_mask:0xf
  s_waitcnt lgkmcnt(6)
  v_mfma_f32_16x16x32_bf16 v[32:35], v[76:79], v[140:143], v[32:35]
  v_add_f32_dpp v20, v20, v20 row_ror:8 row_mask:0xf bank_mask:0xf
  v_add_f32_dpp v21, v21, v21 row_ror:8 row_mask:0xf bank_mask:0xf
  s_waitcnt lgkmcnt(5)
  v_mfma_f32_16x16x32_bf16 v[32:35], v[80:83], v[144:147], v[32:35]
  v_mov_b32 v22, v20
  v_mov_b32 v23, v21
  s_waitcnt lgkmcnt(4)
  v_mfma_f32_16x16x32_bf16 v[32:35], v[84:87], v[148:151], v[32:35]
  v_permlane16_swap_b32 v22, v20
  v_permlane16_swap_b32 v23, v21
  s_waitcnt lgkmcnt(3)
  v_mfma_f32_16x16x32_bf16 v[32:35], v[88:91], v[152:155], v[32:35]
  v_add_f32 v20, v20, v22
  v_add_f32 v21, v21, v23
  v_mov_b32 v22, v20
  v_mov_b32 v23, v21
  s_waitcnt lgkmcnt(2)
  v_mfma_f32_16x16x32_bf16 v[32:35], v[92:95], v[156:159], v[32:35]
  v_permlane32_swap_b32 v22, v20
  v_permlane32_swap_b32 v23, v21
  s_waitcnt lgkmcnt(1)
  v_mfma_f32_16x16x32_bf16 v[32:35], v[96:99], v[160:163], v[32:35]
  v_add_f32 v20, v20, v22
  v_add_f32 v21, v21, v23
  s_waitcnt lgkmcnt(0)
  v_mfma_f32_16x16x32_bf16 v[32:35], v[100:103], v[164:167], v[32:35]
  v_mul_f32 v20, 0xbb000000, v20
  v_mul_f32 v21, 0x3b000000, v21
  v_fma_f32 v21, -v20, v20, v21
  v_max_f32 v21, 0, v21
  v_add_f32 v21, 0x3727c5ac, v21
  v_rsq_f32 v21, v21
  s_nop 1
  v_fmac_f32_dpp v32, v32, v20 row_shl:2 row_mask:0xf bank_mask:0x1
  v_fmac_f32_dpp v33, v33, v20 row_shl:2 row_mask:0xf bank_mask:0x1
  v_fmac_f32_dpp v34, v34, v20 row_shl:2 row_mask:0xf bank_mask:0x1
  v_fmac_f32_dpp v35, v35, v20 row_shl:2 row_mask:0xf bank_mask:0x1
  v_mul_f32 v8, v32, v21
  v_mul_f32 v9, v33, v21
  v_mul_f32 v10, v34, v21
  v_mul_f32 v11, v35, v21
  v_add_f32_dpp v8, v32, v8 row_shl:4 row_mask:0xf bank_mask:0xf
  v_add_f32_dpp v9, v33, v9 row_shl:4 row_mask:0xf bank_mask:0xf
  v_add_f32_dpp v10, v34, v10 row_shl:4 row_mask:0xf bank_mask:0xf
  v_add_f32_dpp v11, v35, v11 row_shl:4 row_mask:0xf bank_mask:0xf
  s_mov_b32 s50, 0x000f000f
  s_mov_b32 s51, 0x000f000f
  v_permlane32_swap_b32 v8, v10
  v_permlane32_swap_b32 v9, v11
  v_mul_f32 v20, 0xbfb8aa3b, v8
  v_mul_f32 v21, 0xbfb8aa3b, v9
  v_exp_f32 v20, v20
  v_exp_f32 v21, v21
  v_mul_f32 v8, v8, v10
  v_mul_f32 v9, v9, v11
  v_add_f32 v20, 1.0, v20
  v_add_f32 v21, 1.0, v21
  v_rcp_f32 v20, v20
  v_rcp_f32 v21, v21
  s_mov_b64 exec, s[50:51]
  v_mul_f32 v8, v8, v20
  v_mul_f32 v9, v9, v21
  v_cvt_pk_bf16_f32 v8, v8, v9
  v_mov_b32 v9, s74
  global_store_dwordx2 v13, v[8:9], s[42:43] sc1
  global_store_dwordx2 v4, v[8:9], s[42:43] sc1
  s_branch L_fin
L_t_f2:
  v_mov_b32 v2, v29
  s_and_b32 s59, s61, 3
  s_mul_i32 s59, s59, 3072
  s_mul_i32 s49, s5, 360448
  s_add_u32 s49, s49, s48
  s_mul_i32 s50, s5, 11264
  s_add_u32 s50, s50, 20480
  s_lshl_b32 s52, s59, 5
  s_add_u32 s49, s49, s52
  s_add_u32 s50, s50, s59
  s_sub_u32 s52, 11264, s59
  s_add_u32 s51, s50, s52
  s_cmp_lt_u32 s50, s51
  s_cbranch_scc0 L_dmae_99
L_dma_98:
  s_mov_b32 m0, s50
  s_add_u32 s50, s50, 1024
  buffer_load_dwordx4 v2, s[44:47], s49 offen  lds
  s_add_u32 s49, s49, 32768
  s_cmp_lt_u32 s50, s51
  s_cbranch_scc1 L_dma_98
L_dmae_99:
  s_mul_i32 s49, s5, 360448
  s_add_u32 s49, s49, s48
  s_mul_i32 s50, s5, 11264
  s_add_u32 s50, s50, 20480
  s_add_u32 s51, s50, s59
  s_cmp_lt_u32 s50, s51
  s_cbranch_scc0 L_dmae_101
L_dma_100:
  s_mov_b32 m0, s50
  s_add_u32 s50, s50, 1024
  buffer_load_dwordx4 v2, s[44:47], s49 offen  lds
  s_add_u32 s49, s49, 32768
  s_cmp_lt_u32 s50, s51
  s_cbranch_scc1 L_dma_100
L_dmae_101:
  v_mov_b32 v2, v6
  s_mov_b32 s50, 0x00030003
  s_mov_b32 s51, 0x00030003
  s_mov_b32 s53, 0x0fff0fff
  s_cmp_eq_u32 s5, 3
  s_cselect_b32 s52, 0x00ff00ff, s53
  s_mov_b32 s53, s52
  s_cmp_lg_u32 s5, 0
  s_cbranch_scc1 L_f2_w
  s_mov_b64 exec, s[50:51]
  global_load_dwordx4 v[104:107], v15, s[42:43] sc1
  global_load_dwordx4 v[108:111], v35, s[42:43] sc1
  global_load_dwordx4 v[112:115], v32, s[42:43] sc1
  global_load_dwordx4 v[116:119], v36, s[42:43] sc1
  global_load_dwordx4 v[120:123], v33, s[42:43] sc1
  global_load_dwordx4 v[124:127], v37, s[42:43] sc1
  global_load_dwordx4 v[128:131], v34, s[42:43] sc1
  global_load_dwordx4 v[132:135], v39, s[42:43] sc1
  s_mov_b64 exec, -1
  s_waitcnt vmcnt(8)
  s_branch L_f2_w2
L_f2_w:
  s_waitcnt vmcnt(0)
L_f2_w2:
  ds_read_b64_tr_b16 v[40:41], v2 offset:0
  ds_read_b64_tr_b16 v[42:43], v2 offset:128
  ds_read_b64_tr_b16 v[44:45], v2 offset:1024
  ds_read_b64_tr_b16 v[46:47], v2 offset:1152
  ds_read_b64_tr_b16 v[48:49], v2 offset:2048
  ds_read_b64_tr_b16 v[50:51], v2 offset:2176
  ds_read_b64_tr_b16 v[52:53], v2 offset:3072
  ds_read_b64_tr_b16 v[54:55], v2 offset:3200
  ds_read_b64_tr_b16 v[56:57], v2 offset:4096
  ds_read_b64_tr_b16 v[58:59], v2 offset:4224
  ds_read_b64_tr_b16 v[60:61], v2 offset:5120
  ds_read_b64_tr_b16 v[62:63], v2 offset:5248
  s_waitcnt lgkmcnt(10)
  ds_read_b64_tr_b16 v[64:65], v2 offset:6144
  ds_read_b64_tr_b16 v[66:67], v2 offset:6272
  s_waitcnt lgkmcnt(10)
  ds_read_b64_tr_b16 v[68:69], v2 offset:7168
  ds_read_b64_tr_b16 v[70:71], v2 offset:7296
  s_waitcnt lgkmcnt(10)
  ds_read_b64_tr_b16 v[72:73], v2 offset:8192
  ds_read_b64_tr_b16 v[74:75], v2 offset:8320
  s_waitcnt lgkmcnt(10)
  ds_read_b64_tr_b16 v[76:77], v2 offset:9216
  ds_read_b64_tr_b16 v[78:79], v2 offset:9344
  s_waitcnt lgkmcnt(10)
  ds_read_b64_tr_b16 v[80:81], v2 offset:10240
  ds_read_b64_tr_b16 v[82:83], v2 offset:10368
  s_waitcnt lgkmcnt(10)
  s_waitcnt lgkmcnt(0)
  s_cmp_lg_u32 s5, 0
  s_cbranch_scc1 L_f2x_102
  s_mov_b32 s70, 0
  s_mov_b64 exec, s[50:51]
  s_branch L_f2_ac
L_f2_a:
  s_mov_b64 exec, s[50:51]
  global_load_dwordx4 v[104:107], v15, s[42:43] sc1
  global_load_dwordx4 v[108:111], v35, s[42:43] sc1
  global_load_dwordx4 v[112:115], v32, s[42:43] sc1
  global_load_dwordx4 v[116:119], v36, s[42:43] sc1
  global_load_dwordx4 v[120:123], v33, s[42:43] sc1
  global_load_dwordx4 v[124:127], v37, s[42:43] sc1
  global_load_dwordx4 v[128:131], v34, s[42:43] sc1
  global_load_dwordx4 v[132:135], v39, s[42:43] sc1
L_f2_ac:
  s_waitcnt vmcnt(0)
  v_xor_b32 v136, s62, v104
  v_xor_b32 v137, s63, v105
  v_xor_b32 v138, s64, v106
  v_xor_b32 v139, s65, v107
  v_xor_b32 v140, s62, v108
  v_xor_b32 v141, s63, v109
  v_xor_b32 v142, s64, v110
  v_xor_b32 v143, s65, v111
  v_xor_b32 v144, s62, v112
  v_xor_b32 v145, s63, v113
  v_xor_b32 v146, s64, v114
  v_xor_b32 v147, s65, v115
  v_xor_b32 v148, s62, v116
  v_xor_b32 v149, s63, v117
  v_xor_b32 v150, s64, v118
  v_xor_b32 v151, s65, v119
  v_xor_b32 v152, s62, v120
  v_xor_b32 v153, s63, v121
  v_xor_b32 v154, s64, v122
  v_xor_b32 v155, s65, v123
  v_xor_b32 v156, s62, v124
  v_xor_b32 v157, s63, v125
  v_xor_b32 v158, s64, v126
  v_xor_b32 v159, s65, v127
  v_xor_b32 v160, s62, v128
  v_xor_b32 v161, s63, v129
  v_xor_b32 v162, s64, v130
  v_xor_b32 v163, s65, v131
  v_xor_b32 v164, s62, v132
  v_xor_b32 v165, s63, v133
  v_xor_b32 v166, s64, v134
  v_xor_b32 v167, s65, v135
  v_or3_b32 v8, v136, v137, v138
  v_or3_b32 v9, v144, v145, v146
  v_or3_b32 v10, v152, v153, v154
  v_or3_b32 v11, v160, v161, v162
  v_or3_b32 v8, v8, v139, v140
  v_or3_b32 v9, v9, v147, v148
  v_or3_b32 v10, v10, v155, v156
  v_or3_b32 v11, v11, v163, v164
  v_or3_b32 v8, v8, v141, v142
  v_or3_b32 v9, v9, v149, v150
  v_or3_b32 v10, v10, v157, v158
  v_or3_b32 v11, v11, v165, v166
  v_or_b32 v8, v8, v143
  v_or_b32 v9, v9, v151
  v_or_b32 v10, v10, v159
  v_or_b32 v11, v11, v167
  v_or3_b32 v3, v8, v9, v10
  v_or_b32 v3, v3, v11
  v_lshlrev_b32 v3, 24, v3
  v_cmp_ne_u32 vcc, 0, v3
  s_cmp_eq_u64 vcc, 0
  s_cbranch_scc1 L_f2_ad
  s_sleep 2
  s_add_u32 s70, s70, 1
  s_cmp_lt_u32 s70, 262144
  s_cbranch_scc1 L_f2_a
L_f2_ad:
  s_mov_b64 exec, -1
  v_pk_add_f32 v[136:137], v[136:137], v[140:141]
  v_pk_add_f32 v[138:139], v[138:139], v[142:143]
  v_pk_add_f32 v[144:145], v[144:145], v[148:149]
  v_pk_add_f32 v[146:147], v[146:147], v[150:151]
  v_pk_add_f32 v[152:153], v[152:153], v[156:157]
  v_pk_add_f32 v[154:155], v[154:155], v[158:159]
  v_pk_add_f32 v[160:161], v[160:161], v[164:165]
  v_pk_add_f32 v[162:163], v[162:163], v[166:167]
  v_pk_add_f32 v[136:137], v[136:137], v[144:145]
  v_pk_add_f32 v[138:139], v[138:139], v[146:147]
  v_pk_add_f32 v[152:153], v[152:153], v[160:161]
  v_pk_add_f32 v[154:155], v[154:155], v[162:163]
  v_pk_add_f32 v[136:137], v[136:137], v[152:153]
  v_pk_add_f32 v[138:139], v[138:139], v[154:155]
  v_cvt_pk_bf16_f32 v136, 0, v136
  v_cvt_pk_bf16_f32 v137, 0, v137
  v_cvt_pk_bf16_f32 v138, 0, v138
  v_cvt_pk_bf16_f32 v139, 0, v139
  v_mul_f32 v136, v136, v20
  v_mul_f32 v137, v137, v21
  v_mul_f32 v138, v138, v22
  v_mul_f32 v139, v139, v23
  v_cvt_pk_bf16_f32 v136, 0, v136
  v_cvt_pk_bf16_f32 v137, 0, v137
  v_cvt_pk_bf16_f32 v138, 0, v138
  v_cvt_pk_bf16_f32 v139, 0, v139
  v_add_f32 v16, v16, v136
  v_add_f32 v17, v17, v137
  v_add_f32 v18, v18, v138
  v_add_f32 v19, v19, v139
  v_cvt_pk_bf16_f32 v16, 0, v16
  v_cvt_pk_bf16_f32 v17, 0, v17
  v_cvt_pk_bf16_f32 v18, 0, v18
  v_cvt_pk_bf16_f32 v19, 0, v19
L_f2x_102:
  v_mov_b32 v112, 0
  v_mov_b32 v113, 0
  v_mov_b32 v114, 0
  v_mov_b32 v115, 0
  s_mov_b32 s70, 0
L_f2_p:
  global_load_dwordx4 v[104:107], v28, s[42:43] offset:-2048 sc1
  global_load_dwordx4 v[108:111], v28, s[42:43] sc1
  s_mov_b64 exec, s[52:53]
  global_load_dwordx4 v[112:115], v28, s[42:43] offset:2048 sc1
  s_mov_b64 exec, -1
  s_waitcnt vmcnt(2)
  v_xor_b32 v105, s74, v105
  v_xor_b32 v107, s74, v107
  s_waitcnt vmcnt(1)
  v_xor_b32 v109, s74, v109
  v_xor_b32 v111, s74, v111
  s_waitcnt vmcnt(0)
  v_xor_b32 v113, s74, v113
  v_xor_b32 v115, s74, v115
  v_or3_b32 v31, v105, v107, v109
  v_or_b32 v3, v113, v115
  v_or_b32 v31, v111, v31
  v_cmp_ne_u32 s[68:69], 0, v3
  v_cmp_ne_u32 vcc, 0, v31
  v_mov_b32_dpp v105, v104 quad_perm:[2,3,2,3] row_mask:0xf bank_mask:0xf
  v_mov_b32_dpp v107, v106 quad_perm:[2,3,2,3] row_mask:0xf bank_mask:0xf
  v_mov_b32_dpp v109, v108 quad_perm:[2,3,2,3] row_mask:0xf bank_mask:0xf
  v_mov_b32_dpp v111, v110 quad_perm:[2,3,2,3] row_mask:0xf bank_mask:0xf
  v_mov_b32_dpp v113, v112 quad_perm:[2,3,2,3] row_mask:0xf bank_mask:0xf
  v_mov_b32_dpp v115, v114 quad_perm:[2,3,2,3] row_mask:0xf bank_mask:0xf
  s_and_b64 s[68:69], s[68:69], s[52:53]
  s_or_b64 vcc, vcc, s[68:69]
  v_mfma_f32_16x16x32_bf16 v[120:123], v[40:43], v[104:107], 0
  v_mfma_f32_16x16x32_bf16 v[124:127], v[44:47], v[104:107], 0
  v_mfma_f32_16x16x32_bf16 v[128:131], v[48:51], v[104:107], 0
  v_mfma_f32_16x16x32_bf16 v[132:135], v[52:55], v[104:107], 0
  s_cmp_eq_u64 vcc, 0
  s_cbranch_scc1 L_f2_ok
  s_add_u32 s70, s70, 1
  s_cmp_lt_u32 s70, 262144
  s_cbranch_scc1 L_f2_p
L_f2_ok:
  v_mfma_f32_16x16x32_bf16 v[120:123], v[56:59], v[108:111], v[120:123]
  v_mfma_f32_16x16x32_bf16 v[124:127], v[60:63], v[108:111], v[124:127]
  v_mfma_f32_16x16x32_bf16 v[128:131], v[64:67], v[108:111], v[128:131]
  v_mfma_f32_16x16x32_bf16 v[132:135], v[68:71], v[108:111], v[132:135]
  v_mfma_f32_16x16x32_bf16 v[120:123], v[72:75], v[112:115], v[120:123]
  v_mfma_f32_16x16x32_bf16 v[124:127], v[76:79], v[112:115], v[124:127]
  v_mfma_f32_16x16x32_bf16 v[128:131], v[80:83], v[112:115], v[128:131]
  s_nop 6
  v_add_f32_dpp v8, v124, v120 row_shl:4 row_mask:0xf bank_mask:0xf
  v_add_f32_dpp v9, v125, v121 row_shl:4 row_mask:0xf bank_mask:0xf
  v_add_f32_dpp v10, v126, v122 row_shl:4 row_mask:0xf bank_mask:0xf
  v_add_f32_dpp v11, v127, v123 row_shl:4 row_mask:0xf bank_mask:0xf
  v_add_f32_dpp v128, v132, v128 row_shl:4 row_mask:0xf bank_mask:0xf
  v_add_f32_dpp v129, v133, v129 row_shl:4 row_mask:0xf bank_mask:0xf
  v_add_f32_dpp v130, v134, v130 row_shl:4 row_mask:0xf bank_mask:0xf
  v_add_f32_dpp v131, v135, v131 row_shl:4 row_mask:0xf bank_mask:0xf
  v_add_f32_dpp v8, v128, v8 row_shl:8 row_mask:0xf bank_mask:0xf
  v_add_f32_dpp v9, v129, v9 row_shl:8 row_mask:0xf bank_mask:0xf
  v_add_f32_dpp v10, v130, v10 row_shl:8 row_mask:0xf bank_mask:0xf
  v_add_f32_dpp v11, v131, v11 row_shl:8 row_mask:0xf bank_mask:0xf
  s_mov_b64 exec, s[50:51]
  ds_write_b128 v30, v[8:11]
  s_waitcnt lgkmcnt(0)
  s_barrier
  s_cmp_lg_u32 s5, s77
  s_cbranch_scc1 L_fin
  ds_read_b128 v[104:107], v12 offset:128
  ds_read_b128 v[108:111], v12 offset:256
  ds_read_b128 v[112:115], v12 offset:384
  s_waitcnt lgkmcnt(2)
  v_pk_add_f32 v[8:9], v[8:9], v[104:105]
  v_pk_add_f32 v[10:11], v[10:11], v[106:107]
  s_waitcnt lgkmcnt(0)
  v_pk_add_f32 v[108:109], v[108:109], v[112:113]
  v_pk_add_f32 v[110:111], v[110:111], v[114:115]
  v_pk_add_f32 v[8:9], v[8:9], v[108:109]
  v_pk_add_f32 v[10:11], v[10:11], v[110:111]
  v_pk_fma_f32 v[8:9], v[8:9], v[24:25], v[16:17]
  v_pk_fma_f32 v[10:11], v[10:11], v[26:27], v[18:19]
  v_cvt_pk_bf16_f32 v8, v8, v9
  v_cvt_pk_bf16_f32 v9, v10, v11
  global_store_dwordx2 v13, v[8:9], s[38:39]
  s_mov_b64 exec, 1
  s_cmp_lg_u32 s61, 0
  s_cbranch_scc1 L_noep
  v_mov_b32 v10, s74
  global_store_dword v38, v10, s[42:43] offset:0
L_noep:
L_fin:
L_end:
  s_endpgm
.p2align 7
L_table:
  .long 0x03803816, 0x0380300d, 0x03803065, 0x03802825, 0x03803075, 0x0380388e, 0x0380303d, 0x0380397e
  .long 0x07803866, 0x078038b6, 0x0780389e, 0x078038c6, 0x03803809, 0x078038d6, 0x0780392e, 0x07803856
  .long 0x0b803005, 0x0b80305d, 0x0b80382e, 0x0b803836, 0x07803916, 0x0b80395e, 0x0b803806, 0x03803811
  .long 0x0f80301d, 0x0f80386e, 0x0f804196, 0x0f8039ee, 0x0b80302d, 0x0f80396e, 0x0f803896, 0x0b8038ee
  .long 0x1380381e, 0x13802855, 0x138039e6, 0x138038de, 0x0f8038ce, 0x138039b6, 0x13803976, 0x0f803045
  .long 0x1780304d, 0x178039d6, 0x178038be, 0x178039a6, 0x13803886, 0x17802835, 0x178039be, 0x138038a6
  .long 0x1b8039ce, 0x1b80398e, 0x03803831, 0x1b80286d, 0x1780391e, 0x1b803846, 0x03803831, 0x17803936
  .long 0x1f803986, 0x1f80385e, 0x1b803015, 0x1f803956, 0x1b80383e, 0x1f80287d, 0x1b80384e, 0x1b8031c6
  .long 0x039c4001, 0x03983801, 0x1f983876, 0x03943801, 0x1f9839ae, 0x039c4001, 0x03983801, 0x1f9c380e
  .long 0x239c38f6, 0x039c4009, 0x039c4009, 0x039c4009, 0x239c28dc, 0x239c3926, 0x039c4009, 0x039c4009
  .long 0x03983811, 0x03983811, 0x239c3906, 0x239c387e, 0x039c4011, 0x279c39fe, 0x1f9c38e6, 0x239c295c
  .long 0x03983819, 0x239c38fe, 0x03a03819, 0x039c3019, 0x03983819, 0x039c3019, 0x039c3019, 0x279c39de
  .long 0x039c4021, 0x27943026, 0x279c394e, 0x279c390e, 0x039c4021, 0x039c4021, 0x039c4021, 0x03983821
  .long 0x279838ae, 0x039c4029, 0x039c4029, 0x039c4029, 0x279c3966, 0x03943829, 0x239c399e, 0x039c4029
  .long 0x2b9c393e, 0x039c4031, 0x2b9c289c, 0x03943831, 0x039c4031, 0x039c4031, 0x279c291c, 0x039c4031
  .long 0x039c4039, 0x2b9c3946, 0x03983839, 0x039c4039, 0x2b9c39f6, 0x03943839, 0x039c4039, 0x03983839
  .long 0x2fbc3094, 0x83b4404a, 0x03b44001, 0x03b050aa, 0x03b44001, 0x2bbc3154, 0x83b44122, 0x03b83801
  .long 0x03b83809, 0x2fbc30ec, 0x2fbc30f4, 0x2bbc30fc, 0x83b048ba, 0x03b83809, 0x2bbc3114, 0x2bbc316c
  .long 0x83b4400a, 0x87b4403a, 0x03b83811, 0x03b83811, 0x2fbc3104, 0x03b83811, 0x03b83811, 0x83b0493a
  .long 0x87b4402a, 0x03b83819, 0x33bc30ac, 0x2fb428b4, 0x87b440c2, 0x2fb4297c, 0x2fb428cc, 0x03b83819
  .long 0x33bc312c, 0x03ac3821, 0x03b83821, 0x03b83821, 0x33bc30bc, 0x33bc30c4, 0x33bc3084, 0x87b4414a
  .long 0x03b44029, 0x33bc3134, 0x37bc313c, 0x33bc3144, 0x03b83829, 0x03b050ea, 0x03b83829, 0x2fbc30d4
  .long 0x03b83831, 0x37bc30a4, 0x83b0487a, 0x03b0509a, 0x37bc314c, 0x37bc310c, 0x87b0491a, 0x33bc3124
  .long 0x37bc30e4, 0x03b83839, 0x87b4406a, 0x37bc3174, 0x03b83839, 0x03b050e2, 0x37bc3164, 0x37b4288c
  .long 0x43d4580b, 0x03d45842, 0x53d45843, 0x03d850a2, 0x63d4589b, 0x6bd458bb, 0x03d4590a, 0x03d45952
  .long 0x03d45812, 0x4bd45833, 0x57d45853, 0x5bd45873, 0x03d458d2, 0x03d458fa, 0x73d458cb, 0x7bd458e3
  .long 0x03d4581a, 0x03d45852, 0x03d45882, 0x03d45892, 0x67d45893, 0x6fd458ab, 0x03d45912, 0x03d45942
  .long 0x03d45802, 0x03d45832, 0xd3d4584b, 0x3bc87000, 0x03d458da, 0x3bc87000, 0x3bc87000, 0x7fd458eb
  .long 0x47d4581b, 0x3bc87000, 0x03d45862, 0x5fd4586b, 0xdbd45883, 0x83d458b3, 0x77d458d3, 0x03d45932
  .long 0xc3d45803, 0x4fd4582b, 0xd7d4585b, 0x83d4587b, 0x03d458b2, 0x03d85102, 0xe3d458c3, 0xebd458f3
  .long 0x03d45822, 0xcbd4583b, 0x03d4585a, 0x03d8508a, 0xdfd4588b, 0x87d458a3, 0x03d4592a, 0xefd458fb
  .long 0xc7d45813, 0xcfd45823, 0x03d45872, 0x87d45863, 0x03d458ca, 0x03d850f2, 0xe7d458db, 0x3bc87000
L_gtab:
  .long 0x017c0000, 0x00000000
  .long 0x02bc0180, 0x00000080
  .long 0x043c02c0, 0x00000100
  .long 0x057c0440, 0x00000180
  .long 0x06fc0580, 0x00000200
  .long 0x083c0700, 0x00000280
  .long 0x097c0840, 0x00000300
  .long 0x0abc0980, 0x00000380
.section .rodata,"a"
.p2align 6
.amdhsa_kernel adaLN_cond__sliding_block_cached__glu_gated_swiglu__decode_kernel
  .amdhsa_next_free_vgpr 168
  .amdhsa_next_free_sgpr 102
  .amdhsa_accum_offset 168
  .amdhsa_group_segment_fixed_size 0
  .amdhsa_kernarg_size 112
  .amdhsa_user_sgpr_count 2
  .amdhsa_user_sgpr_kernarg_segment_ptr 1
  .amdhsa_system_sgpr_workgroup_id_x 1
.end_amdhsa_kernel
```

```asm
; @launch grid=(256,1,1) block=(768,1,1) lds=151552
.amdgcn_target "amdgcn-amd-amdhsa--gfx950"
.text
.globl adaLN_cond__sliding_block_cached__glu_gated_swiglu__decode_kernel
.p2align 8
.type adaLN_cond__sliding_block_cached__glu_gated_swiglu__decode_kernel,@function
adaLN_cond__sliding_block_cached__glu_gated_swiglu__decode_kernel:
  s_cmpk_ge_u32 s2, 256
  s_cbranch_scc1 L_end
  s_load_dwordx2 s[44:45], s[0:1], 8
  v_readfirstlane_b32 s5, v0
  s_and_b32 s6, s2, 63
  s_lshr_b32 s7, s2, 6
  s_lshr_b32 s5, s5, 6
  v_and_b32 v1, 63, v0
  s_cmp_lt_u32 s5, 4
  s_cbranch_scc1 L_helper
  s_lshl_b32 s10, s6, 22
  s_lshl_b32 s11, s5, 9
  s_add_u32 s11, s11, s10
  s_add_u32 s11, s11, 3143680
  v_lshrrev_b32 v3, 5, v1
  v_lshl_add_u32 v2, v1, 4, s11
  v_mul_u32_u24 v3, 32256, v3
  s_mul_i32 s12, s2, 9
  s_lshr_b32 s12, s12, 3
  s_and_b32 s12, s12, 15
  s_mul_i32 s58, s7, 28
  v_add_u32 v2, v2, v3
  s_add_u32 s12, s12, s58
  s_and_b32 s13, s12, -8
  s_add_u32 s12, s12, s13
  s_lshl_b32 s12, s12, 12
  s_lshl_b32 s46, 1, 28
  s_lshl_b32 s47, 1, 17
  s_mov_b32 s19, 36864
  s_waitcnt lgkmcnt(0)
L_nb1:
  buffer_load_dwordx4 v[56:59], v2, s[44:47], s12 offen nt
  s_add_u32 s12, s12, s19
  s_bitset0_b32 s12, 15
  buffer_load_dwordx4 v[60:63], v2, s[44:47], s12 offen nt
  s_add_u32 s12, s12, s19
  s_bitset0_b32 s12, 15
  buffer_load_dwordx4 v[64:67], v2, s[44:47], s12 offen nt
  s_add_u32 s12, s12, s19
  s_bitset0_b32 s12, 15
  s_getpc_b64 s[56:57]
L_pc:
  s_lshl_b32 s3, s2, 2
  s_add_u32 s3, s3, L_table-L_pc
  s_load_dword s14, s[56:57], s3
  s_load_dwordx2 s[48:49], s[0:1], 16
  s_load_dwordx4 s[20:23], s[0:1], 24
  s_load_dwordx2 s[28:29], s[0:1], 80
  s_load_dwordx2 s[42:43], s[0:1], 104
  s_getreg_b32 s68, hwreg(HW_REG_XCC_ID, 0, 3)
  s_lshr_b32 s68, 85, s68
  s_barrier
  s_sub_u32 s9, s5, 4
  s_mov_b64 s[50:51], s[46:47]
  s_mov_b32 s52, 0xcccccccc
  s_mov_b32 s53, 0xcccccccc
  s_mov_b32 s54, 0xaaaaaaaa
  s_mov_b32 s55, 0xaaaaaaaa
  s_mul_i32 s15, s9, 8192
  s_add_u32 s15, s15, 86016
  s_add_u32 s59, s58, 28
  s_and_b32 s13, s58, -8
  s_add_u32 s58, s58, s13
  s_lshl_b32 s58, s58, 12
  s_and_b32 s13, s59, -8
  s_add_u32 s59, s59, s13
  s_lshl_b32 s59, s59, 12
  s_lshl_b32 s13, s9, 9
  v_subrev_u32 v0, s13, v2
  v_mov_b32 v4, 0
  v_lshrrev_b32 v5, 3, v1
  v_and_b32 v6, 6, v5
  v_xor_b32 v6, v6, v1
  v_and_b32 v6, 7, v6
  s_lshl_b32 s33, s9, 6
  s_movk_i32 s26, 6144
  s_mov_b32 s30, 3145728
  s_mov_b32 s31, s47
  s_lshl_b32 s34, s9, 13
  s_add_u32 s34, s34, 20480
  s_add_u32 s35, s34, 8192
  s_and_b32 s36, s2, 7
  s_lshl_b32 s36, s36, 1
  s_and_b32 s37, s9, 1
  s_add_u32 s36, s36, s37
  s_lshr_b32 s37, s9, 1
  s_lshl_b32 s37, s37, 4
  s_add_u32 s36, s36, s37
  s_lshl_b32 s36, s36, 6
  s_waitcnt lgkmcnt(0)
  s_and_b32 s27, s14, 7
  s_cmp_eq_u32 s27, 6
  s_cselect_b64 s[28:29], s[20:21], s[28:29]
  s_cselect_b32 s26, 0x2000, s26
  s_cselect_b32 s30, 0x400000, s30
  s_cmp_eq_u32 s27, 1
  s_cselect_b64 s[28:29], s[22:23], s[28:29]
  s_cselect_b32 s26, 0x400, s26
  s_cselect_b32 s30, 0x400000, s30
  s_cselect_b32 s33, s36, s33
  s_cselect_b32 s27, 4, s27
  v_mul_u32_u24 v5, s26, v5
  v_lshl_add_u32 v5, v6, 4, v5
  v_mov_b32 v6, 1
  s_mul_i32 s33, s33, s26
  s_bfe_u32 s32, s14, 0x60003
  s_lshl_b32 s32, s32, 7
  s_add_u32 s33, s33, s32
  s_lshl_b32 s26, s26, 3
  s_cmp_lt_u32 s27, 4
  s_cbranch_scc1 L_we_2
L_wl_1:
  s_mov_b32 m0, s34
  s_waitcnt vmcnt(4)
  buffer_load_dwordx4 v5, s[28:31], s33 offen nt lds
  s_add_u32 s33, s33, s26
  s_addk_i32 s34, 1024
  s_cmp_lt_u32 s34, s35
  s_cbranch_scc1 L_wl_1
L_we_2:
  s_waitcnt vmcnt(2)
  buffer_load_dwordx4 v[68:71], v2, s[44:47], s12 offen nt
  s_add_u32 s12, s12, s19
  s_bitset0_b32 s12, 15
  s_waitcnt vmcnt(2)
  buffer_load_dwordx4 v[72:75], v2, s[44:47], s12 offen nt
  s_add_u32 s12, s12, s19
  s_bitset0_b32 s12, 15
  s_waitcnt vmcnt(2)
  s_bitcmp0_b32 s68, 0
  s_cbranch_scc1 L_th_3
  s_waitcnt vmcnt(1)
L_th_3:
  buffer_load_dwordx4 v[76:79], v2, s[44:47], s12 offen nt
  s_add_u32 s12, s12, s19
  s_bitset0_b32 s12, 15
  s_cmp_lt_u32 s27, 4
  s_cbranch_scc1 L_ws_4
  s_mov_b64 exec, 1
  ds_add_u32 v4, v6 offset:6720
  s_mov_b64 exec, -1
L_ws_4:
  s_waitcnt vmcnt(2)
  buffer_load_dwordx4 v[80:83], v2, s[44:47], s12 offen nt
  s_add_u32 s12, s12, s19
  s_bitset0_b32 s12, 15
  s_waitcnt vmcnt(2)
  buffer_load_dwordx4 v[84:87], v2, s[44:47], s12 offen nt
  s_add_u32 s12, s12, s19
  s_bitset0_b32 s12, 15
  s_waitcnt vmcnt(2)
  s_bitcmp0_b32 s68, 0
  s_cbranch_scc1 L_th_5
  s_waitcnt vmcnt(1)
L_th_5:
  buffer_load_dwordx4 v[88:91], v2, s[44:47], s12 offen nt
  s_add_u32 s12, s12, s19
  s_bitset0_b32 s12, 15
  s_waitcnt vmcnt(2)
  buffer_load_dwordx4 v[92:95], v2, s[44:47], s12 offen nt
  s_add_u32 s12, s12, s19
  s_bitset0_b32 s12, 15
  s_waitcnt vmcnt(2)
  buffer_load_dwordx4 v[96:99], v2, s[44:47], s12 offen nt
  s_add_u32 s12, s12, s19
  s_bitset0_b32 s12, 15
  s_waitcnt vmcnt(2)
  s_bitcmp0_b32 s68, 0
  s_cbranch_scc1 L_th_6
  s_waitcnt vmcnt(1)
L_th_6:
  buffer_load_dwordx4 v[100:103], v2, s[44:47], s12 offen nt
  s_add_u32 s12, s12, s19
  s_bitset0_b32 s12, 15
  s_waitcnt vmcnt(2)
  buffer_load_dwordx4 v[104:107], v2, s[44:47], s12 offen nt
  s_add_u32 s12, s12, s19
  s_bitset0_b32 s12, 15
  s_cmp_ge_u32 s12, s59
  s_cselect_b32 s12, s58, s12
  s_waitcnt vmcnt(2)
  buffer_load_dwordx4 v[108:111], v2, s[44:47], s12 offen nt
  s_add_u32 s12, s12, s19
  s_bitset0_b32 s12, 15
  s_cmp_ge_u32 s12, s59
  s_cselect_b32 s12, s58, s12
  s_waitcnt vmcnt(2)
  s_bitcmp0_b32 s68, 0
  s_cbranch_scc1 L_th_7
  s_waitcnt vmcnt(1)
L_th_7:
  buffer_load_dwordx4 v[112:115], v2, s[44:47], s12 offen nt
  s_add_u32 s12, s12, s19
  s_bitset0_b32 s12, 15
  s_cmp_ge_u32 s12, s59
  s_cselect_b32 s12, s58, s12
  s_waitcnt vmcnt(2)
  buffer_load_dwordx4 v[116:119], v2, s[44:47], s12 offen nt
  s_add_u32 s12, s12, s19
  s_bitset0_b32 s12, 15
  s_cmp_ge_u32 s12, s59
  s_cselect_b32 s12, s58, s12
  s_waitcnt vmcnt(2)
  buffer_load_dwordx4 v[120:123], v2, s[44:47], s12 offen nt
  s_add_u32 s12, s12, s19
  s_bitset0_b32 s12, 15
  s_cmp_ge_u32 s12, s59
  s_cselect_b32 s12, s58, s12
  s_waitcnt vmcnt(2)
  s_bitcmp0_b32 s68, 0
  s_cbranch_scc1 L_th_8
  s_waitcnt vmcnt(1)
L_th_8:
  buffer_load_dwordx4 v[124:127], v2, s[44:47], s12 offen nt
  s_add_u32 s12, s12, s19
  s_bitset0_b32 s12, 15
  s_cmp_ge_u32 s12, s59
  s_cselect_b32 s12, s58, s12
  s_waitcnt vmcnt(2)
  buffer_load_dwordx4 v[128:131], v2, s[44:47], s12 offen nt
  s_add_u32 s12, s12, s19
  s_bitset0_b32 s12, 15
  s_cmp_ge_u32 s12, s59
  s_cselect_b32 s12, s58, s12
  ds_write_b32 v4, v4 offset:6672
  s_waitcnt vmcnt(2)
  buffer_load_dwordx4 v[132:135], v2, s[44:47], s12 offen nt
  s_add_u32 s12, s12, s19
  s_bitset0_b32 s12, 15
  s_cmp_ge_u32 s12, s59
  s_cselect_b32 s12, s58, s12
  s_waitcnt vmcnt(2)
  s_bitcmp0_b32 s68, 0
  s_cbranch_scc1 L_th_9
  s_waitcnt vmcnt(1)
L_th_9:
  buffer_load_dwordx4 v[136:139], v2, s[44:47], s12 offen nt
  s_add_u32 s12, s12, s19
  s_bitset0_b32 s12, 15
  s_cmp_ge_u32 s12, s59
  s_cselect_b32 s12, s58, s12
  s_waitcnt vmcnt(2)
  buffer_load_dwordx4 v[140:143], v2, s[44:47], s12 offen nt
  s_add_u32 s12, s12, s19
  s_bitset0_b32 s12, 15
  s_cmp_ge_u32 s12, s59
  s_cselect_b32 s12, s58, s12
  s_waitcnt vmcnt(2)
  buffer_load_dwordx4 v[144:147], v2, s[44:47], s12 offen nt
  s_add_u32 s12, s12, s19
  s_bitset0_b32 s12, 15
  s_cmp_ge_u32 s12, s59
  s_cselect_b32 s12, s58, s12
  s_bfe_u32 s61, s14, 0xa0010
  s_add_u32 s61, s61, s9
  s_and_b32 s13, s61, -64
  s_add_u32 s61, s61, s13
  s_lshl_b32 s61, s61, 9
  s_bfe_u32 s60, s14, 0x70009
  s_sub_u32 s60, s9, s60
  s_add_u32 s60, s60, 64
  s_lshr_b32 s60, s60, 3
  v_bfrev_b32 v3, v1
  v_lshrrev_b32 v3, 28, v3
  v_cmp_gt_u32 s[66:67], s60, v3
  v_and_b32 v3, 15, v1
  v_lshlrev_b32 v3, 4, v3
  s_mov_b32 s13, s61
  s_cmp_gt_u32 s60, 7
  s_cbranch_scc1 L_opts_10
  s_waitcnt vmcnt(2)
  s_bitcmp0_b32 s68, 0
  s_cbranch_scc1 L_th_11
  s_waitcnt vmcnt(1)
L_th_11:
  buffer_load_dwordx4 v[52:55], v0, s[44:47], s13 offen nt
  s_add_u32 s13, s13, s19
  s_bitset0_b32 s13, 15
  s_cmp_gt_u32 s60, 6
  s_cbranch_scc1 L_opts_10
  s_waitcnt vmcnt(2)
  buffer_load_dwordx4 v[48:51], v0, s[44:47], s13 offen nt
  s_add_u32 s13, s13, s19
  s_bitset0_b32 s13, 15
  s_cmp_gt_u32 s60, 5
  s_cbranch_scc1 L_opts_10
  s_waitcnt vmcnt(2)
  buffer_load_dwordx4 v[44:47], v0, s[44:47], s13 offen nt
  s_add_u32 s13, s13, s19
  s_bitset0_b32 s13, 15
  s_cmp_gt_u32 s60, 4
  s_cbranch_scc1 L_opts_10
  s_waitcnt vmcnt(2)
  s_bitcmp0_b32 s68, 0
  s_cbranch_scc1 L_th_12
  s_waitcnt vmcnt(1)
L_th_12:
  buffer_load_dwordx4 v[40:43], v0, s[44:47], s13 offen nt
  s_add_u32 s13, s13, s19
  s_bitset0_b32 s13, 15
  s_cmp_gt_u32 s60, 3
  s_cbranch_scc1 L_opts_10
  s_waitcnt vmcnt(2)
  buffer_load_dwordx4 v[36:39], v0, s[44:47], s13 offen nt
  s_add_u32 s13, s13, s19
  s_bitset0_b32 s13, 15
  s_cmp_gt_u32 s60, 2
  s_cbranch_scc1 L_opts_10
  s_waitcnt vmcnt(2)
  buffer_load_dwordx4 v[32:35], v0, s[44:47], s13 offen nt
  s_add_u32 s13, s13, s19
  s_bitset0_b32 s13, 15
  s_cmp_gt_u32 s60, 1
  s_cbranch_scc1 L_opts_10
  s_waitcnt vmcnt(2)
  s_bitcmp0_b32 s68, 0
  s_cbranch_scc1 L_th_13
  s_waitcnt vmcnt(1)
L_th_13:
  buffer_load_dwordx4 v[28:31], v0, s[44:47], s13 offen nt
  s_add_u32 s13, s13, s19
  s_bitset0_b32 s13, 15
  s_cmp_gt_u32 s60, 0
  s_cbranch_scc1 L_opts_10
  s_waitcnt vmcnt(2)
  buffer_load_dwordx4 v[24:27], v0, s[44:47], s13 offen nt
  s_add_u32 s13, s13, s19
  s_bitset0_b32 s13, 15
L_opts_10:
  s_waitcnt vmcnt(2)
  buffer_load_dwordx4 v[148:151], v2, s[44:47], s12 offen nt
  s_add_u32 s12, s12, s19
  s_bitset0_b32 s12, 15
  s_cmp_ge_u32 s12, s59
  s_cselect_b32 s12, s58, s12
  s_waitcnt vmcnt(2)
  s_bitcmp0_b32 s68, 0
  s_cbranch_scc1 L_th_14
  s_waitcnt vmcnt(1)
L_th_14:
  buffer_load_dwordx4 v[152:155], v2, s[44:47], s12 offen nt
  s_add_u32 s12, s12, s19
  s_bitset0_b32 s12, 15
  s_cmp_ge_u32 s12, s59
  s_cselect_b32 s12, s58, s12
  s_waitcnt vmcnt(2)
  buffer_load_dwordx4 v[156:159], v2, s[44:47], s12 offen nt
  s_add_u32 s12, s12, s19
  s_bitset0_b32 s12, 15
  s_cmp_ge_u32 s12, s59
  s_cselect_b32 s12, s58, s12
  s_waitcnt vmcnt(2)
  buffer_load_dwordx4 v[160:163], v2, s[44:47], s12 offen nt
  s_add_u32 s12, s12, s19
  s_bitset0_b32 s12, 15
  s_cmp_ge_u32 s12, s59
  s_cselect_b32 s12, s58, s12
  s_waitcnt vmcnt(2)
  s_bitcmp0_b32 s68, 0
  s_cbranch_scc1 L_th_15
  s_waitcnt vmcnt(1)
L_th_15:
  buffer_load_dwordx4 v[164:167], v2, s[44:47], s12 offen nt
  s_add_u32 s12, s12, s19
  s_bitset0_b32 s12, 15
  s_cmp_ge_u32 s12, s59
  s_cselect_b32 s12, s58, s12
  s_waitcnt vmcnt(2)
  s_add_u32 m0, s15, 0
  s_nop 0
  buffer_load_dwordx4 v2, s[48:51], s12 offen nt lds
  s_add_u32 s12, s12, s19
  s_bitset0_b32 s12, 15
  s_waitcnt vmcnt(2)
  s_add_u32 m0, s15, 1024
  s_nop 0
  buffer_load_dwordx4 v2, s[48:51], s12 offen nt lds
  s_add_u32 s12, s12, s19
  s_bitset0_b32 s12, 15
  s_waitcnt vmcnt(2)
  s_bitcmp0_b32 s68, 0
  s_cbranch_scc1 L_th_16
  s_waitcnt vmcnt(1)
L_th_16:
  s_add_u32 m0, s15, 2048
  s_nop 0
  buffer_load_dwordx4 v2, s[48:51], s12 offen nt lds
  s_add_u32 s12, s12, s19
  s_bitset0_b32 s12, 15
  ds_write_b32 v4, v4 offset:6664
  s_waitcnt vmcnt(2)
  s_add_u32 m0, s15, 3072
  s_nop 0
  buffer_load_dwordx4 v2, s[48:51], s12 offen nt lds
  s_add_u32 s12, s12, s19
  s_bitset0_b32 s12, 15
  s_waitcnt vmcnt(2)
  s_add_u32 m0, s15, 4096
  s_nop 0
  buffer_load_dwordx4 v2, s[48:51], s12 offen nt lds
  s_add_u32 s12, s12, s19
  s_bitset0_b32 s12, 15
  s_waitcnt vmcnt(2)
  s_bitcmp0_b32 s68, 0
  s_cbranch_scc1 L_th_17
  s_waitcnt vmcnt(1)
L_th_17:
  s_add_u32 m0, s15, 5120
  s_nop 0
  buffer_load_dwordx4 v2, s[48:51], s12 offen nt lds
  s_add_u32 s12, s12, s19
  s_bitset0_b32 s12, 15
  s_waitcnt vmcnt(2)
  s_add_u32 m0, s15, 6144
  s_nop 0
  buffer_load_dwordx4 v2, s[48:51], s12 offen nt lds
  s_add_u32 s12, s12, s19
  s_bitset0_b32 s12, 15
  s_waitcnt vmcnt(2)
  s_add_u32 m0, s15, 7168
  s_nop 0
  buffer_load_dwordx4 v2, s[48:51], s12 offen nt lds
  s_add_u32 s12, s12, s19
  s_bitset0_b32 s12, 15
  s_mov_b32 s70, 0
L_pl_18:
  ds_read_b128 v[4:7], v3 offset:6400
  s_waitcnt lgkmcnt(0)
  v_max3_u32 v8, v4, v5, v6
  v_max_u32 v8, v8, v7
  v_cmp_eq_u32 vcc, -1, v8
  s_cmp_eq_u64 vcc, 0
  s_cbranch_scc1 L_pld_19
  s_sleep 2
  s_add_u32 s70, s70, 1
  s_cmp_lt_u32 s70, 1048576
  s_cbranch_scc1 L_pl_18
L_pld_19:
  s_waitcnt vmcnt(8)
  v_dot2_f32_bf16 v8, v56, v4, 0
  v_dot2_f32_bf16 v9, v60, v4, 0
  v_dot2_f32_bf16 v10, v64, v4, 0
  v_dot2_f32_bf16 v11, v68, v4, 0
  v_dot2_f32_bf16 v12, v72, v4, 0
  v_dot2_f32_bf16 v13, v76, v4, 0
  v_dot2_f32_bf16 v14, v80, v4, 0
  v_dot2_f32_bf16 v15, v84, v4, 0
  v_dot2_f32_bf16 v8, v57, v5, v8
  v_dot2_f32_bf16 v9, v61, v5, v9
  v_dot2_f32_bf16 v10, v65, v5, v10
  v_dot2_f32_bf16 v11, v69, v5, v11
  v_dot2_f32_bf16 v12, v73, v5, v12
  v_dot2_f32_bf16 v13, v77, v5, v13
  v_dot2_f32_bf16 v14, v81, v5, v14
  v_dot2_f32_bf16 v15, v85, v5, v15
  v_dot2_f32_bf16 v8, v58, v6, v8
  v_dot2_f32_bf16 v9, v62, v6, v9
  v_dot2_f32_bf16 v10, v66, v6, v10
  v_dot2_f32_bf16 v11, v70, v6, v11
  v_dot2_f32_bf16 v12, v74, v6, v12
  v_dot2_f32_bf16 v13, v78, v6, v13
  v_dot2_f32_bf16 v14, v82, v6, v14
  v_dot2_f32_bf16 v15, v86, v6, v15
  v_dot2_f32_bf16 v8, v59, v7, v8
  v_dot2_f32_bf16 v9, v63, v7, v9
  v_dot2_f32_bf16 v10, v67, v7, v10
  v_dot2_f32_bf16 v11, v71, v7, v11
  v_dot2_f32_bf16 v12, v75, v7, v12
  v_dot2_f32_bf16 v13, v79, v7, v13
  v_dot2_f32_bf16 v14, v83, v7, v14
  v_dot2_f32_bf16 v15, v87, v7, v15
  v_add_f32_dpp v8, v8, v8 row_ror:8 row_mask:0xf bank_mask:0x3
  v_add_f32_dpp v8, v9, v9 row_ror:8 row_mask:0xf bank_mask:0xc
  v_add_f32_dpp v10, v10, v10 row_ror:8 row_mask:0xf bank_mask:0x3
  v_add_f32_dpp v10, v11, v11 row_ror:8 row_mask:0xf bank_mask:0xc
  v_add_f32_dpp v12, v12, v12 row_ror:8 row_mask:0xf bank_mask:0x3
  v_add_f32_dpp v12, v13, v13 row_ror:8 row_mask:0xf bank_mask:0xc
  v_add_f32_dpp v14, v14, v14 row_ror:8 row_mask:0xf bank_mask:0x3
  v_add_f32_dpp v14, v15, v15 row_ror:8 row_mask:0xf bank_mask:0xc
  v_add_f32_dpp v18, v8, v8 row_shl:4 row_mask:0xf bank_mask:0x5
  v_add_f32_dpp v18, v10, v10 row_shr:4 row_mask:0xf bank_mask:0xa
  v_add_f32_dpp v19, v12, v12 row_shl:4 row_mask:0xf bank_mask:0x5
  v_add_f32_dpp v19, v14, v14 row_shr:4 row_mask:0xf bank_mask:0xa
  v_dot2_f32_bf16 v8, v88, v4, 0
  v_dot2_f32_bf16 v9, v92, v4, 0
  v_dot2_f32_bf16 v10, v96, v4, 0
  v_dot2_f32_bf16 v11, v100, v4, 0
  v_dot2_f32_bf16 v12, v104, v4, 0
  v_dot2_f32_bf16 v13, v108, v4, 0
  v_dot2_f32_bf16 v14, v112, v4, 0
  v_dot2_f32_bf16 v15, v116, v4, 0
  v_dot2_f32_bf16 v8, v89, v5, v8
  v_dot2_f32_bf16 v9, v93, v5, v9
  v_dot2_f32_bf16 v10, v97, v5, v10
  v_dot2_f32_bf16 v11, v101, v5, v11
  v_dot2_f32_bf16 v12, v105, v5, v12
  v_dot2_f32_bf16 v13, v109, v5, v13
  v_dot2_f32_bf16 v14, v113, v5, v14
  v_dot2_f32_bf16 v15, v117, v5, v15
  v_dot2_f32_bf16 v8, v90, v6, v8
  v_dot2_f32_bf16 v9, v94, v6, v9
  v_dot2_f32_bf16 v10, v98, v6, v10
  v_dot2_f32_bf16 v11, v102, v6, v11
  v_dot2_f32_bf16 v12, v106, v6, v12
  v_dot2_f32_bf16 v13, v110, v6, v13
  v_dot2_f32_bf16 v14, v114, v6, v14
  v_dot2_f32_bf16 v15, v118, v6, v15
  v_dot2_f32_bf16 v8, v91, v7, v8
  v_dot2_f32_bf16 v9, v95, v7, v9
  v_dot2_f32_bf16 v10, v99, v7, v10
  v_dot2_f32_bf16 v11, v103, v7, v11
  v_dot2_f32_bf16 v12, v107, v7, v12
  v_dot2_f32_bf16 v13, v111, v7, v13
  v_dot2_f32_bf16 v14, v115, v7, v14
  v_dot2_f32_bf16 v15, v119, v7, v15
  v_add_f32_dpp v8, v8, v8 row_ror:8 row_mask:0xf bank_mask:0x3
  v_add_f32_dpp v8, v9, v9 row_ror:8 row_mask:0xf bank_mask:0xc
  v_add_f32_dpp v10, v10, v10 row_ror:8 row_mask:0xf bank_mask:0x3
  v_add_f32_dpp v10, v11, v11 row_ror:8 row_mask:0xf bank_mask:0xc
  v_add_f32_dpp v12, v12, v12 row_ror:8 row_mask:0xf bank_mask:0x3
  v_add_f32_dpp v12, v13, v13 row_ror:8 row_mask:0xf bank_mask:0xc
  v_add_f32_dpp v14, v14, v14 row_ror:8 row_mask:0xf bank_mask:0x3
  v_add_f32_dpp v14, v15, v15 row_ror:8 row_mask:0xf bank_mask:0xc
  v_add_f32_dpp v20, v8, v8 row_shl:4 row_mask:0xf bank_mask:0x5
  v_add_f32_dpp v20, v10, v10 row_shr:4 row_mask:0xf bank_mask:0xa
  v_add_f32_dpp v21, v12, v12 row_shl:4 row_mask:0xf bank_mask:0x5
  v_add_f32_dpp v21, v14, v14 row_shr:4 row_mask:0xf bank_mask:0xa
  v_dot2_f32_bf16 v8, v120, v4, 0
  v_dot2_f32_bf16 v9, v124, v4, 0
  v_dot2_f32_bf16 v10, v128, v4, 0
  v_dot2_f32_bf16 v11, v132, v4, 0
  v_dot2_f32_bf16 v12, v136, v4, 0
  v_dot2_f32_bf16 v13, v140, v4, 0
  v_dot2_f32_bf16 v14, v144, v4, 0
  v_dot2_f32_bf16 v15, v148, v4, 0
  v_dot2_f32_bf16 v8, v121, v5, v8
  v_dot2_f32_bf16 v9, v125, v5, v9
  v_dot2_f32_bf16 v10, v129, v5, v10
  v_dot2_f32_bf16 v11, v133, v5, v11
  v_dot2_f32_bf16 v12, v137, v5, v12
  v_dot2_f32_bf16 v13, v141, v5, v13
  v_dot2_f32_bf16 v14, v145, v5, v14
  v_dot2_f32_bf16 v15, v149, v5, v15
  v_dot2_f32_bf16 v8, v122, v6, v8
  v_dot2_f32_bf16 v9, v126, v6, v9
  v_dot2_f32_bf16 v10, v130, v6, v10
  v_dot2_f32_bf16 v11, v134, v6, v11
  v_dot2_f32_bf16 v12, v138, v6, v12
  v_dot2_f32_bf16 v13, v142, v6, v13
  v_dot2_f32_bf16 v14, v146, v6, v14
  v_dot2_f32_bf16 v15, v150, v6, v15
  v_dot2_f32_bf16 v8, v123, v7, v8
  v_dot2_f32_bf16 v9, v127, v7, v9
  v_dot2_f32_bf16 v10, v131, v7, v10
  v_dot2_f32_bf16 v11, v135, v7, v11
  v_dot2_f32_bf16 v12, v139, v7, v12
  v_dot2_f32_bf16 v13, v143, v7, v13
  v_dot2_f32_bf16 v14, v147, v7, v14
  v_dot2_f32_bf16 v15, v151, v7, v15
  buffer_load_dwordx4 v[88:91], v2, s[48:51], s12 offen nt
  s_add_u32 s12, s12, s19
  s_bitset0_b32 s12, 15
  v_add_f32_dpp v8, v8, v8 row_ror:8 row_mask:0xf bank_mask:0x3
  v_add_f32_dpp v8, v9, v9 row_ror:8 row_mask:0xf bank_mask:0xc
  v_add_f32_dpp v10, v10, v10 row_ror:8 row_mask:0xf bank_mask:0x3
  v_add_f32_dpp v10, v11, v11 row_ror:8 row_mask:0xf bank_mask:0xc
  v_add_f32_dpp v12, v12, v12 row_ror:8 row_mask:0xf bank_mask:0x3
  v_add_f32_dpp v12, v13, v13 row_ror:8 row_mask:0xf bank_mask:0xc
  v_add_f32_dpp v14, v14, v14 row_ror:8 row_mask:0xf bank_mask:0x3
  v_add_f32_dpp v14, v15, v15 row_ror:8 row_mask:0xf bank_mask:0xc
  v_add_f32_dpp v22, v8, v8 row_shl:4 row_mask:0xf bank_mask:0x5
  v_add_f32_dpp v22, v10, v10 row_shr:4 row_mask:0xf bank_mask:0xa
  v_add_f32_dpp v23, v12, v12 row_shl:4 row_mask:0xf bank_mask:0x5
  v_add_f32_dpp v23, v14, v14 row_shr:4 row_mask:0xf bank_mask:0xa
  v_dot2_f32_bf16 v8, v152, v4, 0
  v_dot2_f32_bf16 v9, v156, v4, 0
  v_dot2_f32_bf16 v10, v160, v4, 0
  v_dot2_f32_bf16 v11, v164, v4, 0
  v_dot2_f32_bf16 v8, v153, v5, v8
  v_dot2_f32_bf16 v9, v157, v5, v9
  v_dot2_f32_bf16 v10, v161, v5, v10
  v_dot2_f32_bf16 v11, v165, v5, v11
  v_dot2_f32_bf16 v8, v154, v6, v8
  v_dot2_f32_bf16 v9, v158, v6, v9
  v_dot2_f32_bf16 v10, v162, v6, v10
  v_dot2_f32_bf16 v11, v166, v6, v11
  v_dot2_f32_bf16 v8, v155, v7, v8
  v_dot2_f32_bf16 v9, v159, v7, v9
  v_dot2_f32_bf16 v10, v163, v7, v10
  v_dot2_f32_bf16 v11, v167, v7, v11
  v_add_f32_dpp v8, v8, v8 row_ror:8 row_mask:0xf bank_mask:0x3
  v_add_f32_dpp v8, v9, v9 row_ror:8 row_mask:0xf bank_mask:0xc
  v_add_f32_dpp v10, v10, v10 row_ror:8 row_mask:0xf bank_mask:0x3
  v_add_f32_dpp v10, v11, v11 row_ror:8 row_mask:0xf bank_mask:0xc
  s_nop 0
  v_add_f32_dpp v3, v8, v8 row_shl:4 row_mask:0xf bank_mask:0x5
  v_add_f32_dpp v3, v10, v10 row_shr:4 row_mask:0xf bank_mask:0xa
  v_dot2_f32_bf16 v8, v24, v4, 0
  v_dot2_f32_bf16 v9, v28, v4, 0
  v_dot2_f32_bf16 v10, v32, v4, 0
  v_dot2_f32_bf16 v11, v36, v4, 0
  v_dot2_f32_bf16 v12, v40, v4, 0
  v_dot2_f32_bf16 v13, v44, v4, 0
  v_dot2_f32_bf16 v14, v48, v4, 0
  v_dot2_f32_bf16 v15, v52, v4, 0
  v_dot2_f32_bf16 v8, v25, v5, v8
  v_dot2_f32_bf16 v9, v29, v5, v9
  v_dot2_f32_bf16 v10, v33, v5, v10
  v_dot2_f32_bf16 v11, v37, v5, v11
  v_dot2_f32_bf16 v12, v41, v5, v12
  v_dot2_f32_bf16 v13, v45, v5, v13
  v_dot2_f32_bf16 v14, v49, v5, v14
  v_dot2_f32_bf16 v15, v53, v5, v15
  v_dot2_f32_bf16 v8, v26, v6, v8
  v_dot2_f32_bf16 v9, v30, v6, v9
  v_dot2_f32_bf16 v10, v34, v6, v10
  v_dot2_f32_bf16 v11, v38, v6, v11
  v_dot2_f32_bf16 v12, v42, v6, v12
  v_dot2_f32_bf16 v13, v46, v6, v13
  v_dot2_f32_bf16 v14, v50, v6, v14
  v_dot2_f32_bf16 v15, v54, v6, v15
  v_dot2_f32_bf16 v8, v27, v7, v8
  v_dot2_f32_bf16 v9, v31, v7, v9
  v_dot2_f32_bf16 v10, v35, v7, v10
  v_dot2_f32_bf16 v11, v39, v7, v11
  v_dot2_f32_bf16 v12, v43, v7, v12
  v_dot2_f32_bf16 v13, v47, v7, v13
  v_dot2_f32_bf16 v14, v51, v7, v14
  v_dot2_f32_bf16 v15, v55, v7, v15
  buffer_load_dwordx4 v[92:95], v2, s[48:51], s12 offen nt
  s_add_u32 s12, s12, s19
  s_bitset0_b32 s12, 15
  v_add_f32_dpp v8, v8, v8 row_ror:8 row_mask:0xf bank_mask:0x3
  v_add_f32_dpp v8, v9, v9 row_ror:8 row_mask:0xf bank_mask:0xc
  v_add_f32_dpp v10, v10, v10 row_ror:8 row_mask:0xf bank_mask:0x3
  v_add_f32_dpp v10, v11, v11 row_ror:8 row_mask:0xf bank_mask:0xc
  v_add_f32_dpp v12, v12, v12 row_ror:8 row_mask:0xf bank_mask:0x3
  v_add_f32_dpp v12, v13, v13 row_ror:8 row_mask:0xf bank_mask:0xc
  v_add_f32_dpp v14, v14, v14 row_ror:8 row_mask:0xf bank_mask:0x3
  v_add_f32_dpp v14, v15, v15 row_ror:8 row_mask:0xf bank_mask:0xc
  v_add_f32_dpp v16, v8, v8 row_shl:4 row_mask:0xf bank_mask:0x5
  v_add_f32_dpp v16, v10, v10 row_shr:4 row_mask:0xf bank_mask:0xa
  v_add_f32_dpp v17, v12, v12 row_shl:4 row_mask:0xf bank_mask:0x5
  v_add_f32_dpp v17, v14, v14 row_shr:4 row_mask:0xf bank_mask:0xa
  v_add_f32_dpp v3, v3, v3 quad_perm:[2,3,0,1] row_mask:0xf bank_mask:0xf
  v_add_f32_dpp v18, v18, v18 quad_perm:[2,3,0,1] row_mask:0xf bank_mask:0xf
  v_add_f32_dpp v19, v19, v19 quad_perm:[2,3,0,1] row_mask:0xf bank_mask:0xf
  v_add_f32_dpp v20, v20, v20 quad_perm:[2,3,0,1] row_mask:0xf bank_mask:0xf
  v_add_f32_dpp v21, v21, v21 quad_perm:[2,3,0,1] row_mask:0xf bank_mask:0xf
  v_add_f32_dpp v22, v22, v22 quad_perm:[2,3,0,1] row_mask:0xf bank_mask:0xf
  v_add_f32_dpp v23, v23, v23 quad_perm:[2,3,0,1] row_mask:0xf bank_mask:0xf
  v_add_f32_dpp v16, v16, v16 quad_perm:[2,3,0,1] row_mask:0xf bank_mask:0xf
  v_add_f32_dpp v17, v17, v17 quad_perm:[2,3,0,1] row_mask:0xf bank_mask:0xf
  v_cndmask_b32 v8, v16, v17, s[52:53]
  v_cndmask_b32 v9, v18, v19, s[52:53]
  v_cndmask_b32 v10, v20, v21, s[52:53]
  v_cndmask_b32 v11, v22, v23, s[52:53]
  v_add_f32_dpp v18, v3, v3 quad_perm:[1,0,3,2] row_mask:0xf bank_mask:0xf
  v_add_f32_dpp v8, v8, v8 quad_perm:[1,0,3,2] row_mask:0xf bank_mask:0xf
  v_add_f32_dpp v9, v9, v9 quad_perm:[1,0,3,2] row_mask:0xf bank_mask:0xf
  v_add_f32_dpp v10, v10, v10 quad_perm:[1,0,3,2] row_mask:0xf bank_mask:0xf
  v_add_f32_dpp v11, v11, v11 quad_perm:[1,0,3,2] row_mask:0xf bank_mask:0xf
  v_cndmask_b32 v16, v8, v9, s[54:55]
  v_cndmask_b32 v17, v10, v11, s[54:55]
  v_cvt_pk_bf16_f32 v16, 0, v16
  v_cvt_pk_bf16_f32 v17, 0, v17
  v_cvt_pk_bf16_f32 v18, 0, v18
  v_mul_f32 v16, 0x3db504f3, v16
  v_mul_f32 v17, 0x3db504f3, v17
  v_mul_f32 v18, 0x3db504f3, v18
  v_cvt_pk_bf16_f32 v16, 0, v16
  v_cvt_pk_bf16_f32 v17, 0, v17
  v_cvt_pk_bf16_f32 v18, 0, v18
  v_mov_b32 v19, 0xff800000
  s_mov_b32 s52, 0xeeeeeeee
  s_mov_b32 s53, 0xeeeeeeee
  v_cndmask_b32 v16, v16, v19, s[66:67]
  v_cndmask_b32 v18, v18, v19, s[52:53]
  s_lshl_b32 s11, s9, 10
  v_lshl_add_u32 v3, v1, 4, s11
  ds_write_b128 v3, v[16:19] offset:12032
  s_waitcnt vmcnt(2)
  s_bitcmp0_b32 s68, 0
  s_cbranch_scc1 L_th_20
  s_waitcnt vmcnt(1)
L_th_20:
  buffer_load_dwordx4 v[96:99], v2, s[48:51], s12 offen nt
  s_add_u32 s12, s12, s19
  s_bitset0_b32 s12, 15
  v_lshl_add_u32 v3, v1, 4, s15
  ds_read_b128 v[56:59], v3 offset:0
  ds_read_b128 v[60:63], v3 offset:1024
  ds_read_b128 v[64:67], v3 offset:2048
  ds_read_b128 v[68:71], v3 offset:3072
  ds_read_b128 v[72:75], v3 offset:4096
  ds_read_b128 v[76:79], v3 offset:5120
  ds_read_b128 v[80:83], v3 offset:6144
  ds_read_b128 v[84:87], v3 offset:7168
  v_max3_f32 v22, v16, v17, v18
  s_nop 1
  v_max_f32_dpp v22, v22, v22 row_ror:8 row_mask:0xf bank_mask:0xf
  s_nop 1
  v_max_f32_dpp v22, v22, v22 row_ror:4 row_mask:0xf bank_mask:0xf
  s_nop 1
  v_max_f32_dpp v22, v22, v22 row_ror:2 row_mask:0xf bank_mask:0xf
  s_nop 1
  v_max_f32_dpp v22, v22, v22 row_ror:1 row_mask:0xf bank_mask:0xf
  v_mov_b32 v23, v22
  s_nop 1
  v_permlane16_swap_b32 v23, v22
  v_max_f32 v22, v22, v23
  v_mov_b32 v23, v22
  s_nop 1
  v_permlane32_swap_b32 v23, v22
  v_max_f32 v22, v22, v23
  v_sub_f32 v16, v16, v22
  v_sub_f32 v17, v17, v22
  v_sub_f32 v18, v18, v22
  v_mul_f32 v16, 0x3fb8aa3b, v16
  v_mul_f32 v17, 0x3fb8aa3b, v17
  v_mul_f32 v18, 0x3fb8aa3b, v18
  v_exp_f32 v16, v16
  v_exp_f32 v17, v17
  v_exp_f32 v18, v18
  s_nop 0
  v_cvt_pk_bf16_f32 v4, v16, 0
  v_cvt_pk_bf16_f32 v5, 0, v16
  v_cvt_pk_bf16_f32 v6, v17, 0
  v_cvt_pk_bf16_f32 v7, 0, v17
  v_cvt_pk_bf16_f32 v20, v18, 0
  v_cvt_pk_bf16_f32 v21, 0, v18
  v_mov_b32 v8, 0
  v_mov_b32 v9, 0
  v_mov_b32 v10, 0
  v_mov_b32 v11, 0
  v_mov_b32 v12, 0
  v_mov_b32 v13, 0
  v_mov_b32 v14, 0
  v_mov_b32 v15, 0
  s_lshl_b32 s11, s9, 9
  v_and_b32 v3, 15, v1
  v_lshlrev_b32 v3, 5, v3
  v_lshrrev_b32 v16, 4, v1
  v_lshl_add_u32 v3, v16, 3, v3
  v_add_u32 v3, s11, v3
  v_mov_b32 v16, 6656
  s_waitcnt lgkmcnt(0)
  s_mov_b32 s13, s61
  s_cmp_gt_u32 s60, 7
  s_cbranch_scc1 L_opts_21
  s_waitcnt vmcnt(2)
  buffer_load_dwordx4 v[52:55], v0, s[48:51], s13 offen nt
  s_add_u32 s13, s13, s19
  s_bitset0_b32 s13, 15
  s_cmp_gt_u32 s60, 6
  s_cbranch_scc1 L_opts_21
  s_waitcnt vmcnt(2)
  buffer_load_dwordx4 v[48:51], v0, s[48:51], s13 offen nt
  s_add_u32 s13, s13, s19
  s_bitset0_b32 s13, 15
  s_cmp_gt_u32 s60, 5
  s_cbranch_scc1 L_opts_21
  s_waitcnt vmcnt(2)
  s_bitcmp0_b32 s68, 0
  s_cbranch_scc1 L_th_22
  s_waitcnt vmcnt(1)
L_th_22:
  buffer_load_dwordx4 v[44:47], v0, s[48:51], s13 offen nt
  s_add_u32 s13, s13, s19
  s_bitset0_b32 s13, 15
  s_cmp_gt_u32 s60, 4
  s_cbranch_scc1 L_opts_21
  s_waitcnt vmcnt(2)
  buffer_load_dwordx4 v[40:43], v0, s[48:51], s13 offen nt
  s_add_u32 s13, s13, s19
  s_bitset0_b32 s13, 15
  s_cmp_gt_u32 s60, 3
  s_cbranch_scc1 L_opts_21
  s_waitcnt vmcnt(2)
  buffer_load_dwordx4 v[36:39], v0, s[48:51], s13 offen nt
  s_add_u32 s13, s13, s19
  s_bitset0_b32 s13, 15
  s_cmp_gt_u32 s60, 2
  s_cbranch_scc1 L_opts_21
  s_waitcnt vmcnt(2)
  s_bitcmp0_b32 s68, 0
  s_cbranch_scc1 L_th_23
  s_waitcnt vmcnt(1)
L_th_23:
  buffer_load_dwordx4 v[32:35], v0, s[48:51], s13 offen nt
  s_add_u32 s13, s13, s19
  s_bitset0_b32 s13, 15
  s_cmp_gt_u32 s60, 1
  s_cbranch_scc1 L_opts_21
  s_waitcnt vmcnt(2)
  buffer_load_dwordx4 v[28:31], v0, s[48:51], s13 offen nt
  s_add_u32 s13, s13, s19
  s_bitset0_b32 s13, 15
  s_cmp_gt_u32 s60, 0
  s_cbranch_scc1 L_opts_21
  s_waitcnt vmcnt(2)
  buffer_load_dwordx4 v[24:27], v0, s[48:51], s13 offen nt
  s_add_u32 s13, s13, s19
  s_bitset0_b32 s13, 15
L_opts_21:
  s_waitcnt vmcnt(2)
  s_bitcmp0_b32 s68, 0
  s_cbranch_scc1 L_th_24
  s_waitcnt vmcnt(1)
L_th_24:
  buffer_load_dwordx4 v[100:103], v2, s[48:51], s12 offen nt
  s_add_u32 s12, s12, s19
  s_bitset0_b32 s12, 15
  v_dot2c_f32_bf16_dpp v8, v4, v56 row_newbcast:1 row_mask:0xf bank_mask:0xf
  v_dot2c_f32_bf16_dpp v9, v5, v56 row_newbcast:1 row_mask:0xf bank_mask:0xf
  v_dot2c_f32_bf16_dpp v10, v4, v57 row_newbcast:1 row_mask:0xf bank_mask:0xf
  v_dot2c_f32_bf16_dpp v11, v5, v57 row_newbcast:1 row_mask:0xf bank_mask:0xf
  v_dot2c_f32_bf16_dpp v12, v4, v58 row_newbcast:1 row_mask:0xf bank_mask:0xf
  v_dot2c_f32_bf16_dpp v13, v5, v58 row_newbcast:1 row_mask:0xf bank_mask:0xf
  v_dot2c_f32_bf16_dpp v14, v4, v59 row_newbcast:1 row_mask:0xf bank_mask:0xf
  v_dot2c_f32_bf16_dpp v15, v5, v59 row_newbcast:1 row_mask:0xf bank_mask:0xf
  v_dot2c_f32_bf16_dpp v8, v4, v60 row_newbcast:9 row_mask:0xf bank_mask:0xf
  v_dot2c_f32_bf16_dpp v9, v5, v60 row_newbcast:9 row_mask:0xf bank_mask:0xf
  v_dot2c_f32_bf16_dpp v10, v4, v61 row_newbcast:9 row_mask:0xf bank_mask:0xf
  v_dot2c_f32_bf16_dpp v11, v5, v61 row_newbcast:9 row_mask:0xf bank_mask:0xf
  v_dot2c_f32_bf16_dpp v12, v4, v62 row_newbcast:9 row_mask:0xf bank_mask:0xf
  v_dot2c_f32_bf16_dpp v13, v5, v62 row_newbcast:9 row_mask:0xf bank_mask:0xf
  v_dot2c_f32_bf16_dpp v14, v4, v63 row_newbcast:9 row_mask:0xf bank_mask:0xf
  v_dot2c_f32_bf16_dpp v15, v5, v63 row_newbcast:9 row_mask:0xf bank_mask:0xf
  v_dot2c_f32_bf16_dpp v8, v4, v64 row_newbcast:5 row_mask:0xf bank_mask:0xf
  v_dot2c_f32_bf16_dpp v9, v5, v64 row_newbcast:5 row_mask:0xf bank_mask:0xf
  v_dot2c_f32_bf16_dpp v10, v4, v65 row_newbcast:5 row_mask:0xf bank_mask:0xf
  v_dot2c_f32_bf16_dpp v11, v5, v65 row_newbcast:5 row_mask:0xf bank_mask:0xf
  v_dot2c_f32_bf16_dpp v12, v4, v66 row_newbcast:5 row_mask:0xf bank_mask:0xf
  v_dot2c_f32_bf16_dpp v13, v5, v66 row_newbcast:5 row_mask:0xf bank_mask:0xf
  v_dot2c_f32_bf16_dpp v14, v4, v67 row_newbcast:5 row_mask:0xf bank_mask:0xf
  v_dot2c_f32_bf16_dpp v15, v5, v67 row_newbcast:5 row_mask:0xf bank_mask:0xf
  s_waitcnt vmcnt(2)
  buffer_load_dwordx4 v[104:107], v2, s[48:51], s12 offen nt
  s_add_u32 s12, s12, s19
  s_bitset0_b32 s12, 15
  s_cmp_ge_u32 s12, s59
  s_cselect_b32 s12, s58, s12
  v_dot2c_f32_bf16_dpp v8, v4, v68 row_newbcast:13 row_mask:0xf bank_mask:0xf
  v_dot2c_f32_bf16_dpp v9, v5, v68 row_newbcast:13 row_mask:0xf bank_mask:0xf
  v_dot2c_f32_bf16_dpp v10, v4, v69 row_newbcast:13 row_mask:0xf bank_mask:0xf
  v_dot2c_f32_bf16_dpp v11, v5, v69 row_newbcast:13 row_mask:0xf bank_mask:0xf
  v_dot2c_f32_bf16_dpp v12, v4, v70 row_newbcast:13 row_mask:0xf bank_mask:0xf
  v_dot2c_f32_bf16_dpp v13, v5, v70 row_newbcast:13 row_mask:0xf bank_mask:0xf
  v_dot2c_f32_bf16_dpp v14, v4, v71 row_newbcast:13 row_mask:0xf bank_mask:0xf
  v_dot2c_f32_bf16_dpp v15, v5, v71 row_newbcast:13 row_mask:0xf bank_mask:0xf
  v_dot2c_f32_bf16_dpp v8, v4, v72 row_newbcast:3 row_mask:0xf bank_mask:0xf
  v_dot2c_f32_bf16_dpp v9, v5, v72 row_newbcast:3 row_mask:0xf bank_mask:0xf
  v_dot2c_f32_bf16_dpp v10, v4, v73 row_newbcast:3 row_mask:0xf bank_mask:0xf
  v_dot2c_f32_bf16_dpp v11, v5, v73 row_newbcast:3 row_mask:0xf bank_mask:0xf
  v_dot2c_f32_bf16_dpp v12, v4, v74 row_newbcast:3 row_mask:0xf bank_mask:0xf
  v_dot2c_f32_bf16_dpp v13, v5, v74 row_newbcast:3 row_mask:0xf bank_mask:0xf
  v_dot2c_f32_bf16_dpp v14, v4, v75 row_newbcast:3 row_mask:0xf bank_mask:0xf
  v_dot2c_f32_bf16_dpp v15, v5, v75 row_newbcast:3 row_mask:0xf bank_mask:0xf
  v_dot2c_f32_bf16_dpp v8, v4, v76 row_newbcast:11 row_mask:0xf bank_mask:0xf
  v_dot2c_f32_bf16_dpp v9, v5, v76 row_newbcast:11 row_mask:0xf bank_mask:0xf
  v_dot2c_f32_bf16_dpp v10, v4, v77 row_newbcast:11 row_mask:0xf bank_mask:0xf
  v_dot2c_f32_bf16_dpp v11, v5, v77 row_newbcast:11 row_mask:0xf bank_mask:0xf
  v_dot2c_f32_bf16_dpp v12, v4, v78 row_newbcast:11 row_mask:0xf bank_mask:0xf
  v_dot2c_f32_bf16_dpp v13, v5, v78 row_newbcast:11 row_mask:0xf bank_mask:0xf
  v_dot2c_f32_bf16_dpp v14, v4, v79 row_newbcast:11 row_mask:0xf bank_mask:0xf
  v_dot2c_f32_bf16_dpp v15, v5, v79 row_newbcast:11 row_mask:0xf bank_mask:0xf
  s_waitcnt vmcnt(2)
  buffer_load_dwordx4 v[108:111], v2, s[48:51], s12 offen nt
  s_add_u32 s12, s12, s19
  s_bitset0_b32 s12, 15
  s_cmp_ge_u32 s12, s59
  s_cselect_b32 s12, s58, s12
  v_dot2c_f32_bf16_dpp v8, v4, v80 row_newbcast:7 row_mask:0xf bank_mask:0xf
  v_dot2c_f32_bf16_dpp v9, v5, v80 row_newbcast:7 row_mask:0xf bank_mask:0xf
  v_dot2c_f32_bf16_dpp v10, v4, v81 row_newbcast:7 row_mask:0xf bank_mask:0xf
  v_dot2c_f32_bf16_dpp v11, v5, v81 row_newbcast:7 row_mask:0xf bank_mask:0xf
  v_dot2c_f32_bf16_dpp v12, v4, v82 row_newbcast:7 row_mask:0xf bank_mask:0xf
  v_dot2c_f32_bf16_dpp v13, v5, v82 row_newbcast:7 row_mask:0xf bank_mask:0xf
  v_dot2c_f32_bf16_dpp v14, v4, v83 row_newbcast:7 row_mask:0xf bank_mask:0xf
  v_dot2c_f32_bf16_dpp v15, v5, v83 row_newbcast:7 row_mask:0xf bank_mask:0xf
  v_dot2c_f32_bf16_dpp v8, v4, v84 row_newbcast:15 row_mask:0xf bank_mask:0xf
  v_dot2c_f32_bf16_dpp v9, v5, v84 row_newbcast:15 row_mask:0xf bank_mask:0xf
  v_dot2c_f32_bf16_dpp v10, v4, v85 row_newbcast:15 row_mask:0xf bank_mask:0xf
  v_dot2c_f32_bf16_dpp v11, v5, v85 row_newbcast:15 row_mask:0xf bank_mask:0xf
  v_dot2c_f32_bf16_dpp v12, v4, v86 row_newbcast:15 row_mask:0xf bank_mask:0xf
  v_dot2c_f32_bf16_dpp v13, v5, v86 row_newbcast:15 row_mask:0xf bank_mask:0xf
  v_dot2c_f32_bf16_dpp v14, v4, v87 row_newbcast:15 row_mask:0xf bank_mask:0xf
  v_dot2c_f32_bf16_dpp v15, v5, v87 row_newbcast:15 row_mask:0xf bank_mask:0xf
  v_dot2c_f32_bf16_dpp v8, v6, v88 row_newbcast:0 row_mask:0xf bank_mask:0xf
  v_dot2c_f32_bf16_dpp v9, v7, v88 row_newbcast:0 row_mask:0xf bank_mask:0xf
  v_dot2c_f32_bf16_dpp v10, v6, v89 row_newbcast:0 row_mask:0xf bank_mask:0xf
  v_dot2c_f32_bf16_dpp v11, v7, v89 row_newbcast:0 row_mask:0xf bank_mask:0xf
  v_dot2c_f32_bf16_dpp v12, v6, v90 row_newbcast:0 row_mask:0xf bank_mask:0xf
  v_dot2c_f32_bf16_dpp v13, v7, v90 row_newbcast:0 row_mask:0xf bank_mask:0xf
  v_dot2c_f32_bf16_dpp v14, v6, v91 row_newbcast:0 row_mask:0xf bank_mask:0xf
  v_dot2c_f32_bf16_dpp v15, v7, v91 row_newbcast:0 row_mask:0xf bank_mask:0xf
  s_waitcnt vmcnt(2)
  s_bitcmp0_b32 s68, 0
  s_cbranch_scc1 L_th_25
  s_waitcnt vmcnt(1)
L_th_25:
  buffer_load_dwordx4 v[112:115], v2, s[48:51], s12 offen nt
  s_add_u32 s12, s12, s19
  s_bitset0_b32 s12, 15
  s_cmp_ge_u32 s12, s59
  s_cselect_b32 s12, s58, s12
  v_dot2c_f32_bf16_dpp v8, v6, v92 row_newbcast:8 row_mask:0xf bank_mask:0xf
  v_dot2c_f32_bf16_dpp v9, v7, v92 row_newbcast:8 row_mask:0xf bank_mask:0xf
  v_dot2c_f32_bf16_dpp v10, v6, v93 row_newbcast:8 row_mask:0xf bank_mask:0xf
  v_dot2c_f32_bf16_dpp v11, v7, v93 row_newbcast:8 row_mask:0xf bank_mask:0xf
  v_dot2c_f32_bf16_dpp v12, v6, v94 row_newbcast:8 row_mask:0xf bank_mask:0xf
  v_dot2c_f32_bf16_dpp v13, v7, v94 row_newbcast:8 row_mask:0xf bank_mask:0xf
  v_dot2c_f32_bf16_dpp v14, v6, v95 row_newbcast:8 row_mask:0xf bank_mask:0xf
  v_dot2c_f32_bf16_dpp v15, v7, v95 row_newbcast:8 row_mask:0xf bank_mask:0xf
  v_dot2c_f32_bf16_dpp v8, v6, v96 row_newbcast:4 row_mask:0xf bank_mask:0xf
  v_dot2c_f32_bf16_dpp v9, v7, v96 row_newbcast:4 row_mask:0xf bank_mask:0xf
  v_dot2c_f32_bf16_dpp v10, v6, v97 row_newbcast:4 row_mask:0xf bank_mask:0xf
  v_dot2c_f32_bf16_dpp v11, v7, v97 row_newbcast:4 row_mask:0xf bank_mask:0xf
  v_dot2c_f32_bf16_dpp v12, v6, v98 row_newbcast:4 row_mask:0xf bank_mask:0xf
  v_dot2c_f32_bf16_dpp v13, v7, v98 row_newbcast:4 row_mask:0xf bank_mask:0xf
  v_dot2c_f32_bf16_dpp v14, v6, v99 row_newbcast:4 row_mask:0xf bank_mask:0xf
  v_dot2c_f32_bf16_dpp v15, v7, v99 row_newbcast:4 row_mask:0xf bank_mask:0xf
  s_cmp_gt_u32 s60, 7
  s_cbranch_scc1 L_opt_26
  v_dot2c_f32_bf16_dpp v8, v4, v52 row_newbcast:14 row_mask:0xf bank_mask:0xf
  v_dot2c_f32_bf16_dpp v9, v5, v52 row_newbcast:14 row_mask:0xf bank_mask:0xf
  v_dot2c_f32_bf16_dpp v10, v4, v53 row_newbcast:14 row_mask:0xf bank_mask:0xf
  v_dot2c_f32_bf16_dpp v11, v5, v53 row_newbcast:14 row_mask:0xf bank_mask:0xf
  v_dot2c_f32_bf16_dpp v12, v4, v54 row_newbcast:14 row_mask:0xf bank_mask:0xf
  v_dot2c_f32_bf16_dpp v13, v5, v54 row_newbcast:14 row_mask:0xf bank_mask:0xf
  v_dot2c_f32_bf16_dpp v14, v4, v55 row_newbcast:14 row_mask:0xf bank_mask:0xf
  v_dot2c_f32_bf16_dpp v15, v5, v55 row_newbcast:14 row_mask:0xf bank_mask:0xf
L_opt_26:
  s_waitcnt vmcnt(2)
  buffer_load_dwordx4 v[116:119], v2, s[48:51], s12 offen nt
  s_add_u32 s12, s12, s19
  s_bitset0_b32 s12, 15
  s_cmp_ge_u32 s12, s59
  s_cselect_b32 s12, s58, s12
  s_cmp_gt_u32 s60, 6
  s_cbranch_scc1 L_opt_27
  v_dot2c_f32_bf16_dpp v8, v4, v48 row_newbcast:6 row_mask:0xf bank_mask:0xf
  v_dot2c_f32_bf16_dpp v9, v5, v48 row_newbcast:6 row_mask:0xf bank_mask:0xf
  v_dot2c_f32_bf16_dpp v10, v4, v49 row_newbcast:6 row_mask:0xf bank_mask:0xf
  v_dot2c_f32_bf16_dpp v11, v5, v49 row_newbcast:6 row_mask:0xf bank_mask:0xf
  v_dot2c_f32_bf16_dpp v12, v4, v50 row_newbcast:6 row_mask:0xf bank_mask:0xf
  v_dot2c_f32_bf16_dpp v13, v5, v50 row_newbcast:6 row_mask:0xf bank_mask:0xf
  v_dot2c_f32_bf16_dpp v14, v4, v51 row_newbcast:6 row_mask:0xf bank_mask:0xf
  v_dot2c_f32_bf16_dpp v15, v5, v51 row_newbcast:6 row_mask:0xf bank_mask:0xf
L_opt_27:
  s_cmp_gt_u32 s60, 5
  s_cbranch_scc1 L_opt_28
  v_dot2c_f32_bf16_dpp v8, v4, v44 row_newbcast:10 row_mask:0xf bank_mask:0xf
  v_dot2c_f32_bf16_dpp v9, v5, v44 row_newbcast:10 row_mask:0xf bank_mask:0xf
  v_dot2c_f32_bf16_dpp v10, v4, v45 row_newbcast:10 row_mask:0xf bank_mask:0xf
  v_dot2c_f32_bf16_dpp v11, v5, v45 row_newbcast:10 row_mask:0xf bank_mask:0xf
  v_dot2c_f32_bf16_dpp v12, v4, v46 row_newbcast:10 row_mask:0xf bank_mask:0xf
  v_dot2c_f32_bf16_dpp v13, v5, v46 row_newbcast:10 row_mask:0xf bank_mask:0xf
  v_dot2c_f32_bf16_dpp v14, v4, v47 row_newbcast:10 row_mask:0xf bank_mask:0xf
  v_dot2c_f32_bf16_dpp v15, v5, v47 row_newbcast:10 row_mask:0xf bank_mask:0xf
L_opt_28:
  s_cmp_gt_u32 s60, 4
  s_cbranch_scc1 L_opt_29
  v_dot2c_f32_bf16_dpp v8, v4, v40 row_newbcast:2 row_mask:0xf bank_mask:0xf
  v_dot2c_f32_bf16_dpp v9, v5, v40 row_newbcast:2 row_mask:0xf bank_mask:0xf
  v_dot2c_f32_bf16_dpp v10, v4, v41 row_newbcast:2 row_mask:0xf bank_mask:0xf
  v_dot2c_f32_bf16_dpp v11, v5, v41 row_newbcast:2 row_mask:0xf bank_mask:0xf
  v_dot2c_f32_bf16_dpp v12, v4, v42 row_newbcast:2 row_mask:0xf bank_mask:0xf
  v_dot2c_f32_bf16_dpp v13, v5, v42 row_newbcast:2 row_mask:0xf bank_mask:0xf
  v_dot2c_f32_bf16_dpp v14, v4, v43 row_newbcast:2 row_mask:0xf bank_mask:0xf
  v_dot2c_f32_bf16_dpp v15, v5, v43 row_newbcast:2 row_mask:0xf bank_mask:0xf
L_opt_29:
  s_waitcnt vmcnt(2)
  buffer_load_dwordx4 v[120:123], v2, s[48:51], s12 offen nt
  s_add_u32 s12, s12, s19
  s_bitset0_b32 s12, 15
  s_cmp_ge_u32 s12, s59
  s_cselect_b32 s12, s58, s12
  ds_write_b32 v16, v16 offset:20
  s_cmp_gt_u32 s60, 3
  s_cbranch_scc1 L_opt_30
  v_dot2c_f32_bf16_dpp v8, v4, v36 row_newbcast:12 row_mask:0xf bank_mask:0xf
  v_dot2c_f32_bf16_dpp v9, v5, v36 row_newbcast:12 row_mask:0xf bank_mask:0xf
  v_dot2c_f32_bf16_dpp v10, v4, v37 row_newbcast:12 row_mask:0xf bank_mask:0xf
  v_dot2c_f32_bf16_dpp v11, v5, v37 row_newbcast:12 row_mask:0xf bank_mask:0xf
  v_dot2c_f32_bf16_dpp v12, v4, v38 row_newbcast:12 row_mask:0xf bank_mask:0xf
  v_dot2c_f32_bf16_dpp v13, v5, v38 row_newbcast:12 row_mask:0xf bank_mask:0xf
  v_dot2c_f32_bf16_dpp v14, v4, v39 row_newbcast:12 row_mask:0xf bank_mask:0xf
  v_dot2c_f32_bf16_dpp v15, v5, v39 row_newbcast:12 row_mask:0xf bank_mask:0xf
L_opt_30:
  s_cmp_gt_u32 s60, 2
  s_cbranch_scc1 L_opt_31
  v_dot2c_f32_bf16_dpp v8, v4, v32 row_newbcast:4 row_mask:0xf bank_mask:0xf
  v_dot2c_f32_bf16_dpp v9, v5, v32 row_newbcast:4 row_mask:0xf bank_mask:0xf
  v_dot2c_f32_bf16_dpp v10, v4, v33 row_newbcast:4 row_mask:0xf bank_mask:0xf
  v_dot2c_f32_bf16_dpp v11, v5, v33 row_newbcast:4 row_mask:0xf bank_mask:0xf
  v_dot2c_f32_bf16_dpp v12, v4, v34 row_newbcast:4 row_mask:0xf bank_mask:0xf
  v_dot2c_f32_bf16_dpp v13, v5, v34 row_newbcast:4 row_mask:0xf bank_mask:0xf
  v_dot2c_f32_bf16_dpp v14, v4, v35 row_newbcast:4 row_mask:0xf bank_mask:0xf
  v_dot2c_f32_bf16_dpp v15, v5, v35 row_newbcast:4 row_mask:0xf bank_mask:0xf
L_opt_31:
  s_cmp_gt_u32 s60, 1
  s_cbranch_scc1 L_opt_32
  v_dot2c_f32_bf16_dpp v8, v4, v28 row_newbcast:8 row_mask:0xf bank_mask:0xf
  v_dot2c_f32_bf16_dpp v9, v5, v28 row_newbcast:8 row_mask:0xf bank_mask:0xf
  v_dot2c_f32_bf16_dpp v10, v4, v29 row_newbcast:8 row_mask:0xf bank_mask:0xf
  v_dot2c_f32_bf16_dpp v11, v5, v29 row_newbcast:8 row_mask:0xf bank_mask:0xf
  v_dot2c_f32_bf16_dpp v12, v4, v30 row_newbcast:8 row_mask:0xf bank_mask:0xf
  v_dot2c_f32_bf16_dpp v13, v5, v30 row_newbcast:8 row_mask:0xf bank_mask:0xf
  v_dot2c_f32_bf16_dpp v14, v4, v31 row_newbcast:8 row_mask:0xf bank_mask:0xf
  v_dot2c_f32_bf16_dpp v15, v5, v31 row_newbcast:8 row_mask:0xf bank_mask:0xf
L_opt_32:
  s_waitcnt vmcnt(2)
  s_bitcmp0_b32 s68, 0
  s_cbranch_scc1 L_th_33
  s_waitcnt vmcnt(1)
L_th_33:
  buffer_load_dwordx4 v[124:127], v2, s[48:51], s12 offen nt
  s_add_u32 s12, s12, s19
  s_bitset0_b32 s12, 15
  s_cmp_ge_u32 s12, s59
  s_cselect_b32 s12, s58, s12
  s_cmp_gt_u32 s60, 0
  s_cbranch_scc1 L_opt_34
  v_dot2c_f32_bf16_dpp v8, v4, v24 row_newbcast:0 row_mask:0xf bank_mask:0xf
  v_dot2c_f32_bf16_dpp v9, v5, v24 row_newbcast:0 row_mask:0xf bank_mask:0xf
  v_dot2c_f32_bf16_dpp v10, v4, v25 row_newbcast:0 row_mask:0xf bank_mask:0xf
  v_dot2c_f32_bf16_dpp v11, v5, v25 row_newbcast:0 row_mask:0xf bank_mask:0xf
  v_dot2c_f32_bf16_dpp v12, v4, v26 row_newbcast:0 row_mask:0xf bank_mask:0xf
  v_dot2c_f32_bf16_dpp v13, v5, v26 row_newbcast:0 row_mask:0xf bank_mask:0xf
  v_dot2c_f32_bf16_dpp v14, v4, v27 row_newbcast:0 row_mask:0xf bank_mask:0xf
  v_dot2c_f32_bf16_dpp v15, v5, v27 row_newbcast:0 row_mask:0xf bank_mask:0xf
L_opt_34:
  v_dot2c_f32_bf16_dpp v8, v6, v100 row_newbcast:12 row_mask:0xf bank_mask:0xf
  v_dot2c_f32_bf16_dpp v9, v7, v100 row_newbcast:12 row_mask:0xf bank_mask:0xf
  v_dot2c_f32_bf16_dpp v10, v6, v101 row_newbcast:12 row_mask:0xf bank_mask:0xf
  v_dot2c_f32_bf16_dpp v11, v7, v101 row_newbcast:12 row_mask:0xf bank_mask:0xf
  v_dot2c_f32_bf16_dpp v12, v6, v102 row_newbcast:12 row_mask:0xf bank_mask:0xf
  v_dot2c_f32_bf16_dpp v13, v7, v102 row_newbcast:12 row_mask:0xf bank_mask:0xf
  v_dot2c_f32_bf16_dpp v14, v6, v103 row_newbcast:12 row_mask:0xf bank_mask:0xf
  v_dot2c_f32_bf16_dpp v15, v7, v103 row_newbcast:12 row_mask:0xf bank_mask:0xf
  v_dot2c_f32_bf16_dpp v8, v6, v104 row_newbcast:2 row_mask:0xf bank_mask:0xf
  v_dot2c_f32_bf16_dpp v9, v7, v104 row_newbcast:2 row_mask:0xf bank_mask:0xf
  v_dot2c_f32_bf16_dpp v10, v6, v105 row_newbcast:2 row_mask:0xf bank_mask:0xf
  v_dot2c_f32_bf16_dpp v11, v7, v105 row_newbcast:2 row_mask:0xf bank_mask:0xf
  v_dot2c_f32_bf16_dpp v12, v6, v106 row_newbcast:2 row_mask:0xf bank_mask:0xf
  v_dot2c_f32_bf16_dpp v13, v7, v106 row_newbcast:2 row_mask:0xf bank_mask:0xf
  v_dot2c_f32_bf16_dpp v14, v6, v107 row_newbcast:2 row_mask:0xf bank_mask:0xf
  v_dot2c_f32_bf16_dpp v15, v7, v107 row_newbcast:2 row_mask:0xf bank_mask:0xf
  s_waitcnt vmcnt(2)
  buffer_load_dwordx4 v[128:131], v2, s[48:51], s12 offen nt
  s_add_u32 s12, s12, s19
  s_bitset0_b32 s12, 15
  s_cmp_ge_u32 s12, s59
  s_cselect_b32 s12, s58, s12
  v_dot2c_f32_bf16_dpp v8, v6, v108 row_newbcast:10 row_mask:0xf bank_mask:0xf
  v_dot2c_f32_bf16_dpp v9, v7, v108 row_newbcast:10 row_mask:0xf bank_mask:0xf
  v_dot2c_f32_bf16_dpp v10, v6, v109 row_newbcast:10 row_mask:0xf bank_mask:0xf
  v_dot2c_f32_bf16_dpp v11, v7, v109 row_newbcast:10 row_mask:0xf bank_mask:0xf
  v_dot2c_f32_bf16_dpp v12, v6, v110 row_newbcast:10 row_mask:0xf bank_mask:0xf
  v_dot2c_f32_bf16_dpp v13, v7, v110 row_newbcast:10 row_mask:0xf bank_mask:0xf
  v_dot2c_f32_bf16_dpp v14, v6, v111 row_newbcast:10 row_mask:0xf bank_mask:0xf
  v_dot2c_f32_bf16_dpp v15, v7, v111 row_newbcast:10 row_mask:0xf bank_mask:0xf
  v_dot2c_f32_bf16_dpp v8, v6, v112 row_newbcast:6 row_mask:0xf bank_mask:0xf
  v_dot2c_f32_bf16_dpp v9, v7, v112 row_newbcast:6 row_mask:0xf bank_mask:0xf
  v_dot2c_f32_bf16_dpp v10, v6, v113 row_newbcast:6 row_mask:0xf bank_mask:0xf
  v_dot2c_f32_bf16_dpp v11, v7, v113 row_newbcast:6 row_mask:0xf bank_mask:0xf
  v_dot2c_f32_bf16_dpp v12, v6, v114 row_newbcast:6 row_mask:0xf bank_mask:0xf
  v_dot2c_f32_bf16_dpp v13, v7, v114 row_newbcast:6 row_mask:0xf bank_mask:0xf
  v_dot2c_f32_bf16_dpp v14, v6, v115 row_newbcast:6 row_mask:0xf bank_mask:0xf
  v_dot2c_f32_bf16_dpp v15, v7, v115 row_newbcast:6 row_mask:0xf bank_mask:0xf
  v_dot2c_f32_bf16_dpp v8, v6, v116 row_newbcast:14 row_mask:0xf bank_mask:0xf
  v_dot2c_f32_bf16_dpp v9, v7, v116 row_newbcast:14 row_mask:0xf bank_mask:0xf
  v_dot2c_f32_bf16_dpp v10, v6, v117 row_newbcast:14 row_mask:0xf bank_mask:0xf
  v_dot2c_f32_bf16_dpp v11, v7, v117 row_newbcast:14 row_mask:0xf bank_mask:0xf
  v_dot2c_f32_bf16_dpp v12, v6, v118 row_newbcast:14 row_mask:0xf bank_mask:0xf
  v_dot2c_f32_bf16_dpp v13, v7, v118 row_newbcast:14 row_mask:0xf bank_mask:0xf
  v_dot2c_f32_bf16_dpp v14, v6, v119 row_newbcast:14 row_mask:0xf bank_mask:0xf
  v_dot2c_f32_bf16_dpp v15, v7, v119 row_newbcast:14 row_mask:0xf bank_mask:0xf
  s_waitcnt vmcnt(2)
  buffer_load_dwordx4 v[132:135], v2, s[48:51], s12 offen nt
  s_add_u32 s12, s12, s19
  s_bitset0_b32 s12, 15
  s_cmp_ge_u32 s12, s59
  s_cselect_b32 s12, s58, s12
  v_dot2c_f32_bf16_dpp v8, v6, v120 row_newbcast:1 row_mask:0xf bank_mask:0xf
  v_dot2c_f32_bf16_dpp v9, v7, v120 row_newbcast:1 row_mask:0xf bank_mask:0xf
  v_dot2c_f32_bf16_dpp v10, v6, v121 row_newbcast:1 row_mask:0xf bank_mask:0xf
  v_dot2c_f32_bf16_dpp v11, v7, v121 row_newbcast:1 row_mask:0xf bank_mask:0xf
  v_dot2c_f32_bf16_dpp v12, v6, v122 row_newbcast:1 row_mask:0xf bank_mask:0xf
  v_dot2c_f32_bf16_dpp v13, v7, v122 row_newbcast:1 row_mask:0xf bank_mask:0xf
  v_dot2c_f32_bf16_dpp v14, v6, v123 row_newbcast:1 row_mask:0xf bank_mask:0xf
  v_dot2c_f32_bf16_dpp v15, v7, v123 row_newbcast:1 row_mask:0xf bank_mask:0xf
  s_waitcnt vmcnt(2)
  s_bitcmp0_b32 s68, 0
  s_cbranch_scc1 L_th_35
  s_waitcnt vmcnt(1)
L_th_35:
  buffer_load_dwordx4 v[136:139], v2, s[48:51], s12 offen nt
  s_add_u32 s12, s12, s19
  s_bitset0_b32 s12, 15
  s_cmp_ge_u32 s12, s59
  s_cselect_b32 s12, s58, s12
  v_dot2c_f32_bf16_dpp v8, v6, v124 row_newbcast:9 row_mask:0xf bank_mask:0xf
  v_dot2c_f32_bf16_dpp v9, v7, v124 row_newbcast:9 row_mask:0xf bank_mask:0xf
  v_dot2c_f32_bf16_dpp v10, v6, v125 row_newbcast:9 row_mask:0xf bank_mask:0xf
  v_dot2c_f32_bf16_dpp v11, v7, v125 row_newbcast:9 row_mask:0xf bank_mask:0xf
  v_dot2c_f32_bf16_dpp v12, v6, v126 row_newbcast:9 row_mask:0xf bank_mask:0xf
  v_dot2c_f32_bf16_dpp v13, v7, v126 row_newbcast:9 row_mask:0xf bank_mask:0xf
  v_dot2c_f32_bf16_dpp v14, v6, v127 row_newbcast:9 row_mask:0xf bank_mask:0xf
  v_dot2c_f32_bf16_dpp v15, v7, v127 row_newbcast:9 row_mask:0xf bank_mask:0xf
  s_waitcnt vmcnt(2)
  buffer_load_dwordx4 v[140:143], v2, s[48:51], s12 offen nt
  s_add_u32 s12, s12, s19
  s_bitset0_b32 s12, 15
  s_cmp_ge_u32 s12, s59
  s_cselect_b32 s12, s58, s12
  v_dot2c_f32_bf16_dpp v8, v6, v128 row_newbcast:5 row_mask:0xf bank_mask:0xf
  v_dot2c_f32_bf16_dpp v9, v7, v128 row_newbcast:5 row_mask:0xf bank_mask:0xf
  v_dot2c_f32_bf16_dpp v10, v6, v129 row_newbcast:5 row_mask:0xf bank_mask:0xf
  v_dot2c_f32_bf16_dpp v11, v7, v129 row_newbcast:5 row_mask:0xf bank_mask:0xf
  v_dot2c_f32_bf16_dpp v12, v6, v130 row_newbcast:5 row_mask:0xf bank_mask:0xf
  v_dot2c_f32_bf16_dpp v13, v7, v130 row_newbcast:5 row_mask:0xf bank_mask:0xf
  v_dot2c_f32_bf16_dpp v14, v6, v131 row_newbcast:5 row_mask:0xf bank_mask:0xf
  v_dot2c_f32_bf16_dpp v15, v7, v131 row_newbcast:5 row_mask:0xf bank_mask:0xf
  s_waitcnt vmcnt(2)
  buffer_load_dwordx4 v[144:147], v2, s[48:51], s12 offen nt
  s_add_u32 s12, s12, s19
  s_bitset0_b32 s12, 15
  s_cmp_ge_u32 s12, s59
  s_cselect_b32 s12, s58, s12
  v_dot2c_f32_bf16_dpp v8, v6, v132 row_newbcast:13 row_mask:0xf bank_mask:0xf
  v_dot2c_f32_bf16_dpp v9, v7, v132 row_newbcast:13 row_mask:0xf bank_mask:0xf
  v_dot2c_f32_bf16_dpp v10, v6, v133 row_newbcast:13 row_mask:0xf bank_mask:0xf
  v_dot2c_f32_bf16_dpp v11, v7, v133 row_newbcast:13 row_mask:0xf bank_mask:0xf
  v_dot2c_f32_bf16_dpp v12, v6, v134 row_newbcast:13 row_mask:0xf bank_mask:0xf
  v_dot2c_f32_bf16_dpp v13, v7, v134 row_newbcast:13 row_mask:0xf bank_mask:0xf
  v_dot2c_f32_bf16_dpp v14, v6, v135 row_newbcast:13 row_mask:0xf bank_mask:0xf
  v_dot2c_f32_bf16_dpp v15, v7, v135 row_newbcast:13 row_mask:0xf bank_mask:0xf
  buffer_load_dwordx4 v[148:151], v2, s[48:51], s12 offen nt
  s_add_u32 s12, s12, s19
  s_bitset0_b32 s12, 15
  s_cmp_ge_u32 s12, s59
  s_cselect_b32 s12, s58, s12
  buffer_load_dwordx4 v[152:155], v2, s[48:51], s12 offen nt
  s_add_u32 s12, s12, s19
  s_bitset0_b32 s12, 15
  s_cmp_ge_u32 s12, s59
  s_cselect_b32 s12, s58, s12
  buffer_load_dwordx4 v[156:159], v2, s[48:51], s12 offen nt
  s_add_u32 s12, s12, s19
  s_bitset0_b32 s12, 15
  s_cmp_ge_u32 s12, s59
  s_cselect_b32 s12, s58, s12
  buffer_load_dwordx4 v[160:163], v2, s[48:51], s12 offen nt
  s_add_u32 s12, s12, s19
  s_bitset0_b32 s12, 15
  s_cmp_ge_u32 s12, s59
  s_cselect_b32 s12, s58, s12
  buffer_load_dwordx4 v[164:167], v2, s[48:51], s12 offen nt
  s_mov_b32 s70, 0
L_pl_36:
  ds_read_b32 v18, v16
  s_waitcnt lgkmcnt(0)
  v_cmp_eq_u32 vcc, -1, v18
  s_cmp_eq_u64 vcc, 0
  s_cbranch_scc1 L_pld_37
  s_sleep 2
  s_add_u32 s70, s70, 1
  s_cmp_lt_u32 s70, 1048576
  s_cbranch_scc1 L_pl_36
L_pld_37:
  v_sub_f32 v22, v22, v18
  v_mul_f32 v22, 0x3fb8aa3b, v22
  v_exp_f32 v22, v22
  ds_read_b64 v[18:19], v16 offset:32
  s_lshl_b32 s56, s6, 2
  s_add_u32 s56, s56, s7
  s_lshl_b32 s57, s56, 9
  s_add_u32 s57, s57, 131072
  v_lshl_add_u32 v2, v1, 3, s57
  v_and_b32 v17, 1, v1
  v_lshlrev_b32 v17, 4, v17
  v_lshlrev_b32 v1, 3, v1
  v_mov_b32 v0, 1
  s_movk_i32 s56, 0xff
  s_waitcnt lgkmcnt(0)
  v_readfirstlane_b32 s75, v19
  v_lshrrev_b32 v18, v17, v18
  v_lshrrev_b32 v19, 8, v18
  s_waitcnt vmcnt(7)
  v_dot2c_f32_bf16_dpp v8, v6, v136 row_newbcast:3 row_mask:0xf bank_mask:0xf
  v_dot2c_f32_bf16_dpp v9, v7, v136 row_newbcast:3 row_mask:0xf bank_mask:0xf
  v_dot2c_f32_bf16_dpp v10, v6, v137 row_newbcast:3 row_mask:0xf bank_mask:0xf
  v_dot2c_f32_bf16_dpp v11, v7, v137 row_newbcast:3 row_mask:0xf bank_mask:0xf
  v_dot2c_f32_bf16_dpp v12, v6, v138 row_newbcast:3 row_mask:0xf bank_mask:0xf
  v_dot2c_f32_bf16_dpp v13, v7, v138 row_newbcast:3 row_mask:0xf bank_mask:0xf
  v_dot2c_f32_bf16_dpp v14, v6, v139 row_newbcast:3 row_mask:0xf bank_mask:0xf
  v_dot2c_f32_bf16_dpp v15, v7, v139 row_newbcast:3 row_mask:0xf bank_mask:0xf
  s_waitcnt vmcnt(6)
  v_dot2c_f32_bf16_dpp v8, v6, v140 row_newbcast:11 row_mask:0xf bank_mask:0xf
  v_dot2c_f32_bf16_dpp v9, v7, v140 row_newbcast:11 row_mask:0xf bank_mask:0xf
  v_dot2c_f32_bf16_dpp v10, v6, v141 row_newbcast:11 row_mask:0xf bank_mask:0xf
  v_dot2c_f32_bf16_dpp v11, v7, v141 row_newbcast:11 row_mask:0xf bank_mask:0xf
  v_dot2c_f32_bf16_dpp v12, v6, v142 row_newbcast:11 row_mask:0xf bank_mask:0xf
  v_dot2c_f32_bf16_dpp v13, v7, v142 row_newbcast:11 row_mask:0xf bank_mask:0xf
  v_dot2c_f32_bf16_dpp v14, v6, v143 row_newbcast:11 row_mask:0xf bank_mask:0xf
  v_dot2c_f32_bf16_dpp v15, v7, v143 row_newbcast:11 row_mask:0xf bank_mask:0xf
  s_waitcnt vmcnt(5)
  v_dot2c_f32_bf16_dpp v8, v6, v144 row_newbcast:7 row_mask:0xf bank_mask:0xf
  v_dot2c_f32_bf16_dpp v9, v7, v144 row_newbcast:7 row_mask:0xf bank_mask:0xf
  v_dot2c_f32_bf16_dpp v10, v6, v145 row_newbcast:7 row_mask:0xf bank_mask:0xf
  v_dot2c_f32_bf16_dpp v11, v7, v145 row_newbcast:7 row_mask:0xf bank_mask:0xf
  v_dot2c_f32_bf16_dpp v12, v6, v146 row_newbcast:7 row_mask:0xf bank_mask:0xf
  v_dot2c_f32_bf16_dpp v13, v7, v146 row_newbcast:7 row_mask:0xf bank_mask:0xf
  v_dot2c_f32_bf16_dpp v14, v6, v147 row_newbcast:7 row_mask:0xf bank_mask:0xf
  v_dot2c_f32_bf16_dpp v15, v7, v147 row_newbcast:7 row_mask:0xf bank_mask:0xf
  s_waitcnt vmcnt(4)
  v_dot2c_f32_bf16_dpp v8, v6, v148 row_newbcast:15 row_mask:0xf bank_mask:0xf
  v_dot2c_f32_bf16_dpp v9, v7, v148 row_newbcast:15 row_mask:0xf bank_mask:0xf
  v_dot2c_f32_bf16_dpp v10, v6, v149 row_newbcast:15 row_mask:0xf bank_mask:0xf
  v_dot2c_f32_bf16_dpp v11, v7, v149 row_newbcast:15 row_mask:0xf bank_mask:0xf
  v_dot2c_f32_bf16_dpp v12, v6, v150 row_newbcast:15 row_mask:0xf bank_mask:0xf
  v_dot2c_f32_bf16_dpp v13, v7, v150 row_newbcast:15 row_mask:0xf bank_mask:0xf
  v_dot2c_f32_bf16_dpp v14, v6, v151 row_newbcast:15 row_mask:0xf bank_mask:0xf
  v_dot2c_f32_bf16_dpp v15, v7, v151 row_newbcast:15 row_mask:0xf bank_mask:0xf
  s_waitcnt vmcnt(3)
  v_dot2c_f32_bf16_dpp v8, v20, v152 row_newbcast:0 row_mask:0xf bank_mask:0xf
  v_dot2c_f32_bf16_dpp v9, v21, v152 row_newbcast:0 row_mask:0xf bank_mask:0xf
  v_dot2c_f32_bf16_dpp v10, v20, v153 row_newbcast:0 row_mask:0xf bank_mask:0xf
  v_dot2c_f32_bf16_dpp v11, v21, v153 row_newbcast:0 row_mask:0xf bank_mask:0xf
  v_dot2c_f32_bf16_dpp v12, v20, v154 row_newbcast:0 row_mask:0xf bank_mask:0xf
  v_dot2c_f32_bf16_dpp v13, v21, v154 row_newbcast:0 row_mask:0xf bank_mask:0xf
  v_dot2c_f32_bf16_dpp v14, v20, v155 row_newbcast:0 row_mask:0xf bank_mask:0xf
  v_dot2c_f32_bf16_dpp v15, v21, v155 row_newbcast:0 row_mask:0xf bank_mask:0xf
  s_waitcnt vmcnt(2)
  v_dot2c_f32_bf16_dpp v8, v20, v156 row_newbcast:8 row_mask:0xf bank_mask:0xf
  v_dot2c_f32_bf16_dpp v9, v21, v156 row_newbcast:8 row_mask:0xf bank_mask:0xf
  v_dot2c_f32_bf16_dpp v10, v20, v157 row_newbcast:8 row_mask:0xf bank_mask:0xf
  v_dot2c_f32_bf16_dpp v11, v21, v157 row_newbcast:8 row_mask:0xf bank_mask:0xf
  v_dot2c_f32_bf16_dpp v12, v20, v158 row_newbcast:8 row_mask:0xf bank_mask:0xf
  v_dot2c_f32_bf16_dpp v13, v21, v158 row_newbcast:8 row_mask:0xf bank_mask:0xf
  v_dot2c_f32_bf16_dpp v14, v20, v159 row_newbcast:8 row_mask:0xf bank_mask:0xf
  v_dot2c_f32_bf16_dpp v15, v21, v159 row_newbcast:8 row_mask:0xf bank_mask:0xf
  s_waitcnt vmcnt(1)
  v_dot2c_f32_bf16_dpp v8, v20, v160 row_newbcast:4 row_mask:0xf bank_mask:0xf
  v_dot2c_f32_bf16_dpp v9, v21, v160 row_newbcast:4 row_mask:0xf bank_mask:0xf
  v_dot2c_f32_bf16_dpp v10, v20, v161 row_newbcast:4 row_mask:0xf bank_mask:0xf
  v_dot2c_f32_bf16_dpp v11, v21, v161 row_newbcast:4 row_mask:0xf bank_mask:0xf
  v_dot2c_f32_bf16_dpp v12, v20, v162 row_newbcast:4 row_mask:0xf bank_mask:0xf
  v_dot2c_f32_bf16_dpp v13, v21, v162 row_newbcast:4 row_mask:0xf bank_mask:0xf
  v_dot2c_f32_bf16_dpp v14, v20, v163 row_newbcast:4 row_mask:0xf bank_mask:0xf
  v_dot2c_f32_bf16_dpp v15, v21, v163 row_newbcast:4 row_mask:0xf bank_mask:0xf
  s_waitcnt vmcnt(0)
  v_dot2c_f32_bf16_dpp v8, v20, v164 row_newbcast:12 row_mask:0xf bank_mask:0xf
  v_dot2c_f32_bf16_dpp v9, v21, v164 row_newbcast:12 row_mask:0xf bank_mask:0xf
  v_dot2c_f32_bf16_dpp v10, v20, v165 row_newbcast:12 row_mask:0xf bank_mask:0xf
  v_dot2c_f32_bf16_dpp v11, v21, v165 row_newbcast:12 row_mask:0xf bank_mask:0xf
  v_dot2c_f32_bf16_dpp v12, v20, v166 row_newbcast:12 row_mask:0xf bank_mask:0xf
  v_dot2c_f32_bf16_dpp v13, v21, v166 row_newbcast:12 row_mask:0xf bank_mask:0xf
  v_dot2c_f32_bf16_dpp v14, v20, v167 row_newbcast:12 row_mask:0xf bank_mask:0xf
  v_dot2c_f32_bf16_dpp v15, v21, v167 row_newbcast:12 row_mask:0xf bank_mask:0xf
  s_nop 2
  v_permlane32_swap_b32 v8, v12
  v_permlane32_swap_b32 v9, v13
  v_permlane32_swap_b32 v10, v14
  v_permlane32_swap_b32 v11, v15
  v_add_f32 v8, v8, v12
  v_add_f32 v9, v9, v13
  v_add_f32 v10, v10, v14
  v_add_f32 v11, v11, v15
  s_nop 0
  v_permlane16_swap_b32 v8, v10
  v_permlane16_swap_b32 v9, v11
  v_add_f32 v8, v8, v10
  v_add_f32 v9, v9, v11
  v_mul_f32 v8, v8, v22
  v_mul_f32 v9, v9, v22
  ds_write_b64 v3, v[8:9] offset:6912
  s_mov_b64 exec, 1
  ds_add_rtn_u32 v17, v16, v0 offset:68
  s_mov_b64 exec, -1
  ds_read_b64 v[56:57], v1 offset:6912
  ds_read_b64 v[58:59], v1 offset:7424
  ds_read_b64 v[60:61], v1 offset:7936
  ds_read_b64 v[62:63], v1 offset:8448
  ds_read_b64 v[64:65], v1 offset:8960
  ds_read_b64 v[66:67], v1 offset:9472
  ds_read_b64 v[68:69], v1 offset:9984
  ds_read_b64 v[70:71], v1 offset:10496
  s_waitcnt lgkmcnt(6)
  v_readfirstlane_b32 s57, v17
  v_pk_add_f32 v[56:57], v[56:57], v[58:59]
  s_waitcnt lgkmcnt(4)
  v_pk_add_f32 v[60:61], v[60:61], v[62:63]
  s_waitcnt lgkmcnt(2)
  v_pk_add_f32 v[64:65], v[64:65], v[66:67]
  s_waitcnt lgkmcnt(0)
  v_pk_add_f32 v[68:69], v[68:69], v[70:71]
  v_pk_add_f32 v[56:57], v[56:57], v[60:61]
  v_pk_add_f32 v[64:65], v[64:65], v[68:69]
  s_cmp_lg_u32 s57, 7
  v_pk_add_f32 v[56:57], v[56:57], v[64:65]
  v_bfi_b32 v18, s56, v18, v56
  v_bfi_b32 v19, s56, v19, v57
  s_cbranch_scc1 L_send
  s_cmp_eq_u32 s75, 1
  s_cbranch_scc0 L_pf_38
  global_store_dwordx2 v2, v[18:19], s[42:43]
  s_branch L_pe_39
L_pf_38:
  global_store_dwordx2 v2, v[18:19], s[42:43] sc1
L_pe_39:
L_send:
  s_barrier
  s_endpgm
L_helper:
  v_mov_b32 v4, -1
  v_mov_b32 v5, -1
  v_mov_b32 v6, -1
  v_mov_b32 v7, -1
  v_lshlrev_b32 v2, 4, v0
  ds_write_b128 v2, v[4:7] offset:12032
  ds_write_b128 v2, v[4:7] offset:16128
  v_lshlrev_b32 v2, 2, v1
  ds_write_b32 v2, v4 offset:6400
  v_mov_b32 v38, 0
  ds_write_b128 v38, v[4:7] offset:6656
  ds_write_b128 v38, v[4:7] offset:6672
  v_mov_b32 v39, 0
  ds_write_b64 v38, v[38:39] offset:6720
  s_waitcnt lgkmcnt(0)
  s_barrier
  s_getpc_b64 s[56:57]
L_pc2:
  s_lshl_b32 s3, s2, 2
  s_add_u32 s3, s3, L_table-L_pc2
  s_load_dwordx16 s[16:31], s[0:1], 0
  s_load_dword s14, s[56:57], s3
  s_load_dwordx8 s[32:39], s[0:1], 64
  s_load_dwordx4 s[40:43], s[0:1], 96
  s_and_b32 s8, s2, 7
  s_mov_b64 s[100:101], s[56:57]
  s_mov_b32 s72, 0xfffffffe
  s_mov_b32 s73, 0xffff0000
  s_getreg_b32 s76, hwreg(HW_REG_XCC_ID, 0, 4)
  v_lshrrev_b32 v12, 3, v0
  v_lshlrev_b32 v12, 5, v12
  v_bfe_u32 v3, v1, 2, 1
  v_lshl_add_u32 v12, v3, 10, v12
  v_and_b32 v8, 3, v1
  v_lshl_add_u32 v13, v8, 3, v12
  v_and_b32 v12, 0xffffffdf, v12
  v_lshl_add_u32 v12, v8, 4, v12
  v_bfe_u32 v8, v1, 3, 1
  v_lshl_add_u32 v12, v8, 3, v12
  v_lshl_add_u32 v12, v3, 5, v12
  s_waitcnt lgkmcnt(0)
  s_load_dword s74, s[42:43], 0
  s_and_b32 s13, s14, 7
  s_bfe_u32 s61, s14, 0x60003
  s_cmp_eq_u32 s13, 6
  s_cbranch_scc1 L_r_q
  s_cmp_ge_u32 s13, 4
  s_cbranch_scc1 L_r_moda
  s_cmp_eq_u32 s13, 1
  s_cbranch_scc1 L_r_wo
  s_lshr_b32 s48, s14, 30
  s_cmp_eq_u32 s48, 0
  s_cbranch_scc1 L_noas
  s_bfe_u32 s49, s14, 0x1001a
  s_lshl_b32 s49, s49, 2
  s_add_u32 s49, s49, s5
  s_lshl_b32 s50, s49, 6
  s_lshr_b32 s51, s49, 1
  s_lshl_b32 s51, s51, 4
  s_and_b32 s49, s49, 1
  s_add_u32 s51, s51, s49
  s_lshl_b32 s49, s8, 1
  s_add_u32 s51, s51, s49
  s_lshl_b32 s51, s51, 6
  s_movk_i32 s52, 6144
  s_mov_b64 s[54:55], s[36:37]
  s_cmp_eq_u32 s48, 1
  s_cselect_b32 s52, 0x2000, s52
  s_cselect_b64 s[54:55], s[22:23], s[54:55]
  s_cmp_eq_u32 s48, 2
  s_cselect_b32 s52, 0x400, s52
  s_cselect_b64 s[54:55], s[24:25], s[54:55]
  s_cselect_b32 s50, s51, s50
  s_bfe_u32 s49, s14, 0x3001b
  s_lshl_b32 s49, s49, 10
  s_add_u32 s49, s49, 384
  v_max_u32 v2, 24, v1
  v_add_u32 v2, s50, v2
  v_mul_u32_u24 v2, s52, v2
  v_add_u32 v2, s49, v2
  global_load_dword v167, v2, s[54:55]
L_noas:
  s_cmp_eq_u32 s13, 2
  s_cbranch_scc1 L_r_f1
  s_cmp_eq_u32 s13, 3
  s_cbranch_scc1 L_r_f2
  s_branch L_r_none
L_r_moda:
  s_lshl_b32 s58, s61, 9
  s_add_u32 s58, s58, 4096
  global_load_dwordx2 v[14:15], v13, s[34:35]
  s_waitcnt lgkmcnt(0)
  s_mul_i32 s74, s74, 0x9e3779b1
  s_add_u32 s74, s74, 0x7f4a7c15
  s_add_u32 s76, s76, s74
  s_waitcnt vmcnt(0)
  v_lshlrev_b32 v16, 16, v14
  v_and_b32 v17, s73, v14
  v_lshlrev_b32 v18, 16, v15
  v_and_b32 v19, s73, v15
  v_mul_f32 v20, 0xbfb8aa3b, v16
  v_mul_f32 v21, 0xbfb8aa3b, v17
  v_mul_f32 v22, 0xbfb8aa3b, v18
  v_mul_f32 v23, 0xbfb8aa3b, v19
  v_exp_f32 v20, v20
  v_exp_f32 v21, v21
  v_exp_f32 v22, v22
  v_exp_f32 v23, v23
  s_nop 0
  v_add_f32 v20, 1.0, v20
  v_add_f32 v21, 1.0, v21
  v_add_f32 v22, 1.0, v22
  v_add_f32 v23, 1.0, v23
  v_rcp_f32 v20, v20
  v_rcp_f32 v21, v21
  v_rcp_f32 v22, v22
  v_rcp_f32 v23, v23
  s_nop 0
  v_mul_f32 v16, v16, v20
  v_mul_f32 v17, v17, v21
  v_mul_f32 v18, v18, v22
  v_mul_f32 v19, v19, v23
  v_cvt_pk_bf16_f32 v14, v16, v17
  v_cvt_pk_bf16_f32 v15, v18, v19
  ds_write_b64 v12, v[14:15] offset:0
  v_and_b32 v13, 1, v1
  v_lshlrev_b32 v13, 6, v13
  v_lshrrev_b32 v3, 4, v1
  v_lshl_add_u32 v13, v3, 4, v13
  s_lshl_b32 s49, s5, 7
  s_add_u32 s49, s49, s58
  v_add_u32 v13, s49, v13
  v_and_b32 v14, 1, v1
  v_mul_u32_u24 v14, 1056, v14
  v_lshrrev_b32 v3, 4, v1
  v_lshl_add_u32 v14, v3, 4, v14
  v_lshrrev_b32 v2, 2, v1
  v_bfe_u32 v3, v1, 1, 1
  s_lshl_b32 s49, s5, 1
  v_or_b32 v3, s49, v3
  v_and_b32 v10, 6, v2
  v_xor_b32 v3, v3, v10
  v_lshlrev_b32 v2, 7, v2
  v_lshl_add_u32 v2, v3, 4, v2
  v_and_b32 v3, 1, v1
  v_lshl_add_u32 v2, v3, 3, v2
  v_add_u32 v2, 20480, v2
  s_waitcnt lgkmcnt(0)
  v_mov_b32 v9, 1
  s_mov_b64 exec, 1
  ds_add_u32 v38, v9 offset:6720
  s_mov_b64 exec, -1
  s_mov_b32 s70, 0
L_hs_40:
  ds_read_b32 v9, v38 offset:6720
  s_waitcnt lgkmcnt(0)
  v_cmp_gt_u32 vcc, 12, v9
  s_cmp_eq_u64 vcc, 0
  s_cbranch_scc1 L_hsd_41
  s_sleep 2
  s_add_u32 s70, s70, 1
  s_cmp_lt_u32 s70, 2097152
  s_cbranch_scc1 L_hs_40
L_hsd_41:
  ds_read_b64_tr_b16 v[40:41], v2 offset:0
  ds_read_b64_tr_b16 v[42:43], v2 offset:2048
  ds_read_b128 v[104:107], v14 offset:0
  ds_read_b64_tr_b16 v[44:45], v2 offset:4096
  ds_read_b64_tr_b16 v[46:47], v2 offset:6144
  ds_read_b128 v[108:111], v14 offset:64
  ds_read_b64_tr_b16 v[48:49], v2 offset:8192
  ds_read_b64_tr_b16 v[50:51], v2 offset:10240
  ds_read_b128 v[112:115], v14 offset:128
  ds_read_b64_tr_b16 v[52:53], v2 offset:12288
  ds_read_b64_tr_b16 v[54:55], v2 offset:14336
  ds_read_b128 v[116:119], v14 offset:192
  ds_read_b64_tr_b16 v[56:57], v2 offset:16384
  ds_read_b64_tr_b16 v[58:59], v2 offset:18432
  ds_read_b128 v[120:123], v14 offset:256
  s_waitcnt lgkmcnt(12)
  v_mfma_f32_16x16x32_bf16 v[8:11], v[40:43], v[104:107], 0
  ds_read_b64_tr_b16 v[60:61], v2 offset:20480
  ds_read_b64_tr_b16 v[62:63], v2 offset:22528
  ds_read_b128 v[124:127], v14 offset:320
  s_waitcnt lgkmcnt(12)
  v_mfma_f32_16x16x32_bf16 v[8:11], v[44:47], v[108:111], v[8:11]
  ds_read_b64_tr_b16 v[64:65], v2 offset:24576
  ds_read_b64_tr_b16 v[66:67], v2 offset:26624
  ds_read_b128 v[128:131], v14 offset:384
  s_waitcnt lgkmcnt(12)
  v_mfma_f32_16x16x32_bf16 v[8:11], v[48:51], v[112:115], v[8:11]
  ds_read_b64_tr_b16 v[68:69], v2 offset:28672
  ds_read_b64_tr_b16 v[70:71], v2 offset:30720
  ds_read_b128 v[132:135], v14 offset:448
  s_waitcnt lgkmcnt(12)
  v_mfma_f32_16x16x32_bf16 v[8:11], v[52:55], v[116:119], v[8:11]
  ds_read_b64_tr_b16 v[72:73], v2 offset:32768
  ds_read_b64_tr_b16 v[74:75], v2 offset:34816
  ds_read_b128 v[136:139], v14 offset:512
  s_waitcnt lgkmcnt(12)
  v_mfma_f32_16x16x32_bf16 v[8:11], v[56:59], v[120:123], v[8:11]
  ds_read_b64_tr_b16 v[76:77], v2 offset:36864
  ds_read_b64_tr_b16 v[78:79], v2 offset:38912
  ds_read_b128 v[140:143], v14 offset:576
  s_waitcnt lgkmcnt(12)
  v_mfma_f32_16x16x32_bf16 v[8:11], v[60:63], v[124:127], v[8:11]
  ds_read_b64_tr_b16 v[80:81], v2 offset:40960
  ds_read_b64_tr_b16 v[82:83], v2 offset:43008
  ds_read_b128 v[144:147], v14 offset:640
  s_waitcnt lgkmcnt(12)
  v_mfma_f32_16x16x32_bf16 v[8:11], v[64:67], v[128:131], v[8:11]
  ds_read_b64_tr_b16 v[84:85], v2 offset:45056
  ds_read_b64_tr_b16 v[86:87], v2 offset:47104
  ds_read_b128 v[148:151], v14 offset:704
  s_waitcnt lgkmcnt(12)
  v_mfma_f32_16x16x32_bf16 v[8:11], v[68:71], v[132:135], v[8:11]
  ds_read_b64_tr_b16 v[88:89], v2 offset:49152
  ds_read_b64_tr_b16 v[90:91], v2 offset:51200
  ds_read_b128 v[152:155], v14 offset:768
  s_waitcnt lgkmcnt(12)
  v_mfma_f32_16x16x32_bf16 v[8:11], v[72:75], v[136:139], v[8:11]
  ds_read_b64_tr_b16 v[92:93], v2 offset:53248
  ds_read_b64_tr_b16 v[94:95], v2 offset:55296
  ds_read_b128 v[156:159], v14 offset:832
  s_waitcnt lgkmcnt(12)
  v_mfma_f32_16x16x32_bf16 v[8:11], v[76:79], v[140:143], v[8:11]
  ds_read_b64_tr_b16 v[96:97], v2 offset:57344
  ds_read_b64_tr_b16 v[98:99], v2 offset:59392
  ds_read_b128 v[160:163], v14 offset:896
  s_waitcnt lgkmcnt(12)
  v_mfma_f32_16x16x32_bf16 v[8:11], v[80:83], v[144:147], v[8:11]
  ds_read_b64_tr_b16 v[100:101], v2 offset:61440
  ds_read_b64_tr_b16 v[102:103], v2 offset:63488
  ds_read_b128 v[164:167], v14 offset:960
  s_waitcnt lgkmcnt(12)
  v_mfma_f32_16x16x32_bf16 v[8:11], v[84:87], v[148:151], v[8:11]
  s_waitcnt lgkmcnt(9)
  v_mfma_f32_16x16x32_bf16 v[8:11], v[88:91], v[152:155], v[8:11]
  s_waitcnt lgkmcnt(6)
  v_mfma_f32_16x16x32_bf16 v[8:11], v[92:95], v[156:159], v[8:11]
  s_waitcnt lgkmcnt(3)
  v_mfma_f32_16x16x32_bf16 v[8:11], v[96:99], v[160:163], v[8:11]
  s_waitcnt lgkmcnt(0)
  v_mfma_f32_16x16x32_bf16 v[8:11], v[100:103], v[164:167], v[8:11]
  s_nop 7
  v_cvt_pk_bf16_f32 v8, v8, v9
  v_cvt_pk_bf16_f32 v10, v10, v11
  v_mov_b32 v9, s74
  v_mov_b32 v11, s74
  s_mov_b32 exec_lo, 0x00030003
  s_mov_b32 exec_hi, 0x00030003
  global_store_dwordx4 v13, v[8:11], s[42:43] sc1
  s_mov_b64 exec, -1
  s_mov_b32 s60, 0
  s_branch L_svc1
L_r_q:
  s_lshl_b32 s58, s61, 9
  s_add_u32 s58, s58, 32768
  global_load_dwordx2 v[14:15], v13, s[16:17]
  s_waitcnt lgkmcnt(0)
  s_mul_i32 s74, s74, 0x9e3779b1
  s_add_u32 s74, s74, 0x7f4a7c15
  s_add_u32 s76, s76, s74
  s_waitcnt vmcnt(0)
  v_bfe_u32 v6, v1, 2, 1
  v_lshlrev_b32 v6, 5, v6
  v_add_u32 v6, 11008, v6
  s_lshl_b32 s49, s5, 3
  v_add_u32 v5, s49, v6
  v_lshlrev_b32 v20, 16, v14
  v_and_b32 v21, s73, v14
  v_lshlrev_b32 v22, 16, v15
  v_and_b32 v23, s73, v15
  v_add_f32 v8, v20, v21
  v_mul_f32 v9, v20, v20
  v_add_f32 v10, v22, v23
  v_mul_f32 v11, v22, v22
  v_fmac_f32 v9, v21, v21
  v_fmac_f32 v11, v23, v23
  v_add_f32 v8, v8, v10
  v_add_f32 v9, v9, v11
  s_nop 0
  v_add_f32_dpp v8, v8, v8 quad_perm:[1,0,3,2] row_mask:0xf bank_mask:0xf
  v_add_f32_dpp v9, v9, v9 quad_perm:[1,0,3,2] row_mask:0xf bank_mask:0xf
  s_nop 0
  v_add_f32_dpp v8, v8, v8 quad_perm:[2,3,0,1] row_mask:0xf bank_mask:0xf
  v_add_f32_dpp v9, v9, v9 quad_perm:[2,3,0,1] row_mask:0xf bank_mask:0xf
  s_nop 0
  v_add_f32_dpp v8, v8, v8 row_ror:8 row_mask:0xf bank_mask:0xf
  v_add_f32_dpp v9, v9, v9 row_ror:8 row_mask:0xf bank_mask:0xf
  s_nop 0
  v_mov_b32 v10, v8
  v_mov_b32 v11, v9
  s_nop 0
  v_permlane16_swap_b32 v10, v8
  v_permlane16_swap_b32 v11, v9
  v_add_f32 v8, v8, v10
  v_add_f32 v9, v9, v11
  v_mov_b32 v10, v8
  v_mov_b32 v11, v9
  s_nop 0
  v_permlane32_swap_b32 v10, v8
  v_permlane32_swap_b32 v11, v9
  v_add_f32 v8, v8, v10
  v_add_f32 v9, v9, v11
  ds_write_b64 v5, v[8:9]
  s_waitcnt lgkmcnt(0)
  v_mov_b32 v9, 1
  s_mov_b64 exec, 1
  ds_add_u32 v38, v9 offset:6720
  s_mov_b64 exec, -1
  s_mov_b32 s70, 0
L_hs_42:
  ds_read_b32 v9, v38 offset:6720
  s_waitcnt lgkmcnt(0)
  v_cmp_gt_u32 vcc, 12, v9
  s_cmp_eq_u64 vcc, 0
  s_cbranch_scc1 L_hsd_43
  s_sleep 4
  s_add_u32 s70, s70, 1
  s_cmp_lt_u32 s70, 2097152
  s_cbranch_scc1 L_hs_42
L_hsd_43:
  ds_read_b128 v[24:27], v6
  ds_read_b128 v[28:31], v6 offset:16
  s_waitcnt lgkmcnt(0)
  v_pk_add_f32 v[24:25], v[24:25], v[26:27]
  v_pk_add_f32 v[28:29], v[28:29], v[30:31]
  v_pk_add_f32 v[24:25], v[24:25], v[28:29]
  v_mul_f32 v8, 0x3b000000, v24
  v_mul_f32 v9, 0x3b000000, v25
  v_fma_f32 v9, -v8, v8, v9
  v_cvt_pk_bf16_f32 v8, 0, v8
  v_max_f32 v9, 0, v9
  v_cvt_pk_bf16_f32 v9, 0, v9
  v_sub_f32 v20, v20, v8
  v_sub_f32 v21, v21, v8
  v_add_f32 v9, 0x3727c5ac, v9
  v_sub_f32 v22, v22, v8
  v_sub_f32 v23, v23, v8
  v_cvt_pk_bf16_f32 v9, 0, v9
  v_cvt_pk_bf16_f32 v20, 0, v20
  v_sqrt_f32 v9, v9
  v_cvt_pk_bf16_f32 v21, 0, v21
  v_cvt_pk_bf16_f32 v9, 0, v9
  v_cvt_pk_bf16_f32 v22, 0, v22
  v_rcp_f32 v9, v9
  v_cvt_pk_bf16_f32 v23, 0, v23
  v_mul_f32 v20, v20, v9
  v_mul_f32 v21, v21, v9
  v_mul_f32 v22, v22, v9
  v_mul_f32 v23, v23, v9
  v_cvt_pk_bf16_f32 v20, 0, v20
  v_cvt_pk_bf16_f32 v21, 0, v21
  v_cvt_pk_bf16_f32 v22, 0, v22
  v_cvt_pk_bf16_f32 v23, 0, v23
  v_lshrrev_b32 v2, 2, v1
  v_bfe_u32 v3, v1, 1, 1
  s_lshl_b32 s49, s5, 1
  v_or_b32 v3, s49, v3
  v_and_b32 v10, 6, v2
  v_xor_b32 v3, v3, v10
  v_lshlrev_b32 v2, 7, v2
  v_lshl_add_u32 v2, v3, 4, v2
  v_and_b32 v3, 1, v1
  v_lshl_add_u32 v2, v3, 3, v2
  v_add_u32 v2, 20480, v2
  ds_read_b64_tr_b16 v[40:41], v2 offset:0
  ds_read_b64_tr_b16 v[42:43], v2 offset:2048
  ds_read_b64_tr_b16 v[44:45], v2 offset:4096
  ds_read_b64_tr_b16 v[46:47], v2 offset:6144
  ds_read_b64_tr_b16 v[48:49], v2 offset:8192
  ds_read_b64_tr_b16 v[50:51], v2 offset:10240
  ds_read_b64_tr_b16 v[52:53], v2 offset:12288
  ds_read_b64_tr_b16 v[54:55], v2 offset:14336
  ds_read_b64_tr_b16 v[56:57], v2 offset:16384
  ds_read_b64_tr_b16 v[58:59], v2 offset:18432
  ds_read_b64_tr_b16 v[60:61], v2 offset:20480
  ds_read_b64_tr_b16 v[62:63], v2 offset:22528
  s_waitcnt lgkmcnt(10)
  ds_read_b64_tr_b16 v[64:65], v2 offset:24576
  ds_read_b64_tr_b16 v[66:67], v2 offset:26624
  s_waitcnt lgkmcnt(10)
  ds_read_b64_tr_b16 v[68:69], v2 offset:28672
  ds_read_b64_tr_b16 v[70:71], v2 offset:30720
  s_waitcnt lgkmcnt(10)
  ds_read_b64_tr_b16 v[72:73], v2 offset:32768
  ds_read_b64_tr_b16 v[74:75], v2 offset:34816
  s_waitcnt lgkmcnt(10)
  ds_read_b64_tr_b16 v[76:77], v2 offset:36864
  ds_read_b64_tr_b16 v[78:79], v2 offset:38912
  s_waitcnt lgkmcnt(10)
  ds_read_b64_tr_b16 v[80:81], v2 offset:40960
  ds_read_b64_tr_b16 v[82:83], v2 offset:43008
  s_waitcnt lgkmcnt(10)
  ds_read_b64_tr_b16 v[84:85], v2 offset:45056
  ds_read_b64_tr_b16 v[86:87], v2 offset:47104
  s_waitcnt lgkmcnt(10)
  ds_read_b64_tr_b16 v[88:89], v2 offset:49152
  ds_read_b64_tr_b16 v[90:91], v2 offset:51200
  s_waitcnt lgkmcnt(10)
  ds_read_b64_tr_b16 v[92:93], v2 offset:53248
  ds_read_b64_tr_b16 v[94:95], v2 offset:55296
  s_waitcnt lgkmcnt(10)
  ds_read_b64_tr_b16 v[96:97], v2 offset:57344
  ds_read_b64_tr_b16 v[98:99], v2 offset:59392
  s_waitcnt lgkmcnt(10)
  ds_read_b64_tr_b16 v[100:101], v2 offset:61440
  ds_read_b64_tr_b16 v[102:103], v2 offset:63488
  s_waitcnt lgkmcnt(10)
  s_waitcnt lgkmcnt(0)
  v_and_b32 v13, 1, v1
  v_lshlrev_b32 v13, 6, v13
  v_lshrrev_b32 v3, 4, v1
  v_lshl_add_u32 v13, v3, 4, v13
  s_lshl_b32 s49, s5, 7
  s_add_u32 s49, s49, s58
  v_add_u32 v13, s49, v13
  v_and_b32 v14, 1, v1
  v_mul_u32_u24 v14, 1056, v14
  v_lshrrev_b32 v3, 4, v1
  v_lshl_add_u32 v14, v3, 4, v14
  v_lshlrev_b32 v15, 4, v0
  v_add_u32 v15, 4096, v15
  v_add_u32 v36, 0x1000, v15
  s_mov_b32 s70, 0
L_pl_44:
  ds_read_b32 v8, v38 offset:6672
  s_waitcnt lgkmcnt(0)
  v_cmp_eq_u32 vcc, -1, v8
  s_cmp_eq_u64 vcc, 0
  s_cbranch_scc1 L_pld_45
  s_sleep 8
  s_add_u32 s70, s70, 1
  s_cmp_lt_u32 s70, 1048576
  s_cbranch_scc1 L_pl_44
L_pld_45:
  s_mov_b64 s[64:65], -1
  s_mov_b64 s[66:67], -1
  s_mov_b32 s70, 0
L_q_p:
  s_mov_b64 exec, s[64:65]
  global_load_dwordx4 v[16:19], v15, s[42:43] sc1
  s_mov_b64 exec, s[66:67]
  global_load_dwordx4 v[32:35], v36, s[42:43] sc1
  s_mov_b64 exec, -1
  s_waitcnt vmcnt(0)
  v_cmp_ne_u32 s[64:65], s74, v17
  v_cmp_ne_u32 s[68:69], s74, v19
  s_or_b64 s[64:65], s[64:65], s[68:69]
  v_cmp_ne_u32 s[66:67], s74, v33
  v_cmp_ne_u32 s[68:69], s74, v35
  s_or_b64 s[66:67], s[66:67], s[68:69]
  s_or_b64 vcc, s[64:65], s[66:67]
  s_cmp_eq_u64 vcc, 0
  s_cbranch_scc1 L_q_ok
  s_add_u32 s70, s70, 1
  s_cmp_lt_u32 s70, 262144
  s_cbranch_scc1 L_q_p
L_q_ok:
  v_lshlrev_b32 v28, 16, v32
  v_and_b32 v29, s73, v32
  v_lshlrev_b32 v30, 16, v34
  v_and_b32 v31, s73, v34
  v_lshlrev_b32 v24, 16, v16
  v_and_b32 v25, s73, v16
  v_lshlrev_b32 v26, 16, v18
  v_and_b32 v27, s73, v18
  v_add_f32 v28, 1.0, v28
  v_add_f32 v29, 1.0, v29
  v_add_f32 v30, 1.0, v30
  v_add_f32 v31, 1.0, v31
  v_cvt_pk_bf16_f32 v28, 0, v28
  v_cvt_pk_bf16_f32 v29, 0, v29
  v_cvt_pk_bf16_f32 v30, 0, v30
  v_cvt_pk_bf16_f32 v31, 0, v31
  v_mul_f32 v20, v20, v28
  v_mul_f32 v21, v21, v29
  v_mul_f32 v22, v22, v30
  v_mul_f32 v23, v23, v31
  v_cvt_pk_bf16_f32 v20, 0, v20
  v_cvt_pk_bf16_f32 v21, 0, v21
  v_cvt_pk_bf16_f32 v22, 0, v22
  v_cvt_pk_bf16_f32 v23, 0, v23
  v_add_f32 v20, v20, v24
  v_add_f32 v21, v21, v25
  v_add_f32 v22, v22, v26
  v_add_f32 v23, v23, v27
  v_cvt_pk_bf16_f32 v16, v20, v21
  v_cvt_pk_bf16_f32 v17, v22, v23
  ds_write_b64 v12, v[16:17] offset:0
  v_mov_b32 v9, 1
  s_mov_b64 exec, 1
  ds_add_u32 v38, v9 offset:6720
  s_mov_b64 exec, -1
  s_mov_b32 s70, 0
L_hs_46:
  ds_read_b32 v9, v38 offset:6720
  s_waitcnt lgkmcnt(0)
  v_cmp_gt_u32 vcc, 16, v9
  s_cmp_eq_u64 vcc, 0
  s_cbranch_scc1 L_hsd_47
  s_add_u32 s70, s70, 1
  s_cmp_lt_u32 s70, 2097152
  s_cbranch_scc1 L_hs_46
L_hsd_47:
  ds_read_b128 v[104:107], v14 offset:0
  ds_read_b128 v[108:111], v14 offset:64
  ds_read_b128 v[112:115], v14 offset:128
  ds_read_b128 v[116:119], v14 offset:192
  ds_read_b128 v[120:123], v14 offset:256
  ds_read_b128 v[124:127], v14 offset:320
  ds_read_b128 v[128:131], v14 offset:384
  ds_read_b128 v[132:135], v14 offset:448
  ds_read_b128 v[136:139], v14 offset:512
  ds_read_b128 v[140:143], v14 offset:576
  ds_read_b128 v[144:147], v14 offset:640
  ds_read_b128 v[148:151], v14 offset:704
  s_waitcnt lgkmcnt(11)
  v_mfma_f32_16x16x32_bf16 v[8:11], v[40:43], v[104:107], 0
  ds_read_b128 v[152:155], v14 offset:768
  s_waitcnt lgkmcnt(11)
  v_mfma_f32_16x16x32_bf16 v[8:11], v[44:47], v[108:111], v[8:11]
  ds_read_b128 v[156:159], v14 offset:832
  s_waitcnt lgkmcnt(11)
  v_mfma_f32_16x16x32_bf16 v[8:11], v[48:51], v[112:115], v[8:11]
  ds_read_b128 v[160:163], v14 offset:896
  s_waitcnt lgkmcnt(11)
  v_mfma_f32_16x16x32_bf16 v[8:11], v[52:55], v[116:119], v[8:11]
  ds_read_b128 v[164:167], v14 offset:960
  s_waitcnt lgkmcnt(11)
  v_mfma_f32_16x16x32_bf16 v[8:11], v[56:59], v[120:123], v[8:11]
  s_waitcnt lgkmcnt(10)
  v_mfma_f32_16x16x32_bf16 v[8:11], v[60:63], v[124:127], v[8:11]
  s_waitcnt lgkmcnt(9)
  v_mfma_f32_16x16x32_bf16 v[8:11], v[64:67], v[128:131], v[8:11]
  s_waitcnt lgkmcnt(8)
  v_mfma_f32_16x16x32_bf16 v[8:11], v[68:71], v[132:135], v[8:11]
  s_waitcnt lgkmcnt(7)
  v_mfma_f32_16x16x32_bf16 v[8:11], v[72:75], v[136:139], v[8:11]
  s_waitcnt lgkmcnt(6)
  v_mfma_f32_16x16x32_bf16 v[8:11], v[76:79], v[140:143], v[8:11]
  s_waitcnt lgkmcnt(5)
  v_mfma_f32_16x16x32_bf16 v[8:11], v[80:83], v[144:147], v[8:11]
  s_waitcnt lgkmcnt(4)
  v_mfma_f32_16x16x32_bf16 v[8:11], v[84:87], v[148:151], v[8:11]
  s_waitcnt lgkmcnt(3)
  v_mfma_f32_16x16x32_bf16 v[8:11], v[88:91], v[152:155], v[8:11]
  s_waitcnt lgkmcnt(2)
  v_mfma_f32_16x16x32_bf16 v[8:11], v[92:95], v[156:159], v[8:11]
  s_waitcnt lgkmcnt(1)
  v_mfma_f32_16x16x32_bf16 v[8:11], v[96:99], v[160:163], v[8:11]
  s_waitcnt lgkmcnt(0)
  v_mfma_f32_16x16x32_bf16 v[8:11], v[100:103], v[164:167], v[8:11]
  s_nop 7
  v_cvt_pk_bf16_f32 v8, v8, v9
  v_cvt_pk_bf16_f32 v10, v10, v11
  v_mov_b32 v9, s74
  v_mov_b32 v11, s74
  v_min_u32 v8, s72, v8
  v_min_u32 v10, s72, v10
  s_mov_b32 exec_lo, 0x00030003
  s_mov_b32 exec_hi, 0x00030003
  global_store_dwordx4 v13, v[8:11], s[42:43] sc1
  s_mov_b64 exec, -1
  s_mov_b32 s60, 0
  s_branch L_svc1
L_r_wo:
  s_and_b32 s66, s2, 7
  s_lshr_b32 s58, s66, 1
  s_lshl_b32 s58, s58, 14
  s_and_b32 s49, s66, 1
  s_lshl_b32 s49, s49, 12
  s_add_u32 s58, s58, s49
  s_lshl_b32 s49, s61, 9
  s_add_u32 s58, s58, s49
  s_add_u32 s58, s58, 327680
  s_waitcnt lgkmcnt(0)
  s_mul_i32 s74, s74, 0x9e3779b1
  s_add_u32 s74, s74, 0x7f4a7c15
  s_add_u32 s76, s76, s74
  s_cmp_lg_u32 s5, 3
  s_cbranch_scc1 L_nr_48
  s_lshl_b32 s49, s61, 14
  s_lshl_b32 s50, s8, 10
  s_add_u32 s49, s49, s50
  s_add_u32 s49, s49, 524288
  s_add_u32 s50, s49, 256
  s_mov_b32 s54, 0
L_nrl_49:
  s_xor_b32 s55, s49, 0x2000
  s_mov_b32 s51, s74
  s_mov_b32 s52, s74
  s_load_dword s51, s[42:43], s49
  s_load_dword s52, s[42:43], s55
  s_waitcnt lgkmcnt(1)
  s_cmp_lg_u32 s52, s74
  s_addc_u32 s54, s54, 0
  s_cmp_lg_u32 s51, s74
  s_subb_u32 s54, s54, 0
  s_waitcnt lgkmcnt(0)
  s_add_u32 s49, s49, 128
  s_xor_b32 s55, s49, 0x2000
  s_mov_b32 s51, s74
  s_mov_b32 s52, s74
  s_load_dword s52, s[42:43], s55
  s_load_dword s51, s[42:43], s49
  s_waitcnt lgkmcnt(1)
  s_cmp_lg_u32 s52, s74
  s_addc_u32 s54, s54, 0
  s_cmp_lg_u32 s51, s74
  s_subb_u32 s54, s54, 0
  s_waitcnt lgkmcnt(0)
  s_add_u32 s49, s49, 128
  s_cmp_lt_u32 s49, s50
  s_cbranch_scc1 L_nrl_49
  s_cmp_lg_u32 s54, 0
  s_cselect_b32 s53, 0, 2
  s_cmp_gt_i32 s54, 0
  s_cselect_b32 s54, 1, 0
  s_sub_u32 s55, s76, s74
  s_lshr_b32 s55, s55, 2
  s_xor_b32 s54, s54, s55
  s_and_b32 s54, s54, 1
  s_or_b32 s54, s54, s53
  s_add_u32 s54, s54, s74
  s_lshl_b32 s55, s8, 3
  s_add_u32 s55, s55, s61
  s_lshl_b32 s55, s55, 5
  v_mov_b32 v8, s55
  v_mov_b32 v10, s76
  v_mov_b32 v11, s54
  s_mov_b64 exec, 1
  global_store_dwordx2 v8, v[10:11], s[42:43] offset:1024 sc1
  s_mov_b64 exec, -1
L_nr_48:
  s_mov_b32 s60, 1
  s_branch L_svc1
L_r_f1:
  s_lshl_b32 s48, s61, 6
  s_mul_i32 s49, s61, 47
  s_lshr_b32 s49, s49, 9
  s_mul_i32 s49, s49, 10752
  s_lshl_b32 s58, s61, 9
  s_add_u32 s58, s58, s49
  s_add_u32 s58, s58, 262144
  s_cmp_lt_u32 s5, 2
  s_cselect_b32 s44, s28, s30
  s_cselect_b32 s45, s29, s31
  s_mov_b32 s46, 1409024
  s_mov_b32 s47, 0x20000
  s_mov_b32 s60, 2
  s_waitcnt lgkmcnt(0)
  s_mul_i32 s74, s74, 0x9e3779b1
  s_add_u32 s74, s74, 0x7f4a7c15
  s_add_u32 s76, s76, s74
  s_branch L_svc1
L_r_f2:
  s_mov_b32 s44, s32
  s_mov_b32 s45, s33
  s_mov_b32 s46, 1409024
  s_mov_b32 s47, 0x20000
  s_waitcnt lgkmcnt(0)
  s_mul_i32 s74, s74, 0x9e3779b1
  s_add_u32 s74, s74, 0x7f4a7c15
  s_add_u32 s76, s76, s74
  s_mov_b32 s60, 3
  s_lshl_b32 s48, s61, 5
  global_load_dword v167, v38, s[38:39]
  s_branch L_svc1
L_r_none:
  s_mov_b32 s60, 0
  s_waitcnt lgkmcnt(0)
  s_mul_i32 s74, s74, 0x9e3779b1
  s_add_u32 s74, s74, 0x7f4a7c15
  s_add_u32 s76, s76, s74
L_svc1:
  s_cmp_lg_u32 s5, 0
  s_cbranch_scc1 L_disp3
  s_and_b32 s64, s6, 31
  s_lshl_b32 s64, s64, 10
  s_and_b32 s65, s6, 32
  s_lshl_b32 s65, s65, 1
  s_add_u32 s64, s64, s65
  s_add_u32 s64, s64, 32768
  v_bfe_u32 v16, v1, 2, 3
  v_lshl_add_u32 v16, v16, 7, s64
  v_and_b32 v17, 3, v1
  v_lshl_add_u32 v16, v17, 4, v16
  v_and_b32 v17, 31, v1
  v_lshlrev_b32 v17, 3, v17
  s_lshl_b32 s71, s8, 8
  v_and_b32 v18, 7, v1
  v_lshl_add_u32 v18, v18, 5, s71
  s_mov_b32 s70, 0
L_pl_50:
  ds_read_b32 v8, v38 offset:6664
  s_waitcnt lgkmcnt(0)
  v_cmp_eq_u32 vcc, -1, v8
  s_cmp_eq_u64 vcc, 0
  s_cbranch_scc1 L_pld_51
  s_sleep 8
  s_add_u32 s70, s70, 1
  s_cmp_lt_u32 s70, 1048576
  s_cbranch_scc1 L_pl_50
L_pld_51:
  global_load_dword v19, v18, s[42:43] offset:1024 sc1
  s_mov_b32 s70, 0
L_polt_52:
  global_load_dwordx4 v[20:23], v16, s[42:43] sc1
  s_waitcnt vmcnt(0)
  v_cmp_ne_u32 vcc, s74, v21
  v_cmp_ne_u32 s[68:69], s74, v23
  s_or_b64 vcc, vcc, s[68:69]
  s_cmp_eq_u64 vcc, 0
  s_cbranch_scc1 L_poltd_53
  s_add_u32 s70, s70, 1
  s_cmp_lt_u32 s70, 262144
  s_cbranch_scc1 L_polt_52
L_poltd_53:
  v_mov_b32 v21, v22
  ds_write_b64 v17, v[20:21] offset:6400
  v_cmp_ne_u32 vcc, s76, v19
  s_cmp_eq_u64 vcc, 0
  s_cselect_b32 s75, 1, 0
  v_mov_b32 v20, s74
  v_mov_b32 v21, s75
  ds_write_b64 v38, v[20:21] offset:6688
L_svc2:
  v_lshlrev_b32 v16, 4, v1
  s_lshl_b32 s64, s6, 9
  s_add_u32 s64, s64, 65536
  s_lshl_b32 s65, s7, 7
  s_add_u32 s65, s65, s64
  v_mov_b32 v18, s65
  s_mov_b32 s70, 0
L_pl_54:
  ds_read_b128 v[104:107], v16 offset:12032
  ds_read_b128 v[108:111], v16 offset:13056
  ds_read_b128 v[112:115], v16 offset:14080
  ds_read_b128 v[116:119], v16 offset:15104
  ds_read_b128 v[120:123], v16 offset:16128
  ds_read_b128 v[124:127], v16 offset:17152
  ds_read_b128 v[128:131], v16 offset:18176
  ds_read_b128 v[132:135], v16 offset:19200
  s_waitcnt lgkmcnt(0)
  v_max3_u32 v8, v104, v105, v106
  v_max3_u32 v8, v8, v108, v109
  v_max3_u32 v8, v8, v110, v112
  v_max3_u32 v8, v8, v113, v114
  v_max3_u32 v8, v8, v116, v117
  v_max3_u32 v8, v8, v118, v120
  v_max3_u32 v8, v8, v121, v122
  v_max3_u32 v8, v8, v124, v125
  v_max3_u32 v8, v8, v126, v128
  v_max3_u32 v8, v8, v129, v130
  v_max3_u32 v8, v8, v132, v133
  v_max_u32 v8, v8, v134
  v_cmp_eq_u32 vcc, -1, v8
  s_cmp_eq_u64 vcc, 0
  s_cbranch_scc1 L_pld_55
  s_sleep 4
  s_add_u32 s70, s70, 1
  s_cmp_lt_u32 s70, 1048576
  s_cbranch_scc1 L_pl_54
L_pld_55:
  v_max3_f32 v8, v104, v105, v106
  v_max3_f32 v8, v8, v108, v109
  v_max3_f32 v8, v8, v110, v112
  v_max3_f32 v8, v8, v113, v114
  v_max3_f32 v8, v8, v116, v117
  v_max3_f32 v8, v8, v118, v120
  v_max3_f32 v8, v8, v121, v122
  v_max3_f32 v8, v8, v124, v125
  v_max3_f32 v8, v8, v126, v128
  v_max3_f32 v8, v8, v129, v130
  v_max3_f32 v8, v8, v132, v133
  v_max_f32 v8, v8, v134
  s_nop 1
  v_max_f32_dpp v8, v8, v8 row_ror:8 row_mask:0xf bank_mask:0xf
  s_nop 1
  v_max_f32_dpp v8, v8, v8 row_ror:4 row_mask:0xf bank_mask:0xf
  s_nop 1
  v_max_f32_dpp v8, v8, v8 row_ror:2 row_mask:0xf bank_mask:0xf
  s_nop 1
  v_max_f32_dpp v8, v8, v8 row_ror:1 row_mask:0xf bank_mask:0xf
  v_mov_b32 v11, v8
  s_nop 1
  v_permlane16_swap_b32 v11, v8
  v_max_f32 v8, v8, v11
  v_mov_b32 v11, v8
  s_nop 1
  v_permlane32_swap_b32 v11, v8
  v_max_f32 v8, v8, v11
  v_min_u32 v9, s72, v8
  ds_write_b32 v38, v9 offset:6656
  v_sub_f32 v104, v104, v8
  v_sub_f32 v105, v105, v8
  v_sub_f32 v106, v106, v8
  v_sub_f32 v108, v108, v8
  v_sub_f32 v109, v109, v8
  v_sub_f32 v110, v110, v8
  v_sub_f32 v112, v112, v8
  v_sub_f32 v113, v113, v8
  v_sub_f32 v114, v114, v8
  v_sub_f32 v116, v116, v8
  v_sub_f32 v117, v117, v8
  v_sub_f32 v118, v118, v8
  v_sub_f32 v120, v120, v8
  v_sub_f32 v121, v121, v8
  v_sub_f32 v122, v122, v8
  v_sub_f32 v124, v124, v8
  v_sub_f32 v125, v125, v8
  v_sub_f32 v126, v126, v8
  v_sub_f32 v128, v128, v8
  v_sub_f32 v129, v129, v8
  v_sub_f32 v130, v130, v8
  v_sub_f32 v132, v132, v8
  v_sub_f32 v133, v133, v8
  v_sub_f32 v134, v134, v8
  v_mul_f32 v104, 0x3fb8aa3b, v104
  v_mul_f32 v105, 0x3fb8aa3b, v105
  v_mul_f32 v106, 0x3fb8aa3b, v106
  v_mul_f32 v108, 0x3fb8aa3b, v108
  v_mul_f32 v109, 0x3fb8aa3b, v109
  v_mul_f32 v110, 0x3fb8aa3b, v110
  v_mul_f32 v112, 0x3fb8aa3b, v112
  v_mul_f32 v113, 0x3fb8aa3b, v113
  v_mul_f32 v114, 0x3fb8aa3b, v114
  v_mul_f32 v116, 0x3fb8aa3b, v116
  v_mul_f32 v117, 0x3fb8aa3b, v117
  v_mul_f32 v118, 0x3fb8aa3b, v118
  v_mul_f32 v120, 0x3fb8aa3b, v120
  v_mul_f32 v121, 0x3fb8aa3b, v121
  v_mul_f32 v122, 0x3fb8aa3b, v122
  v_mul_f32 v124, 0x3fb8aa3b, v124
  v_mul_f32 v125, 0x3fb8aa3b, v125
  v_mul_f32 v126, 0x3fb8aa3b, v126
  v_mul_f32 v128, 0x3fb8aa3b, v128
  v_mul_f32 v129, 0x3fb8aa3b, v129
  v_mul_f32 v130, 0x3fb8aa3b, v130
  v_mul_f32 v132, 0x3fb8aa3b, v132
  v_mul_f32 v133, 0x3fb8aa3b, v133
  v_mul_f32 v134, 0x3fb8aa3b, v134
  v_exp_f32 v104, v104
  v_exp_f32 v105, v105
  v_exp_f32 v106, v106
  v_exp_f32 v108, v108
  v_exp_f32 v109, v109
  v_exp_f32 v110, v110
  v_exp_f32 v112, v112
  v_exp_f32 v113, v113
  v_exp_f32 v114, v114
  v_exp_f32 v116, v116
  v_exp_f32 v117, v117
  v_exp_f32 v118, v118
  v_exp_f32 v120, v120
  v_exp_f32 v121, v121
  v_exp_f32 v122, v122
  v_exp_f32 v124, v124
  v_exp_f32 v125, v125
  v_exp_f32 v126, v126
  v_exp_f32 v128, v128
  v_exp_f32 v129, v129
  v_exp_f32 v130, v130
  v_exp_f32 v132, v132
  v_exp_f32 v133, v133
  v_exp_f32 v134, v134
  s_nop 0
  v_add_f32 v104, v104, v120
  v_add_f32 v105, v105, v121
  v_add_f32 v106, v106, v122
  v_add_f32 v108, v108, v124
  v_add_f32 v109, v109, v125
  v_add_f32 v110, v110, v126
  v_add_f32 v112, v112, v128
  v_add_f32 v113, v113, v129
  v_add_f32 v114, v114, v130
  v_add_f32 v116, v116, v132
  v_add_f32 v117, v117, v133
  v_add_f32 v118, v118, v134
  v_add_f32 v104, v104, v112
  v_add_f32 v105, v105, v113
  v_add_f32 v106, v106, v114
  v_add_f32 v108, v108, v116
  v_add_f32 v109, v109, v117
  v_add_f32 v110, v110, v118
  v_add_f32 v104, v104, v108
  v_add_f32 v105, v105, v109
  v_add_f32 v106, v106, v110
  v_add_f32 v10, v104, v105
  v_add_f32 v10, v10, v106
  s_nop 1
  v_add_f32_dpp v10, v10, v10 row_ror:8 row_mask:0xf bank_mask:0xf
  s_nop 1
  v_add_f32_dpp v10, v10, v10 row_ror:4 row_mask:0xf bank_mask:0xf
  s_nop 1
  v_add_f32_dpp v10, v10, v10 row_ror:2 row_mask:0xf bank_mask:0xf
  s_nop 1
  v_add_f32_dpp v10, v10, v10 row_ror:1 row_mask:0xf bank_mask:0xf
  v_mov_b32 v11, v10
  s_nop 1
  v_permlane16_swap_b32 v11, v10
  v_add_f32 v10, v10, v11
  v_mov_b32 v11, v10
  s_nop 1
  v_permlane32_swap_b32 v11, v10
  v_add_f32 v10, v10, v11
  v_mov_b32 v9, s74
  v_mov_b32 v11, s74
  s_mov_b64 exec, 1
  s_cmp_eq_u32 s75, 1
  s_cbranch_scc0 L_pf_56
  global_store_dwordx4 v18, v[8:11], s[42:43]
  s_branch L_pe_57
L_pf_56:
  global_store_dwordx4 v18, v[8:11], s[42:43] sc1
L_pe_57:
  s_mov_b64 exec, -1
L_disp3:
  s_bfe_u32 s62, s74, 0x80000
  s_bfe_u32 s63, s74, 0x80008
  s_bfe_u32 s64, s74, 0x80010
  s_bfe_u32 s65, s74, 0x80018
  s_cmp_lg_u32 s5, 2
  s_cbranch_scc1 L_opt_58
  s_mov_b32 s70, 0
L_pl_59:
  ds_read_b32 v8, v38 offset:6656
  s_waitcnt lgkmcnt(0)
  v_cmp_eq_u32 vcc, -1, v8
  s_cmp_eq_u64 vcc, 0
  s_cbranch_scc1 L_pld_60
  s_sleep 32
  s_add_u32 s70, s70, 1
  s_cmp_lt_u32 s70, 1048576
  s_cbranch_scc1 L_pl_59
L_pld_60:
  s_lshl_b32 s56, s6, 2
  s_add_u32 s56, s56, s7
  s_lshl_b32 s57, s56, 9
  s_add_u32 s57, s57, 131072
  v_lshl_add_u32 v3, v1, 3, s57
  global_load_dword v167, v3, s[42:43] sc1
L_opt_58:
  s_cmp_eq_u32 s60, 2
  s_cbranch_scc1 L_pre_f1
  s_cmp_eq_u32 s60, 3
  s_cbranch_scc1 L_pre_f2
  s_cmp_eq_u32 s60, 1
  s_cbranch_scc1 L_pre_wo
  s_lshr_b32 s68, s14, 29
  s_mul_i32 s68, s68, 1
  s_xor_b32 s68, s68, s8
  s_lshl_b32 s68, s68, 3
  s_add_u32 s68, s68, L_gtab-L_pc2
  s_load_dwordx2 s[100:101], s[100:101], s68
  s_waitcnt lgkmcnt(0)
  s_lshr_b32 s68, s14, 26
  s_lshl_b32 s68, s68, 2
  s_add_u32 s68, s68, s5
  s_and_b32 s68, s68, 31
  s_and_b32 s69, s100, 0xffff
  s_lshr_b32 s100, s100, 16
  v_and_b32 v12, 3, v1
  v_lshl_add_u32 v12, v12, 7, s69
  v_min_u32 v12, s100, v12
  v_lshrrev_b32 v13, 2, v1
  v_mul_u32_u24 v13, 2752, v13
  s_mul_i32 s69, s68, 44032
  v_add3_u32 v12, v12, v13, s69
  v_min_u32 v13, 42, v1
  s_mul_i32 s68, s68, 44032
  s_add_u32 s68, s68, s101
  v_lshl_add_u32 v13, v13, 10, s68
  s_branch L_join
L_pre_wo:
  s_mov_b32 s70, 0
L_hs_61:
  ds_read_b32 v9, v38 offset:6720
  s_waitcnt lgkmcnt(0)
  v_cmp_gt_u32 vcc, 8, v9
  s_cmp_eq_u64 vcc, 0
  s_cbranch_scc1 L_hsd_62
  s_sleep 8
  s_add_u32 s70, s70, 1
  s_cmp_lt_u32 s70, 2097152
  s_cbranch_scc1 L_hs_61
L_hsd_62:
  v_lshrrev_b32 v2, 2, v1
  v_bfe_u32 v3, v1, 1, 1
  s_lshl_b32 s49, s5, 1
  v_or_b32 v3, s49, v3
  v_and_b32 v10, 6, v2
  v_xor_b32 v3, v3, v10
  v_lshlrev_b32 v2, 7, v2
  v_lshl_add_u32 v2, v3, 4, v2
  v_and_b32 v3, 1, v1
  v_lshl_add_u32 v2, v3, 3, v2
  v_add_u32 v2, 20480, v2
  s_add_u32 s49, s5, 0
  s_and_b32 s49, s49, 3
  s_mul_i32 s49, s49, 16384
  v_add_u32 v3, s49, v2
  ds_read_b64_tr_b16 v[40:41], v3 offset:0
  ds_read_b64_tr_b16 v[42:43], v3 offset:2048
  ds_read_b64_tr_b16 v[44:45], v3 offset:4096
  ds_read_b64_tr_b16 v[46:47], v3 offset:6144
  ds_read_b64_tr_b16 v[48:49], v3 offset:8192
  ds_read_b64_tr_b16 v[50:51], v3 offset:10240
  ds_read_b64_tr_b16 v[52:53], v3 offset:12288
  ds_read_b64_tr_b16 v[54:55], v3 offset:14336
  s_add_u32 s49, s5, 1
  s_and_b32 s49, s49, 3
  s_mul_i32 s49, s49, 16384
  v_add_u32 v3, s49, v2
  ds_read_b64_tr_b16 v[56:57], v3 offset:0
  ds_read_b64_tr_b16 v[58:59], v3 offset:2048
  ds_read_b64_tr_b16 v[60:61], v3 offset:4096
  ds_read_b64_tr_b16 v[62:63], v3 offset:6144
  s_waitcnt lgkmcnt(10)
  ds_read_b64_tr_b16 v[64:65], v3 offset:8192
  ds_read_b64_tr_b16 v[66:67], v3 offset:10240
  s_waitcnt lgkmcnt(10)
  ds_read_b64_tr_b16 v[68:69], v3 offset:12288
  ds_read_b64_tr_b16 v[70:71], v3 offset:14336
  s_waitcnt lgkmcnt(10)
  s_add_u32 s49, s5, 2
  s_and_b32 s49, s49, 3
  s_mul_i32 s49, s49, 16384
  v_add_u32 v3, s49, v2
  ds_read_b64_tr_b16 v[72:73], v3 offset:0
  ds_read_b64_tr_b16 v[74:75], v3 offset:2048
  s_waitcnt lgkmcnt(10)
  ds_read_b64_tr_b16 v[76:77], v3 offset:4096
  ds_read_b64_tr_b16 v[78:79], v3 offset:6144
  s_waitcnt lgkmcnt(10)
  ds_read_b64_tr_b16 v[80:81], v3 offset:8192
  ds_read_b64_tr_b16 v[82:83], v3 offset:10240
  s_waitcnt lgkmcnt(10)
  ds_read_b64_tr_b16 v[84:85], v3 offset:12288
  ds_read_b64_tr_b16 v[86:87], v3 offset:14336
  s_waitcnt lgkmcnt(10)
  s_add_u32 s49, s5, 3
  s_and_b32 s49, s49, 3
  s_mul_i32 s49, s49, 16384
  v_add_u32 v3, s49, v2
  ds_read_b64_tr_b16 v[88:89], v3 offset:0
  ds_read_b64_tr_b16 v[90:91], v3 offset:2048
  s_waitcnt lgkmcnt(10)
  ds_read_b64_tr_b16 v[92:93], v3 offset:4096
  ds_read_b64_tr_b16 v[94:95], v3 offset:6144
  s_waitcnt lgkmcnt(10)
  ds_read_b64_tr_b16 v[96:97], v3 offset:8192
  ds_read_b64_tr_b16 v[98:99], v3 offset:10240
  s_waitcnt lgkmcnt(10)
  ds_read_b64_tr_b16 v[100:101], v3 offset:12288
  ds_read_b64_tr_b16 v[102:103], v3 offset:14336
  s_waitcnt lgkmcnt(10)
  s_waitcnt lgkmcnt(0)
  s_lshl_b32 s49, s5, 3
  s_add_u32 s49, s49, s66
  s_lshl_b32 s50, s49, 9
  s_add_u32 s50, s50, 65536
  v_lshrrev_b32 v12, 5, v1
  v_lshl_add_u32 v15, v12, 14, s50
  v_and_b32 v16, 3, v1
  v_lshl_add_u32 v15, v16, 7, v15
  s_mov_b32 s70, 0
L_pl_63:
  ds_read_b32 v8, v38 offset:6676
  s_waitcnt lgkmcnt(0)
  v_cmp_eq_u32 vcc, -1, v8
  s_cmp_eq_u64 vcc, 0
  s_cbranch_scc1 L_pld_64
  s_sleep 16
  s_add_u32 s70, s70, 1
  s_cmp_lt_u32 s70, 1048576
  s_cbranch_scc1 L_pl_63
L_pld_64:
  s_mov_b32 s70, 0
L_polt_65:
  global_load_dwordx4 v[16:19], v15, s[42:43] sc1
  s_waitcnt vmcnt(0)
  v_cmp_ne_u32 vcc, s74, v17
  v_cmp_ne_u32 s[68:69], s74, v19
  s_or_b64 vcc, vcc, s[68:69]
  s_cmp_eq_u64 vcc, 0
  s_cbranch_scc1 L_poltd_66
  s_sleep 8
  s_add_u32 s70, s70, 1
  s_cmp_lt_u32 s70, 262144
  s_cbranch_scc1 L_polt_65
L_poltd_66:
  v_max_f32_dpp v10, v16, v16 quad_perm:[1,0,3,2] row_mask:0xf bank_mask:0xf
  s_nop 1
  v_max_f32_dpp v10, v10, v10 quad_perm:[2,3,0,1] row_mask:0xf bank_mask:0xf
  v_sub_f32 v8, v16, v10
  v_mul_f32 v8, 0x3fb8aa3b, v8
  v_exp_f32 v8, v8
  s_nop 0
  v_mul_f32 v9, v18, v8
  s_nop 1
  v_add_f32_dpp v9, v9, v9 quad_perm:[1,0,3,2] row_mask:0xf bank_mask:0xf
  s_nop 1
  v_add_f32_dpp v9, v9, v9 quad_perm:[2,3,0,1] row_mask:0xf bank_mask:0xf
  v_rcp_f32 v9, v9
  s_nop 0
  v_mul_f32 v8, v8, v9
  s_nop 1
  v_mov_b32_dpp v20, v8 quad_perm:[0,0,0,0] row_mask:0xf bank_mask:0xf
  v_mov_b32_dpp v21, v8 quad_perm:[1,1,1,1] row_mask:0xf bank_mask:0xf
  v_mov_b32_dpp v22, v8 quad_perm:[2,2,2,2] row_mask:0xf bank_mask:0xf
  v_mov_b32_dpp v23, v8 quad_perm:[3,3,3,3] row_mask:0xf bank_mask:0xf
  s_lshl_b32 s49, s49, 11
  s_add_u32 s49, s49, 131072
  v_lshrrev_b32 v12, 5, v1
  v_and_b32 v16, 31, v1
  v_lshlrev_b32 v15, 16, v12
  v_lshl_add_u32 v15, v16, 4, v15
  v_add_u32 v15, s49, v15
  v_mul_u32_u24 v12, 1056, v12
  v_bfe_u32 v16, v1, 3, 2
  v_lshl_add_u32 v12, v16, 6, v12
  v_and_b32 v16, 3, v1
  v_lshl_add_u32 v12, v16, 4, v12
  v_bfe_u32 v16, v1, 2, 1
  v_lshl_add_u32 v12, v16, 3, v12
  s_lshl_b32 s49, s5, 8
  v_add_u32 v12, s49, v12
  v_and_b32 v14, 1, v1
  v_mul_u32_u24 v14, 1056, v14
  v_lshrrev_b32 v3, 4, v1
  v_lshl_add_u32 v14, v3, 4, v14
  v_and_b32 v13, 1, v1
  v_lshlrev_b32 v13, 6, v13
  v_lshrrev_b32 v3, 4, v1
  v_lshl_add_u32 v13, v3, 4, v13
  s_lshl_b32 s49, s5, 7
  s_add_u32 s49, s49, s58
  v_add_u32 v13, s49, v13
  v_add_u32 v37, 0x2000, v13
  v_mov_b32 v36, 0xff
  s_add_u32 s49, s5, 1
  s_and_b32 s49, s49, 3
  s_lshl_b32 s49, s49, 8
  v_add_u32 v0, s49, v14
  s_add_u32 s49, s5, 2
  s_and_b32 s49, s49, 3
  s_lshl_b32 s49, s49, 8
  v_add_u32 v2, s49, v14
  s_add_u32 s49, s5, 3
  s_and_b32 s49, s49, 3
  s_lshl_b32 s49, s49, 8
  v_add_u32 v3, s49, v14
  s_add_u32 s49, s5, 0
  s_and_b32 s49, s49, 3
  s_lshl_b32 s49, s49, 8
  v_add_u32 v14, s49, v14
  s_branch L_join
L_pre_f1:
  s_cmp_lg_u32 s5, 3
  s_cbranch_scc1 L_hc_67
  s_mov_b32 s70, 0
L_pl_68:
  ds_read_b32 v8, v38 offset:6400
  s_waitcnt lgkmcnt(0)
  v_cmp_eq_u32 vcc, -1, v8
  s_cmp_eq_u64 vcc, 0
  s_cbranch_scc1 L_pld_69
  s_sleep 32
  s_add_u32 s70, s70, 1
  s_cmp_lt_u32 s70, 1048576
  s_cbranch_scc1 L_pl_68
L_pld_69:
  v_lshlrev_b32 v110, 5, v1
  global_load_dword v109, v110, s[42:43] offset:1028 sc1
  s_waitcnt vmcnt(0)
  v_subrev_u32 v109, s74, v109
  v_cmp_eq_u32 vcc, 1, v109
  s_bcnt1_i32_b64 s70, vcc
  v_cmp_eq_u32 vcc, 0, v109
  s_bcnt1_i32_b64 s71, vcc
  s_cmp_gt_u32 s70, s71
  s_cselect_b32 s71, 4, 0
  s_sub_u32 s68, s76, s74
  s_xor_b32 s71, s71, s68
  s_and_b32 s71, s71, 4
  s_lshl_b32 s71, s71, 11
  v_mov_b32 v104, s71
  ds_write_b32 v38, v104 offset:6668
L_hc_67:
  v_mov_b32 v31, v13
  v_lshlrev_b32 v15, 4, v0
  v_add_u32 v24, 12288, v15
  v_add_u32 v25, 16384, v15
  v_add_u32 v26, 20480, v15
  s_mov_b32 s70, 0
L_pl_70:
  ds_read_b32 v11, v38 offset:6668
  s_waitcnt lgkmcnt(0)
  v_cmp_eq_u32 vcc, -1, v11
  s_cmp_eq_u64 vcc, 0
  s_cbranch_scc1 L_pld_71
  s_sleep 8
  s_add_u32 s70, s70, 1
  s_cmp_lt_u32 s70, 1048576
  s_cbranch_scc1 L_pl_70
L_pld_71:
  v_add_u32 v15, 327680, v15
  v_add_u32 v15, v11, v15
  v_add_u32 v35, 4096, v15
  v_add_u32 v32, 16384, v15
  v_add_u32 v36, 20480, v15
  v_add_u32 v33, 32768, v15
  v_add_u32 v37, 36864, v15
  v_add_u32 v34, 49152, v15
  v_add_u32 v39, 53248, v15
  v_bfe_u32 v5, v1, 2, 1
  v_mul_u32_u24 v5, 1056, v5
  v_lshrrev_b32 v3, 3, v0
  v_lshl_add_u32 v5, v3, 5, v5
  v_and_b32 v3, 3, v1
  v_lshl_add_u32 v5, v3, 3, v5
  v_and_b32 v14, 7, v1
  v_mul_u32_u24 v14, 1056, v14
  v_lshrrev_b32 v3, 4, v1
  v_lshl_add_u32 v14, v3, 4, v14
  v_and_b32 v7, 1, v1
  v_mul_u32_u24 v7, 1056, v7
  v_lshrrev_b32 v3, 1, v1
  v_lshl_add_u32 v7, v3, 5, v7
  v_and_b32 v13, 3, v1
  v_lshlrev_b32 v13, 5, v13
  v_bfe_u32 v3, v1, 4, 1
  v_lshl_add_u32 v13, v3, 3, v13
  s_lshl_b32 s49, s5, 7
  s_add_u32 s49, s49, s58
  v_add_u32 v13, s49, v13
  v_lshrrev_b32 v3, 5, v1
  v_lshl_add_u32 v13, v3, 4, v13
  v_add_u32 v4, 0x2000, v13
  s_and_b32 s54, s61, 1
  s_mul_i32 s52, s54, -2
  s_add_u32 s52, s52, 1
  s_mul_i32 s53, s52, 16384
  s_sub_u32 s53, s53, 8192
  s_mul_i32 s52, s52, 2752
  s_sub_u32 s52, s52, 704512
  v_lshrrev_b32 v2, 2, v1
  v_mul_u32_u24 v2, 5504, v2
  s_and_b32 s49, s5, 2
  s_or_b32 s49, s49, s54
  v_xor_b32 v3, s49, v1
  v_and_b32 v3, 3, v3
  v_lshl_add_u32 v2, v3, 4, v2
  v_mov_b32 v0, v2
  v_lshrrev_b32 v6, 3, v1
  v_lshlrev_b32 v6, 6, v6
  v_bfe_u32 v3, v1, 2, 1
  v_lshl_add_u32 v6, v3, 14, v6
  v_and_b32 v8, 2, v1
  v_or_b32 v3, v3, v8
  v_xor_b32 v3, s5, v3
  v_lshl_add_u32 v6, v3, 4, v6
  v_lshl_add_u32 v6, v8, 14, v6
  v_and_b32 v3, 1, v1
  v_lshl_add_u32 v6, v3, 3, v6
  v_add_u32 v6, 20480, v6
  s_and_b32 s55, s5, 1
  s_mul_i32 s49, s55, 704512
  s_add_u32 s49, s49, s48
  s_mul_i32 s50, s54, 2752
  s_add_u32 s49, s49, s50
  s_lshr_b32 s50, s5, 1
  s_lshl_b32 s50, s50, 15
  s_lshl_b32 s54, s54, 14
  s_add_u32 s50, s50, s54
  s_lshl_b32 s55, s55, 13
  s_add_u32 s50, s50, s55
  s_add_u32 s50, s50, 20480
  s_mov_b32 s70, 0
L_pl_72:
  ds_read_b32 v8, v38 offset:6676
  s_waitcnt lgkmcnt(0)
  v_cmp_eq_u32 vcc, -1, v8
  s_cmp_eq_u64 vcc, 0
  s_cbranch_scc1 L_pld_73
  s_sleep 16
  s_add_u32 s70, s70, 1
  s_cmp_lt_u32 s70, 1048576
  s_cbranch_scc1 L_pl_72
L_pld_73:
  global_load_dwordx2 v[8:9], v31, s[16:17]
  s_mov_b32 s70, 0
L_polt_74:
  global_load_dwordx4 v[136:139], v24, s[42:43] sc1
  global_load_dwordx4 v[140:143], v25, s[42:43] sc1
  global_load_dwordx4 v[144:147], v26, s[42:43] sc1
  s_waitcnt vmcnt(0)
  v_cmp_ne_u32 vcc, s74, v137
  v_cmp_ne_u32 s[68:69], s74, v139
  s_or_b64 vcc, vcc, s[68:69]
  v_cmp_ne_u32 s[68:69], s74, v141
  s_or_b64 vcc, vcc, s[68:69]
  v_cmp_ne_u32 s[68:69], s74, v143
  s_or_b64 vcc, vcc, s[68:69]
  v_cmp_ne_u32 s[68:69], s74, v145
  s_or_b64 vcc, vcc, s[68:69]
  v_cmp_ne_u32 s[68:69], s74, v147
  s_or_b64 vcc, vcc, s[68:69]
  s_cmp_eq_u64 vcc, 0
  s_cbranch_scc1 L_poltd_75
  s_sleep 8
  s_add_u32 s70, s70, 1
  s_cmp_lt_u32 s70, 262144
  s_cbranch_scc1 L_polt_74
L_poltd_75:
  v_lshlrev_b32 v16, 16, v8
  v_and_b32 v17, s73, v8
  v_lshlrev_b32 v18, 16, v9
  v_and_b32 v19, s73, v9
  v_lshlrev_b32 v20, 16, v136
  v_and_b32 v21, s73, v136
  v_lshlrev_b32 v22, 16, v138
  v_and_b32 v23, s73, v138
  v_lshlrev_b32 v28, 16, v144
  v_and_b32 v29, s73, v144
  v_lshlrev_b32 v30, 16, v146
  v_and_b32 v31, s73, v146
  v_add_f32 v28, 1.0, v28
  v_add_f32 v29, 1.0, v29
  v_add_f32 v30, 1.0, v30
  v_add_f32 v31, 1.0, v31
  v_cvt_pk_bf16_f32 v8, v28, v29
  v_cvt_pk_bf16_f32 v9, v30, v31
  v_mov_b32 v141, v142
  ds_write_b64 v12, v[8:9] offset:2112
  ds_write_b64 v12, v[140:141] offset:4224
  v_cvt_pk_bf16_f32 v28, 0, v28
  v_cvt_pk_bf16_f32 v29, 0, v29
  v_cvt_pk_bf16_f32 v30, 0, v30
  v_cvt_pk_bf16_f32 v31, 0, v31
  v_mul_f32 v24, v20, v28
  v_mul_f32 v25, v21, v29
  v_mul_f32 v26, v22, v30
  v_mul_f32 v27, v23, v31
  v_mul_f32 v28, v16, v28
  v_mul_f32 v29, v17, v29
  v_mul_f32 v30, v18, v30
  v_mul_f32 v31, v19, v31
  s_branch L_join
L_pre_f2:
  s_cmp_lg_u32 s5, 3
  s_cbranch_scc1 L_hc_76
  s_mov_b32 s70, 0
L_pl_77:
  ds_read_b32 v8, v38 offset:6400
  s_waitcnt lgkmcnt(0)
  v_cmp_eq_u32 vcc, -1, v8
  s_cmp_eq_u64 vcc, 0
  s_cbranch_scc1 L_pld_78
  s_sleep 32
  s_add_u32 s70, s70, 1
  s_cmp_lt_u32 s70, 1048576
  s_cbranch_scc1 L_pl_77
L_pld_78:
  v_lshlrev_b32 v110, 5, v1
  global_load_dword v109, v110, s[42:43] offset:1028 sc1
  s_waitcnt vmcnt(0)
  v_subrev_u32 v109, s74, v109
  v_cmp_eq_u32 vcc, 1, v109
  s_bcnt1_i32_b64 s70, vcc
  v_cmp_eq_u32 vcc, 0, v109
  s_bcnt1_i32_b64 s71, vcc
  s_cmp_gt_u32 s70, s71
  s_cselect_b32 s71, 4, 0
  s_sub_u32 s68, s76, s74
  s_xor_b32 s71, s71, s68
  s_and_b32 s71, s71, 4
  s_lshl_b32 s71, s71, 11
  v_mov_b32 v104, s71
  ds_write_b32 v38, v104 offset:6668
L_hc_76:
  v_and_b32 v12, 1, v1
  v_lshrrev_b32 v14, 4, v1
  s_lshl_b32 s49, s61, 5
  v_lshl_add_u32 v3, v14, 3, s49
  v_lshl_add_u32 v13, v12, 10, v3
  v_mov_b32 v31, v13
  v_lshlrev_b32 v15, 6, v12
  v_lshl_add_u32 v15, v14, 4, v15
  s_lshl_b32 s49, s61, 7
  v_add_u32 v15, s49, v15
  v_add_u32 v24, 12288, v15
  v_add_u32 v25, 24576, v15
  s_mov_b32 s70, 0
L_pl_79:
  ds_read_b32 v11, v38 offset:6668
  s_waitcnt lgkmcnt(0)
  v_cmp_eq_u32 vcc, -1, v11
  s_cmp_eq_u64 vcc, 0
  s_cbranch_scc1 L_pld_80
  s_sleep 8
  s_add_u32 s70, s70, 1
  s_cmp_lt_u32 s70, 1048576
  s_cbranch_scc1 L_pl_79
L_pld_80:
  v_add_u32 v15, 327680, v15
  v_add_u32 v15, v11, v15
  v_add_u32 v35, 4096, v15
  v_add_u32 v32, 16384, v15
  v_add_u32 v36, 20480, v15
  v_add_u32 v33, 32768, v15
  v_add_u32 v37, 36864, v15
  v_add_u32 v34, 49152, v15
  v_add_u32 v39, 53248, v15
  s_lshl_b32 s49, s5, 14
  s_add_u32 s49, s49, 264192
  v_lshl_add_u32 v28, v14, 7, s49
  v_add_u32 v28, v11, v28
  v_lshl_add_u32 v28, v12, 5, v28
  v_and_b32 v3, 2, v1
  v_lshl_add_u32 v28, v3, 3, v28
  v_bfe_u32 v3, v1, 2, 2
  v_lshl_add_u32 v28, v3, 9, v28
  v_lshl_add_u32 v12, v14, 1, v12
  v_lshlrev_b32 v12, 4, v12
  v_add_u32 v12, 11008, v12
  s_lshl_b32 s49, s5, 7
  v_add_u32 v30, s49, v12
  v_lshrrev_b32 v2, 1, v1
  v_lshlrev_b32 v2, 10, v2
  v_and_b32 v3, 1, v1
  v_lshl_add_u32 v2, v3, 4, v2
  v_mov_b32 v29, v2
  v_lshlrev_b32 v6, 8, v14
  v_bfe_u32 v3, v1, 2, 2
  v_lshl_add_u32 v6, v3, 5, v6
  v_and_b32 v3, 3, v1
  v_lshl_add_u32 v6, v3, 3, v6
  s_mul_i32 s49, s5, 11264
  s_add_u32 s49, s49, 20480
  v_add_u32 v6, s49, v6
  s_mov_b32 s70, 0
L_pl_81:
  ds_read_b32 v8, v38 offset:6676
  s_waitcnt lgkmcnt(0)
  v_cmp_eq_u32 vcc, -1, v8
  s_cmp_eq_u64 vcc, 0
  s_cbranch_scc1 L_pld_82
  s_sleep 16
  s_add_u32 s70, s70, 1
  s_cmp_lt_u32 s70, 1048576
  s_cbranch_scc1 L_pl_81
L_pld_82:
  global_load_dwordx2 v[8:9], v31, s[16:17]
  s_mov_b32 s70, 0
L_polt_83:
  global_load_dwordx4 v[136:139], v24, s[42:43] sc1
  global_load_dwordx4 v[140:143], v25, s[42:43] sc1
  s_waitcnt vmcnt(0)
  v_cmp_ne_u32 vcc, s74, v137
  v_cmp_ne_u32 s[68:69], s74, v139
  s_or_b64 vcc, vcc, s[68:69]
  v_cmp_ne_u32 s[68:69], s74, v141
  s_or_b64 vcc, vcc, s[68:69]
  v_cmp_ne_u32 s[68:69], s74, v143
  s_or_b64 vcc, vcc, s[68:69]
  s_cmp_eq_u64 vcc, 0
  s_cbranch_scc1 L_poltd_84
  s_sleep 8
  s_add_u32 s70, s70, 1
  s_cmp_lt_u32 s70, 262144
  s_cbranch_scc1 L_polt_83
L_poltd_84:
  s_cmp_lg_u32 s5, 2
  s_cbranch_scc1 L_apw_85
  s_and_b32 s49, s61, 3
  s_lshl_b32 s49, s49, 14
  s_add_u32 s49, s49, 327680
  v_lshl_add_u32 v3, v1, 7, s49
  v_add_u32 v3, v11, v3
  global_load_dword v167, v3, s[42:43] sc1
L_apw_85:
  v_lshlrev_b32 v16, 16, v8
  v_and_b32 v17, s73, v8
  v_lshlrev_b32 v18, 16, v9
  v_and_b32 v19, s73, v9
  v_lshlrev_b32 v20, 16, v136
  v_and_b32 v21, s73, v136
  v_lshlrev_b32 v22, 16, v138
  v_and_b32 v23, s73, v138
  v_lshlrev_b32 v24, 16, v140
  v_and_b32 v25, s73, v140
  v_lshlrev_b32 v26, 16, v142
  v_and_b32 v27, s73, v142
L_join:
  s_waitcnt vmcnt(0) lgkmcnt(0)
  s_barrier
  s_cmp_eq_u32 s60, 1
  s_cbranch_scc1 L_t_wo
  s_cmp_eq_u32 s60, 2
  s_cbranch_scc1 L_t_f1
  s_cmp_eq_u32 s60, 3
  s_cbranch_scc1 L_t_f2
  global_load_dword v16, v12, s[28:29]
  global_load_dword v17, v12, s[30:31]
  global_load_dword v18, v13, s[32:33]
  s_branch L_fin
L_t_wo:
  s_mov_b32 s70, 0
L_wo_p:
  global_load_dwordx4 v[104:107], v15, s[42:43] offset:0 sc1
  global_load_dwordx4 v[108:111], v15, s[42:43] offset:512 sc1
  global_load_dwordx4 v[112:115], v15, s[42:43] offset:1024 sc1
  global_load_dwordx4 v[116:119], v15, s[42:43] offset:1536 sc1
  s_waitcnt vmcnt(3)
  v_xor_b32 v104, s62, v104
  v_xor_b32 v105, s63, v105
  v_xor_b32 v106, s64, v106
  v_xor_b32 v107, s65, v107
  s_waitcnt vmcnt(2)
  v_xor_b32 v108, s62, v108
  v_xor_b32 v109, s63, v109
  v_xor_b32 v110, s64, v110
  v_xor_b32 v111, s65, v111
  s_waitcnt vmcnt(1)
  v_xor_b32 v112, s62, v112
  v_xor_b32 v113, s63, v113
  v_xor_b32 v114, s64, v114
  v_xor_b32 v115, s65, v115
  s_waitcnt vmcnt(0)
  v_xor_b32 v116, s62, v116
  v_xor_b32 v117, s63, v117
  v_xor_b32 v118, s64, v118
  v_xor_b32 v119, s65, v119
  v_or3_b32 v28, v104, v105, v106
  v_or3_b32 v29, v107, v108, v109
  v_or3_b32 v30, v110, v111, v112
  v_or3_b32 v31, v113, v114, v115
  v_or3_b32 v28, v28, v29, v30
  v_or3_b32 v31, v31, v116, v117
  v_or3_b32 v28, v28, v118, v119
  v_or_b32 v28, v28, v31
  v_lshlrev_b32 v28, 24, v28
  v_cmp_ne_u32 vcc, 0, v28
  v_pk_mul_f32 v[16:17], v[104:105], v[20:21] op_sel:[0,0] op_sel_hi:[1,0]
  v_pk_mul_f32 v[18:19], v[106:107], v[20:21] op_sel:[0,0] op_sel_hi:[1,0]
  v_pk_fma_f32 v[16:17], v[108:109], v[20:21], v[16:17] op_sel:[0,1,0] op_sel_hi:[1,1,1]
  v_pk_fma_f32 v[18:19], v[110:111], v[20:21], v[18:19] op_sel:[0,1,0] op_sel_hi:[1,1,1]
  v_pk_fma_f32 v[16:17], v[112:113], v[22:23], v[16:17] op_sel:[0,0,0] op_sel_hi:[1,0,1]
  v_pk_fma_f32 v[18:19], v[114:115], v[22:23], v[18:19] op_sel:[0,0,0] op_sel_hi:[1,0,1]
  v_pk_fma_f32 v[16:17], v[116:117], v[22:23], v[16:17] op_sel:[0,1,0] op_sel_hi:[1,1,1]
  v_pk_fma_f32 v[18:19], v[118:119], v[22:23], v[18:19] op_sel:[0,1,0] op_sel_hi:[1,1,1]
  s_cmp_eq_u64 vcc, 0
  s_cbranch_scc1 L_wo_ok
  s_add_u32 s70, s70, 1
  s_cmp_lt_u32 s70, 262144
  s_cbranch_scc1 L_wo_p
L_wo_ok:
  v_cvt_pk_bf16_f32 v16, v16, v17
  v_cvt_pk_bf16_f32 v17, v18, v19
  ds_write_b64 v12, v[16:17] offset:0
  ds_read_b128 v[104:107], v14 offset:0
  ds_read_b128 v[108:111], v14 offset:64
  ds_read_b128 v[112:115], v14 offset:128
  ds_read_b128 v[116:119], v14 offset:192
  s_waitcnt lgkmcnt(4)
  s_barrier
  ds_read_b128 v[120:123], v0 offset:0
  ds_read_b128 v[124:127], v0 offset:64
  ds_read_b128 v[128:131], v0 offset:128
  ds_read_b128 v[132:135], v0 offset:192
  s_waitcnt lgkmcnt(4)
  v_mfma_f32_16x16x32_bf16 v[8:11], v[40:43], v[104:107], 0
  ds_read_b128 v[136:139], v2 offset:0
  ds_read_b128 v[140:143], v2 offset:64
  v_mfma_f32_16x16x32_bf16 v[8:11], v[44:47], v[108:111], v[8:11]
  ds_read_b128 v[144:147], v2 offset:128
  ds_read_b128 v[148:151], v2 offset:192
  v_mfma_f32_16x16x32_bf16 v[8:11], v[48:51], v[112:115], v[8:11]
  ds_read_b128 v[152:155], v3 offset:0
  ds_read_b128 v[156:159], v3 offset:64
  v_mfma_f32_16x16x32_bf16 v[8:11], v[52:55], v[116:119], v[8:11]
  ds_read_b128 v[160:163], v3 offset:128
  ds_read_b128 v[164:167], v3 offset:192
  s_waitcnt lgkmcnt(11)
  v_mfma_f32_16x16x32_bf16 v[8:11], v[56:59], v[120:123], v[8:11]
  s_waitcnt lgkmcnt(10)
  v_mfma_f32_16x16x32_bf16 v[8:11], v[60:63], v[124:127], v[8:11]
  s_waitcnt lgkmcnt(9)
  v_mfma_f32_16x16x32_bf16 v[8:11], v[64:67], v[128:131], v[8:11]
  s_waitcnt lgkmcnt(8)
  v_mfma_f32_16x16x32_bf16 v[8:11], v[68:71], v[132:135], v[8:11]
  s_waitcnt lgkmcnt(7)
  v_mfma_f32_16x16x32_bf16 v[8:11], v[72:75], v[136:139], v[8:11]
  s_waitcnt lgkmcnt(6)
  v_mfma_f32_16x16x32_bf16 v[8:11], v[76:79], v[140:143], v[8:11]
  s_waitcnt lgkmcnt(5)
  v_mfma_f32_16x16x32_bf16 v[8:11], v[80:83], v[144:147], v[8:11]
  s_waitcnt lgkmcnt(4)
  v_mfma_f32_16x16x32_bf16 v[8:11], v[84:87], v[148:151], v[8:11]
  s_waitcnt lgkmcnt(3)
  v_mfma_f32_16x16x32_bf16 v[8:11], v[88:91], v[152:155], v[8:11]
  s_waitcnt lgkmcnt(2)
  v_mfma_f32_16x16x32_bf16 v[8:11], v[92:95], v[156:159], v[8:11]
  s_waitcnt lgkmcnt(1)
  v_mfma_f32_16x16x32_bf16 v[8:11], v[96:99], v[160:163], v[8:11]
  s_waitcnt lgkmcnt(0)
  v_mfma_f32_16x16x32_bf16 v[8:11], v[100:103], v[164:167], v[8:11]
  s_nop 5
  s_mov_b32 exec_lo, 0x00030003
  s_mov_b32 exec_hi, 0x00030003
  v_bfi_b32 v8, v36, s62, v8
  v_bfi_b32 v9, v36, s63, v9
  v_bfi_b32 v10, v36, s64, v10
  v_bfi_b32 v11, v36, s65, v11
  global_store_dwordx4 v13, v[8:11], s[42:43] sc1
  global_store_dwordx4 v37, v[8:11], s[42:43] sc1
  s_branch L_fin
L_t_f1:
  v_mov_b32 v2, v0
  s_add_u32 s51, s50, 8192
L_dma_86:
  s_mov_b32 m0, s50
  s_add_u32 s50, s50, 1024
  buffer_load_dwordx4 v2, s[44:47], s49 offen  lds
  s_add_u32 s49, s49, 88064
  s_cmp_lt_u32 s50, s51
  s_cbranch_scc1 L_dma_86
L_dmae_87:
  v_xor_b32 v2, 16, v2
  s_add_u32 s49, s49, s52
  s_add_u32 s50, s50, s53
  s_add_u32 s51, s50, 8192
L_dma_88:
  s_mov_b32 m0, s50
  s_add_u32 s50, s50, 1024
  buffer_load_dwordx4 v2, s[44:47], s49 offen  lds
  s_add_u32 s49, s49, 88064
  s_cmp_lt_u32 s50, s51
  s_cbranch_scc1 L_dma_88
L_dmae_89:
  v_mov_b32 v2, v6
  s_waitcnt vmcnt(0)
  s_barrier
  global_load_dwordx4 v[104:107], v15, s[42:43] sc1
  global_load_dwordx4 v[108:111], v35, s[42:43] sc1
  global_load_dwordx4 v[112:115], v32, s[42:43] sc1
  global_load_dwordx4 v[116:119], v36, s[42:43] sc1
  global_load_dwordx4 v[120:123], v33, s[42:43] sc1
  global_load_dwordx4 v[124:127], v37, s[42:43] sc1
  global_load_dwordx4 v[128:131], v34, s[42:43] sc1
  global_load_dwordx4 v[132:135], v39, s[42:43] sc1
  s_add_u32 s49, s5, 0
  s_and_b32 s49, s49, 3
  s_mul_i32 s49, s49, 4096
  v_add_u32 v3, s49, v2
  ds_read_b64_tr_b16 v[40:41], v3 offset:0
  ds_read_b64_tr_b16 v[42:43], v3 offset:512
  ds_read_b64_tr_b16 v[44:45], v3 offset:1024
  ds_read_b64_tr_b16 v[46:47], v3 offset:1536
  ds_read_b64_tr_b16 v[48:49], v3 offset:2048
  ds_read_b64_tr_b16 v[50:51], v3 offset:2560
  ds_read_b64_tr_b16 v[52:53], v3 offset:3072
  ds_read_b64_tr_b16 v[54:55], v3 offset:3584
  s_add_u32 s49, s5, 1
  s_and_b32 s49, s49, 3
  s_mul_i32 s49, s49, 4096
  v_add_u32 v3, s49, v2
  ds_read_b64_tr_b16 v[56:57], v3 offset:0
  ds_read_b64_tr_b16 v[58:59], v3 offset:512
  ds_read_b64_tr_b16 v[60:61], v3 offset:1024
  ds_read_b64_tr_b16 v[62:63], v3 offset:1536
  s_waitcnt lgkmcnt(10)
  ds_read_b64_tr_b16 v[64:65], v3 offset:2048
  ds_read_b64_tr_b16 v[66:67], v3 offset:2560
  s_waitcnt lgkmcnt(10)
  ds_read_b64_tr_b16 v[68:69], v3 offset:3072
  ds_read_b64_tr_b16 v[70:71], v3 offset:3584
  s_waitcnt lgkmcnt(10)
  s_add_u32 s49, s5, 2
  s_and_b32 s49, s49, 3
  s_mul_i32 s49, s49, 4096
  v_add_u32 v3, s49, v2
  ds_read_b64_tr_b16 v[72:73], v3 offset:0
  ds_read_b64_tr_b16 v[74:75], v3 offset:512
  s_waitcnt lgkmcnt(10)
  ds_read_b64_tr_b16 v[76:77], v3 offset:1024
  ds_read_b64_tr_b16 v[78:79], v3 offset:1536
  s_waitcnt lgkmcnt(10)
  ds_read_b64_tr_b16 v[80:81], v3 offset:2048
  ds_read_b64_tr_b16 v[82:83], v3 offset:2560
  s_waitcnt lgkmcnt(10)
  ds_read_b64_tr_b16 v[84:85], v3 offset:3072
  ds_read_b64_tr_b16 v[86:87], v3 offset:3584
  s_waitcnt lgkmcnt(10)
  s_add_u32 s49, s5, 3
  s_and_b32 s49, s49, 3
  s_mul_i32 s49, s49, 4096
  v_add_u32 v3, s49, v2
  ds_read_b64_tr_b16 v[88:89], v3 offset:0
  ds_read_b64_tr_b16 v[90:91], v3 offset:512
  s_waitcnt lgkmcnt(10)
  ds_read_b64_tr_b16 v[92:93], v3 offset:1024
  ds_read_b64_tr_b16 v[94:95], v3 offset:1536
  s_waitcnt lgkmcnt(10)
  ds_read_b64_tr_b16 v[96:97], v3 offset:2048
  ds_read_b64_tr_b16 v[98:99], v3 offset:2560
  s_waitcnt lgkmcnt(10)
  ds_read_b64_tr_b16 v[100:101], v3 offset:3072
  ds_read_b64_tr_b16 v[102:103], v3 offset:3584
  s_waitcnt lgkmcnt(10)
  s_waitcnt lgkmcnt(0)
  s_add_u32 s49, s5, 1
  s_and_b32 s49, s49, 3
  s_lshl_b32 s49, s49, 8
  v_add_u32 v0, s49, v14
  s_add_u32 s49, s5, 2
  s_and_b32 s49, s49, 3
  s_lshl_b32 s49, s49, 8
  v_add_u32 v2, s49, v14
  s_add_u32 s49, s5, 3
  s_and_b32 s49, s49, 3
  s_lshl_b32 s49, s49, 8
  v_add_u32 v3, s49, v14
  s_add_u32 s49, s5, 0
  s_and_b32 s49, s49, 3
  s_lshl_b32 s49, s49, 8
  v_add_u32 v14, s49, v14
  s_mov_b32 s70, 0
  s_mov_b32 s71, 15
  s_branch L_f1_c
L_f1_p:
  s_add_u32 s70, s70, 1
  s_cmp_ge_u32 s70, 262144
  s_cbranch_scc1 L_f1_ok
  s_bitcmp1_b32 s71, 0
  s_cbranch_scc0 L_fl_90
  global_load_dwordx4 v[104:107], v15, s[42:43] sc1
  global_load_dwordx4 v[108:111], v35, s[42:43] sc1
L_fl_90:
  s_bitcmp1_b32 s71, 1
  s_cbranch_scc0 L_fl_91
  global_load_dwordx4 v[112:115], v32, s[42:43] sc1
  global_load_dwordx4 v[116:119], v36, s[42:43] sc1
L_fl_91:
  s_bitcmp1_b32 s71, 2
  s_cbranch_scc0 L_fl_92
  global_load_dwordx4 v[120:123], v33, s[42:43] sc1
  global_load_dwordx4 v[124:127], v37, s[42:43] sc1
L_fl_92:
  s_bitcmp1_b32 s71, 3
  s_cbranch_scc0 L_fl_93
  global_load_dwordx4 v[128:131], v34, s[42:43] sc1
  global_load_dwordx4 v[132:135], v39, s[42:43] sc1
L_fl_93:
L_f1_c:
  s_waitcnt vmcnt(0)
  s_bitcmp1_b32 s71, 0
  s_cbranch_scc0 L_fc_94
  v_xor_b32 v104, s62, v104
  v_xor_b32 v105, s63, v105
  v_xor_b32 v106, s64, v106
  v_xor_b32 v107, s65, v107
  v_xor_b32 v108, s62, v108
  v_xor_b32 v109, s63, v109
  v_xor_b32 v110, s64, v110
  v_xor_b32 v111, s65, v111
  v_or3_b32 v8, v104, v105, v106
  v_or3_b32 v9, v107, v108, v109
  v_or3_b32 v8, v8, v110, v111
  v_pk_add_f32 v[136:137], v[104:105], v[108:109]
  v_pk_add_f32 v[138:139], v[106:107], v[110:111]
  v_or_b32 v8, v8, v9
  v_lshlrev_b32 v8, 24, v8
  v_cmp_ne_u32 vcc, 0, v8
  s_cmp_lg_u64 vcc, 0
  s_cbranch_scc1 L_fc_94
  s_bitset0_b32 s71, 0
L_fc_94:
  s_bitcmp1_b32 s71, 1
  s_cbranch_scc0 L_fc_95
  v_xor_b32 v112, s62, v112
  v_xor_b32 v113, s63, v113
  v_xor_b32 v114, s64, v114
  v_xor_b32 v115, s65, v115
  v_xor_b32 v116, s62, v116
  v_xor_b32 v117, s63, v117
  v_xor_b32 v118, s64, v118
  v_xor_b32 v119, s65, v119
  v_or3_b32 v8, v112, v113, v114
  v_or3_b32 v9, v115, v116, v117
  v_or3_b32 v8, v8, v118, v119
  v_pk_add_f32 v[144:145], v[112:113], v[116:117]
  v_pk_add_f32 v[146:147], v[114:115], v[118:119]
  v_or_b32 v8, v8, v9
  v_lshlrev_b32 v8, 24, v8
  v_cmp_ne_u32 vcc, 0, v8
  s_cmp_lg_u64 vcc, 0
  s_cbranch_scc1 L_fc_95
  s_bitset0_b32 s71, 1
L_fc_95:
  s_bitcmp1_b32 s71, 2
  s_cbranch_scc0 L_fc_96
  v_xor_b32 v120, s62, v120
  v_xor_b32 v121, s63, v121
  v_xor_b32 v122, s64, v122
  v_xor_b32 v123, s65, v123
  v_xor_b32 v124, s62, v124
  v_xor_b32 v125, s63, v125
  v_xor_b32 v126, s64, v126
  v_xor_b32 v127, s65, v127
  v_or3_b32 v8, v120, v121, v122
  v_or3_b32 v9, v123, v124, v125
  v_or3_b32 v8, v8, v126, v127
  v_pk_add_f32 v[152:153], v[120:121], v[124:125]
  v_pk_add_f32 v[154:155], v[122:123], v[126:127]
  v_or_b32 v8, v8, v9
  v_lshlrev_b32 v8, 24, v8
  v_cmp_ne_u32 vcc, 0, v8
  s_cmp_lg_u64 vcc, 0
  s_cbranch_scc1 L_fc_96
  s_bitset0_b32 s71, 2
L_fc_96:
  s_bitcmp1_b32 s71, 3
  s_cbranch_scc0 L_fc_97
  v_xor_b32 v128, s62, v128
  v_xor_b32 v129, s63, v129
  v_xor_b32 v130, s64, v130
  v_xor_b32 v131, s65, v131
  v_xor_b32 v132, s62, v132
  v_xor_b32 v133, s63, v133
  v_xor_b32 v134, s64, v134
  v_xor_b32 v135, s65, v135
  v_or3_b32 v8, v128, v129, v130
  v_or3_b32 v9, v131, v132, v133
  v_or3_b32 v8, v8, v134, v135
  v_pk_add_f32 v[160:161], v[128:129], v[132:133]
  v_pk_add_f32 v[162:163], v[130:131], v[134:135]
  v_or_b32 v8, v8, v9
  v_lshlrev_b32 v8, 24, v8
  v_cmp_ne_u32 vcc, 0, v8
  s_cmp_lg_u64 vcc, 0
  s_cbranch_scc1 L_fc_97
  s_bitset0_b32 s71, 3
L_fc_97:
  s_cmp_lg_u32 s71, 0
  s_cbranch_scc1 L_f1_p
L_f1_ok:
  v_pk_add_f32 v[136:137], v[136:137], v[144:145]
  v_pk_add_f32 v[138:139], v[138:139], v[146:147]
  v_pk_add_f32 v[152:153], v[152:153], v[160:161]
  v_pk_add_f32 v[154:155], v[154:155], v[162:163]
  v_pk_add_f32 v[136:137], v[136:137], v[152:153]
  v_pk_add_f32 v[138:139], v[138:139], v[154:155]
  v_pk_fma_f32 v[8:9], v[136:137], v[24:25], v[28:29]
  v_pk_fma_f32 v[10:11], v[138:139], v[26:27], v[30:31]
  v_cvt_pk_bf16_f32 v8, v8, v9
  v_cvt_pk_bf16_f32 v9, v10, v11
  ds_write_b64 v12, v[8:9] offset:0
  ds_read_b128 v[104:107], v14 offset:0
  ds_read_b128 v[108:111], v14 offset:64
  ds_read_b128 v[112:115], v14 offset:128
  ds_read_b128 v[116:119], v14 offset:192
  v_pk_fma_f32 v[16:17], v[136:137], v[20:21], v[16:17]
  v_pk_fma_f32 v[18:19], v[138:139], v[22:23], v[18:19]
  v_pk_mul_f32 v[10:11], v[16:17], v[16:17]
  v_pk_add_f32 v[20:21], v[16:17], v[18:19]
  v_pk_fma_f32 v[10:11], v[18:19], v[18:19], v[10:11]
  v_add_f32 v20, v20, v21
  v_add_f32 v21, v10, v11
  ds_write_b64 v5, v[20:21] offset:12032
  s_waitcnt lgkmcnt(0)
  s_barrier
  ds_read_b128 v[120:123], v0 offset:0
  ds_read_b128 v[124:127], v0 offset:64
  ds_read_b128 v[128:131], v0 offset:128
  ds_read_b128 v[132:135], v0 offset:192
  ds_read_b128 v[20:23], v7 offset:12032
  ds_read_b128 v[24:27], v7 offset:12048
  v_mfma_f32_16x16x32_bf16 v[32:35], v[40:43], v[104:107], 0
  ds_read_b128 v[136:139], v2 offset:0
  ds_read_b128 v[140:143], v2 offset:64
  v_mfma_f32_16x16x32_bf16 v[32:35], v[44:47], v[108:111], v[32:35]
  ds_read_b128 v[144:147], v2 offset:128
  ds_read_b128 v[148:151], v2 offset:192
  v_mfma_f32_16x16x32_bf16 v[32:35], v[48:51], v[112:115], v[32:35]
  ds_read_b128 v[152:155], v3 offset:0
  ds_read_b128 v[156:159], v3 offset:64
  v_mfma_f32_16x16x32_bf16 v[32:35], v[52:55], v[116:119], v[32:35]
  ds_read_b128 v[160:163], v3 offset:128
  ds_read_b128 v[164:167], v3 offset:192
  s_waitcnt lgkmcnt(13)
  v_mfma_f32_16x16x32_bf16 v[32:35], v[56:59], v[120:123], v[32:35]
  s_waitcnt lgkmcnt(12)
  v_mfma_f32_16x16x32_bf16 v[32:35], v[60:63], v[124:127], v[32:35]
  s_waitcnt lgkmcnt(8)
  v_pk_add_f32 v[20:21], v[20:21], v[22:23]
  v_pk_add_f32 v[24:25], v[24:25], v[26:27]
  v_mfma_f32_16x16x32_bf16 v[32:35], v[64:67], v[128:131], v[32:35]
  v_pk_add_f32 v[20:21], v[20:21], v[24:25]
  s_nop 0
  v_mfma_f32_16x16x32_bf16 v[32:35], v[68:71], v[132:135], v[32:35]
  v_add_f32_dpp v20, v20, v20 quad_perm:[2,3,0,1] row_mask:0xf bank_mask:0xf
  v_add_f32_dpp v21, v21, v21 quad_perm:[2,3,0,1] row_mask:0xf bank_mask:0xf
  s_waitcnt lgkmcnt(7)
  v_mfma_f32_16x16x32_bf16 v[32:35], v[72:75], v[136:139], v[32:35]
  v_add_f32_dpp v20, v20, v20 row_ror:4 row_mask:0xf bank_mask:0xf
  v_add_f32_dpp v21, v21, v21 row_ror:4 row_mask:0xf bank_mask:0xf
  s_waitcnt lgkmcnt(6)
  v_mfma_f32_16x16x32_bf16 v[32:35], v[76:79], v[140:143], v[32:35]
  v_add_f32_dpp v20, v20, v20 row_ror:8 row_mask:0xf bank_mask:0xf
  v_add_f32_dpp v21, v21, v21 row_ror:8 row_mask:0xf bank_mask:0xf
  s_waitcnt lgkmcnt(5)
  v_mfma_f32_16x16x32_bf16 v[32:35], v[80:83], v[144:147], v[32:35]
  v_mov_b32 v22, v20
  v_mov_b32 v23, v21
  s_waitcnt lgkmcnt(4)
  v_mfma_f32_16x16x32_bf16 v[32:35], v[84:87], v[148:151], v[32:35]
  v_permlane16_swap_b32 v22, v20
  v_permlane16_swap_b32 v23, v21
  s_waitcnt lgkmcnt(3)
  v_mfma_f32_16x16x32_bf16 v[32:35], v[88:91], v[152:155], v[32:35]
  v_add_f32 v20, v20, v22
  v_add_f32 v21, v21, v23
  v_mov_b32 v22, v20
  v_mov_b32 v23, v21
  s_waitcnt lgkmcnt(2)
  v_mfma_f32_16x16x32_bf16 v[32:35], v[92:95], v[156:159], v[32:35]
  v_permlane32_swap_b32 v22, v20
  v_permlane32_swap_b32 v23, v21
  s_waitcnt lgkmcnt(1)
  v_mfma_f32_16x16x32_bf16 v[32:35], v[96:99], v[160:163], v[32:35]
  v_add_f32 v20, v20, v22
  v_add_f32 v21, v21, v23
  s_waitcnt lgkmcnt(0)
  v_mfma_f32_16x16x32_bf16 v[32:35], v[100:103], v[164:167], v[32:35]
  v_mul_f32 v20, 0xbb000000, v20
  v_mul_f32 v21, 0x3b000000, v21
  v_fma_f32 v21, -v20, v20, v21
  v_max_f32 v21, 0, v21
  v_add_f32 v21, 0x3727c5ac, v21
  v_rsq_f32 v21, v21
  s_nop 1
  v_fmac_f32_dpp v32, v32, v20 row_shl:2 row_mask:0xf bank_mask:0x1
  v_fmac_f32_dpp v33, v33, v20 row_shl:2 row_mask:0xf bank_mask:0x1
  v_fmac_f32_dpp v34, v34, v20 row_shl:2 row_mask:0xf bank_mask:0x1
  v_fmac_f32_dpp v35, v35, v20 row_shl:2 row_mask:0xf bank_mask:0x1
  v_mul_f32 v8, v32, v21
  v_mul_f32 v9, v33, v21
  v_mul_f32 v10, v34, v21
  v_mul_f32 v11, v35, v21
  v_add_f32_dpp v8, v32, v8 row_shl:4 row_mask:0xf bank_mask:0xf
  v_add_f32_dpp v9, v33, v9 row_shl:4 row_mask:0xf bank_mask:0xf
  v_add_f32_dpp v10, v34, v10 row_shl:4 row_mask:0xf bank_mask:0xf
  v_add_f32_dpp v11, v35, v11 row_shl:4 row_mask:0xf bank_mask:0xf
  s_mov_b32 s50, 0x000f000f
  s_mov_b32 s51, 0x000f000f
  v_permlane32_swap_b32 v8, v10
  v_permlane32_swap_b32 v9, v11
  v_mul_f32 v20, 0xbfb8aa3b, v8
  v_mul_f32 v21, 0xbfb8aa3b, v9
  v_exp_f32 v20, v20
  v_exp_f32 v21, v21
  v_mul_f32 v8, v8, v10
  v_mul_f32 v9, v9, v11
  v_add_f32 v20, 1.0, v20
  v_add_f32 v21, 1.0, v21
  v_rcp_f32 v20, v20
  v_rcp_f32 v21, v21
  s_mov_b64 exec, s[50:51]
  v_mul_f32 v8, v8, v20
  v_mul_f32 v9, v9, v21
  v_cvt_pk_bf16_f32 v8, v8, v9
  v_mov_b32 v9, s74
  global_store_dwordx2 v13, v[8:9], s[42:43] sc1
  global_store_dwordx2 v4, v[8:9], s[42:43] sc1
  s_branch L_fin
L_t_f2:
  v_mov_b32 v2, v29
  s_and_b32 s59, s61, 3
  s_mul_i32 s59, s59, 3072
  s_mul_i32 s49, s5, 360448
  s_add_u32 s49, s49, s48
  s_mul_i32 s50, s5, 11264
  s_add_u32 s50, s50, 20480
  s_lshl_b32 s52, s59, 5
  s_add_u32 s49, s49, s52
  s_add_u32 s50, s50, s59
  s_sub_u32 s52, 11264, s59
  s_add_u32 s51, s50, s52
  s_cmp_lt_u32 s50, s51
  s_cbranch_scc0 L_dmae_99
L_dma_98:
  s_mov_b32 m0, s50
  s_add_u32 s50, s50, 1024
  buffer_load_dwordx4 v2, s[44:47], s49 offen  lds
  s_add_u32 s49, s49, 32768
  s_cmp_lt_u32 s50, s51
  s_cbranch_scc1 L_dma_98
L_dmae_99:
  s_mul_i32 s49, s5, 360448
  s_add_u32 s49, s49, s48
  s_mul_i32 s50, s5, 11264
  s_add_u32 s50, s50, 20480
  s_add_u32 s51, s50, s59
  s_cmp_lt_u32 s50, s51
  s_cbranch_scc0 L_dmae_101
L_dma_100:
  s_mov_b32 m0, s50
  s_add_u32 s50, s50, 1024
  buffer_load_dwordx4 v2, s[44:47], s49 offen  lds
  s_add_u32 s49, s49, 32768
  s_cmp_lt_u32 s50, s51
  s_cbranch_scc1 L_dma_100
L_dmae_101:
  v_mov_b32 v2, v6
  s_mov_b32 s50, 0x00030003
  s_mov_b32 s51, 0x00030003
  s_mov_b32 s53, 0x0fff0fff
  s_cmp_eq_u32 s5, 3
  s_cselect_b32 s52, 0x00ff00ff, s53
  s_mov_b32 s53, s52
  s_cmp_lg_u32 s5, 0
  s_cbranch_scc1 L_f2_w
  s_mov_b64 exec, s[50:51]
  global_load_dwordx4 v[104:107], v15, s[42:43] sc1
  global_load_dwordx4 v[108:111], v35, s[42:43] sc1
  global_load_dwordx4 v[112:115], v32, s[42:43] sc1
  global_load_dwordx4 v[116:119], v36, s[42:43] sc1
  global_load_dwordx4 v[120:123], v33, s[42:43] sc1
  global_load_dwordx4 v[124:127], v37, s[42:43] sc1
  global_load_dwordx4 v[128:131], v34, s[42:43] sc1
  global_load_dwordx4 v[132:135], v39, s[42:43] sc1
  s_mov_b64 exec, -1
  s_waitcnt vmcnt(8)
  s_branch L_f2_w2
L_f2_w:
  s_waitcnt vmcnt(0)
L_f2_w2:
  ds_read_b64_tr_b16 v[40:41], v2 offset:0
  ds_read_b64_tr_b16 v[42:43], v2 offset:128
  ds_read_b64_tr_b16 v[44:45], v2 offset:1024
  ds_read_b64_tr_b16 v[46:47], v2 offset:1152
  ds_read_b64_tr_b16 v[48:49], v2 offset:2048
  ds_read_b64_tr_b16 v[50:51], v2 offset:2176
  ds_read_b64_tr_b16 v[52:53], v2 offset:3072
  ds_read_b64_tr_b16 v[54:55], v2 offset:3200
  ds_read_b64_tr_b16 v[56:57], v2 offset:4096
  ds_read_b64_tr_b16 v[58:59], v2 offset:4224
  ds_read_b64_tr_b16 v[60:61], v2 offset:5120
  ds_read_b64_tr_b16 v[62:63], v2 offset:5248
  s_waitcnt lgkmcnt(10)
  ds_read_b64_tr_b16 v[64:65], v2 offset:6144
  ds_read_b64_tr_b16 v[66:67], v2 offset:6272
  s_waitcnt lgkmcnt(10)
  ds_read_b64_tr_b16 v[68:69], v2 offset:7168
  ds_read_b64_tr_b16 v[70:71], v2 offset:7296
  s_waitcnt lgkmcnt(10)
  ds_read_b64_tr_b16 v[72:73], v2 offset:8192
  ds_read_b64_tr_b16 v[74:75], v2 offset:8320
  s_waitcnt lgkmcnt(10)
  ds_read_b64_tr_b16 v[76:77], v2 offset:9216
  ds_read_b64_tr_b16 v[78:79], v2 offset:9344
  s_waitcnt lgkmcnt(10)
  ds_read_b64_tr_b16 v[80:81], v2 offset:10240
  ds_read_b64_tr_b16 v[82:83], v2 offset:10368
  s_waitcnt lgkmcnt(10)
  s_waitcnt lgkmcnt(0)
  s_cmp_lg_u32 s5, 0
  s_cbranch_scc1 L_f2x_102
  s_mov_b32 s70, 0
  s_mov_b64 exec, s[50:51]
  s_branch L_f2_ac
L_f2_a:
  s_mov_b64 exec, s[50:51]
  global_load_dwordx4 v[104:107], v15, s[42:43] sc1
  global_load_dwordx4 v[108:111], v35, s[42:43] sc1
  global_load_dwordx4 v[112:115], v32, s[42:43] sc1
  global_load_dwordx4 v[116:119], v36, s[42:43] sc1
  global_load_dwordx4 v[120:123], v33, s[42:43] sc1
  global_load_dwordx4 v[124:127], v37, s[42:43] sc1
  global_load_dwordx4 v[128:131], v34, s[42:43] sc1
  global_load_dwordx4 v[132:135], v39, s[42:43] sc1
L_f2_ac:
  s_waitcnt vmcnt(0)
  v_xor_b32 v136, s62, v104
  v_xor_b32 v137, s63, v105
  v_xor_b32 v138, s64, v106
  v_xor_b32 v139, s65, v107
  v_xor_b32 v140, s62, v108
  v_xor_b32 v141, s63, v109
  v_xor_b32 v142, s64, v110
  v_xor_b32 v143, s65, v111
  v_xor_b32 v144, s62, v112
  v_xor_b32 v145, s63, v113
  v_xor_b32 v146, s64, v114
  v_xor_b32 v147, s65, v115
  v_xor_b32 v148, s62, v116
  v_xor_b32 v149, s63, v117
  v_xor_b32 v150, s64, v118
  v_xor_b32 v151, s65, v119
  v_xor_b32 v152, s62, v120
  v_xor_b32 v153, s63, v121
  v_xor_b32 v154, s64, v122
  v_xor_b32 v155, s65, v123
  v_xor_b32 v156, s62, v124
  v_xor_b32 v157, s63, v125
  v_xor_b32 v158, s64, v126
  v_xor_b32 v159, s65, v127
  v_xor_b32 v160, s62, v128
  v_xor_b32 v161, s63, v129
  v_xor_b32 v162, s64, v130
  v_xor_b32 v163, s65, v131
  v_xor_b32 v164, s62, v132
  v_xor_b32 v165, s63, v133
  v_xor_b32 v166, s64, v134
  v_xor_b32 v167, s65, v135
  v_or3_b32 v8, v136, v137, v138
  v_or3_b32 v9, v144, v145, v146
  v_or3_b32 v10, v152, v153, v154
  v_or3_b32 v11, v160, v161, v162
  v_or3_b32 v8, v8, v139, v140
  v_or3_b32 v9, v9, v147, v148
  v_or3_b32 v10, v10, v155, v156
  v_or3_b32 v11, v11, v163, v164
  v_or3_b32 v8, v8, v141, v142
  v_or3_b32 v9, v9, v149, v150
  v_or3_b32 v10, v10, v157, v158
  v_or3_b32 v11, v11, v165, v166
  v_or_b32 v8, v8, v143
  v_or_b32 v9, v9, v151
  v_or_b32 v10, v10, v159
  v_or_b32 v11, v11, v167
  v_or3_b32 v3, v8, v9, v10
  v_or_b32 v3, v3, v11
  v_lshlrev_b32 v3, 24, v3
  v_cmp_ne_u32 vcc, 0, v3
  s_cmp_eq_u64 vcc, 0
  s_cbranch_scc1 L_f2_ad
  s_sleep 2
  s_add_u32 s70, s70, 1
  s_cmp_lt_u32 s70, 262144
  s_cbranch_scc1 L_f2_a
L_f2_ad:
  s_mov_b64 exec, -1
  v_pk_add_f32 v[136:137], v[136:137], v[140:141]
  v_pk_add_f32 v[138:139], v[138:139], v[142:143]
  v_pk_add_f32 v[144:145], v[144:145], v[148:149]
  v_pk_add_f32 v[146:147], v[146:147], v[150:151]
  v_pk_add_f32 v[152:153], v[152:153], v[156:157]
  v_pk_add_f32 v[154:155], v[154:155], v[158:159]
  v_pk_add_f32 v[160:161], v[160:161], v[164:165]
  v_pk_add_f32 v[162:163], v[162:163], v[166:167]
  v_pk_add_f32 v[136:137], v[136:137], v[144:145]
  v_pk_add_f32 v[138:139], v[138:139], v[146:147]
  v_pk_add_f32 v[152:153], v[152:153], v[160:161]
  v_pk_add_f32 v[154:155], v[154:155], v[162:163]
  v_pk_add_f32 v[136:137], v[136:137], v[152:153]
  v_pk_add_f32 v[138:139], v[138:139], v[154:155]
  v_cvt_pk_bf16_f32 v136, 0, v136
  v_cvt_pk_bf16_f32 v137, 0, v137
  v_cvt_pk_bf16_f32 v138, 0, v138
  v_cvt_pk_bf16_f32 v139, 0, v139
  v_mul_f32 v136, v136, v20
  v_mul_f32 v137, v137, v21
  v_mul_f32 v138, v138, v22
  v_mul_f32 v139, v139, v23
  v_cvt_pk_bf16_f32 v136, 0, v136
  v_cvt_pk_bf16_f32 v137, 0, v137
  v_cvt_pk_bf16_f32 v138, 0, v138
  v_cvt_pk_bf16_f32 v139, 0, v139
  v_add_f32 v16, v16, v136
  v_add_f32 v17, v17, v137
  v_add_f32 v18, v18, v138
  v_add_f32 v19, v19, v139
  v_cvt_pk_bf16_f32 v16, 0, v16
  v_cvt_pk_bf16_f32 v17, 0, v17
  v_cvt_pk_bf16_f32 v18, 0, v18
  v_cvt_pk_bf16_f32 v19, 0, v19
L_f2x_102:
  v_mov_b32 v112, 0
  v_mov_b32 v113, 0
  v_mov_b32 v114, 0
  v_mov_b32 v115, 0
  s_mov_b32 s70, 0
L_f2_p:
  global_load_dwordx4 v[104:107], v28, s[42:43] offset:-2048 sc1
  global_load_dwordx4 v[108:111], v28, s[42:43] sc1
  s_mov_b64 exec, s[52:53]
  global_load_dwordx4 v[112:115], v28, s[42:43] offset:2048 sc1
  s_mov_b64 exec, -1
  s_waitcnt vmcnt(2)
  v_xor_b32 v105, s74, v105
  v_xor_b32 v107, s74, v107
  s_waitcnt vmcnt(1)
  v_xor_b32 v109, s74, v109
  v_xor_b32 v111, s74, v111
  s_waitcnt vmcnt(0)
  v_xor_b32 v113, s74, v113
  v_xor_b32 v115, s74, v115
  v_or3_b32 v31, v105, v107, v109
  v_or_b32 v3, v113, v115
  v_or_b32 v31, v111, v31
  v_cmp_ne_u32 s[68:69], 0, v3
  v_cmp_ne_u32 vcc, 0, v31
  v_mov_b32_dpp v105, v104 quad_perm:[2,3,2,3] row_mask:0xf bank_mask:0xf
  v_mov_b32_dpp v107, v106 quad_perm:[2,3,2,3] row_mask:0xf bank_mask:0xf
  v_mov_b32_dpp v109, v108 quad_perm:[2,3,2,3] row_mask:0xf bank_mask:0xf
  v_mov_b32_dpp v111, v110 quad_perm:[2,3,2,3] row_mask:0xf bank_mask:0xf
  v_mov_b32_dpp v113, v112 quad_perm:[2,3,2,3] row_mask:0xf bank_mask:0xf
  v_mov_b32_dpp v115, v114 quad_perm:[2,3,2,3] row_mask:0xf bank_mask:0xf
  s_and_b64 s[68:69], s[68:69], s[52:53]
  s_or_b64 vcc, vcc, s[68:69]
  v_mfma_f32_16x16x32_bf16 v[120:123], v[40:43], v[104:107], 0
  v_mfma_f32_16x16x32_bf16 v[124:127], v[44:47], v[104:107], 0
  v_mfma_f32_16x16x32_bf16 v[128:131], v[48:51], v[104:107], 0
  v_mfma_f32_16x16x32_bf16 v[132:135], v[52:55], v[104:107], 0
  s_cmp_eq_u64 vcc, 0
  s_cbranch_scc1 L_f2_ok
  s_add_u32 s70, s70, 1
  s_cmp_lt_u32 s70, 262144
  s_cbranch_scc1 L_f2_p
L_f2_ok:
  v_mfma_f32_16x16x32_bf16 v[120:123], v[56:59], v[108:111], v[120:123]
  v_mfma_f32_16x16x32_bf16 v[124:127], v[60:63], v[108:111], v[124:127]
  v_mfma_f32_16x16x32_bf16 v[128:131], v[64:67], v[108:111], v[128:131]
  v_mfma_f32_16x16x32_bf16 v[132:135], v[68:71], v[108:111], v[132:135]
  v_mfma_f32_16x16x32_bf16 v[120:123], v[72:75], v[112:115], v[120:123]
  v_mfma_f32_16x16x32_bf16 v[124:127], v[76:79], v[112:115], v[124:127]
  v_mfma_f32_16x16x32_bf16 v[128:131], v[80:83], v[112:115], v[128:131]
  s_nop 6
  v_add_f32_dpp v8, v124, v120 row_shl:4 row_mask:0xf bank_mask:0xf
  v_add_f32_dpp v9, v125, v121 row_shl:4 row_mask:0xf bank_mask:0xf
  v_add_f32_dpp v10, v126, v122 row_shl:4 row_mask:0xf bank_mask:0xf
  v_add_f32_dpp v11, v127, v123 row_shl:4 row_mask:0xf bank_mask:0xf
  v_add_f32_dpp v128, v132, v128 row_shl:4 row_mask:0xf bank_mask:0xf
  v_add_f32_dpp v129, v133, v129 row_shl:4 row_mask:0xf bank_mask:0xf
  v_add_f32_dpp v130, v134, v130 row_shl:4 row_mask:0xf bank_mask:0xf
  v_add_f32_dpp v131, v135, v131 row_shl:4 row_mask:0xf bank_mask:0xf
  v_add_f32_dpp v8, v128, v8 row_shl:8 row_mask:0xf bank_mask:0xf
  v_add_f32_dpp v9, v129, v9 row_shl:8 row_mask:0xf bank_mask:0xf
  v_add_f32_dpp v10, v130, v10 row_shl:8 row_mask:0xf bank_mask:0xf
  v_add_f32_dpp v11, v131, v11 row_shl:8 row_mask:0xf bank_mask:0xf
  s_mov_b64 exec, s[50:51]
  ds_write_b128 v30, v[8:11]
  s_waitcnt lgkmcnt(0)
  s_barrier
  s_cmp_lg_u32 s5, 0
  s_cbranch_scc1 L_fin
  ds_read_b128 v[104:107], v12 offset:128
  ds_read_b128 v[108:111], v12 offset:256
  ds_read_b128 v[112:115], v12 offset:384
  s_waitcnt lgkmcnt(2)
  v_pk_add_f32 v[8:9], v[8:9], v[104:105]
  v_pk_add_f32 v[10:11], v[10:11], v[106:107]
  s_waitcnt lgkmcnt(0)
  v_pk_add_f32 v[108:109], v[108:109], v[112:113]
  v_pk_add_f32 v[110:111], v[110:111], v[114:115]
  v_pk_add_f32 v[8:9], v[8:9], v[108:109]
  v_pk_add_f32 v[10:11], v[10:11], v[110:111]
  v_pk_fma_f32 v[8:9], v[8:9], v[24:25], v[16:17]
  v_pk_fma_f32 v[10:11], v[10:11], v[26:27], v[18:19]
  v_cvt_pk_bf16_f32 v8, v8, v9
  v_cvt_pk_bf16_f32 v9, v10, v11
  global_store_dwordx2 v13, v[8:9], s[38:39]
  s_mov_b64 exec, 1
  s_cmp_lg_u32 s61, 0
  s_cbranch_scc1 L_noep
  v_mov_b32 v10, s74
  global_store_dword v38, v10, s[42:43] offset:0
L_noep:
L_fin:
L_end:
  s_endpgm
.p2align 7
L_table:
  .long 0x0380281d, 0x0380386e, 0x03803801, 0x038038c6, 0x0380383e, 0x03802835, 0x0380319e, 0x038038a6
  .long 0x078038ae, 0x03803809, 0x03802865, 0x0780286d, 0x07803886, 0x078039fe, 0x078038e6, 0x078038ee
  .long 0x0b803986, 0x078038fe, 0x07803996, 0x0b80390e, 0x0b803916, 0x0b80388e, 0x0b80392e, 0x0b803856
  .long 0x0f803866, 0x0b8038b6, 0x0b8039e6, 0x03803819, 0x0f8039f6, 0x03803819, 0x0f80283d, 0x0f802845
  .long 0x13802805, 0x0f80285d, 0x0f803876, 0x0f8030de, 0x13803075, 0x0f80396e, 0x03803821, 0x03803821
  .long 0x1780304d, 0x13803946, 0x13803015, 0x138039ee, 0x178039ae, 0x1380315e, 0x13803806, 0x1380380e
  .long 0x1b803816, 0x1780280d, 0x1780394e, 0x17803956, 0x03803831, 0x1780287d, 0x17803896, 0x03803831
  .long 0x03803839, 0x1b802855, 0x1b803906, 0x1b802825, 0x1b80282d, 0x1b803926, 0x03803839, 0x17803936
  .long 0x1f9439ce, 0x1f9c418e, 0x1f9c30f4, 0x039c3801, 0x039c3801, 0x1f9438d6, 0x1b9839be, 0x1b9c41c6
  .long 0x239c40f6, 0x239c30a4, 0x2394389e, 0x1f94387e, 0x1f9c4166, 0x039c3809, 0x039c3809, 0x039c3809
  .long 0x279c413e, 0x039c3811, 0x279c402e, 0x039c3811, 0x039c3811, 0x039c3811, 0x1f9c404e, 0x1f9c31de
  .long 0x039c3819, 0x039c3819, 0x039c3819, 0x239c28b4, 0x039c3819, 0x239c290c, 0x23943976, 0x2394397e
  .long 0x2b94381e, 0x27943826, 0x039c3821, 0x03983821, 0x03983821, 0x279c3846, 0x279c3164, 0x279c308c
  .long 0x03983829, 0x2b9c39d6, 0x03983829, 0x039c3829, 0x239c40ce, 0x03983829, 0x039c3829, 0x039c3829
  .long 0x039c3831, 0x2f94385e, 0x039c3831, 0x279c3836, 0x279c30bc, 0x2b9439b6, 0x039c3831, 0x2b9c28d4
  .long 0x2f9c312c, 0x03943839, 0x2b9c40be, 0x2b9439a6, 0x2b94391e, 0x039c3839, 0x2b9c2884, 0x039c3839
  .long 0x03b03801, 0x03bc4001, 0x2fb4313c, 0x5bb8488a, 0x2fb828dc, 0x03b03801, 0x03b43801, 0x03bc4001
  .long 0x03bc4009, 0x33b430ec, 0x03b03809, 0x03b03809, 0x03bc4009, 0x6bb848e2, 0x2fb8291c, 0x83b84952
  .long 0x03bc4011, 0x83b84852, 0x03bc4011, 0x87b848a2, 0x83b848d2, 0x2fb82954, 0x03bc4011, 0x03b43811
  .long 0x43b84802, 0xcbb84842, 0x33b8289c, 0x2fb03174, 0xdfb848ca, 0x33b030c4, 0x03b03819, 0x03b03819
  .long 0x03b03821, 0x03b03821, 0x87b84882, 0x33b43144, 0x33b4314c, 0x03b83821, 0x33b430cc, 0x2fb4316c
  .long 0x33b43094, 0x03b83829, 0x37b430ac, 0x37b828fc, 0x03bc4029, 0x37b4317c, 0xe7b84922, 0x33b8295c
  .long 0xc3b84812, 0x03b03831, 0x83b8487a, 0x03b83831, 0x37b43104, 0x03b03831, 0x73b8490a, 0x37b03124
  .long 0x37b430e4, 0x37b03134, 0x03bc4039, 0x03b03839, 0x03b03839, 0x6fb848ea, 0x37b03114, 0xefb8494a
  .long 0x03cc680b, 0x4bdc4832, 0x03cc6843, 0x83dc489a, 0x03cc6883, 0x03cc68b3, 0x87d060c3, 0x7bdc4932
  .long 0x87dc482a, 0x03cc6833, 0x03cc6853, 0x03cc6873, 0xdbdc48c2, 0x83dc48f2, 0x03cc68d3, 0xebdc4942
  .long 0x83dc4822, 0xcfdc484a, 0xd7dc4872, 0x5fdc4892, 0x87dc48da, 0x03cc68a3, 0x77dc4912, 0x87d060e3
  .long 0xc7dc481a, 0x4fdc483a, 0x03cc684b, 0x3bc87000, 0x67dc48ba, 0x3bc87000, 0x03cc68db, 0x03cc68eb
  .long 0x03cc681b, 0x03cc682b, 0xd3dc486a, 0x03cc686b, 0x03cc688b, 0x03d45902, 0x03cc68cb, 0x03cc68f3
  .long 0x03cc6803, 0x87d45823, 0x03cc685b, 0x03cc687b, 0x63dc48b2, 0x03cc68bb, 0xe3dc491a, 0x03cc68fb
  .long 0x47dc480a, 0x03cc683b, 0x57dc4862, 0x03d458aa, 0x03cc689b, 0x03cc68ab, 0x83dc492a, 0x3bc87000
  .long 0x03cc6813, 0x3bc87000, 0x53dc485a, 0x03cc6863, 0x03cc6893, 0x87dc48fa, 0x3bc87000, 0x7fdc493a
L_gtab:
  .long 0x017c0000, 0x00000000
  .long 0x02bc0180, 0x00000080
  .long 0x043c02c0, 0x00000100
  .long 0x057c0440, 0x00000180
  .long 0x06fc0580, 0x00000200
  .long 0x083c0700, 0x00000280
  .long 0x097c0840, 0x00000300
  .long 0x0abc0980, 0x00000380
.section .rodata,"a"
.p2align 6
.amdhsa_kernel adaLN_cond__sliding_block_cached__glu_gated_swiglu__decode_kernel
  .amdhsa_next_free_vgpr 168
  .amdhsa_next_free_sgpr 102
  .amdhsa_accum_offset 168
  .amdhsa_group_segment_fixed_size 0
  .amdhsa_kernarg_size 112
  .amdhsa_user_sgpr_count 2
  .amdhsa_user_sgpr_kernarg_segment_ptr 1
  .amdhsa_system_sgpr_workgroup_id_x 1
.end_amdhsa_kernel
```
